```python
import torch

def _softmax(x, axis=-1):
    return torch.softmax(x, dim=axis)
def _gelu(x):
    return torch.nn.functional.gelu(x, approximate="tanh")
def _silu(x):
    return torch.nn.functional.silu(x)
def _sigmoid(x):
    return torch.sigmoid(x)
def _layernorm(x, axis=-1, eps=1e-5):
    m = x.mean(dim=axis, keepdim=True)
    v = x.var(dim=axis, keepdim=True, unbiased=False)
    return (x - m) / torch.sqrt(v + eps)
def _scatter_add(tgt, idx, src, axis=0):
    return tgt.clone().index_add_(axis, idx, src)
def _segment_sum(src, seg, n):
    out = torch.zeros((n,) + src.shape[1:], dtype=src.dtype)
    return out.index_add_(0, seg, src)
def _pad(x, pw):
    flat = tuple(v for pair in reversed(pw) for v in pair)
    return torch.nn.functional.pad(x, flat)

kernel_name = 'recurrent_scan__sliding_block_cached__mixer_token_mlp__prompt'

def setup_inputs():

    _w = (lambda a: (lambda t: t.to(torch.bfloat16) if t.is_floating_point() else t)(torch.as_tensor(a)))
    def _A_setup():
        B, Sq, D = 1, 2048, 1024
        Hq, Hkv, Sk, Dh = 32, 4, 2048, 128
        assert Hq % Hkv == 0, (Hq, Hkv)
        return {
            "x": _w((lambda *s: torch.randn(*s, dtype=torch.bfloat16) * 0.05)(B, Sq, D)),
            "k_cache": _w((lambda *s: torch.randn(*s, dtype=torch.bfloat16) * 1.6)(B, Hkv, Sk, Dh)),
            "v_cache": _w((lambda *s: torch.randn(*s, dtype=torch.bfloat16) * 0.8)(B, Hkv, Sk, Dh)),
            "wq": _w((lambda *s: torch.randn(*s, dtype=torch.bfloat16) * 1.6)(D, Hq * Dh) * (D ** -0.5)),
            "wo": _w((lambda *s: torch.randn(*s, dtype=torch.bfloat16) * 0.8)(Hq * Dh, D) * ((Hq * Dh) ** -0.5)),
        }
    _A_in = _A_setup()

    def _B_setup():
        B, S, D, F = 1, 2048, 1024, 3584
        return {
            "x": _w((lambda *s: torch.randn(*s, dtype=torch.bfloat16) * 0.05)(B, S, D)),
            "w1": _w((lambda *s: torch.randn(*s, dtype=torch.bfloat16) * 1.6)(S, F) * (S ** -0.5)),
            "b1": _w((lambda *s: torch.randn(*s, dtype=torch.bfloat16) * 1.6)(F) * 0.02),
            "w2": _w((lambda *s: torch.randn(*s, dtype=torch.bfloat16) * 0.2)(F, S) * (F ** -0.5)),
            "b2": _w((lambda *s: torch.randn(*s, dtype=torch.bfloat16) * 0.2)(S) * 0.02),
        }
    _B_in = _B_setup()

    return {
        "A_x": _A_in["x"],
        "A_k_cache": _A_in["k_cache"],
        "A_v_cache": _A_in["v_cache"],
        "A_wq": _A_in["wq"],
        "A_wo": _A_in["wo"],
        "B_x": _B_in["x"],
        "B_w1": _B_in["w1"],
        "B_b1": _B_in["b1"],
        "B_w2": _B_in["w2"],
        "B_b2": _B_in["b2"],
    }

def reference(A_x, A_k_cache, A_v_cache, A_wq, A_wo, B_x, B_w1, B_b1, B_w2, B_b2):
    def _A_ref(x, k_cache, v_cache, wq, wo):
        B, Sq, D = x.shape
        Hq, Dh = 32, 128
        Hkv, Sk = k_cache.shape[1], k_cache.shape[2]
        W = min(4096, max(256, Sk // 4))
        rep = Hq // Hkv
        q = (lambda x, *d: x.permute(*d))((x @ wq).reshape(B, Sq, Hq, Dh), 0, 2, 1, 3)
        k = (lambda x, n, axis: torch.repeat_interleave(x, n, dim=axis))(k_cache[:, :, Sk - W:, :], rep, axis=1)
        v = (lambda x, n, axis: torch.repeat_interleave(x, n, dim=axis))(v_cache[:, :, Sk - W:, :], rep, axis=1)
        scores = torch.einsum("bhqd,bhkd->bhqk", q, k) * (Dh ** -0.5)
        p = _softmax(scores, axis=-1)
        o = torch.einsum("bhqk,bhkd->bhqd", p, v)
        return (lambda x, *d: x.permute(*d))(o, 0, 2, 1, 3).reshape(B, Sq, Hq * Dh) @ wo

    def _B_ref(x, w1, b1, w2, b2):
        B, S, D = x.shape
        h = _layernorm(x, axis=-1)
        u = torch.einsum("bsd,sf->bdf", h, w1) + b1
        u = _gelu(u)
        y = torch.einsum("bdf,fs->bds", u, w2) + b2
        return (lambda x, *d: x.permute(*d))(y, 0, 2, 1)

    x = A_x
    xn = _layernorm(x, axis=-1)
    s = _A_ref(xn, A_k_cache, A_v_cache, A_wq, A_wo)
    g = _silu(_B_ref(xn, B_w1, B_b1, B_w2, B_b2))
    return x + s * g
```

```asm
; @launch grid=(256,1,1) block=(256,1,1) lds=163840
.amdgcn_target "amdgcn-amd-amdhsa--gfx950"
.text

.globl recurrent_scan__sliding_block_cached__mixer_token_mlp__prompt_kernel
.p2align 8
.type recurrent_scan__sliding_block_cached__mixer_token_mlp__prompt_kernel,@function
recurrent_scan__sliding_block_cached__mixer_token_mlp__prompt_kernel:
  s_cmp_ge_u32 s2, 256
  s_cbranch_scc1 L_end
  s_getpc_b64 s[62:63]
L_code_ref:
  s_load_dwordx16 s[72:87], s[0:1], 0
  s_load_dwordx8 s[88:95], s[0:1], 64
  s_load_dwordx2 s[96:97], s[0:1], 96
  s_memrealtime s[64:65]
  v_lshrrev_b32 v1, 6, v0
  v_and_b32 v2, 63, v0
  v_readfirstlane_b32 s16, v1
  v_lshlrev_b32 v3, 4, v2
  v_lshlrev_b32 v58, 7, v2
  s_cmp_lg_u32 s16, 3
  s_cbranch_scc1 L_nocpf
  s_mov_b32 s4, s62
  s_and_b32 s5, s63, 0xffff
  s_mov_b32 s6, L_code_end-L_code_ref
  s_mov_b32 s7, 0x00020000
  s_bfe_u32 s3, s2, 0x40003
  s_lshl_b32 s3, s3, 13
  buffer_load_dword v59, v58, s[4:7], s3 offen
L_nocpf:
  s_lshr_b32 s21, s2, 2
  s_lshl_b32 s21, s21, 5
  s_and_b32 s22, s2, 3
  s_lshl_b32 s22, s22, 2
  s_add_u32 s21, s21, s22
  s_and_b32 s22, s16, 1
  s_lshl_b32 s22, s22, 1
  s_add_u32 s21, s21, s22
  s_lshr_b32 s22, s16, 1
  s_lshl_b32 s22, s22, 4
  s_add_u32 s21, s21, s22
  s_lshl_b32 s23, s21, 11
  s_waitcnt lgkmcnt(0)
  s_mov_b32 s60, s72
  s_and_b32 s61, s73, 0xffff
  s_mov_b32 s62, 4194304
  s_mov_b32 s63, 0x00020000
  buffer_load_dwordx4 v[196:199], v3, s[60:63], s23 offen offset:0
  buffer_load_dwordx4 v[200:203], v3, s[60:63], s23 offen offset:1024
  buffer_load_dwordx4 v[204:207], v3, s[60:63], s23 offen offset:2048
  buffer_load_dwordx4 v[208:211], v3, s[60:63], s23 offen offset:3072
  s_mov_b32 s32, s94
  s_and_b32 s33, s95, 0xffff
  s_mov_b32 s34, 256
  s_mov_b32 s35, 0x00020000
  v_mov_b32 v35, 0
  s_lshr_b32 s21, s2, 3
  s_or_b32 s21, s21, s16
  s_cmp_lg_u32 s21, 0
  s_cbranch_scc1 L_nononce
  s_or_b32 s64, s64, 1
  v_mov_b32 v36, s64
  v_mov_b32 v37, 0
  s_mov_b64 exec, 1
  buffer_atomic_cmpswap v[36:37], v35, s[32:35], 0 offen sc1
  s_mov_b64 exec, -1
  s_nop 1
L_nononce:
  s_lshl_b32 s19, s16, 12
  v_lshrrev_b32 v34, 4, v2
  s_and_b32 s21, s2, 1
  s_bfe_u32 s22, s2, 0x10002
  s_bfe_u32 s23, s2, 0x10001
  s_lshl_b32 s3, s21, 1
  s_add_u32 s3, s3, s22
  s_lshl_b32 s36, s3, 3
  s_bfe_u32 s40, s2, 0x30003
  s_add_u32 s36, s36, s40
  s_lshl_b32 s23, s23, 2
  s_lshr_b32 s3, s2, 6
  s_add_u32 s37, s3, s23
  s_bfe_u32 s41, s2, 0x20001
  s_lshl_b32 s41, s41, 2
  s_add_u32 s41, s41, s3
  s_lshl_b32 s68, s41, 3
  s_add_u32 s68, s68, s40
  s_bfe_u32 s38, s2, 0x20003
  s_add_u32 s38, s38, s23
  s_lshr_b32 s3, s2, 5
  s_lshl_b32 s22, s22, 3
  s_add_u32 s39, s22, s3
  s_cmp_eq_u32 s21, 0
  s_cselect_b32 s23, 4, 3
  s_cselect_b32 s3, 1536, 0
  s_cselect_b32 s22, 16, 0
  s_mul_i32 s71, s39, s23
  s_lshl_b32 s71, s71, 5
  s_add_u32 s71, s71, s3
  s_lshl_b32 s70, s38, 5
  s_add_u32 s70, s70, s39
  s_add_u32 s70, s70, s22
  s_lshl_b32 s70, s70, 5
  s_add_u32 s70, s70, 16384
  s_lshr_b32 s69, s2, 1
  s_lshl_b32 s69, s69, 13
  s_mov_b32 s50, 0x41800000
  s_mov_b32 s43, 0
  s_mov_b32 s98, 2048
  s_mov_b32 s99, 4096
  s_mov_b32 s100, 6144
  v_add_u32 v57, 4096, v3
  v_bfe_u32 v36, v2, 2, 2
  v_xor_b32 v37, v36, v34
  v_lshlrev_b32 v37, 6, v37
  v_and_b32 v38, 3, v2
  v_lshl_add_u32 v33, v38, 4, v37
  v_bfe_u32 v37, v2, 1, 3
  v_xor_b32 v37, v37, v34
  v_lshlrev_b32 v37, 5, v37
  v_and_b32 v1, 1, v2
  v_lshl_add_u32 v44, v1, 4, v37
  v_xor_b32 v45, 128, v44
  s_bitcmp1_b32 s2, 0
  s_cbranch_scc1 L_e_m
  s_mul_i32 s21, s16, 131072
  v_mul_u32_u24 v7, 8192, v34
  v_add3_u32 v4, v7, v44, s21
  v_add3_u32 v5, v7, v45, s21
  v_add_u32 v5, 31744, v5
  v_add_u32 v6, 63488, v4
  v_add_u32 v7, 63488, v5
  s_mov_b32 s17, 0
  s_mov_b32 s18, 0
  s_lshl_b32 s21, s36, 8
  s_sub_u32 s22, 8388608, s21
  s_add_u32 s8, s78, s21
  s_addc_u32 s9, s79, 0
  s_and_b32 s9, s9, 0xffff
  s_mov_b32 s10, s22
  s_mov_b32 s11, 0x00020000
  s_lshl_b32 s21, s37, 3
  s_lshl_b32 s22, s16, 1
  s_add_u32 s21, s21, s22
  s_lshl_b32 s22, s21, 16
  s_add_u32 s12, s96, s22
  s_addc_u32 s13, s97, 0
  s_and_b32 s13, s13, 0xffff
  s_mov_b32 s14, 65536
  s_mov_b32 s15, 0x00020000
  s_add_u32 s22, s22, 65536
  s_add_u32 s24, s96, s22
  s_addc_u32 s25, s97, 0
  s_and_b32 s25, s25, 0xffff
  s_mov_b32 s26, 65536
  s_mov_b32 s27, 0x00020000
  s_lshl_b32 s17, s37, 20
  s_lshl_b32 s18, s37, 13
  s_mov_b32 s51, 524288
  s_mov_b32 s101, 8388608
  s_mov_b32 s4, s96
  s_and_b32 s5, s97, 0xffff
  s_mov_b32 s6, 0
  s_mov_b32 s7, 0x00020000
  s_mov_b32 s44, s96
  s_and_b32 s45, s97, 0xffff
  s_mov_b32 s46, 0
  s_mov_b32 s47, 0x00020000
  v_mov_b32 v48, 0
  v_mov_b32 v49, 0
  v_mov_b32 v50, 0
  v_mov_b32 v51, 0
  s_branch L_e_c
L_e_m:
  s_mul_i32 s21, s16, 114688
  v_mul_u32_u24 v7, 7168, v34
  v_add3_u32 v4, v7, v44, s21
  v_add3_u32 v5, v7, v45, s21
  v_add_u32 v5, 27648, v5
  v_add_u32 v6, 55296, v4
  v_add_u32 v7, 55296, v5
  s_mov_b32 s17, 0
  s_mov_b32 s18, 0
  s_lshl_b32 s21, s71, 1
  s_sub_u32 s22, 14680064, s21
  s_add_u32 s8, s84, s21
  s_addc_u32 s9, s85, 0
  s_and_b32 s9, s9, 0xffff
  s_mov_b32 s10, s22
  s_mov_b32 s11, 0x00020000
  s_lshl_b32 s21, s38, 2
  s_add_u32 s21, s21, s16
  s_lshl_b32 s22, s21, 17
  s_add_u32 s22, s22, 4194304
  s_add_u32 s12, s96, s22
  s_addc_u32 s13, s97, 0
  s_and_b32 s13, s13, 0xffff
  s_mov_b32 s14, 131072
  s_mov_b32 s15, 0x00020000
  s_mul_i32 s17, s38, 1835008
  s_lshl_b32 s18, s38, 14
  v_cmp_le_u32 vcc, 192, v44
  v_mov_b32 v1, 0x40000000
  s_nop 0
  v_cndmask_b32 v4, v4, v1, vcc
  v_cndmask_b32 v6, v6, v1, vcc
  v_cmp_le_u32 vcc, 192, v45
  v_mov_b32 v1, 0x40000000
  s_nop 0
  v_cndmask_b32 v5, v5, v1, vcc
  v_cndmask_b32 v7, v7, v1, vcc
  s_mov_b32 s51, 458752
  s_mov_b32 s101, 14680064
  s_mul_i32 s21, s16, 131072
  v_mul_u32_u24 v51, 8192, v34
  v_add3_u32 v48, v51, v44, s21
  v_add3_u32 v49, v51, v45, s21
  v_add_u32 v49, 31744, v49
  v_add_u32 v50, 63488, v48
  v_add_u32 v51, 63488, v49
  s_mov_b32 s66, 0
  s_mov_b32 s67, 0
  s_lshl_b32 s21, s36, 8
  s_sub_u32 s22, 8388608, s21
  s_add_u32 s4, s78, s21
  s_addc_u32 s5, s79, 0
  s_and_b32 s5, s5, 0xffff
  s_mov_b32 s6, s22
  s_mov_b32 s7, 0x00020000
  s_lshl_b32 s21, s37, 3
  s_lshl_b32 s22, s16, 1
  s_add_u32 s21, s21, s22
  s_lshl_b32 s22, s21, 16
  s_add_u32 s44, s96, s22
  s_addc_u32 s45, s97, 0
  s_and_b32 s45, s45, 0xffff
  s_mov_b32 s46, 65536
  s_mov_b32 s47, 0x00020000
  s_add_u32 s22, s22, 65536
  s_add_u32 s24, s96, s22
  s_addc_u32 s25, s97, 0
  s_and_b32 s25, s25, 0xffff
  s_mov_b32 s26, 65536
  s_mov_b32 s27, 0x00020000
  s_lshl_b32 s66, s37, 20
  s_lshl_b32 s67, s37, 13
L_e_c:
  s_lshr_b32 s62, s51, 1
  v_subrev_u32 v64, s62, v4
  v_subrev_u32 v65, s62, v5
  v_subrev_u32 v66, s62, v6
  v_subrev_u32 v67, s62, v7
  s_mov_b32 s21, 0x3a800000
  s_mov_b32 s22, 0x3727c5ac
  s_mov_b32 s23, 0xffff0000
  s_mov_b32 s64, 0x3e0293ee
  s_add_u32 s3, s19, 131072
  v_add_u32 v188, s3, v3
  v_and_b32 v189, 7, v2
  v_lshlrev_b32 v190, 11, v189
  v_lshrrev_b32 v191, 5, v2
  v_lshl_add_u32 v190, v191, 6, v190
  v_bfe_u32 v193, v2, 3, 2
  v_lshl_add_u32 v190, v193, 3, v190
  s_lshl_b32 s65, s16, 10
  s_add_u32 s65, s65, 131072
  v_add_u32 v190, s65, v190
  v_lshlrev_b32 v192, 11, v191
  v_lshl_add_u32 v192, v193, 8, v192
  v_lshl_add_u32 v192, v38, 4, v192
  v_bfe_u32 v193, v2, 2, 1
  v_lshl_add_u32 v192, v193, 10, v192
  v_lshlrev_b32 v194, 11, v36
  v_lshl_add_u32 v194, v34, 5, v194
  v_lshl_add_u32 v194, v38, 3, v194
  v_add_u32 v194, s65, v194
  v_lshlrev_b32 v195, 17, v191
  v_bfe_u32 v193, v2, 4, 1
  v_lshl_add_u32 v195, v193, 10, v195
  v_and_b32 v193, 15, v2
  v_lshl_add_u32 v195, v193, 4, v195
  s_lshr_b32 s3, s2, 2
  s_lshl_b32 s0, s3, 11
  s_lshl_b32 s3, s3, 16
  s_and_b32 s65, s2, 3
  s_lshl_b32 s65, s65, 6
  s_add_u32 s3, s3, s65
  s_lshl_b32 s65, s65, 2
  s_add_u32 s0, s0, s65
  s_lshl_b32 s65, s16, 15
  s_add_u32 s3, s3, s65
  s_add_u32 s0, s0, 4194304
  s_lshl_b32 s65, s16, 21
  s_add_u32 s0, s0, s65
  s_mov_b32 s28, s96
  s_and_b32 s29, s97, 0xffff
  s_mov_b32 s30, 8388608
  s_mov_b32 s31, 0x00020000
  s_add_u32 s52, s96, 41943040
  s_addc_u32 s53, s97, 0
  s_and_b32 s53, s53, 0xffff
  s_mov_b32 s54, 65536
  s_mov_b32 s55, 0x00020000
  s_lshl_b32 s1, s2, 5
  s_cmp_lt_u32 s16, 2
  s_cbranch_scc1 L_xw0
  s_waitcnt vmcnt(0)
  s_branch L_xw1
L_xw0:
  s_waitcnt vmcnt(0)
L_xw1:
  s_cmp_lt_u32 s16, 2
  s_cbranch_scc1 L_mk0_pf_1
  s_add_u32 m0, s19, 0
  s_sub_u32 s63, s17, s62
  buffer_load_dwordx4 v4, s[8:11], s17 offen offset:0 lds
  buffer_load_dwordx4 v5, s[8:11], s17 offen offset:1024 lds
  buffer_load_dwordx4 v6, s[8:11], s17 offen offset:2048 lds
  buffer_load_dwordx4 v7, s[8:11], s17 offen offset:3072 lds
  s_add_u32 m0, s19, -8192
  s_nop 0
  buffer_load_dwordx4 v64, s[8:11], s17 offen offset:0 lds
  buffer_load_dwordx4 v65, s[8:11], s17 offen offset:1024 lds
  buffer_load_dwordx4 v66, s[8:11], s17 offen offset:2048 lds
  buffer_load_dwordx4 v67, s[8:11], s17 offen offset:3072 lds
L_mk0_pf_1:
  s_add_u32 s17, s17, s51
  s_cmp_eq_u32 s17, s101
  s_cselect_b32 s17, 0, s17
  s_call_b64 s[48:49], L_ln_unpack
  buffer_load_dword v39, v35, s[32:35], 0 offen sc1
  v_mul_f32 v80, s64, v80
  v_mul_f32 v81, s64, v81
  v_mul_f32 v82, s64, v82
  v_mul_f32 v83, s64, v83
  v_mul_f32 v84, s64, v84
  v_mul_f32 v85, s64, v85
  v_mul_f32 v86, s64, v86
  v_mul_f32 v87, s64, v87
  v_mul_f32 v88, s64, v88
  v_mul_f32 v89, s64, v89
  v_mul_f32 v90, s64, v90
  v_mul_f32 v91, s64, v91
  v_mul_f32 v92, s64, v92
  v_mul_f32 v93, s64, v93
  v_mul_f32 v94, s64, v94
  v_mul_f32 v95, s64, v95
  v_mul_f32 v96, s64, v96
  v_mul_f32 v97, s64, v97
  v_mul_f32 v98, s64, v98
  v_mul_f32 v99, s64, v99
  v_mul_f32 v100, s64, v100
  v_mul_f32 v101, s64, v101
  v_mul_f32 v102, s64, v102
  v_mul_f32 v103, s64, v103
  v_mul_f32 v104, s64, v104
  v_mul_f32 v105, s64, v105
  v_mul_f32 v106, s64, v106
  v_mul_f32 v107, s64, v107
  v_mul_f32 v108, s64, v108
  v_mul_f32 v109, s64, v109
  v_mul_f32 v110, s64, v110
  v_mul_f32 v111, s64, v111
  v_cvt_pk_bf16_f32 v164, v80, v81
  v_cvt_pk_bf16_f32 v172, v96, v97
  v_cvt_pk_bf16_f32 v165, v82, v83
  v_cvt_pk_bf16_f32 v173, v98, v99
  v_cvt_pk_bf16_f32 v166, v84, v85
  v_cvt_pk_bf16_f32 v174, v100, v101
  v_cvt_pk_bf16_f32 v167, v86, v87
  v_cvt_pk_bf16_f32 v175, v102, v103
  v_cvt_pk_bf16_f32 v168, v88, v89
  v_cvt_pk_bf16_f32 v176, v104, v105
  v_cvt_pk_bf16_f32 v169, v90, v91
  v_cvt_pk_bf16_f32 v177, v106, v107
  v_cvt_pk_bf16_f32 v170, v92, v93
  v_cvt_pk_bf16_f32 v178, v108, v109
  v_cvt_pk_bf16_f32 v171, v94, v95
  v_cvt_pk_bf16_f32 v179, v110, v111
  ds_write_b128 v188, v[164:167] offset:0
  ds_write_b128 v188, v[168:171] offset:1024
  ds_write_b128 v188, v[172:175] offset:2048
  ds_write_b128 v188, v[176:179] offset:3072
  s_waitcnt lgkmcnt(0)
  s_barrier
  s_cmp_ge_u32 s16, 2
  s_cbranch_scc1 L_nox
  ds_read2_b64 v[112:115], v190 offset0:0 offset1:4
  ds_read2_b64 v[116:119], v190 offset0:16 offset1:20
  ds_read2_b64 v[120:123], v190 offset0:32 offset1:36
  ds_read2_b64 v[124:127], v190 offset0:48 offset1:52
  ds_read2_b64 v[128:131], v190 offset0:64 offset1:68
  ds_read2_b64 v[132:135], v190 offset0:80 offset1:84
  ds_read2_b64 v[136:139], v190 offset0:96 offset1:100
  ds_read2_b64 v[140:143], v190 offset0:112 offset1:116
  s_waitcnt lgkmcnt(7)
  buffer_store_dwordx4 v[112:115], v192, s[28:31], s3 offen sc1
  s_add_u32 s3, s3, 4096
  s_waitcnt lgkmcnt(6)
  buffer_store_dwordx4 v[116:119], v192, s[28:31], s3 offen sc1
  s_add_u32 s3, s3, 4096
  s_waitcnt lgkmcnt(5)
  buffer_store_dwordx4 v[120:123], v192, s[28:31], s3 offen sc1
  s_add_u32 s3, s3, 4096
  s_waitcnt lgkmcnt(4)
  buffer_store_dwordx4 v[124:127], v192, s[28:31], s3 offen sc1
  s_add_u32 s3, s3, 4096
  s_waitcnt lgkmcnt(3)
  buffer_store_dwordx4 v[128:131], v192, s[28:31], s3 offen sc1
  s_add_u32 s3, s3, 4096
  s_waitcnt lgkmcnt(2)
  buffer_store_dwordx4 v[132:135], v192, s[28:31], s3 offen sc1
  s_add_u32 s3, s3, 4096
  s_waitcnt lgkmcnt(1)
  buffer_store_dwordx4 v[136:139], v192, s[28:31], s3 offen sc1
  s_add_u32 s3, s3, 4096
  s_waitcnt lgkmcnt(0)
  buffer_store_dwordx4 v[140:143], v192, s[28:31], s3 offen sc1
  s_add_u32 s3, s3, 4096
L_nox:
  s_cmp_lt_u32 s16, 2
  s_cbranch_scc1 L_mk0_pf_2
  s_add_u32 m0, s19, 16384
  s_sub_u32 s63, s17, s62
  buffer_load_dwordx4 v4, s[8:11], s17 offen offset:0 lds
  buffer_load_dwordx4 v5, s[8:11], s17 offen offset:1024 lds
  buffer_load_dwordx4 v6, s[8:11], s17 offen offset:2048 lds
  buffer_load_dwordx4 v7, s[8:11], s17 offen offset:3072 lds
  s_add_u32 m0, s19, 8192
  s_nop 0
  buffer_load_dwordx4 v64, s[8:11], s17 offen offset:0 lds
  buffer_load_dwordx4 v65, s[8:11], s17 offen offset:1024 lds
  buffer_load_dwordx4 v66, s[8:11], s17 offen offset:2048 lds
  buffer_load_dwordx4 v67, s[8:11], s17 offen offset:3072 lds
L_mk0_pf_2:
  s_add_u32 s17, s17, s51
  s_cmp_eq_u32 s17, s101
  s_cselect_b32 s17, 0, s17
  s_call_b64 s[48:49], L_ln_unpack
  ds_write_b128 v188, v[196:199] offset:16384
  ds_write_b128 v188, v[200:203] offset:17408
  ds_write_b128 v188, v[204:207] offset:18432
  ds_write_b128 v188, v[208:211] offset:19456
  s_mov_b32 s64, 0x200000
  s_add_u32 s21, s1, 40960
  s_cmp_ge_u32 s16, 2
  s_cbranch_scc1 L_nonce_ok
  s_waitcnt vmcnt(0)
L_nonce_loop:
  v_readfirstlane_b32 s42, v39
  s_cmp_lg_u32 s42, 0
  s_cbranch_scc1 L_nonce_ok
  buffer_load_dword v39, v35, s[32:35], 0 offen sc1
  s_waitcnt vmcnt(0)
  s_sub_u32 s64, s64, 1
  s_cmp_lg_u32 s64, 0
  s_cbranch_scc1 L_nonce_loop
L_nonce_ok:
  s_waitcnt lgkmcnt(0)
  s_barrier
  s_cmp_ge_u32 s16, 2
  s_cbranch_scc1 L_noh
  ds_read_b64_tr_b16 v[112:113], v194 offset:16384
  ds_read_b64_tr_b16 v[114:115], v194 offset:24576
  ds_read_b64_tr_b16 v[116:117], v194 offset:16512
  ds_read_b64_tr_b16 v[118:119], v194 offset:24704
  ds_read_b64_tr_b16 v[120:121], v194 offset:16640
  ds_read_b64_tr_b16 v[122:123], v194 offset:24832
  ds_read_b64_tr_b16 v[124:125], v194 offset:16768
  ds_read_b64_tr_b16 v[126:127], v194 offset:24960
  ds_read_b64_tr_b16 v[128:129], v194 offset:16896
  ds_read_b64_tr_b16 v[130:131], v194 offset:25088
  ds_read_b64_tr_b16 v[132:133], v194 offset:17024
  ds_read_b64_tr_b16 v[134:135], v194 offset:25216
  ds_read_b64_tr_b16 v[136:137], v194 offset:17152
  ds_read_b64_tr_b16 v[138:139], v194 offset:25344
  ds_read_b64_tr_b16 v[140:141], v194 offset:17280
  ds_read_b64_tr_b16 v[142:143], v194 offset:25472
  s_cmp_lg_u32 s16, 0
  s_cbranch_scc1 L_mk0_nopub_3
  v_mov_b32 v1, s21
  v_mov_b32 v56, s42
  s_mov_b64 exec, 1
  buffer_store_dword v56, v1, s[52:55], 0 offen sc1
  s_mov_b64 exec, -1
  s_nop 3
L_mk0_nopub_3:
  s_waitcnt lgkmcnt(14)
  buffer_store_dwordx4 v[112:115], v195, s[28:31], s0 offen sc1
  s_add_u32 s0, s0, 262144
  s_waitcnt lgkmcnt(12)
  buffer_store_dwordx4 v[116:119], v195, s[28:31], s0 offen sc1
  s_add_u32 s0, s0, 262144
  s_waitcnt lgkmcnt(10)
  buffer_store_dwordx4 v[120:123], v195, s[28:31], s0 offen sc1
  s_add_u32 s0, s0, 262144
  s_waitcnt lgkmcnt(8)
  buffer_store_dwordx4 v[124:127], v195, s[28:31], s0 offen sc1
  s_add_u32 s0, s0, 262144
  s_waitcnt lgkmcnt(6)
  buffer_store_dwordx4 v[128:131], v195, s[28:31], s0 offen sc1
  s_add_u32 s0, s0, 262144
  s_waitcnt lgkmcnt(4)
  buffer_store_dwordx4 v[132:135], v195, s[28:31], s0 offen sc1
  s_add_u32 s0, s0, 262144
  s_waitcnt lgkmcnt(2)
  buffer_store_dwordx4 v[136:139], v195, s[28:31], s0 offen sc1
  s_add_u32 s0, s0, 262144
  s_waitcnt lgkmcnt(0)
  buffer_store_dwordx4 v[140:143], v195, s[28:31], s0 offen sc1
  s_add_u32 s0, s0, 262144
L_noh:
  buffer_load_dword v61, v35, s[32:35], 0 offen sc1
  v_lshrrev_b32 v37, 5, v2
  v_lshlrev_b32 v46, 8, v37
  v_lshl_add_u32 v37, v37, 2, v36
  v_lshlrev_b32 v37, 8, v37
  v_bfe_u32 v39, v2, 4, 1
  v_lshl_add_u32 v46, v39, 10, v46
  v_and_b32 v1, 15, v2
  v_lshl_add_u32 v46, v1, 4, v46
  v_lshl_add_u32 v37, v39, 5, v37
  v_lshl_add_u32 v37, v38, 3, v37
  v_add_u32 v37, 73728, v37
  v_xor_b32 v1, 0, v36
  v_lshl_add_u32 v24, v1, 6, v37
  v_xor_b32 v1, 1, v36
  v_lshl_add_u32 v25, v1, 6, v37
  v_xor_b32 v1, 2, v36
  v_lshl_add_u32 v26, v1, 6, v37
  v_xor_b32 v1, 3, v36
  v_lshl_add_u32 v27, v1, 6, v37
  v_lshrrev_b32 v37, 2, v2
  v_and_b32 v1, 7, v37
  v_lshlrev_b32 v37, 8, v37
  v_lshl_add_u32 v37, v1, 5, v37
  v_lshl_add_u32 v8, v38, 3, v37
  v_xor_b32 v9, 32, v8
  v_xor_b32 v10, 64, v8
  v_xor_b32 v11, 96, v8
  v_xor_b32 v40, 128, v8
  v_xor_b32 v41, 160, v8
  v_xor_b32 v42, 192, v8
  v_xor_b32 v43, 224, v8
  v_and_b32 v36, 31, v2
  v_lshlrev_b32 v36, 8, v36
  v_add_u32 v36, 65536, v36
  v_and_b32 v37, 15, v2
  v_lshrrev_b32 v38, 5, v2
  v_xor_b32 v37, v37, v38
  v_xor_b32 v38, 0, v37
  v_lshl_add_u32 v16, v38, 4, v36
  v_xor_b32 v38, 2, v37
  v_lshl_add_u32 v17, v38, 4, v36
  v_xor_b32 v38, 4, v37
  v_lshl_add_u32 v18, v38, 4, v36
  v_xor_b32 v38, 6, v37
  v_lshl_add_u32 v19, v38, 4, v36
  v_xor_b32 v38, 8, v37
  v_lshl_add_u32 v20, v38, 4, v36
  v_xor_b32 v38, 10, v37
  v_lshl_add_u32 v21, v38, 4, v36
  v_xor_b32 v38, 12, v37
  v_lshl_add_u32 v22, v38, 4, v36
  v_xor_b32 v38, 14, v37
  v_lshl_add_u32 v23, v38, 4, v36
  s_and_b32 s21, s16, 1
  s_lshl_b32 s21, s21, 12
  v_lshlrev_b32 v38, 8, v34
  v_add_u32 v38, s21, v38
  s_cmp_ge_u32 s16, 2
  s_cbranch_scc1 L_q_vw
  v_and_b32 v37, 15, v2
  v_xor_b32 v37, v37, v34
  v_lshlrev_b32 v37, 4, v37
  v_add_u32 v38, 393216, v38
  v_xor_b32 v12, 0, v37
  v_add_u32 v12, v12, v38
  v_xor_b32 v13, 64, v37
  v_add_u32 v13, v13, v38
  v_xor_b32 v14, 128, v37
  v_add_u32 v14, v14, v38
  v_xor_b32 v15, 192, v37
  v_add_u32 v15, v15, v38
  s_branch L_q_vw_done
L_q_vw:
  v_add_u32 v38, 385024, v38
  v_add_u32 v12, v33, v38
  v_add_u32 v13, v33, v38
  v_add_u32 v14, v33, v38
  v_add_u32 v15, v33, v38
L_q_vw_done:
  s_cmp_ge_u32 s16, 2
  s_cselect_b32 s60, s76, s74
  s_cselect_b32 s61, s77, s75
  s_lshr_b32 s21, s36, 3
  s_lshl_b32 s21, s21, 19
  s_sub_u32 s22, 2097152, s21
  s_add_u32 s28, s60, s21
  s_addc_u32 s29, s61, 0
  s_and_b32 s29, s29, 0xffff
  s_mov_b32 s30, s22
  s_mov_b32 s31, 0x00020000
  s_cmp_ge_u32 s16, 2
  s_cbranch_scc1 L_nohw
  s_waitcnt vmcnt(0)
L_nohw:
  s_barrier
  s_cmp_lg_u32 s16, 0
  s_cbranch_scc1 L_mk0_nopub_4
  v_mov_b32 v1, s1
  v_mov_b32 v56, s42
  s_mov_b64 exec, 1
  buffer_store_dword v56, v1, s[52:55], 0 offen sc1
  s_mov_b64 exec, -1
  s_nop 3
L_mk0_nopub_4:
  s_bitcmp1_b32 s2, 0
  s_cbranch_scc1 L_c1
  s_branch L_c0
L_end:
  s_endpgm
L_ln:
  v_add_f32 v180, v80, v81
  v_add_f32 v181, v88, v89
  v_add_f32 v182, v96, v97
  v_add_f32 v183, v104, v105
  v_add_f32 v180, v180, v82
  v_add_f32 v181, v181, v90
  v_add_f32 v182, v182, v98
  v_add_f32 v183, v183, v106
  v_add_f32 v180, v180, v83
  v_add_f32 v181, v181, v91
  v_add_f32 v182, v182, v99
  v_add_f32 v183, v183, v107
  v_add_f32 v180, v180, v84
  v_add_f32 v181, v181, v92
  v_add_f32 v182, v182, v100
  v_add_f32 v183, v183, v108
  v_add_f32 v180, v180, v85
  v_add_f32 v181, v181, v93
  v_add_f32 v182, v182, v101
  v_add_f32 v183, v183, v109
  v_add_f32 v180, v180, v86
  v_add_f32 v181, v181, v94
  v_add_f32 v182, v182, v102
  v_add_f32 v183, v183, v110
  v_add_f32 v180, v180, v87
  v_add_f32 v181, v181, v95
  v_add_f32 v182, v182, v103
  v_add_f32 v183, v183, v111
  v_add_f32 v144, v180, v181
  v_add_f32 v146, v182, v183
  s_nop 0
  v_add_f32_dpp v144, v144, v144 quad_perm:[1,0,3,2] row_mask:0xf bank_mask:0xf
  v_add_f32_dpp v146, v146, v146 quad_perm:[1,0,3,2] row_mask:0xf bank_mask:0xf
  s_nop 0
  v_add_f32_dpp v144, v144, v144 quad_perm:[2,3,0,1] row_mask:0xf bank_mask:0xf
  v_add_f32_dpp v146, v146, v146 quad_perm:[2,3,0,1] row_mask:0xf bank_mask:0xf
  s_nop 0
  v_add_f32_dpp v144, v144, v144 row_half_mirror row_mask:0xf bank_mask:0xf
  v_add_f32_dpp v146, v146, v146 row_half_mirror row_mask:0xf bank_mask:0xf
  s_nop 0
  v_add_f32_dpp v144, v144, v144 row_mirror row_mask:0xf bank_mask:0xf
  v_add_f32_dpp v146, v146, v146 row_mirror row_mask:0xf bank_mask:0xf
  v_mov_b32 v148, v144
  v_mov_b32 v149, v146
  s_nop 0
  v_permlane16_swap_b32 v144, v148
  v_permlane16_swap_b32 v146, v149
  v_add_f32 v144, v144, v148
  v_add_f32 v146, v146, v149
  v_mov_b32 v148, v144
  v_mov_b32 v149, v146
  s_nop 0
  v_permlane32_swap_b32 v144, v148
  v_permlane32_swap_b32 v146, v149
  v_add_f32 v144, v144, v148
  v_add_f32 v146, v146, v149
  v_mul_f32 v144, s21, v144
  v_mul_f32 v146, s21, v146
  v_sub_f32 v80, v80, v144
  v_sub_f32 v96, v96, v146
  v_sub_f32 v81, v81, v144
  v_sub_f32 v97, v97, v146
  v_sub_f32 v82, v82, v144
  v_sub_f32 v98, v98, v146
  v_sub_f32 v83, v83, v144
  v_sub_f32 v99, v99, v146
  v_sub_f32 v84, v84, v144
  v_sub_f32 v100, v100, v146
  v_sub_f32 v85, v85, v144
  v_sub_f32 v101, v101, v146
  v_sub_f32 v86, v86, v144
  v_sub_f32 v102, v102, v146
  v_sub_f32 v87, v87, v144
  v_sub_f32 v103, v103, v146
  v_sub_f32 v88, v88, v144
  v_sub_f32 v104, v104, v146
  v_sub_f32 v89, v89, v144
  v_sub_f32 v105, v105, v146
  v_sub_f32 v90, v90, v144
  v_sub_f32 v106, v106, v146
  v_sub_f32 v91, v91, v144
  v_sub_f32 v107, v107, v146
  v_sub_f32 v92, v92, v144
  v_sub_f32 v108, v108, v146
  v_sub_f32 v93, v93, v144
  v_sub_f32 v109, v109, v146
  v_sub_f32 v94, v94, v144
  v_sub_f32 v110, v110, v146
  v_sub_f32 v95, v95, v144
  v_sub_f32 v111, v111, v146
  v_mul_f32 v180, v80, v80
  v_mul_f32 v181, v88, v88
  v_mul_f32 v182, v96, v96
  v_mul_f32 v183, v104, v104
  v_fmac_f32 v180, v81, v81
  v_fmac_f32 v181, v89, v89
  v_fmac_f32 v182, v97, v97
  v_fmac_f32 v183, v105, v105
  v_fmac_f32 v180, v82, v82
  v_fmac_f32 v181, v90, v90
  v_fmac_f32 v182, v98, v98
  v_fmac_f32 v183, v106, v106
  v_fmac_f32 v180, v83, v83
  v_fmac_f32 v181, v91, v91
  v_fmac_f32 v182, v99, v99
  v_fmac_f32 v183, v107, v107
  v_fmac_f32 v180, v84, v84
  v_fmac_f32 v181, v92, v92
  v_fmac_f32 v182, v100, v100
  v_fmac_f32 v183, v108, v108
  v_fmac_f32 v180, v85, v85
  v_fmac_f32 v181, v93, v93
  v_fmac_f32 v182, v101, v101
  v_fmac_f32 v183, v109, v109
  v_fmac_f32 v180, v86, v86
  v_fmac_f32 v181, v94, v94
  v_fmac_f32 v182, v102, v102
  v_fmac_f32 v183, v110, v110
  v_fmac_f32 v180, v87, v87
  v_fmac_f32 v181, v95, v95
  v_fmac_f32 v182, v103, v103
  v_fmac_f32 v183, v111, v111
  v_add_f32 v144, v180, v181
  v_add_f32 v146, v182, v183
  s_nop 0
  v_add_f32_dpp v144, v144, v144 quad_perm:[1,0,3,2] row_mask:0xf bank_mask:0xf
  v_add_f32_dpp v146, v146, v146 quad_perm:[1,0,3,2] row_mask:0xf bank_mask:0xf
  s_nop 0
  v_add_f32_dpp v144, v144, v144 quad_perm:[2,3,0,1] row_mask:0xf bank_mask:0xf
  v_add_f32_dpp v146, v146, v146 quad_perm:[2,3,0,1] row_mask:0xf bank_mask:0xf
  s_nop 0
  v_add_f32_dpp v144, v144, v144 row_half_mirror row_mask:0xf bank_mask:0xf
  v_add_f32_dpp v146, v146, v146 row_half_mirror row_mask:0xf bank_mask:0xf
  s_nop 0
  v_add_f32_dpp v144, v144, v144 row_mirror row_mask:0xf bank_mask:0xf
  v_add_f32_dpp v146, v146, v146 row_mirror row_mask:0xf bank_mask:0xf
  v_mov_b32 v148, v144
  v_mov_b32 v149, v146
  s_nop 0
  v_permlane16_swap_b32 v144, v148
  v_permlane16_swap_b32 v146, v149
  v_add_f32 v144, v144, v148
  v_add_f32 v146, v146, v149
  v_mov_b32 v148, v144
  v_mov_b32 v149, v146
  s_nop 0
  v_permlane32_swap_b32 v144, v148
  v_permlane32_swap_b32 v146, v149
  v_add_f32 v144, v144, v148
  v_add_f32 v146, v146, v149
  v_mul_f32 v144, s21, v144
  v_mul_f32 v146, s21, v146
  v_cvt_pk_bf16_f32 v154, v144, v144
  v_cvt_pk_bf16_f32 v156, v146, v146
  v_and_b32 v154, s23, v154
  v_and_b32 v156, s23, v156
  v_add_f32 v154, s22, v154
  v_add_f32 v156, s22, v156
  v_cvt_pk_bf16_f32 v154, v154, v154
  v_cvt_pk_bf16_f32 v156, v156, v156
  v_and_b32 v154, s23, v154
  v_and_b32 v156, s23, v156
  v_sqrt_f32 v154, v154
  v_sqrt_f32 v156, v156
  s_nop 0
  v_cvt_pk_bf16_f32 v154, v154, v154
  v_cvt_pk_bf16_f32 v156, v156, v156
  v_and_b32 v154, s23, v154
  v_and_b32 v156, s23, v156
  v_rcp_f32 v158, v154
  v_rcp_f32 v160, v156
  s_nop 0
  v_mul_f32 v80, v80, v158
  v_mul_f32 v96, v96, v160
  v_mul_f32 v81, v81, v158
  v_mul_f32 v97, v97, v160
  v_mul_f32 v82, v82, v158
  v_mul_f32 v98, v98, v160
  v_mul_f32 v83, v83, v158
  v_mul_f32 v99, v99, v160
  v_mul_f32 v84, v84, v158
  v_mul_f32 v100, v100, v160
  v_mul_f32 v85, v85, v158
  v_mul_f32 v101, v101, v160
  v_mul_f32 v86, v86, v158
  v_mul_f32 v102, v102, v160
  v_mul_f32 v87, v87, v158
  v_mul_f32 v103, v103, v160
  v_mul_f32 v88, v88, v158
  v_mul_f32 v104, v104, v160
  v_mul_f32 v89, v89, v158
  v_mul_f32 v105, v105, v160
  v_mul_f32 v90, v90, v158
  v_mul_f32 v106, v106, v160
  v_mul_f32 v91, v91, v158
  v_mul_f32 v107, v107, v160
  v_mul_f32 v92, v92, v158
  v_mul_f32 v108, v108, v160
  v_mul_f32 v93, v93, v158
  v_mul_f32 v109, v109, v160
  v_mul_f32 v94, v94, v158
  v_mul_f32 v110, v110, v160
  v_mul_f32 v95, v95, v158
  v_mul_f32 v111, v111, v160
  v_cvt_pk_bf16_f32 v196, v80, v81
  v_cvt_pk_bf16_f32 v204, v96, v97
  v_cvt_pk_bf16_f32 v197, v82, v83
  v_cvt_pk_bf16_f32 v205, v98, v99
  v_cvt_pk_bf16_f32 v198, v84, v85
  v_cvt_pk_bf16_f32 v206, v100, v101
  v_cvt_pk_bf16_f32 v199, v86, v87
  v_cvt_pk_bf16_f32 v207, v102, v103
  v_cvt_pk_bf16_f32 v200, v88, v89
  v_cvt_pk_bf16_f32 v208, v104, v105
  v_cvt_pk_bf16_f32 v201, v90, v91
  v_cvt_pk_bf16_f32 v209, v106, v107
  v_cvt_pk_bf16_f32 v202, v92, v93
  v_cvt_pk_bf16_f32 v210, v108, v109
  v_cvt_pk_bf16_f32 v203, v94, v95
  v_cvt_pk_bf16_f32 v211, v110, v111
  s_setpc_b64 s[48:49]
L_ln_unpack:
  v_lshlrev_b32 v80, 16, v196
  v_and_b32 v81, s23, v196
  v_lshlrev_b32 v96, 16, v204
  v_and_b32 v97, s23, v204
  v_lshlrev_b32 v82, 16, v197
  v_and_b32 v83, s23, v197
  v_lshlrev_b32 v98, 16, v205
  v_and_b32 v99, s23, v205
  v_lshlrev_b32 v84, 16, v198
  v_and_b32 v85, s23, v198
  v_lshlrev_b32 v100, 16, v206
  v_and_b32 v101, s23, v206
  v_lshlrev_b32 v86, 16, v199
  v_and_b32 v87, s23, v199
  v_lshlrev_b32 v102, 16, v207
  v_and_b32 v103, s23, v207
  v_lshlrev_b32 v88, 16, v200
  v_and_b32 v89, s23, v200
  v_lshlrev_b32 v104, 16, v208
  v_and_b32 v105, s23, v208
  v_lshlrev_b32 v90, 16, v201
  v_and_b32 v91, s23, v201
  v_lshlrev_b32 v106, 16, v209
  v_and_b32 v107, s23, v209
  v_lshlrev_b32 v92, 16, v202
  v_and_b32 v93, s23, v202
  v_lshlrev_b32 v108, 16, v210
  v_and_b32 v109, s23, v210
  v_lshlrev_b32 v94, 16, v203
  v_and_b32 v95, s23, v203
  v_lshlrev_b32 v110, 16, v211
  v_and_b32 v111, s23, v211
  s_branch L_ln
L_c0:
  s_add_u32 m0, s19, 65536
  s_nop 0
  buffer_load_dwordx4 v12, s[28:31], s43 offen offset:0 lds
  buffer_load_dwordx4 v13, s[28:31], s43 offen offset:1024 lds
  buffer_load_dwordx4 v14, s[28:31], s43 offen offset:2048 lds
  buffer_load_dwordx4 v15, s[28:31], s43 offen offset:3072 lds
  s_add_u32 s43, s43, 8192
  s_add_u32 m0, s19, 81920
  s_nop 0
  buffer_load_dwordx4 v12, s[28:31], s43 offen offset:0 lds
  buffer_load_dwordx4 v13, s[28:31], s43 offen offset:1024 lds
  buffer_load_dwordx4 v14, s[28:31], s43 offen offset:2048 lds
  buffer_load_dwordx4 v15, s[28:31], s43 offen offset:3072 lds
  s_add_u32 s43, s43, 8192
  v_and_b32 v60, 31, v2
  v_lshlrev_b32 v60, 5, v60
  s_lshl_b32 s21, s37, 10
  s_add_u32 s21, s21, 40960
  v_add_u32 v60, s21, v60
  v_mov_b32 v128, 0
  v_mov_b32 v129, 0
  v_mov_b32 v130, 0
  v_mov_b32 v131, 0
  v_mov_b32 v132, 0
  v_mov_b32 v133, 0
  v_mov_b32 v134, 0
  v_mov_b32 v135, 0
  v_mov_b32 v136, 0
  v_mov_b32 v137, 0
  v_mov_b32 v138, 0
  v_mov_b32 v139, 0
  v_mov_b32 v140, 0
  v_mov_b32 v141, 0
  v_mov_b32 v142, 0
  v_mov_b32 v143, 0
  v_mov_b32 v144, 0
  v_mov_b32 v145, 0
  v_mov_b32 v146, 0
  v_mov_b32 v147, 0
  v_mov_b32 v148, 0
  v_mov_b32 v149, 0
  v_mov_b32 v150, 0
  v_mov_b32 v151, 0
  v_mov_b32 v152, 0
  v_mov_b32 v153, 0
  v_mov_b32 v154, 0
  v_mov_b32 v155, 0
  v_mov_b32 v156, 0
  v_mov_b32 v157, 0
  v_mov_b32 v158, 0
  v_mov_b32 v159, 0
  v_mov_b32 v160, 0
  v_mov_b32 v161, 0
  v_mov_b32 v162, 0
  v_mov_b32 v163, 0
  v_mov_b32 v164, 0
  v_mov_b32 v165, 0
  v_mov_b32 v166, 0
  v_mov_b32 v167, 0
  v_mov_b32 v168, 0
  v_mov_b32 v169, 0
  v_mov_b32 v170, 0
  v_mov_b32 v171, 0
  v_mov_b32 v172, 0
  v_mov_b32 v173, 0
  v_mov_b32 v174, 0
  v_mov_b32 v175, 0
  v_mov_b32 v176, 0
  v_mov_b32 v177, 0
  v_mov_b32 v178, 0
  v_mov_b32 v179, 0
  v_mov_b32 v180, 0
  v_mov_b32 v181, 0
  v_mov_b32 v182, 0
  v_mov_b32 v183, 0
  v_mov_b32 v184, 0
  v_mov_b32 v185, 0
  v_mov_b32 v186, 0
  v_mov_b32 v187, 0
  v_mov_b32 v188, 0
  v_mov_b32 v189, 0
  v_mov_b32 v190, 0
  v_mov_b32 v191, 0
  v_mov_b32 v192, 0
  v_mov_b32 v193, 0
  v_mov_b32 v194, 0
  v_mov_b32 v195, 0
  v_mov_b32 v196, 0
  v_mov_b32 v197, 0
  v_mov_b32 v198, 0
  v_mov_b32 v199, 0
  v_mov_b32 v200, 0
  v_mov_b32 v201, 0
  v_mov_b32 v202, 0
  v_mov_b32 v203, 0
  v_mov_b32 v204, 0
  v_mov_b32 v205, 0
  v_mov_b32 v206, 0
  v_mov_b32 v207, 0
  v_mov_b32 v208, 0
  v_mov_b32 v209, 0
  v_mov_b32 v210, 0
  v_mov_b32 v211, 0
  v_mov_b32 v212, 0
  v_mov_b32 v213, 0
  v_mov_b32 v214, 0
  v_mov_b32 v215, 0
  v_mov_b32 v216, 0
  v_mov_b32 v217, 0
  v_mov_b32 v218, 0
  v_mov_b32 v219, 0
  v_mov_b32 v220, 0
  v_mov_b32 v221, 0
  v_mov_b32 v222, 0
  v_mov_b32 v223, 0
  v_mov_b32 v224, 0
  v_mov_b32 v225, 0
  v_mov_b32 v226, 0
  v_mov_b32 v227, 0
  v_mov_b32 v228, 0
  v_mov_b32 v229, 0
  v_mov_b32 v230, 0
  v_mov_b32 v231, 0
  v_mov_b32 v232, 0
  v_mov_b32 v233, 0
  v_mov_b32 v234, 0
  v_mov_b32 v235, 0
  v_mov_b32 v236, 0
  v_mov_b32 v237, 0
  v_mov_b32 v238, 0
  v_mov_b32 v239, 0
  v_mov_b32 v240, 0
  v_mov_b32 v241, 0
  v_mov_b32 v242, 0
  v_mov_b32 v243, 0
  v_mov_b32 v244, 0
  v_mov_b32 v245, 0
  v_mov_b32 v246, 0
  v_mov_b32 v247, 0
  v_mov_b32 v248, 0
  v_mov_b32 v249, 0
  v_mov_b32 v250, 0
  v_mov_b32 v251, 0
  v_mov_b32 v252, 0
  v_mov_b32 v253, 0
  v_mov_b32 v254, 0
  v_mov_b32 v255, 0
  s_waitcnt vmcnt(8)
  v_readfirstlane_b32 s42, v61
  s_cmp_lg_u32 s16, 0
  s_cbranch_scc1 L_mk2_wp_1
  s_call_b64 s[48:49], L_poll1
L_mk2_wp_1:
  s_barrier
  buffer_load_dwordx4 a[0:3], v3, s[12:15], s18 offen offset:0 sc1
  buffer_load_dwordx4 a[4:7], v3, s[12:15], s18 offen offset:1024 sc1
  buffer_load_dwordx4 a[8:11], v3, s[24:27], s18 offen offset:0 sc1
  buffer_load_dwordx4 a[12:15], v3, s[24:27], s18 offen offset:1024 sc1
  buffer_load_dwordx4 a[16:19], v3, s[12:15], s18 offen offset:2048 sc1
  buffer_load_dwordx4 a[20:23], v3, s[12:15], s18 offen offset:3072 sc1
  buffer_load_dwordx4 a[24:27], v3, s[24:27], s18 offen offset:2048 sc1
  buffer_load_dwordx4 a[28:31], v3, s[24:27], s18 offen offset:3072 sc1
  s_add_u32 s18, s18, 4096
  s_cmp_eq_u32 s18, 65536
  s_cselect_b32 s18, 0, s18
  buffer_load_dwordx4 a[32:35], v3, s[12:15], s18 offen offset:0 sc1
  buffer_load_dwordx4 a[36:39], v3, s[12:15], s18 offen offset:1024 sc1
  buffer_load_dwordx4 a[40:43], v3, s[24:27], s18 offen offset:0 sc1
  buffer_load_dwordx4 a[44:47], v3, s[24:27], s18 offen offset:1024 sc1
  ds_read_b64_tr_b16 a[192:193], v8 offset:0
  ds_read_b64_tr_b16 a[194:195], v8 offset:4096
  ds_read_b64_tr_b16 a[196:197], v9 offset:0
  ds_read_b64_tr_b16 a[198:199], v9 offset:4096
  ds_read_b64_tr_b16 a[200:201], v10 offset:0
  ds_read_b64_tr_b16 a[202:203], v10 offset:4096
  s_mov_b32 s20, 4
L_mk2_q_2:
  s_waitcnt vmcnt(8) lgkmcnt(2)
  v_mfma_f32_16x16x32_bf16 v[128:131], a[192:195], a[0:3], v[128:131]
  ds_read_b64_tr_b16 a[204:205], v11 offset:0
  v_mfma_f32_16x16x32_bf16 v[132:135], a[192:195], a[4:7], v[132:135]
  ds_read_b64_tr_b16 a[206:207], v11 offset:4096
  v_mfma_f32_16x16x32_bf16 v[136:139], a[192:195], a[8:11], v[136:139]
  buffer_load_dwordx4 a[48:51], v3, s[12:15], s18 offen offset:2048 sc1
  v_mfma_f32_16x16x32_bf16 v[140:143], a[192:195], a[12:15], v[140:143]
  v_mfma_f32_16x16x32_bf16 v[144:147], a[196:199], a[0:3], v[144:147]
  ds_read_b64_tr_b16 a[208:209], v40 offset:0
  v_mfma_f32_16x16x32_bf16 v[148:151], a[196:199], a[4:7], v[148:151]
  ds_read_b64_tr_b16 a[210:211], v40 offset:4096
  v_mfma_f32_16x16x32_bf16 v[152:155], a[196:199], a[8:11], v[152:155]
  buffer_load_dwordx4 a[52:55], v3, s[12:15], s18 offen offset:3072 sc1
  v_mfma_f32_16x16x32_bf16 v[156:159], a[196:199], a[12:15], v[156:159]
  s_waitcnt lgkmcnt(2)
  v_mfma_f32_16x16x32_bf16 v[160:163], a[200:203], a[0:3], v[160:163]
  ds_read_b64_tr_b16 a[212:213], v41 offset:0
  v_mfma_f32_16x16x32_bf16 v[164:167], a[200:203], a[4:7], v[164:167]
  ds_read_b64_tr_b16 a[214:215], v41 offset:4096
  v_mfma_f32_16x16x32_bf16 v[168:171], a[200:203], a[8:11], v[168:171]
  buffer_load_dwordx4 a[56:59], v3, s[24:27], s18 offen offset:2048 sc1
  v_mfma_f32_16x16x32_bf16 v[172:175], a[200:203], a[12:15], v[172:175]
  v_mfma_f32_16x16x32_bf16 v[176:179], a[204:207], a[0:3], v[176:179]
  ds_read_b64_tr_b16 a[216:217], v42 offset:0
  v_mfma_f32_16x16x32_bf16 v[180:183], a[204:207], a[4:7], v[180:183]
  ds_read_b64_tr_b16 a[218:219], v42 offset:4096
  v_mfma_f32_16x16x32_bf16 v[184:187], a[204:207], a[8:11], v[184:187]
  buffer_load_dwordx4 a[60:63], v3, s[24:27], s18 offen offset:3072 sc1
  s_add_u32 s18, s18, 4096
  s_cmp_eq_u32 s18, 65536
  s_cselect_b32 s18, 0, s18
  v_mfma_f32_16x16x32_bf16 v[188:191], a[204:207], a[12:15], v[188:191]
  s_add_u32 m0, s19, 32768
  s_waitcnt lgkmcnt(2)
  v_mfma_f32_16x16x32_bf16 v[192:195], a[208:211], a[0:3], v[192:195]
  ds_read_b64_tr_b16 a[220:221], v43 offset:0
  v_mfma_f32_16x16x32_bf16 v[196:199], a[208:211], a[4:7], v[196:199]
  ds_read_b64_tr_b16 a[222:223], v43 offset:4096
  v_mfma_f32_16x16x32_bf16 v[200:203], a[208:211], a[8:11], v[200:203]
  v_mfma_f32_16x16x32_bf16 v[204:207], a[208:211], a[12:15], v[204:207]
  buffer_load_dwordx4 v4, s[8:11], s17 offen offset:0 lds
  v_mfma_f32_16x16x32_bf16 v[208:211], a[212:215], a[0:3], v[208:211]
  ds_read_b64_tr_b16 a[192:193], v8 offset:8192
  v_mfma_f32_16x16x32_bf16 v[212:215], a[212:215], a[4:7], v[212:215]
  ds_read_b64_tr_b16 a[194:195], v8 offset:12288
  v_mfma_f32_16x16x32_bf16 v[216:219], a[212:215], a[8:11], v[216:219]
  v_mfma_f32_16x16x32_bf16 v[220:223], a[212:215], a[12:15], v[220:223]
  buffer_load_dwordx4 v5, s[8:11], s17 offen offset:1024 lds
  s_waitcnt lgkmcnt(2)
  v_mfma_f32_16x16x32_bf16 v[224:227], a[216:219], a[0:3], v[224:227]
  ds_read_b64_tr_b16 a[196:197], v9 offset:8192
  v_mfma_f32_16x16x32_bf16 v[228:231], a[216:219], a[4:7], v[228:231]
  ds_read_b64_tr_b16 a[198:199], v9 offset:12288
  v_mfma_f32_16x16x32_bf16 v[232:235], a[216:219], a[8:11], v[232:235]
  v_mfma_f32_16x16x32_bf16 v[236:239], a[216:219], a[12:15], v[236:239]
  buffer_load_dwordx4 v6, s[8:11], s17 offen offset:2048 lds
  v_mfma_f32_16x16x32_bf16 v[240:243], a[220:223], a[0:3], v[240:243]
  ds_read_b64_tr_b16 a[200:201], v10 offset:8192
  v_mfma_f32_16x16x32_bf16 v[244:247], a[220:223], a[4:7], v[244:247]
  ds_read_b64_tr_b16 a[202:203], v10 offset:12288
  v_mfma_f32_16x16x32_bf16 v[248:251], a[220:223], a[8:11], v[248:251]
  v_mfma_f32_16x16x32_bf16 v[252:255], a[220:223], a[12:15], v[252:255]
  buffer_load_dwordx4 v7, s[8:11], s17 offen offset:3072 lds
  s_add_u32 s17, s17, 524288
  s_cmp_eq_u32 s17, 8388608
  s_cselect_b32 s17, 0, s17
  s_waitcnt vmcnt(12) lgkmcnt(2)
  v_mfma_f32_16x16x32_bf16 v[128:131], a[192:195], a[16:19], v[128:131]
  ds_read_b64_tr_b16 a[204:205], v11 offset:8192
  v_mfma_f32_16x16x32_bf16 v[132:135], a[192:195], a[20:23], v[132:135]
  ds_read_b64_tr_b16 a[206:207], v11 offset:12288
  v_mfma_f32_16x16x32_bf16 v[136:139], a[192:195], a[24:27], v[136:139]
  v_mfma_f32_16x16x32_bf16 v[140:143], a[192:195], a[28:31], v[140:143]
  v_mfma_f32_16x16x32_bf16 v[144:147], a[196:199], a[16:19], v[144:147]
  ds_read_b64_tr_b16 a[208:209], v40 offset:8192
  v_mfma_f32_16x16x32_bf16 v[148:151], a[196:199], a[20:23], v[148:151]
  ds_read_b64_tr_b16 a[210:211], v40 offset:12288
  v_mfma_f32_16x16x32_bf16 v[152:155], a[196:199], a[24:27], v[152:155]
  buffer_load_dwordx4 a[0:3], v3, s[12:15], s18 offen offset:0 sc1
  v_mfma_f32_16x16x32_bf16 v[156:159], a[196:199], a[28:31], v[156:159]
  s_waitcnt lgkmcnt(2)
  v_mfma_f32_16x16x32_bf16 v[160:163], a[200:203], a[16:19], v[160:163]
  ds_read_b64_tr_b16 a[212:213], v41 offset:8192
  v_mfma_f32_16x16x32_bf16 v[164:167], a[200:203], a[20:23], v[164:167]
  ds_read_b64_tr_b16 a[214:215], v41 offset:12288
  v_mfma_f32_16x16x32_bf16 v[168:171], a[200:203], a[24:27], v[168:171]
  buffer_load_dwordx4 a[4:7], v3, s[12:15], s18 offen offset:1024 sc1
  v_mfma_f32_16x16x32_bf16 v[172:175], a[200:203], a[28:31], v[172:175]
  v_mfma_f32_16x16x32_bf16 v[176:179], a[204:207], a[16:19], v[176:179]
  ds_read_b64_tr_b16 a[216:217], v42 offset:8192
  v_mfma_f32_16x16x32_bf16 v[180:183], a[204:207], a[20:23], v[180:183]
  ds_read_b64_tr_b16 a[218:219], v42 offset:12288
  v_mfma_f32_16x16x32_bf16 v[184:187], a[204:207], a[24:27], v[184:187]
  buffer_load_dwordx4 a[8:11], v3, s[24:27], s18 offen offset:0 sc1
  v_mfma_f32_16x16x32_bf16 v[188:191], a[204:207], a[28:31], v[188:191]
  s_waitcnt lgkmcnt(2)
  v_mfma_f32_16x16x32_bf16 v[192:195], a[208:211], a[16:19], v[192:195]
  ds_read_b64_tr_b16 a[220:221], v43 offset:8192
  v_mfma_f32_16x16x32_bf16 v[196:199], a[208:211], a[20:23], v[196:199]
  ds_read_b64_tr_b16 a[222:223], v43 offset:12288
  v_mfma_f32_16x16x32_bf16 v[200:203], a[208:211], a[24:27], v[200:203]
  buffer_load_dwordx4 a[12:15], v3, s[24:27], s18 offen offset:1024 sc1
  v_mfma_f32_16x16x32_bf16 v[204:207], a[208:211], a[28:31], v[204:207]
  v_mfma_f32_16x16x32_bf16 v[208:211], a[212:215], a[16:19], v[208:211]
  s_barrier
  ds_read_b64_tr_b16 a[192:193], v8 offset:16384
  v_mfma_f32_16x16x32_bf16 v[212:215], a[212:215], a[20:23], v[212:215]
  ds_read_b64_tr_b16 a[194:195], v8 offset:20480
  v_mfma_f32_16x16x32_bf16 v[216:219], a[212:215], a[24:27], v[216:219]
  v_mfma_f32_16x16x32_bf16 v[220:223], a[212:215], a[28:31], v[220:223]
  s_waitcnt lgkmcnt(2)
  v_mfma_f32_16x16x32_bf16 v[224:227], a[216:219], a[16:19], v[224:227]
  ds_read_b64_tr_b16 a[196:197], v9 offset:16384
  v_mfma_f32_16x16x32_bf16 v[228:231], a[216:219], a[20:23], v[228:231]
  ds_read_b64_tr_b16 a[198:199], v9 offset:20480
  v_mfma_f32_16x16x32_bf16 v[232:235], a[216:219], a[24:27], v[232:235]
  v_mfma_f32_16x16x32_bf16 v[236:239], a[216:219], a[28:31], v[236:239]
  v_mfma_f32_16x16x32_bf16 v[240:243], a[220:223], a[16:19], v[240:243]
  ds_read_b64_tr_b16 a[200:201], v10 offset:16384
  v_mfma_f32_16x16x32_bf16 v[244:247], a[220:223], a[20:23], v[244:247]
  ds_read_b64_tr_b16 a[202:203], v10 offset:20480
  v_mfma_f32_16x16x32_bf16 v[248:251], a[220:223], a[24:27], v[248:251]
  v_mfma_f32_16x16x32_bf16 v[252:255], a[220:223], a[28:31], v[252:255]
  s_waitcnt vmcnt(12) lgkmcnt(2)
  v_mfma_f32_16x16x32_bf16 v[128:131], a[192:195], a[32:35], v[128:131]
  ds_read_b64_tr_b16 a[204:205], v11 offset:16384
  v_mfma_f32_16x16x32_bf16 v[132:135], a[192:195], a[36:39], v[132:135]
  ds_read_b64_tr_b16 a[206:207], v11 offset:20480
  v_mfma_f32_16x16x32_bf16 v[136:139], a[192:195], a[40:43], v[136:139]
  buffer_load_dwordx4 a[16:19], v3, s[12:15], s18 offen offset:2048 sc1
  v_mfma_f32_16x16x32_bf16 v[140:143], a[192:195], a[44:47], v[140:143]
  v_mfma_f32_16x16x32_bf16 v[144:147], a[196:199], a[32:35], v[144:147]
  ds_read_b64_tr_b16 a[208:209], v40 offset:16384
  v_mfma_f32_16x16x32_bf16 v[148:151], a[196:199], a[36:39], v[148:151]
  ds_read_b64_tr_b16 a[210:211], v40 offset:20480
  v_mfma_f32_16x16x32_bf16 v[152:155], a[196:199], a[40:43], v[152:155]
  buffer_load_dwordx4 a[20:23], v3, s[12:15], s18 offen offset:3072 sc1
  v_mfma_f32_16x16x32_bf16 v[156:159], a[196:199], a[44:47], v[156:159]
  s_waitcnt lgkmcnt(2)
  v_mfma_f32_16x16x32_bf16 v[160:163], a[200:203], a[32:35], v[160:163]
  ds_read_b64_tr_b16 a[212:213], v41 offset:16384
  v_mfma_f32_16x16x32_bf16 v[164:167], a[200:203], a[36:39], v[164:167]
  ds_read_b64_tr_b16 a[214:215], v41 offset:20480
  v_mfma_f32_16x16x32_bf16 v[168:171], a[200:203], a[40:43], v[168:171]
  buffer_load_dwordx4 a[24:27], v3, s[24:27], s18 offen offset:2048 sc1
  v_mfma_f32_16x16x32_bf16 v[172:175], a[200:203], a[44:47], v[172:175]
  v_mfma_f32_16x16x32_bf16 v[176:179], a[204:207], a[32:35], v[176:179]
  ds_read_b64_tr_b16 a[216:217], v42 offset:16384
  v_mfma_f32_16x16x32_bf16 v[180:183], a[204:207], a[36:39], v[180:183]
  ds_read_b64_tr_b16 a[218:219], v42 offset:20480
  v_mfma_f32_16x16x32_bf16 v[184:187], a[204:207], a[40:43], v[184:187]
  buffer_load_dwordx4 a[28:31], v3, s[24:27], s18 offen offset:3072 sc1
  s_add_u32 s18, s18, 4096
  s_cmp_eq_u32 s18, 65536
  s_cselect_b32 s18, 0, s18
  v_mfma_f32_16x16x32_bf16 v[188:191], a[204:207], a[44:47], v[188:191]
  s_add_u32 m0, s19, 49152
  s_waitcnt lgkmcnt(2)
  v_mfma_f32_16x16x32_bf16 v[192:195], a[208:211], a[32:35], v[192:195]
  ds_read_b64_tr_b16 a[220:221], v43 offset:16384
  v_mfma_f32_16x16x32_bf16 v[196:199], a[208:211], a[36:39], v[196:199]
  ds_read_b64_tr_b16 a[222:223], v43 offset:20480
  v_mfma_f32_16x16x32_bf16 v[200:203], a[208:211], a[40:43], v[200:203]
  v_mfma_f32_16x16x32_bf16 v[204:207], a[208:211], a[44:47], v[204:207]
  buffer_load_dwordx4 v4, s[8:11], s17 offen offset:0 lds
  v_mfma_f32_16x16x32_bf16 v[208:211], a[212:215], a[32:35], v[208:211]
  ds_read_b64_tr_b16 a[192:193], v8 offset:24576
  v_mfma_f32_16x16x32_bf16 v[212:215], a[212:215], a[36:39], v[212:215]
  ds_read_b64_tr_b16 a[194:195], v8 offset:28672
  v_mfma_f32_16x16x32_bf16 v[216:219], a[212:215], a[40:43], v[216:219]
  v_mfma_f32_16x16x32_bf16 v[220:223], a[212:215], a[44:47], v[220:223]
  buffer_load_dwordx4 v5, s[8:11], s17 offen offset:1024 lds
  s_waitcnt lgkmcnt(2)
  v_mfma_f32_16x16x32_bf16 v[224:227], a[216:219], a[32:35], v[224:227]
  ds_read_b64_tr_b16 a[196:197], v9 offset:24576
  v_mfma_f32_16x16x32_bf16 v[228:231], a[216:219], a[36:39], v[228:231]
  ds_read_b64_tr_b16 a[198:199], v9 offset:28672
  v_mfma_f32_16x16x32_bf16 v[232:235], a[216:219], a[40:43], v[232:235]
  v_mfma_f32_16x16x32_bf16 v[236:239], a[216:219], a[44:47], v[236:239]
  buffer_load_dwordx4 v6, s[8:11], s17 offen offset:2048 lds
  v_mfma_f32_16x16x32_bf16 v[240:243], a[220:223], a[32:35], v[240:243]
  ds_read_b64_tr_b16 a[200:201], v10 offset:24576
  v_mfma_f32_16x16x32_bf16 v[244:247], a[220:223], a[36:39], v[244:247]
  ds_read_b64_tr_b16 a[202:203], v10 offset:28672
  v_mfma_f32_16x16x32_bf16 v[248:251], a[220:223], a[40:43], v[248:251]
  v_mfma_f32_16x16x32_bf16 v[252:255], a[220:223], a[44:47], v[252:255]
  buffer_load_dwordx4 v7, s[8:11], s17 offen offset:3072 lds
  s_add_u32 s17, s17, 524288
  s_cmp_eq_u32 s17, 8388608
  s_cselect_b32 s17, 0, s17
  s_waitcnt vmcnt(16) lgkmcnt(2)
  v_mfma_f32_16x16x32_bf16 v[128:131], a[192:195], a[48:51], v[128:131]
  ds_read_b64_tr_b16 a[204:205], v11 offset:24576
  v_mfma_f32_16x16x32_bf16 v[132:135], a[192:195], a[52:55], v[132:135]
  ds_read_b64_tr_b16 a[206:207], v11 offset:28672
  v_mfma_f32_16x16x32_bf16 v[136:139], a[192:195], a[56:59], v[136:139]
  v_mfma_f32_16x16x32_bf16 v[140:143], a[192:195], a[60:63], v[140:143]
  v_mfma_f32_16x16x32_bf16 v[144:147], a[196:199], a[48:51], v[144:147]
  ds_read_b64_tr_b16 a[208:209], v40 offset:24576
  v_mfma_f32_16x16x32_bf16 v[148:151], a[196:199], a[52:55], v[148:151]
  ds_read_b64_tr_b16 a[210:211], v40 offset:28672
  v_mfma_f32_16x16x32_bf16 v[152:155], a[196:199], a[56:59], v[152:155]
  buffer_load_dwordx4 a[32:35], v3, s[12:15], s18 offen offset:0 sc1
  v_mfma_f32_16x16x32_bf16 v[156:159], a[196:199], a[60:63], v[156:159]
  s_waitcnt lgkmcnt(2)
  v_mfma_f32_16x16x32_bf16 v[160:163], a[200:203], a[48:51], v[160:163]
  ds_read_b64_tr_b16 a[212:213], v41 offset:24576
  v_mfma_f32_16x16x32_bf16 v[164:167], a[200:203], a[52:55], v[164:167]
  ds_read_b64_tr_b16 a[214:215], v41 offset:28672
  v_mfma_f32_16x16x32_bf16 v[168:171], a[200:203], a[56:59], v[168:171]
  buffer_load_dwordx4 a[36:39], v3, s[12:15], s18 offen offset:1024 sc1
  v_mfma_f32_16x16x32_bf16 v[172:175], a[200:203], a[60:63], v[172:175]
  v_mfma_f32_16x16x32_bf16 v[176:179], a[204:207], a[48:51], v[176:179]
  ds_read_b64_tr_b16 a[216:217], v42 offset:24576
  v_mfma_f32_16x16x32_bf16 v[180:183], a[204:207], a[52:55], v[180:183]
  ds_read_b64_tr_b16 a[218:219], v42 offset:28672
  v_mfma_f32_16x16x32_bf16 v[184:187], a[204:207], a[56:59], v[184:187]
  buffer_load_dwordx4 a[40:43], v3, s[24:27], s18 offen offset:0 sc1
  v_mfma_f32_16x16x32_bf16 v[188:191], a[204:207], a[60:63], v[188:191]
  s_waitcnt lgkmcnt(2)
  v_mfma_f32_16x16x32_bf16 v[192:195], a[208:211], a[48:51], v[192:195]
  ds_read_b64_tr_b16 a[220:221], v43 offset:24576
  v_mfma_f32_16x16x32_bf16 v[196:199], a[208:211], a[52:55], v[196:199]
  ds_read_b64_tr_b16 a[222:223], v43 offset:28672
  v_mfma_f32_16x16x32_bf16 v[200:203], a[208:211], a[56:59], v[200:203]
  buffer_load_dwordx4 a[44:47], v3, s[24:27], s18 offen offset:1024 sc1
  v_mfma_f32_16x16x32_bf16 v[204:207], a[208:211], a[60:63], v[204:207]
  v_mfma_f32_16x16x32_bf16 v[208:211], a[212:215], a[48:51], v[208:211]
  s_waitcnt vmcnt(16)
  s_barrier
  ds_read_b64_tr_b16 a[192:193], v8 offset:32768
  v_mfma_f32_16x16x32_bf16 v[212:215], a[212:215], a[52:55], v[212:215]
  ds_read_b64_tr_b16 a[194:195], v8 offset:36864
  v_mfma_f32_16x16x32_bf16 v[216:219], a[212:215], a[56:59], v[216:219]
  v_mfma_f32_16x16x32_bf16 v[220:223], a[212:215], a[60:63], v[220:223]
  s_waitcnt lgkmcnt(2)
  v_mfma_f32_16x16x32_bf16 v[224:227], a[216:219], a[48:51], v[224:227]
  ds_read_b64_tr_b16 a[196:197], v9 offset:32768
  v_mfma_f32_16x16x32_bf16 v[228:231], a[216:219], a[52:55], v[228:231]
  ds_read_b64_tr_b16 a[198:199], v9 offset:36864
  v_mfma_f32_16x16x32_bf16 v[232:235], a[216:219], a[56:59], v[232:235]
  v_mfma_f32_16x16x32_bf16 v[236:239], a[216:219], a[60:63], v[236:239]
  v_mfma_f32_16x16x32_bf16 v[240:243], a[220:223], a[48:51], v[240:243]
  ds_read_b64_tr_b16 a[200:201], v10 offset:32768
  v_mfma_f32_16x16x32_bf16 v[244:247], a[220:223], a[52:55], v[244:247]
  ds_read_b64_tr_b16 a[202:203], v10 offset:36864
  v_mfma_f32_16x16x32_bf16 v[248:251], a[220:223], a[56:59], v[248:251]
  v_mfma_f32_16x16x32_bf16 v[252:255], a[220:223], a[60:63], v[252:255]
  s_waitcnt vmcnt(12) lgkmcnt(2)
  v_mfma_f32_16x16x32_bf16 v[128:131], a[192:195], a[0:3], v[128:131]
  ds_read_b64_tr_b16 a[204:205], v11 offset:32768
  v_mfma_f32_16x16x32_bf16 v[132:135], a[192:195], a[4:7], v[132:135]
  ds_read_b64_tr_b16 a[206:207], v11 offset:36864
  v_mfma_f32_16x16x32_bf16 v[136:139], a[192:195], a[8:11], v[136:139]
  buffer_load_dwordx4 a[48:51], v3, s[12:15], s18 offen offset:2048 sc1
  v_mfma_f32_16x16x32_bf16 v[140:143], a[192:195], a[12:15], v[140:143]
  v_mfma_f32_16x16x32_bf16 v[144:147], a[196:199], a[0:3], v[144:147]
  ds_read_b64_tr_b16 a[208:209], v40 offset:32768
  v_mfma_f32_16x16x32_bf16 v[148:151], a[196:199], a[4:7], v[148:151]
  ds_read_b64_tr_b16 a[210:211], v40 offset:36864
  v_mfma_f32_16x16x32_bf16 v[152:155], a[196:199], a[8:11], v[152:155]
  buffer_load_dwordx4 a[52:55], v3, s[12:15], s18 offen offset:3072 sc1
  v_mfma_f32_16x16x32_bf16 v[156:159], a[196:199], a[12:15], v[156:159]
  s_waitcnt lgkmcnt(2)
  v_mfma_f32_16x16x32_bf16 v[160:163], a[200:203], a[0:3], v[160:163]
  ds_read_b64_tr_b16 a[212:213], v41 offset:32768
  v_mfma_f32_16x16x32_bf16 v[164:167], a[200:203], a[4:7], v[164:167]
  ds_read_b64_tr_b16 a[214:215], v41 offset:36864
  v_mfma_f32_16x16x32_bf16 v[168:171], a[200:203], a[8:11], v[168:171]
  buffer_load_dwordx4 a[56:59], v3, s[24:27], s18 offen offset:2048 sc1
  v_mfma_f32_16x16x32_bf16 v[172:175], a[200:203], a[12:15], v[172:175]
  v_mfma_f32_16x16x32_bf16 v[176:179], a[204:207], a[0:3], v[176:179]
  ds_read_b64_tr_b16 a[216:217], v42 offset:32768
  v_mfma_f32_16x16x32_bf16 v[180:183], a[204:207], a[4:7], v[180:183]
  ds_read_b64_tr_b16 a[218:219], v42 offset:36864
  v_mfma_f32_16x16x32_bf16 v[184:187], a[204:207], a[8:11], v[184:187]
  buffer_load_dwordx4 a[60:63], v3, s[24:27], s18 offen offset:3072 sc1
  s_add_u32 s18, s18, 4096
  s_cmp_eq_u32 s18, 65536
  s_cselect_b32 s18, 0, s18
  v_mfma_f32_16x16x32_bf16 v[188:191], a[204:207], a[12:15], v[188:191]
  s_add_u32 m0, s19, 0
  s_waitcnt lgkmcnt(2)
  v_mfma_f32_16x16x32_bf16 v[192:195], a[208:211], a[0:3], v[192:195]
  ds_read_b64_tr_b16 a[220:221], v43 offset:32768
  v_mfma_f32_16x16x32_bf16 v[196:199], a[208:211], a[4:7], v[196:199]
  ds_read_b64_tr_b16 a[222:223], v43 offset:36864
  v_mfma_f32_16x16x32_bf16 v[200:203], a[208:211], a[8:11], v[200:203]
  v_mfma_f32_16x16x32_bf16 v[204:207], a[208:211], a[12:15], v[204:207]
  buffer_load_dwordx4 v4, s[8:11], s17 offen offset:0 lds
  v_mfma_f32_16x16x32_bf16 v[208:211], a[212:215], a[0:3], v[208:211]
  ds_read_b64_tr_b16 a[192:193], v8 offset:40960
  v_mfma_f32_16x16x32_bf16 v[212:215], a[212:215], a[4:7], v[212:215]
  ds_read_b64_tr_b16 a[194:195], v8 offset:45056
  v_mfma_f32_16x16x32_bf16 v[216:219], a[212:215], a[8:11], v[216:219]
  v_mfma_f32_16x16x32_bf16 v[220:223], a[212:215], a[12:15], v[220:223]
  buffer_load_dwordx4 v5, s[8:11], s17 offen offset:1024 lds
  s_waitcnt lgkmcnt(2)
  v_mfma_f32_16x16x32_bf16 v[224:227], a[216:219], a[0:3], v[224:227]
  ds_read_b64_tr_b16 a[196:197], v9 offset:40960
  v_mfma_f32_16x16x32_bf16 v[228:231], a[216:219], a[4:7], v[228:231]
  ds_read_b64_tr_b16 a[198:199], v9 offset:45056
  v_mfma_f32_16x16x32_bf16 v[232:235], a[216:219], a[8:11], v[232:235]
  v_mfma_f32_16x16x32_bf16 v[236:239], a[216:219], a[12:15], v[236:239]
  buffer_load_dwordx4 v6, s[8:11], s17 offen offset:2048 lds
  v_mfma_f32_16x16x32_bf16 v[240:243], a[220:223], a[0:3], v[240:243]
  ds_read_b64_tr_b16 a[200:201], v10 offset:40960
  v_mfma_f32_16x16x32_bf16 v[244:247], a[220:223], a[4:7], v[244:247]
  ds_read_b64_tr_b16 a[202:203], v10 offset:45056
  v_mfma_f32_16x16x32_bf16 v[248:251], a[220:223], a[8:11], v[248:251]
  v_mfma_f32_16x16x32_bf16 v[252:255], a[220:223], a[12:15], v[252:255]
  buffer_load_dwordx4 v7, s[8:11], s17 offen offset:3072 lds
  s_add_u32 s17, s17, 524288
  s_cmp_eq_u32 s17, 8388608
  s_cselect_b32 s17, 0, s17
  s_waitcnt vmcnt(16) lgkmcnt(2)
  v_mfma_f32_16x16x32_bf16 v[128:131], a[192:195], a[16:19], v[128:131]
  ds_read_b64_tr_b16 a[204:205], v11 offset:40960
  v_mfma_f32_16x16x32_bf16 v[132:135], a[192:195], a[20:23], v[132:135]
  ds_read_b64_tr_b16 a[206:207], v11 offset:45056
  v_mfma_f32_16x16x32_bf16 v[136:139], a[192:195], a[24:27], v[136:139]
  v_mfma_f32_16x16x32_bf16 v[140:143], a[192:195], a[28:31], v[140:143]
  v_mfma_f32_16x16x32_bf16 v[144:147], a[196:199], a[16:19], v[144:147]
  ds_read_b64_tr_b16 a[208:209], v40 offset:40960
  v_mfma_f32_16x16x32_bf16 v[148:151], a[196:199], a[20:23], v[148:151]
  ds_read_b64_tr_b16 a[210:211], v40 offset:45056
  v_mfma_f32_16x16x32_bf16 v[152:155], a[196:199], a[24:27], v[152:155]
  buffer_load_dwordx4 a[0:3], v3, s[12:15], s18 offen offset:0 sc1
  v_mfma_f32_16x16x32_bf16 v[156:159], a[196:199], a[28:31], v[156:159]
  s_waitcnt lgkmcnt(2)
  v_mfma_f32_16x16x32_bf16 v[160:163], a[200:203], a[16:19], v[160:163]
  ds_read_b64_tr_b16 a[212:213], v41 offset:40960
  v_mfma_f32_16x16x32_bf16 v[164:167], a[200:203], a[20:23], v[164:167]
  ds_read_b64_tr_b16 a[214:215], v41 offset:45056
  v_mfma_f32_16x16x32_bf16 v[168:171], a[200:203], a[24:27], v[168:171]
  buffer_load_dwordx4 a[4:7], v3, s[12:15], s18 offen offset:1024 sc1
  v_mfma_f32_16x16x32_bf16 v[172:175], a[200:203], a[28:31], v[172:175]
  v_mfma_f32_16x16x32_bf16 v[176:179], a[204:207], a[16:19], v[176:179]
  ds_read_b64_tr_b16 a[216:217], v42 offset:40960
  v_mfma_f32_16x16x32_bf16 v[180:183], a[204:207], a[20:23], v[180:183]
  ds_read_b64_tr_b16 a[218:219], v42 offset:45056
  v_mfma_f32_16x16x32_bf16 v[184:187], a[204:207], a[24:27], v[184:187]
  buffer_load_dwordx4 a[8:11], v3, s[24:27], s18 offen offset:0 sc1
  v_mfma_f32_16x16x32_bf16 v[188:191], a[204:207], a[28:31], v[188:191]
  s_waitcnt lgkmcnt(2)
  v_mfma_f32_16x16x32_bf16 v[192:195], a[208:211], a[16:19], v[192:195]
  ds_read_b64_tr_b16 a[220:221], v43 offset:40960
  v_mfma_f32_16x16x32_bf16 v[196:199], a[208:211], a[20:23], v[196:199]
  ds_read_b64_tr_b16 a[222:223], v43 offset:45056
  v_mfma_f32_16x16x32_bf16 v[200:203], a[208:211], a[24:27], v[200:203]
  buffer_load_dwordx4 a[12:15], v3, s[24:27], s18 offen offset:1024 sc1
  v_mfma_f32_16x16x32_bf16 v[204:207], a[208:211], a[28:31], v[204:207]
  v_mfma_f32_16x16x32_bf16 v[208:211], a[212:215], a[16:19], v[208:211]
  s_waitcnt vmcnt(16)
  s_barrier
  ds_read_b64_tr_b16 a[192:193], v8 offset:49152
  v_mfma_f32_16x16x32_bf16 v[212:215], a[212:215], a[20:23], v[212:215]
  ds_read_b64_tr_b16 a[194:195], v8 offset:53248
  v_mfma_f32_16x16x32_bf16 v[216:219], a[212:215], a[24:27], v[216:219]
  v_mfma_f32_16x16x32_bf16 v[220:223], a[212:215], a[28:31], v[220:223]
  s_waitcnt lgkmcnt(2)
  v_mfma_f32_16x16x32_bf16 v[224:227], a[216:219], a[16:19], v[224:227]
  ds_read_b64_tr_b16 a[196:197], v9 offset:49152
  v_mfma_f32_16x16x32_bf16 v[228:231], a[216:219], a[20:23], v[228:231]
  ds_read_b64_tr_b16 a[198:199], v9 offset:53248
  v_mfma_f32_16x16x32_bf16 v[232:235], a[216:219], a[24:27], v[232:235]
  v_mfma_f32_16x16x32_bf16 v[236:239], a[216:219], a[28:31], v[236:239]
  v_mfma_f32_16x16x32_bf16 v[240:243], a[220:223], a[16:19], v[240:243]
  ds_read_b64_tr_b16 a[200:201], v10 offset:49152
  v_mfma_f32_16x16x32_bf16 v[244:247], a[220:223], a[20:23], v[244:247]
  ds_read_b64_tr_b16 a[202:203], v10 offset:53248
  v_mfma_f32_16x16x32_bf16 v[248:251], a[220:223], a[24:27], v[248:251]
  v_mfma_f32_16x16x32_bf16 v[252:255], a[220:223], a[28:31], v[252:255]
  s_waitcnt vmcnt(12) lgkmcnt(2)
  v_mfma_f32_16x16x32_bf16 v[128:131], a[192:195], a[32:35], v[128:131]
  ds_read_b64_tr_b16 a[204:205], v11 offset:49152
  v_mfma_f32_16x16x32_bf16 v[132:135], a[192:195], a[36:39], v[132:135]
  ds_read_b64_tr_b16 a[206:207], v11 offset:53248
  v_mfma_f32_16x16x32_bf16 v[136:139], a[192:195], a[40:43], v[136:139]
  buffer_load_dwordx4 a[16:19], v3, s[12:15], s18 offen offset:2048 sc1
  v_mfma_f32_16x16x32_bf16 v[140:143], a[192:195], a[44:47], v[140:143]
  v_mfma_f32_16x16x32_bf16 v[144:147], a[196:199], a[32:35], v[144:147]
  ds_read_b64_tr_b16 a[208:209], v40 offset:49152
  v_mfma_f32_16x16x32_bf16 v[148:151], a[196:199], a[36:39], v[148:151]
  ds_read_b64_tr_b16 a[210:211], v40 offset:53248
  v_mfma_f32_16x16x32_bf16 v[152:155], a[196:199], a[40:43], v[152:155]
  buffer_load_dwordx4 a[20:23], v3, s[12:15], s18 offen offset:3072 sc1
  v_mfma_f32_16x16x32_bf16 v[156:159], a[196:199], a[44:47], v[156:159]
  s_waitcnt lgkmcnt(2)
  v_mfma_f32_16x16x32_bf16 v[160:163], a[200:203], a[32:35], v[160:163]
  ds_read_b64_tr_b16 a[212:213], v41 offset:49152
  v_mfma_f32_16x16x32_bf16 v[164:167], a[200:203], a[36:39], v[164:167]
  ds_read_b64_tr_b16 a[214:215], v41 offset:53248
  v_mfma_f32_16x16x32_bf16 v[168:171], a[200:203], a[40:43], v[168:171]
  buffer_load_dwordx4 a[24:27], v3, s[24:27], s18 offen offset:2048 sc1
  v_mfma_f32_16x16x32_bf16 v[172:175], a[200:203], a[44:47], v[172:175]
  v_mfma_f32_16x16x32_bf16 v[176:179], a[204:207], a[32:35], v[176:179]
  ds_read_b64_tr_b16 a[216:217], v42 offset:49152
  v_mfma_f32_16x16x32_bf16 v[180:183], a[204:207], a[36:39], v[180:183]
  ds_read_b64_tr_b16 a[218:219], v42 offset:53248
  v_mfma_f32_16x16x32_bf16 v[184:187], a[204:207], a[40:43], v[184:187]
  buffer_load_dwordx4 a[28:31], v3, s[24:27], s18 offen offset:3072 sc1
  s_add_u32 s18, s18, 4096
  s_cmp_eq_u32 s18, 65536
  s_cselect_b32 s18, 0, s18
  v_mfma_f32_16x16x32_bf16 v[188:191], a[204:207], a[44:47], v[188:191]
  s_add_u32 m0, s19, 16384
  s_waitcnt lgkmcnt(2)
  v_mfma_f32_16x16x32_bf16 v[192:195], a[208:211], a[32:35], v[192:195]
  ds_read_b64_tr_b16 a[220:221], v43 offset:49152
  v_mfma_f32_16x16x32_bf16 v[196:199], a[208:211], a[36:39], v[196:199]
  ds_read_b64_tr_b16 a[222:223], v43 offset:53248
  v_mfma_f32_16x16x32_bf16 v[200:203], a[208:211], a[40:43], v[200:203]
  v_mfma_f32_16x16x32_bf16 v[204:207], a[208:211], a[44:47], v[204:207]
  buffer_load_dwordx4 v4, s[8:11], s17 offen offset:0 lds
  v_mfma_f32_16x16x32_bf16 v[208:211], a[212:215], a[32:35], v[208:211]
  ds_read_b64_tr_b16 a[192:193], v8 offset:57344
  v_mfma_f32_16x16x32_bf16 v[212:215], a[212:215], a[36:39], v[212:215]
  ds_read_b64_tr_b16 a[194:195], v8 offset:61440
  v_mfma_f32_16x16x32_bf16 v[216:219], a[212:215], a[40:43], v[216:219]
  v_mfma_f32_16x16x32_bf16 v[220:223], a[212:215], a[44:47], v[220:223]
  buffer_load_dwordx4 v5, s[8:11], s17 offen offset:1024 lds
  s_waitcnt lgkmcnt(2)
  v_mfma_f32_16x16x32_bf16 v[224:227], a[216:219], a[32:35], v[224:227]
  ds_read_b64_tr_b16 a[196:197], v9 offset:57344
  v_mfma_f32_16x16x32_bf16 v[228:231], a[216:219], a[36:39], v[228:231]
  ds_read_b64_tr_b16 a[198:199], v9 offset:61440
  v_mfma_f32_16x16x32_bf16 v[232:235], a[216:219], a[40:43], v[232:235]
  v_mfma_f32_16x16x32_bf16 v[236:239], a[216:219], a[44:47], v[236:239]
  buffer_load_dwordx4 v6, s[8:11], s17 offen offset:2048 lds
  v_mfma_f32_16x16x32_bf16 v[240:243], a[220:223], a[32:35], v[240:243]
  ds_read_b64_tr_b16 a[200:201], v10 offset:57344
  v_mfma_f32_16x16x32_bf16 v[244:247], a[220:223], a[36:39], v[244:247]
  ds_read_b64_tr_b16 a[202:203], v10 offset:61440
  v_mfma_f32_16x16x32_bf16 v[248:251], a[220:223], a[40:43], v[248:251]
  v_mfma_f32_16x16x32_bf16 v[252:255], a[220:223], a[44:47], v[252:255]
  buffer_load_dwordx4 v7, s[8:11], s17 offen offset:3072 lds
  s_add_u32 s17, s17, 524288
  s_cmp_eq_u32 s17, 8388608
  s_cselect_b32 s17, 0, s17
  s_waitcnt vmcnt(16) lgkmcnt(2)
  v_mfma_f32_16x16x32_bf16 v[128:131], a[192:195], a[48:51], v[128:131]
  ds_read_b64_tr_b16 a[204:205], v11 offset:57344
  v_mfma_f32_16x16x32_bf16 v[132:135], a[192:195], a[52:55], v[132:135]
  ds_read_b64_tr_b16 a[206:207], v11 offset:61440
  v_mfma_f32_16x16x32_bf16 v[136:139], a[192:195], a[56:59], v[136:139]
  v_mfma_f32_16x16x32_bf16 v[140:143], a[192:195], a[60:63], v[140:143]
  v_mfma_f32_16x16x32_bf16 v[144:147], a[196:199], a[48:51], v[144:147]
  ds_read_b64_tr_b16 a[208:209], v40 offset:57344
  v_mfma_f32_16x16x32_bf16 v[148:151], a[196:199], a[52:55], v[148:151]
  ds_read_b64_tr_b16 a[210:211], v40 offset:61440
  v_mfma_f32_16x16x32_bf16 v[152:155], a[196:199], a[56:59], v[152:155]
  buffer_load_dwordx4 a[32:35], v3, s[12:15], s18 offen offset:0 sc1
  v_mfma_f32_16x16x32_bf16 v[156:159], a[196:199], a[60:63], v[156:159]
  s_waitcnt lgkmcnt(2)
  v_mfma_f32_16x16x32_bf16 v[160:163], a[200:203], a[48:51], v[160:163]
  ds_read_b64_tr_b16 a[212:213], v41 offset:57344
  v_mfma_f32_16x16x32_bf16 v[164:167], a[200:203], a[52:55], v[164:167]
  ds_read_b64_tr_b16 a[214:215], v41 offset:61440
  v_mfma_f32_16x16x32_bf16 v[168:171], a[200:203], a[56:59], v[168:171]
  buffer_load_dwordx4 a[36:39], v3, s[12:15], s18 offen offset:1024 sc1
  v_mfma_f32_16x16x32_bf16 v[172:175], a[200:203], a[60:63], v[172:175]
  v_mfma_f32_16x16x32_bf16 v[176:179], a[204:207], a[48:51], v[176:179]
  ds_read_b64_tr_b16 a[216:217], v42 offset:57344
  v_mfma_f32_16x16x32_bf16 v[180:183], a[204:207], a[52:55], v[180:183]
  ds_read_b64_tr_b16 a[218:219], v42 offset:61440
  v_mfma_f32_16x16x32_bf16 v[184:187], a[204:207], a[56:59], v[184:187]
  buffer_load_dwordx4 a[40:43], v3, s[24:27], s18 offen offset:0 sc1
  v_mfma_f32_16x16x32_bf16 v[188:191], a[204:207], a[60:63], v[188:191]
  s_waitcnt lgkmcnt(2)
  v_mfma_f32_16x16x32_bf16 v[192:195], a[208:211], a[48:51], v[192:195]
  ds_read_b64_tr_b16 a[220:221], v43 offset:57344
  v_mfma_f32_16x16x32_bf16 v[196:199], a[208:211], a[52:55], v[196:199]
  ds_read_b64_tr_b16 a[222:223], v43 offset:61440
  v_mfma_f32_16x16x32_bf16 v[200:203], a[208:211], a[56:59], v[200:203]
  buffer_load_dwordx4 a[44:47], v3, s[24:27], s18 offen offset:1024 sc1
  v_mfma_f32_16x16x32_bf16 v[204:207], a[208:211], a[60:63], v[204:207]
  v_mfma_f32_16x16x32_bf16 v[208:211], a[212:215], a[48:51], v[208:211]
  s_waitcnt vmcnt(16)
  s_barrier
  ds_read_b64_tr_b16 a[192:193], v8 offset:0
  v_mfma_f32_16x16x32_bf16 v[212:215], a[212:215], a[52:55], v[212:215]
  ds_read_b64_tr_b16 a[194:195], v8 offset:4096
  v_mfma_f32_16x16x32_bf16 v[216:219], a[212:215], a[56:59], v[216:219]
  v_mfma_f32_16x16x32_bf16 v[220:223], a[212:215], a[60:63], v[220:223]
  s_waitcnt lgkmcnt(2)
  v_mfma_f32_16x16x32_bf16 v[224:227], a[216:219], a[48:51], v[224:227]
  ds_read_b64_tr_b16 a[196:197], v9 offset:0
  v_mfma_f32_16x16x32_bf16 v[228:231], a[216:219], a[52:55], v[228:231]
  ds_read_b64_tr_b16 a[198:199], v9 offset:4096
  v_mfma_f32_16x16x32_bf16 v[232:235], a[216:219], a[56:59], v[232:235]
  v_mfma_f32_16x16x32_bf16 v[236:239], a[216:219], a[60:63], v[236:239]
  v_mfma_f32_16x16x32_bf16 v[240:243], a[220:223], a[48:51], v[240:243]
  ds_read_b64_tr_b16 a[200:201], v10 offset:0
  v_mfma_f32_16x16x32_bf16 v[244:247], a[220:223], a[52:55], v[244:247]
  ds_read_b64_tr_b16 a[202:203], v10 offset:4096
  v_mfma_f32_16x16x32_bf16 v[248:251], a[220:223], a[56:59], v[248:251]
  v_mfma_f32_16x16x32_bf16 v[252:255], a[220:223], a[60:63], v[252:255]
  s_sub_u32 s20, s20, 1
  s_cmp_lg_u32 s20, 0
  s_cbranch_scc1 L_mk2_q_2
  s_waitcnt lgkmcnt(4)
  ds_read_b128 a[192:195], v16 offset:0
  s_waitcnt lgkmcnt(3)
  ds_read_b128 a[196:199], v17 offset:0
  s_waitcnt lgkmcnt(2)
  ds_read_b128 a[200:203], v18 offset:0
  ds_read_b128 a[204:207], v19 offset:0
  ds_read_b128 a[208:211], v20 offset:0
  ds_read_b128 a[212:215], v21 offset:0
  ds_read_b128 a[216:219], v22 offset:0
  ds_read_b128 a[220:223], v23 offset:0
  s_add_u32 m0, s19, 98304
  s_nop 0
  buffer_load_dwordx4 v12, s[28:31], s43 offen offset:0 lds
  buffer_load_dwordx4 v13, s[28:31], s43 offen offset:1024 lds
  buffer_load_dwordx4 v14, s[28:31], s43 offen offset:2048 lds
  buffer_load_dwordx4 v15, s[28:31], s43 offen offset:3072 lds
  s_add_u32 s43, s43, 8192
  s_add_u32 m0, s19, 114688
  s_nop 0
  buffer_load_dwordx4 v12, s[28:31], s43 offen offset:0 lds
  buffer_load_dwordx4 v13, s[28:31], s43 offen offset:1024 lds
  buffer_load_dwordx4 v14, s[28:31], s43 offen offset:2048 lds
  buffer_load_dwordx4 v15, s[28:31], s43 offen offset:3072 lds
  s_add_u32 s43, s43, 8192
  v_cvt_pk_bf16_f32 v36, v128, v129
  v_cvt_pk_bf16_f32 v37, v130, v131
  v_cvt_pk_bf16_f32 v38, v132, v133
  v_cvt_pk_bf16_f32 v39, v134, v135
  v_cvt_pk_bf16_f32 v52, v136, v137
  v_cvt_pk_bf16_f32 v53, v138, v139
  v_cvt_pk_bf16_f32 v54, v140, v141
  v_cvt_pk_bf16_f32 v55, v142, v143
  v_permlane16_swap_b32 v36, v38
  v_permlane16_swap_b32 v37, v39
  v_accvgpr_write_b32 a128, v36
  v_permlane16_swap_b32 v52, v54
  v_permlane16_swap_b32 v53, v55
  v_accvgpr_write_b32 a129, v37
  v_accvgpr_write_b32 a130, v38
  v_accvgpr_write_b32 a131, v39
  v_accvgpr_write_b32 a160, v52
  v_accvgpr_write_b32 a161, v53
  v_accvgpr_write_b32 a162, v54
  v_accvgpr_write_b32 a163, v55
  v_cvt_pk_bf16_f32 v36, v144, v145
  v_cvt_pk_bf16_f32 v37, v146, v147
  v_cvt_pk_bf16_f32 v38, v148, v149
  v_cvt_pk_bf16_f32 v39, v150, v151
  v_cvt_pk_bf16_f32 v52, v152, v153
  v_cvt_pk_bf16_f32 v53, v154, v155
  v_cvt_pk_bf16_f32 v54, v156, v157
  v_cvt_pk_bf16_f32 v55, v158, v159
  v_permlane16_swap_b32 v36, v38
  v_permlane16_swap_b32 v37, v39
  v_accvgpr_write_b32 a132, v36
  v_permlane16_swap_b32 v52, v54
  v_permlane16_swap_b32 v53, v55
  v_accvgpr_write_b32 a133, v37
  v_accvgpr_write_b32 a134, v38
  v_accvgpr_write_b32 a135, v39
  v_accvgpr_write_b32 a164, v52
  v_accvgpr_write_b32 a165, v53
  v_accvgpr_write_b32 a166, v54
  v_accvgpr_write_b32 a167, v55
  v_cvt_pk_bf16_f32 v36, v160, v161
  v_cvt_pk_bf16_f32 v37, v162, v163
  v_cvt_pk_bf16_f32 v38, v164, v165
  v_cvt_pk_bf16_f32 v39, v166, v167
  v_cvt_pk_bf16_f32 v52, v168, v169
  v_cvt_pk_bf16_f32 v53, v170, v171
  v_cvt_pk_bf16_f32 v54, v172, v173
  v_cvt_pk_bf16_f32 v55, v174, v175
  v_permlane16_swap_b32 v36, v38
  v_permlane16_swap_b32 v37, v39
  v_accvgpr_write_b32 a136, v36
  v_permlane16_swap_b32 v52, v54
  v_permlane16_swap_b32 v53, v55
  v_accvgpr_write_b32 a137, v37
  v_accvgpr_write_b32 a138, v38
  v_accvgpr_write_b32 a139, v39
  v_accvgpr_write_b32 a168, v52
  v_accvgpr_write_b32 a169, v53
  v_accvgpr_write_b32 a170, v54
  v_accvgpr_write_b32 a171, v55
  v_cvt_pk_bf16_f32 v36, v176, v177
  v_cvt_pk_bf16_f32 v37, v178, v179
  v_cvt_pk_bf16_f32 v38, v180, v181
  v_cvt_pk_bf16_f32 v39, v182, v183
  v_cvt_pk_bf16_f32 v52, v184, v185
  v_cvt_pk_bf16_f32 v53, v186, v187
  v_cvt_pk_bf16_f32 v54, v188, v189
  v_cvt_pk_bf16_f32 v55, v190, v191
  v_permlane16_swap_b32 v36, v38
  v_permlane16_swap_b32 v37, v39
  v_accvgpr_write_b32 a140, v36
  v_permlane16_swap_b32 v52, v54
  v_permlane16_swap_b32 v53, v55
  v_accvgpr_write_b32 a141, v37
  v_accvgpr_write_b32 a142, v38
  v_accvgpr_write_b32 a143, v39
  v_accvgpr_write_b32 a172, v52
  v_accvgpr_write_b32 a173, v53
  v_accvgpr_write_b32 a174, v54
  v_accvgpr_write_b32 a175, v55
  s_nop 0
  s_waitcnt lgkmcnt(7)
  v_mfma_f32_32x32x16_bf16 v[128:143], a[192:195], a[128:131], 0
  v_cvt_pk_bf16_f32 v36, v192, v193
  v_cvt_pk_bf16_f32 v37, v194, v195
  v_cvt_pk_bf16_f32 v38, v196, v197
  v_cvt_pk_bf16_f32 v39, v198, v199
  v_cvt_pk_bf16_f32 v52, v200, v201
  v_cvt_pk_bf16_f32 v53, v202, v203
  v_cvt_pk_bf16_f32 v54, v204, v205
  v_cvt_pk_bf16_f32 v55, v206, v207
  v_permlane16_swap_b32 v36, v38
  v_permlane16_swap_b32 v37, v39
  v_mfma_f32_32x32x16_bf16 v[144:159], a[192:195], a[160:163], 0
  v_accvgpr_write_b32 a144, v36
  v_permlane16_swap_b32 v52, v54
  v_permlane16_swap_b32 v53, v55
  v_accvgpr_write_b32 a145, v37
  v_accvgpr_write_b32 a146, v38
  v_accvgpr_write_b32 a147, v39
  v_accvgpr_write_b32 a176, v52
  v_accvgpr_write_b32 a177, v53
  v_accvgpr_write_b32 a178, v54
  v_accvgpr_write_b32 a179, v55
  s_waitcnt lgkmcnt(6)
  v_mfma_f32_32x32x16_bf16 v[128:143], a[196:199], a[132:135], v[128:143]
  v_cvt_pk_bf16_f32 v36, v208, v209
  v_cvt_pk_bf16_f32 v37, v210, v211
  v_cvt_pk_bf16_f32 v38, v212, v213
  v_cvt_pk_bf16_f32 v39, v214, v215
  v_cvt_pk_bf16_f32 v52, v216, v217
  v_cvt_pk_bf16_f32 v53, v218, v219
  v_cvt_pk_bf16_f32 v54, v220, v221
  v_cvt_pk_bf16_f32 v55, v222, v223
  v_permlane16_swap_b32 v36, v38
  v_permlane16_swap_b32 v37, v39
  v_mfma_f32_32x32x16_bf16 v[144:159], a[196:199], a[164:167], v[144:159]
  v_accvgpr_write_b32 a148, v36
  v_permlane16_swap_b32 v52, v54
  v_permlane16_swap_b32 v53, v55
  v_accvgpr_write_b32 a149, v37
  v_accvgpr_write_b32 a150, v38
  v_accvgpr_write_b32 a151, v39
  v_accvgpr_write_b32 a180, v52
  v_accvgpr_write_b32 a181, v53
  v_accvgpr_write_b32 a182, v54
  v_accvgpr_write_b32 a183, v55
  s_waitcnt lgkmcnt(5)
  v_mfma_f32_32x32x16_bf16 v[128:143], a[200:203], a[136:139], v[128:143]
  v_cvt_pk_bf16_f32 v36, v224, v225
  v_cvt_pk_bf16_f32 v37, v226, v227
  v_cvt_pk_bf16_f32 v38, v228, v229
  v_cvt_pk_bf16_f32 v39, v230, v231
  v_cvt_pk_bf16_f32 v52, v232, v233
  v_cvt_pk_bf16_f32 v53, v234, v235
  v_cvt_pk_bf16_f32 v54, v236, v237
  v_cvt_pk_bf16_f32 v55, v238, v239
  v_permlane16_swap_b32 v36, v38
  v_permlane16_swap_b32 v37, v39
  v_mfma_f32_32x32x16_bf16 v[144:159], a[200:203], a[168:171], v[144:159]
  v_accvgpr_write_b32 a152, v36
  v_permlane16_swap_b32 v52, v54
  v_permlane16_swap_b32 v53, v55
  v_accvgpr_write_b32 a153, v37
  v_accvgpr_write_b32 a154, v38
  v_accvgpr_write_b32 a155, v39
  v_accvgpr_write_b32 a184, v52
  v_accvgpr_write_b32 a185, v53
  v_accvgpr_write_b32 a186, v54
  v_accvgpr_write_b32 a187, v55
  s_waitcnt lgkmcnt(4)
  v_mfma_f32_32x32x16_bf16 v[128:143], a[204:207], a[140:143], v[128:143]
  v_cvt_pk_bf16_f32 v36, v240, v241
  v_cvt_pk_bf16_f32 v37, v242, v243
  v_cvt_pk_bf16_f32 v38, v244, v245
  v_cvt_pk_bf16_f32 v39, v246, v247
  v_cvt_pk_bf16_f32 v52, v248, v249
  v_cvt_pk_bf16_f32 v53, v250, v251
  v_cvt_pk_bf16_f32 v54, v252, v253
  v_cvt_pk_bf16_f32 v55, v254, v255
  v_permlane16_swap_b32 v36, v38
  v_permlane16_swap_b32 v37, v39
  v_mfma_f32_32x32x16_bf16 v[144:159], a[204:207], a[172:175], v[144:159]
  v_accvgpr_write_b32 a156, v36
  v_permlane16_swap_b32 v52, v54
  v_permlane16_swap_b32 v53, v55
  v_accvgpr_write_b32 a157, v37
  v_accvgpr_write_b32 a158, v38
  v_accvgpr_write_b32 a159, v39
  v_accvgpr_write_b32 a188, v52
  v_accvgpr_write_b32 a189, v53
  v_accvgpr_write_b32 a190, v54
  v_accvgpr_write_b32 a191, v55
  s_waitcnt lgkmcnt(3)
  v_mfma_f32_32x32x16_bf16 v[128:143], a[208:211], a[144:147], v[128:143]
  v_mfma_f32_32x32x16_bf16 v[144:159], a[208:211], a[176:179], v[144:159]
  ds_read_b128 a[192:195], v16 offset:16384
  s_waitcnt lgkmcnt(3)
  v_mfma_f32_32x32x16_bf16 v[128:143], a[212:215], a[148:151], v[128:143]
  v_mfma_f32_32x32x16_bf16 v[144:159], a[212:215], a[180:183], v[144:159]
  ds_read_b128 a[196:199], v17 offset:16384
  s_waitcnt lgkmcnt(3)
  v_mfma_f32_32x32x16_bf16 v[128:143], a[216:219], a[152:155], v[128:143]
  v_mfma_f32_32x32x16_bf16 v[144:159], a[216:219], a[184:187], v[144:159]
  ds_read_b128 a[200:203], v18 offset:16384
  s_waitcnt lgkmcnt(3)
  v_mfma_f32_32x32x16_bf16 v[128:143], a[220:223], a[156:159], v[128:143]
  v_mfma_f32_32x32x16_bf16 v[144:159], a[220:223], a[188:191], v[144:159]
  ds_read_b128 a[204:207], v19 offset:16384
  v_mov_b32 v28, 0
  v_mov_b32 v29, 0
  s_nop 7
  s_nop 1
  v_max3_f32 v30, v128, v129, v130
  v_max3_f32 v31, v144, v145, v146
  v_max3_f32 v30, v30, v131, v132
  v_max3_f32 v31, v31, v147, v148
  v_max3_f32 v30, v30, v133, v134
  v_max3_f32 v31, v31, v149, v150
  v_max3_f32 v30, v30, v135, v136
  v_max3_f32 v31, v31, v151, v152
  v_max3_f32 v30, v30, v137, v138
  v_max3_f32 v31, v31, v153, v154
  v_max3_f32 v30, v30, v139, v140
  v_max3_f32 v31, v31, v155, v156
  v_max3_f32 v30, v30, v141, v142
  v_max3_f32 v31, v31, v157, v158
  v_max_f32 v30, v30, v143
  v_max_f32 v31, v31, v159
  v_mov_b32 v36, v30
  v_mov_b32 v37, v31
  s_nop 1
  v_permlane32_swap_b32 v30, v36
  v_permlane32_swap_b32 v31, v37
  s_nop 0
  v_max_f32 v30, v30, v36
  v_max_f32 v31, v31, v37
  v_sub_f32 v192, 0, v30
  v_sub_f32 v193, 0, v30
  v_sub_f32 v194, 0, v30
  v_sub_f32 v195, 0, v30
  v_sub_f32 v196, 0, v30
  v_sub_f32 v197, 0, v30
  v_sub_f32 v198, 0, v30
  v_sub_f32 v199, 0, v30
  v_sub_f32 v200, 0, v30
  v_sub_f32 v201, 0, v30
  v_sub_f32 v202, 0, v30
  v_sub_f32 v203, 0, v30
  v_sub_f32 v204, 0, v30
  v_sub_f32 v205, 0, v30
  v_sub_f32 v206, 0, v30
  v_sub_f32 v207, 0, v30
  v_sub_f32 v208, 0, v31
  v_sub_f32 v209, 0, v31
  v_sub_f32 v210, 0, v31
  v_sub_f32 v211, 0, v31
  v_sub_f32 v212, 0, v31
  v_sub_f32 v213, 0, v31
  v_sub_f32 v214, 0, v31
  v_sub_f32 v215, 0, v31
  v_sub_f32 v216, 0, v31
  v_sub_f32 v217, 0, v31
  v_sub_f32 v218, 0, v31
  v_sub_f32 v219, 0, v31
  v_sub_f32 v220, 0, v31
  v_sub_f32 v221, 0, v31
  v_sub_f32 v222, 0, v31
  v_sub_f32 v223, 0, v31
  v_sub_f32 v128, v128, v30
  v_sub_f32 v129, v129, v30
  v_sub_f32 v130, v130, v30
  v_sub_f32 v131, v131, v30
  v_sub_f32 v132, v132, v30
  v_sub_f32 v133, v133, v30
  v_sub_f32 v134, v134, v30
  v_sub_f32 v135, v135, v30
  v_sub_f32 v136, v136, v30
  v_sub_f32 v137, v137, v30
  v_sub_f32 v138, v138, v30
  v_sub_f32 v139, v139, v30
  v_sub_f32 v140, v140, v30
  v_sub_f32 v141, v141, v30
  v_sub_f32 v142, v142, v30
  v_sub_f32 v143, v143, v30
  v_sub_f32 v144, v144, v31
  v_sub_f32 v145, v145, v31
  v_sub_f32 v146, v146, v31
  v_sub_f32 v147, v147, v31
  v_sub_f32 v148, v148, v31
  v_sub_f32 v149, v149, v31
  v_sub_f32 v150, v150, v31
  v_sub_f32 v151, v151, v31
  v_sub_f32 v152, v152, v31
  v_sub_f32 v153, v153, v31
  v_sub_f32 v154, v154, v31
  v_sub_f32 v155, v155, v31
  v_sub_f32 v156, v156, v31
  v_sub_f32 v157, v157, v31
  v_sub_f32 v158, v158, v31
  v_sub_f32 v159, v159, v31
  s_waitcnt lgkmcnt(2)
  v_mfma_f32_32x32x16_bf16 v[160:175], a[192:195], a[128:131], v[192:207]
  ds_read_b128 a[208:211], v20 offset:16384
  s_cmp_lg_u32 s16, 0
  s_cbranch_scc1 L_mk2_ga_3
  s_mov_b32 s60, s88
  s_and_b32 s61, s89, 0xffff
  s_mov_b32 s62, 14680064
  s_mov_b32 s63, 0x00020000
  s_add_u32 s64, s69, 0
  buffer_load_dword v59, v58, s[60:63], s64 offen
L_mk2_ga_3:
  v_exp_f32 v128, v128
  v_mfma_f32_32x32x16_bf16 v[176:191], a[192:195], a[160:163], v[208:223]
  s_cmp_lg_u32 s16, 1
  s_cbranch_scc1 L_mk2_ga_4
  s_mov_b32 s60, s88
  s_and_b32 s61, s89, 0xffff
  s_mov_b32 s62, 14680064
  s_mov_b32 s63, 0x00020000
  s_add_u32 s64, s69, 1048576
  buffer_load_dword v59, v58, s[60:63], s64 offen
L_mk2_ga_4:
  v_exp_f32 v129, v129
  v_exp_f32 v130, v130
  v_cvt_pk_bf16_f32 v224, v128, v129
  v_mfma_f32_32x32x16_bf16 v[160:175], a[196:199], a[132:135], v[160:175]
  ds_read_b128 a[212:215], v21 offset:16384
  v_exp_f32 v131, v131
  v_exp_f32 v132, v132
  v_cvt_pk_bf16_f32 v225, v130, v131
  v_mfma_f32_32x32x16_bf16 v[176:191], a[196:199], a[164:167], v[176:191]
  v_exp_f32 v133, v133
  v_exp_f32 v134, v134
  v_cvt_pk_bf16_f32 v226, v132, v133
  v_add_f32 v28, v28, v128
  s_waitcnt lgkmcnt(2)
  v_mfma_f32_32x32x16_bf16 v[160:175], a[200:203], a[136:139], v[160:175]
  ds_read_b128 a[216:219], v22 offset:16384
  v_exp_f32 v135, v135
  v_exp_f32 v144, v144
  v_mfma_f32_32x32x16_bf16 v[176:191], a[200:203], a[168:171], v[176:191]
  v_cvt_pk_bf16_f32 v227, v134, v135
  v_exp_f32 v145, v145
  v_exp_f32 v146, v146
  v_cvt_pk_bf16_f32 v232, v144, v145
  v_mfma_f32_32x32x16_bf16 v[160:175], a[204:207], a[140:143], v[160:175]
  ds_read_b128 a[220:223], v23 offset:16384
  v_exp_f32 v147, v147
  v_exp_f32 v148, v148
  v_cvt_pk_bf16_f32 v233, v146, v147
  v_mfma_f32_32x32x16_bf16 v[176:191], a[204:207], a[172:175], v[176:191]
  v_exp_f32 v149, v149
  v_exp_f32 v150, v150
  v_cvt_pk_bf16_f32 v234, v148, v149
  v_add_f32 v28, v28, v129
  s_waitcnt lgkmcnt(2)
  v_mfma_f32_32x32x16_bf16 v[160:175], a[208:211], a[144:147], v[160:175]
  ds_read_b64_tr_b16 a[224:225], v24 offset:16384
  v_exp_f32 v151, v151
  v_exp_f32 v136, v136
  v_mfma_f32_32x32x16_bf16 v[176:191], a[208:211], a[176:179], v[176:191]
  ds_read_b64_tr_b16 a[226:227], v24 offset:18432
  v_cvt_pk_bf16_f32 v235, v150, v151
  v_exp_f32 v137, v137
  v_exp_f32 v138, v138
  v_mfma_f32_32x32x16_bf16 v[160:175], a[212:215], a[148:151], v[160:175]
  ds_read_b64_tr_b16 a[228:229], v25 offset:16384
  v_cvt_pk_bf16_f32 v228, v136, v137
  v_exp_f32 v139, v139
  v_exp_f32 v140, v140
  v_mfma_f32_32x32x16_bf16 v[176:191], a[212:215], a[180:183], v[176:191]
  ds_read_b64_tr_b16 a[230:231], v25 offset:18432
  v_cvt_pk_bf16_f32 v229, v138, v139
  v_exp_f32 v141, v141
  v_exp_f32 v142, v142
  s_waitcnt lgkmcnt(4)
  v_mfma_f32_32x32x16_bf16 v[160:175], a[216:219], a[152:155], v[160:175]
  ds_read_b64_tr_b16 a[232:233], v26 offset:16384
  v_cvt_pk_bf16_f32 v230, v140, v141
  v_exp_f32 v143, v143
  v_add_f32 v28, v28, v130
  v_mfma_f32_32x32x16_bf16 v[176:191], a[216:219], a[184:187], v[176:191]
  ds_read_b64_tr_b16 a[234:235], v26 offset:18432
  v_exp_f32 v152, v152
  v_cvt_pk_bf16_f32 v231, v142, v143
  v_exp_f32 v153, v153
  v_mfma_f32_32x32x16_bf16 v[160:175], a[220:223], a[156:159], v[160:175]
  ds_read_b64_tr_b16 a[236:237], v27 offset:16384
  v_exp_f32 v154, v154
  v_cvt_pk_bf16_f32 v236, v152, v153
  v_exp_f32 v155, v155
  v_mfma_f32_32x32x16_bf16 v[176:191], a[220:223], a[188:191], v[176:191]
  ds_read_b64_tr_b16 a[238:239], v27 offset:18432
  v_exp_f32 v156, v156
  v_cvt_pk_bf16_f32 v237, v154, v155
  v_exp_f32 v157, v157
  s_nop 0
  s_waitcnt vmcnt(20) lgkmcnt(4)
  v_mfma_f32_32x32x16_bf16 a[0:15], a[224:227], v[224:227], 0
  ds_read_b64_tr_b16 a[240:241], v24 offset:20480
  v_exp_f32 v158, v158
  v_cvt_pk_bf16_f32 v238, v156, v157
  v_add_f32 v28, v28, v131
  s_waitcnt vmcnt(16)
  v_mfma_f32_32x32x16_bf16 a[16:31], a[224:227], v[232:235], 0
  ds_read_b64_tr_b16 a[242:243], v24 offset:22528
  v_exp_f32 v159, v159
  v_add_f32 v28, v28, v132
  v_add_f32 v28, v28, v133
  v_add_f32 v28, v28, v134
  s_waitcnt vmcnt(8)
  v_mfma_f32_32x32x16_bf16 a[32:47], a[228:231], v[224:227], 0
  ds_read_b64_tr_b16 a[244:245], v25 offset:20480
  v_cvt_pk_bf16_f32 v239, v158, v159
  v_add_f32 v28, v28, v135
  v_add_f32 v29, v29, v144
  v_add_f32 v29, v29, v145
  v_add_f32 v29, v29, v146
  v_mfma_f32_32x32x16_bf16 a[48:63], a[228:231], v[232:235], 0
  ds_read_b64_tr_b16 a[246:247], v25 offset:22528
  v_add_f32 v29, v29, v147
  v_add_f32 v29, v29, v148
  v_add_f32 v29, v29, v149
  v_max3_f32 v30, v160, v161, v162
  v_add_f32 v29, v29, v150
  s_waitcnt lgkmcnt(4)
  v_mfma_f32_32x32x16_bf16 a[64:79], a[232:235], v[224:227], 0
  ds_read_b64_tr_b16 a[248:249], v26 offset:20480
  v_max3_f32 v31, v176, v177, v178
  v_add_f32 v29, v29, v151
  v_max3_f32 v30, v30, v163, v164
  v_add_f32 v28, v28, v136
  v_mfma_f32_32x32x16_bf16 a[80:95], a[232:235], v[232:235], 0
  ds_read_b64_tr_b16 a[250:251], v26 offset:22528
  v_max3_f32 v31, v31, v179, v180
  v_add_f32 v28, v28, v137
  v_max3_f32 v30, v30, v165, v166
  v_add_f32 v28, v28, v138
  v_max3_f32 v31, v31, v181, v182
  v_mfma_f32_32x32x16_bf16 a[96:111], a[236:239], v[224:227], 0
  ds_read_b64_tr_b16 a[252:253], v27 offset:20480
  v_add_f32 v28, v28, v139
  v_max3_f32 v30, v30, v167, v168
  v_add_f32 v28, v28, v140
  v_max3_f32 v31, v31, v183, v184
  v_add_f32 v28, v28, v141
  v_mfma_f32_32x32x16_bf16 a[112:127], a[236:239], v[232:235], 0
  ds_read_b64_tr_b16 a[254:255], v27 offset:22528
  v_max3_f32 v30, v30, v169, v170
  v_add_f32 v28, v28, v142
  v_max3_f32 v31, v31, v185, v186
  v_add_f32 v28, v28, v143
  v_max3_f32 v30, v30, v171, v172
  s_waitcnt lgkmcnt(4)
  v_mfma_f32_32x32x16_bf16 a[0:15], a[240:243], v[228:231], a[0:15]
  s_waitcnt vmcnt(4)
  s_barrier
  ds_read_b128 a[192:195], v16 offset:32768
  v_add_f32 v29, v29, v152
  v_max3_f32 v31, v31, v187, v188
  s_add_u32 m0, s19, 65536
  v_mfma_f32_32x32x16_bf16 a[16:31], a[240:243], v[236:239], a[16:31]
  v_add_f32 v29, v29, v153
  v_max3_f32 v30, v30, v173, v174
  v_add_f32 v29, v29, v154
  buffer_load_dwordx4 v12, s[28:31], s43 offen offset:0 lds
  v_mfma_f32_32x32x16_bf16 a[32:47], a[244:247], v[228:231], a[32:47]
  ds_read_b128 a[196:199], v17 offset:32768
  v_max3_f32 v31, v31, v189, v190
  v_add_f32 v29, v29, v155
  buffer_load_dwordx4 v13, s[28:31], s43 offen offset:1024 lds
  v_mfma_f32_32x32x16_bf16 a[48:63], a[244:247], v[236:239], a[48:63]
  v_max_f32 v30, v30, v175
  v_add_f32 v29, v29, v156
  v_max_f32 v31, v31, v191
  buffer_load_dwordx4 v14, s[28:31], s43 offen offset:2048 lds
  s_waitcnt lgkmcnt(2)
  v_mfma_f32_32x32x16_bf16 a[64:79], a[248:251], v[228:231], a[64:79]
  ds_read_b128 a[200:203], v18 offset:32768
  v_add_f32 v29, v29, v157
  buffer_load_dwordx4 v15, s[28:31], s43 offen offset:3072 lds
  s_add_u32 s43, s43, 8192
  v_mfma_f32_32x32x16_bf16 a[80:95], a[248:251], v[236:239], a[80:95]
  v_add_f32 v29, v29, v158
  v_add_f32 v29, v29, v159
  v_mfma_f32_32x32x16_bf16 a[96:111], a[252:255], v[228:231], a[96:111]
  ds_read_b128 a[204:207], v19 offset:32768
  v_mfma_f32_32x32x16_bf16 a[112:127], a[252:255], v[236:239], a[112:127]
  v_max_f32 v32, v30, v31
  v_cmp_lt_f32 vcc, s50, v32
  s_cbranch_vccz L_mk2_norescale_5
  s_call_b64 s[48:49], L_q_rescale1
L_mk2_norescale_5:
  s_waitcnt lgkmcnt(2)
  v_mfma_f32_32x32x16_bf16 v[128:143], a[192:195], a[128:131], v[192:207]
  ds_read_b128 a[208:211], v20 offset:32768
  s_cmp_lg_u32 s16, 2
  s_cbranch_scc1 L_mk2_ga_6
  s_mov_b32 s60, s88
  s_and_b32 s61, s89, 0xffff
  s_mov_b32 s62, 14680064
  s_mov_b32 s63, 0x00020000
  s_add_u32 s64, s69, 2097152
  buffer_load_dword v59, v58, s[60:63], s64 offen
L_mk2_ga_6:
  v_exp_f32 v160, v160
  v_mfma_f32_32x32x16_bf16 v[144:159], a[192:195], a[160:163], v[208:223]
  s_cmp_lg_u32 s16, 3
  s_cbranch_scc1 L_mk2_ga_7
  s_mov_b32 s60, s88
  s_and_b32 s61, s89, 0xffff
  s_mov_b32 s62, 14680064
  s_mov_b32 s63, 0x00020000
  s_add_u32 s64, s69, 3145728
  buffer_load_dword v59, v58, s[60:63], s64 offen
L_mk2_ga_7:
  v_exp_f32 v161, v161
  v_exp_f32 v162, v162
  v_cvt_pk_bf16_f32 v224, v160, v161
  v_mfma_f32_32x32x16_bf16 v[128:143], a[196:199], a[132:135], v[128:143]
  ds_read_b128 a[212:215], v21 offset:32768
  v_exp_f32 v163, v163
  v_exp_f32 v164, v164
  v_cvt_pk_bf16_f32 v225, v162, v163
  v_mfma_f32_32x32x16_bf16 v[144:159], a[196:199], a[164:167], v[144:159]
  v_exp_f32 v165, v165
  v_exp_f32 v166, v166
  v_cvt_pk_bf16_f32 v226, v164, v165
  v_add_f32 v28, v28, v160
  s_waitcnt lgkmcnt(2)
  v_mfma_f32_32x32x16_bf16 v[128:143], a[200:203], a[136:139], v[128:143]
  ds_read_b128 a[216:219], v22 offset:32768
  v_exp_f32 v167, v167
  v_exp_f32 v176, v176
  v_mfma_f32_32x32x16_bf16 v[144:159], a[200:203], a[168:171], v[144:159]
  v_cvt_pk_bf16_f32 v227, v166, v167
  v_exp_f32 v177, v177
  v_exp_f32 v178, v178
  v_cvt_pk_bf16_f32 v232, v176, v177
  v_mfma_f32_32x32x16_bf16 v[128:143], a[204:207], a[140:143], v[128:143]
  ds_read_b128 a[220:223], v23 offset:32768
  v_exp_f32 v179, v179
  v_exp_f32 v180, v180
  v_cvt_pk_bf16_f32 v233, v178, v179
  v_mfma_f32_32x32x16_bf16 v[144:159], a[204:207], a[172:175], v[144:159]
  v_exp_f32 v181, v181
  v_exp_f32 v182, v182
  v_cvt_pk_bf16_f32 v234, v180, v181
  v_add_f32 v28, v28, v161
  s_waitcnt lgkmcnt(2)
  v_mfma_f32_32x32x16_bf16 v[128:143], a[208:211], a[144:147], v[128:143]
  ds_read_b64_tr_b16 a[224:225], v24 offset:32768
  v_exp_f32 v183, v183
  v_exp_f32 v168, v168
  v_mfma_f32_32x32x16_bf16 v[144:159], a[208:211], a[176:179], v[144:159]
  ds_read_b64_tr_b16 a[226:227], v24 offset:34816
  v_cvt_pk_bf16_f32 v235, v182, v183
  v_exp_f32 v169, v169
  v_exp_f32 v170, v170
  v_mfma_f32_32x32x16_bf16 v[128:143], a[212:215], a[148:151], v[128:143]
  ds_read_b64_tr_b16 a[228:229], v25 offset:32768
  v_cvt_pk_bf16_f32 v228, v168, v169
  v_exp_f32 v171, v171
  v_exp_f32 v172, v172
  v_mfma_f32_32x32x16_bf16 v[144:159], a[212:215], a[180:183], v[144:159]
  ds_read_b64_tr_b16 a[230:231], v25 offset:34816
  v_cvt_pk_bf16_f32 v229, v170, v171
  v_exp_f32 v173, v173
  v_exp_f32 v174, v174
  s_waitcnt lgkmcnt(4)
  v_mfma_f32_32x32x16_bf16 v[128:143], a[216:219], a[152:155], v[128:143]
  ds_read_b64_tr_b16 a[232:233], v26 offset:32768
  v_cvt_pk_bf16_f32 v230, v172, v173
  v_exp_f32 v175, v175
  v_add_f32 v28, v28, v162
  v_mfma_f32_32x32x16_bf16 v[144:159], a[216:219], a[184:187], v[144:159]
  ds_read_b64_tr_b16 a[234:235], v26 offset:34816
  v_exp_f32 v184, v184
  v_cvt_pk_bf16_f32 v231, v174, v175
  v_exp_f32 v185, v185
  v_mfma_f32_32x32x16_bf16 v[128:143], a[220:223], a[156:159], v[128:143]
  ds_read_b64_tr_b16 a[236:237], v27 offset:32768
  v_exp_f32 v186, v186
  v_cvt_pk_bf16_f32 v236, v184, v185
  v_exp_f32 v187, v187
  v_mfma_f32_32x32x16_bf16 v[144:159], a[220:223], a[188:191], v[144:159]
  ds_read_b64_tr_b16 a[238:239], v27 offset:34816
  v_exp_f32 v188, v188
  v_cvt_pk_bf16_f32 v237, v186, v187
  v_exp_f32 v189, v189
  s_nop 0
  s_waitcnt lgkmcnt(4)
  v_mfma_f32_32x32x16_bf16 a[0:15], a[224:227], v[224:227], a[0:15]
  ds_read_b64_tr_b16 a[240:241], v24 offset:36864
  v_exp_f32 v190, v190
  v_cvt_pk_bf16_f32 v238, v188, v189
  v_add_f32 v28, v28, v163
  v_mfma_f32_32x32x16_bf16 a[16:31], a[224:227], v[232:235], a[16:31]
  ds_read_b64_tr_b16 a[242:243], v24 offset:38912
  v_exp_f32 v191, v191
  v_add_f32 v28, v28, v164
  v_add_f32 v28, v28, v165
  v_add_f32 v28, v28, v166
  v_mfma_f32_32x32x16_bf16 a[32:47], a[228:231], v[224:227], a[32:47]
  ds_read_b64_tr_b16 a[244:245], v25 offset:36864
  v_cvt_pk_bf16_f32 v239, v190, v191
  v_add_f32 v28, v28, v167
  v_add_f32 v29, v29, v176
  v_add_f32 v29, v29, v177
  v_add_f32 v29, v29, v178
  v_mfma_f32_32x32x16_bf16 a[48:63], a[228:231], v[232:235], a[48:63]
  ds_read_b64_tr_b16 a[246:247], v25 offset:38912
  v_add_f32 v29, v29, v179
  v_add_f32 v29, v29, v180
  v_add_f32 v29, v29, v181
  v_max3_f32 v30, v128, v129, v130
  v_add_f32 v29, v29, v182
  s_waitcnt lgkmcnt(4)
  v_mfma_f32_32x32x16_bf16 a[64:79], a[232:235], v[224:227], a[64:79]
  ds_read_b64_tr_b16 a[248:249], v26 offset:36864
  v_max3_f32 v31, v144, v145, v146
  v_add_f32 v29, v29, v183
  v_max3_f32 v30, v30, v131, v132
  v_add_f32 v28, v28, v168
  v_mfma_f32_32x32x16_bf16 a[80:95], a[232:235], v[232:235], a[80:95]
  ds_read_b64_tr_b16 a[250:251], v26 offset:38912
  v_max3_f32 v31, v31, v147, v148
  v_add_f32 v28, v28, v169
  v_max3_f32 v30, v30, v133, v134
  v_add_f32 v28, v28, v170
  v_max3_f32 v31, v31, v149, v150
  v_mfma_f32_32x32x16_bf16 a[96:111], a[236:239], v[224:227], a[96:111]
  ds_read_b64_tr_b16 a[252:253], v27 offset:36864
  v_add_f32 v28, v28, v171
  v_max3_f32 v30, v30, v135, v136
  v_add_f32 v28, v28, v172
  v_max3_f32 v31, v31, v151, v152
  v_add_f32 v28, v28, v173
  v_mfma_f32_32x32x16_bf16 a[112:127], a[236:239], v[232:235], a[112:127]
  ds_read_b64_tr_b16 a[254:255], v27 offset:38912
  v_max3_f32 v30, v30, v137, v138
  v_add_f32 v28, v28, v174
  v_max3_f32 v31, v31, v153, v154
  v_add_f32 v28, v28, v175
  v_max3_f32 v30, v30, v139, v140
  s_waitcnt lgkmcnt(4)
  v_mfma_f32_32x32x16_bf16 a[0:15], a[240:243], v[228:231], a[0:15]
  s_waitcnt vmcnt(4)
  s_barrier
  ds_read_b128 a[192:195], v16 offset:49152
  v_add_f32 v29, v29, v184
  v_max3_f32 v31, v31, v155, v156
  s_add_u32 m0, s19, 81920
  v_mfma_f32_32x32x16_bf16 a[16:31], a[240:243], v[236:239], a[16:31]
  v_add_f32 v29, v29, v185
  v_max3_f32 v30, v30, v141, v142
  v_add_f32 v29, v29, v186
  buffer_load_dwordx4 v12, s[28:31], s43 offen offset:0 lds
  v_mfma_f32_32x32x16_bf16 a[32:47], a[244:247], v[228:231], a[32:47]
  ds_read_b128 a[196:199], v17 offset:49152
  v_max3_f32 v31, v31, v157, v158
  v_add_f32 v29, v29, v187
  buffer_load_dwordx4 v13, s[28:31], s43 offen offset:1024 lds
  v_mfma_f32_32x32x16_bf16 a[48:63], a[244:247], v[236:239], a[48:63]
  v_max_f32 v30, v30, v143
  v_add_f32 v29, v29, v188
  v_max_f32 v31, v31, v159
  buffer_load_dwordx4 v14, s[28:31], s43 offen offset:2048 lds
  s_waitcnt lgkmcnt(2)
  v_mfma_f32_32x32x16_bf16 a[64:79], a[248:251], v[228:231], a[64:79]
  ds_read_b128 a[200:203], v18 offset:49152
  v_add_f32 v29, v29, v189
  buffer_load_dwordx4 v15, s[28:31], s43 offen offset:3072 lds
  s_add_u32 s43, s43, 8192
  v_mfma_f32_32x32x16_bf16 a[80:95], a[248:251], v[236:239], a[80:95]
  v_add_f32 v29, v29, v190
  v_add_f32 v29, v29, v191
  v_mfma_f32_32x32x16_bf16 a[96:111], a[252:255], v[228:231], a[96:111]
  ds_read_b128 a[204:207], v19 offset:49152
  v_mfma_f32_32x32x16_bf16 a[112:127], a[252:255], v[236:239], a[112:127]
  v_max_f32 v32, v30, v31
  v_cmp_lt_f32 vcc, s50, v32
  s_cbranch_vccz L_mk2_norescale_8
  s_call_b64 s[48:49], L_q_rescale0
L_mk2_norescale_8:
  s_waitcnt lgkmcnt(2)
  v_mfma_f32_32x32x16_bf16 v[160:175], a[192:195], a[128:131], v[192:207]
  ds_read_b128 a[208:211], v20 offset:49152
  s_cmp_lg_u32 s16, 0
  s_cbranch_scc1 L_mk2_ga_9
  s_mov_b32 s60, s88
  s_and_b32 s61, s89, 0xffff
  s_mov_b32 s62, 14680064
  s_mov_b32 s63, 0x00020000
  s_add_u32 s64, s69, 4194304
  buffer_load_dword v59, v58, s[60:63], s64 offen
L_mk2_ga_9:
  v_exp_f32 v128, v128
  v_mfma_f32_32x32x16_bf16 v[176:191], a[192:195], a[160:163], v[208:223]
  s_cmp_lg_u32 s16, 1
  s_cbranch_scc1 L_mk2_ga_10
  s_mov_b32 s60, s88
  s_and_b32 s61, s89, 0xffff
  s_mov_b32 s62, 14680064
  s_mov_b32 s63, 0x00020000
  s_add_u32 s64, s69, 5242880
  buffer_load_dword v59, v58, s[60:63], s64 offen
L_mk2_ga_10:
  v_exp_f32 v129, v129
  v_exp_f32 v130, v130
  v_cvt_pk_bf16_f32 v224, v128, v129
  v_mfma_f32_32x32x16_bf16 v[160:175], a[196:199], a[132:135], v[160:175]
  ds_read_b128 a[212:215], v21 offset:49152
  v_exp_f32 v131, v131
  v_exp_f32 v132, v132
  v_cvt_pk_bf16_f32 v225, v130, v131
  v_mfma_f32_32x32x16_bf16 v[176:191], a[196:199], a[164:167], v[176:191]
  v_exp_f32 v133, v133
  v_exp_f32 v134, v134
  v_cvt_pk_bf16_f32 v226, v132, v133
  v_add_f32 v28, v28, v128
  s_waitcnt lgkmcnt(2)
  v_mfma_f32_32x32x16_bf16 v[160:175], a[200:203], a[136:139], v[160:175]
  ds_read_b128 a[216:219], v22 offset:49152
  s_mov_b32 s60, s86
  s_and_b32 s61, s87, 0xffff
  v_exp_f32 v135, v135
  v_mfma_f32_32x32x16_bf16 v[176:191], a[200:203], a[168:171], v[176:191]
  v_exp_f32 v144, v144
  v_cvt_pk_bf16_f32 v227, v134, v135
  v_exp_f32 v145, v145
  v_add_f32 v28, v28, v129
  v_mfma_f32_32x32x16_bf16 v[160:175], a[204:207], a[140:143], v[160:175]
  ds_read_b128 a[220:223], v23 offset:49152
  s_mov_b32 s62, 7168
  s_mov_b32 s63, 0x00020000
  v_exp_f32 v146, v146
  v_cvt_pk_bf16_f32 v232, v144, v145
  v_mfma_f32_32x32x16_bf16 v[176:191], a[204:207], a[172:175], v[176:191]
  v_exp_f32 v147, v147
  v_exp_f32 v148, v148
  v_cvt_pk_bf16_f32 v233, v146, v147
  v_add_f32 v28, v28, v130
  s_waitcnt lgkmcnt(2)
  v_mfma_f32_32x32x16_bf16 v[160:175], a[208:211], a[144:147], v[160:175]
  ds_read_b64_tr_b16 a[224:225], v24 offset:49152
  v_exp_f32 v149, v149
  v_exp_f32 v150, v150
  v_mfma_f32_32x32x16_bf16 v[176:191], a[208:211], a[176:179], v[176:191]
  ds_read_b64_tr_b16 a[226:227], v24 offset:51200
  v_lshlrev_b32 v1, 3, v34
  s_lshl_b32 s23, s71, 1
  v_cvt_pk_bf16_f32 v234, v148, v149
  v_exp_f32 v151, v151
  v_mfma_f32_32x32x16_bf16 v[160:175], a[212:215], a[148:151], v[160:175]
  ds_read_b64_tr_b16 a[228:229], v25 offset:49152
  v_exp_f32 v136, v136
  v_cvt_pk_bf16_f32 v235, v150, v151
  v_exp_f32 v137, v137
  v_mfma_f32_32x32x16_bf16 v[176:191], a[212:215], a[180:183], v[176:191]
  ds_read_b64_tr_b16 a[230:231], v25 offset:51200
  buffer_load_dwordx2 v[112:113], v1, s[60:63], s23 offen offset:0
  buffer_load_dwordx2 v[114:115], v1, s[60:63], s23 offen offset:32
  s_waitcnt lgkmcnt(4)
  v_mfma_f32_32x32x16_bf16 v[160:175], a[216:219], a[152:155], v[160:175]
  ds_read_b64_tr_b16 a[232:233], v26 offset:49152
  v_exp_f32 v138, v138
  v_cvt_pk_bf16_f32 v228, v136, v137
  v_add_f32 v28, v28, v131
  v_mfma_f32_32x32x16_bf16 v[176:191], a[216:219], a[184:187], v[176:191]
  ds_read_b64_tr_b16 a[234:235], v26 offset:51200
  v_exp_f32 v139, v139
  v_exp_f32 v140, v140
  v_cvt_pk_bf16_f32 v229, v138, v139
  v_mfma_f32_32x32x16_bf16 v[160:175], a[220:223], a[156:159], v[160:175]
  ds_read_b64_tr_b16 a[236:237], v27 offset:49152
  buffer_load_dwordx2 v[116:117], v1, s[60:63], s23 offen offset:64
  buffer_load_dwordx2 v[118:119], v1, s[60:63], s23 offen offset:96
  v_mfma_f32_32x32x16_bf16 v[176:191], a[220:223], a[188:191], v[176:191]
  ds_read_b64_tr_b16 a[238:239], v27 offset:51200
  v_exp_f32 v141, v141
  v_exp_f32 v142, v142
  v_cvt_pk_bf16_f32 v230, v140, v141
  s_nop 0
  s_nop 0
  s_waitcnt lgkmcnt(4)
  v_mfma_f32_32x32x16_bf16 a[0:15], a[224:227], v[224:227], a[0:15]
  ds_read_b64_tr_b16 a[240:241], v24 offset:53248
  buffer_load_dwordx2 v[120:121], v1, s[60:63], s23 offen offset:128
  buffer_load_dwordx2 v[122:123], v1, s[60:63], s23 offen offset:160
  v_mfma_f32_32x32x16_bf16 a[16:31], a[224:227], v[232:235], a[16:31]
  ds_read_b64_tr_b16 a[242:243], v24 offset:55296
  v_exp_f32 v143, v143
  v_exp_f32 v152, v152
  v_cvt_pk_bf16_f32 v231, v142, v143
  v_mfma_f32_32x32x16_bf16 a[32:47], a[228:231], v[224:227], a[32:47]
  ds_read_b64_tr_b16 a[244:245], v25 offset:53248
  v_exp_f32 v153, v153
  v_exp_f32 v154, v154
  v_cvt_pk_bf16_f32 v236, v152, v153
  v_mfma_f32_32x32x16_bf16 a[48:63], a[228:231], v[232:235], a[48:63]
  ds_read_b64_tr_b16 a[246:247], v25 offset:55296
  buffer_load_dwordx2 v[124:125], v1, s[60:63], s23 offen offset:192
  buffer_load_dwordx2 v[126:127], v1, s[60:63], s23 offen offset:224
  s_waitcnt lgkmcnt(4)
  v_mfma_f32_32x32x16_bf16 a[64:79], a[232:235], v[224:227], a[64:79]
  ds_read_b64_tr_b16 a[248:249], v26 offset:53248
  v_exp_f32 v155, v155
  v_exp_f32 v156, v156
  v_mfma_f32_32x32x16_bf16 a[80:95], a[232:235], v[232:235], a[80:95]
  ds_read_b64_tr_b16 a[250:251], v26 offset:55296
  v_cvt_pk_bf16_f32 v237, v154, v155
  v_exp_f32 v157, v157
  v_exp_f32 v158, v158
  v_mfma_f32_32x32x16_bf16 a[96:111], a[236:239], v[224:227], a[96:111]
  ds_read_b64_tr_b16 a[252:253], v27 offset:53248
  v_cvt_pk_bf16_f32 v238, v156, v157
  v_exp_f32 v159, v159
  v_add_f32 v28, v28, v132
  v_add_f32 v28, v28, v133
  v_mfma_f32_32x32x16_bf16 a[112:127], a[236:239], v[232:235], a[112:127]
  ds_read_b64_tr_b16 a[254:255], v27 offset:55296
  v_cvt_pk_bf16_f32 v239, v158, v159
  v_add_f32 v28, v28, v134
  v_add_f32 v28, v28, v135
  v_add_f32 v29, v29, v144
  v_add_f32 v29, v29, v145
  s_waitcnt lgkmcnt(4)
  v_mfma_f32_32x32x16_bf16 a[0:15], a[240:243], v[228:231], a[0:15]
  s_waitcnt vmcnt(12)
  s_barrier
  ds_read_b128 a[192:195], v16 offset:0
  v_add_f32 v29, v29, v146
  v_add_f32 v29, v29, v147
  s_add_u32 m0, s19, 98304
  v_mfma_f32_32x32x16_bf16 a[16:31], a[240:243], v[236:239], a[16:31]
  v_add_f32 v29, v29, v148
  v_add_f32 v29, v29, v149
  v_max3_f32 v30, v160, v161, v162
  buffer_load_dwordx4 v12, s[28:31], s43 offen offset:0 lds
  v_mfma_f32_32x32x16_bf16 a[32:47], a[244:247], v[228:231], a[32:47]
  ds_read_b128 a[196:199], v17 offset:0
  v_add_f32 v29, v29, v150
  v_max3_f32 v31, v176, v177, v178
  buffer_load_dwordx4 v13, s[28:31], s43 offen offset:1024 lds
  v_mfma_f32_32x32x16_bf16 a[48:63], a[244:247], v[236:239], a[48:63]
  v_add_f32 v29, v29, v151
  v_max3_f32 v30, v30, v163, v164
  v_add_f32 v28, v28, v136
  buffer_load_dwordx4 v14, s[28:31], s43 offen offset:2048 lds
  s_waitcnt lgkmcnt(2)
  v_mfma_f32_32x32x16_bf16 a[64:79], a[248:251], v[228:231], a[64:79]
  ds_read_b128 a[200:203], v18 offset:0
  v_max3_f32 v31, v31, v179, v180
  buffer_load_dwordx4 v15, s[28:31], s43 offen offset:3072 lds
  s_add_u32 s43, s43, 8192
  v_mfma_f32_32x32x16_bf16 a[80:95], a[248:251], v[236:239], a[80:95]
  v_add_f32 v28, v28, v137
  v_max3_f32 v30, v30, v165, v166
  v_add_f32 v28, v28, v138
  v_max3_f32 v31, v31, v181, v182
  v_add_f32 v28, v28, v139
  v_max3_f32 v30, v30, v167, v168
  v_mfma_f32_32x32x16_bf16 a[96:111], a[252:255], v[228:231], a[96:111]
  ds_read_b128 a[204:207], v19 offset:0
  v_add_f32 v28, v28, v140
  v_max3_f32 v31, v31, v183, v184
  v_add_f32 v28, v28, v141
  v_max3_f32 v30, v30, v169, v170
  v_add_f32 v28, v28, v142
  v_mfma_f32_32x32x16_bf16 a[112:127], a[252:255], v[236:239], a[112:127]
  v_max3_f32 v31, v31, v185, v186
  v_add_f32 v28, v28, v143
  v_max3_f32 v30, v30, v171, v172
  v_add_f32 v29, v29, v152
  v_max3_f32 v31, v31, v187, v188
  v_add_f32 v29, v29, v153
  v_max3_f32 v30, v30, v173, v174
  v_add_f32 v29, v29, v154
  v_max3_f32 v31, v31, v189, v190
  v_add_f32 v29, v29, v155
  v_max_f32 v30, v30, v175
  v_add_f32 v29, v29, v156
  v_max_f32 v31, v31, v191
  v_add_f32 v29, v29, v157
  v_max_f32 v32, v30, v31
  v_add_f32 v29, v29, v158
  v_cmp_lt_f32 vcc, s50, v32
  v_add_f32 v29, v29, v159
  s_cbranch_vccz L_mk2_norescale_11
  s_call_b64 s[48:49], L_q_rescale1
L_mk2_norescale_11:
  s_waitcnt lgkmcnt(2)
  v_mfma_f32_32x32x16_bf16 v[128:143], a[192:195], a[128:131], v[192:207]
  ds_read_b128 a[208:211], v20 offset:0
  s_cmp_lg_u32 s16, 2
  s_cbranch_scc1 L_mk2_ga_12
  s_mov_b32 s60, s88
  s_and_b32 s61, s89, 0xffff
  s_mov_b32 s62, 14680064
  s_mov_b32 s63, 0x00020000
  s_add_u32 s64, s69, 6291456
  buffer_load_dword v59, v58, s[60:63], s64 offen
L_mk2_ga_12:
  v_exp_f32 v160, v160
  v_mfma_f32_32x32x16_bf16 v[144:159], a[192:195], a[160:163], v[208:223]
  s_cmp_lg_u32 s16, 3
  s_cbranch_scc1 L_mk2_ga_13
  s_mov_b32 s60, s88
  s_and_b32 s61, s89, 0xffff
  s_mov_b32 s62, 14680064
  s_mov_b32 s63, 0x00020000
  s_add_u32 s64, s69, 7340032
  buffer_load_dword v59, v58, s[60:63], s64 offen
L_mk2_ga_13:
  v_exp_f32 v161, v161
  v_exp_f32 v162, v162
  v_cvt_pk_bf16_f32 v224, v160, v161
  v_mfma_f32_32x32x16_bf16 v[128:143], a[196:199], a[132:135], v[128:143]
  ds_read_b128 a[212:215], v21 offset:0
  v_exp_f32 v163, v163
  v_exp_f32 v164, v164
  v_cvt_pk_bf16_f32 v225, v162, v163
  v_mfma_f32_32x32x16_bf16 v[144:159], a[196:199], a[164:167], v[144:159]
  v_exp_f32 v165, v165
  v_exp_f32 v166, v166
  v_cvt_pk_bf16_f32 v226, v164, v165
  v_add_f32 v28, v28, v160
  s_waitcnt lgkmcnt(2)
  v_mfma_f32_32x32x16_bf16 v[128:143], a[200:203], a[136:139], v[128:143]
  ds_read_b128 a[216:219], v22 offset:0
  v_exp_f32 v167, v167
  v_exp_f32 v176, v176
  v_mfma_f32_32x32x16_bf16 v[144:159], a[200:203], a[168:171], v[144:159]
  v_cvt_pk_bf16_f32 v227, v166, v167
  v_exp_f32 v177, v177
  v_exp_f32 v178, v178
  v_cvt_pk_bf16_f32 v232, v176, v177
  v_mfma_f32_32x32x16_bf16 v[128:143], a[204:207], a[140:143], v[128:143]
  ds_read_b128 a[220:223], v23 offset:0
  v_exp_f32 v179, v179
  v_exp_f32 v180, v180
  v_cvt_pk_bf16_f32 v233, v178, v179
  v_mfma_f32_32x32x16_bf16 v[144:159], a[204:207], a[172:175], v[144:159]
  v_exp_f32 v181, v181
  v_exp_f32 v182, v182
  v_cvt_pk_bf16_f32 v234, v180, v181
  v_add_f32 v28, v28, v161
  s_waitcnt lgkmcnt(2)
  v_mfma_f32_32x32x16_bf16 v[128:143], a[208:211], a[144:147], v[128:143]
  ds_read_b64_tr_b16 a[224:225], v24 offset:0
  v_exp_f32 v183, v183
  v_exp_f32 v168, v168
  v_mfma_f32_32x32x16_bf16 v[144:159], a[208:211], a[176:179], v[144:159]
  ds_read_b64_tr_b16 a[226:227], v24 offset:2048
  v_cvt_pk_bf16_f32 v235, v182, v183
  v_exp_f32 v169, v169
  v_exp_f32 v170, v170
  v_mfma_f32_32x32x16_bf16 v[128:143], a[212:215], a[148:151], v[128:143]
  ds_read_b64_tr_b16 a[228:229], v25 offset:0
  v_cvt_pk_bf16_f32 v228, v168, v169
  v_exp_f32 v171, v171
  v_exp_f32 v172, v172
  v_mfma_f32_32x32x16_bf16 v[144:159], a[212:215], a[180:183], v[144:159]
  ds_read_b64_tr_b16 a[230:231], v25 offset:2048
  v_cvt_pk_bf16_f32 v229, v170, v171
  v_exp_f32 v173, v173
  v_exp_f32 v174, v174
  s_waitcnt lgkmcnt(4)
  v_mfma_f32_32x32x16_bf16 v[128:143], a[216:219], a[152:155], v[128:143]
  ds_read_b64_tr_b16 a[232:233], v26 offset:0
  v_cvt_pk_bf16_f32 v230, v172, v173
  v_exp_f32 v175, v175
  v_add_f32 v28, v28, v162
  v_mfma_f32_32x32x16_bf16 v[144:159], a[216:219], a[184:187], v[144:159]
  ds_read_b64_tr_b16 a[234:235], v26 offset:2048
  v_exp_f32 v184, v184
  v_cvt_pk_bf16_f32 v231, v174, v175
  v_exp_f32 v185, v185
  v_mfma_f32_32x32x16_bf16 v[128:143], a[220:223], a[156:159], v[128:143]
  ds_read_b64_tr_b16 a[236:237], v27 offset:0
  v_exp_f32 v186, v186
  v_cvt_pk_bf16_f32 v236, v184, v185
  v_exp_f32 v187, v187
  v_mfma_f32_32x32x16_bf16 v[144:159], a[220:223], a[188:191], v[144:159]
  ds_read_b64_tr_b16 a[238:239], v27 offset:2048
  v_exp_f32 v188, v188
  v_cvt_pk_bf16_f32 v237, v186, v187
  v_exp_f32 v189, v189
  s_nop 0
  s_waitcnt lgkmcnt(4)
  v_mfma_f32_32x32x16_bf16 a[0:15], a[224:227], v[224:227], a[0:15]
  ds_read_b64_tr_b16 a[240:241], v24 offset:4096
  v_exp_f32 v190, v190
  v_cvt_pk_bf16_f32 v238, v188, v189
  v_add_f32 v28, v28, v163
  v_mfma_f32_32x32x16_bf16 a[16:31], a[224:227], v[232:235], a[16:31]
  ds_read_b64_tr_b16 a[242:243], v24 offset:6144
  v_exp_f32 v191, v191
  v_add_f32 v28, v28, v164
  v_add_f32 v28, v28, v165
  v_add_f32 v28, v28, v166
  v_mfma_f32_32x32x16_bf16 a[32:47], a[228:231], v[224:227], a[32:47]
  ds_read_b64_tr_b16 a[244:245], v25 offset:4096
  v_cvt_pk_bf16_f32 v239, v190, v191
  v_add_f32 v28, v28, v167
  v_add_f32 v29, v29, v176
  v_add_f32 v29, v29, v177
  v_add_f32 v29, v29, v178
  v_mfma_f32_32x32x16_bf16 a[48:63], a[228:231], v[232:235], a[48:63]
  ds_read_b64_tr_b16 a[246:247], v25 offset:6144
  v_add_f32 v29, v29, v179
  v_add_f32 v29, v29, v180
  v_add_f32 v29, v29, v181
  v_max3_f32 v30, v128, v129, v130
  v_add_f32 v29, v29, v182
  s_waitcnt lgkmcnt(4)
  v_mfma_f32_32x32x16_bf16 a[64:79], a[232:235], v[224:227], a[64:79]
  ds_read_b64_tr_b16 a[248:249], v26 offset:4096
  v_max3_f32 v31, v144, v145, v146
  v_add_f32 v29, v29, v183
  v_max3_f32 v30, v30, v131, v132
  v_add_f32 v28, v28, v168
  v_mfma_f32_32x32x16_bf16 a[80:95], a[232:235], v[232:235], a[80:95]
  ds_read_b64_tr_b16 a[250:251], v26 offset:6144
  v_max3_f32 v31, v31, v147, v148
  v_add_f32 v28, v28, v169
  v_max3_f32 v30, v30, v133, v134
  v_add_f32 v28, v28, v170
  v_max3_f32 v31, v31, v149, v150
  v_mfma_f32_32x32x16_bf16 a[96:111], a[236:239], v[224:227], a[96:111]
  ds_read_b64_tr_b16 a[252:253], v27 offset:4096
  v_add_f32 v28, v28, v171
  v_max3_f32 v30, v30, v135, v136
  v_add_f32 v28, v28, v172
  v_max3_f32 v31, v31, v151, v152
  v_add_f32 v28, v28, v173
  v_mfma_f32_32x32x16_bf16 a[112:127], a[236:239], v[232:235], a[112:127]
  ds_read_b64_tr_b16 a[254:255], v27 offset:6144
  v_max3_f32 v30, v30, v137, v138
  v_add_f32 v28, v28, v174
  v_max3_f32 v31, v31, v153, v154
  v_add_f32 v28, v28, v175
  v_max3_f32 v30, v30, v139, v140
  s_waitcnt lgkmcnt(4)
  v_mfma_f32_32x32x16_bf16 a[0:15], a[240:243], v[228:231], a[0:15]
  s_waitcnt vmcnt(12)
  s_barrier
  ds_read_b128 a[192:195], v16 offset:16384
  v_add_f32 v29, v29, v184
  v_max3_f32 v31, v31, v155, v156
  s_add_u32 m0, s19, 114688
  v_mfma_f32_32x32x16_bf16 a[16:31], a[240:243], v[236:239], a[16:31]
  v_add_f32 v29, v29, v185
  v_max3_f32 v30, v30, v141, v142
  v_add_f32 v29, v29, v186
  buffer_load_dwordx4 v12, s[28:31], s43 offen offset:0 lds
  v_mfma_f32_32x32x16_bf16 a[32:47], a[244:247], v[228:231], a[32:47]
  ds_read_b128 a[196:199], v17 offset:16384
  v_max3_f32 v31, v31, v157, v158
  v_add_f32 v29, v29, v187
  buffer_load_dwordx4 v13, s[28:31], s43 offen offset:1024 lds
  v_mfma_f32_32x32x16_bf16 a[48:63], a[244:247], v[236:239], a[48:63]
  v_max_f32 v30, v30, v143
  v_add_f32 v29, v29, v188
  v_max_f32 v31, v31, v159
  buffer_load_dwordx4 v14, s[28:31], s43 offen offset:2048 lds
  s_waitcnt lgkmcnt(2)
  v_mfma_f32_32x32x16_bf16 a[64:79], a[248:251], v[228:231], a[64:79]
  ds_read_b128 a[200:203], v18 offset:16384
  v_add_f32 v29, v29, v189
  buffer_load_dwordx4 v15, s[28:31], s43 offen offset:3072 lds
  s_add_u32 s43, s43, 8192
  v_mfma_f32_32x32x16_bf16 a[80:95], a[248:251], v[236:239], a[80:95]
  v_add_f32 v29, v29, v190
  v_add_f32 v29, v29, v191
  v_mfma_f32_32x32x16_bf16 a[96:111], a[252:255], v[228:231], a[96:111]
  ds_read_b128 a[204:207], v19 offset:16384
  v_mfma_f32_32x32x16_bf16 a[112:127], a[252:255], v[236:239], a[112:127]
  v_max_f32 v32, v30, v31
  v_cmp_lt_f32 vcc, s50, v32
  s_cbranch_vccz L_mk2_norescale_14
  s_call_b64 s[48:49], L_q_rescale0
L_mk2_norescale_14:
  s_waitcnt lgkmcnt(2)
  v_mfma_f32_32x32x16_bf16 v[160:175], a[192:195], a[128:131], v[192:207]
  ds_read_b128 a[208:211], v20 offset:16384
  s_cmp_lg_u32 s16, 0
  s_cbranch_scc1 L_mk2_ga_15
  s_mov_b32 s60, s88
  s_and_b32 s61, s89, 0xffff
  s_mov_b32 s62, 14680064
  s_mov_b32 s63, 0x00020000
  s_add_u32 s64, s69, 8388608
  buffer_load_dword v59, v58, s[60:63], s64 offen
L_mk2_ga_15:
  v_exp_f32 v128, v128
  v_mfma_f32_32x32x16_bf16 v[176:191], a[192:195], a[160:163], v[208:223]
  s_cmp_lg_u32 s16, 1
  s_cbranch_scc1 L_mk2_ga_16
  s_mov_b32 s60, s88
  s_and_b32 s61, s89, 0xffff
  s_mov_b32 s62, 14680064
  s_mov_b32 s63, 0x00020000
  s_add_u32 s64, s69, 9437184
  buffer_load_dword v59, v58, s[60:63], s64 offen
L_mk2_ga_16:
  v_exp_f32 v129, v129
  v_exp_f32 v130, v130
  v_cvt_pk_bf16_f32 v224, v128, v129
  v_mfma_f32_32x32x16_bf16 v[160:175], a[196:199], a[132:135], v[160:175]
  ds_read_b128 a[212:215], v21 offset:16384
  v_exp_f32 v131, v131
  v_exp_f32 v132, v132
  v_cvt_pk_bf16_f32 v225, v130, v131
  v_mfma_f32_32x32x16_bf16 v[176:191], a[196:199], a[164:167], v[176:191]
  v_exp_f32 v133, v133
  v_exp_f32 v134, v134
  v_cvt_pk_bf16_f32 v226, v132, v133
  v_add_f32 v28, v28, v128
  s_waitcnt lgkmcnt(2)
  v_mfma_f32_32x32x16_bf16 v[160:175], a[200:203], a[136:139], v[160:175]
  ds_read_b128 a[216:219], v22 offset:16384
  v_exp_f32 v135, v135
  v_exp_f32 v144, v144
  v_mfma_f32_32x32x16_bf16 v[176:191], a[200:203], a[168:171], v[176:191]
  v_cvt_pk_bf16_f32 v227, v134, v135
  v_exp_f32 v145, v145
  v_exp_f32 v146, v146
  v_cvt_pk_bf16_f32 v232, v144, v145
  v_mfma_f32_32x32x16_bf16 v[160:175], a[204:207], a[140:143], v[160:175]
  ds_read_b128 a[220:223], v23 offset:16384
  v_exp_f32 v147, v147
  v_exp_f32 v148, v148
  v_cvt_pk_bf16_f32 v233, v146, v147
  v_mfma_f32_32x32x16_bf16 v[176:191], a[204:207], a[172:175], v[176:191]
  v_exp_f32 v149, v149
  v_exp_f32 v150, v150
  v_cvt_pk_bf16_f32 v234, v148, v149
  v_add_f32 v28, v28, v129
  s_waitcnt lgkmcnt(2)
  v_mfma_f32_32x32x16_bf16 v[160:175], a[208:211], a[144:147], v[160:175]
  ds_read_b64_tr_b16 a[224:225], v24 offset:16384
  v_exp_f32 v151, v151
  v_exp_f32 v136, v136
  v_mfma_f32_32x32x16_bf16 v[176:191], a[208:211], a[176:179], v[176:191]
  ds_read_b64_tr_b16 a[226:227], v24 offset:18432
  v_cvt_pk_bf16_f32 v235, v150, v151
  v_exp_f32 v137, v137
  v_exp_f32 v138, v138
  v_mfma_f32_32x32x16_bf16 v[160:175], a[212:215], a[148:151], v[160:175]
  ds_read_b64_tr_b16 a[228:229], v25 offset:16384
  v_cvt_pk_bf16_f32 v228, v136, v137
  v_exp_f32 v139, v139
  v_exp_f32 v140, v140
  v_mfma_f32_32x32x16_bf16 v[176:191], a[212:215], a[180:183], v[176:191]
  ds_read_b64_tr_b16 a[230:231], v25 offset:18432
  v_cvt_pk_bf16_f32 v229, v138, v139
  v_exp_f32 v141, v141
  v_exp_f32 v142, v142
  s_waitcnt lgkmcnt(4)
  v_mfma_f32_32x32x16_bf16 v[160:175], a[216:219], a[152:155], v[160:175]
  ds_read_b64_tr_b16 a[232:233], v26 offset:16384
  v_cvt_pk_bf16_f32 v230, v140, v141
  v_exp_f32 v143, v143
  v_add_f32 v28, v28, v130
  v_mfma_f32_32x32x16_bf16 v[176:191], a[216:219], a[184:187], v[176:191]
  ds_read_b64_tr_b16 a[234:235], v26 offset:18432
  v_exp_f32 v152, v152
  v_cvt_pk_bf16_f32 v231, v142, v143
  v_exp_f32 v153, v153
  v_mfma_f32_32x32x16_bf16 v[160:175], a[220:223], a[156:159], v[160:175]
  ds_read_b64_tr_b16 a[236:237], v27 offset:16384
  v_exp_f32 v154, v154
  v_cvt_pk_bf16_f32 v236, v152, v153
  v_exp_f32 v155, v155
  v_mfma_f32_32x32x16_bf16 v[176:191], a[220:223], a[188:191], v[176:191]
  ds_read_b64_tr_b16 a[238:239], v27 offset:18432
  v_exp_f32 v156, v156
  v_cvt_pk_bf16_f32 v237, v154, v155
  v_exp_f32 v157, v157
  s_nop 0
  s_waitcnt lgkmcnt(4)
  v_mfma_f32_32x32x16_bf16 a[0:15], a[224:227], v[224:227], a[0:15]
  ds_read_b64_tr_b16 a[240:241], v24 offset:20480
  v_exp_f32 v158, v158
  v_cvt_pk_bf16_f32 v238, v156, v157
  v_add_f32 v28, v28, v131
  v_mfma_f32_32x32x16_bf16 a[16:31], a[224:227], v[232:235], a[16:31]
  ds_read_b64_tr_b16 a[242:243], v24 offset:22528
  v_exp_f32 v159, v159
  v_add_f32 v28, v28, v132
  v_add_f32 v28, v28, v133
  v_add_f32 v28, v28, v134
  v_mfma_f32_32x32x16_bf16 a[32:47], a[228:231], v[224:227], a[32:47]
  ds_read_b64_tr_b16 a[244:245], v25 offset:20480
  v_cvt_pk_bf16_f32 v239, v158, v159
  v_add_f32 v28, v28, v135
  v_add_f32 v29, v29, v144
  v_add_f32 v29, v29, v145
  v_add_f32 v29, v29, v146
  v_mfma_f32_32x32x16_bf16 a[48:63], a[228:231], v[232:235], a[48:63]
  ds_read_b64_tr_b16 a[246:247], v25 offset:22528
  v_add_f32 v29, v29, v147
  v_add_f32 v29, v29, v148
  v_add_f32 v29, v29, v149
  v_max3_f32 v30, v160, v161, v162
  v_add_f32 v29, v29, v150
  s_waitcnt lgkmcnt(4)
  v_mfma_f32_32x32x16_bf16 a[64:79], a[232:235], v[224:227], a[64:79]
  ds_read_b64_tr_b16 a[248:249], v26 offset:20480
  v_max3_f32 v31, v176, v177, v178
  v_add_f32 v29, v29, v151
  v_max3_f32 v30, v30, v163, v164
  v_add_f32 v28, v28, v136
  v_mfma_f32_32x32x16_bf16 a[80:95], a[232:235], v[232:235], a[80:95]
  ds_read_b64_tr_b16 a[250:251], v26 offset:22528
  v_max3_f32 v31, v31, v179, v180
  v_add_f32 v28, v28, v137
  v_max3_f32 v30, v30, v165, v166
  v_add_f32 v28, v28, v138
  v_max3_f32 v31, v31, v181, v182
  v_mfma_f32_32x32x16_bf16 a[96:111], a[236:239], v[224:227], a[96:111]
  ds_read_b64_tr_b16 a[252:253], v27 offset:20480
  v_add_f32 v28, v28, v139
  v_max3_f32 v30, v30, v167, v168
  v_add_f32 v28, v28, v140
  v_max3_f32 v31, v31, v183, v184
  v_add_f32 v28, v28, v141
  v_mfma_f32_32x32x16_bf16 a[112:127], a[236:239], v[232:235], a[112:127]
  ds_read_b64_tr_b16 a[254:255], v27 offset:22528
  v_max3_f32 v30, v30, v169, v170
  v_add_f32 v28, v28, v142
  v_max3_f32 v31, v31, v185, v186
  v_add_f32 v28, v28, v143
  v_max3_f32 v30, v30, v171, v172
  s_waitcnt lgkmcnt(4)
  v_mfma_f32_32x32x16_bf16 a[0:15], a[240:243], v[228:231], a[0:15]
  s_waitcnt vmcnt(4)
  s_barrier
  ds_read_b128 a[192:195], v16 offset:32768
  v_add_f32 v29, v29, v152
  v_max3_f32 v31, v31, v187, v188
  s_add_u32 m0, s19, 65536
  v_mfma_f32_32x32x16_bf16 a[16:31], a[240:243], v[236:239], a[16:31]
  v_add_f32 v29, v29, v153
  v_max3_f32 v30, v30, v173, v174
  v_add_f32 v29, v29, v154
  buffer_load_dwordx4 v12, s[28:31], s43 offen offset:0 lds
  v_mfma_f32_32x32x16_bf16 a[32:47], a[244:247], v[228:231], a[32:47]
  ds_read_b128 a[196:199], v17 offset:32768
  v_max3_f32 v31, v31, v189, v190
  v_add_f32 v29, v29, v155
  buffer_load_dwordx4 v13, s[28:31], s43 offen offset:1024 lds
  v_mfma_f32_32x32x16_bf16 a[48:63], a[244:247], v[236:239], a[48:63]
  v_max_f32 v30, v30, v175
  v_add_f32 v29, v29, v156
  v_max_f32 v31, v31, v191
  buffer_load_dwordx4 v14, s[28:31], s43 offen offset:2048 lds
  s_waitcnt lgkmcnt(2)
  v_mfma_f32_32x32x16_bf16 a[64:79], a[248:251], v[228:231], a[64:79]
  ds_read_b128 a[200:203], v18 offset:32768
  v_add_f32 v29, v29, v157
  buffer_load_dwordx4 v15, s[28:31], s43 offen offset:3072 lds
  s_add_u32 s43, s43, 8192
  v_mfma_f32_32x32x16_bf16 a[80:95], a[248:251], v[236:239], a[80:95]
  v_add_f32 v29, v29, v158
  v_add_f32 v29, v29, v159
  v_mfma_f32_32x32x16_bf16 a[96:111], a[252:255], v[228:231], a[96:111]
  ds_read_b128 a[204:207], v19 offset:32768
  v_mfma_f32_32x32x16_bf16 a[112:127], a[252:255], v[236:239], a[112:127]
  v_max_f32 v32, v30, v31
  v_cmp_lt_f32 vcc, s50, v32
  s_cbranch_vccz L_mk2_norescale_17
  s_call_b64 s[48:49], L_q_rescale1
L_mk2_norescale_17:
  s_waitcnt lgkmcnt(2)
  v_mfma_f32_32x32x16_bf16 v[128:143], a[192:195], a[128:131], v[192:207]
  ds_read_b128 a[208:211], v20 offset:32768
  s_cmp_lg_u32 s16, 2
  s_cbranch_scc1 L_mk2_ga_18
  s_mov_b32 s60, s88
  s_and_b32 s61, s89, 0xffff
  s_mov_b32 s62, 14680064
  s_mov_b32 s63, 0x00020000
  s_add_u32 s64, s69, 10485760
  buffer_load_dword v59, v58, s[60:63], s64 offen
L_mk2_ga_18:
  v_exp_f32 v160, v160
  v_mfma_f32_32x32x16_bf16 v[144:159], a[192:195], a[160:163], v[208:223]
  s_cmp_lg_u32 s16, 3
  s_cbranch_scc1 L_mk2_ga_19
  s_mov_b32 s60, s88
  s_and_b32 s61, s89, 0xffff
  s_mov_b32 s62, 14680064
  s_mov_b32 s63, 0x00020000
  s_add_u32 s64, s69, 11534336
  buffer_load_dword v59, v58, s[60:63], s64 offen
L_mk2_ga_19:
  v_exp_f32 v161, v161
  v_exp_f32 v162, v162
  v_cvt_pk_bf16_f32 v224, v160, v161
  v_mfma_f32_32x32x16_bf16 v[128:143], a[196:199], a[132:135], v[128:143]
  ds_read_b128 a[212:215], v21 offset:32768
  v_exp_f32 v163, v163
  v_exp_f32 v164, v164
  v_cvt_pk_bf16_f32 v225, v162, v163
  v_mfma_f32_32x32x16_bf16 v[144:159], a[196:199], a[164:167], v[144:159]
  v_exp_f32 v165, v165
  v_exp_f32 v166, v166
  v_cvt_pk_bf16_f32 v226, v164, v165
  v_add_f32 v28, v28, v160
  s_waitcnt lgkmcnt(2)
  v_mfma_f32_32x32x16_bf16 v[128:143], a[200:203], a[136:139], v[128:143]
  ds_read_b128 a[216:219], v22 offset:32768
  v_lshlrev_b32 v64, 16, v112
  v_and_b32 v65, 0xffff0000, v112
  v_exp_f32 v167, v167
  v_mfma_f32_32x32x16_bf16 v[144:159], a[200:203], a[168:171], v[144:159]
  v_lshlrev_b32 v66, 16, v113
  v_exp_f32 v176, v176
  v_cvt_pk_bf16_f32 v227, v166, v167
  v_exp_f32 v177, v177
  v_mfma_f32_32x32x16_bf16 v[128:143], a[204:207], a[140:143], v[128:143]
  ds_read_b128 a[220:223], v23 offset:32768
  v_and_b32 v67, 0xffff0000, v113
  v_exp_f32 v178, v178
  v_cvt_pk_bf16_f32 v232, v176, v177
  v_add_f32 v28, v28, v161
  v_mfma_f32_32x32x16_bf16 v[144:159], a[204:207], a[172:175], v[144:159]
  v_lshlrev_b32 v72, 16, v112
  v_exp_f32 v179, v179
  v_exp_f32 v180, v180
  v_cvt_pk_bf16_f32 v233, v178, v179
  s_waitcnt lgkmcnt(2)
  v_mfma_f32_32x32x16_bf16 v[128:143], a[208:211], a[144:147], v[128:143]
  ds_read_b64_tr_b16 a[224:225], v24 offset:32768
  v_and_b32 v73, 0xffff0000, v112
  v_lshlrev_b32 v74, 16, v113
  v_exp_f32 v181, v181
  v_mfma_f32_32x32x16_bf16 v[144:159], a[208:211], a[176:179], v[144:159]
  ds_read_b64_tr_b16 a[226:227], v24 offset:34816
  v_and_b32 v75, 0xffff0000, v113
  v_exp_f32 v182, v182
  v_cvt_pk_bf16_f32 v234, v180, v181
  v_add_f32 v28, v28, v162
  v_mfma_f32_32x32x16_bf16 v[128:143], a[212:215], a[148:151], v[128:143]
  ds_read_b64_tr_b16 a[228:229], v25 offset:32768
  v_lshlrev_b32 v68, 16, v114
  v_exp_f32 v183, v183
  v_exp_f32 v168, v168
  v_mfma_f32_32x32x16_bf16 v[144:159], a[212:215], a[180:183], v[144:159]
  ds_read_b64_tr_b16 a[230:231], v25 offset:34816
  v_and_b32 v69, 0xffff0000, v114
  v_cvt_pk_bf16_f32 v235, v182, v183
  v_exp_f32 v169, v169
  v_add_f32 v28, v28, v163
  s_waitcnt lgkmcnt(4)
  v_mfma_f32_32x32x16_bf16 v[128:143], a[216:219], a[152:155], v[128:143]
  ds_read_b64_tr_b16 a[232:233], v26 offset:32768
  v_lshlrev_b32 v70, 16, v115
  v_exp_f32 v170, v170
  v_cvt_pk_bf16_f32 v228, v168, v169
  v_mfma_f32_32x32x16_bf16 v[144:159], a[216:219], a[184:187], v[144:159]
  ds_read_b64_tr_b16 a[234:235], v26 offset:34816
  v_and_b32 v71, 0xffff0000, v115
  v_lshlrev_b32 v76, 16, v114
  v_exp_f32 v171, v171
  v_add_f32 v28, v28, v164
  v_mfma_f32_32x32x16_bf16 v[128:143], a[220:223], a[156:159], v[128:143]
  ds_read_b64_tr_b16 a[236:237], v27 offset:32768
  v_and_b32 v77, 0xffff0000, v114
  v_exp_f32 v172, v172
  v_cvt_pk_bf16_f32 v229, v170, v171
  v_add_f32 v28, v28, v165
  v_mfma_f32_32x32x16_bf16 v[144:159], a[220:223], a[188:191], v[144:159]
  ds_read_b64_tr_b16 a[238:239], v27 offset:34816
  v_lshlrev_b32 v78, 16, v115
  v_exp_f32 v173, v173
  v_exp_f32 v174, v174
  s_waitcnt lgkmcnt(4)
  v_mfma_f32_32x32x16_bf16 a[0:15], a[224:227], v[224:227], a[0:15]
  ds_read_b64_tr_b16 a[240:241], v24 offset:36864
  v_and_b32 v79, 0xffff0000, v115
  v_cvt_pk_bf16_f32 v230, v172, v173
  v_exp_f32 v175, v175
  v_mfma_f32_32x32x16_bf16 a[16:31], a[224:227], v[232:235], a[16:31]
  ds_read_b64_tr_b16 a[242:243], v24 offset:38912
  v_lshlrev_b32 v80, 16, v116
  v_and_b32 v81, 0xffff0000, v116
  v_exp_f32 v184, v184
  v_cvt_pk_bf16_f32 v231, v174, v175
  v_mfma_f32_32x32x16_bf16 a[32:47], a[228:231], v[224:227], a[32:47]
  ds_read_b64_tr_b16 a[244:245], v25 offset:36864
  v_lshlrev_b32 v82, 16, v117
  v_exp_f32 v185, v185
  v_exp_f32 v186, v186
  v_mfma_f32_32x32x16_bf16 a[48:63], a[228:231], v[232:235], a[48:63]
  ds_read_b64_tr_b16 a[246:247], v25 offset:38912
  v_and_b32 v83, 0xffff0000, v117
  v_cvt_pk_bf16_f32 v236, v184, v185
  v_exp_f32 v187, v187
  v_max3_f32 v30, v128, v129, v130
  s_waitcnt lgkmcnt(4)
  v_mfma_f32_32x32x16_bf16 a[64:79], a[232:235], v[224:227], a[64:79]
  ds_read_b64_tr_b16 a[248:249], v26 offset:36864
  v_lshlrev_b32 v88, 16, v116
  v_exp_f32 v188, v188
  v_cvt_pk_bf16_f32 v237, v186, v187
  v_mfma_f32_32x32x16_bf16 a[80:95], a[232:235], v[232:235], a[80:95]
  ds_read_b64_tr_b16 a[250:251], v26 offset:38912
  v_and_b32 v89, 0xffff0000, v116
  v_exp_f32 v189, v189
  v_exp_f32 v190, v190
  v_mfma_f32_32x32x16_bf16 a[96:111], a[236:239], v[224:227], a[96:111]
  ds_read_b64_tr_b16 a[252:253], v27 offset:36864
  v_cvt_pk_bf16_f32 v238, v188, v189
  v_exp_f32 v191, v191
  v_add_f32 v28, v28, v166
  v_add_f32 v28, v28, v167
  v_mfma_f32_32x32x16_bf16 a[112:127], a[236:239], v[232:235], a[112:127]
  ds_read_b64_tr_b16 a[254:255], v27 offset:38912
  v_cvt_pk_bf16_f32 v239, v190, v191
  v_add_f32 v29, v29, v176
  v_add_f32 v29, v29, v177
  v_add_f32 v29, v29, v178
  v_add_f32 v29, v29, v179
  s_waitcnt lgkmcnt(4)
  v_mfma_f32_32x32x16_bf16 a[0:15], a[240:243], v[228:231], a[0:15]
  s_waitcnt vmcnt(4)
  s_barrier
  ds_read_b128 a[192:195], v16 offset:49152
  v_add_f32 v29, v29, v180
  v_add_f32 v29, v29, v181
  s_add_u32 m0, s19, 81920
  v_mfma_f32_32x32x16_bf16 a[16:31], a[240:243], v[236:239], a[16:31]
  v_add_f32 v29, v29, v182
  v_max3_f32 v31, v144, v145, v146
  v_add_f32 v29, v29, v183
  buffer_load_dwordx4 v12, s[28:31], s43 offen offset:0 lds
  v_mfma_f32_32x32x16_bf16 a[32:47], a[244:247], v[228:231], a[32:47]
  ds_read_b128 a[196:199], v17 offset:49152
  v_max3_f32 v30, v30, v131, v132
  v_add_f32 v28, v28, v168
  buffer_load_dwordx4 v13, s[28:31], s43 offen offset:1024 lds
  v_mfma_f32_32x32x16_bf16 a[48:63], a[244:247], v[236:239], a[48:63]
  v_max3_f32 v31, v31, v147, v148
  v_add_f32 v28, v28, v169
  v_max3_f32 v30, v30, v133, v134
  buffer_load_dwordx4 v14, s[28:31], s43 offen offset:2048 lds
  s_waitcnt lgkmcnt(2)
  v_mfma_f32_32x32x16_bf16 a[64:79], a[248:251], v[228:231], a[64:79]
  ds_read_b128 a[200:203], v18 offset:49152
  v_add_f32 v28, v28, v170
  buffer_load_dwordx4 v15, s[28:31], s43 offen offset:3072 lds
  s_add_u32 s43, s43, 8192
  v_mfma_f32_32x32x16_bf16 a[80:95], a[248:251], v[236:239], a[80:95]
  v_max3_f32 v31, v31, v149, v150
  v_add_f32 v28, v28, v171
  v_max3_f32 v30, v30, v135, v136
  v_add_f32 v28, v28, v172
  v_max3_f32 v31, v31, v151, v152
  v_add_f32 v28, v28, v173
  v_mfma_f32_32x32x16_bf16 a[96:111], a[252:255], v[228:231], a[96:111]
  ds_read_b128 a[204:207], v19 offset:49152
  v_max3_f32 v30, v30, v137, v138
  v_add_f32 v28, v28, v174
  v_max3_f32 v31, v31, v153, v154
  v_add_f32 v28, v28, v175
  v_max3_f32 v30, v30, v139, v140
  v_mfma_f32_32x32x16_bf16 a[112:127], a[252:255], v[236:239], a[112:127]
  v_add_f32 v29, v29, v184
  v_max3_f32 v31, v31, v155, v156
  v_add_f32 v29, v29, v185
  v_max3_f32 v30, v30, v141, v142
  v_add_f32 v29, v29, v186
  v_max3_f32 v31, v31, v157, v158
  v_add_f32 v29, v29, v187
  v_max_f32 v30, v30, v143
  v_add_f32 v29, v29, v188
  v_max_f32 v31, v31, v159
  v_add_f32 v29, v29, v189
  v_max_f32 v32, v30, v31
  v_add_f32 v29, v29, v190
  v_cmp_lt_f32 vcc, s50, v32
  v_add_f32 v29, v29, v191
  s_cbranch_vccz L_mk2_norescale_20
  s_call_b64 s[48:49], L_q_rescale0
L_mk2_norescale_20:
  s_waitcnt lgkmcnt(2)
  v_mfma_f32_32x32x16_bf16 v[160:175], a[192:195], a[128:131], v[192:207]
  ds_read_b128 a[208:211], v20 offset:49152
  s_cmp_lg_u32 s16, 0
  s_cbranch_scc1 L_mk2_ga_21
  s_mov_b32 s60, s88
  s_and_b32 s61, s89, 0xffff
  s_mov_b32 s62, 14680064
  s_mov_b32 s63, 0x00020000
  s_add_u32 s64, s69, 12582912
  buffer_load_dword v59, v58, s[60:63], s64 offen
L_mk2_ga_21:
  v_exp_f32 v128, v128
  v_mfma_f32_32x32x16_bf16 v[176:191], a[192:195], a[160:163], v[208:223]
  s_cmp_lg_u32 s16, 1
  s_cbranch_scc1 L_mk2_ga_22
  s_mov_b32 s60, s88
  s_and_b32 s61, s89, 0xffff
  s_mov_b32 s62, 14680064
  s_mov_b32 s63, 0x00020000
  s_add_u32 s64, s69, 13631488
  buffer_load_dword v59, v58, s[60:63], s64 offen
L_mk2_ga_22:
  v_exp_f32 v129, v129
  v_exp_f32 v130, v130
  v_cvt_pk_bf16_f32 v224, v128, v129
  v_mfma_f32_32x32x16_bf16 v[160:175], a[196:199], a[132:135], v[160:175]
  ds_read_b128 a[212:215], v21 offset:49152
  v_exp_f32 v131, v131
  v_exp_f32 v132, v132
  v_cvt_pk_bf16_f32 v225, v130, v131
  v_mfma_f32_32x32x16_bf16 v[176:191], a[196:199], a[164:167], v[176:191]
  v_exp_f32 v133, v133
  v_exp_f32 v134, v134
  v_cvt_pk_bf16_f32 v226, v132, v133
  v_add_f32 v28, v28, v128
  s_waitcnt lgkmcnt(2)
  v_mfma_f32_32x32x16_bf16 v[160:175], a[200:203], a[136:139], v[160:175]
  ds_read_b128 a[216:219], v22 offset:49152
  v_lshlrev_b32 v90, 16, v117
  v_and_b32 v91, 0xffff0000, v117
  v_exp_f32 v135, v135
  v_mfma_f32_32x32x16_bf16 v[176:191], a[200:203], a[168:171], v[176:191]
  v_lshlrev_b32 v84, 16, v118
  v_exp_f32 v144, v144
  v_cvt_pk_bf16_f32 v227, v134, v135
  v_exp_f32 v145, v145
  v_mfma_f32_32x32x16_bf16 v[160:175], a[204:207], a[140:143], v[160:175]
  ds_read_b128 a[220:223], v23 offset:49152
  v_and_b32 v85, 0xffff0000, v118
  v_exp_f32 v146, v146
  v_cvt_pk_bf16_f32 v232, v144, v145
  v_add_f32 v28, v28, v129
  v_mfma_f32_32x32x16_bf16 v[176:191], a[204:207], a[172:175], v[176:191]
  v_lshlrev_b32 v86, 16, v119
  v_exp_f32 v147, v147
  v_exp_f32 v148, v148
  v_cvt_pk_bf16_f32 v233, v146, v147
  s_waitcnt lgkmcnt(2)
  v_mfma_f32_32x32x16_bf16 v[160:175], a[208:211], a[144:147], v[160:175]
  ds_read_b64_tr_b16 a[224:225], v24 offset:49152
  v_and_b32 v87, 0xffff0000, v119
  v_lshlrev_b32 v92, 16, v118
  v_exp_f32 v149, v149
  v_mfma_f32_32x32x16_bf16 v[176:191], a[208:211], a[176:179], v[176:191]
  ds_read_b64_tr_b16 a[226:227], v24 offset:51200
  v_and_b32 v93, 0xffff0000, v118
  v_exp_f32 v150, v150
  v_cvt_pk_bf16_f32 v234, v148, v149
  v_add_f32 v28, v28, v130
  v_mfma_f32_32x32x16_bf16 v[160:175], a[212:215], a[148:151], v[160:175]
  ds_read_b64_tr_b16 a[228:229], v25 offset:49152
  v_lshlrev_b32 v94, 16, v119
  v_exp_f32 v151, v151
  v_exp_f32 v136, v136
  v_mfma_f32_32x32x16_bf16 v[176:191], a[212:215], a[180:183], v[176:191]
  ds_read_b64_tr_b16 a[230:231], v25 offset:51200
  v_and_b32 v95, 0xffff0000, v119
  v_cvt_pk_bf16_f32 v235, v150, v151
  v_exp_f32 v137, v137
  v_add_f32 v28, v28, v131
  s_waitcnt lgkmcnt(4)
  v_mfma_f32_32x32x16_bf16 v[160:175], a[216:219], a[152:155], v[160:175]
  ds_read_b64_tr_b16 a[232:233], v26 offset:49152
  v_lshlrev_b32 v96, 16, v120
  v_exp_f32 v138, v138
  v_cvt_pk_bf16_f32 v228, v136, v137
  v_mfma_f32_32x32x16_bf16 v[176:191], a[216:219], a[184:187], v[176:191]
  ds_read_b64_tr_b16 a[234:235], v26 offset:51200
  v_and_b32 v97, 0xffff0000, v120
  v_lshlrev_b32 v98, 16, v121
  v_exp_f32 v139, v139
  v_add_f32 v28, v28, v132
  v_mfma_f32_32x32x16_bf16 v[160:175], a[220:223], a[156:159], v[160:175]
  ds_read_b64_tr_b16 a[236:237], v27 offset:49152
  v_and_b32 v99, 0xffff0000, v121
  v_exp_f32 v140, v140
  v_cvt_pk_bf16_f32 v229, v138, v139
  v_add_f32 v28, v28, v133
  v_mfma_f32_32x32x16_bf16 v[176:191], a[220:223], a[188:191], v[176:191]
  ds_read_b64_tr_b16 a[238:239], v27 offset:51200
  v_lshlrev_b32 v104, 16, v120
  v_exp_f32 v141, v141
  v_exp_f32 v142, v142
  s_waitcnt lgkmcnt(4)
  v_mfma_f32_32x32x16_bf16 a[0:15], a[224:227], v[224:227], a[0:15]
  ds_read_b64_tr_b16 a[240:241], v24 offset:53248
  v_and_b32 v105, 0xffff0000, v120
  v_cvt_pk_bf16_f32 v230, v140, v141
  v_exp_f32 v143, v143
  v_mfma_f32_32x32x16_bf16 a[16:31], a[224:227], v[232:235], a[16:31]
  ds_read_b64_tr_b16 a[242:243], v24 offset:55296
  v_lshlrev_b32 v106, 16, v121
  v_and_b32 v107, 0xffff0000, v121
  v_exp_f32 v152, v152
  v_cvt_pk_bf16_f32 v231, v142, v143
  v_mfma_f32_32x32x16_bf16 a[32:47], a[228:231], v[224:227], a[32:47]
  ds_read_b64_tr_b16 a[244:245], v25 offset:53248
  v_lshlrev_b32 v100, 16, v122
  v_exp_f32 v153, v153
  v_exp_f32 v154, v154
  v_mfma_f32_32x32x16_bf16 a[48:63], a[228:231], v[232:235], a[48:63]
  ds_read_b64_tr_b16 a[246:247], v25 offset:55296
  v_and_b32 v101, 0xffff0000, v122
  v_cvt_pk_bf16_f32 v236, v152, v153
  v_exp_f32 v155, v155
  v_max3_f32 v30, v160, v161, v162
  s_waitcnt lgkmcnt(4)
  v_mfma_f32_32x32x16_bf16 a[64:79], a[232:235], v[224:227], a[64:79]
  ds_read_b64_tr_b16 a[248:249], v26 offset:53248
  v_lshlrev_b32 v102, 16, v123
  v_exp_f32 v156, v156
  v_cvt_pk_bf16_f32 v237, v154, v155
  v_mfma_f32_32x32x16_bf16 a[80:95], a[232:235], v[232:235], a[80:95]
  ds_read_b64_tr_b16 a[250:251], v26 offset:55296
  v_and_b32 v103, 0xffff0000, v123
  v_exp_f32 v157, v157
  v_exp_f32 v158, v158
  v_mfma_f32_32x32x16_bf16 a[96:111], a[236:239], v[224:227], a[96:111]
  ds_read_b64_tr_b16 a[252:253], v27 offset:53248
  v_cvt_pk_bf16_f32 v238, v156, v157
  v_exp_f32 v159, v159
  v_add_f32 v28, v28, v134
  v_add_f32 v28, v28, v135
  v_mfma_f32_32x32x16_bf16 a[112:127], a[236:239], v[232:235], a[112:127]
  ds_read_b64_tr_b16 a[254:255], v27 offset:55296
  v_cvt_pk_bf16_f32 v239, v158, v159
  v_add_f32 v29, v29, v144
  v_add_f32 v29, v29, v145
  v_add_f32 v29, v29, v146
  v_add_f32 v29, v29, v147
  s_waitcnt lgkmcnt(4)
  v_mfma_f32_32x32x16_bf16 a[0:15], a[240:243], v[228:231], a[0:15]
  s_waitcnt vmcnt(4)
  s_barrier
  ds_read_b128 a[192:195], v16 offset:0
  v_add_f32 v29, v29, v148
  v_add_f32 v29, v29, v149
  s_add_u32 m0, s19, 98304
  v_mfma_f32_32x32x16_bf16 a[16:31], a[240:243], v[236:239], a[16:31]
  v_add_f32 v29, v29, v150
  v_max3_f32 v31, v176, v177, v178
  v_add_f32 v29, v29, v151
  buffer_load_dwordx4 v12, s[28:31], s43 offen offset:0 lds
  v_mfma_f32_32x32x16_bf16 a[32:47], a[244:247], v[228:231], a[32:47]
  ds_read_b128 a[196:199], v17 offset:0
  v_max3_f32 v30, v30, v163, v164
  v_add_f32 v28, v28, v136
  buffer_load_dwordx4 v13, s[28:31], s43 offen offset:1024 lds
  v_mfma_f32_32x32x16_bf16 a[48:63], a[244:247], v[236:239], a[48:63]
  v_max3_f32 v31, v31, v179, v180
  v_add_f32 v28, v28, v137
  v_max3_f32 v30, v30, v165, v166
  buffer_load_dwordx4 v14, s[28:31], s43 offen offset:2048 lds
  s_waitcnt lgkmcnt(2)
  v_mfma_f32_32x32x16_bf16 a[64:79], a[248:251], v[228:231], a[64:79]
  ds_read_b128 a[200:203], v18 offset:0
  v_add_f32 v28, v28, v138
  buffer_load_dwordx4 v15, s[28:31], s43 offen offset:3072 lds
  s_add_u32 s43, s43, 8192
  v_mfma_f32_32x32x16_bf16 a[80:95], a[248:251], v[236:239], a[80:95]
  v_max3_f32 v31, v31, v181, v182
  v_add_f32 v28, v28, v139
  v_max3_f32 v30, v30, v167, v168
  v_add_f32 v28, v28, v140
  v_max3_f32 v31, v31, v183, v184
  v_add_f32 v28, v28, v141
  v_mfma_f32_32x32x16_bf16 a[96:111], a[252:255], v[228:231], a[96:111]
  ds_read_b128 a[204:207], v19 offset:0
  v_max3_f32 v30, v30, v169, v170
  v_add_f32 v28, v28, v142
  v_max3_f32 v31, v31, v185, v186
  v_add_f32 v28, v28, v143
  v_max3_f32 v30, v30, v171, v172
  v_mfma_f32_32x32x16_bf16 a[112:127], a[252:255], v[236:239], a[112:127]
  v_add_f32 v29, v29, v152
  v_max3_f32 v31, v31, v187, v188
  v_add_f32 v29, v29, v153
  v_max3_f32 v30, v30, v173, v174
  v_add_f32 v29, v29, v154
  v_max3_f32 v31, v31, v189, v190
  v_add_f32 v29, v29, v155
  v_max_f32 v30, v30, v175
  v_add_f32 v29, v29, v156
  v_max_f32 v31, v31, v191
  v_add_f32 v29, v29, v157
  v_max_f32 v32, v30, v31
  v_add_f32 v29, v29, v158
  v_cmp_lt_f32 vcc, s50, v32
  v_add_f32 v29, v29, v159
  s_cbranch_vccz L_mk2_norescale_23
  s_call_b64 s[48:49], L_q_rescale1
L_mk2_norescale_23:
  s_waitcnt lgkmcnt(2)
  v_mfma_f32_32x32x16_bf16 v[128:143], a[192:195], a[128:131], v[192:207]
  ds_read_b128 a[208:211], v20 offset:0
  s_cmp_lg_u32 s16, 2
  s_cbranch_scc1 L_mk2_ga_24
  s_mov_b32 s60, s80
  s_and_b32 s61, s81, 0xffff
  s_mov_b32 s62, 8388608
  s_mov_b32 s63, 0x00020000
  s_add_u32 s64, s69, 0
  buffer_load_dword v59, v58, s[60:63], s64 offen
L_mk2_ga_24:
  v_exp_f32 v160, v160
  v_mfma_f32_32x32x16_bf16 v[144:159], a[192:195], a[160:163], v[208:223]
  s_cmp_lg_u32 s16, 3
  s_cbranch_scc1 L_mk2_ga_25
  s_mov_b32 s60, s80
  s_and_b32 s61, s81, 0xffff
  s_mov_b32 s62, 8388608
  s_mov_b32 s63, 0x00020000
  s_add_u32 s64, s69, 1048576
  buffer_load_dword v59, v58, s[60:63], s64 offen
L_mk2_ga_25:
  v_exp_f32 v161, v161
  v_exp_f32 v162, v162
  v_cvt_pk_bf16_f32 v224, v160, v161
  v_mfma_f32_32x32x16_bf16 v[128:143], a[196:199], a[132:135], v[128:143]
  ds_read_b128 a[212:215], v21 offset:0
  v_exp_f32 v163, v163
  v_exp_f32 v164, v164
  v_cvt_pk_bf16_f32 v225, v162, v163
  v_mfma_f32_32x32x16_bf16 v[144:159], a[196:199], a[164:167], v[144:159]
  v_exp_f32 v165, v165
  v_exp_f32 v166, v166
  v_cvt_pk_bf16_f32 v226, v164, v165
  v_add_f32 v28, v28, v160
  s_waitcnt lgkmcnt(2)
  v_mfma_f32_32x32x16_bf16 v[128:143], a[200:203], a[136:139], v[128:143]
  ds_read_b128 a[216:219], v22 offset:0
  v_exp_f32 v167, v167
  v_exp_f32 v176, v176
  v_mfma_f32_32x32x16_bf16 v[144:159], a[200:203], a[168:171], v[144:159]
  v_cvt_pk_bf16_f32 v227, v166, v167
  v_exp_f32 v177, v177
  v_exp_f32 v178, v178
  v_cvt_pk_bf16_f32 v232, v176, v177
  v_mfma_f32_32x32x16_bf16 v[128:143], a[204:207], a[140:143], v[128:143]
  ds_read_b128 a[220:223], v23 offset:0
  v_exp_f32 v179, v179
  v_exp_f32 v180, v180
  v_cvt_pk_bf16_f32 v233, v178, v179
  v_mfma_f32_32x32x16_bf16 v[144:159], a[204:207], a[172:175], v[144:159]
  v_exp_f32 v181, v181
  v_exp_f32 v182, v182
  v_cvt_pk_bf16_f32 v234, v180, v181
  v_add_f32 v28, v28, v161
  s_waitcnt lgkmcnt(2)
  v_mfma_f32_32x32x16_bf16 v[128:143], a[208:211], a[144:147], v[128:143]
  ds_read_b64_tr_b16 a[224:225], v24 offset:0
  v_exp_f32 v183, v183
  v_exp_f32 v168, v168
  v_mfma_f32_32x32x16_bf16 v[144:159], a[208:211], a[176:179], v[144:159]
  ds_read_b64_tr_b16 a[226:227], v24 offset:2048
  v_cvt_pk_bf16_f32 v235, v182, v183
  v_exp_f32 v169, v169
  v_exp_f32 v170, v170
  v_mfma_f32_32x32x16_bf16 v[128:143], a[212:215], a[148:151], v[128:143]
  ds_read_b64_tr_b16 a[228:229], v25 offset:0
  v_cvt_pk_bf16_f32 v228, v168, v169
  v_exp_f32 v171, v171
  v_exp_f32 v172, v172
  v_mfma_f32_32x32x16_bf16 v[144:159], a[212:215], a[180:183], v[144:159]
  ds_read_b64_tr_b16 a[230:231], v25 offset:2048
  v_cvt_pk_bf16_f32 v229, v170, v171
  v_exp_f32 v173, v173
  v_exp_f32 v174, v174
  s_waitcnt lgkmcnt(4)
  v_mfma_f32_32x32x16_bf16 v[128:143], a[216:219], a[152:155], v[128:143]
  ds_read_b64_tr_b16 a[232:233], v26 offset:0
  v_cvt_pk_bf16_f32 v230, v172, v173
  v_exp_f32 v175, v175
  v_add_f32 v28, v28, v162
  v_mfma_f32_32x32x16_bf16 v[144:159], a[216:219], a[184:187], v[144:159]
  ds_read_b64_tr_b16 a[234:235], v26 offset:2048
  v_exp_f32 v184, v184
  v_cvt_pk_bf16_f32 v231, v174, v175
  v_exp_f32 v185, v185
  v_mfma_f32_32x32x16_bf16 v[128:143], a[220:223], a[156:159], v[128:143]
  ds_read_b64_tr_b16 a[236:237], v27 offset:0
  v_exp_f32 v186, v186
  v_cvt_pk_bf16_f32 v236, v184, v185
  v_exp_f32 v187, v187
  v_mfma_f32_32x32x16_bf16 v[144:159], a[220:223], a[188:191], v[144:159]
  ds_read_b64_tr_b16 a[238:239], v27 offset:2048
  v_exp_f32 v188, v188
  v_cvt_pk_bf16_f32 v237, v186, v187
  v_exp_f32 v189, v189
  s_nop 0
  s_waitcnt lgkmcnt(4)
  v_mfma_f32_32x32x16_bf16 a[0:15], a[224:227], v[224:227], a[0:15]
  ds_read_b64_tr_b16 a[240:241], v24 offset:4096
  v_exp_f32 v190, v190
  v_cvt_pk_bf16_f32 v238, v188, v189
  v_add_f32 v28, v28, v163
  v_mfma_f32_32x32x16_bf16 a[16:31], a[224:227], v[232:235], a[16:31]
  ds_read_b64_tr_b16 a[242:243], v24 offset:6144
  v_exp_f32 v191, v191
  v_add_f32 v28, v28, v164
  v_add_f32 v28, v28, v165
  v_add_f32 v28, v28, v166
  v_mfma_f32_32x32x16_bf16 a[32:47], a[228:231], v[224:227], a[32:47]
  ds_read_b64_tr_b16 a[244:245], v25 offset:4096
  v_cvt_pk_bf16_f32 v239, v190, v191
  v_add_f32 v28, v28, v167
  v_add_f32 v29, v29, v176
  v_add_f32 v29, v29, v177
  v_add_f32 v29, v29, v178
  v_mfma_f32_32x32x16_bf16 a[48:63], a[228:231], v[232:235], a[48:63]
  ds_read_b64_tr_b16 a[246:247], v25 offset:6144
  v_add_f32 v29, v29, v179
  v_add_f32 v29, v29, v180
  v_add_f32 v29, v29, v181
  v_max3_f32 v30, v128, v129, v130
  v_add_f32 v29, v29, v182
  s_waitcnt lgkmcnt(4)
  v_mfma_f32_32x32x16_bf16 a[64:79], a[232:235], v[224:227], a[64:79]
  ds_read_b64_tr_b16 a[248:249], v26 offset:4096
  v_max3_f32 v31, v144, v145, v146
  v_add_f32 v29, v29, v183
  v_max3_f32 v30, v30, v131, v132
  v_add_f32 v28, v28, v168
  v_mfma_f32_32x32x16_bf16 a[80:95], a[232:235], v[232:235], a[80:95]
  ds_read_b64_tr_b16 a[250:251], v26 offset:6144
  v_max3_f32 v31, v31, v147, v148
  v_add_f32 v28, v28, v169
  v_max3_f32 v30, v30, v133, v134
  v_add_f32 v28, v28, v170
  v_max3_f32 v31, v31, v149, v150
  v_mfma_f32_32x32x16_bf16 a[96:111], a[236:239], v[224:227], a[96:111]
  ds_read_b64_tr_b16 a[252:253], v27 offset:4096
  v_add_f32 v28, v28, v171
  v_max3_f32 v30, v30, v135, v136
  v_add_f32 v28, v28, v172
  v_max3_f32 v31, v31, v151, v152
  v_add_f32 v28, v28, v173
  v_mfma_f32_32x32x16_bf16 a[112:127], a[236:239], v[232:235], a[112:127]
  ds_read_b64_tr_b16 a[254:255], v27 offset:6144
  v_max3_f32 v30, v30, v137, v138
  v_add_f32 v28, v28, v174
  v_max3_f32 v31, v31, v153, v154
  v_add_f32 v28, v28, v175
  v_max3_f32 v30, v30, v139, v140
  s_waitcnt lgkmcnt(4)
  v_mfma_f32_32x32x16_bf16 a[0:15], a[240:243], v[228:231], a[0:15]
  s_waitcnt vmcnt(4)
  s_barrier
  ds_read_b128 a[192:195], v16 offset:16384
  v_add_f32 v29, v29, v184
  v_max3_f32 v31, v31, v155, v156
  s_add_u32 m0, s19, 114688
  v_mfma_f32_32x32x16_bf16 a[16:31], a[240:243], v[236:239], a[16:31]
  v_add_f32 v29, v29, v185
  v_max3_f32 v30, v30, v141, v142
  v_add_f32 v29, v29, v186
  buffer_load_dwordx4 v12, s[28:31], s43 offen offset:0 lds
  v_mfma_f32_32x32x16_bf16 a[32:47], a[244:247], v[228:231], a[32:47]
  ds_read_b128 a[196:199], v17 offset:16384
  v_max3_f32 v31, v31, v157, v158
  v_add_f32 v29, v29, v187
  buffer_load_dwordx4 v13, s[28:31], s43 offen offset:1024 lds
  v_mfma_f32_32x32x16_bf16 a[48:63], a[244:247], v[236:239], a[48:63]
  v_max_f32 v30, v30, v143
  v_add_f32 v29, v29, v188
  v_max_f32 v31, v31, v159
  buffer_load_dwordx4 v14, s[28:31], s43 offen offset:2048 lds
  s_waitcnt lgkmcnt(2)
  v_mfma_f32_32x32x16_bf16 a[64:79], a[248:251], v[228:231], a[64:79]
  ds_read_b128 a[200:203], v18 offset:16384
  v_add_f32 v29, v29, v189
  buffer_load_dwordx4 v15, s[28:31], s43 offen offset:3072 lds
  s_add_u32 s43, s43, 8192
  v_mfma_f32_32x32x16_bf16 a[80:95], a[248:251], v[236:239], a[80:95]
  v_add_f32 v29, v29, v190
  v_add_f32 v29, v29, v191
  v_mfma_f32_32x32x16_bf16 a[96:111], a[252:255], v[228:231], a[96:111]
  ds_read_b128 a[204:207], v19 offset:16384
  v_mfma_f32_32x32x16_bf16 a[112:127], a[252:255], v[236:239], a[112:127]
  v_max_f32 v32, v30, v31
  v_cmp_lt_f32 vcc, s50, v32
  s_cbranch_vccz L_mk2_norescale_26
  s_call_b64 s[48:49], L_q_rescale0
L_mk2_norescale_26:
  s_waitcnt lgkmcnt(2)
  v_mfma_f32_32x32x16_bf16 v[160:175], a[192:195], a[128:131], v[192:207]
  ds_read_b128 a[208:211], v20 offset:16384
  s_cmp_lg_u32 s16, 0
  s_cbranch_scc1 L_mk2_ga_27
  s_mov_b32 s60, s80
  s_and_b32 s61, s81, 0xffff
  s_mov_b32 s62, 8388608
  s_mov_b32 s63, 0x00020000
  s_add_u32 s64, s69, 2097152
  buffer_load_dword v59, v58, s[60:63], s64 offen
L_mk2_ga_27:
  v_exp_f32 v128, v128
  v_mfma_f32_32x32x16_bf16 v[176:191], a[192:195], a[160:163], v[208:223]
  s_cmp_lg_u32 s16, 1
  s_cbranch_scc1 L_mk2_ga_28
  s_mov_b32 s60, s80
  s_and_b32 s61, s81, 0xffff
  s_mov_b32 s62, 8388608
  s_mov_b32 s63, 0x00020000
  s_add_u32 s64, s69, 3145728
  buffer_load_dword v59, v58, s[60:63], s64 offen
L_mk2_ga_28:
  v_exp_f32 v129, v129
  v_exp_f32 v130, v130
  v_cvt_pk_bf16_f32 v224, v128, v129
  v_mfma_f32_32x32x16_bf16 v[160:175], a[196:199], a[132:135], v[160:175]
  ds_read_b128 a[212:215], v21 offset:16384
  v_exp_f32 v131, v131
  v_exp_f32 v132, v132
  v_cvt_pk_bf16_f32 v225, v130, v131
  v_mfma_f32_32x32x16_bf16 v[176:191], a[196:199], a[164:167], v[176:191]
  v_exp_f32 v133, v133
  v_exp_f32 v134, v134
  v_cvt_pk_bf16_f32 v226, v132, v133
  v_add_f32 v28, v28, v128
  s_waitcnt lgkmcnt(2)
  v_mfma_f32_32x32x16_bf16 v[160:175], a[200:203], a[136:139], v[160:175]
  ds_read_b128 a[216:219], v22 offset:16384
  v_lshlrev_b32 v108, 16, v122
  v_and_b32 v109, 0xffff0000, v122
  v_exp_f32 v135, v135
  v_mfma_f32_32x32x16_bf16 v[176:191], a[200:203], a[168:171], v[176:191]
  v_lshlrev_b32 v110, 16, v123
  v_exp_f32 v144, v144
  v_cvt_pk_bf16_f32 v227, v134, v135
  v_exp_f32 v145, v145
  v_mfma_f32_32x32x16_bf16 v[160:175], a[204:207], a[140:143], v[160:175]
  ds_read_b128 a[220:223], v23 offset:16384
  v_and_b32 v111, 0xffff0000, v123
  v_exp_f32 v146, v146
  v_cvt_pk_bf16_f32 v232, v144, v145
  v_add_f32 v28, v28, v129
  v_mfma_f32_32x32x16_bf16 v[176:191], a[204:207], a[172:175], v[176:191]
  v_lshlrev_b32 v112, 16, v124
  v_exp_f32 v147, v147
  v_exp_f32 v148, v148
  v_cvt_pk_bf16_f32 v233, v146, v147
  s_waitcnt lgkmcnt(2)
  v_mfma_f32_32x32x16_bf16 v[160:175], a[208:211], a[144:147], v[160:175]
  ds_read_b64_tr_b16 a[224:225], v24 offset:16384
  v_and_b32 v113, 0xffff0000, v124
  v_exp_f32 v149, v149
  v_add_f32 v28, v28, v130
  v_mfma_f32_32x32x16_bf16 v[176:191], a[208:211], a[176:179], v[176:191]
  ds_read_b64_tr_b16 a[226:227], v24 offset:18432
  v_lshlrev_b32 v114, 16, v125
  v_exp_f32 v150, v150
  v_cvt_pk_bf16_f32 v234, v148, v149
  v_add_f32 v28, v28, v131
  v_mfma_f32_32x32x16_bf16 v[160:175], a[212:215], a[148:151], v[160:175]
  ds_read_b64_tr_b16 a[228:229], v25 offset:16384
  v_and_b32 v115, 0xffff0000, v125
  v_exp_f32 v151, v151
  v_exp_f32 v136, v136
  v_mfma_f32_32x32x16_bf16 v[176:191], a[212:215], a[180:183], v[176:191]
  ds_read_b64_tr_b16 a[230:231], v25 offset:18432
  v_lshlrev_b32 v116, 16, v126
  v_cvt_pk_bf16_f32 v235, v150, v151
  v_exp_f32 v137, v137
  v_add_f32 v28, v28, v132
  s_waitcnt lgkmcnt(4)
  v_mfma_f32_32x32x16_bf16 v[160:175], a[216:219], a[152:155], v[160:175]
  ds_read_b64_tr_b16 a[232:233], v26 offset:16384
  v_and_b32 v117, 0xffff0000, v126
  v_exp_f32 v138, v138
  v_cvt_pk_bf16_f32 v228, v136, v137
  v_mfma_f32_32x32x16_bf16 v[176:191], a[216:219], a[184:187], v[176:191]
  ds_read_b64_tr_b16 a[234:235], v26 offset:18432
  v_lshlrev_b32 v118, 16, v127
  v_and_b32 v119, 0xffff0000, v127
  v_exp_f32 v139, v139
  v_add_f32 v28, v28, v133
  v_mfma_f32_32x32x16_bf16 v[160:175], a[220:223], a[156:159], v[160:175]
  ds_read_b64_tr_b16 a[236:237], v27 offset:16384
  v_mov_b32 v120, v112
  v_exp_f32 v140, v140
  v_cvt_pk_bf16_f32 v229, v138, v139
  v_add_f32 v28, v28, v134
  v_mfma_f32_32x32x16_bf16 v[176:191], a[220:223], a[188:191], v[176:191]
  ds_read_b64_tr_b16 a[238:239], v27 offset:18432
  v_mov_b32 v121, v113
  v_exp_f32 v141, v141
  v_exp_f32 v142, v142
  s_waitcnt lgkmcnt(4)
  v_mfma_f32_32x32x16_bf16 a[0:15], a[224:227], v[224:227], a[0:15]
  ds_read_b64_tr_b16 a[240:241], v24 offset:20480
  v_mov_b32 v122, v114
  v_cvt_pk_bf16_f32 v230, v140, v141
  v_exp_f32 v143, v143
  v_mfma_f32_32x32x16_bf16 a[16:31], a[224:227], v[232:235], a[16:31]
  ds_read_b64_tr_b16 a[242:243], v24 offset:22528
  v_mov_b32 v123, v115
  v_exp_f32 v152, v152
  v_cvt_pk_bf16_f32 v231, v142, v143
  v_add_f32 v28, v28, v135
  v_mfma_f32_32x32x16_bf16 a[32:47], a[228:231], v[224:227], a[32:47]
  ds_read_b64_tr_b16 a[244:245], v25 offset:20480
  v_mov_b32 v124, v116
  v_exp_f32 v153, v153
  v_exp_f32 v154, v154
  v_mfma_f32_32x32x16_bf16 a[48:63], a[228:231], v[232:235], a[48:63]
  ds_read_b64_tr_b16 a[246:247], v25 offset:22528
  v_mov_b32 v125, v117
  v_cvt_pk_bf16_f32 v236, v152, v153
  v_exp_f32 v155, v155
  v_max3_f32 v30, v160, v161, v162
  s_waitcnt lgkmcnt(4)
  v_mfma_f32_32x32x16_bf16 a[64:79], a[232:235], v[224:227], a[64:79]
  ds_read_b64_tr_b16 a[248:249], v26 offset:20480
  v_mov_b32 v126, v118
  v_exp_f32 v156, v156
  v_cvt_pk_bf16_f32 v237, v154, v155
  v_mfma_f32_32x32x16_bf16 a[80:95], a[232:235], v[232:235], a[80:95]
  ds_read_b64_tr_b16 a[250:251], v26 offset:22528
  v_mov_b32 v127, v119
  v_exp_f32 v157, v157
  v_exp_f32 v158, v158
  v_mfma_f32_32x32x16_bf16 a[96:111], a[236:239], v[224:227], a[96:111]
  ds_read_b64_tr_b16 a[252:253], v27 offset:20480
  v_cvt_pk_bf16_f32 v238, v156, v157
  v_exp_f32 v159, v159
  v_add_f32 v29, v29, v144
  v_add_f32 v29, v29, v145
  v_mfma_f32_32x32x16_bf16 a[112:127], a[236:239], v[232:235], a[112:127]
  ds_read_b64_tr_b16 a[254:255], v27 offset:22528
  v_cvt_pk_bf16_f32 v239, v158, v159
  v_add_f32 v29, v29, v146
  v_add_f32 v29, v29, v147
  v_add_f32 v29, v29, v148
  v_max3_f32 v31, v176, v177, v178
  s_waitcnt lgkmcnt(4)
  v_mfma_f32_32x32x16_bf16 a[0:15], a[240:243], v[228:231], a[0:15]
  s_waitcnt vmcnt(4)
  s_barrier
  ds_read_b128 a[192:195], v16 offset:32768
  v_add_f32 v29, v29, v149
  v_add_f32 v29, v29, v150
  s_add_u32 m0, s19, 65536
  v_mfma_f32_32x32x16_bf16 a[16:31], a[240:243], v[236:239], a[16:31]
  v_add_f32 v29, v29, v151
  v_max3_f32 v30, v30, v163, v164
  v_add_f32 v28, v28, v136
  buffer_load_dwordx4 v12, s[28:31], s43 offen offset:0 lds
  v_mfma_f32_32x32x16_bf16 a[32:47], a[244:247], v[228:231], a[32:47]
  ds_read_b128 a[196:199], v17 offset:32768
  v_max3_f32 v31, v31, v179, v180
  v_add_f32 v28, v28, v137
  buffer_load_dwordx4 v13, s[28:31], s43 offen offset:1024 lds
  v_mfma_f32_32x32x16_bf16 a[48:63], a[244:247], v[236:239], a[48:63]
  v_max3_f32 v30, v30, v165, v166
  v_add_f32 v28, v28, v138
  v_max3_f32 v31, v31, v181, v182
  buffer_load_dwordx4 v14, s[28:31], s43 offen offset:2048 lds
  s_waitcnt lgkmcnt(2)
  v_mfma_f32_32x32x16_bf16 a[64:79], a[248:251], v[228:231], a[64:79]
  ds_read_b128 a[200:203], v18 offset:32768
  v_add_f32 v28, v28, v139
  buffer_load_dwordx4 v15, s[28:31], s43 offen offset:3072 lds
  s_add_u32 s43, s43, 8192
  v_mfma_f32_32x32x16_bf16 a[80:95], a[248:251], v[236:239], a[80:95]
  v_max3_f32 v30, v30, v167, v168
  v_add_f32 v28, v28, v140
  v_max3_f32 v31, v31, v183, v184
  v_add_f32 v28, v28, v141
  v_max3_f32 v30, v30, v169, v170
  v_add_f32 v28, v28, v142
  v_mfma_f32_32x32x16_bf16 a[96:111], a[252:255], v[228:231], a[96:111]
  ds_read_b128 a[204:207], v19 offset:32768
  v_max3_f32 v31, v31, v185, v186
  v_add_f32 v28, v28, v143
  v_max3_f32 v30, v30, v171, v172
  v_add_f32 v29, v29, v152
  v_max3_f32 v31, v31, v187, v188
  v_mfma_f32_32x32x16_bf16 a[112:127], a[252:255], v[236:239], a[112:127]
  v_add_f32 v29, v29, v153
  v_max3_f32 v30, v30, v173, v174
  v_add_f32 v29, v29, v154
  v_max3_f32 v31, v31, v189, v190
  v_add_f32 v29, v29, v155
  v_max_f32 v30, v30, v175
  v_add_f32 v29, v29, v156
  v_max_f32 v31, v31, v191
  v_add_f32 v29, v29, v157
  v_max_f32 v32, v30, v31
  v_add_f32 v29, v29, v158
  v_cmp_lt_f32 vcc, s50, v32
  v_add_f32 v29, v29, v159
  s_cbranch_vccz L_mk2_norescale_29
  s_call_b64 s[48:49], L_q_rescale1
L_mk2_norescale_29:
  s_waitcnt lgkmcnt(2)
  v_mfma_f32_32x32x16_bf16 v[128:143], a[192:195], a[128:131], v[192:207]
  ds_read_b128 a[208:211], v20 offset:32768
  s_cmp_lg_u32 s16, 2
  s_cbranch_scc1 L_mk2_ga_30
  s_mov_b32 s60, s80
  s_and_b32 s61, s81, 0xffff
  s_mov_b32 s62, 8388608
  s_mov_b32 s63, 0x00020000
  s_add_u32 s64, s69, 4194304
  buffer_load_dword v59, v58, s[60:63], s64 offen
L_mk2_ga_30:
  v_exp_f32 v160, v160
  v_mfma_f32_32x32x16_bf16 v[144:159], a[192:195], a[160:163], v[208:223]
  s_cmp_lg_u32 s16, 3
  s_cbranch_scc1 L_mk2_ga_31
  s_mov_b32 s60, s80
  s_and_b32 s61, s81, 0xffff
  s_mov_b32 s62, 8388608
  s_mov_b32 s63, 0x00020000
  s_add_u32 s64, s69, 5242880
  buffer_load_dword v59, v58, s[60:63], s64 offen
L_mk2_ga_31:
  v_exp_f32 v161, v161
  v_exp_f32 v162, v162
  v_cvt_pk_bf16_f32 v224, v160, v161
  v_mfma_f32_32x32x16_bf16 v[128:143], a[196:199], a[132:135], v[128:143]
  ds_read_b128 a[212:215], v21 offset:32768
  s_mul_i32 s21, s16, 114688
  v_mul_u32_u24 v51, 7168, v34
  v_exp_f32 v163, v163
  v_add_f32 v28, v28, v160
  v_mfma_f32_32x32x16_bf16 v[144:159], a[196:199], a[164:167], v[144:159]
  v_add3_u32 v48, v51, v44, s21
  v_add3_u32 v49, v51, v45, s21
  v_exp_f32 v164, v164
  v_cvt_pk_bf16_f32 v225, v162, v163
  v_add_f32 v28, v28, v161
  s_waitcnt lgkmcnt(2)
  v_mfma_f32_32x32x16_bf16 v[128:143], a[200:203], a[136:139], v[128:143]
  ds_read_b128 a[216:219], v22 offset:32768
  v_exp_f32 v165, v165
  v_exp_f32 v166, v166
  v_mfma_f32_32x32x16_bf16 v[144:159], a[200:203], a[168:171], v[144:159]
  v_add_u32 v49, 27648, v49
  v_add_u32 v50, 55296, v48
  v_cvt_pk_bf16_f32 v226, v164, v165
  v_exp_f32 v167, v167
  v_add_f32 v28, v28, v162
  v_mfma_f32_32x32x16_bf16 v[128:143], a[204:207], a[140:143], v[128:143]
  ds_read_b128 a[220:223], v23 offset:32768
  v_add_u32 v51, 55296, v49
  s_mov_b32 s66, 0
  v_exp_f32 v176, v176
  v_cvt_pk_bf16_f32 v227, v166, v167
  v_mfma_f32_32x32x16_bf16 v[144:159], a[204:207], a[172:175], v[144:159]
  v_exp_f32 v177, v177
  v_exp_f32 v178, v178
  v_cvt_pk_bf16_f32 v232, v176, v177
  v_add_f32 v28, v28, v163
  s_waitcnt lgkmcnt(2)
  v_mfma_f32_32x32x16_bf16 v[128:143], a[208:211], a[144:147], v[128:143]
  ds_read_b64_tr_b16 a[224:225], v24 offset:32768
  s_mov_b32 s67, 0
  s_lshl_b32 s21, s71, 1
  v_exp_f32 v179, v179
  v_mfma_f32_32x32x16_bf16 v[144:159], a[208:211], a[176:179], v[144:159]
  ds_read_b64_tr_b16 a[226:227], v24 offset:34816
  s_sub_u32 s22, 14680064, s21
  s_add_u32 s4, s84, s21
  s_addc_u32 s5, s85, 0
  v_exp_f32 v180, v180
  v_cvt_pk_bf16_f32 v233, v178, v179
  v_mfma_f32_32x32x16_bf16 v[128:143], a[212:215], a[148:151], v[128:143]
  ds_read_b64_tr_b16 a[228:229], v25 offset:32768
  v_exp_f32 v181, v181
  v_exp_f32 v182, v182
  v_cvt_pk_bf16_f32 v234, v180, v181
  v_mfma_f32_32x32x16_bf16 v[144:159], a[212:215], a[180:183], v[144:159]
  ds_read_b64_tr_b16 a[230:231], v25 offset:34816
  s_and_b32 s5, s5, 0xffff
  s_mov_b32 s6, s22
  v_exp_f32 v183, v183
  v_add_f32 v28, v28, v164
  s_waitcnt lgkmcnt(4)
  v_mfma_f32_32x32x16_bf16 v[128:143], a[216:219], a[152:155], v[128:143]
  ds_read_b64_tr_b16 a[232:233], v26 offset:32768
  s_mov_b32 s7, 0x00020000
  s_lshl_b32 s21, s38, 2
  v_exp_f32 v168, v168
  v_mfma_f32_32x32x16_bf16 v[144:159], a[216:219], a[184:187], v[144:159]
  ds_read_b64_tr_b16 a[234:235], v26 offset:34816
  v_cvt_pk_bf16_f32 v235, v182, v183
  v_exp_f32 v169, v169
  v_exp_f32 v170, v170
  v_mfma_f32_32x32x16_bf16 v[128:143], a[220:223], a[156:159], v[128:143]
  ds_read_b64_tr_b16 a[236:237], v27 offset:32768
  s_add_u32 s21, s21, s16
  s_lshl_b32 s22, s21, 17
  v_cvt_pk_bf16_f32 v228, v168, v169
  v_exp_f32 v171, v171
  v_mfma_f32_32x32x16_bf16 v[144:159], a[220:223], a[188:191], v[144:159]
  ds_read_b64_tr_b16 a[238:239], v27 offset:34816
  s_add_u32 s22, s22, 4194304
  s_add_u32 s44, s96, s22
  s_addc_u32 s45, s97, 0
  v_exp_f32 v172, v172
  v_cvt_pk_bf16_f32 v229, v170, v171
  s_nop 0
  s_nop 0
  s_waitcnt lgkmcnt(4)
  v_mfma_f32_32x32x16_bf16 a[0:15], a[224:227], v[224:227], a[0:15]
  ds_read_b64_tr_b16 a[240:241], v24 offset:36864
  v_exp_f32 v173, v173
  v_exp_f32 v174, v174
  v_mfma_f32_32x32x16_bf16 a[16:31], a[224:227], v[232:235], a[16:31]
  ds_read_b64_tr_b16 a[242:243], v24 offset:38912
  s_and_b32 s45, s45, 0xffff
  s_mov_b32 s46, 131072
  v_cvt_pk_bf16_f32 v230, v172, v173
  v_exp_f32 v175, v175
  v_mfma_f32_32x32x16_bf16 a[32:47], a[228:231], v[224:227], a[32:47]
  ds_read_b64_tr_b16 a[244:245], v25 offset:36864
  s_mov_b32 s47, 0x00020000
  s_mul_i32 s66, s38, 1835008
  v_exp_f32 v184, v184
  v_cvt_pk_bf16_f32 v231, v174, v175
  v_mfma_f32_32x32x16_bf16 a[48:63], a[228:231], v[232:235], a[48:63]
  ds_read_b64_tr_b16 a[246:247], v25 offset:38912
  v_exp_f32 v185, v185
  v_exp_f32 v186, v186
  v_cvt_pk_bf16_f32 v236, v184, v185
  s_waitcnt lgkmcnt(4)
  v_mfma_f32_32x32x16_bf16 a[64:79], a[232:235], v[224:227], a[64:79]
  ds_read_b64_tr_b16 a[248:249], v26 offset:36864
  s_lshl_b32 s67, s38, 14
  v_lshlrev_b32 v60, 5, v2
  v_exp_f32 v187, v187
  v_mfma_f32_32x32x16_bf16 a[80:95], a[232:235], v[232:235], a[80:95]
  ds_read_b64_tr_b16 a[250:251], v26 offset:38912
  v_exp_f32 v188, v188
  v_cvt_pk_bf16_f32 v237, v186, v187
  v_exp_f32 v189, v189
  v_mfma_f32_32x32x16_bf16 a[96:111], a[236:239], v[224:227], a[96:111]
  ds_read_b64_tr_b16 a[252:253], v27 offset:36864
  v_exp_f32 v190, v190
  v_cvt_pk_bf16_f32 v238, v188, v189
  v_exp_f32 v191, v191
  v_mfma_f32_32x32x16_bf16 a[112:127], a[236:239], v[232:235], a[112:127]
  ds_read_b64_tr_b16 a[254:255], v27 offset:38912
  v_cvt_pk_bf16_f32 v239, v190, v191
  v_add_f32 v28, v28, v165
  v_add_f32 v28, v28, v166
  v_add_f32 v28, v28, v167
  v_add_f32 v29, v29, v176
  s_waitcnt lgkmcnt(4)
  v_mfma_f32_32x32x16_bf16 a[0:15], a[240:243], v[228:231], a[0:15]
  s_waitcnt vmcnt(4)
  s_barrier
  ds_read_b128 a[192:195], v16 offset:49152
  v_add_f32 v29, v29, v177
  v_add_f32 v29, v29, v178
  s_add_u32 m0, s19, 81920
  v_mfma_f32_32x32x16_bf16 a[16:31], a[240:243], v[236:239], a[16:31]
  v_add_f32 v29, v29, v179
  v_add_f32 v29, v29, v180
  v_add_f32 v29, v29, v181
  buffer_load_dwordx4 v12, s[28:31], s43 offen offset:0 lds
  v_mfma_f32_32x32x16_bf16 a[32:47], a[244:247], v[228:231], a[32:47]
  ds_read_b128 a[196:199], v17 offset:49152
  v_max3_f32 v30, v128, v129, v130
  v_add_f32 v29, v29, v182
  buffer_load_dwordx4 v13, s[28:31], s43 offen offset:1024 lds
  v_mfma_f32_32x32x16_bf16 a[48:63], a[244:247], v[236:239], a[48:63]
  v_max3_f32 v31, v144, v145, v146
  v_add_f32 v29, v29, v183
  v_max3_f32 v30, v30, v131, v132
  buffer_load_dwordx4 v14, s[28:31], s43 offen offset:2048 lds
  s_waitcnt lgkmcnt(2)
  v_mfma_f32_32x32x16_bf16 a[64:79], a[248:251], v[228:231], a[64:79]
  ds_read_b128 a[200:203], v18 offset:49152
  v_add_f32 v28, v28, v168
  buffer_load_dwordx4 v15, s[28:31], s43 offen offset:3072 lds
  s_add_u32 s43, s43, 8192
  v_mfma_f32_32x32x16_bf16 a[80:95], a[248:251], v[236:239], a[80:95]
  v_max3_f32 v31, v31, v147, v148
  v_add_f32 v28, v28, v169
  v_max3_f32 v30, v30, v133, v134
  v_add_f32 v28, v28, v170
  v_max3_f32 v31, v31, v149, v150
  v_add_f32 v28, v28, v171
  v_mfma_f32_32x32x16_bf16 a[96:111], a[252:255], v[228:231], a[96:111]
  ds_read_b128 a[204:207], v19 offset:49152
  v_max3_f32 v30, v30, v135, v136
  v_add_f32 v28, v28, v172
  v_max3_f32 v31, v31, v151, v152
  v_add_f32 v28, v28, v173
  v_max3_f32 v30, v30, v137, v138
  v_mfma_f32_32x32x16_bf16 a[112:127], a[252:255], v[236:239], a[112:127]
  v_add_f32 v28, v28, v174
  v_max3_f32 v31, v31, v153, v154
  v_add_f32 v28, v28, v175
  v_max3_f32 v30, v30, v139, v140
  v_add_f32 v29, v29, v184
  v_max3_f32 v31, v31, v155, v156
  v_add_f32 v29, v29, v185
  v_max3_f32 v30, v30, v141, v142
  v_add_f32 v29, v29, v186
  v_max3_f32 v31, v31, v157, v158
  v_add_f32 v29, v29, v187
  v_max_f32 v30, v30, v143
  v_add_f32 v29, v29, v188
  v_max_f32 v31, v31, v159
  v_add_f32 v29, v29, v189
  v_max_f32 v32, v30, v31
  v_add_f32 v29, v29, v190
  v_cmp_lt_f32 vcc, s50, v32
  v_add_f32 v29, v29, v191
  s_cbranch_vccz L_mk2_norescale_32
  s_call_b64 s[48:49], L_q_rescale0
L_mk2_norescale_32:
  s_waitcnt lgkmcnt(2)
  v_mfma_f32_32x32x16_bf16 v[160:175], a[192:195], a[128:131], v[192:207]
  ds_read_b128 a[208:211], v20 offset:49152
  s_cmp_lg_u32 s16, 0
  s_cbranch_scc1 L_mk2_ga_33
  s_mov_b32 s60, s80
  s_and_b32 s61, s81, 0xffff
  s_mov_b32 s62, 8388608
  s_mov_b32 s63, 0x00020000
  s_add_u32 s64, s69, 6291456
  buffer_load_dword v59, v58, s[60:63], s64 offen
L_mk2_ga_33:
  v_exp_f32 v128, v128
  v_mfma_f32_32x32x16_bf16 v[176:191], a[192:195], a[160:163], v[208:223]
  s_cmp_lg_u32 s16, 1
  s_cbranch_scc1 L_mk2_ga_34
  s_mov_b32 s60, s80
  s_and_b32 s61, s81, 0xffff
  s_mov_b32 s62, 8388608
  s_mov_b32 s63, 0x00020000
  s_add_u32 s64, s69, 7340032
  buffer_load_dword v59, v58, s[60:63], s64 offen
L_mk2_ga_34:
  v_exp_f32 v129, v129
  v_exp_f32 v130, v130
  v_cvt_pk_bf16_f32 v224, v128, v129
  v_mfma_f32_32x32x16_bf16 v[160:175], a[196:199], a[132:135], v[160:175]
  ds_read_b128 a[212:215], v21 offset:49152
  buffer_load_dword v52, v60, s[52:55], 0 offen sc1
  buffer_load_dword v53, v60, s[52:55], s98 offen sc1
  buffer_load_dword v54, v60, s[52:55], s99 offen sc1
  buffer_load_dword v55, v60, s[52:55], s100 offen sc1
  v_exp_f32 v131, v131
  v_exp_f32 v132, v132
  v_mfma_f32_32x32x16_bf16 v[176:191], a[196:199], a[164:167], v[176:191]
  v_cvt_pk_bf16_f32 v225, v130, v131
  v_exp_f32 v133, v133
  v_exp_f32 v134, v134
  v_cvt_pk_bf16_f32 v226, v132, v133
  s_waitcnt lgkmcnt(2)
  v_mfma_f32_32x32x16_bf16 v[160:175], a[200:203], a[136:139], v[160:175]
  ds_read_b128 a[216:219], v22 offset:49152
  v_exp_f32 v135, v135
  v_exp_f32 v144, v144
  v_mfma_f32_32x32x16_bf16 v[176:191], a[200:203], a[168:171], v[176:191]
  v_cvt_pk_bf16_f32 v227, v134, v135
  v_exp_f32 v145, v145
  v_exp_f32 v146, v146
  v_cvt_pk_bf16_f32 v232, v144, v145
  v_mfma_f32_32x32x16_bf16 v[160:175], a[204:207], a[140:143], v[160:175]
  ds_read_b128 a[220:223], v23 offset:49152
  v_exp_f32 v147, v147
  v_exp_f32 v148, v148
  v_cvt_pk_bf16_f32 v233, v146, v147
  v_mfma_f32_32x32x16_bf16 v[176:191], a[204:207], a[172:175], v[176:191]
  v_exp_f32 v149, v149
  v_exp_f32 v150, v150
  v_cvt_pk_bf16_f32 v234, v148, v149
  v_add_f32 v28, v28, v128
  s_waitcnt lgkmcnt(2)
  v_mfma_f32_32x32x16_bf16 v[160:175], a[208:211], a[144:147], v[160:175]
  ds_read_b64_tr_b16 a[224:225], v24 offset:49152
  v_exp_f32 v151, v151
  v_exp_f32 v136, v136
  v_mfma_f32_32x32x16_bf16 v[176:191], a[208:211], a[176:179], v[176:191]
  ds_read_b64_tr_b16 a[226:227], v24 offset:51200
  v_cvt_pk_bf16_f32 v235, v150, v151
  v_exp_f32 v137, v137
  v_exp_f32 v138, v138
  v_mfma_f32_32x32x16_bf16 v[160:175], a[212:215], a[148:151], v[160:175]
  ds_read_b64_tr_b16 a[228:229], v25 offset:49152
  v_cvt_pk_bf16_f32 v228, v136, v137
  v_exp_f32 v139, v139
  v_exp_f32 v140, v140
  v_mfma_f32_32x32x16_bf16 v[176:191], a[212:215], a[180:183], v[176:191]
  ds_read_b64_tr_b16 a[230:231], v25 offset:51200
  v_cvt_pk_bf16_f32 v229, v138, v139
  v_exp_f32 v141, v141
  v_exp_f32 v142, v142
  s_waitcnt lgkmcnt(4)
  v_mfma_f32_32x32x16_bf16 v[160:175], a[216:219], a[152:155], v[160:175]
  ds_read_b64_tr_b16 a[232:233], v26 offset:49152
  v_cvt_pk_bf16_f32 v230, v140, v141
  v_exp_f32 v143, v143
  v_add_f32 v28, v28, v129
  v_mfma_f32_32x32x16_bf16 v[176:191], a[216:219], a[184:187], v[176:191]
  ds_read_b64_tr_b16 a[234:235], v26 offset:51200
  v_exp_f32 v152, v152
  v_cvt_pk_bf16_f32 v231, v142, v143
  v_exp_f32 v153, v153
  v_mfma_f32_32x32x16_bf16 v[160:175], a[220:223], a[156:159], v[160:175]
  ds_read_b64_tr_b16 a[236:237], v27 offset:49152
  v_exp_f32 v154, v154
  v_cvt_pk_bf16_f32 v236, v152, v153
  v_exp_f32 v155, v155
  v_mfma_f32_32x32x16_bf16 v[176:191], a[220:223], a[188:191], v[176:191]
  ds_read_b64_tr_b16 a[238:239], v27 offset:51200
  v_exp_f32 v156, v156
  v_cvt_pk_bf16_f32 v237, v154, v155
  v_exp_f32 v157, v157
  s_nop 0
  s_waitcnt lgkmcnt(4)
  v_mfma_f32_32x32x16_bf16 a[0:15], a[224:227], v[224:227], a[0:15]
  ds_read_b64_tr_b16 a[240:241], v24 offset:53248
  v_exp_f32 v158, v158
  v_cvt_pk_bf16_f32 v238, v156, v157
  v_add_f32 v28, v28, v130
  v_mfma_f32_32x32x16_bf16 a[16:31], a[224:227], v[232:235], a[16:31]
  ds_read_b64_tr_b16 a[242:243], v24 offset:55296
  v_exp_f32 v159, v159
  v_add_f32 v28, v28, v131
  v_add_f32 v28, v28, v132
  v_add_f32 v28, v28, v133
  v_mfma_f32_32x32x16_bf16 a[32:47], a[228:231], v[224:227], a[32:47]
  ds_read_b64_tr_b16 a[244:245], v25 offset:53248
  v_cvt_pk_bf16_f32 v239, v158, v159
  v_add_f32 v28, v28, v134
  v_add_f32 v28, v28, v135
  v_add_f32 v29, v29, v144
  v_add_f32 v29, v29, v145
  v_mfma_f32_32x32x16_bf16 a[48:63], a[228:231], v[232:235], a[48:63]
  ds_read_b64_tr_b16 a[246:247], v25 offset:55296
  v_add_f32 v29, v29, v146
  v_add_f32 v29, v29, v147
  v_add_f32 v29, v29, v148
  v_add_f32 v29, v29, v149
  v_max3_f32 v30, v160, v161, v162
  s_waitcnt lgkmcnt(4)
  v_mfma_f32_32x32x16_bf16 a[64:79], a[232:235], v[224:227], a[64:79]
  ds_read_b64_tr_b16 a[248:249], v26 offset:53248
  v_add_f32 v29, v29, v150
  v_max3_f32 v31, v176, v177, v178
  v_add_f32 v29, v29, v151
  v_max3_f32 v30, v30, v163, v164
  v_mfma_f32_32x32x16_bf16 a[80:95], a[232:235], v[232:235], a[80:95]
  ds_read_b64_tr_b16 a[250:251], v26 offset:55296
  v_add_f32 v28, v28, v136
  v_max3_f32 v31, v31, v179, v180
  v_add_f32 v28, v28, v137
  v_max3_f32 v30, v30, v165, v166
  v_add_f32 v28, v28, v138
  v_mfma_f32_32x32x16_bf16 a[96:111], a[236:239], v[224:227], a[96:111]
  ds_read_b64_tr_b16 a[252:253], v27 offset:53248
  v_max3_f32 v31, v31, v181, v182
  v_add_f32 v28, v28, v139
  v_max3_f32 v30, v30, v167, v168
  v_add_f32 v28, v28, v140
  v_max3_f32 v31, v31, v183, v184
  v_mfma_f32_32x32x16_bf16 a[112:127], a[236:239], v[232:235], a[112:127]
  ds_read_b64_tr_b16 a[254:255], v27 offset:55296
  v_add_f32 v28, v28, v141
  v_max3_f32 v30, v30, v169, v170
  v_add_f32 v28, v28, v142
  v_max3_f32 v31, v31, v185, v186
  v_add_f32 v28, v28, v143
  s_waitcnt lgkmcnt(4)
  v_mfma_f32_32x32x16_bf16 a[0:15], a[240:243], v[228:231], a[0:15]
  s_waitcnt vmcnt(8)
  s_barrier
  ds_read_b128 a[192:195], v16 offset:0
  v_max3_f32 v30, v30, v171, v172
  v_add_f32 v29, v29, v152
  s_add_u32 m0, s19, 98304
  v_mfma_f32_32x32x16_bf16 a[16:31], a[240:243], v[236:239], a[16:31]
  v_max3_f32 v31, v31, v187, v188
  v_add_f32 v29, v29, v153
  v_max3_f32 v30, v30, v173, v174
  buffer_load_dwordx4 v12, s[28:31], s43 offen offset:0 lds
  v_mfma_f32_32x32x16_bf16 a[32:47], a[244:247], v[228:231], a[32:47]
  ds_read_b128 a[196:199], v17 offset:0
  v_add_f32 v29, v29, v154
  v_max3_f32 v31, v31, v189, v190
  buffer_load_dwordx4 v13, s[28:31], s43 offen offset:1024 lds
  v_mfma_f32_32x32x16_bf16 a[48:63], a[244:247], v[236:239], a[48:63]
  v_add_f32 v29, v29, v155
  v_max_f32 v30, v30, v175
  v_add_f32 v29, v29, v156
  buffer_load_dwordx4 v14, s[28:31], s43 offen offset:2048 lds
  s_waitcnt lgkmcnt(2)
  v_mfma_f32_32x32x16_bf16 a[64:79], a[248:251], v[228:231], a[64:79]
  ds_read_b128 a[200:203], v18 offset:0
  v_max_f32 v31, v31, v191
  buffer_load_dwordx4 v15, s[28:31], s43 offen offset:3072 lds
  s_add_u32 s43, s43, 8192
  v_mfma_f32_32x32x16_bf16 a[80:95], a[248:251], v[236:239], a[80:95]
  v_add_f32 v29, v29, v157
  v_add_f32 v29, v29, v158
  v_add_f32 v29, v29, v159
  v_mfma_f32_32x32x16_bf16 a[96:111], a[252:255], v[228:231], a[96:111]
  ds_read_b128 a[204:207], v19 offset:0
  v_mfma_f32_32x32x16_bf16 a[112:127], a[252:255], v[236:239], a[112:127]
  v_max_f32 v32, v30, v31
  v_cmp_lt_f32 vcc, s50, v32
  s_cbranch_vccz L_mk2_norescale_35
  s_call_b64 s[48:49], L_q_rescale1
L_mk2_norescale_35:
  s_waitcnt lgkmcnt(2)
  v_mfma_f32_32x32x16_bf16 v[128:143], a[192:195], a[128:131], v[192:207]
  ds_read_b128 a[208:211], v20 offset:0
  v_exp_f32 v160, v160
  v_exp_f32 v161, v161
  v_mfma_f32_32x32x16_bf16 v[144:159], a[192:195], a[160:163], v[208:223]
  v_exp_f32 v162, v162
  v_cvt_pk_bf16_f32 v224, v160, v161
  v_exp_f32 v163, v163
  v_mfma_f32_32x32x16_bf16 v[128:143], a[196:199], a[132:135], v[128:143]
  ds_read_b128 a[212:215], v21 offset:0
  s_add_u32 m0, s19, 0
  v_exp_f32 v164, v164
  v_cvt_pk_bf16_f32 v225, v162, v163
  v_add_f32 v28, v28, v160
  v_mfma_f32_32x32x16_bf16 v[144:159], a[196:199], a[164:167], v[144:159]
  v_exp_f32 v165, v165
  v_exp_f32 v166, v166
  v_cvt_pk_bf16_f32 v226, v164, v165
  v_add_f32 v28, v28, v161
  s_waitcnt lgkmcnt(2)
  v_mfma_f32_32x32x16_bf16 v[128:143], a[200:203], a[136:139], v[128:143]
  ds_read_b128 a[216:219], v22 offset:0
  buffer_load_dwordx4 v48, s[4:7], s66 offen offset:0 lds
  v_add_f32 v28, v28, v162
  v_mfma_f32_32x32x16_bf16 v[144:159], a[200:203], a[168:171], v[144:159]
  v_exp_f32 v167, v167
  v_exp_f32 v176, v176
  v_cvt_pk_bf16_f32 v227, v166, v167
  v_add_f32 v28, v28, v163
  v_mfma_f32_32x32x16_bf16 v[128:143], a[204:207], a[140:143], v[128:143]
  ds_read_b128 a[220:223], v23 offset:0
  buffer_load_dwordx4 v49, s[4:7], s66 offen offset:1024 lds
  v_exp_f32 v177, v177
  v_mfma_f32_32x32x16_bf16 v[144:159], a[204:207], a[172:175], v[144:159]
  v_exp_f32 v178, v178
  v_cvt_pk_bf16_f32 v232, v176, v177
  v_exp_f32 v179, v179
  v_add_f32 v28, v28, v164
  s_waitcnt lgkmcnt(2)
  v_mfma_f32_32x32x16_bf16 v[128:143], a[208:211], a[144:147], v[128:143]
  ds_read_b64_tr_b16 a[224:225], v24 offset:0
  buffer_load_dwordx4 v50, s[4:7], s66 offen offset:2048 lds
  v_add_f32 v28, v28, v165
  v_mfma_f32_32x32x16_bf16 v[144:159], a[208:211], a[176:179], v[144:159]
  ds_read_b64_tr_b16 a[226:227], v24 offset:2048
  v_exp_f32 v180, v180
  v_cvt_pk_bf16_f32 v233, v178, v179
  v_exp_f32 v181, v181
  v_mfma_f32_32x32x16_bf16 v[128:143], a[212:215], a[148:151], v[128:143]
  ds_read_b64_tr_b16 a[228:229], v25 offset:0
  buffer_load_dwordx4 v51, s[4:7], s66 offen offset:3072 lds
  s_add_u32 s66, s66, 458752
  s_cmp_eq_u32 s66, 14680064
  s_cselect_b32 s66, 0, s66
  v_add_f32 v28, v28, v166
  v_mfma_f32_32x32x16_bf16 v[144:159], a[212:215], a[180:183], v[144:159]
  ds_read_b64_tr_b16 a[230:231], v25 offset:2048
  v_exp_f32 v182, v182
  v_cvt_pk_bf16_f32 v234, v180, v181
  v_exp_f32 v183, v183
  s_waitcnt lgkmcnt(4)
  v_mfma_f32_32x32x16_bf16 v[128:143], a[216:219], a[152:155], v[128:143]
  ds_read_b64_tr_b16 a[232:233], v26 offset:0
  s_add_u32 m0, s19, 16384
  v_exp_f32 v168, v168
  v_cvt_pk_bf16_f32 v235, v182, v183
  v_mfma_f32_32x32x16_bf16 v[144:159], a[216:219], a[184:187], v[144:159]
  ds_read_b64_tr_b16 a[234:235], v26 offset:2048
  v_exp_f32 v169, v169
  v_exp_f32 v170, v170
  v_cvt_pk_bf16_f32 v228, v168, v169
  v_mfma_f32_32x32x16_bf16 v[128:143], a[220:223], a[156:159], v[128:143]
  ds_read_b64_tr_b16 a[236:237], v27 offset:0
  buffer_load_dwordx4 v48, s[4:7], s66 offen offset:0 lds
  v_exp_f32 v171, v171
  v_mfma_f32_32x32x16_bf16 v[144:159], a[220:223], a[188:191], v[144:159]
  ds_read_b64_tr_b16 a[238:239], v27 offset:2048
  v_exp_f32 v172, v172
  v_cvt_pk_bf16_f32 v229, v170, v171
  v_exp_f32 v173, v173
  s_nop 0
  s_waitcnt lgkmcnt(4)
  v_mfma_f32_32x32x16_bf16 a[0:15], a[224:227], v[224:227], a[0:15]
  ds_read_b64_tr_b16 a[240:241], v24 offset:4096
  buffer_load_dwordx4 v49, s[4:7], s66 offen offset:1024 lds
  v_add_f32 v28, v28, v167
  v_mfma_f32_32x32x16_bf16 a[16:31], a[224:227], v[232:235], a[16:31]
  ds_read_b64_tr_b16 a[242:243], v24 offset:6144
  v_exp_f32 v174, v174
  v_cvt_pk_bf16_f32 v230, v172, v173
  v_exp_f32 v175, v175
  v_mfma_f32_32x32x16_bf16 a[32:47], a[228:231], v[224:227], a[32:47]
  ds_read_b64_tr_b16 a[244:245], v25 offset:4096
  buffer_load_dwordx4 v50, s[4:7], s66 offen offset:2048 lds
  v_exp_f32 v184, v184
  v_mfma_f32_32x32x16_bf16 a[48:63], a[228:231], v[232:235], a[48:63]
  ds_read_b64_tr_b16 a[246:247], v25 offset:6144
  v_cvt_pk_bf16_f32 v231, v174, v175
  v_exp_f32 v185, v185
  v_exp_f32 v186, v186
  s_waitcnt lgkmcnt(4)
  v_mfma_f32_32x32x16_bf16 a[64:79], a[232:235], v[224:227], a[64:79]
  ds_read_b64_tr_b16 a[248:249], v26 offset:4096
  buffer_load_dwordx4 v51, s[4:7], s66 offen offset:3072 lds
  s_add_u32 s66, s66, 458752
  s_cmp_eq_u32 s66, 14680064
  s_cselect_b32 s66, 0, s66
  v_mfma_f32_32x32x16_bf16 a[80:95], a[232:235], v[232:235], a[80:95]
  ds_read_b64_tr_b16 a[250:251], v26 offset:6144
  v_cvt_pk_bf16_f32 v236, v184, v185
  v_exp_f32 v187, v187
  v_exp_f32 v188, v188
  v_mfma_f32_32x32x16_bf16 a[96:111], a[236:239], v[224:227], a[96:111]
  ds_read_b64_tr_b16 a[252:253], v27 offset:4096
  v_cvt_pk_bf16_f32 v237, v186, v187
  v_exp_f32 v189, v189
  v_exp_f32 v190, v190
  v_mfma_f32_32x32x16_bf16 a[112:127], a[236:239], v[232:235], a[112:127]
  ds_read_b64_tr_b16 a[254:255], v27 offset:6144
  v_cvt_pk_bf16_f32 v238, v188, v189
  v_exp_f32 v191, v191
  v_add_f32 v29, v29, v176
  v_cvt_pk_bf16_f32 v239, v190, v191
  v_add_f32 v29, v29, v177
  s_nop 0
  s_waitcnt lgkmcnt(4)
  v_mfma_f32_32x32x16_bf16 a[0:15], a[240:243], v[228:231], a[0:15]
  s_waitcnt vmcnt(16)
  s_barrier
  ds_read_b128 a[192:195], v16 offset:16384
  v_add_f32 v29, v29, v178
  v_add_f32 v29, v29, v179
  s_add_u32 m0, s19, 114688
  v_mfma_f32_32x32x16_bf16 a[16:31], a[240:243], v[236:239], a[16:31]
  v_add_f32 v29, v29, v180
  v_add_f32 v29, v29, v181
  v_max3_f32 v30, v128, v129, v130
  buffer_load_dwordx4 v12, s[28:31], s43 offen offset:0 lds
  v_mfma_f32_32x32x16_bf16 a[32:47], a[244:247], v[228:231], a[32:47]
  ds_read_b128 a[196:199], v17 offset:16384
  v_add_f32 v29, v29, v182
  v_max3_f32 v31, v144, v145, v146
  buffer_load_dwordx4 v13, s[28:31], s43 offen offset:1024 lds
  v_mfma_f32_32x32x16_bf16 a[48:63], a[244:247], v[236:239], a[48:63]
  v_add_f32 v29, v29, v183
  v_max3_f32 v30, v30, v131, v132
  v_add_f32 v28, v28, v168
  buffer_load_dwordx4 v14, s[28:31], s43 offen offset:2048 lds
  s_waitcnt lgkmcnt(2)
  v_mfma_f32_32x32x16_bf16 a[64:79], a[248:251], v[228:231], a[64:79]
  ds_read_b128 a[200:203], v18 offset:16384
  v_max3_f32 v31, v31, v147, v148
  buffer_load_dwordx4 v15, s[28:31], s43 offen offset:3072 lds
  s_add_u32 s43, s43, 8192
  v_mfma_f32_32x32x16_bf16 a[80:95], a[248:251], v[236:239], a[80:95]
  v_add_f32 v28, v28, v169
  v_max3_f32 v30, v30, v133, v134
  v_add_f32 v28, v28, v170
  v_max3_f32 v31, v31, v149, v150
  v_add_f32 v28, v28, v171
  v_max3_f32 v30, v30, v135, v136
  v_mfma_f32_32x32x16_bf16 a[96:111], a[252:255], v[228:231], a[96:111]
  ds_read_b128 a[204:207], v19 offset:16384
  v_add_f32 v28, v28, v172
  v_max3_f32 v31, v31, v151, v152
  v_add_f32 v28, v28, v173
  v_max3_f32 v30, v30, v137, v138
  v_add_f32 v28, v28, v174
  v_mfma_f32_32x32x16_bf16 a[112:127], a[252:255], v[236:239], a[112:127]
  v_max3_f32 v31, v31, v153, v154
  v_add_f32 v28, v28, v175
  v_max3_f32 v30, v30, v139, v140
  v_add_f32 v29, v29, v184
  v_max3_f32 v31, v31, v155, v156
  v_add_f32 v29, v29, v185
  v_max3_f32 v30, v30, v141, v142
  v_add_f32 v29, v29, v186
  v_max3_f32 v31, v31, v157, v158
  v_add_f32 v29, v29, v187
  v_max_f32 v30, v30, v143
  v_add_f32 v29, v29, v188
  v_max_f32 v31, v31, v159
  v_add_f32 v29, v29, v189
  v_max_f32 v32, v30, v31
  v_add_f32 v29, v29, v190
  v_cmp_lt_f32 vcc, s50, v32
  v_add_f32 v29, v29, v191
  s_cbranch_vccz L_mk2_norescale_36
  s_call_b64 s[48:49], L_q_rescale0
L_mk2_norescale_36:
  s_waitcnt lgkmcnt(2)
  v_mfma_f32_32x32x16_bf16 v[160:175], a[192:195], a[128:131], v[192:207]
  ds_read_b128 a[208:211], v20 offset:16384
  v_exp_f32 v128, v128
  v_exp_f32 v129, v129
  v_mfma_f32_32x32x16_bf16 v[176:191], a[192:195], a[160:163], v[208:223]
  v_exp_f32 v130, v130
  v_cvt_pk_bf16_f32 v224, v128, v129
  v_exp_f32 v131, v131
  v_mfma_f32_32x32x16_bf16 v[160:175], a[196:199], a[132:135], v[160:175]
  ds_read_b128 a[212:215], v21 offset:16384
  s_add_u32 m0, s19, 32768
  v_exp_f32 v132, v132
  v_cvt_pk_bf16_f32 v225, v130, v131
  v_add_f32 v28, v28, v128
  v_mfma_f32_32x32x16_bf16 v[176:191], a[196:199], a[164:167], v[176:191]
  v_exp_f32 v133, v133
  v_exp_f32 v134, v134
  v_cvt_pk_bf16_f32 v226, v132, v133
  v_add_f32 v28, v28, v129
  s_waitcnt lgkmcnt(2)
  v_mfma_f32_32x32x16_bf16 v[160:175], a[200:203], a[136:139], v[160:175]
  ds_read_b128 a[216:219], v22 offset:16384
  buffer_load_dwordx4 v48, s[4:7], s66 offen offset:0 lds
  v_add_f32 v28, v28, v130
  v_mfma_f32_32x32x16_bf16 v[176:191], a[200:203], a[168:171], v[176:191]
  v_exp_f32 v135, v135
  v_exp_f32 v144, v144
  v_cvt_pk_bf16_f32 v227, v134, v135
  v_add_f32 v28, v28, v131
  v_mfma_f32_32x32x16_bf16 v[160:175], a[204:207], a[140:143], v[160:175]
  ds_read_b128 a[220:223], v23 offset:16384
  buffer_load_dwordx4 v49, s[4:7], s66 offen offset:1024 lds
  v_exp_f32 v145, v145
  v_mfma_f32_32x32x16_bf16 v[176:191], a[204:207], a[172:175], v[176:191]
  v_exp_f32 v146, v146
  v_cvt_pk_bf16_f32 v232, v144, v145
  v_exp_f32 v147, v147
  v_add_f32 v28, v28, v132
  s_waitcnt lgkmcnt(2)
  v_mfma_f32_32x32x16_bf16 v[160:175], a[208:211], a[144:147], v[160:175]
  ds_read_b64_tr_b16 a[224:225], v24 offset:16384
  buffer_load_dwordx4 v50, s[4:7], s66 offen offset:2048 lds
  v_add_f32 v28, v28, v133
  v_mfma_f32_32x32x16_bf16 v[176:191], a[208:211], a[176:179], v[176:191]
  ds_read_b64_tr_b16 a[226:227], v24 offset:18432
  v_exp_f32 v148, v148
  v_cvt_pk_bf16_f32 v233, v146, v147
  v_exp_f32 v149, v149
  v_mfma_f32_32x32x16_bf16 v[160:175], a[212:215], a[148:151], v[160:175]
  ds_read_b64_tr_b16 a[228:229], v25 offset:16384
  buffer_load_dwordx4 v51, s[4:7], s66 offen offset:3072 lds
  s_add_u32 s66, s66, 458752
  s_cmp_eq_u32 s66, 14680064
  s_cselect_b32 s66, 0, s66
  v_add_f32 v28, v28, v134
  v_mfma_f32_32x32x16_bf16 v[176:191], a[212:215], a[180:183], v[176:191]
  ds_read_b64_tr_b16 a[230:231], v25 offset:18432
  v_exp_f32 v150, v150
  v_cvt_pk_bf16_f32 v234, v148, v149
  v_exp_f32 v151, v151
  s_waitcnt lgkmcnt(4)
  v_mfma_f32_32x32x16_bf16 v[160:175], a[216:219], a[152:155], v[160:175]
  ds_read_b64_tr_b16 a[232:233], v26 offset:16384
  s_add_u32 m0, s19, 49152
  v_exp_f32 v136, v136
  v_cvt_pk_bf16_f32 v235, v150, v151
  v_mfma_f32_32x32x16_bf16 v[176:191], a[216:219], a[184:187], v[176:191]
  ds_read_b64_tr_b16 a[234:235], v26 offset:18432
  v_exp_f32 v137, v137
  v_exp_f32 v138, v138
  v_cvt_pk_bf16_f32 v228, v136, v137
  v_mfma_f32_32x32x16_bf16 v[160:175], a[220:223], a[156:159], v[160:175]
  ds_read_b64_tr_b16 a[236:237], v27 offset:16384
  buffer_load_dwordx4 v48, s[4:7], s66 offen offset:0 lds
  v_exp_f32 v139, v139
  v_mfma_f32_32x32x16_bf16 v[176:191], a[220:223], a[188:191], v[176:191]
  ds_read_b64_tr_b16 a[238:239], v27 offset:18432
  v_exp_f32 v140, v140
  v_cvt_pk_bf16_f32 v229, v138, v139
  v_exp_f32 v141, v141
  s_nop 0
  s_waitcnt lgkmcnt(4)
  v_mfma_f32_32x32x16_bf16 a[0:15], a[224:227], v[224:227], a[0:15]
  ds_read_b64_tr_b16 a[240:241], v24 offset:20480
  buffer_load_dwordx4 v49, s[4:7], s66 offen offset:1024 lds
  v_add_f32 v28, v28, v135
  v_mfma_f32_32x32x16_bf16 a[16:31], a[224:227], v[232:235], a[16:31]
  ds_read_b64_tr_b16 a[242:243], v24 offset:22528
  v_exp_f32 v142, v142
  v_cvt_pk_bf16_f32 v230, v140, v141
  v_exp_f32 v143, v143
  v_mfma_f32_32x32x16_bf16 a[32:47], a[228:231], v[224:227], a[32:47]
  ds_read_b64_tr_b16 a[244:245], v25 offset:20480
  buffer_load_dwordx4 v50, s[4:7], s66 offen offset:2048 lds
  v_exp_f32 v152, v152
  v_mfma_f32_32x32x16_bf16 a[48:63], a[228:231], v[232:235], a[48:63]
  ds_read_b64_tr_b16 a[246:247], v25 offset:22528
  v_cvt_pk_bf16_f32 v231, v142, v143
  v_exp_f32 v153, v153
  v_exp_f32 v154, v154
  s_waitcnt lgkmcnt(4)
  v_mfma_f32_32x32x16_bf16 a[64:79], a[232:235], v[224:227], a[64:79]
  ds_read_b64_tr_b16 a[248:249], v26 offset:20480
  buffer_load_dwordx4 v51, s[4:7], s66 offen offset:3072 lds
  s_add_u32 s66, s66, 458752
  s_cmp_eq_u32 s66, 14680064
  s_cselect_b32 s66, 0, s66
  v_mfma_f32_32x32x16_bf16 a[80:95], a[232:235], v[232:235], a[80:95]
  ds_read_b64_tr_b16 a[250:251], v26 offset:22528
  v_cvt_pk_bf16_f32 v236, v152, v153
  v_exp_f32 v155, v155
  v_exp_f32 v156, v156
  v_mfma_f32_32x32x16_bf16 a[96:111], a[236:239], v[224:227], a[96:111]
  ds_read_b64_tr_b16 a[252:253], v27 offset:20480
  v_cvt_pk_bf16_f32 v237, v154, v155
  v_exp_f32 v157, v157
  v_exp_f32 v158, v158
  v_mfma_f32_32x32x16_bf16 a[112:127], a[236:239], v[232:235], a[112:127]
  ds_read_b64_tr_b16 a[254:255], v27 offset:22528
  v_cvt_pk_bf16_f32 v238, v156, v157
  v_exp_f32 v159, v159
  v_add_f32 v29, v29, v144
  v_cvt_pk_bf16_f32 v239, v158, v159
  v_add_f32 v29, v29, v145
  s_nop 0
  s_waitcnt lgkmcnt(4)
  v_mfma_f32_32x32x16_bf16 a[0:15], a[240:243], v[228:231], a[0:15]
  s_waitcnt vmcnt(20)
  s_barrier
  ds_read_b128 a[192:195], v16 offset:32768
  v_add_f32 v29, v29, v146
  v_add_f32 v29, v29, v147
  s_add_u32 m0, s19, 65536
  v_mfma_f32_32x32x16_bf16 a[16:31], a[240:243], v[236:239], a[16:31]
  v_add_f32 v29, v29, v148
  v_add_f32 v29, v29, v149
  v_max3_f32 v30, v160, v161, v162
  buffer_load_dwordx4 v12, s[28:31], s43 offen offset:0 lds
  v_mfma_f32_32x32x16_bf16 a[32:47], a[244:247], v[228:231], a[32:47]
  ds_read_b128 a[196:199], v17 offset:32768
  v_add_f32 v29, v29, v150
  v_max3_f32 v31, v176, v177, v178
  buffer_load_dwordx4 v13, s[28:31], s43 offen offset:1024 lds
  v_mfma_f32_32x32x16_bf16 a[48:63], a[244:247], v[236:239], a[48:63]
  v_add_f32 v29, v29, v151
  v_max3_f32 v30, v30, v163, v164
  v_add_f32 v28, v28, v136
  buffer_load_dwordx4 v14, s[28:31], s43 offen offset:2048 lds
  s_waitcnt lgkmcnt(2)
  v_mfma_f32_32x32x16_bf16 a[64:79], a[248:251], v[228:231], a[64:79]
  ds_read_b128 a[200:203], v18 offset:32768
  v_max3_f32 v31, v31, v179, v180
  buffer_load_dwordx4 v15, s[28:31], s43 offen offset:3072 lds
  s_add_u32 s43, s43, 8192
  v_mfma_f32_32x32x16_bf16 a[80:95], a[248:251], v[236:239], a[80:95]
  v_add_f32 v28, v28, v137
  v_max3_f32 v30, v30, v165, v166
  v_add_f32 v28, v28, v138
  v_max3_f32 v31, v31, v181, v182
  v_add_f32 v28, v28, v139
  v_max3_f32 v30, v30, v167, v168
  v_mfma_f32_32x32x16_bf16 a[96:111], a[252:255], v[228:231], a[96:111]
  ds_read_b128 a[204:207], v19 offset:32768
  v_add_f32 v28, v28, v140
  v_max3_f32 v31, v31, v183, v184
  v_add_f32 v28, v28, v141
  v_max3_f32 v30, v30, v169, v170
  v_add_f32 v28, v28, v142
  v_mfma_f32_32x32x16_bf16 a[112:127], a[252:255], v[236:239], a[112:127]
  v_max3_f32 v31, v31, v185, v186
  v_add_f32 v28, v28, v143
  v_max3_f32 v30, v30, v171, v172
  v_add_f32 v29, v29, v152
  v_max3_f32 v31, v31, v187, v188
  v_add_f32 v29, v29, v153
  v_max3_f32 v30, v30, v173, v174
  v_add_f32 v29, v29, v154
  v_max3_f32 v31, v31, v189, v190
  v_add_f32 v29, v29, v155
  v_max_f32 v30, v30, v175
  v_add_f32 v29, v29, v156
  v_max_f32 v31, v31, v191
  v_add_f32 v29, v29, v157
  v_max_f32 v32, v30, v31
  v_add_f32 v29, v29, v158
  v_cmp_lt_f32 vcc, s50, v32
  v_add_f32 v29, v29, v159
  s_cbranch_vccz L_mk2_norescale_37
  s_call_b64 s[48:49], L_q_rescale1
L_mk2_norescale_37:
  s_waitcnt lgkmcnt(2)
  v_mfma_f32_32x32x16_bf16 v[128:143], a[192:195], a[128:131], v[192:207]
  ds_read_b128 a[208:211], v20 offset:32768
  v_exp_f32 v160, v160
  v_exp_f32 v161, v161
  v_mfma_f32_32x32x16_bf16 v[144:159], a[192:195], a[160:163], v[208:223]
  v_exp_f32 v162, v162
  v_cvt_pk_bf16_f32 v224, v160, v161
  v_exp_f32 v163, v163
  v_mfma_f32_32x32x16_bf16 v[128:143], a[196:199], a[132:135], v[128:143]
  ds_read_b128 a[212:215], v21 offset:32768
  v_exp_f32 v164, v164
  v_cvt_pk_bf16_f32 v225, v162, v163
  v_exp_f32 v165, v165
  v_mfma_f32_32x32x16_bf16 v[144:159], a[196:199], a[164:167], v[144:159]
  v_exp_f32 v166, v166
  v_cvt_pk_bf16_f32 v226, v164, v165
  v_exp_f32 v167, v167
  v_add_f32 v28, v28, v160
  s_waitcnt lgkmcnt(2)
  v_mfma_f32_32x32x16_bf16 v[128:143], a[200:203], a[136:139], v[128:143]
  ds_read_b128 a[216:219], v22 offset:32768
  v_xor_b32 v52, s42, v52
  v_xor_b32 v53, s42, v53
  v_xor_b32 v54, s42, v54
  v_xor_b32 v55, s42, v55
  v_or3_b32 v52, v52, v53, v54
  v_or_b32 v52, v52, v55
  v_cmp_ne_u32 vcc, 0, v52
  s_cbranch_vccz L_mk2_fok_38
  s_call_b64 s[48:49], L_poll4
L_mk2_fok_38:
  v_exp_f32 v176, v176
  v_cvt_pk_bf16_f32 v227, v166, v167
  v_mfma_f32_32x32x16_bf16 v[144:159], a[200:203], a[168:171], v[144:159]
  v_exp_f32 v177, v177
  v_exp_f32 v178, v178
  v_cvt_pk_bf16_f32 v232, v176, v177
  v_add_f32 v28, v28, v161
  v_mfma_f32_32x32x16_bf16 v[128:143], a[204:207], a[140:143], v[128:143]
  ds_read_b128 a[220:223], v23 offset:32768
  v_exp_f32 v179, v179
  v_exp_f32 v180, v180
  v_cvt_pk_bf16_f32 v233, v178, v179
  v_mfma_f32_32x32x16_bf16 v[144:159], a[204:207], a[172:175], v[144:159]
  v_exp_f32 v181, v181
  v_exp_f32 v182, v182
  v_cvt_pk_bf16_f32 v234, v180, v181
  v_add_f32 v28, v28, v162
  s_waitcnt lgkmcnt(2)
  v_mfma_f32_32x32x16_bf16 v[128:143], a[208:211], a[144:147], v[128:143]
  ds_read_b64_tr_b16 a[224:225], v24 offset:32768
  v_exp_f32 v183, v183
  v_exp_f32 v168, v168
  v_mfma_f32_32x32x16_bf16 v[144:159], a[208:211], a[176:179], v[144:159]
  ds_read_b64_tr_b16 a[226:227], v24 offset:34816
  v_cvt_pk_bf16_f32 v235, v182, v183
  v_exp_f32 v169, v169
  v_exp_f32 v170, v170
  v_mfma_f32_32x32x16_bf16 v[128:143], a[212:215], a[148:151], v[128:143]
  ds_read_b64_tr_b16 a[228:229], v25 offset:32768
  v_cvt_pk_bf16_f32 v228, v168, v169
  v_exp_f32 v171, v171
  v_exp_f32 v172, v172
  v_mfma_f32_32x32x16_bf16 v[144:159], a[212:215], a[180:183], v[144:159]
  ds_read_b64_tr_b16 a[230:231], v25 offset:34816
  v_cvt_pk_bf16_f32 v229, v170, v171
  v_exp_f32 v173, v173
  v_exp_f32 v174, v174
  s_waitcnt lgkmcnt(4)
  v_mfma_f32_32x32x16_bf16 v[128:143], a[216:219], a[152:155], v[128:143]
  ds_read_b64_tr_b16 a[232:233], v26 offset:32768
  v_cvt_pk_bf16_f32 v230, v172, v173
  v_exp_f32 v175, v175
  v_add_f32 v28, v28, v163
  v_mfma_f32_32x32x16_bf16 v[144:159], a[216:219], a[184:187], v[144:159]
  ds_read_b64_tr_b16 a[234:235], v26 offset:34816
  v_exp_f32 v184, v184
  v_cvt_pk_bf16_f32 v231, v174, v175
  v_exp_f32 v185, v185
  v_mfma_f32_32x32x16_bf16 v[128:143], a[220:223], a[156:159], v[128:143]
  ds_read_b64_tr_b16 a[236:237], v27 offset:32768
  v_exp_f32 v186, v186
  v_cvt_pk_bf16_f32 v236, v184, v185
  v_exp_f32 v187, v187
  v_mfma_f32_32x32x16_bf16 v[144:159], a[220:223], a[188:191], v[144:159]
  ds_read_b64_tr_b16 a[238:239], v27 offset:34816
  v_exp_f32 v188, v188
  v_cvt_pk_bf16_f32 v237, v186, v187
  v_exp_f32 v189, v189
  s_nop 0
  s_waitcnt lgkmcnt(4)
  v_mfma_f32_32x32x16_bf16 a[0:15], a[224:227], v[224:227], a[0:15]
  ds_read_b64_tr_b16 a[240:241], v24 offset:36864
  v_exp_f32 v190, v190
  v_cvt_pk_bf16_f32 v238, v188, v189
  v_add_f32 v28, v28, v164
  v_mfma_f32_32x32x16_bf16 a[16:31], a[224:227], v[232:235], a[16:31]
  ds_read_b64_tr_b16 a[242:243], v24 offset:38912
  v_exp_f32 v191, v191
  v_add_f32 v28, v28, v165
  v_add_f32 v28, v28, v166
  v_add_f32 v28, v28, v167
  v_mfma_f32_32x32x16_bf16 a[32:47], a[228:231], v[224:227], a[32:47]
  ds_read_b64_tr_b16 a[244:245], v25 offset:36864
  v_cvt_pk_bf16_f32 v239, v190, v191
  v_add_f32 v29, v29, v176
  v_add_f32 v29, v29, v177
  v_add_f32 v29, v29, v178
  v_add_f32 v29, v29, v179
  v_mfma_f32_32x32x16_bf16 a[48:63], a[228:231], v[232:235], a[48:63]
  ds_read_b64_tr_b16 a[246:247], v25 offset:38912
  v_add_f32 v29, v29, v180
  v_add_f32 v29, v29, v181
  v_max3_f32 v30, v128, v129, v130
  v_add_f32 v29, v29, v182
  v_max3_f32 v31, v144, v145, v146
  s_waitcnt lgkmcnt(4)
  v_mfma_f32_32x32x16_bf16 a[64:79], a[232:235], v[224:227], a[64:79]
  ds_read_b64_tr_b16 a[248:249], v26 offset:36864
  v_add_f32 v29, v29, v183
  v_max3_f32 v30, v30, v131, v132
  v_add_f32 v28, v28, v168
  v_max3_f32 v31, v31, v147, v148
  v_mfma_f32_32x32x16_bf16 a[80:95], a[232:235], v[232:235], a[80:95]
  ds_read_b64_tr_b16 a[250:251], v26 offset:38912
  v_add_f32 v28, v28, v169
  v_max3_f32 v30, v30, v133, v134
  v_add_f32 v28, v28, v170
  v_max3_f32 v31, v31, v149, v150
  v_add_f32 v28, v28, v171
  v_mfma_f32_32x32x16_bf16 a[96:111], a[236:239], v[224:227], a[96:111]
  ds_read_b64_tr_b16 a[252:253], v27 offset:36864
  v_max3_f32 v30, v30, v135, v136
  v_add_f32 v28, v28, v172
  v_max3_f32 v31, v31, v151, v152
  v_add_f32 v28, v28, v173
  v_max3_f32 v30, v30, v137, v138
  v_mfma_f32_32x32x16_bf16 a[112:127], a[236:239], v[232:235], a[112:127]
  ds_read_b64_tr_b16 a[254:255], v27 offset:38912
  v_add_f32 v28, v28, v174
  v_max3_f32 v31, v31, v153, v154
  v_add_f32 v28, v28, v175
  v_max3_f32 v30, v30, v139, v140
  v_add_f32 v29, v29, v184
  s_waitcnt lgkmcnt(4)
  v_mfma_f32_32x32x16_bf16 a[0:15], a[240:243], v[228:231], a[0:15]
  s_waitcnt vmcnt(12)
  s_barrier
  ds_read_b128 a[192:195], v16 offset:49152
  v_max3_f32 v31, v31, v155, v156
  v_add_f32 v29, v29, v185
  v_max3_f32 v30, v30, v141, v142
  v_add_f32 v29, v29, v186
  v_mfma_f32_32x32x16_bf16 a[16:31], a[240:243], v[236:239], a[16:31]
  v_max3_f32 v31, v31, v157, v158
  v_add_f32 v29, v29, v187
  v_max_f32 v30, v30, v143
  v_add_f32 v29, v29, v188
  v_max_f32 v31, v31, v159
  v_add_f32 v29, v29, v189
  v_mfma_f32_32x32x16_bf16 a[32:47], a[244:247], v[228:231], a[32:47]
  ds_read_b128 a[196:199], v17 offset:49152
  v_add_f32 v29, v29, v190
  v_add_f32 v29, v29, v191
  v_mfma_f32_32x32x16_bf16 a[48:63], a[244:247], v[236:239], a[48:63]
  s_waitcnt lgkmcnt(2)
  v_mfma_f32_32x32x16_bf16 a[64:79], a[248:251], v[228:231], a[64:79]
  ds_read_b128 a[200:203], v18 offset:49152
  v_mfma_f32_32x32x16_bf16 a[80:95], a[248:251], v[236:239], a[80:95]
  v_mfma_f32_32x32x16_bf16 a[96:111], a[252:255], v[228:231], a[96:111]
  ds_read_b128 a[204:207], v19 offset:49152
  v_mfma_f32_32x32x16_bf16 a[112:127], a[252:255], v[236:239], a[112:127]
  v_max_f32 v32, v30, v31
  v_cmp_lt_f32 vcc, s50, v32
  s_cbranch_vccz L_mk2_norescale_39
  s_call_b64 s[48:49], L_q_rescale0
L_mk2_norescale_39:
  s_waitcnt lgkmcnt(2)
  v_mfma_f32_32x32x16_bf16 v[160:175], a[192:195], a[128:131], v[192:207]
  ds_read_b128 a[208:211], v20 offset:49152
  v_exp_f32 v128, v128
  v_exp_f32 v129, v129
  v_mfma_f32_32x32x16_bf16 v[176:191], a[192:195], a[160:163], v[208:223]
  v_exp_f32 v130, v130
  v_cvt_pk_bf16_f32 v224, v128, v129
  v_exp_f32 v131, v131
  v_mfma_f32_32x32x16_bf16 v[160:175], a[196:199], a[132:135], v[160:175]
  ds_read_b128 a[212:215], v21 offset:49152
  v_exp_f32 v132, v132
  v_cvt_pk_bf16_f32 v225, v130, v131
  v_exp_f32 v133, v133
  v_mfma_f32_32x32x16_bf16 v[176:191], a[196:199], a[164:167], v[176:191]
  v_exp_f32 v134, v134
  v_cvt_pk_bf16_f32 v226, v132, v133
  v_exp_f32 v135, v135
  v_add_f32 v28, v28, v128
  s_waitcnt lgkmcnt(2)
  v_mfma_f32_32x32x16_bf16 v[160:175], a[200:203], a[136:139], v[160:175]
  ds_read_b128 a[216:219], v22 offset:49152
  v_exp_f32 v144, v144
  v_cvt_pk_bf16_f32 v227, v134, v135
  v_add_f32 v28, v28, v129
  v_mfma_f32_32x32x16_bf16 v[176:191], a[200:203], a[168:171], v[176:191]
  v_exp_f32 v145, v145
  v_exp_f32 v146, v146
  v_cvt_pk_bf16_f32 v232, v144, v145
  v_add_f32 v28, v28, v130
  v_mfma_f32_32x32x16_bf16 v[160:175], a[204:207], a[140:143], v[160:175]
  ds_read_b128 a[220:223], v23 offset:49152
  v_exp_f32 v147, v147
  v_exp_f32 v148, v148
  v_cvt_pk_bf16_f32 v233, v146, v147
  v_mfma_f32_32x32x16_bf16 v[176:191], a[204:207], a[172:175], v[176:191]
  v_exp_f32 v149, v149
  v_exp_f32 v150, v150
  v_cvt_pk_bf16_f32 v234, v148, v149
  v_add_f32 v28, v28, v131
  s_waitcnt lgkmcnt(2)
  v_mfma_f32_32x32x16_bf16 v[160:175], a[208:211], a[144:147], v[160:175]
  ds_read_b64_tr_b16 a[224:225], v24 offset:49152
  v_exp_f32 v151, v151
  v_exp_f32 v136, v136
  v_mfma_f32_32x32x16_bf16 v[176:191], a[208:211], a[176:179], v[176:191]
  ds_read_b64_tr_b16 a[226:227], v24 offset:51200
  v_cvt_pk_bf16_f32 v235, v150, v151
  v_exp_f32 v137, v137
  v_exp_f32 v138, v138
  v_mfma_f32_32x32x16_bf16 v[160:175], a[212:215], a[148:151], v[160:175]
  ds_read_b64_tr_b16 a[228:229], v25 offset:49152
  v_cvt_pk_bf16_f32 v228, v136, v137
  v_exp_f32 v139, v139
  v_exp_f32 v140, v140
  v_mfma_f32_32x32x16_bf16 v[176:191], a[212:215], a[180:183], v[176:191]
  ds_read_b64_tr_b16 a[230:231], v25 offset:51200
  v_cvt_pk_bf16_f32 v229, v138, v139
  v_exp_f32 v141, v141
  v_exp_f32 v142, v142
  s_waitcnt lgkmcnt(4)
  v_mfma_f32_32x32x16_bf16 v[160:175], a[216:219], a[152:155], v[160:175]
  ds_read_b64_tr_b16 a[232:233], v26 offset:49152
  v_cvt_pk_bf16_f32 v230, v140, v141
  v_exp_f32 v143, v143
  v_add_f32 v28, v28, v132
  v_mfma_f32_32x32x16_bf16 v[176:191], a[216:219], a[184:187], v[176:191]
  ds_read_b64_tr_b16 a[234:235], v26 offset:51200
  v_exp_f32 v152, v152
  v_cvt_pk_bf16_f32 v231, v142, v143
  v_exp_f32 v153, v153
  v_mfma_f32_32x32x16_bf16 v[160:175], a[220:223], a[156:159], v[160:175]
  ds_read_b64_tr_b16 a[236:237], v27 offset:49152
  v_exp_f32 v154, v154
  v_cvt_pk_bf16_f32 v236, v152, v153
  v_exp_f32 v155, v155
  v_mfma_f32_32x32x16_bf16 v[176:191], a[220:223], a[188:191], v[176:191]
  ds_read_b64_tr_b16 a[238:239], v27 offset:51200
  v_exp_f32 v156, v156
  v_cvt_pk_bf16_f32 v237, v154, v155
  v_exp_f32 v157, v157
  s_nop 0
  s_waitcnt lgkmcnt(4)
  v_mfma_f32_32x32x16_bf16 a[0:15], a[224:227], v[224:227], a[0:15]
  ds_read_b64_tr_b16 a[240:241], v24 offset:53248
  buffer_load_dwordx4 a[128:131], v3, s[44:47], s67 offen offset:0 sc1
  v_add_f32 v28, v28, v133
  v_mfma_f32_32x32x16_bf16 a[16:31], a[224:227], v[232:235], a[16:31]
  ds_read_b64_tr_b16 a[242:243], v24 offset:55296
  v_exp_f32 v158, v158
  v_cvt_pk_bf16_f32 v238, v156, v157
  v_exp_f32 v159, v159
  v_mfma_f32_32x32x16_bf16 a[32:47], a[228:231], v[224:227], a[32:47]
  ds_read_b64_tr_b16 a[244:245], v25 offset:53248
  buffer_load_dwordx4 a[132:135], v3, s[44:47], s67 offen offset:1024 sc1
  v_cvt_pk_bf16_f32 v239, v158, v159
  v_mfma_f32_32x32x16_bf16 a[48:63], a[228:231], v[232:235], a[48:63]
  ds_read_b64_tr_b16 a[246:247], v25 offset:55296
  v_add_f32 v28, v28, v134
  v_add_f32 v28, v28, v135
  v_add_f32 v29, v29, v144
  v_add_f32 v29, v29, v145
  v_add_f32 v29, v29, v146
  s_waitcnt lgkmcnt(4)
  v_mfma_f32_32x32x16_bf16 a[64:79], a[232:235], v[224:227], a[64:79]
  ds_read_b64_tr_b16 a[248:249], v26 offset:53248
  v_add_f32 v29, v29, v147
  v_add_f32 v29, v29, v148
  v_add_f32 v29, v29, v149
  v_max3_f32 v30, v160, v161, v162
  v_mfma_f32_32x32x16_bf16 a[80:95], a[232:235], v[232:235], a[80:95]
  ds_read_b64_tr_b16 a[250:251], v26 offset:55296
  buffer_load_dwordx4 a[136:139], v3, s[44:47], s67 offen offset:2048 sc1
  v_add_f32 v29, v29, v150
  v_max3_f32 v31, v176, v177, v178
  v_mfma_f32_32x32x16_bf16 a[96:111], a[236:239], v[224:227], a[96:111]
  ds_read_b64_tr_b16 a[252:253], v27 offset:53248
  v_add_f32 v29, v29, v151
  v_max3_f32 v30, v30, v163, v164
  v_add_f32 v28, v28, v136
  v_max3_f32 v31, v31, v179, v180
  v_add_f32 v28, v28, v137
  v_mfma_f32_32x32x16_bf16 a[112:127], a[236:239], v[232:235], a[112:127]
  ds_read_b64_tr_b16 a[254:255], v27 offset:55296
  v_max3_f32 v30, v30, v165, v166
  v_add_f32 v28, v28, v138
  v_max3_f32 v31, v31, v181, v182
  v_add_f32 v28, v28, v139
  v_max3_f32 v30, v30, v167, v168
  s_waitcnt lgkmcnt(4)
  v_mfma_f32_32x32x16_bf16 a[0:15], a[240:243], v[228:231], a[0:15]
  s_waitcnt vmcnt(3)
  s_barrier
  buffer_load_dwordx4 a[140:143], v3, s[44:47], s67 offen offset:3072 sc1
  s_add_u32 s67, s67, 4096
  s_cmp_eq_u32 s67, 131072
  s_cselect_b32 s67, 0, s67
  v_add_f32 v28, v28, v140
  v_mfma_f32_32x32x16_bf16 a[16:31], a[240:243], v[236:239], a[16:31]
  v_max3_f32 v31, v31, v183, v184
  v_add_f32 v28, v28, v141
  v_max3_f32 v30, v30, v169, v170
  v_add_f32 v28, v28, v142
  v_max3_f32 v31, v31, v185, v186
  v_add_f32 v28, v28, v143
  v_mfma_f32_32x32x16_bf16 a[32:47], a[244:247], v[228:231], a[32:47]
  buffer_load_dwordx4 a[144:147], v3, s[44:47], s67 offen offset:0 sc1
  v_max3_f32 v30, v30, v171, v172
  v_add_f32 v29, v29, v152
  v_max3_f32 v31, v31, v187, v188
  v_mfma_f32_32x32x16_bf16 a[48:63], a[244:247], v[236:239], a[48:63]
  v_add_f32 v29, v29, v153
  v_max3_f32 v30, v30, v173, v174
  v_add_f32 v29, v29, v154
  v_max3_f32 v31, v31, v189, v190
  v_add_f32 v29, v29, v155
  v_max_f32 v30, v30, v175
  s_waitcnt lgkmcnt(0)
  v_mfma_f32_32x32x16_bf16 a[64:79], a[248:251], v[228:231], a[64:79]
  v_add_f32 v29, v29, v156
  v_max_f32 v31, v31, v191
  v_add_f32 v29, v29, v157
  v_add_f32 v29, v29, v158
  v_add_f32 v29, v29, v159
  v_mfma_f32_32x32x16_bf16 a[80:95], a[248:251], v[236:239], a[80:95]
  buffer_load_dwordx4 a[148:151], v3, s[44:47], s67 offen offset:1024 sc1
  v_mfma_f32_32x32x16_bf16 a[96:111], a[252:255], v[228:231], a[96:111]
  v_mfma_f32_32x32x16_bf16 a[112:127], a[252:255], v[236:239], a[112:127]
  v_max_f32 v32, v30, v31
  v_cmp_lt_f32 vcc, s50, v32
  s_cbranch_vccz L_mk2_norescale_40
  s_call_b64 s[48:49], L_q_rescale1
L_mk2_norescale_40:
  buffer_load_dwordx4 a[152:155], v3, s[44:47], s67 offen offset:2048 sc1
  buffer_load_dwordx4 a[156:159], v3, s[44:47], s67 offen offset:3072 sc1
  s_add_u32 s67, s67, 4096
  s_cmp_eq_u32 s67, 131072
  s_cselect_b32 s67, 0, s67
  buffer_load_dwordx4 a[160:163], v3, s[44:47], s67 offen offset:0 sc1
  buffer_load_dwordx4 a[164:167], v3, s[44:47], s67 offen offset:1024 sc1
  ds_read_b64_tr_b16 a[224:225], v24 offset:0
  ds_read_b64_tr_b16 a[226:227], v24 offset:2048
  ds_read_b64_tr_b16 a[228:229], v25 offset:0
  buffer_load_dwordx4 a[168:171], v3, s[44:47], s67 offen offset:2048 sc1
  ds_read_b64_tr_b16 a[230:231], v25 offset:2048
  ds_read_b64_tr_b16 a[232:233], v26 offset:0
  buffer_load_dwordx4 a[172:175], v3, s[44:47], s67 offen offset:3072 sc1
  s_add_u32 s67, s67, 4096
  s_cmp_eq_u32 s67, 131072
  s_cselect_b32 s67, 0, s67
  ds_read_b64_tr_b16 a[234:235], v26 offset:2048
  ds_read_b64_tr_b16 a[236:237], v27 offset:0
  ds_read_b64_tr_b16 a[238:239], v27 offset:2048
  buffer_load_dwordx4 a[176:179], v3, s[44:47], s67 offen offset:0 sc1
  v_exp_f32 v160, v160
  v_exp_f32 v161, v161
  v_exp_f32 v162, v162
  v_cvt_pk_bf16_f32 v224, v160, v161
  v_exp_f32 v163, v163
  v_exp_f32 v164, v164
  v_cvt_pk_bf16_f32 v225, v162, v163
  v_exp_f32 v165, v165
  v_exp_f32 v166, v166
  v_cvt_pk_bf16_f32 v226, v164, v165
  v_exp_f32 v167, v167
  v_exp_f32 v176, v176
  v_cvt_pk_bf16_f32 v227, v166, v167
  v_exp_f32 v177, v177
  v_exp_f32 v178, v178
  v_cvt_pk_bf16_f32 v232, v176, v177
  v_exp_f32 v179, v179
  v_exp_f32 v180, v180
  v_cvt_pk_bf16_f32 v233, v178, v179
  v_exp_f32 v181, v181
  v_exp_f32 v182, v182
  v_cvt_pk_bf16_f32 v234, v180, v181
  v_exp_f32 v183, v183
  v_exp_f32 v168, v168
  v_cvt_pk_bf16_f32 v235, v182, v183
  s_nop 0
  s_nop 0
  s_waitcnt lgkmcnt(4)
  v_mfma_f32_32x32x16_bf16 a[0:15], a[224:227], v[224:227], a[0:15]
  ds_read_b64_tr_b16 a[240:241], v24 offset:4096
  v_exp_f32 v169, v169
  v_exp_f32 v170, v170
  v_mfma_f32_32x32x16_bf16 a[16:31], a[224:227], v[232:235], a[16:31]
  ds_read_b64_tr_b16 a[242:243], v24 offset:6144
  buffer_load_dwordx4 a[180:183], v3, s[44:47], s67 offen offset:1024 sc1
  v_cvt_pk_bf16_f32 v228, v168, v169
  v_mfma_f32_32x32x16_bf16 a[32:47], a[228:231], v[224:227], a[32:47]
  ds_read_b64_tr_b16 a[244:245], v25 offset:4096
  v_exp_f32 v171, v171
  v_exp_f32 v172, v172
  v_cvt_pk_bf16_f32 v229, v170, v171
  v_mfma_f32_32x32x16_bf16 a[48:63], a[228:231], v[232:235], a[48:63]
  ds_read_b64_tr_b16 a[246:247], v25 offset:6144
  v_exp_f32 v173, v173
  v_exp_f32 v174, v174
  v_cvt_pk_bf16_f32 v230, v172, v173
  s_waitcnt lgkmcnt(4)
  v_mfma_f32_32x32x16_bf16 a[64:79], a[232:235], v[224:227], a[64:79]
  ds_read_b64_tr_b16 a[248:249], v26 offset:4096
  v_exp_f32 v175, v175
  v_exp_f32 v184, v184
  v_mfma_f32_32x32x16_bf16 a[80:95], a[232:235], v[232:235], a[80:95]
  ds_read_b64_tr_b16 a[250:251], v26 offset:6144
  v_cvt_pk_bf16_f32 v231, v174, v175
  v_exp_f32 v185, v185
  v_exp_f32 v186, v186
  v_mfma_f32_32x32x16_bf16 a[96:111], a[236:239], v[224:227], a[96:111]
  ds_read_b64_tr_b16 a[252:253], v27 offset:4096
  v_cvt_pk_bf16_f32 v236, v184, v185
  v_exp_f32 v187, v187
  v_exp_f32 v188, v188
  v_mfma_f32_32x32x16_bf16 a[112:127], a[236:239], v[232:235], a[112:127]
  ds_read_b64_tr_b16 a[254:255], v27 offset:6144
  v_cvt_pk_bf16_f32 v237, v186, v187
  v_exp_f32 v189, v189
  v_exp_f32 v190, v190
  v_cvt_pk_bf16_f32 v238, v188, v189
  v_exp_f32 v191, v191
  v_add_f32 v28, v28, v160
  v_cvt_pk_bf16_f32 v239, v190, v191
  s_nop 0
  s_nop 0
  s_waitcnt lgkmcnt(4)
  v_mfma_f32_32x32x16_bf16 a[0:15], a[240:243], v[228:231], a[0:15]
  v_add_f32 v28, v28, v161
  v_add_f32 v28, v28, v162
  v_add_f32 v28, v28, v163
  v_add_f32 v28, v28, v164
  v_add_f32 v28, v28, v165
  v_mfma_f32_32x32x16_bf16 a[16:31], a[240:243], v[236:239], a[16:31]
  v_add_f32 v28, v28, v166
  v_add_f32 v28, v28, v167
  v_add_f32 v29, v29, v176
  v_add_f32 v29, v29, v177
  v_add_f32 v29, v29, v178
  v_add_f32 v29, v29, v179
  v_mfma_f32_32x32x16_bf16 a[32:47], a[244:247], v[228:231], a[32:47]
  v_add_f32 v29, v29, v180
  v_add_f32 v29, v29, v181
  v_add_f32 v29, v29, v182
  v_add_f32 v29, v29, v183
  v_add_f32 v28, v28, v168
  v_add_f32 v28, v28, v169
  v_mfma_f32_32x32x16_bf16 a[48:63], a[244:247], v[236:239], a[48:63]
  v_add_f32 v28, v28, v170
  v_add_f32 v28, v28, v171
  v_add_f32 v28, v28, v172
  v_add_f32 v28, v28, v173
  v_add_f32 v28, v28, v174
  v_add_f32 v28, v28, v175
  s_waitcnt lgkmcnt(0)
  v_mfma_f32_32x32x16_bf16 a[64:79], a[248:251], v[228:231], a[64:79]
  v_add_f32 v29, v29, v184
  v_add_f32 v29, v29, v185
  v_add_f32 v29, v29, v186
  v_add_f32 v29, v29, v187
  v_add_f32 v29, v29, v188
  v_mfma_f32_32x32x16_bf16 a[80:95], a[248:251], v[236:239], a[80:95]
  v_add_f32 v29, v29, v189
  v_add_f32 v29, v29, v190
  v_add_f32 v29, v29, v191
  v_mfma_f32_32x32x16_bf16 a[96:111], a[252:255], v[228:231], a[96:111]
  v_mfma_f32_32x32x16_bf16 a[112:127], a[252:255], v[236:239], a[112:127]
  s_barrier
  ds_read_b64_tr_b16 a[192:193], v8 offset:0
  ds_read_b64_tr_b16 a[194:195], v8 offset:4096
  ds_read_b64_tr_b16 a[196:197], v9 offset:0
  ds_read_b64_tr_b16 a[198:199], v9 offset:4096
  ds_read_b64_tr_b16 a[200:201], v10 offset:0
  ds_read_b64_tr_b16 a[202:203], v10 offset:4096
  ds_read_b64_tr_b16 a[204:205], v11 offset:0
  ds_read_b64_tr_b16 a[206:207], v11 offset:4096
  ds_read_b64_tr_b16 a[208:209], v40 offset:0
  ds_read_b64_tr_b16 a[210:211], v40 offset:4096
  ds_read_b64_tr_b16 a[212:213], v41 offset:0
  ds_read_b64_tr_b16 a[214:215], v41 offset:4096
  v_add_u32 v208, 0x10000, v8
  v_add_u32 v209, 0x10000, v9
  v_add_u32 v210, 0x10000, v10
  v_add_u32 v211, 0x10000, v11
  v_add_u32 v212, 0x10000, v40
  v_add_u32 v213, 0x10000, v41
  v_add_u32 v214, 0x10000, v42
  v_add_u32 v215, 0x10000, v43
  v_mov_b32 v36, v28
  v_mov_b32 v37, v29
  s_lshl_b32 s21, s37, 3
  s_lshl_b32 s22, s16, 1
  v_permlane32_swap_b32 v28, v36
  v_permlane32_swap_b32 v29, v37
  s_add_u32 s21, s21, s22
  v_add_f32 v28, v28, v36
  v_add_f32 v29, v29, v37
  v_rcp_f32 v28, v28
  v_rcp_f32 v29, v29
  s_lshl_b32 s22, s21, 18
  s_add_u32 s22, s22, 8388608
  s_add_u32 s32, s96, s22
  s_addc_u32 s33, s97, 0
  s_and_b32 s33, s33, 0xffff
  s_mov_b32 s34, 524288
  s_mov_b32 s35, 0x00020000
  s_lshl_b32 s65, s36, 13
  s_add_u32 s23, s65, 262144
  s_lshl_b32 s3, s37, 5
  s_add_u32 s3, s3, s36
  s_lshl_b32 s3, s3, 5
  s_add_u32 s101, s3, 8192
  v_add_u32 v38, 4096, v46
  v_accvgpr_read_b32 v128, a0
  v_accvgpr_read_b32 v129, a1
  v_accvgpr_read_b32 v130, a2
  v_accvgpr_read_b32 v131, a3
  v_accvgpr_read_b32 v132, a8
  v_accvgpr_read_b32 v133, a9
  v_accvgpr_read_b32 v134, a10
  v_accvgpr_read_b32 v135, a11
  v_mul_f32 v128, v128, v28
  v_mul_f32 v129, v129, v28
  v_mul_f32 v130, v130, v28
  v_mul_f32 v131, v131, v28
  v_mul_f32 v132, v132, v28
  v_mul_f32 v133, v133, v28
  v_mul_f32 v134, v134, v28
  v_mul_f32 v135, v135, v28
  s_waitcnt vmcnt(12) lgkmcnt(8)
  v_mfma_f32_16x16x32_bf16 v[64:67], a[192:195], a[128:131], v[64:67]
  ds_read_b64_tr_b16 a[216:217], v42 offset:0
  ds_read_b64_tr_b16 a[218:219], v42 offset:4096
  v_cvt_pk_bf16_f32 v192, v128, v129
  v_mfma_f32_16x16x32_bf16 v[72:75], a[192:195], a[132:135], v[72:75]
  s_add_u32 m0, s19, 65536
  v_cvt_pk_bf16_f32 v193, v130, v131
  v_cvt_pk_bf16_f32 v194, v132, v133
  v_mfma_f32_16x16x32_bf16 v[68:71], a[196:199], a[128:131], v[68:71]
  ds_read_b64_tr_b16 a[220:221], v43 offset:0
  ds_read_b64_tr_b16 a[222:223], v43 offset:4096
  v_cvt_pk_bf16_f32 v195, v134, v135
  v_mfma_f32_16x16x32_bf16 v[76:79], a[196:199], a[132:135], v[76:79]
  buffer_load_dwordx4 v48, s[4:7], s66 offen offset:0 lds
  buffer_store_dwordx4 v[192:195], v46, s[32:35], s65 offen offset:0 sc1
  v_accvgpr_read_b32 v136, a4
  s_waitcnt lgkmcnt(8)
  v_mfma_f32_16x16x32_bf16 v[80:83], a[200:203], a[128:131], v[80:83]
  ds_read_b64_tr_b16 a[192:193], v8 offset:8192
  ds_read_b64_tr_b16 a[194:195], v8 offset:12288
  v_accvgpr_read_b32 v137, a5
  v_accvgpr_read_b32 v138, a6
  v_mfma_f32_16x16x32_bf16 v[88:91], a[200:203], a[132:135], v[88:91]
  buffer_load_dwordx4 v49, s[4:7], s66 offen offset:1024 lds
  v_accvgpr_read_b32 v139, a7
  v_mfma_f32_16x16x32_bf16 v[84:87], a[204:207], a[128:131], v[84:87]
  ds_read_b64_tr_b16 a[196:197], v9 offset:8192
  ds_read_b64_tr_b16 a[198:199], v9 offset:12288
  v_accvgpr_read_b32 v140, a12
  v_accvgpr_read_b32 v141, a13
  v_mfma_f32_16x16x32_bf16 v[92:95], a[204:207], a[132:135], v[92:95]
  buffer_load_dwordx4 v50, s[4:7], s66 offen offset:2048 lds
  v_accvgpr_read_b32 v142, a14
  s_waitcnt lgkmcnt(8)
  v_mfma_f32_16x16x32_bf16 v[96:99], a[208:211], a[128:131], v[96:99]
  ds_read_b64_tr_b16 a[200:201], v10 offset:8192
  ds_read_b64_tr_b16 a[202:203], v10 offset:12288
  v_accvgpr_read_b32 v143, a15
  v_mul_f32 v136, v136, v28
  v_mfma_f32_16x16x32_bf16 v[104:107], a[208:211], a[132:135], v[104:107]
  buffer_load_dwordx4 v51, s[4:7], s66 offen offset:3072 lds
  s_add_u32 s66, s66, 458752
  s_cmp_eq_u32 s66, 14680064
  s_cselect_b32 s66, 0, s66
  v_mul_f32 v137, v137, v28
  v_mul_f32 v138, v138, v28
  v_mfma_f32_16x16x32_bf16 v[100:103], a[212:215], a[128:131], v[100:103]
  ds_read_b64_tr_b16 a[204:205], v11 offset:8192
  ds_read_b64_tr_b16 a[206:207], v11 offset:12288
  v_mul_f32 v139, v139, v28
  v_mfma_f32_16x16x32_bf16 v[108:111], a[212:215], a[132:135], v[108:111]
  s_add_u32 m0, s19, 81920
  v_mul_f32 v140, v140, v28
  v_mul_f32 v141, v141, v28
  s_waitcnt lgkmcnt(8)
  v_mfma_f32_16x16x32_bf16 v[112:115], a[216:219], a[128:131], v[112:115]
  ds_read_b64_tr_b16 a[208:209], v40 offset:8192
  ds_read_b64_tr_b16 a[210:211], v40 offset:12288
  v_mul_f32 v142, v142, v28
  v_mfma_f32_16x16x32_bf16 v[120:123], a[216:219], a[132:135], v[120:123]
  buffer_load_dwordx4 v48, s[4:7], s66 offen offset:0 lds
  v_mul_f32 v143, v143, v28
  v_cvt_pk_bf16_f32 v196, v136, v137
  v_mfma_f32_16x16x32_bf16 v[116:119], a[220:223], a[128:131], v[116:119]
  ds_read_b64_tr_b16 a[212:213], v41 offset:8192
  ds_read_b64_tr_b16 a[214:215], v41 offset:12288
  v_cvt_pk_bf16_f32 v197, v138, v139
  v_cvt_pk_bf16_f32 v198, v140, v141
  v_mfma_f32_16x16x32_bf16 v[124:127], a[220:223], a[132:135], v[124:127]
  buffer_load_dwordx4 v49, s[4:7], s66 offen offset:1024 lds
  v_cvt_pk_bf16_f32 v199, v142, v143
  s_waitcnt vmcnt(17) lgkmcnt(8)
  v_mfma_f32_16x16x32_bf16 v[64:67], a[192:195], a[136:139], v[64:67]
  ds_read_b64_tr_b16 a[216:217], v42 offset:8192
  ds_read_b64_tr_b16 a[218:219], v42 offset:12288
  buffer_store_dwordx4 v[196:199], v46, s[32:35], s65 offen offset:512 sc1
  v_accvgpr_read_b32 v144, a16
  v_mfma_f32_16x16x32_bf16 v[72:75], a[192:195], a[140:143], v[72:75]
  buffer_load_dwordx4 v50, s[4:7], s66 offen offset:2048 lds
  v_accvgpr_read_b32 v145, a17
  v_mfma_f32_16x16x32_bf16 v[68:71], a[196:199], a[136:139], v[68:71]
  ds_read_b64_tr_b16 a[220:221], v43 offset:8192
  ds_read_b64_tr_b16 a[222:223], v43 offset:12288
  v_accvgpr_read_b32 v146, a18
  v_accvgpr_read_b32 v147, a19
  v_mfma_f32_16x16x32_bf16 v[76:79], a[196:199], a[140:143], v[76:79]
  buffer_load_dwordx4 v51, s[4:7], s66 offen offset:3072 lds
  s_add_u32 s66, s66, 458752
  s_cmp_eq_u32 s66, 14680064
  s_cselect_b32 s66, 0, s66
  v_accvgpr_read_b32 v148, a24
  v_accvgpr_read_b32 v149, a25
  s_waitcnt lgkmcnt(8)
  v_mfma_f32_16x16x32_bf16 v[80:83], a[200:203], a[136:139], v[80:83]
  s_barrier
  ds_read_b64_tr_b16 a[192:193], v8 offset:16384
  ds_read_b64_tr_b16 a[194:195], v8 offset:20480
  v_accvgpr_read_b32 v150, a26
  v_mfma_f32_16x16x32_bf16 v[88:91], a[200:203], a[140:143], v[88:91]
  buffer_load_dwordx4 a[184:187], v3, s[44:47], s67 offen offset:2048 sc1
  v_accvgpr_read_b32 v151, a27
  v_mul_f32 v144, v144, v29
  v_mfma_f32_16x16x32_bf16 v[84:87], a[204:207], a[136:139], v[84:87]
  ds_read_b64_tr_b16 a[196:197], v9 offset:16384
  ds_read_b64_tr_b16 a[198:199], v9 offset:20480
  v_mul_f32 v145, v145, v29
  v_mfma_f32_16x16x32_bf16 v[92:95], a[204:207], a[140:143], v[92:95]
  buffer_load_dwordx4 a[188:191], v3, s[44:47], s67 offen offset:3072 sc1
  s_add_u32 s67, s67, 4096
  s_cmp_eq_u32 s67, 131072
  s_cselect_b32 s67, 0, s67
  v_mul_f32 v146, v146, v29
  v_mul_f32 v147, v147, v29
  s_waitcnt lgkmcnt(8)
  v_mfma_f32_16x16x32_bf16 v[96:99], a[208:211], a[136:139], v[96:99]
  ds_read_b64_tr_b16 a[200:201], v10 offset:16384
  ds_read_b64_tr_b16 a[202:203], v10 offset:20480
  v_mul_f32 v148, v148, v29
  v_mul_f32 v149, v149, v29
  v_mfma_f32_16x16x32_bf16 v[104:107], a[208:211], a[140:143], v[104:107]
  s_add_u32 m0, s19, 98304
  v_mul_f32 v150, v150, v29
  v_mfma_f32_16x16x32_bf16 v[100:103], a[212:215], a[136:139], v[100:103]
  ds_read_b64_tr_b16 a[204:205], v11 offset:16384
  ds_read_b64_tr_b16 a[206:207], v11 offset:20480
  v_mul_f32 v151, v151, v29
  v_cvt_pk_bf16_f32 v200, v144, v145
  v_mfma_f32_16x16x32_bf16 v[108:111], a[212:215], a[140:143], v[108:111]
  buffer_load_dwordx4 v48, s[4:7], s66 offen offset:0 lds
  v_cvt_pk_bf16_f32 v201, v146, v147
  v_cvt_pk_bf16_f32 v202, v148, v149
  s_waitcnt lgkmcnt(8)
  v_mfma_f32_16x16x32_bf16 v[112:115], a[216:219], a[136:139], v[112:115]
  ds_read_b64_tr_b16 a[208:209], v40 offset:16384
  ds_read_b64_tr_b16 a[210:211], v40 offset:20480
  v_cvt_pk_bf16_f32 v203, v150, v151
  v_mfma_f32_16x16x32_bf16 v[120:123], a[216:219], a[140:143], v[120:123]
  buffer_store_dwordx4 v[200:203], v46, s[32:35], s23 offen offset:0 sc1
  v_accvgpr_read_b32 v152, a20
  v_mfma_f32_16x16x32_bf16 v[116:119], a[220:223], a[136:139], v[116:119]
  ds_read_b64_tr_b16 a[212:213], v41 offset:16384
  ds_read_b64_tr_b16 a[214:215], v41 offset:20480
  v_accvgpr_read_b32 v153, a21
  v_mfma_f32_16x16x32_bf16 v[124:127], a[220:223], a[140:143], v[124:127]
  buffer_load_dwordx4 v49, s[4:7], s66 offen offset:1024 lds
  v_accvgpr_read_b32 v154, a22
  v_accvgpr_read_b32 v155, a23
  s_waitcnt vmcnt(23) lgkmcnt(8)
  v_mfma_f32_16x16x32_bf16 v[64:67], a[192:195], a[144:147], v[64:67]
  ds_read_b64_tr_b16 a[216:217], v42 offset:16384
  ds_read_b64_tr_b16 a[218:219], v42 offset:20480
  v_accvgpr_read_b32 v156, a28
  v_accvgpr_read_b32 v157, a29
  v_mfma_f32_16x16x32_bf16 v[72:75], a[192:195], a[148:151], v[72:75]
  buffer_load_dwordx4 v50, s[4:7], s66 offen offset:2048 lds
  v_accvgpr_read_b32 v158, a30
  v_mfma_f32_16x16x32_bf16 v[68:71], a[196:199], a[144:147], v[68:71]
  ds_read_b64_tr_b16 a[220:221], v43 offset:16384
  ds_read_b64_tr_b16 a[222:223], v43 offset:20480
  v_accvgpr_read_b32 v159, a31
  v_mul_f32 v152, v152, v29
  v_mfma_f32_16x16x32_bf16 v[76:79], a[196:199], a[148:151], v[76:79]
  buffer_load_dwordx4 v51, s[4:7], s66 offen offset:3072 lds
  s_add_u32 s66, s66, 458752
  s_cmp_eq_u32 s66, 14680064
  s_cselect_b32 s66, 0, s66
  v_mul_f32 v153, v153, v29
  s_waitcnt lgkmcnt(8)
  v_mfma_f32_16x16x32_bf16 v[80:83], a[200:203], a[144:147], v[80:83]
  ds_read_b64_tr_b16 a[192:193], v8 offset:24576
  ds_read_b64_tr_b16 a[194:195], v8 offset:28672
  v_mul_f32 v154, v154, v29
  v_mul_f32 v155, v155, v29
  v_mfma_f32_16x16x32_bf16 v[88:91], a[200:203], a[148:151], v[88:91]
  buffer_load_dwordx4 a[128:131], v3, s[44:47], s67 offen offset:0 sc1
  v_mul_f32 v156, v156, v29
  v_mul_f32 v157, v157, v29
  v_mfma_f32_16x16x32_bf16 v[84:87], a[204:207], a[144:147], v[84:87]
  ds_read_b64_tr_b16 a[196:197], v9 offset:24576
  ds_read_b64_tr_b16 a[198:199], v9 offset:28672
  v_mul_f32 v158, v158, v29
  v_mfma_f32_16x16x32_bf16 v[92:95], a[204:207], a[148:151], v[92:95]
  buffer_load_dwordx4 a[132:135], v3, s[44:47], s67 offen offset:1024 sc1
  v_mul_f32 v159, v159, v29
  v_cvt_pk_bf16_f32 v204, v152, v153
  s_waitcnt lgkmcnt(8)
  v_mfma_f32_16x16x32_bf16 v[96:99], a[208:211], a[144:147], v[96:99]
  ds_read_b64_tr_b16 a[200:201], v10 offset:24576
  ds_read_b64_tr_b16 a[202:203], v10 offset:28672
  v_cvt_pk_bf16_f32 v205, v154, v155
  v_mfma_f32_16x16x32_bf16 v[104:107], a[208:211], a[148:151], v[104:107]
  v_cvt_pk_bf16_f32 v206, v156, v157
  v_cvt_pk_bf16_f32 v207, v158, v159
  v_mfma_f32_16x16x32_bf16 v[100:103], a[212:215], a[144:147], v[100:103]
  ds_read_b64_tr_b16 a[204:205], v11 offset:24576
  ds_read_b64_tr_b16 a[206:207], v11 offset:28672
  buffer_store_dwordx4 v[204:207], v46, s[32:35], s23 offen offset:512 sc1
  v_accvgpr_read_b32 v160, a32
  v_mfma_f32_16x16x32_bf16 v[108:111], a[212:215], a[148:151], v[108:111]
  buffer_load_dwordx4 a[136:139], v3, s[44:47], s67 offen offset:2048 sc1
  v_accvgpr_read_b32 v161, a33
  s_waitcnt lgkmcnt(8)
  v_mfma_f32_16x16x32_bf16 v[112:115], a[216:219], a[144:147], v[112:115]
  ds_read_b64_tr_b16 a[208:209], v40 offset:24576
  ds_read_b64_tr_b16 a[210:211], v40 offset:28672
  v_accvgpr_read_b32 v162, a34
  v_accvgpr_read_b32 v163, a35
  v_mfma_f32_16x16x32_bf16 v[120:123], a[216:219], a[148:151], v[120:123]
  v_accvgpr_read_b32 v164, a40
  v_mfma_f32_16x16x32_bf16 v[116:119], a[220:223], a[144:147], v[116:119]
  ds_read_b64_tr_b16 a[212:213], v41 offset:24576
  ds_read_b64_tr_b16 a[214:215], v41 offset:28672
  v_accvgpr_read_b32 v165, a41
  v_accvgpr_read_b32 v166, a42
  v_mfma_f32_16x16x32_bf16 v[124:127], a[220:223], a[148:151], v[124:127]
  buffer_load_dwordx4 a[140:143], v3, s[44:47], s67 offen offset:3072 sc1
  s_add_u32 s67, s67, 4096
  s_cmp_eq_u32 s67, 131072
  s_cselect_b32 s67, 0, s67
  v_accvgpr_read_b32 v167, a43
  v_mul_f32 v160, v160, v28
  s_waitcnt vmcnt(28) lgkmcnt(8)
  v_mfma_f32_16x16x32_bf16 v[64:67], a[192:195], a[152:155], v[64:67]
  ds_read_b64_tr_b16 a[216:217], v42 offset:24576
  ds_read_b64_tr_b16 a[218:219], v42 offset:28672
  v_mul_f32 v161, v161, v28
  v_mfma_f32_16x16x32_bf16 v[72:75], a[192:195], a[156:159], v[72:75]
  s_add_u32 m0, s19, 114688
  v_mul_f32 v162, v162, v28
  v_mul_f32 v163, v163, v28
  v_mfma_f32_16x16x32_bf16 v[68:71], a[196:199], a[152:155], v[68:71]
  ds_read_b64_tr_b16 a[220:221], v43 offset:24576
  ds_read_b64_tr_b16 a[222:223], v43 offset:28672
  v_mul_f32 v164, v164, v28
  v_mul_f32 v165, v165, v28
  v_mfma_f32_16x16x32_bf16 v[76:79], a[196:199], a[156:159], v[76:79]
  buffer_load_dwordx4 v48, s[4:7], s66 offen offset:0 lds
  v_mul_f32 v166, v166, v28
  s_waitcnt lgkmcnt(8)
  v_mfma_f32_16x16x32_bf16 v[80:83], a[200:203], a[152:155], v[80:83]
  s_barrier
  ds_read_b64_tr_b16 a[192:193], v8 offset:32768
  ds_read_b64_tr_b16 a[194:195], v8 offset:36864
  v_mul_f32 v167, v167, v28
  v_cvt_pk_bf16_f32 v192, v160, v161
  v_mfma_f32_16x16x32_bf16 v[88:91], a[200:203], a[156:159], v[88:91]
  v_cvt_pk_bf16_f32 v193, v162, v163
  v_mfma_f32_16x16x32_bf16 v[84:87], a[204:207], a[152:155], v[84:87]
  ds_read_b64_tr_b16 a[196:197], v9 offset:32768
  ds_read_b64_tr_b16 a[198:199], v9 offset:36864
  v_cvt_pk_bf16_f32 v194, v164, v165
  v_cvt_pk_bf16_f32 v195, v166, v167
  v_mfma_f32_16x16x32_bf16 v[92:95], a[204:207], a[156:159], v[92:95]
  buffer_load_dwordx4 v49, s[4:7], s66 offen offset:1024 lds
  buffer_store_dwordx4 v[192:195], v46, s[32:35], s65 offen offset:2048 sc1
  v_accvgpr_read_b32 v168, a36
  s_waitcnt lgkmcnt(8)
  v_mfma_f32_16x16x32_bf16 v[96:99], a[208:211], a[152:155], v[96:99]
  ds_read_b64_tr_b16 a[200:201], v10 offset:32768
  ds_read_b64_tr_b16 a[202:203], v10 offset:36864
  v_accvgpr_read_b32 v169, a37
  v_mfma_f32_16x16x32_bf16 v[104:107], a[208:211], a[156:159], v[104:107]
  v_accvgpr_read_b32 v170, a38
  v_accvgpr_read_b32 v171, a39
  v_mfma_f32_16x16x32_bf16 v[100:103], a[212:215], a[152:155], v[100:103]
  ds_read_b64_tr_b16 a[204:205], v11 offset:32768
  ds_read_b64_tr_b16 a[206:207], v11 offset:36864
  v_accvgpr_read_b32 v172, a44
  v_mfma_f32_16x16x32_bf16 v[108:111], a[212:215], a[156:159], v[108:111]
  buffer_load_dwordx4 v50, s[4:7], s66 offen offset:2048 lds
  v_accvgpr_read_b32 v173, a45
  v_accvgpr_read_b32 v174, a46
  s_waitcnt lgkmcnt(8)
  v_mfma_f32_16x16x32_bf16 v[112:115], a[216:219], a[152:155], v[112:115]
  ds_read_b64_tr_b16 a[208:209], v40 offset:32768
  ds_read_b64_tr_b16 a[210:211], v40 offset:36864
  v_accvgpr_read_b32 v175, a47
  v_mul_f32 v168, v168, v28
  v_mfma_f32_16x16x32_bf16 v[120:123], a[216:219], a[156:159], v[120:123]
  v_mul_f32 v169, v169, v28
  v_mfma_f32_16x16x32_bf16 v[116:119], a[220:223], a[152:155], v[116:119]
  ds_read_b64_tr_b16 a[212:213], v41 offset:32768
  ds_read_b64_tr_b16 a[214:215], v41 offset:36864
  v_mul_f32 v170, v170, v28
  v_mul_f32 v171, v171, v28
  v_mfma_f32_16x16x32_bf16 v[124:127], a[220:223], a[156:159], v[124:127]
  buffer_load_dwordx4 v51, s[4:7], s66 offen offset:3072 lds
  s_add_u32 s66, s66, 458752
  s_cmp_eq_u32 s66, 14680064
  s_cselect_b32 s66, 0, s66
  v_mul_f32 v172, v172, v28
  s_waitcnt vmcnt(31) lgkmcnt(8)
  v_mfma_f32_16x16x32_bf16 v[64:67], a[192:195], a[160:163], v[64:67]
  ds_read_b64_tr_b16 a[216:217], v42 offset:32768
  ds_read_b64_tr_b16 a[218:219], v42 offset:36864
  v_mul_f32 v173, v173, v28
  v_mul_f32 v174, v174, v28
  v_mfma_f32_16x16x32_bf16 v[72:75], a[192:195], a[164:167], v[72:75]
  buffer_load_dwordx4 a[144:147], v3, s[44:47], s67 offen offset:0 sc1
  v_mul_f32 v175, v175, v28
  v_cvt_pk_bf16_f32 v196, v168, v169
  v_mfma_f32_16x16x32_bf16 v[68:71], a[196:199], a[160:163], v[68:71]
  ds_read_b64_tr_b16 a[220:221], v43 offset:32768
  ds_read_b64_tr_b16 a[222:223], v43 offset:36864
  v_cvt_pk_bf16_f32 v197, v170, v171
  v_mfma_f32_16x16x32_bf16 v[76:79], a[196:199], a[164:167], v[76:79]
  buffer_load_dwordx4 a[148:151], v3, s[44:47], s67 offen offset:1024 sc1
  v_cvt_pk_bf16_f32 v198, v172, v173
  v_cvt_pk_bf16_f32 v199, v174, v175
  s_waitcnt lgkmcnt(8)
  v_mfma_f32_16x16x32_bf16 v[80:83], a[200:203], a[160:163], v[80:83]
  ds_read_b64_tr_b16 a[192:193], v8 offset:40960
  ds_read_b64_tr_b16 a[194:195], v8 offset:45056
  buffer_store_dwordx4 v[196:199], v46, s[32:35], s65 offen offset:2560 sc1
  v_mfma_f32_16x16x32_bf16 v[88:91], a[200:203], a[164:167], v[88:91]
  v_accvgpr_read_b32 v176, a48
  v_accvgpr_read_b32 v177, a49
  v_mfma_f32_16x16x32_bf16 v[84:87], a[204:207], a[160:163], v[84:87]
  ds_read_b64_tr_b16 a[196:197], v9 offset:40960
  ds_read_b64_tr_b16 a[198:199], v9 offset:45056
  v_accvgpr_read_b32 v178, a50
  v_accvgpr_read_b32 v179, a51
  v_mfma_f32_16x16x32_bf16 v[92:95], a[204:207], a[164:167], v[92:95]
  buffer_load_dwordx4 a[152:155], v3, s[44:47], s67 offen offset:2048 sc1
  v_accvgpr_read_b32 v180, a56
  s_waitcnt lgkmcnt(8)
  v_mfma_f32_16x16x32_bf16 v[96:99], a[208:211], a[160:163], v[96:99]
  ds_read_b64_tr_b16 a[200:201], v10 offset:40960
  ds_read_b64_tr_b16 a[202:203], v10 offset:45056
  v_accvgpr_read_b32 v181, a57
  v_accvgpr_read_b32 v182, a58
  v_mfma_f32_16x16x32_bf16 v[104:107], a[208:211], a[164:167], v[104:107]
  v_accvgpr_read_b32 v183, a59
  v_mfma_f32_16x16x32_bf16 v[100:103], a[212:215], a[160:163], v[100:103]
  ds_read_b64_tr_b16 a[204:205], v11 offset:40960
  ds_read_b64_tr_b16 a[206:207], v11 offset:45056
  v_mul_f32 v176, v176, v29
  v_mul_f32 v177, v177, v29
  v_mfma_f32_16x16x32_bf16 v[108:111], a[212:215], a[164:167], v[108:111]
  buffer_load_dwordx4 a[156:159], v3, s[44:47], s67 offen offset:3072 sc1
  s_add_u32 s67, s67, 4096
  s_cmp_eq_u32 s67, 131072
  s_cselect_b32 s67, 0, s67
  v_mul_f32 v178, v178, v29
  v_mul_f32 v179, v179, v29
  s_waitcnt lgkmcnt(8)
  v_mfma_f32_16x16x32_bf16 v[112:115], a[216:219], a[160:163], v[112:115]
  ds_read_b64_tr_b16 a[208:209], v40 offset:40960
  ds_read_b64_tr_b16 a[210:211], v40 offset:45056
  v_mul_f32 v180, v180, v29
  v_mfma_f32_16x16x32_bf16 v[120:123], a[216:219], a[164:167], v[120:123]
  s_add_u32 m0, s19, 0
  v_mul_f32 v181, v181, v29
  v_mul_f32 v182, v182, v29
  v_mfma_f32_16x16x32_bf16 v[116:119], a[220:223], a[160:163], v[116:119]
  ds_read_b64_tr_b16 a[212:213], v41 offset:40960
  ds_read_b64_tr_b16 a[214:215], v41 offset:45056
  v_mul_f32 v183, v183, v29
  v_cvt_pk_bf16_f32 v200, v176, v177
  v_mfma_f32_16x16x32_bf16 v[124:127], a[220:223], a[164:167], v[124:127]
  buffer_load_dwordx4 v48, s[4:7], s66 offen offset:0 lds
  v_cvt_pk_bf16_f32 v201, v178, v179
  s_waitcnt vmcnt(35) lgkmcnt(8)
  v_mfma_f32_16x16x32_bf16 v[64:67], a[192:195], a[168:171], v[64:67]
  ds_read_b64_tr_b16 a[216:217], v42 offset:40960
  ds_read_b64_tr_b16 a[218:219], v42 offset:45056
  v_cvt_pk_bf16_f32 v202, v180, v181
  v_cvt_pk_bf16_f32 v203, v182, v183
  v_mfma_f32_16x16x32_bf16 v[72:75], a[192:195], a[172:175], v[72:75]
  buffer_store_dwordx4 v[200:203], v46, s[32:35], s23 offen offset:2048 sc1
  v_mfma_f32_16x16x32_bf16 v[68:71], a[196:199], a[168:171], v[68:71]
  ds_read_b64_tr_b16 a[220:221], v43 offset:40960
  ds_read_b64_tr_b16 a[222:223], v43 offset:45056
  v_accvgpr_read_b32 v184, a52
  v_accvgpr_read_b32 v185, a53
  v_mfma_f32_16x16x32_bf16 v[76:79], a[196:199], a[172:175], v[76:79]
  buffer_load_dwordx4 v49, s[4:7], s66 offen offset:1024 lds
  v_accvgpr_read_b32 v186, a54
  v_accvgpr_read_b32 v187, a55
  s_waitcnt lgkmcnt(8)
  v_mfma_f32_16x16x32_bf16 v[80:83], a[200:203], a[168:171], v[80:83]
  s_barrier
  ds_read_b64_tr_b16 a[192:193], v8 offset:49152
  ds_read_b64_tr_b16 a[194:195], v8 offset:53248
  v_accvgpr_read_b32 v188, a60
  v_mfma_f32_16x16x32_bf16 v[88:91], a[200:203], a[172:175], v[88:91]
  v_accvgpr_read_b32 v189, a61
  v_accvgpr_read_b32 v190, a62
  v_mfma_f32_16x16x32_bf16 v[84:87], a[204:207], a[168:171], v[84:87]
  ds_read_b64_tr_b16 a[196:197], v9 offset:49152
  ds_read_b64_tr_b16 a[198:199], v9 offset:53248
  v_accvgpr_read_b32 v191, a63
  v_mfma_f32_16x16x32_bf16 v[92:95], a[204:207], a[172:175], v[92:95]
  buffer_load_dwordx4 v50, s[4:7], s66 offen offset:2048 lds
  v_mul_f32 v184, v184, v29
  v_mul_f32 v185, v185, v29
  s_waitcnt lgkmcnt(8)
  v_mfma_f32_16x16x32_bf16 v[96:99], a[208:211], a[168:171], v[96:99]
  ds_read_b64_tr_b16 a[200:201], v10 offset:49152
  ds_read_b64_tr_b16 a[202:203], v10 offset:53248
  v_mul_f32 v186, v186, v29
  v_mul_f32 v187, v187, v29
  v_mfma_f32_16x16x32_bf16 v[104:107], a[208:211], a[172:175], v[104:107]
  v_mul_f32 v188, v188, v29
  v_mfma_f32_16x16x32_bf16 v[100:103], a[212:215], a[168:171], v[100:103]
  ds_read_b64_tr_b16 a[204:205], v11 offset:49152
  ds_read_b64_tr_b16 a[206:207], v11 offset:53248
  v_mul_f32 v189, v189, v29
  v_mul_f32 v190, v190, v29
  v_mfma_f32_16x16x32_bf16 v[108:111], a[212:215], a[172:175], v[108:111]
  buffer_load_dwordx4 v51, s[4:7], s66 offen offset:3072 lds
  s_add_u32 s66, s66, 458752
  s_cmp_eq_u32 s66, 14680064
  s_cselect_b32 s66, 0, s66
  v_mul_f32 v191, v191, v29
  s_waitcnt lgkmcnt(8)
  v_mfma_f32_16x16x32_bf16 v[112:115], a[216:219], a[168:171], v[112:115]
  ds_read_b64_tr_b16 a[208:209], v40 offset:49152
  ds_read_b64_tr_b16 a[210:211], v40 offset:53248
  v_cvt_pk_bf16_f32 v204, v184, v185
  v_cvt_pk_bf16_f32 v205, v186, v187
  v_mfma_f32_16x16x32_bf16 v[120:123], a[216:219], a[172:175], v[120:123]
  v_cvt_pk_bf16_f32 v206, v188, v189
  v_cvt_pk_bf16_f32 v207, v190, v191
  v_mfma_f32_16x16x32_bf16 v[116:119], a[220:223], a[168:171], v[116:119]
  ds_read_b64_tr_b16 a[212:213], v41 offset:49152
  ds_read_b64_tr_b16 a[214:215], v41 offset:53248
  buffer_store_dwordx4 v[204:207], v46, s[32:35], s23 offen offset:2560 sc1
  v_mfma_f32_16x16x32_bf16 v[124:127], a[220:223], a[172:175], v[124:127]
  buffer_load_dwordx4 a[160:163], v3, s[44:47], s67 offen offset:0 sc1
  v_accvgpr_read_b32 v128, a64
  v_accvgpr_read_b32 v129, a65
  s_waitcnt vmcnt(39) lgkmcnt(8)
  v_mfma_f32_16x16x32_bf16 v[64:67], a[192:195], a[176:179], v[64:67]
  ds_read_b64_tr_b16 a[216:217], v42 offset:49152
  ds_read_b64_tr_b16 a[218:219], v42 offset:53248
  v_accvgpr_read_b32 v130, a66
  v_mfma_f32_16x16x32_bf16 v[72:75], a[192:195], a[180:183], v[72:75]
  buffer_load_dwordx4 a[164:167], v3, s[44:47], s67 offen offset:1024 sc1
  v_accvgpr_read_b32 v131, a67
  v_accvgpr_read_b32 v132, a72
  v_mfma_f32_16x16x32_bf16 v[68:71], a[196:199], a[176:179], v[68:71]
  ds_read_b64_tr_b16 a[220:221], v43 offset:49152
  ds_read_b64_tr_b16 a[222:223], v43 offset:53248
  v_accvgpr_read_b32 v133, a73
  v_accvgpr_read_b32 v134, a74
  v_mfma_f32_16x16x32_bf16 v[76:79], a[196:199], a[180:183], v[76:79]
  v_accvgpr_read_b32 v135, a75
  s_waitcnt lgkmcnt(8)
  v_mfma_f32_16x16x32_bf16 v[80:83], a[200:203], a[176:179], v[80:83]
  ds_read_b64_tr_b16 a[192:193], v8 offset:57344
  ds_read_b64_tr_b16 a[194:195], v8 offset:61440
  v_mul_f32 v128, v128, v28
  v_mul_f32 v129, v129, v28
  v_mfma_f32_16x16x32_bf16 v[88:91], a[200:203], a[180:183], v[88:91]
  buffer_load_dwordx4 a[168:171], v3, s[44:47], s67 offen offset:2048 sc1
  v_mul_f32 v130, v130, v28
  v_mul_f32 v131, v131, v28
  v_mfma_f32_16x16x32_bf16 v[84:87], a[204:207], a[176:179], v[84:87]
  ds_read_b64_tr_b16 a[196:197], v9 offset:57344
  ds_read_b64_tr_b16 a[198:199], v9 offset:61440
  v_mul_f32 v132, v132, v28
  v_mfma_f32_16x16x32_bf16 v[92:95], a[204:207], a[180:183], v[92:95]
  v_mul_f32 v133, v133, v28
  v_mul_f32 v134, v134, v28
  s_waitcnt lgkmcnt(8)
  v_mfma_f32_16x16x32_bf16 v[96:99], a[208:211], a[176:179], v[96:99]
  ds_read_b64_tr_b16 a[200:201], v10 offset:57344
  ds_read_b64_tr_b16 a[202:203], v10 offset:61440
  v_mul_f32 v135, v135, v28
  v_mfma_f32_16x16x32_bf16 v[104:107], a[208:211], a[180:183], v[104:107]
  buffer_load_dwordx4 a[172:175], v3, s[44:47], s67 offen offset:3072 sc1
  s_add_u32 s67, s67, 4096
  s_cmp_eq_u32 s67, 131072
  s_cselect_b32 s67, 0, s67
  v_cvt_pk_bf16_f32 v192, v128, v129
  v_cvt_pk_bf16_f32 v193, v130, v131
  v_mfma_f32_16x16x32_bf16 v[100:103], a[212:215], a[176:179], v[100:103]
  ds_read_b64_tr_b16 a[204:205], v11 offset:57344
  ds_read_b64_tr_b16 a[206:207], v11 offset:61440
  v_cvt_pk_bf16_f32 v194, v132, v133
  v_cvt_pk_bf16_f32 v195, v134, v135
  v_mfma_f32_16x16x32_bf16 v[108:111], a[212:215], a[180:183], v[108:111]
  s_add_u32 m0, s19, 16384
  buffer_store_dwordx4 v[192:195], v38, s[32:35], s65 offen offset:0 sc1
  s_waitcnt lgkmcnt(8)
  v_mfma_f32_16x16x32_bf16 v[112:115], a[216:219], a[176:179], v[112:115]
  ds_read_b64_tr_b16 a[208:209], v40 offset:57344
  ds_read_b64_tr_b16 a[210:211], v40 offset:61440
  v_accvgpr_read_b32 v136, a68
  v_accvgpr_read_b32 v137, a69
  v_mfma_f32_16x16x32_bf16 v[120:123], a[216:219], a[180:183], v[120:123]
  buffer_load_dwordx4 v48, s[4:7], s66 offen offset:0 lds
  v_accvgpr_read_b32 v138, a70
  v_mfma_f32_16x16x32_bf16 v[116:119], a[220:223], a[176:179], v[116:119]
  ds_read_b64_tr_b16 a[212:213], v41 offset:57344
  ds_read_b64_tr_b16 a[214:215], v41 offset:61440
  v_accvgpr_read_b32 v139, a71
  v_accvgpr_read_b32 v140, a76
  v_mfma_f32_16x16x32_bf16 v[124:127], a[220:223], a[180:183], v[124:127]
  v_accvgpr_read_b32 v141, a77
  v_accvgpr_read_b32 v142, a78
  s_waitcnt vmcnt(32) lgkmcnt(8)
  v_mfma_f32_16x16x32_bf16 v[64:67], a[192:195], a[184:187], v[64:67]
  ds_read_b64_tr_b16 a[216:217], v42 offset:57344
  ds_read_b64_tr_b16 a[218:219], v42 offset:61440
  v_accvgpr_read_b32 v143, a79
  v_mfma_f32_16x16x32_bf16 v[72:75], a[192:195], a[188:191], v[72:75]
  buffer_load_dwordx4 v49, s[4:7], s66 offen offset:1024 lds
  v_mul_f32 v136, v136, v28
  v_mul_f32 v137, v137, v28
  v_mfma_f32_16x16x32_bf16 v[68:71], a[196:199], a[184:187], v[68:71]
  ds_read_b64_tr_b16 a[220:221], v43 offset:57344
  ds_read_b64_tr_b16 a[222:223], v43 offset:61440
  v_mul_f32 v138, v138, v28
  v_mfma_f32_16x16x32_bf16 v[76:79], a[196:199], a[188:191], v[76:79]
  v_mul_f32 v139, v139, v28
  v_mul_f32 v140, v140, v28
  s_waitcnt lgkmcnt(8)
  v_mfma_f32_16x16x32_bf16 v[80:83], a[200:203], a[184:187], v[80:83]
  s_barrier
  ds_read_b64_tr_b16 a[192:193], v208 offset:0
  ds_read_b64_tr_b16 a[194:195], v208 offset:4096
  v_mul_f32 v141, v141, v28
  v_mul_f32 v142, v142, v28
  v_mfma_f32_16x16x32_bf16 v[88:91], a[200:203], a[188:191], v[88:91]
  buffer_load_dwordx4 v50, s[4:7], s66 offen offset:2048 lds
  v_mul_f32 v143, v143, v28
  v_mfma_f32_16x16x32_bf16 v[84:87], a[204:207], a[184:187], v[84:87]
  ds_read_b64_tr_b16 a[196:197], v209 offset:0
  ds_read_b64_tr_b16 a[198:199], v209 offset:4096
  v_cvt_pk_bf16_f32 v196, v136, v137
  v_cvt_pk_bf16_f32 v197, v138, v139
  v_mfma_f32_16x16x32_bf16 v[92:95], a[204:207], a[188:191], v[92:95]
  v_cvt_pk_bf16_f32 v198, v140, v141
  s_waitcnt lgkmcnt(8)
  v_mfma_f32_16x16x32_bf16 v[96:99], a[208:211], a[184:187], v[96:99]
  ds_read_b64_tr_b16 a[200:201], v210 offset:0
  ds_read_b64_tr_b16 a[202:203], v210 offset:4096
  v_cvt_pk_bf16_f32 v199, v142, v143
  buffer_store_dwordx4 v[196:199], v38, s[32:35], s65 offen offset:512 sc1
  v_mfma_f32_16x16x32_bf16 v[104:107], a[208:211], a[188:191], v[104:107]
  buffer_load_dwordx4 v51, s[4:7], s66 offen offset:3072 lds
  s_add_u32 s66, s66, 458752
  s_cmp_eq_u32 s66, 14680064
  s_cselect_b32 s66, 0, s66
  v_accvgpr_read_b32 v144, a80
  v_accvgpr_read_b32 v145, a81
  v_mfma_f32_16x16x32_bf16 v[100:103], a[212:215], a[184:187], v[100:103]
  ds_read_b64_tr_b16 a[204:205], v211 offset:0
  ds_read_b64_tr_b16 a[206:207], v211 offset:4096
  v_accvgpr_read_b32 v146, a82
  v_mfma_f32_16x16x32_bf16 v[108:111], a[212:215], a[188:191], v[108:111]
  v_accvgpr_read_b32 v147, a83
  v_accvgpr_read_b32 v148, a88
  s_waitcnt lgkmcnt(8)
  v_mfma_f32_16x16x32_bf16 v[112:115], a[216:219], a[184:187], v[112:115]
  ds_read_b64_tr_b16 a[208:209], v212 offset:0
  ds_read_b64_tr_b16 a[210:211], v212 offset:4096
  v_accvgpr_read_b32 v149, a89
  v_accvgpr_read_b32 v150, a90
  v_mfma_f32_16x16x32_bf16 v[120:123], a[216:219], a[188:191], v[120:123]
  buffer_load_dwordx4 a[176:179], v3, s[44:47], s67 offen offset:0 sc1
  v_accvgpr_read_b32 v151, a91
  v_mfma_f32_16x16x32_bf16 v[116:119], a[220:223], a[184:187], v[116:119]
  ds_read_b64_tr_b16 a[212:213], v213 offset:0
  ds_read_b64_tr_b16 a[214:215], v213 offset:4096
  v_mul_f32 v144, v144, v29
  v_mul_f32 v145, v145, v29
  v_mfma_f32_16x16x32_bf16 v[124:127], a[220:223], a[188:191], v[124:127]
  v_mul_f32 v146, v146, v29
  s_waitcnt vmcnt(30) lgkmcnt(8)
  v_mfma_f32_16x16x32_bf16 v[64:67], a[192:195], a[128:131], v[64:67]
  ds_read_b64_tr_b16 a[216:217], v214 offset:0
  ds_read_b64_tr_b16 a[218:219], v214 offset:4096
  v_mul_f32 v147, v147, v29
  v_mul_f32 v148, v148, v29
  v_mfma_f32_16x16x32_bf16 v[72:75], a[192:195], a[132:135], v[72:75]
  buffer_load_dwordx4 a[180:183], v3, s[44:47], s67 offen offset:1024 sc1
  v_mul_f32 v149, v149, v29
  v_mul_f32 v150, v150, v29
  v_mfma_f32_16x16x32_bf16 v[68:71], a[196:199], a[128:131], v[68:71]
  ds_read_b64_tr_b16 a[220:221], v215 offset:0
  ds_read_b64_tr_b16 a[222:223], v215 offset:4096
  v_mul_f32 v151, v151, v29
  v_mfma_f32_16x16x32_bf16 v[76:79], a[196:199], a[132:135], v[76:79]
  v_cvt_pk_bf16_f32 v200, v144, v145
  v_cvt_pk_bf16_f32 v201, v146, v147
  s_waitcnt lgkmcnt(8)
  v_mfma_f32_16x16x32_bf16 v[80:83], a[200:203], a[128:131], v[80:83]
  ds_read_b64_tr_b16 a[192:193], v208 offset:8192
  ds_read_b64_tr_b16 a[194:195], v208 offset:12288
  v_cvt_pk_bf16_f32 v202, v148, v149
  v_mfma_f32_16x16x32_bf16 v[88:91], a[200:203], a[132:135], v[88:91]
  buffer_load_dwordx4 a[184:187], v3, s[44:47], s67 offen offset:2048 sc1
  v_cvt_pk_bf16_f32 v203, v150, v151
  buffer_store_dwordx4 v[200:203], v38, s[32:35], s23 offen offset:0 sc1
  v_mfma_f32_16x16x32_bf16 v[84:87], a[204:207], a[128:131], v[84:87]
  ds_read_b64_tr_b16 a[196:197], v209 offset:8192
  ds_read_b64_tr_b16 a[198:199], v209 offset:12288
  v_accvgpr_read_b32 v152, a84
  v_accvgpr_read_b32 v153, a85
  v_mfma_f32_16x16x32_bf16 v[92:95], a[204:207], a[132:135], v[92:95]
  v_accvgpr_read_b32 v154, a86
  s_waitcnt lgkmcnt(8)
  v_mfma_f32_16x16x32_bf16 v[96:99], a[208:211], a[128:131], v[96:99]
  ds_read_b64_tr_b16 a[200:201], v210 offset:8192
  ds_read_b64_tr_b16 a[202:203], v210 offset:12288
  v_accvgpr_read_b32 v155, a87
  v_accvgpr_read_b32 v156, a92
  v_mfma_f32_16x16x32_bf16 v[104:107], a[208:211], a[132:135], v[104:107]
  buffer_load_dwordx4 a[188:191], v3, s[44:47], s67 offen offset:3072 sc1
  s_add_u32 s67, s67, 4096
  s_cmp_eq_u32 s67, 131072
  s_cselect_b32 s67, 0, s67
  v_accvgpr_read_b32 v157, a93
  v_mfma_f32_16x16x32_bf16 v[100:103], a[212:215], a[128:131], v[100:103]
  ds_read_b64_tr_b16 a[204:205], v211 offset:8192
  ds_read_b64_tr_b16 a[206:207], v211 offset:12288
  v_accvgpr_read_b32 v158, a94
  v_accvgpr_read_b32 v159, a95
  v_mfma_f32_16x16x32_bf16 v[108:111], a[212:215], a[132:135], v[108:111]
  s_add_u32 m0, s19, 32768
  v_mul_f32 v152, v152, v29
  v_mul_f32 v153, v153, v29
  s_waitcnt lgkmcnt(8)
  v_mfma_f32_16x16x32_bf16 v[112:115], a[216:219], a[128:131], v[112:115]
  ds_read_b64_tr_b16 a[208:209], v212 offset:8192
  ds_read_b64_tr_b16 a[210:211], v212 offset:12288
  v_mul_f32 v154, v154, v29
  v_mfma_f32_16x16x32_bf16 v[120:123], a[216:219], a[132:135], v[120:123]
  buffer_load_dwordx4 v48, s[4:7], s66 offen offset:0 lds
  v_mul_f32 v155, v155, v29
  v_mul_f32 v156, v156, v29
  v_mfma_f32_16x16x32_bf16 v[116:119], a[220:223], a[128:131], v[116:119]
  ds_read_b64_tr_b16 a[212:213], v213 offset:8192
  ds_read_b64_tr_b16 a[214:215], v213 offset:12288
  v_mul_f32 v157, v157, v29
  v_mfma_f32_16x16x32_bf16 v[124:127], a[220:223], a[132:135], v[124:127]
  v_mul_f32 v158, v158, v29
  v_mul_f32 v159, v159, v29
  s_waitcnt vmcnt(32) lgkmcnt(8)
  v_mfma_f32_16x16x32_bf16 v[64:67], a[192:195], a[136:139], v[64:67]
  ds_read_b64_tr_b16 a[216:217], v214 offset:8192
  ds_read_b64_tr_b16 a[218:219], v214 offset:12288
  v_cvt_pk_bf16_f32 v204, v152, v153
  v_cvt_pk_bf16_f32 v205, v154, v155
  v_mfma_f32_16x16x32_bf16 v[72:75], a[192:195], a[140:143], v[72:75]
  buffer_load_dwordx4 v49, s[4:7], s66 offen offset:1024 lds
  v_cvt_pk_bf16_f32 v206, v156, v157
  v_mfma_f32_16x16x32_bf16 v[68:71], a[196:199], a[136:139], v[68:71]
  ds_read_b64_tr_b16 a[220:221], v215 offset:8192
  ds_read_b64_tr_b16 a[222:223], v215 offset:12288
  v_cvt_pk_bf16_f32 v207, v158, v159
  buffer_store_dwordx4 v[204:207], v38, s[32:35], s23 offen offset:512 sc1
  v_mfma_f32_16x16x32_bf16 v[76:79], a[196:199], a[140:143], v[76:79]
  v_accvgpr_read_b32 v160, a96
  s_waitcnt lgkmcnt(8)
  v_mfma_f32_16x16x32_bf16 v[80:83], a[200:203], a[136:139], v[80:83]
  s_barrier
  ds_read_b64_tr_b16 a[192:193], v208 offset:16384
  ds_read_b64_tr_b16 a[194:195], v208 offset:20480
  v_accvgpr_read_b32 v161, a97
  v_accvgpr_read_b32 v162, a98
  v_mfma_f32_16x16x32_bf16 v[88:91], a[200:203], a[140:143], v[88:91]
  buffer_load_dwordx4 v50, s[4:7], s66 offen offset:2048 lds
  v_accvgpr_read_b32 v163, a99
  v_accvgpr_read_b32 v164, a104
  v_mfma_f32_16x16x32_bf16 v[84:87], a[204:207], a[136:139], v[84:87]
  ds_read_b64_tr_b16 a[196:197], v209 offset:16384
  ds_read_b64_tr_b16 a[198:199], v209 offset:20480
  v_accvgpr_read_b32 v165, a105
  v_mfma_f32_16x16x32_bf16 v[92:95], a[204:207], a[140:143], v[92:95]
  v_accvgpr_read_b32 v166, a106
  v_accvgpr_read_b32 v167, a107
  s_waitcnt lgkmcnt(8)
  v_mfma_f32_16x16x32_bf16 v[96:99], a[208:211], a[136:139], v[96:99]
  ds_read_b64_tr_b16 a[200:201], v210 offset:16384
  ds_read_b64_tr_b16 a[202:203], v210 offset:20480
  v_mul_f32 v160, v160, v28
  v_mul_f32 v161, v161, v28
  v_mfma_f32_16x16x32_bf16 v[104:107], a[208:211], a[140:143], v[104:107]
  buffer_load_dwordx4 v51, s[4:7], s66 offen offset:3072 lds
  s_add_u32 s66, s66, 458752
  s_cmp_eq_u32 s66, 14680064
  s_cselect_b32 s66, 0, s66
  v_mul_f32 v162, v162, v28
  v_mfma_f32_16x16x32_bf16 v[100:103], a[212:215], a[136:139], v[100:103]
  ds_read_b64_tr_b16 a[204:205], v211 offset:16384
  ds_read_b64_tr_b16 a[206:207], v211 offset:20480
  v_mul_f32 v163, v163, v28
  v_mul_f32 v164, v164, v28
  v_mfma_f32_16x16x32_bf16 v[108:111], a[212:215], a[140:143], v[108:111]
  v_mul_f32 v165, v165, v28
  s_waitcnt lgkmcnt(8)
  v_mfma_f32_16x16x32_bf16 v[112:115], a[216:219], a[136:139], v[112:115]
  ds_read_b64_tr_b16 a[208:209], v212 offset:16384
  ds_read_b64_tr_b16 a[210:211], v212 offset:20480
  v_mul_f32 v166, v166, v28
  v_mul_f32 v167, v167, v28
  v_mfma_f32_16x16x32_bf16 v[120:123], a[216:219], a[140:143], v[120:123]
  buffer_load_dwordx4 a[128:131], v3, s[44:47], s67 offen offset:0 sc1
  v_cvt_pk_bf16_f32 v192, v160, v161
  v_cvt_pk_bf16_f32 v193, v162, v163
  v_mfma_f32_16x16x32_bf16 v[116:119], a[220:223], a[136:139], v[116:119]
  ds_read_b64_tr_b16 a[212:213], v213 offset:16384
  ds_read_b64_tr_b16 a[214:215], v213 offset:20480
  v_cvt_pk_bf16_f32 v194, v164, v165
  v_mfma_f32_16x16x32_bf16 v[124:127], a[220:223], a[140:143], v[124:127]
  v_cvt_pk_bf16_f32 v195, v166, v167
  buffer_store_dwordx4 v[192:195], v38, s[32:35], s65 offen offset:2048 sc1
  s_waitcnt vmcnt(31) lgkmcnt(8)
  v_mfma_f32_16x16x32_bf16 v[64:67], a[192:195], a[144:147], v[64:67]
  ds_read_b64_tr_b16 a[216:217], v214 offset:16384
  ds_read_b64_tr_b16 a[218:219], v214 offset:20480
  v_accvgpr_read_b32 v168, a100
  v_mfma_f32_16x16x32_bf16 v[72:75], a[192:195], a[148:151], v[72:75]
  buffer_load_dwordx4 a[132:135], v3, s[44:47], s67 offen offset:1024 sc1
  v_accvgpr_read_b32 v169, a101
  v_accvgpr_read_b32 v170, a102
  v_mfma_f32_16x16x32_bf16 v[68:71], a[196:199], a[144:147], v[68:71]
  ds_read_b64_tr_b16 a[220:221], v215 offset:16384
  ds_read_b64_tr_b16 a[222:223], v215 offset:20480
  v_accvgpr_read_b32 v171, a103
  v_accvgpr_read_b32 v172, a108
  v_mfma_f32_16x16x32_bf16 v[76:79], a[196:199], a[148:151], v[76:79]
  v_accvgpr_read_b32 v173, a109
  s_waitcnt lgkmcnt(8)
  v_mfma_f32_16x16x32_bf16 v[80:83], a[200:203], a[144:147], v[80:83]
  ds_read_b64_tr_b16 a[192:193], v208 offset:24576
  ds_read_b64_tr_b16 a[194:195], v208 offset:28672
  v_accvgpr_read_b32 v174, a110
  v_accvgpr_read_b32 v175, a111
  v_mfma_f32_16x16x32_bf16 v[88:91], a[200:203], a[148:151], v[88:91]
  buffer_load_dwordx4 a[136:139], v3, s[44:47], s67 offen offset:2048 sc1
  v_mul_f32 v168, v168, v28
  v_mfma_f32_16x16x32_bf16 v[84:87], a[204:207], a[144:147], v[84:87]
  ds_read_b64_tr_b16 a[196:197], v209 offset:24576
  ds_read_b64_tr_b16 a[198:199], v209 offset:28672
  v_mul_f32 v169, v169, v28
  v_mul_f32 v170, v170, v28
  v_mfma_f32_16x16x32_bf16 v[92:95], a[204:207], a[148:151], v[92:95]
  v_mul_f32 v171, v171, v28
  v_mul_f32 v172, v172, v28
  s_waitcnt lgkmcnt(8)
  v_mfma_f32_16x16x32_bf16 v[96:99], a[208:211], a[144:147], v[96:99]
  ds_read_b64_tr_b16 a[200:201], v210 offset:24576
  ds_read_b64_tr_b16 a[202:203], v210 offset:28672
  v_mul_f32 v173, v173, v28
  v_mfma_f32_16x16x32_bf16 v[104:107], a[208:211], a[148:151], v[104:107]
  buffer_load_dwordx4 a[140:143], v3, s[44:47], s67 offen offset:3072 sc1
  s_add_u32 s67, s67, 4096
  s_cmp_eq_u32 s67, 131072
  s_cselect_b32 s67, 0, s67
  v_mul_f32 v174, v174, v28
  v_mul_f32 v175, v175, v28
  v_mfma_f32_16x16x32_bf16 v[100:103], a[212:215], a[144:147], v[100:103]
  ds_read_b64_tr_b16 a[204:205], v211 offset:24576
  ds_read_b64_tr_b16 a[206:207], v211 offset:28672
  v_cvt_pk_bf16_f32 v196, v168, v169
  v_mfma_f32_16x16x32_bf16 v[108:111], a[212:215], a[148:151], v[108:111]
  s_add_u32 m0, s19, 49152
  v_cvt_pk_bf16_f32 v197, v170, v171
  v_cvt_pk_bf16_f32 v198, v172, v173
  s_waitcnt lgkmcnt(8)
  v_mfma_f32_16x16x32_bf16 v[112:115], a[216:219], a[144:147], v[112:115]
  ds_read_b64_tr_b16 a[208:209], v212 offset:24576
  ds_read_b64_tr_b16 a[210:211], v212 offset:28672
  v_cvt_pk_bf16_f32 v199, v174, v175
  buffer_store_dwordx4 v[196:199], v38, s[32:35], s65 offen offset:2560 sc1
  v_mfma_f32_16x16x32_bf16 v[120:123], a[216:219], a[148:151], v[120:123]
  buffer_load_dwordx4 v48, s[4:7], s66 offen offset:0 lds
  v_accvgpr_read_b32 v176, a112
  v_mfma_f32_16x16x32_bf16 v[116:119], a[220:223], a[144:147], v[116:119]
  ds_read_b64_tr_b16 a[212:213], v213 offset:24576
  ds_read_b64_tr_b16 a[214:215], v213 offset:28672
  v_accvgpr_read_b32 v177, a113
  v_accvgpr_read_b32 v178, a114
  v_mfma_f32_16x16x32_bf16 v[124:127], a[220:223], a[148:151], v[124:127]
  v_accvgpr_read_b32 v179, a115
  v_accvgpr_read_b32 v180, a120
  s_waitcnt vmcnt(33) lgkmcnt(8)
  v_mfma_f32_16x16x32_bf16 v[64:67], a[192:195], a[152:155], v[64:67]
  ds_read_b64_tr_b16 a[216:217], v214 offset:24576
  ds_read_b64_tr_b16 a[218:219], v214 offset:28672
  v_accvgpr_read_b32 v181, a121
  v_mfma_f32_16x16x32_bf16 v[72:75], a[192:195], a[156:159], v[72:75]
  buffer_load_dwordx4 v49, s[4:7], s66 offen offset:1024 lds
  v_accvgpr_read_b32 v182, a122
  v_accvgpr_read_b32 v183, a123
  v_mfma_f32_16x16x32_bf16 v[68:71], a[196:199], a[152:155], v[68:71]
  ds_read_b64_tr_b16 a[220:221], v215 offset:24576
  ds_read_b64_tr_b16 a[222:223], v215 offset:28672
  v_mul_f32 v176, v176, v29
  v_mfma_f32_16x16x32_bf16 v[76:79], a[196:199], a[156:159], v[76:79]
  v_mul_f32 v177, v177, v29
  v_mul_f32 v178, v178, v29
  s_waitcnt lgkmcnt(8)
  v_mfma_f32_16x16x32_bf16 v[80:83], a[200:203], a[152:155], v[80:83]
  s_barrier
  ds_read_b64_tr_b16 a[192:193], v208 offset:32768
  ds_read_b64_tr_b16 a[194:195], v208 offset:36864
  v_mul_f32 v179, v179, v29
  v_mul_f32 v180, v180, v29
  v_mfma_f32_16x16x32_bf16 v[88:91], a[200:203], a[156:159], v[88:91]
  buffer_load_dwordx4 v50, s[4:7], s66 offen offset:2048 lds
  v_mul_f32 v181, v181, v29
  v_mfma_f32_16x16x32_bf16 v[84:87], a[204:207], a[152:155], v[84:87]
  ds_read_b64_tr_b16 a[196:197], v209 offset:32768
  ds_read_b64_tr_b16 a[198:199], v209 offset:36864
  v_mul_f32 v182, v182, v29
  v_mul_f32 v183, v183, v29
  v_mfma_f32_16x16x32_bf16 v[92:95], a[204:207], a[156:159], v[92:95]
  v_cvt_pk_bf16_f32 v200, v176, v177
  s_waitcnt lgkmcnt(8)
  v_mfma_f32_16x16x32_bf16 v[96:99], a[208:211], a[152:155], v[96:99]
  ds_read_b64_tr_b16 a[200:201], v210 offset:32768
  ds_read_b64_tr_b16 a[202:203], v210 offset:36864
  v_cvt_pk_bf16_f32 v201, v178, v179
  v_cvt_pk_bf16_f32 v202, v180, v181
  v_mfma_f32_16x16x32_bf16 v[104:107], a[208:211], a[156:159], v[104:107]
  buffer_load_dwordx4 v51, s[4:7], s66 offen offset:3072 lds
  s_add_u32 s66, s66, 458752
  s_cmp_eq_u32 s66, 14680064
  s_cselect_b32 s66, 0, s66
  v_cvt_pk_bf16_f32 v203, v182, v183
  buffer_store_dwordx4 v[200:203], v38, s[32:35], s23 offen offset:2048 sc1
  v_mfma_f32_16x16x32_bf16 v[100:103], a[212:215], a[152:155], v[100:103]
  ds_read_b64_tr_b16 a[204:205], v211 offset:32768
  ds_read_b64_tr_b16 a[206:207], v211 offset:36864
  v_accvgpr_read_b32 v184, a116
  v_mfma_f32_16x16x32_bf16 v[108:111], a[212:215], a[156:159], v[108:111]
  v_accvgpr_read_b32 v185, a117
  v_accvgpr_read_b32 v186, a118
  s_waitcnt lgkmcnt(8)
  v_mfma_f32_16x16x32_bf16 v[112:115], a[216:219], a[152:155], v[112:115]
  ds_read_b64_tr_b16 a[208:209], v212 offset:32768
  ds_read_b64_tr_b16 a[210:211], v212 offset:36864
  v_accvgpr_read_b32 v187, a119
  v_mfma_f32_16x16x32_bf16 v[120:123], a[216:219], a[156:159], v[120:123]
  buffer_load_dwordx4 a[144:147], v3, s[44:47], s67 offen offset:0 sc1
  v_accvgpr_read_b32 v188, a124
  v_accvgpr_read_b32 v189, a125
  v_mfma_f32_16x16x32_bf16 v[116:119], a[220:223], a[152:155], v[116:119]
  ds_read_b64_tr_b16 a[212:213], v213 offset:32768
  ds_read_b64_tr_b16 a[214:215], v213 offset:36864
  v_accvgpr_read_b32 v190, a126
  v_accvgpr_read_b32 v191, a127
  v_mfma_f32_16x16x32_bf16 v[124:127], a[220:223], a[156:159], v[124:127]
  v_mul_f32 v184, v184, v29
  s_waitcnt vmcnt(30) lgkmcnt(8)
  v_mfma_f32_16x16x32_bf16 v[64:67], a[192:195], a[160:163], v[64:67]
  ds_read_b64_tr_b16 a[216:217], v214 offset:32768
  ds_read_b64_tr_b16 a[218:219], v214 offset:36864
  v_mul_f32 v185, v185, v29
  v_mul_f32 v186, v186, v29
  v_mfma_f32_16x16x32_bf16 v[72:75], a[192:195], a[164:167], v[72:75]
  buffer_load_dwordx4 a[148:151], v3, s[44:47], s67 offen offset:1024 sc1
  v_mul_f32 v187, v187, v29
  v_mfma_f32_16x16x32_bf16 v[68:71], a[196:199], a[160:163], v[68:71]
  ds_read_b64_tr_b16 a[220:221], v215 offset:32768
  ds_read_b64_tr_b16 a[222:223], v215 offset:36864
  v_mul_f32 v188, v188, v29
  v_mul_f32 v189, v189, v29
  v_mfma_f32_16x16x32_bf16 v[76:79], a[196:199], a[164:167], v[76:79]
  v_mul_f32 v190, v190, v29
  v_mul_f32 v191, v191, v29
  s_waitcnt lgkmcnt(8)
  v_mfma_f32_16x16x32_bf16 v[80:83], a[200:203], a[160:163], v[80:83]
  ds_read_b64_tr_b16 a[192:193], v208 offset:40960
  ds_read_b64_tr_b16 a[194:195], v208 offset:45056
  v_cvt_pk_bf16_f32 v204, v184, v185
  v_mfma_f32_16x16x32_bf16 v[88:91], a[200:203], a[164:167], v[88:91]
  buffer_load_dwordx4 a[152:155], v3, s[44:47], s67 offen offset:2048 sc1
  v_cvt_pk_bf16_f32 v205, v186, v187
  v_cvt_pk_bf16_f32 v206, v188, v189
  v_mfma_f32_16x16x32_bf16 v[84:87], a[204:207], a[160:163], v[84:87]
  ds_read_b64_tr_b16 a[196:197], v209 offset:40960
  ds_read_b64_tr_b16 a[198:199], v209 offset:45056
  v_cvt_pk_bf16_f32 v207, v190, v191
  buffer_store_dwordx4 v[204:207], v38, s[32:35], s23 offen offset:2560 sc1
  v_mfma_f32_16x16x32_bf16 v[92:95], a[204:207], a[164:167], v[92:95]
  s_waitcnt lgkmcnt(8)
  v_mfma_f32_16x16x32_bf16 v[96:99], a[208:211], a[160:163], v[96:99]
  ds_read_b64_tr_b16 a[200:201], v210 offset:40960
  ds_read_b64_tr_b16 a[202:203], v210 offset:45056
  v_mfma_f32_16x16x32_bf16 v[104:107], a[208:211], a[164:167], v[104:107]
  buffer_load_dwordx4 a[156:159], v3, s[44:47], s67 offen offset:3072 sc1
  s_add_u32 s67, s67, 4096
  s_cmp_eq_u32 s67, 131072
  s_cselect_b32 s67, 0, s67
  v_mfma_f32_16x16x32_bf16 v[100:103], a[212:215], a[160:163], v[100:103]
  ds_read_b64_tr_b16 a[204:205], v211 offset:40960
  ds_read_b64_tr_b16 a[206:207], v211 offset:45056
  v_mfma_f32_16x16x32_bf16 v[108:111], a[212:215], a[164:167], v[108:111]
  s_add_u32 m0, s19, 65536
  s_waitcnt lgkmcnt(8)
  v_mfma_f32_16x16x32_bf16 v[112:115], a[216:219], a[160:163], v[112:115]
  ds_read_b64_tr_b16 a[208:209], v212 offset:40960
  ds_read_b64_tr_b16 a[210:211], v212 offset:45056
  v_mfma_f32_16x16x32_bf16 v[120:123], a[216:219], a[164:167], v[120:123]
  buffer_load_dwordx4 v48, s[4:7], s66 offen offset:0 lds
  v_mfma_f32_16x16x32_bf16 v[116:119], a[220:223], a[160:163], v[116:119]
  ds_read_b64_tr_b16 a[212:213], v213 offset:40960
  ds_read_b64_tr_b16 a[214:215], v213 offset:45056
  v_mfma_f32_16x16x32_bf16 v[124:127], a[220:223], a[164:167], v[124:127]
  s_waitcnt vmcnt(33) lgkmcnt(8)
  v_mfma_f32_16x16x32_bf16 v[64:67], a[192:195], a[168:171], v[64:67]
  ds_read_b64_tr_b16 a[216:217], v214 offset:40960
  ds_read_b64_tr_b16 a[218:219], v214 offset:45056
  v_mfma_f32_16x16x32_bf16 v[72:75], a[192:195], a[172:175], v[72:75]
  buffer_load_dwordx4 v49, s[4:7], s66 offen offset:1024 lds
  v_mfma_f32_16x16x32_bf16 v[68:71], a[196:199], a[168:171], v[68:71]
  ds_read_b64_tr_b16 a[220:221], v215 offset:40960
  ds_read_b64_tr_b16 a[222:223], v215 offset:45056
  v_mfma_f32_16x16x32_bf16 v[76:79], a[196:199], a[172:175], v[76:79]
  s_waitcnt lgkmcnt(8)
  v_mfma_f32_16x16x32_bf16 v[80:83], a[200:203], a[168:171], v[80:83]
  s_barrier
  ds_read_b64_tr_b16 a[192:193], v208 offset:49152
  ds_read_b64_tr_b16 a[194:195], v208 offset:53248
  v_mfma_f32_16x16x32_bf16 v[88:91], a[200:203], a[172:175], v[88:91]
  buffer_load_dwordx4 v50, s[4:7], s66 offen offset:2048 lds
  v_mfma_f32_16x16x32_bf16 v[84:87], a[204:207], a[168:171], v[84:87]
  ds_read_b64_tr_b16 a[196:197], v209 offset:49152
  ds_read_b64_tr_b16 a[198:199], v209 offset:53248
  v_mfma_f32_16x16x32_bf16 v[92:95], a[204:207], a[172:175], v[92:95]
  s_waitcnt lgkmcnt(8)
  v_mfma_f32_16x16x32_bf16 v[96:99], a[208:211], a[168:171], v[96:99]
  ds_read_b64_tr_b16 a[200:201], v210 offset:49152
  ds_read_b64_tr_b16 a[202:203], v210 offset:53248
  v_mfma_f32_16x16x32_bf16 v[104:107], a[208:211], a[172:175], v[104:107]
  buffer_load_dwordx4 v51, s[4:7], s66 offen offset:3072 lds
  s_add_u32 s66, s66, 458752
  s_cmp_eq_u32 s66, 14680064
  s_cselect_b32 s66, 0, s66
  v_mfma_f32_16x16x32_bf16 v[100:103], a[212:215], a[168:171], v[100:103]
  ds_read_b64_tr_b16 a[204:205], v211 offset:49152
  ds_read_b64_tr_b16 a[206:207], v211 offset:53248
  v_mfma_f32_16x16x32_bf16 v[108:111], a[212:215], a[172:175], v[108:111]
  s_waitcnt lgkmcnt(8)
  v_mfma_f32_16x16x32_bf16 v[112:115], a[216:219], a[168:171], v[112:115]
  ds_read_b64_tr_b16 a[208:209], v212 offset:49152
  ds_read_b64_tr_b16 a[210:211], v212 offset:53248
  v_mfma_f32_16x16x32_bf16 v[120:123], a[216:219], a[172:175], v[120:123]
  buffer_load_dwordx4 a[160:163], v3, s[44:47], s67 offen offset:0 sc1
  v_mfma_f32_16x16x32_bf16 v[116:119], a[220:223], a[168:171], v[116:119]
  ds_read_b64_tr_b16 a[212:213], v213 offset:49152
  ds_read_b64_tr_b16 a[214:215], v213 offset:53248
  v_mfma_f32_16x16x32_bf16 v[124:127], a[220:223], a[172:175], v[124:127]
  s_waitcnt vmcnt(29) lgkmcnt(8)
  v_mfma_f32_16x16x32_bf16 v[64:67], a[192:195], a[176:179], v[64:67]
  ds_read_b64_tr_b16 a[216:217], v214 offset:49152
  ds_read_b64_tr_b16 a[218:219], v214 offset:53248
  v_mfma_f32_16x16x32_bf16 v[72:75], a[192:195], a[180:183], v[72:75]
  buffer_load_dwordx4 a[164:167], v3, s[44:47], s67 offen offset:1024 sc1
  v_mfma_f32_16x16x32_bf16 v[68:71], a[196:199], a[176:179], v[68:71]
  ds_read_b64_tr_b16 a[220:221], v215 offset:49152
  ds_read_b64_tr_b16 a[222:223], v215 offset:53248
  v_mfma_f32_16x16x32_bf16 v[76:79], a[196:199], a[180:183], v[76:79]
  s_waitcnt lgkmcnt(8)
  v_mfma_f32_16x16x32_bf16 v[80:83], a[200:203], a[176:179], v[80:83]
  ds_read_b64_tr_b16 a[192:193], v208 offset:57344
  ds_read_b64_tr_b16 a[194:195], v208 offset:61440
  v_mfma_f32_16x16x32_bf16 v[88:91], a[200:203], a[180:183], v[88:91]
  buffer_load_dwordx4 a[168:171], v3, s[44:47], s67 offen offset:2048 sc1
  v_mfma_f32_16x16x32_bf16 v[84:87], a[204:207], a[176:179], v[84:87]
  ds_read_b64_tr_b16 a[196:197], v209 offset:57344
  ds_read_b64_tr_b16 a[198:199], v209 offset:61440
  v_mfma_f32_16x16x32_bf16 v[92:95], a[204:207], a[180:183], v[92:95]
  s_waitcnt lgkmcnt(8)
  v_mfma_f32_16x16x32_bf16 v[96:99], a[208:211], a[176:179], v[96:99]
  ds_read_b64_tr_b16 a[200:201], v210 offset:57344
  ds_read_b64_tr_b16 a[202:203], v210 offset:61440
  v_mfma_f32_16x16x32_bf16 v[104:107], a[208:211], a[180:183], v[104:107]
  buffer_load_dwordx4 a[172:175], v3, s[44:47], s67 offen offset:3072 sc1
  s_add_u32 s67, s67, 4096
  s_cmp_eq_u32 s67, 131072
  s_cselect_b32 s67, 0, s67
  v_mfma_f32_16x16x32_bf16 v[100:103], a[212:215], a[176:179], v[100:103]
  ds_read_b64_tr_b16 a[204:205], v211 offset:57344
  ds_read_b64_tr_b16 a[206:207], v211 offset:61440
  v_mfma_f32_16x16x32_bf16 v[108:111], a[212:215], a[180:183], v[108:111]
  s_add_u32 m0, s19, 81920
  s_waitcnt lgkmcnt(8)
  v_mfma_f32_16x16x32_bf16 v[112:115], a[216:219], a[176:179], v[112:115]
  ds_read_b64_tr_b16 a[208:209], v212 offset:57344
  ds_read_b64_tr_b16 a[210:211], v212 offset:61440
  v_mfma_f32_16x16x32_bf16 v[120:123], a[216:219], a[180:183], v[120:123]
  buffer_load_dwordx4 v48, s[4:7], s66 offen offset:0 lds
  v_mfma_f32_16x16x32_bf16 v[116:119], a[220:223], a[176:179], v[116:119]
  ds_read_b64_tr_b16 a[212:213], v213 offset:57344
  ds_read_b64_tr_b16 a[214:215], v213 offset:61440
  v_mfma_f32_16x16x32_bf16 v[124:127], a[220:223], a[180:183], v[124:127]
  s_waitcnt vmcnt(30) lgkmcnt(8)
  v_mfma_f32_16x16x32_bf16 v[64:67], a[192:195], a[184:187], v[64:67]
  ds_read_b64_tr_b16 a[216:217], v214 offset:57344
  ds_read_b64_tr_b16 a[218:219], v214 offset:61440
  v_mfma_f32_16x16x32_bf16 v[72:75], a[192:195], a[188:191], v[72:75]
  buffer_load_dwordx4 v49, s[4:7], s66 offen offset:1024 lds
  v_mfma_f32_16x16x32_bf16 v[68:71], a[196:199], a[184:187], v[68:71]
  ds_read_b64_tr_b16 a[220:221], v215 offset:57344
  ds_read_b64_tr_b16 a[222:223], v215 offset:61440
  v_mfma_f32_16x16x32_bf16 v[76:79], a[196:199], a[188:191], v[76:79]
  s_waitcnt lgkmcnt(8)
  v_mfma_f32_16x16x32_bf16 v[80:83], a[200:203], a[184:187], v[80:83]
  s_waitcnt vmcnt(11)
  s_barrier
  s_cmp_lg_u32 s16, 0
  s_cbranch_scc1 L_mk2_nopub_41
  v_mov_b32 v1, s101
  v_mov_b32 v56, s42
  s_mov_b64 exec, 1
  buffer_store_dword v56, v1, s[52:55], 0 offen sc1
  s_mov_b64 exec, -1
  s_nop 3
L_mk2_nopub_41:
  ds_read_b64_tr_b16 a[192:193], v8 offset:0
  ds_read_b64_tr_b16 a[194:195], v8 offset:4096
  v_mfma_f32_16x16x32_bf16 v[88:91], a[200:203], a[188:191], v[88:91]
  buffer_load_dwordx4 v50, s[4:7], s66 offen offset:2048 lds
  v_mfma_f32_16x16x32_bf16 v[84:87], a[204:207], a[184:187], v[84:87]
  ds_read_b64_tr_b16 a[196:197], v9 offset:0
  ds_read_b64_tr_b16 a[198:199], v9 offset:4096
  v_mfma_f32_16x16x32_bf16 v[92:95], a[204:207], a[188:191], v[92:95]
  s_waitcnt lgkmcnt(8)
  v_mfma_f32_16x16x32_bf16 v[96:99], a[208:211], a[184:187], v[96:99]
  ds_read_b64_tr_b16 a[200:201], v10 offset:0
  ds_read_b64_tr_b16 a[202:203], v10 offset:4096
  v_mfma_f32_16x16x32_bf16 v[104:107], a[208:211], a[188:191], v[104:107]
  buffer_load_dwordx4 v51, s[4:7], s66 offen offset:3072 lds
  s_add_u32 s66, s66, 458752
  s_cmp_eq_u32 s66, 14680064
  s_cselect_b32 s66, 0, s66
  v_mfma_f32_16x16x32_bf16 v[100:103], a[212:215], a[184:187], v[100:103]
  ds_read_b64_tr_b16 a[204:205], v11 offset:0
  ds_read_b64_tr_b16 a[206:207], v11 offset:4096
  v_mfma_f32_16x16x32_bf16 v[108:111], a[212:215], a[188:191], v[108:111]
  buffer_load_dwordx4 a[176:179], v3, s[44:47], s67 offen offset:0 sc1
  s_waitcnt lgkmcnt(8)
  v_mfma_f32_16x16x32_bf16 v[112:115], a[216:219], a[184:187], v[112:115]
  ds_read_b64_tr_b16 a[208:209], v40 offset:0
  ds_read_b64_tr_b16 a[210:211], v40 offset:4096
  v_mfma_f32_16x16x32_bf16 v[120:123], a[216:219], a[188:191], v[120:123]
  buffer_load_dwordx4 a[180:183], v3, s[44:47], s67 offen offset:1024 sc1
  v_mfma_f32_16x16x32_bf16 v[116:119], a[220:223], a[184:187], v[116:119]
  ds_read_b64_tr_b16 a[212:213], v41 offset:0
  ds_read_b64_tr_b16 a[214:215], v41 offset:4096
  v_mfma_f32_16x16x32_bf16 v[124:127], a[220:223], a[188:191], v[124:127]
  s_mov_b32 s20, 2
L_mk2_m_42:
  s_waitcnt vmcnt(24) lgkmcnt(8)
  v_mfma_f32_16x16x32_bf16 v[64:67], a[192:195], a[128:131], v[64:67]
  ds_read_b64_tr_b16 a[216:217], v42 offset:0
  ds_read_b64_tr_b16 a[218:219], v42 offset:4096
  v_mfma_f32_16x16x32_bf16 v[72:75], a[192:195], a[132:135], v[72:75]
  buffer_load_dwordx4 a[184:187], v3, s[44:47], s67 offen offset:2048 sc1
  v_mfma_f32_16x16x32_bf16 v[68:71], a[196:199], a[128:131], v[68:71]
  ds_read_b64_tr_b16 a[220:221], v43 offset:0
  ds_read_b64_tr_b16 a[222:223], v43 offset:4096
  v_mfma_f32_16x16x32_bf16 v[76:79], a[196:199], a[132:135], v[76:79]
  s_waitcnt lgkmcnt(8)
  v_mfma_f32_16x16x32_bf16 v[80:83], a[200:203], a[128:131], v[80:83]
  ds_read_b64_tr_b16 a[192:193], v8 offset:8192
  ds_read_b64_tr_b16 a[194:195], v8 offset:12288
  v_mfma_f32_16x16x32_bf16 v[88:91], a[200:203], a[132:135], v[88:91]
  buffer_load_dwordx4 a[188:191], v3, s[44:47], s67 offen offset:3072 sc1
  s_add_u32 s67, s67, 4096
  s_cmp_eq_u32 s67, 131072
  s_cselect_b32 s67, 0, s67
  v_mfma_f32_16x16x32_bf16 v[84:87], a[204:207], a[128:131], v[84:87]
  ds_read_b64_tr_b16 a[196:197], v9 offset:8192
  ds_read_b64_tr_b16 a[198:199], v9 offset:12288
  v_mfma_f32_16x16x32_bf16 v[92:95], a[204:207], a[132:135], v[92:95]
  s_add_u32 m0, s19, 98304
  s_waitcnt lgkmcnt(8)
  v_mfma_f32_16x16x32_bf16 v[96:99], a[208:211], a[128:131], v[96:99]
  ds_read_b64_tr_b16 a[200:201], v10 offset:8192
  ds_read_b64_tr_b16 a[202:203], v10 offset:12288
  v_mfma_f32_16x16x32_bf16 v[104:107], a[208:211], a[132:135], v[104:107]
  buffer_load_dwordx4 v48, s[4:7], s66 offen offset:0 lds
  v_mfma_f32_16x16x32_bf16 v[100:103], a[212:215], a[128:131], v[100:103]
  ds_read_b64_tr_b16 a[204:205], v11 offset:8192
  ds_read_b64_tr_b16 a[206:207], v11 offset:12288
  v_mfma_f32_16x16x32_bf16 v[108:111], a[212:215], a[132:135], v[108:111]
  s_waitcnt lgkmcnt(8)
  v_mfma_f32_16x16x32_bf16 v[112:115], a[216:219], a[128:131], v[112:115]
  ds_read_b64_tr_b16 a[208:209], v40 offset:8192
  ds_read_b64_tr_b16 a[210:211], v40 offset:12288
  v_mfma_f32_16x16x32_bf16 v[120:123], a[216:219], a[132:135], v[120:123]
  buffer_load_dwordx4 v49, s[4:7], s66 offen offset:1024 lds
  v_mfma_f32_16x16x32_bf16 v[116:119], a[220:223], a[128:131], v[116:119]
  ds_read_b64_tr_b16 a[212:213], v41 offset:8192
  ds_read_b64_tr_b16 a[214:215], v41 offset:12288
  v_mfma_f32_16x16x32_bf16 v[124:127], a[220:223], a[132:135], v[124:127]
  s_waitcnt vmcnt(26) lgkmcnt(8)
  v_mfma_f32_16x16x32_bf16 v[64:67], a[192:195], a[136:139], v[64:67]
  ds_read_b64_tr_b16 a[216:217], v42 offset:8192
  ds_read_b64_tr_b16 a[218:219], v42 offset:12288
  v_mfma_f32_16x16x32_bf16 v[72:75], a[192:195], a[140:143], v[72:75]
  buffer_load_dwordx4 v50, s[4:7], s66 offen offset:2048 lds
  v_mfma_f32_16x16x32_bf16 v[68:71], a[196:199], a[136:139], v[68:71]
  ds_read_b64_tr_b16 a[220:221], v43 offset:8192
  ds_read_b64_tr_b16 a[222:223], v43 offset:12288
  v_mfma_f32_16x16x32_bf16 v[76:79], a[196:199], a[140:143], v[76:79]
  s_waitcnt lgkmcnt(8)
  v_mfma_f32_16x16x32_bf16 v[80:83], a[200:203], a[136:139], v[80:83]
  s_barrier
  ds_read_b64_tr_b16 a[192:193], v8 offset:16384
  ds_read_b64_tr_b16 a[194:195], v8 offset:20480
  v_mfma_f32_16x16x32_bf16 v[88:91], a[200:203], a[140:143], v[88:91]
  buffer_load_dwordx4 v51, s[4:7], s66 offen offset:3072 lds
  s_add_u32 s66, s66, 458752
  s_cmp_eq_u32 s66, 14680064
  s_cselect_b32 s66, 0, s66
  v_mfma_f32_16x16x32_bf16 v[84:87], a[204:207], a[136:139], v[84:87]
  ds_read_b64_tr_b16 a[196:197], v9 offset:16384
  ds_read_b64_tr_b16 a[198:199], v9 offset:20480
  v_mfma_f32_16x16x32_bf16 v[92:95], a[204:207], a[140:143], v[92:95]
  s_waitcnt lgkmcnt(8)
  v_mfma_f32_16x16x32_bf16 v[96:99], a[208:211], a[136:139], v[96:99]
  ds_read_b64_tr_b16 a[200:201], v10 offset:16384
  ds_read_b64_tr_b16 a[202:203], v10 offset:20480
  v_mfma_f32_16x16x32_bf16 v[104:107], a[208:211], a[140:143], v[104:107]
  buffer_load_dwordx4 a[128:131], v3, s[44:47], s67 offen offset:0 sc1
  v_mfma_f32_16x16x32_bf16 v[100:103], a[212:215], a[136:139], v[100:103]
  ds_read_b64_tr_b16 a[204:205], v11 offset:16384
  ds_read_b64_tr_b16 a[206:207], v11 offset:20480
  v_mfma_f32_16x16x32_bf16 v[108:111], a[212:215], a[140:143], v[108:111]
  s_waitcnt lgkmcnt(8)
  v_mfma_f32_16x16x32_bf16 v[112:115], a[216:219], a[136:139], v[112:115]
  ds_read_b64_tr_b16 a[208:209], v40 offset:16384
  ds_read_b64_tr_b16 a[210:211], v40 offset:20480
  v_mfma_f32_16x16x32_bf16 v[120:123], a[216:219], a[140:143], v[120:123]
  buffer_load_dwordx4 a[132:135], v3, s[44:47], s67 offen offset:1024 sc1
  v_mfma_f32_16x16x32_bf16 v[116:119], a[220:223], a[136:139], v[116:119]
  ds_read_b64_tr_b16 a[212:213], v41 offset:16384
  ds_read_b64_tr_b16 a[214:215], v41 offset:20480
  v_mfma_f32_16x16x32_bf16 v[124:127], a[220:223], a[140:143], v[124:127]
  s_waitcnt vmcnt(24) lgkmcnt(8)
  v_mfma_f32_16x16x32_bf16 v[64:67], a[192:195], a[144:147], v[64:67]
  ds_read_b64_tr_b16 a[216:217], v42 offset:16384
  ds_read_b64_tr_b16 a[218:219], v42 offset:20480
  v_mfma_f32_16x16x32_bf16 v[72:75], a[192:195], a[148:151], v[72:75]
  buffer_load_dwordx4 a[136:139], v3, s[44:47], s67 offen offset:2048 sc1
  v_mfma_f32_16x16x32_bf16 v[68:71], a[196:199], a[144:147], v[68:71]
  ds_read_b64_tr_b16 a[220:221], v43 offset:16384
  ds_read_b64_tr_b16 a[222:223], v43 offset:20480
  v_mfma_f32_16x16x32_bf16 v[76:79], a[196:199], a[148:151], v[76:79]
  s_waitcnt lgkmcnt(8)
  v_mfma_f32_16x16x32_bf16 v[80:83], a[200:203], a[144:147], v[80:83]
  ds_read_b64_tr_b16 a[192:193], v8 offset:24576
  ds_read_b64_tr_b16 a[194:195], v8 offset:28672
  v_mfma_f32_16x16x32_bf16 v[88:91], a[200:203], a[148:151], v[88:91]
  buffer_load_dwordx4 a[140:143], v3, s[44:47], s67 offen offset:3072 sc1
  s_add_u32 s67, s67, 4096
  s_cmp_eq_u32 s67, 131072
  s_cselect_b32 s67, 0, s67
  v_mfma_f32_16x16x32_bf16 v[84:87], a[204:207], a[144:147], v[84:87]
  ds_read_b64_tr_b16 a[196:197], v9 offset:24576
  ds_read_b64_tr_b16 a[198:199], v9 offset:28672
  v_mfma_f32_16x16x32_bf16 v[92:95], a[204:207], a[148:151], v[92:95]
  s_add_u32 m0, s19, 114688
  s_waitcnt lgkmcnt(8)
  v_mfma_f32_16x16x32_bf16 v[96:99], a[208:211], a[144:147], v[96:99]
  ds_read_b64_tr_b16 a[200:201], v10 offset:24576
  ds_read_b64_tr_b16 a[202:203], v10 offset:28672
  v_mfma_f32_16x16x32_bf16 v[104:107], a[208:211], a[148:151], v[104:107]
  buffer_load_dwordx4 v48, s[4:7], s66 offen offset:0 lds
  v_mfma_f32_16x16x32_bf16 v[100:103], a[212:215], a[144:147], v[100:103]
  ds_read_b64_tr_b16 a[204:205], v11 offset:24576
  ds_read_b64_tr_b16 a[206:207], v11 offset:28672
  v_mfma_f32_16x16x32_bf16 v[108:111], a[212:215], a[148:151], v[108:111]
  s_waitcnt lgkmcnt(8)
  v_mfma_f32_16x16x32_bf16 v[112:115], a[216:219], a[144:147], v[112:115]
  ds_read_b64_tr_b16 a[208:209], v40 offset:24576
  ds_read_b64_tr_b16 a[210:211], v40 offset:28672
  v_mfma_f32_16x16x32_bf16 v[120:123], a[216:219], a[148:151], v[120:123]
  buffer_load_dwordx4 v49, s[4:7], s66 offen offset:1024 lds
  v_mfma_f32_16x16x32_bf16 v[116:119], a[220:223], a[144:147], v[116:119]
  ds_read_b64_tr_b16 a[212:213], v41 offset:24576
  ds_read_b64_tr_b16 a[214:215], v41 offset:28672
  v_mfma_f32_16x16x32_bf16 v[124:127], a[220:223], a[148:151], v[124:127]
  s_waitcnt vmcnt(26) lgkmcnt(8)
  v_mfma_f32_16x16x32_bf16 v[64:67], a[192:195], a[152:155], v[64:67]
  ds_read_b64_tr_b16 a[216:217], v42 offset:24576
  ds_read_b64_tr_b16 a[218:219], v42 offset:28672
  v_mfma_f32_16x16x32_bf16 v[72:75], a[192:195], a[156:159], v[72:75]
  buffer_load_dwordx4 v50, s[4:7], s66 offen offset:2048 lds
  v_mfma_f32_16x16x32_bf16 v[68:71], a[196:199], a[152:155], v[68:71]
  ds_read_b64_tr_b16 a[220:221], v43 offset:24576
  ds_read_b64_tr_b16 a[222:223], v43 offset:28672
  v_mfma_f32_16x16x32_bf16 v[76:79], a[196:199], a[156:159], v[76:79]
  s_waitcnt lgkmcnt(8)
  v_mfma_f32_16x16x32_bf16 v[80:83], a[200:203], a[152:155], v[80:83]
  s_barrier
  ds_read_b64_tr_b16 a[192:193], v8 offset:32768
  ds_read_b64_tr_b16 a[194:195], v8 offset:36864
  v_mfma_f32_16x16x32_bf16 v[88:91], a[200:203], a[156:159], v[88:91]
  buffer_load_dwordx4 v51, s[4:7], s66 offen offset:3072 lds
  s_add_u32 s66, s66, 458752
  s_cmp_eq_u32 s66, 14680064
  s_cselect_b32 s66, 0, s66
  v_mfma_f32_16x16x32_bf16 v[84:87], a[204:207], a[152:155], v[84:87]
  ds_read_b64_tr_b16 a[196:197], v9 offset:32768
  ds_read_b64_tr_b16 a[198:199], v9 offset:36864
  v_mfma_f32_16x16x32_bf16 v[92:95], a[204:207], a[156:159], v[92:95]
  s_waitcnt lgkmcnt(8)
  v_mfma_f32_16x16x32_bf16 v[96:99], a[208:211], a[152:155], v[96:99]
  ds_read_b64_tr_b16 a[200:201], v10 offset:32768
  ds_read_b64_tr_b16 a[202:203], v10 offset:36864
  v_mfma_f32_16x16x32_bf16 v[104:107], a[208:211], a[156:159], v[104:107]
  buffer_load_dwordx4 a[144:147], v3, s[44:47], s67 offen offset:0 sc1
  v_mfma_f32_16x16x32_bf16 v[100:103], a[212:215], a[152:155], v[100:103]
  ds_read_b64_tr_b16 a[204:205], v11 offset:32768
  ds_read_b64_tr_b16 a[206:207], v11 offset:36864
  v_mfma_f32_16x16x32_bf16 v[108:111], a[212:215], a[156:159], v[108:111]
  s_waitcnt lgkmcnt(8)
  v_mfma_f32_16x16x32_bf16 v[112:115], a[216:219], a[152:155], v[112:115]
  ds_read_b64_tr_b16 a[208:209], v40 offset:32768
  ds_read_b64_tr_b16 a[210:211], v40 offset:36864
  v_mfma_f32_16x16x32_bf16 v[120:123], a[216:219], a[156:159], v[120:123]
  buffer_load_dwordx4 a[148:151], v3, s[44:47], s67 offen offset:1024 sc1
  v_mfma_f32_16x16x32_bf16 v[116:119], a[220:223], a[152:155], v[116:119]
  ds_read_b64_tr_b16 a[212:213], v41 offset:32768
  ds_read_b64_tr_b16 a[214:215], v41 offset:36864
  v_mfma_f32_16x16x32_bf16 v[124:127], a[220:223], a[156:159], v[124:127]
  s_waitcnt vmcnt(24) lgkmcnt(8)
  v_mfma_f32_16x16x32_bf16 v[64:67], a[192:195], a[160:163], v[64:67]
  ds_read_b64_tr_b16 a[216:217], v42 offset:32768
  ds_read_b64_tr_b16 a[218:219], v42 offset:36864
  v_mfma_f32_16x16x32_bf16 v[72:75], a[192:195], a[164:167], v[72:75]
  buffer_load_dwordx4 a[152:155], v3, s[44:47], s67 offen offset:2048 sc1
  v_mfma_f32_16x16x32_bf16 v[68:71], a[196:199], a[160:163], v[68:71]
  ds_read_b64_tr_b16 a[220:221], v43 offset:32768
  ds_read_b64_tr_b16 a[222:223], v43 offset:36864
  v_mfma_f32_16x16x32_bf16 v[76:79], a[196:199], a[164:167], v[76:79]
  s_waitcnt lgkmcnt(8)
  v_mfma_f32_16x16x32_bf16 v[80:83], a[200:203], a[160:163], v[80:83]
  ds_read_b64_tr_b16 a[192:193], v8 offset:40960
  ds_read_b64_tr_b16 a[194:195], v8 offset:45056
  v_mfma_f32_16x16x32_bf16 v[88:91], a[200:203], a[164:167], v[88:91]
  buffer_load_dwordx4 a[156:159], v3, s[44:47], s67 offen offset:3072 sc1
  s_add_u32 s67, s67, 4096
  s_cmp_eq_u32 s67, 131072
  s_cselect_b32 s67, 0, s67
  v_mfma_f32_16x16x32_bf16 v[84:87], a[204:207], a[160:163], v[84:87]
  ds_read_b64_tr_b16 a[196:197], v9 offset:40960
  ds_read_b64_tr_b16 a[198:199], v9 offset:45056
  v_mfma_f32_16x16x32_bf16 v[92:95], a[204:207], a[164:167], v[92:95]
  s_add_u32 m0, s19, 0
  s_waitcnt lgkmcnt(8)
  v_mfma_f32_16x16x32_bf16 v[96:99], a[208:211], a[160:163], v[96:99]
  ds_read_b64_tr_b16 a[200:201], v10 offset:40960
  ds_read_b64_tr_b16 a[202:203], v10 offset:45056
  v_mfma_f32_16x16x32_bf16 v[104:107], a[208:211], a[164:167], v[104:107]
  buffer_load_dwordx4 v48, s[4:7], s66 offen offset:0 lds
  v_mfma_f32_16x16x32_bf16 v[100:103], a[212:215], a[160:163], v[100:103]
  ds_read_b64_tr_b16 a[204:205], v11 offset:40960
  ds_read_b64_tr_b16 a[206:207], v11 offset:45056
  v_mfma_f32_16x16x32_bf16 v[108:111], a[212:215], a[164:167], v[108:111]
  s_waitcnt lgkmcnt(8)
  v_mfma_f32_16x16x32_bf16 v[112:115], a[216:219], a[160:163], v[112:115]
  ds_read_b64_tr_b16 a[208:209], v40 offset:40960
  ds_read_b64_tr_b16 a[210:211], v40 offset:45056
  v_mfma_f32_16x16x32_bf16 v[120:123], a[216:219], a[164:167], v[120:123]
  buffer_load_dwordx4 v49, s[4:7], s66 offen offset:1024 lds
  v_mfma_f32_16x16x32_bf16 v[116:119], a[220:223], a[160:163], v[116:119]
  ds_read_b64_tr_b16 a[212:213], v41 offset:40960
  ds_read_b64_tr_b16 a[214:215], v41 offset:45056
  v_mfma_f32_16x16x32_bf16 v[124:127], a[220:223], a[164:167], v[124:127]
  s_waitcnt vmcnt(26) lgkmcnt(8)
  v_mfma_f32_16x16x32_bf16 v[64:67], a[192:195], a[168:171], v[64:67]
  ds_read_b64_tr_b16 a[216:217], v42 offset:40960
  ds_read_b64_tr_b16 a[218:219], v42 offset:45056
  v_mfma_f32_16x16x32_bf16 v[72:75], a[192:195], a[172:175], v[72:75]
  buffer_load_dwordx4 v50, s[4:7], s66 offen offset:2048 lds
  v_mfma_f32_16x16x32_bf16 v[68:71], a[196:199], a[168:171], v[68:71]
  ds_read_b64_tr_b16 a[220:221], v43 offset:40960
  ds_read_b64_tr_b16 a[222:223], v43 offset:45056
  v_mfma_f32_16x16x32_bf16 v[76:79], a[196:199], a[172:175], v[76:79]
  s_waitcnt lgkmcnt(8)
  v_mfma_f32_16x16x32_bf16 v[80:83], a[200:203], a[168:171], v[80:83]
  s_barrier
  ds_read_b64_tr_b16 a[192:193], v8 offset:49152
  ds_read_b64_tr_b16 a[194:195], v8 offset:53248
  v_mfma_f32_16x16x32_bf16 v[88:91], a[200:203], a[172:175], v[88:91]
  buffer_load_dwordx4 v51, s[4:7], s66 offen offset:3072 lds
  s_add_u32 s66, s66, 458752
  s_cmp_eq_u32 s66, 14680064
  s_cselect_b32 s66, 0, s66
  v_mfma_f32_16x16x32_bf16 v[84:87], a[204:207], a[168:171], v[84:87]
  ds_read_b64_tr_b16 a[196:197], v9 offset:49152
  ds_read_b64_tr_b16 a[198:199], v9 offset:53248
  v_mfma_f32_16x16x32_bf16 v[92:95], a[204:207], a[172:175], v[92:95]
  s_waitcnt lgkmcnt(8)
  v_mfma_f32_16x16x32_bf16 v[96:99], a[208:211], a[168:171], v[96:99]
  ds_read_b64_tr_b16 a[200:201], v10 offset:49152
  ds_read_b64_tr_b16 a[202:203], v10 offset:53248
  v_mfma_f32_16x16x32_bf16 v[104:107], a[208:211], a[172:175], v[104:107]
  buffer_load_dwordx4 a[160:163], v3, s[44:47], s67 offen offset:0 sc1
  v_mfma_f32_16x16x32_bf16 v[100:103], a[212:215], a[168:171], v[100:103]
  ds_read_b64_tr_b16 a[204:205], v11 offset:49152
  ds_read_b64_tr_b16 a[206:207], v11 offset:53248
  v_mfma_f32_16x16x32_bf16 v[108:111], a[212:215], a[172:175], v[108:111]
  s_waitcnt lgkmcnt(8)
  v_mfma_f32_16x16x32_bf16 v[112:115], a[216:219], a[168:171], v[112:115]
  ds_read_b64_tr_b16 a[208:209], v40 offset:49152
  ds_read_b64_tr_b16 a[210:211], v40 offset:53248
  v_mfma_f32_16x16x32_bf16 v[120:123], a[216:219], a[172:175], v[120:123]
  buffer_load_dwordx4 a[164:167], v3, s[44:47], s67 offen offset:1024 sc1
  v_mfma_f32_16x16x32_bf16 v[116:119], a[220:223], a[168:171], v[116:119]
  ds_read_b64_tr_b16 a[212:213], v41 offset:49152
  ds_read_b64_tr_b16 a[214:215], v41 offset:53248
  v_mfma_f32_16x16x32_bf16 v[124:127], a[220:223], a[172:175], v[124:127]
  s_waitcnt vmcnt(24) lgkmcnt(8)
  v_mfma_f32_16x16x32_bf16 v[64:67], a[192:195], a[176:179], v[64:67]
  ds_read_b64_tr_b16 a[216:217], v42 offset:49152
  ds_read_b64_tr_b16 a[218:219], v42 offset:53248
  v_mfma_f32_16x16x32_bf16 v[72:75], a[192:195], a[180:183], v[72:75]
  buffer_load_dwordx4 a[168:171], v3, s[44:47], s67 offen offset:2048 sc1
  v_mfma_f32_16x16x32_bf16 v[68:71], a[196:199], a[176:179], v[68:71]
  ds_read_b64_tr_b16 a[220:221], v43 offset:49152
  ds_read_b64_tr_b16 a[222:223], v43 offset:53248
  v_mfma_f32_16x16x32_bf16 v[76:79], a[196:199], a[180:183], v[76:79]
  s_waitcnt lgkmcnt(8)
  v_mfma_f32_16x16x32_bf16 v[80:83], a[200:203], a[176:179], v[80:83]
  ds_read_b64_tr_b16 a[192:193], v8 offset:57344
  ds_read_b64_tr_b16 a[194:195], v8 offset:61440
  v_mfma_f32_16x16x32_bf16 v[88:91], a[200:203], a[180:183], v[88:91]
  buffer_load_dwordx4 a[172:175], v3, s[44:47], s67 offen offset:3072 sc1
  s_add_u32 s67, s67, 4096
  s_cmp_eq_u32 s67, 131072
  s_cselect_b32 s67, 0, s67
  v_mfma_f32_16x16x32_bf16 v[84:87], a[204:207], a[176:179], v[84:87]
  ds_read_b64_tr_b16 a[196:197], v9 offset:57344
  ds_read_b64_tr_b16 a[198:199], v9 offset:61440
  v_mfma_f32_16x16x32_bf16 v[92:95], a[204:207], a[180:183], v[92:95]
  s_add_u32 m0, s19, 16384
  s_waitcnt lgkmcnt(8)
  v_mfma_f32_16x16x32_bf16 v[96:99], a[208:211], a[176:179], v[96:99]
  ds_read_b64_tr_b16 a[200:201], v10 offset:57344
  ds_read_b64_tr_b16 a[202:203], v10 offset:61440
  v_mfma_f32_16x16x32_bf16 v[104:107], a[208:211], a[180:183], v[104:107]
  buffer_load_dwordx4 v48, s[4:7], s66 offen offset:0 lds
  v_mfma_f32_16x16x32_bf16 v[100:103], a[212:215], a[176:179], v[100:103]
  ds_read_b64_tr_b16 a[204:205], v11 offset:57344
  ds_read_b64_tr_b16 a[206:207], v11 offset:61440
  v_mfma_f32_16x16x32_bf16 v[108:111], a[212:215], a[180:183], v[108:111]
  s_waitcnt lgkmcnt(8)
  v_mfma_f32_16x16x32_bf16 v[112:115], a[216:219], a[176:179], v[112:115]
  ds_read_b64_tr_b16 a[208:209], v40 offset:57344
  ds_read_b64_tr_b16 a[210:211], v40 offset:61440
  v_mfma_f32_16x16x32_bf16 v[120:123], a[216:219], a[180:183], v[120:123]
  buffer_load_dwordx4 v49, s[4:7], s66 offen offset:1024 lds
  v_mfma_f32_16x16x32_bf16 v[116:119], a[220:223], a[176:179], v[116:119]
  ds_read_b64_tr_b16 a[212:213], v41 offset:57344
  ds_read_b64_tr_b16 a[214:215], v41 offset:61440
  v_mfma_f32_16x16x32_bf16 v[124:127], a[220:223], a[180:183], v[124:127]
  s_waitcnt vmcnt(26) lgkmcnt(8)
  v_mfma_f32_16x16x32_bf16 v[64:67], a[192:195], a[184:187], v[64:67]
  ds_read_b64_tr_b16 a[216:217], v42 offset:57344
  ds_read_b64_tr_b16 a[218:219], v42 offset:61440
  v_mfma_f32_16x16x32_bf16 v[72:75], a[192:195], a[188:191], v[72:75]
  buffer_load_dwordx4 v50, s[4:7], s66 offen offset:2048 lds
  v_mfma_f32_16x16x32_bf16 v[68:71], a[196:199], a[184:187], v[68:71]
  ds_read_b64_tr_b16 a[220:221], v43 offset:57344
  ds_read_b64_tr_b16 a[222:223], v43 offset:61440
  v_mfma_f32_16x16x32_bf16 v[76:79], a[196:199], a[188:191], v[76:79]
  s_waitcnt lgkmcnt(8)
  v_mfma_f32_16x16x32_bf16 v[80:83], a[200:203], a[184:187], v[80:83]
  s_barrier
  ds_read_b64_tr_b16 a[192:193], v208 offset:0
  ds_read_b64_tr_b16 a[194:195], v208 offset:4096
  v_mfma_f32_16x16x32_bf16 v[88:91], a[200:203], a[188:191], v[88:91]
  buffer_load_dwordx4 v51, s[4:7], s66 offen offset:3072 lds
  s_add_u32 s66, s66, 458752
  s_cmp_eq_u32 s66, 14680064
  s_cselect_b32 s66, 0, s66
  v_mfma_f32_16x16x32_bf16 v[84:87], a[204:207], a[184:187], v[84:87]
  ds_read_b64_tr_b16 a[196:197], v209 offset:0
  ds_read_b64_tr_b16 a[198:199], v209 offset:4096
  v_mfma_f32_16x16x32_bf16 v[92:95], a[204:207], a[188:191], v[92:95]
  s_waitcnt lgkmcnt(8)
  v_mfma_f32_16x16x32_bf16 v[96:99], a[208:211], a[184:187], v[96:99]
  ds_read_b64_tr_b16 a[200:201], v210 offset:0
  ds_read_b64_tr_b16 a[202:203], v210 offset:4096
  v_mfma_f32_16x16x32_bf16 v[104:107], a[208:211], a[188:191], v[104:107]
  buffer_load_dwordx4 a[176:179], v3, s[44:47], s67 offen offset:0 sc1
  v_mfma_f32_16x16x32_bf16 v[100:103], a[212:215], a[184:187], v[100:103]
  ds_read_b64_tr_b16 a[204:205], v211 offset:0
  ds_read_b64_tr_b16 a[206:207], v211 offset:4096
  v_mfma_f32_16x16x32_bf16 v[108:111], a[212:215], a[188:191], v[108:111]
  s_waitcnt lgkmcnt(8)
  v_mfma_f32_16x16x32_bf16 v[112:115], a[216:219], a[184:187], v[112:115]
  ds_read_b64_tr_b16 a[208:209], v212 offset:0
  ds_read_b64_tr_b16 a[210:211], v212 offset:4096
  v_mfma_f32_16x16x32_bf16 v[120:123], a[216:219], a[188:191], v[120:123]
  buffer_load_dwordx4 a[180:183], v3, s[44:47], s67 offen offset:1024 sc1
  v_mfma_f32_16x16x32_bf16 v[116:119], a[220:223], a[184:187], v[116:119]
  ds_read_b64_tr_b16 a[212:213], v213 offset:0
  ds_read_b64_tr_b16 a[214:215], v213 offset:4096
  v_mfma_f32_16x16x32_bf16 v[124:127], a[220:223], a[188:191], v[124:127]
  s_waitcnt vmcnt(24) lgkmcnt(8)
  v_mfma_f32_16x16x32_bf16 v[64:67], a[192:195], a[128:131], v[64:67]
  ds_read_b64_tr_b16 a[216:217], v214 offset:0
  ds_read_b64_tr_b16 a[218:219], v214 offset:4096
  v_mfma_f32_16x16x32_bf16 v[72:75], a[192:195], a[132:135], v[72:75]
  buffer_load_dwordx4 a[184:187], v3, s[44:47], s67 offen offset:2048 sc1
  v_mfma_f32_16x16x32_bf16 v[68:71], a[196:199], a[128:131], v[68:71]
  ds_read_b64_tr_b16 a[220:221], v215 offset:0
  ds_read_b64_tr_b16 a[222:223], v215 offset:4096
  v_mfma_f32_16x16x32_bf16 v[76:79], a[196:199], a[132:135], v[76:79]
  s_waitcnt lgkmcnt(8)
  v_mfma_f32_16x16x32_bf16 v[80:83], a[200:203], a[128:131], v[80:83]
  ds_read_b64_tr_b16 a[192:193], v208 offset:8192
  ds_read_b64_tr_b16 a[194:195], v208 offset:12288
  v_mfma_f32_16x16x32_bf16 v[88:91], a[200:203], a[132:135], v[88:91]
  buffer_load_dwordx4 a[188:191], v3, s[44:47], s67 offen offset:3072 sc1
  s_add_u32 s67, s67, 4096
  s_cmp_eq_u32 s67, 131072
  s_cselect_b32 s67, 0, s67
  v_mfma_f32_16x16x32_bf16 v[84:87], a[204:207], a[128:131], v[84:87]
  ds_read_b64_tr_b16 a[196:197], v209 offset:8192
  ds_read_b64_tr_b16 a[198:199], v209 offset:12288
  v_mfma_f32_16x16x32_bf16 v[92:95], a[204:207], a[132:135], v[92:95]
  s_add_u32 m0, s19, 32768
  s_waitcnt lgkmcnt(8)
  v_mfma_f32_16x16x32_bf16 v[96:99], a[208:211], a[128:131], v[96:99]
  ds_read_b64_tr_b16 a[200:201], v210 offset:8192
  ds_read_b64_tr_b16 a[202:203], v210 offset:12288
  v_mfma_f32_16x16x32_bf16 v[104:107], a[208:211], a[132:135], v[104:107]
  buffer_load_dwordx4 v48, s[4:7], s66 offen offset:0 lds
  v_mfma_f32_16x16x32_bf16 v[100:103], a[212:215], a[128:131], v[100:103]
  ds_read_b64_tr_b16 a[204:205], v211 offset:8192
  ds_read_b64_tr_b16 a[206:207], v211 offset:12288
  v_mfma_f32_16x16x32_bf16 v[108:111], a[212:215], a[132:135], v[108:111]
  s_waitcnt lgkmcnt(8)
  v_mfma_f32_16x16x32_bf16 v[112:115], a[216:219], a[128:131], v[112:115]
  ds_read_b64_tr_b16 a[208:209], v212 offset:8192
  ds_read_b64_tr_b16 a[210:211], v212 offset:12288
  v_mfma_f32_16x16x32_bf16 v[120:123], a[216:219], a[132:135], v[120:123]
  buffer_load_dwordx4 v49, s[4:7], s66 offen offset:1024 lds
  v_mfma_f32_16x16x32_bf16 v[116:119], a[220:223], a[128:131], v[116:119]
  ds_read_b64_tr_b16 a[212:213], v213 offset:8192
  ds_read_b64_tr_b16 a[214:215], v213 offset:12288
  v_mfma_f32_16x16x32_bf16 v[124:127], a[220:223], a[132:135], v[124:127]
  s_waitcnt vmcnt(26) lgkmcnt(8)
  v_mfma_f32_16x16x32_bf16 v[64:67], a[192:195], a[136:139], v[64:67]
  ds_read_b64_tr_b16 a[216:217], v214 offset:8192
  ds_read_b64_tr_b16 a[218:219], v214 offset:12288
  v_mfma_f32_16x16x32_bf16 v[72:75], a[192:195], a[140:143], v[72:75]
  buffer_load_dwordx4 v50, s[4:7], s66 offen offset:2048 lds
  v_mfma_f32_16x16x32_bf16 v[68:71], a[196:199], a[136:139], v[68:71]
  ds_read_b64_tr_b16 a[220:221], v215 offset:8192
  ds_read_b64_tr_b16 a[222:223], v215 offset:12288
  v_mfma_f32_16x16x32_bf16 v[76:79], a[196:199], a[140:143], v[76:79]
  s_waitcnt lgkmcnt(8)
  v_mfma_f32_16x16x32_bf16 v[80:83], a[200:203], a[136:139], v[80:83]
  s_barrier
  ds_read_b64_tr_b16 a[192:193], v208 offset:16384
  ds_read_b64_tr_b16 a[194:195], v208 offset:20480
  v_mfma_f32_16x16x32_bf16 v[88:91], a[200:203], a[140:143], v[88:91]
  buffer_load_dwordx4 v51, s[4:7], s66 offen offset:3072 lds
  s_add_u32 s66, s66, 458752
  s_cmp_eq_u32 s66, 14680064
  s_cselect_b32 s66, 0, s66
  v_mfma_f32_16x16x32_bf16 v[84:87], a[204:207], a[136:139], v[84:87]
  ds_read_b64_tr_b16 a[196:197], v209 offset:16384
  ds_read_b64_tr_b16 a[198:199], v209 offset:20480
  v_mfma_f32_16x16x32_bf16 v[92:95], a[204:207], a[140:143], v[92:95]
  s_waitcnt lgkmcnt(8)
  v_mfma_f32_16x16x32_bf16 v[96:99], a[208:211], a[136:139], v[96:99]
  ds_read_b64_tr_b16 a[200:201], v210 offset:16384
  ds_read_b64_tr_b16 a[202:203], v210 offset:20480
  v_mfma_f32_16x16x32_bf16 v[104:107], a[208:211], a[140:143], v[104:107]
  buffer_load_dwordx4 a[128:131], v3, s[44:47], s67 offen offset:0 sc1
  v_mfma_f32_16x16x32_bf16 v[100:103], a[212:215], a[136:139], v[100:103]
  ds_read_b64_tr_b16 a[204:205], v211 offset:16384
  ds_read_b64_tr_b16 a[206:207], v211 offset:20480
  v_mfma_f32_16x16x32_bf16 v[108:111], a[212:215], a[140:143], v[108:111]
  s_waitcnt lgkmcnt(8)
  v_mfma_f32_16x16x32_bf16 v[112:115], a[216:219], a[136:139], v[112:115]
  ds_read_b64_tr_b16 a[208:209], v212 offset:16384
  ds_read_b64_tr_b16 a[210:211], v212 offset:20480
  v_mfma_f32_16x16x32_bf16 v[120:123], a[216:219], a[140:143], v[120:123]
  buffer_load_dwordx4 a[132:135], v3, s[44:47], s67 offen offset:1024 sc1
  v_mfma_f32_16x16x32_bf16 v[116:119], a[220:223], a[136:139], v[116:119]
  ds_read_b64_tr_b16 a[212:213], v213 offset:16384
  ds_read_b64_tr_b16 a[214:215], v213 offset:20480
  v_mfma_f32_16x16x32_bf16 v[124:127], a[220:223], a[140:143], v[124:127]
  s_waitcnt vmcnt(24) lgkmcnt(8)
  v_mfma_f32_16x16x32_bf16 v[64:67], a[192:195], a[144:147], v[64:67]
  ds_read_b64_tr_b16 a[216:217], v214 offset:16384
  ds_read_b64_tr_b16 a[218:219], v214 offset:20480
  v_mfma_f32_16x16x32_bf16 v[72:75], a[192:195], a[148:151], v[72:75]
  buffer_load_dwordx4 a[136:139], v3, s[44:47], s67 offen offset:2048 sc1
  v_mfma_f32_16x16x32_bf16 v[68:71], a[196:199], a[144:147], v[68:71]
  ds_read_b64_tr_b16 a[220:221], v215 offset:16384
  ds_read_b64_tr_b16 a[222:223], v215 offset:20480
  v_mfma_f32_16x16x32_bf16 v[76:79], a[196:199], a[148:151], v[76:79]
  s_waitcnt lgkmcnt(8)
  v_mfma_f32_16x16x32_bf16 v[80:83], a[200:203], a[144:147], v[80:83]
  ds_read_b64_tr_b16 a[192:193], v208 offset:24576
  ds_read_b64_tr_b16 a[194:195], v208 offset:28672
  v_mfma_f32_16x16x32_bf16 v[88:91], a[200:203], a[148:151], v[88:91]
  buffer_load_dwordx4 a[140:143], v3, s[44:47], s67 offen offset:3072 sc1
  s_add_u32 s67, s67, 4096
  s_cmp_eq_u32 s67, 131072
  s_cselect_b32 s67, 0, s67
  v_mfma_f32_16x16x32_bf16 v[84:87], a[204:207], a[144:147], v[84:87]
  ds_read_b64_tr_b16 a[196:197], v209 offset:24576
  ds_read_b64_tr_b16 a[198:199], v209 offset:28672
  v_mfma_f32_16x16x32_bf16 v[92:95], a[204:207], a[148:151], v[92:95]
  s_add_u32 m0, s19, 49152
  s_waitcnt lgkmcnt(8)
  v_mfma_f32_16x16x32_bf16 v[96:99], a[208:211], a[144:147], v[96:99]
  ds_read_b64_tr_b16 a[200:201], v210 offset:24576
  ds_read_b64_tr_b16 a[202:203], v210 offset:28672
  v_mfma_f32_16x16x32_bf16 v[104:107], a[208:211], a[148:151], v[104:107]
  buffer_load_dwordx4 v48, s[4:7], s66 offen offset:0 lds
  v_mfma_f32_16x16x32_bf16 v[100:103], a[212:215], a[144:147], v[100:103]
  ds_read_b64_tr_b16 a[204:205], v211 offset:24576
  ds_read_b64_tr_b16 a[206:207], v211 offset:28672
  v_mfma_f32_16x16x32_bf16 v[108:111], a[212:215], a[148:151], v[108:111]
  s_waitcnt lgkmcnt(8)
  v_mfma_f32_16x16x32_bf16 v[112:115], a[216:219], a[144:147], v[112:115]
  ds_read_b64_tr_b16 a[208:209], v212 offset:24576
  ds_read_b64_tr_b16 a[210:211], v212 offset:28672
  v_mfma_f32_16x16x32_bf16 v[120:123], a[216:219], a[148:151], v[120:123]
  buffer_load_dwordx4 v49, s[4:7], s66 offen offset:1024 lds
  v_mfma_f32_16x16x32_bf16 v[116:119], a[220:223], a[144:147], v[116:119]
  ds_read_b64_tr_b16 a[212:213], v213 offset:24576
  ds_read_b64_tr_b16 a[214:215], v213 offset:28672
  v_mfma_f32_16x16x32_bf16 v[124:127], a[220:223], a[148:151], v[124:127]
  s_waitcnt vmcnt(26) lgkmcnt(8)
  v_mfma_f32_16x16x32_bf16 v[64:67], a[192:195], a[152:155], v[64:67]
  ds_read_b64_tr_b16 a[216:217], v214 offset:24576
  ds_read_b64_tr_b16 a[218:219], v214 offset:28672
  v_mfma_f32_16x16x32_bf16 v[72:75], a[192:195], a[156:159], v[72:75]
  buffer_load_dwordx4 v50, s[4:7], s66 offen offset:2048 lds
  v_mfma_f32_16x16x32_bf16 v[68:71], a[196:199], a[152:155], v[68:71]
  ds_read_b64_tr_b16 a[220:221], v215 offset:24576
  ds_read_b64_tr_b16 a[222:223], v215 offset:28672
  v_mfma_f32_16x16x32_bf16 v[76:79], a[196:199], a[156:159], v[76:79]
  s_waitcnt lgkmcnt(8)
  v_mfma_f32_16x16x32_bf16 v[80:83], a[200:203], a[152:155], v[80:83]
  s_barrier
  ds_read_b64_tr_b16 a[192:193], v208 offset:32768
  ds_read_b64_tr_b16 a[194:195], v208 offset:36864
  v_mfma_f32_16x16x32_bf16 v[88:91], a[200:203], a[156:159], v[88:91]
  buffer_load_dwordx4 v51, s[4:7], s66 offen offset:3072 lds
  s_add_u32 s66, s66, 458752
  s_cmp_eq_u32 s66, 14680064
  s_cselect_b32 s66, 0, s66
  v_mfma_f32_16x16x32_bf16 v[84:87], a[204:207], a[152:155], v[84:87]
  ds_read_b64_tr_b16 a[196:197], v209 offset:32768
  ds_read_b64_tr_b16 a[198:199], v209 offset:36864
  v_mfma_f32_16x16x32_bf16 v[92:95], a[204:207], a[156:159], v[92:95]
  s_waitcnt lgkmcnt(8)
  v_mfma_f32_16x16x32_bf16 v[96:99], a[208:211], a[152:155], v[96:99]
  ds_read_b64_tr_b16 a[200:201], v210 offset:32768
  ds_read_b64_tr_b16 a[202:203], v210 offset:36864
  v_mfma_f32_16x16x32_bf16 v[104:107], a[208:211], a[156:159], v[104:107]
  buffer_load_dwordx4 a[144:147], v3, s[44:47], s67 offen offset:0 sc1
  v_mfma_f32_16x16x32_bf16 v[100:103], a[212:215], a[152:155], v[100:103]
  ds_read_b64_tr_b16 a[204:205], v211 offset:32768
  ds_read_b64_tr_b16 a[206:207], v211 offset:36864
  v_mfma_f32_16x16x32_bf16 v[108:111], a[212:215], a[156:159], v[108:111]
  s_waitcnt lgkmcnt(8)
  v_mfma_f32_16x16x32_bf16 v[112:115], a[216:219], a[152:155], v[112:115]
  ds_read_b64_tr_b16 a[208:209], v212 offset:32768
  ds_read_b64_tr_b16 a[210:211], v212 offset:36864
  v_mfma_f32_16x16x32_bf16 v[120:123], a[216:219], a[156:159], v[120:123]
  buffer_load_dwordx4 a[148:151], v3, s[44:47], s67 offen offset:1024 sc1
  v_mfma_f32_16x16x32_bf16 v[116:119], a[220:223], a[152:155], v[116:119]
  ds_read_b64_tr_b16 a[212:213], v213 offset:32768
  ds_read_b64_tr_b16 a[214:215], v213 offset:36864
  v_mfma_f32_16x16x32_bf16 v[124:127], a[220:223], a[156:159], v[124:127]
  s_waitcnt vmcnt(24) lgkmcnt(8)
  v_mfma_f32_16x16x32_bf16 v[64:67], a[192:195], a[160:163], v[64:67]
  ds_read_b64_tr_b16 a[216:217], v214 offset:32768
  ds_read_b64_tr_b16 a[218:219], v214 offset:36864
  v_mfma_f32_16x16x32_bf16 v[72:75], a[192:195], a[164:167], v[72:75]
  buffer_load_dwordx4 a[152:155], v3, s[44:47], s67 offen offset:2048 sc1
  v_mfma_f32_16x16x32_bf16 v[68:71], a[196:199], a[160:163], v[68:71]
  ds_read_b64_tr_b16 a[220:221], v215 offset:32768
  ds_read_b64_tr_b16 a[222:223], v215 offset:36864
  v_mfma_f32_16x16x32_bf16 v[76:79], a[196:199], a[164:167], v[76:79]
  s_waitcnt lgkmcnt(8)
  v_mfma_f32_16x16x32_bf16 v[80:83], a[200:203], a[160:163], v[80:83]
  ds_read_b64_tr_b16 a[192:193], v208 offset:40960
  ds_read_b64_tr_b16 a[194:195], v208 offset:45056
  v_mfma_f32_16x16x32_bf16 v[88:91], a[200:203], a[164:167], v[88:91]
  buffer_load_dwordx4 a[156:159], v3, s[44:47], s67 offen offset:3072 sc1
  s_add_u32 s67, s67, 4096
  s_cmp_eq_u32 s67, 131072
  s_cselect_b32 s67, 0, s67
  v_mfma_f32_16x16x32_bf16 v[84:87], a[204:207], a[160:163], v[84:87]
  ds_read_b64_tr_b16 a[196:197], v209 offset:40960
  ds_read_b64_tr_b16 a[198:199], v209 offset:45056
  v_mfma_f32_16x16x32_bf16 v[92:95], a[204:207], a[164:167], v[92:95]
  s_add_u32 m0, s19, 65536
  s_waitcnt lgkmcnt(8)
  v_mfma_f32_16x16x32_bf16 v[96:99], a[208:211], a[160:163], v[96:99]
  ds_read_b64_tr_b16 a[200:201], v210 offset:40960
  ds_read_b64_tr_b16 a[202:203], v210 offset:45056
  v_mfma_f32_16x16x32_bf16 v[104:107], a[208:211], a[164:167], v[104:107]
  buffer_load_dwordx4 v48, s[4:7], s66 offen offset:0 lds
  v_mfma_f32_16x16x32_bf16 v[100:103], a[212:215], a[160:163], v[100:103]
  ds_read_b64_tr_b16 a[204:205], v211 offset:40960
  ds_read_b64_tr_b16 a[206:207], v211 offset:45056
  v_mfma_f32_16x16x32_bf16 v[108:111], a[212:215], a[164:167], v[108:111]
  s_waitcnt lgkmcnt(8)
  v_mfma_f32_16x16x32_bf16 v[112:115], a[216:219], a[160:163], v[112:115]
  ds_read_b64_tr_b16 a[208:209], v212 offset:40960
  ds_read_b64_tr_b16 a[210:211], v212 offset:45056
  v_mfma_f32_16x16x32_bf16 v[120:123], a[216:219], a[164:167], v[120:123]
  buffer_load_dwordx4 v49, s[4:7], s66 offen offset:1024 lds
  v_mfma_f32_16x16x32_bf16 v[116:119], a[220:223], a[160:163], v[116:119]
  ds_read_b64_tr_b16 a[212:213], v213 offset:40960
  ds_read_b64_tr_b16 a[214:215], v213 offset:45056
  v_mfma_f32_16x16x32_bf16 v[124:127], a[220:223], a[164:167], v[124:127]
  s_waitcnt vmcnt(26) lgkmcnt(8)
  v_mfma_f32_16x16x32_bf16 v[64:67], a[192:195], a[168:171], v[64:67]
  ds_read_b64_tr_b16 a[216:217], v214 offset:40960
  ds_read_b64_tr_b16 a[218:219], v214 offset:45056
  v_mfma_f32_16x16x32_bf16 v[72:75], a[192:195], a[172:175], v[72:75]
  buffer_load_dwordx4 v50, s[4:7], s66 offen offset:2048 lds
  v_mfma_f32_16x16x32_bf16 v[68:71], a[196:199], a[168:171], v[68:71]
  ds_read_b64_tr_b16 a[220:221], v215 offset:40960
  ds_read_b64_tr_b16 a[222:223], v215 offset:45056
  v_mfma_f32_16x16x32_bf16 v[76:79], a[196:199], a[172:175], v[76:79]
  s_waitcnt lgkmcnt(8)
  v_mfma_f32_16x16x32_bf16 v[80:83], a[200:203], a[168:171], v[80:83]
  s_barrier
  ds_read_b64_tr_b16 a[192:193], v208 offset:49152
  ds_read_b64_tr_b16 a[194:195], v208 offset:53248
  v_mfma_f32_16x16x32_bf16 v[88:91], a[200:203], a[172:175], v[88:91]
  buffer_load_dwordx4 v51, s[4:7], s66 offen offset:3072 lds
  s_add_u32 s66, s66, 458752
  s_cmp_eq_u32 s66, 14680064
  s_cselect_b32 s66, 0, s66
  v_mfma_f32_16x16x32_bf16 v[84:87], a[204:207], a[168:171], v[84:87]
  ds_read_b64_tr_b16 a[196:197], v209 offset:49152
  ds_read_b64_tr_b16 a[198:199], v209 offset:53248
  v_mfma_f32_16x16x32_bf16 v[92:95], a[204:207], a[172:175], v[92:95]
  s_waitcnt lgkmcnt(8)
  v_mfma_f32_16x16x32_bf16 v[96:99], a[208:211], a[168:171], v[96:99]
  ds_read_b64_tr_b16 a[200:201], v210 offset:49152
  ds_read_b64_tr_b16 a[202:203], v210 offset:53248
  v_mfma_f32_16x16x32_bf16 v[104:107], a[208:211], a[172:175], v[104:107]
  buffer_load_dwordx4 a[160:163], v3, s[44:47], s67 offen offset:0 sc1
  v_mfma_f32_16x16x32_bf16 v[100:103], a[212:215], a[168:171], v[100:103]
  ds_read_b64_tr_b16 a[204:205], v211 offset:49152
  ds_read_b64_tr_b16 a[206:207], v211 offset:53248
  v_mfma_f32_16x16x32_bf16 v[108:111], a[212:215], a[172:175], v[108:111]
  s_waitcnt lgkmcnt(8)
  v_mfma_f32_16x16x32_bf16 v[112:115], a[216:219], a[168:171], v[112:115]
  ds_read_b64_tr_b16 a[208:209], v212 offset:49152
  ds_read_b64_tr_b16 a[210:211], v212 offset:53248
  v_mfma_f32_16x16x32_bf16 v[120:123], a[216:219], a[172:175], v[120:123]
  buffer_load_dwordx4 a[164:167], v3, s[44:47], s67 offen offset:1024 sc1
  v_mfma_f32_16x16x32_bf16 v[116:119], a[220:223], a[168:171], v[116:119]
  ds_read_b64_tr_b16 a[212:213], v213 offset:49152
  ds_read_b64_tr_b16 a[214:215], v213 offset:53248
  v_mfma_f32_16x16x32_bf16 v[124:127], a[220:223], a[172:175], v[124:127]
  s_waitcnt vmcnt(24) lgkmcnt(8)
  v_mfma_f32_16x16x32_bf16 v[64:67], a[192:195], a[176:179], v[64:67]
  ds_read_b64_tr_b16 a[216:217], v214 offset:49152
  ds_read_b64_tr_b16 a[218:219], v214 offset:53248
  v_mfma_f32_16x16x32_bf16 v[72:75], a[192:195], a[180:183], v[72:75]
  buffer_load_dwordx4 a[168:171], v3, s[44:47], s67 offen offset:2048 sc1
  v_mfma_f32_16x16x32_bf16 v[68:71], a[196:199], a[176:179], v[68:71]
  ds_read_b64_tr_b16 a[220:221], v215 offset:49152
  ds_read_b64_tr_b16 a[222:223], v215 offset:53248
  v_mfma_f32_16x16x32_bf16 v[76:79], a[196:199], a[180:183], v[76:79]
  s_waitcnt lgkmcnt(8)
  v_mfma_f32_16x16x32_bf16 v[80:83], a[200:203], a[176:179], v[80:83]
  ds_read_b64_tr_b16 a[192:193], v208 offset:57344
  ds_read_b64_tr_b16 a[194:195], v208 offset:61440
  v_mfma_f32_16x16x32_bf16 v[88:91], a[200:203], a[180:183], v[88:91]
  buffer_load_dwordx4 a[172:175], v3, s[44:47], s67 offen offset:3072 sc1
  s_add_u32 s67, s67, 4096
  s_cmp_eq_u32 s67, 131072
  s_cselect_b32 s67, 0, s67
  v_mfma_f32_16x16x32_bf16 v[84:87], a[204:207], a[176:179], v[84:87]
  ds_read_b64_tr_b16 a[196:197], v209 offset:57344
  ds_read_b64_tr_b16 a[198:199], v209 offset:61440
  v_mfma_f32_16x16x32_bf16 v[92:95], a[204:207], a[180:183], v[92:95]
  s_add_u32 m0, s19, 81920
  s_waitcnt lgkmcnt(8)
  v_mfma_f32_16x16x32_bf16 v[96:99], a[208:211], a[176:179], v[96:99]
  ds_read_b64_tr_b16 a[200:201], v210 offset:57344
  ds_read_b64_tr_b16 a[202:203], v210 offset:61440
  v_mfma_f32_16x16x32_bf16 v[104:107], a[208:211], a[180:183], v[104:107]
  buffer_load_dwordx4 v48, s[4:7], s66 offen offset:0 lds
  v_mfma_f32_16x16x32_bf16 v[100:103], a[212:215], a[176:179], v[100:103]
  ds_read_b64_tr_b16 a[204:205], v211 offset:57344
  ds_read_b64_tr_b16 a[206:207], v211 offset:61440
  v_mfma_f32_16x16x32_bf16 v[108:111], a[212:215], a[180:183], v[108:111]
  s_waitcnt lgkmcnt(8)
  v_mfma_f32_16x16x32_bf16 v[112:115], a[216:219], a[176:179], v[112:115]
  ds_read_b64_tr_b16 a[208:209], v212 offset:57344
  ds_read_b64_tr_b16 a[210:211], v212 offset:61440
  v_mfma_f32_16x16x32_bf16 v[120:123], a[216:219], a[180:183], v[120:123]
  buffer_load_dwordx4 v49, s[4:7], s66 offen offset:1024 lds
  v_mfma_f32_16x16x32_bf16 v[116:119], a[220:223], a[176:179], v[116:119]
  ds_read_b64_tr_b16 a[212:213], v213 offset:57344
  ds_read_b64_tr_b16 a[214:215], v213 offset:61440
  v_mfma_f32_16x16x32_bf16 v[124:127], a[220:223], a[180:183], v[124:127]
  s_waitcnt vmcnt(26) lgkmcnt(8)
  v_mfma_f32_16x16x32_bf16 v[64:67], a[192:195], a[184:187], v[64:67]
  ds_read_b64_tr_b16 a[216:217], v214 offset:57344
  ds_read_b64_tr_b16 a[218:219], v214 offset:61440
  v_mfma_f32_16x16x32_bf16 v[72:75], a[192:195], a[188:191], v[72:75]
  buffer_load_dwordx4 v50, s[4:7], s66 offen offset:2048 lds
  v_mfma_f32_16x16x32_bf16 v[68:71], a[196:199], a[184:187], v[68:71]
  ds_read_b64_tr_b16 a[220:221], v215 offset:57344
  ds_read_b64_tr_b16 a[222:223], v215 offset:61440
  v_mfma_f32_16x16x32_bf16 v[76:79], a[196:199], a[188:191], v[76:79]
  s_waitcnt lgkmcnt(8)
  v_mfma_f32_16x16x32_bf16 v[80:83], a[200:203], a[184:187], v[80:83]
  s_barrier
  ds_read_b64_tr_b16 a[192:193], v8 offset:0
  ds_read_b64_tr_b16 a[194:195], v8 offset:4096
  v_mfma_f32_16x16x32_bf16 v[88:91], a[200:203], a[188:191], v[88:91]
  buffer_load_dwordx4 v51, s[4:7], s66 offen offset:3072 lds
  s_add_u32 s66, s66, 458752
  s_cmp_eq_u32 s66, 14680064
  s_cselect_b32 s66, 0, s66
  v_mfma_f32_16x16x32_bf16 v[84:87], a[204:207], a[184:187], v[84:87]
  ds_read_b64_tr_b16 a[196:197], v9 offset:0
  ds_read_b64_tr_b16 a[198:199], v9 offset:4096
  v_mfma_f32_16x16x32_bf16 v[92:95], a[204:207], a[188:191], v[92:95]
  s_waitcnt lgkmcnt(8)
  v_mfma_f32_16x16x32_bf16 v[96:99], a[208:211], a[184:187], v[96:99]
  ds_read_b64_tr_b16 a[200:201], v10 offset:0
  ds_read_b64_tr_b16 a[202:203], v10 offset:4096
  v_mfma_f32_16x16x32_bf16 v[104:107], a[208:211], a[188:191], v[104:107]
  buffer_load_dwordx4 a[176:179], v3, s[44:47], s67 offen offset:0 sc1
  v_mfma_f32_16x16x32_bf16 v[100:103], a[212:215], a[184:187], v[100:103]
  ds_read_b64_tr_b16 a[204:205], v11 offset:0
  ds_read_b64_tr_b16 a[206:207], v11 offset:4096
  v_mfma_f32_16x16x32_bf16 v[108:111], a[212:215], a[188:191], v[108:111]
  s_waitcnt lgkmcnt(8)
  v_mfma_f32_16x16x32_bf16 v[112:115], a[216:219], a[184:187], v[112:115]
  ds_read_b64_tr_b16 a[208:209], v40 offset:0
  ds_read_b64_tr_b16 a[210:211], v40 offset:4096
  v_mfma_f32_16x16x32_bf16 v[120:123], a[216:219], a[188:191], v[120:123]
  buffer_load_dwordx4 a[180:183], v3, s[44:47], s67 offen offset:1024 sc1
  v_mfma_f32_16x16x32_bf16 v[116:119], a[220:223], a[184:187], v[116:119]
  ds_read_b64_tr_b16 a[212:213], v41 offset:0
  ds_read_b64_tr_b16 a[214:215], v41 offset:4096
  v_mfma_f32_16x16x32_bf16 v[124:127], a[220:223], a[188:191], v[124:127]
  s_sub_u32 s20, s20, 1
  s_cmp_lg_u32 s20, 0
  s_cbranch_scc1 L_mk2_m_42
  s_mul_i32 s21, s16, 65536
  v_mul_u32_u24 v7, 4096, v34
  v_add3_u32 v4, v7, v44, s21
  v_add3_u32 v5, v7, v45, s21
  v_add_u32 v5, 15360, v5
  v_add_u32 v6, 30720, v4
  v_add_u32 v7, 30720, v5
  s_mov_b32 s17, 0
  s_mov_b32 s18, 0
  s_lshl_b32 s21, s41, 8
  s_sub_u32 s22, 14680064, s21
  s_add_u32 s8, s88, s21
  s_addc_u32 s9, s89, 0
  s_and_b32 s9, s9, 0xffff
  s_mov_b32 s10, s22
  s_mov_b32 s11, 0x00020000
  s_lshl_b32 s21, s40, 2
  s_add_u32 s21, s21, s16
  s_mul_i32 s22, s21, 229376
  s_add_u32 s22, s22, 25165824
  s_add_u32 s12, s96, s22
  s_addc_u32 s13, s97, 0
  s_and_b32 s13, s13, 0xffff
  s_mov_b32 s14, 229376
  s_mov_b32 s15, 0x00020000
  v_and_b32 v60, 15, v2
  v_lshlrev_b32 v60, 5, v60
  s_lshl_b32 s21, s40, 10
  s_add_u32 s21, s21, 16384
  v_add_u32 v60, s21, v60
  buffer_load_dword v52, v60, s[52:55], 0 offen sc1
  s_waitcnt vmcnt(25) lgkmcnt(8)
  v_mfma_f32_16x16x32_bf16 v[64:67], a[192:195], a[128:131], v[64:67]
  ds_read_b64_tr_b16 a[216:217], v42 offset:0
  ds_read_b64_tr_b16 a[218:219], v42 offset:4096
  v_mfma_f32_16x16x32_bf16 v[72:75], a[192:195], a[132:135], v[72:75]
  buffer_load_dwordx4 a[184:187], v3, s[44:47], s67 offen offset:2048 sc1
  v_mfma_f32_16x16x32_bf16 v[68:71], a[196:199], a[128:131], v[68:71]
  ds_read_b64_tr_b16 a[220:221], v43 offset:0
  ds_read_b64_tr_b16 a[222:223], v43 offset:4096
  v_mfma_f32_16x16x32_bf16 v[76:79], a[196:199], a[132:135], v[76:79]
  s_waitcnt lgkmcnt(8)
  v_mfma_f32_16x16x32_bf16 v[80:83], a[200:203], a[128:131], v[80:83]
  ds_read_b64_tr_b16 a[192:193], v8 offset:8192
  ds_read_b64_tr_b16 a[194:195], v8 offset:12288
  v_mfma_f32_16x16x32_bf16 v[88:91], a[200:203], a[132:135], v[88:91]
  buffer_load_dwordx4 a[188:191], v3, s[44:47], s67 offen offset:3072 sc1
  s_add_u32 s67, s67, 4096
  s_cmp_eq_u32 s67, 131072
  s_cselect_b32 s67, 0, s67
  v_mfma_f32_16x16x32_bf16 v[84:87], a[204:207], a[128:131], v[84:87]
  ds_read_b64_tr_b16 a[196:197], v9 offset:8192
  ds_read_b64_tr_b16 a[198:199], v9 offset:12288
  v_mfma_f32_16x16x32_bf16 v[92:95], a[204:207], a[132:135], v[92:95]
  s_add_u32 m0, s19, 98304
  s_waitcnt lgkmcnt(8)
  v_mfma_f32_16x16x32_bf16 v[96:99], a[208:211], a[128:131], v[96:99]
  ds_read_b64_tr_b16 a[200:201], v10 offset:8192
  ds_read_b64_tr_b16 a[202:203], v10 offset:12288
  v_mfma_f32_16x16x32_bf16 v[104:107], a[208:211], a[132:135], v[104:107]
  buffer_load_dwordx4 v48, s[4:7], s66 offen offset:0 lds
  v_mfma_f32_16x16x32_bf16 v[100:103], a[212:215], a[128:131], v[100:103]
  ds_read_b64_tr_b16 a[204:205], v11 offset:8192
  ds_read_b64_tr_b16 a[206:207], v11 offset:12288
  v_mfma_f32_16x16x32_bf16 v[108:111], a[212:215], a[132:135], v[108:111]
  s_waitcnt lgkmcnt(8)
  v_mfma_f32_16x16x32_bf16 v[112:115], a[216:219], a[128:131], v[112:115]
  ds_read_b64_tr_b16 a[208:209], v40 offset:8192
  ds_read_b64_tr_b16 a[210:211], v40 offset:12288
  v_mfma_f32_16x16x32_bf16 v[120:123], a[216:219], a[132:135], v[120:123]
  buffer_load_dwordx4 v49, s[4:7], s66 offen offset:1024 lds
  v_mfma_f32_16x16x32_bf16 v[116:119], a[220:223], a[128:131], v[116:119]
  ds_read_b64_tr_b16 a[212:213], v41 offset:8192
  ds_read_b64_tr_b16 a[214:215], v41 offset:12288
  v_mfma_f32_16x16x32_bf16 v[124:127], a[220:223], a[132:135], v[124:127]
  s_waitcnt vmcnt(27) lgkmcnt(8)
  v_mfma_f32_16x16x32_bf16 v[64:67], a[192:195], a[136:139], v[64:67]
  ds_read_b64_tr_b16 a[216:217], v42 offset:8192
  ds_read_b64_tr_b16 a[218:219], v42 offset:12288
  v_mfma_f32_16x16x32_bf16 v[72:75], a[192:195], a[140:143], v[72:75]
  buffer_load_dwordx4 v50, s[4:7], s66 offen offset:2048 lds
  v_mfma_f32_16x16x32_bf16 v[68:71], a[196:199], a[136:139], v[68:71]
  ds_read_b64_tr_b16 a[220:221], v43 offset:8192
  ds_read_b64_tr_b16 a[222:223], v43 offset:12288
  v_mfma_f32_16x16x32_bf16 v[76:79], a[196:199], a[140:143], v[76:79]
  s_waitcnt lgkmcnt(8)
  v_mfma_f32_16x16x32_bf16 v[80:83], a[200:203], a[136:139], v[80:83]
  s_barrier
  ds_read_b64_tr_b16 a[192:193], v8 offset:16384
  ds_read_b64_tr_b16 a[194:195], v8 offset:20480
  v_mfma_f32_16x16x32_bf16 v[88:91], a[200:203], a[140:143], v[88:91]
  buffer_load_dwordx4 v51, s[4:7], s66 offen offset:3072 lds
  s_add_u32 s66, s66, 458752
  s_cmp_eq_u32 s66, 14680064
  s_cselect_b32 s66, 0, s66
  v_mfma_f32_16x16x32_bf16 v[84:87], a[204:207], a[136:139], v[84:87]
  ds_read_b64_tr_b16 a[196:197], v9 offset:16384
  ds_read_b64_tr_b16 a[198:199], v9 offset:20480
  v_mfma_f32_16x16x32_bf16 v[92:95], a[204:207], a[140:143], v[92:95]
  s_waitcnt lgkmcnt(8)
  v_mfma_f32_16x16x32_bf16 v[96:99], a[208:211], a[136:139], v[96:99]
  ds_read_b64_tr_b16 a[200:201], v10 offset:16384
  ds_read_b64_tr_b16 a[202:203], v10 offset:20480
  v_mfma_f32_16x16x32_bf16 v[104:107], a[208:211], a[140:143], v[104:107]
  buffer_load_dwordx4 a[128:131], v3, s[44:47], s67 offen offset:0 sc1
  v_mfma_f32_16x16x32_bf16 v[100:103], a[212:215], a[136:139], v[100:103]
  ds_read_b64_tr_b16 a[204:205], v11 offset:16384
  ds_read_b64_tr_b16 a[206:207], v11 offset:20480
  v_mfma_f32_16x16x32_bf16 v[108:111], a[212:215], a[140:143], v[108:111]
  s_waitcnt lgkmcnt(8)
  v_mfma_f32_16x16x32_bf16 v[112:115], a[216:219], a[136:139], v[112:115]
  ds_read_b64_tr_b16 a[208:209], v40 offset:16384
  ds_read_b64_tr_b16 a[210:211], v40 offset:20480
  v_mfma_f32_16x16x32_bf16 v[120:123], a[216:219], a[140:143], v[120:123]
  buffer_load_dwordx4 a[132:135], v3, s[44:47], s67 offen offset:1024 sc1
  v_mfma_f32_16x16x32_bf16 v[116:119], a[220:223], a[136:139], v[116:119]
  ds_read_b64_tr_b16 a[212:213], v41 offset:16384
  ds_read_b64_tr_b16 a[214:215], v41 offset:20480
  v_mfma_f32_16x16x32_bf16 v[124:127], a[220:223], a[140:143], v[124:127]
  s_waitcnt vmcnt(25) lgkmcnt(8)
  v_mfma_f32_16x16x32_bf16 v[64:67], a[192:195], a[144:147], v[64:67]
  ds_read_b64_tr_b16 a[216:217], v42 offset:16384
  ds_read_b64_tr_b16 a[218:219], v42 offset:20480
  v_mfma_f32_16x16x32_bf16 v[72:75], a[192:195], a[148:151], v[72:75]
  buffer_load_dwordx4 a[136:139], v3, s[44:47], s67 offen offset:2048 sc1
  v_mfma_f32_16x16x32_bf16 v[68:71], a[196:199], a[144:147], v[68:71]
  ds_read_b64_tr_b16 a[220:221], v43 offset:16384
  ds_read_b64_tr_b16 a[222:223], v43 offset:20480
  v_mfma_f32_16x16x32_bf16 v[76:79], a[196:199], a[148:151], v[76:79]
  s_waitcnt lgkmcnt(8)
  v_mfma_f32_16x16x32_bf16 v[80:83], a[200:203], a[144:147], v[80:83]
  ds_read_b64_tr_b16 a[192:193], v8 offset:24576
  ds_read_b64_tr_b16 a[194:195], v8 offset:28672
  v_mfma_f32_16x16x32_bf16 v[88:91], a[200:203], a[148:151], v[88:91]
  buffer_load_dwordx4 a[140:143], v3, s[44:47], s67 offen offset:3072 sc1
  s_add_u32 s67, s67, 4096
  s_cmp_eq_u32 s67, 131072
  s_cselect_b32 s67, 0, s67
  v_mfma_f32_16x16x32_bf16 v[84:87], a[204:207], a[144:147], v[84:87]
  ds_read_b64_tr_b16 a[196:197], v9 offset:24576
  ds_read_b64_tr_b16 a[198:199], v9 offset:28672
  v_mfma_f32_16x16x32_bf16 v[92:95], a[204:207], a[148:151], v[92:95]
  s_add_u32 m0, s19, 114688
  s_waitcnt lgkmcnt(8)
  v_mfma_f32_16x16x32_bf16 v[96:99], a[208:211], a[144:147], v[96:99]
  ds_read_b64_tr_b16 a[200:201], v10 offset:24576
  ds_read_b64_tr_b16 a[202:203], v10 offset:28672
  v_mfma_f32_16x16x32_bf16 v[104:107], a[208:211], a[148:151], v[104:107]
  buffer_load_dwordx4 v48, s[4:7], s66 offen offset:0 lds
  v_mfma_f32_16x16x32_bf16 v[100:103], a[212:215], a[144:147], v[100:103]
  ds_read_b64_tr_b16 a[204:205], v11 offset:24576
  ds_read_b64_tr_b16 a[206:207], v11 offset:28672
  v_mfma_f32_16x16x32_bf16 v[108:111], a[212:215], a[148:151], v[108:111]
  s_waitcnt lgkmcnt(8)
  v_mfma_f32_16x16x32_bf16 v[112:115], a[216:219], a[144:147], v[112:115]
  ds_read_b64_tr_b16 a[208:209], v40 offset:24576
  ds_read_b64_tr_b16 a[210:211], v40 offset:28672
  v_mfma_f32_16x16x32_bf16 v[120:123], a[216:219], a[148:151], v[120:123]
  buffer_load_dwordx4 v49, s[4:7], s66 offen offset:1024 lds
  v_mfma_f32_16x16x32_bf16 v[116:119], a[220:223], a[144:147], v[116:119]
  ds_read_b64_tr_b16 a[212:213], v41 offset:24576
  ds_read_b64_tr_b16 a[214:215], v41 offset:28672
  v_mfma_f32_16x16x32_bf16 v[124:127], a[220:223], a[148:151], v[124:127]
  s_waitcnt vmcnt(27) lgkmcnt(8)
  v_mfma_f32_16x16x32_bf16 v[64:67], a[192:195], a[152:155], v[64:67]
  ds_read_b64_tr_b16 a[216:217], v42 offset:24576
  ds_read_b64_tr_b16 a[218:219], v42 offset:28672
  v_mfma_f32_16x16x32_bf16 v[72:75], a[192:195], a[156:159], v[72:75]
  buffer_load_dwordx4 v50, s[4:7], s66 offen offset:2048 lds
  v_mfma_f32_16x16x32_bf16 v[68:71], a[196:199], a[152:155], v[68:71]
  ds_read_b64_tr_b16 a[220:221], v43 offset:24576
  ds_read_b64_tr_b16 a[222:223], v43 offset:28672
  v_mfma_f32_16x16x32_bf16 v[76:79], a[196:199], a[156:159], v[76:79]
  s_waitcnt lgkmcnt(8)
  v_mfma_f32_16x16x32_bf16 v[80:83], a[200:203], a[152:155], v[80:83]
  s_barrier
  ds_read_b64_tr_b16 a[192:193], v8 offset:32768
  ds_read_b64_tr_b16 a[194:195], v8 offset:36864
  v_mfma_f32_16x16x32_bf16 v[88:91], a[200:203], a[156:159], v[88:91]
  buffer_load_dwordx4 v51, s[4:7], s66 offen offset:3072 lds
  s_add_u32 s66, s66, 458752
  s_cmp_eq_u32 s66, 14680064
  s_cselect_b32 s66, 0, s66
  v_mfma_f32_16x16x32_bf16 v[84:87], a[204:207], a[152:155], v[84:87]
  ds_read_b64_tr_b16 a[196:197], v9 offset:32768
  ds_read_b64_tr_b16 a[198:199], v9 offset:36864
  v_mfma_f32_16x16x32_bf16 v[92:95], a[204:207], a[156:159], v[92:95]
  s_waitcnt lgkmcnt(8)
  v_mfma_f32_16x16x32_bf16 v[96:99], a[208:211], a[152:155], v[96:99]
  ds_read_b64_tr_b16 a[200:201], v10 offset:32768
  ds_read_b64_tr_b16 a[202:203], v10 offset:36864
  v_mfma_f32_16x16x32_bf16 v[104:107], a[208:211], a[156:159], v[104:107]
  buffer_load_dwordx4 a[144:147], v3, s[44:47], s67 offen offset:0 sc1
  v_mfma_f32_16x16x32_bf16 v[100:103], a[212:215], a[152:155], v[100:103]
  ds_read_b64_tr_b16 a[204:205], v11 offset:32768
  ds_read_b64_tr_b16 a[206:207], v11 offset:36864
  v_mfma_f32_16x16x32_bf16 v[108:111], a[212:215], a[156:159], v[108:111]
  s_waitcnt lgkmcnt(8)
  v_mfma_f32_16x16x32_bf16 v[112:115], a[216:219], a[152:155], v[112:115]
  ds_read_b64_tr_b16 a[208:209], v40 offset:32768
  ds_read_b64_tr_b16 a[210:211], v40 offset:36864
  v_mfma_f32_16x16x32_bf16 v[120:123], a[216:219], a[156:159], v[120:123]
  buffer_load_dwordx4 a[148:151], v3, s[44:47], s67 offen offset:1024 sc1
  v_mfma_f32_16x16x32_bf16 v[116:119], a[220:223], a[152:155], v[116:119]
  ds_read_b64_tr_b16 a[212:213], v41 offset:32768
  ds_read_b64_tr_b16 a[214:215], v41 offset:36864
  v_mfma_f32_16x16x32_bf16 v[124:127], a[220:223], a[156:159], v[124:127]
  s_waitcnt vmcnt(25) lgkmcnt(8)
  v_mfma_f32_16x16x32_bf16 v[64:67], a[192:195], a[160:163], v[64:67]
  ds_read_b64_tr_b16 a[216:217], v42 offset:32768
  ds_read_b64_tr_b16 a[218:219], v42 offset:36864
  v_mfma_f32_16x16x32_bf16 v[72:75], a[192:195], a[164:167], v[72:75]
  buffer_load_dwordx4 a[152:155], v3, s[44:47], s67 offen offset:2048 sc1
  v_mfma_f32_16x16x32_bf16 v[68:71], a[196:199], a[160:163], v[68:71]
  ds_read_b64_tr_b16 a[220:221], v43 offset:32768
  ds_read_b64_tr_b16 a[222:223], v43 offset:36864
  v_mfma_f32_16x16x32_bf16 v[76:79], a[196:199], a[164:167], v[76:79]
  s_waitcnt lgkmcnt(8)
  v_mfma_f32_16x16x32_bf16 v[80:83], a[200:203], a[160:163], v[80:83]
  ds_read_b64_tr_b16 a[192:193], v8 offset:40960
  ds_read_b64_tr_b16 a[194:195], v8 offset:45056
  v_mfma_f32_16x16x32_bf16 v[88:91], a[200:203], a[164:167], v[88:91]
  buffer_load_dwordx4 a[156:159], v3, s[44:47], s67 offen offset:3072 sc1
  s_add_u32 s67, s67, 4096
  s_cmp_eq_u32 s67, 131072
  s_cselect_b32 s67, 0, s67
  v_mfma_f32_16x16x32_bf16 v[84:87], a[204:207], a[160:163], v[84:87]
  ds_read_b64_tr_b16 a[196:197], v9 offset:40960
  ds_read_b64_tr_b16 a[198:199], v9 offset:45056
  v_mfma_f32_16x16x32_bf16 v[92:95], a[204:207], a[164:167], v[92:95]
  s_add_u32 m0, s19, 0
  s_waitcnt lgkmcnt(8)
  v_mfma_f32_16x16x32_bf16 v[96:99], a[208:211], a[160:163], v[96:99]
  ds_read_b64_tr_b16 a[200:201], v10 offset:40960
  ds_read_b64_tr_b16 a[202:203], v10 offset:45056
  v_mfma_f32_16x16x32_bf16 v[104:107], a[208:211], a[164:167], v[104:107]
  buffer_load_dwordx4 v4, s[8:11], s17 offen offset:0 lds
  v_mfma_f32_16x16x32_bf16 v[100:103], a[212:215], a[160:163], v[100:103]
  ds_read_b64_tr_b16 a[204:205], v11 offset:40960
  ds_read_b64_tr_b16 a[206:207], v11 offset:45056
  v_mfma_f32_16x16x32_bf16 v[108:111], a[212:215], a[164:167], v[108:111]
  s_waitcnt lgkmcnt(8)
  v_mfma_f32_16x16x32_bf16 v[112:115], a[216:219], a[160:163], v[112:115]
  ds_read_b64_tr_b16 a[208:209], v40 offset:40960
  ds_read_b64_tr_b16 a[210:211], v40 offset:45056
  v_mfma_f32_16x16x32_bf16 v[120:123], a[216:219], a[164:167], v[120:123]
  buffer_load_dwordx4 v5, s[8:11], s17 offen offset:1024 lds
  v_mfma_f32_16x16x32_bf16 v[116:119], a[220:223], a[160:163], v[116:119]
  ds_read_b64_tr_b16 a[212:213], v41 offset:40960
  ds_read_b64_tr_b16 a[214:215], v41 offset:45056
  v_mfma_f32_16x16x32_bf16 v[124:127], a[220:223], a[164:167], v[124:127]
  s_waitcnt vmcnt(27) lgkmcnt(8)
  v_mfma_f32_16x16x32_bf16 v[64:67], a[192:195], a[168:171], v[64:67]
  ds_read_b64_tr_b16 a[216:217], v42 offset:40960
  ds_read_b64_tr_b16 a[218:219], v42 offset:45056
  v_mfma_f32_16x16x32_bf16 v[72:75], a[192:195], a[172:175], v[72:75]
  buffer_load_dwordx4 v6, s[8:11], s17 offen offset:2048 lds
  v_mfma_f32_16x16x32_bf16 v[68:71], a[196:199], a[168:171], v[68:71]
  ds_read_b64_tr_b16 a[220:221], v43 offset:40960
  ds_read_b64_tr_b16 a[222:223], v43 offset:45056
  v_mfma_f32_16x16x32_bf16 v[76:79], a[196:199], a[172:175], v[76:79]
  s_waitcnt lgkmcnt(8)
  v_mfma_f32_16x16x32_bf16 v[80:83], a[200:203], a[168:171], v[80:83]
  s_barrier
  ds_read_b64_tr_b16 a[192:193], v8 offset:49152
  ds_read_b64_tr_b16 a[194:195], v8 offset:53248
  v_mfma_f32_16x16x32_bf16 v[88:91], a[200:203], a[172:175], v[88:91]
  buffer_load_dwordx4 v7, s[8:11], s17 offen offset:3072 lds
  s_add_u32 s17, s17, 262144
  v_mfma_f32_16x16x32_bf16 v[84:87], a[204:207], a[168:171], v[84:87]
  ds_read_b64_tr_b16 a[196:197], v9 offset:49152
  ds_read_b64_tr_b16 a[198:199], v9 offset:53248
  v_mfma_f32_16x16x32_bf16 v[92:95], a[204:207], a[172:175], v[92:95]
  s_waitcnt lgkmcnt(8)
  v_mfma_f32_16x16x32_bf16 v[96:99], a[208:211], a[168:171], v[96:99]
  ds_read_b64_tr_b16 a[200:201], v10 offset:49152
  ds_read_b64_tr_b16 a[202:203], v10 offset:53248
  v_mfma_f32_16x16x32_bf16 v[104:107], a[208:211], a[172:175], v[104:107]
  buffer_load_dwordx4 a[160:163], v3, s[44:47], s67 offen offset:0 sc1
  v_mfma_f32_16x16x32_bf16 v[100:103], a[212:215], a[168:171], v[100:103]
  ds_read_b64_tr_b16 a[204:205], v11 offset:49152
  ds_read_b64_tr_b16 a[206:207], v11 offset:53248
  v_mfma_f32_16x16x32_bf16 v[108:111], a[212:215], a[172:175], v[108:111]
  s_waitcnt lgkmcnt(8)
  v_mfma_f32_16x16x32_bf16 v[112:115], a[216:219], a[168:171], v[112:115]
  ds_read_b64_tr_b16 a[208:209], v40 offset:49152
  ds_read_b64_tr_b16 a[210:211], v40 offset:53248
  v_mfma_f32_16x16x32_bf16 v[120:123], a[216:219], a[172:175], v[120:123]
  buffer_load_dwordx4 a[164:167], v3, s[44:47], s67 offen offset:1024 sc1
  v_mfma_f32_16x16x32_bf16 v[116:119], a[220:223], a[168:171], v[116:119]
  ds_read_b64_tr_b16 a[212:213], v41 offset:49152
  ds_read_b64_tr_b16 a[214:215], v41 offset:53248
  v_mfma_f32_16x16x32_bf16 v[124:127], a[220:223], a[172:175], v[124:127]
  s_waitcnt vmcnt(25) lgkmcnt(8)
  v_mfma_f32_16x16x32_bf16 v[64:67], a[192:195], a[176:179], v[64:67]
  ds_read_b64_tr_b16 a[216:217], v42 offset:49152
  ds_read_b64_tr_b16 a[218:219], v42 offset:53248
  v_mfma_f32_16x16x32_bf16 v[72:75], a[192:195], a[180:183], v[72:75]
  buffer_load_dwordx4 a[168:171], v3, s[44:47], s67 offen offset:2048 sc1
  v_mfma_f32_16x16x32_bf16 v[68:71], a[196:199], a[176:179], v[68:71]
  ds_read_b64_tr_b16 a[220:221], v43 offset:49152
  ds_read_b64_tr_b16 a[222:223], v43 offset:53248
  v_mfma_f32_16x16x32_bf16 v[76:79], a[196:199], a[180:183], v[76:79]
  s_waitcnt lgkmcnt(8)
  v_mfma_f32_16x16x32_bf16 v[80:83], a[200:203], a[176:179], v[80:83]
  ds_read_b64_tr_b16 a[192:193], v8 offset:57344
  ds_read_b64_tr_b16 a[194:195], v8 offset:61440
  v_mfma_f32_16x16x32_bf16 v[88:91], a[200:203], a[180:183], v[88:91]
  buffer_load_dwordx4 a[172:175], v3, s[44:47], s67 offen offset:3072 sc1
  s_add_u32 s67, s67, 4096
  s_cmp_eq_u32 s67, 131072
  s_cselect_b32 s67, 0, s67
  v_mfma_f32_16x16x32_bf16 v[84:87], a[204:207], a[176:179], v[84:87]
  ds_read_b64_tr_b16 a[196:197], v9 offset:57344
  ds_read_b64_tr_b16 a[198:199], v9 offset:61440
  v_mfma_f32_16x16x32_bf16 v[92:95], a[204:207], a[180:183], v[92:95]
  s_add_u32 m0, s19, 16384
  s_waitcnt lgkmcnt(8)
  v_mfma_f32_16x16x32_bf16 v[96:99], a[208:211], a[176:179], v[96:99]
  ds_read_b64_tr_b16 a[200:201], v10 offset:57344
  ds_read_b64_tr_b16 a[202:203], v10 offset:61440
  v_mfma_f32_16x16x32_bf16 v[104:107], a[208:211], a[180:183], v[104:107]
  buffer_load_dwordx4 v4, s[8:11], s17 offen offset:0 lds
  v_mfma_f32_16x16x32_bf16 v[100:103], a[212:215], a[176:179], v[100:103]
  ds_read_b64_tr_b16 a[204:205], v11 offset:57344
  ds_read_b64_tr_b16 a[206:207], v11 offset:61440
  v_mfma_f32_16x16x32_bf16 v[108:111], a[212:215], a[180:183], v[108:111]
  s_waitcnt lgkmcnt(8)
  v_mfma_f32_16x16x32_bf16 v[112:115], a[216:219], a[176:179], v[112:115]
  ds_read_b64_tr_b16 a[208:209], v40 offset:57344
  ds_read_b64_tr_b16 a[210:211], v40 offset:61440
  v_mfma_f32_16x16x32_bf16 v[120:123], a[216:219], a[180:183], v[120:123]
  buffer_load_dwordx4 v5, s[8:11], s17 offen offset:1024 lds
  v_mfma_f32_16x16x32_bf16 v[116:119], a[220:223], a[176:179], v[116:119]
  ds_read_b64_tr_b16 a[212:213], v41 offset:57344
  ds_read_b64_tr_b16 a[214:215], v41 offset:61440
  v_mfma_f32_16x16x32_bf16 v[124:127], a[220:223], a[180:183], v[124:127]
  s_waitcnt vmcnt(26) lgkmcnt(8)
  v_mfma_f32_16x16x32_bf16 v[64:67], a[192:195], a[184:187], v[64:67]
  ds_read_b64_tr_b16 a[216:217], v42 offset:57344
  ds_read_b64_tr_b16 a[218:219], v42 offset:61440
  v_mfma_f32_16x16x32_bf16 v[72:75], a[192:195], a[188:191], v[72:75]
  buffer_load_dwordx4 v6, s[8:11], s17 offen offset:2048 lds
  v_mfma_f32_16x16x32_bf16 v[68:71], a[196:199], a[184:187], v[68:71]
  ds_read_b64_tr_b16 a[220:221], v43 offset:57344
  ds_read_b64_tr_b16 a[222:223], v43 offset:61440
  v_mfma_f32_16x16x32_bf16 v[76:79], a[196:199], a[188:191], v[76:79]
  s_waitcnt lgkmcnt(8)
  v_mfma_f32_16x16x32_bf16 v[80:83], a[200:203], a[184:187], v[80:83]
  s_barrier
  ds_read_b64_tr_b16 a[192:193], v208 offset:0
  ds_read_b64_tr_b16 a[194:195], v208 offset:4096
  v_mfma_f32_16x16x32_bf16 v[88:91], a[200:203], a[188:191], v[88:91]
  buffer_load_dwordx4 v7, s[8:11], s17 offen offset:3072 lds
  s_add_u32 s17, s17, 262144
  v_mfma_f32_16x16x32_bf16 v[84:87], a[204:207], a[184:187], v[84:87]
  ds_read_b64_tr_b16 a[196:197], v209 offset:0
  ds_read_b64_tr_b16 a[198:199], v209 offset:4096
  v_mfma_f32_16x16x32_bf16 v[92:95], a[204:207], a[188:191], v[92:95]
  s_waitcnt lgkmcnt(8)
  v_mfma_f32_16x16x32_bf16 v[96:99], a[208:211], a[184:187], v[96:99]
  v_cmp_ne_u32 vcc, s42, v52
  s_cbranch_vccz L_mk2_fok_43
  s_call_b64 s[48:49], L_poll1
L_mk2_fok_43:
  ds_read_b64_tr_b16 a[200:201], v210 offset:0
  ds_read_b64_tr_b16 a[202:203], v210 offset:4096
  v_mfma_f32_16x16x32_bf16 v[104:107], a[208:211], a[188:191], v[104:107]
  buffer_load_dwordx4 a[176:179], v3, s[44:47], s67 offen offset:0 sc1
  v_mfma_f32_16x16x32_bf16 v[100:103], a[212:215], a[184:187], v[100:103]
  ds_read_b64_tr_b16 a[204:205], v211 offset:0
  ds_read_b64_tr_b16 a[206:207], v211 offset:4096
  v_mfma_f32_16x16x32_bf16 v[108:111], a[212:215], a[188:191], v[108:111]
  s_waitcnt lgkmcnt(8)
  v_mfma_f32_16x16x32_bf16 v[112:115], a[216:219], a[184:187], v[112:115]
  ds_read_b64_tr_b16 a[208:209], v212 offset:0
  ds_read_b64_tr_b16 a[210:211], v212 offset:4096
  v_mfma_f32_16x16x32_bf16 v[120:123], a[216:219], a[188:191], v[120:123]
  buffer_load_dwordx4 a[180:183], v3, s[44:47], s67 offen offset:1024 sc1
  v_mfma_f32_16x16x32_bf16 v[116:119], a[220:223], a[184:187], v[116:119]
  ds_read_b64_tr_b16 a[212:213], v213 offset:0
  ds_read_b64_tr_b16 a[214:215], v213 offset:4096
  v_mfma_f32_16x16x32_bf16 v[124:127], a[220:223], a[188:191], v[124:127]
  s_waitcnt vmcnt(24) lgkmcnt(8)
  v_mfma_f32_16x16x32_bf16 v[64:67], a[192:195], a[128:131], v[64:67]
  ds_read_b64_tr_b16 a[216:217], v214 offset:0
  ds_read_b64_tr_b16 a[218:219], v214 offset:4096
  v_mfma_f32_16x16x32_bf16 v[72:75], a[192:195], a[132:135], v[72:75]
  buffer_load_dwordx4 a[184:187], v3, s[44:47], s67 offen offset:2048 sc1
  v_mfma_f32_16x16x32_bf16 v[68:71], a[196:199], a[128:131], v[68:71]
  ds_read_b64_tr_b16 a[220:221], v215 offset:0
  ds_read_b64_tr_b16 a[222:223], v215 offset:4096
  v_mfma_f32_16x16x32_bf16 v[76:79], a[196:199], a[132:135], v[76:79]
  s_waitcnt lgkmcnt(8)
  v_mfma_f32_16x16x32_bf16 v[80:83], a[200:203], a[128:131], v[80:83]
  ds_read_b64_tr_b16 a[192:193], v208 offset:8192
  ds_read_b64_tr_b16 a[194:195], v208 offset:12288
  v_mfma_f32_16x16x32_bf16 v[88:91], a[200:203], a[132:135], v[88:91]
  buffer_load_dwordx4 a[188:191], v3, s[44:47], s67 offen offset:3072 sc1
  s_add_u32 s67, s67, 4096
  s_cmp_eq_u32 s67, 131072
  s_cselect_b32 s67, 0, s67
  v_mfma_f32_16x16x32_bf16 v[84:87], a[204:207], a[128:131], v[84:87]
  ds_read_b64_tr_b16 a[196:197], v209 offset:8192
  ds_read_b64_tr_b16 a[198:199], v209 offset:12288
  v_mfma_f32_16x16x32_bf16 v[92:95], a[204:207], a[132:135], v[92:95]
  s_add_u32 m0, s19, 32768
  s_waitcnt lgkmcnt(8)
  v_mfma_f32_16x16x32_bf16 v[96:99], a[208:211], a[128:131], v[96:99]
  ds_read_b64_tr_b16 a[200:201], v210 offset:8192
  ds_read_b64_tr_b16 a[202:203], v210 offset:12288
  v_mfma_f32_16x16x32_bf16 v[104:107], a[208:211], a[132:135], v[104:107]
  buffer_load_dwordx4 v4, s[8:11], s17 offen offset:0 lds
  v_mfma_f32_16x16x32_bf16 v[100:103], a[212:215], a[128:131], v[100:103]
  ds_read_b64_tr_b16 a[204:205], v211 offset:8192
  ds_read_b64_tr_b16 a[206:207], v211 offset:12288
  v_mfma_f32_16x16x32_bf16 v[108:111], a[212:215], a[132:135], v[108:111]
  s_waitcnt lgkmcnt(8)
  v_mfma_f32_16x16x32_bf16 v[112:115], a[216:219], a[128:131], v[112:115]
  ds_read_b64_tr_b16 a[208:209], v212 offset:8192
  ds_read_b64_tr_b16 a[210:211], v212 offset:12288
  v_mfma_f32_16x16x32_bf16 v[120:123], a[216:219], a[132:135], v[120:123]
  buffer_load_dwordx4 v5, s[8:11], s17 offen offset:1024 lds
  v_mfma_f32_16x16x32_bf16 v[116:119], a[220:223], a[128:131], v[116:119]
  ds_read_b64_tr_b16 a[212:213], v213 offset:8192
  ds_read_b64_tr_b16 a[214:215], v213 offset:12288
  v_mfma_f32_16x16x32_bf16 v[124:127], a[220:223], a[132:135], v[124:127]
  s_waitcnt vmcnt(26) lgkmcnt(8)
  v_mfma_f32_16x16x32_bf16 v[64:67], a[192:195], a[136:139], v[64:67]
  ds_read_b64_tr_b16 a[216:217], v214 offset:8192
  ds_read_b64_tr_b16 a[218:219], v214 offset:12288
  v_mfma_f32_16x16x32_bf16 v[72:75], a[192:195], a[140:143], v[72:75]
  buffer_load_dwordx4 v6, s[8:11], s17 offen offset:2048 lds
  v_mfma_f32_16x16x32_bf16 v[68:71], a[196:199], a[136:139], v[68:71]
  ds_read_b64_tr_b16 a[220:221], v215 offset:8192
  ds_read_b64_tr_b16 a[222:223], v215 offset:12288
  v_mfma_f32_16x16x32_bf16 v[76:79], a[196:199], a[140:143], v[76:79]
  s_waitcnt lgkmcnt(8)
  v_mfma_f32_16x16x32_bf16 v[80:83], a[200:203], a[136:139], v[80:83]
  s_barrier
  ds_read_b64_tr_b16 a[192:193], v208 offset:16384
  ds_read_b64_tr_b16 a[194:195], v208 offset:20480
  v_mfma_f32_16x16x32_bf16 v[88:91], a[200:203], a[140:143], v[88:91]
  buffer_load_dwordx4 v7, s[8:11], s17 offen offset:3072 lds
  s_add_u32 s17, s17, 262144
  v_mfma_f32_16x16x32_bf16 v[84:87], a[204:207], a[136:139], v[84:87]
  ds_read_b64_tr_b16 a[196:197], v209 offset:16384
  ds_read_b64_tr_b16 a[198:199], v209 offset:20480
  v_mfma_f32_16x16x32_bf16 v[92:95], a[204:207], a[140:143], v[92:95]
  s_waitcnt lgkmcnt(8)
  v_mfma_f32_16x16x32_bf16 v[96:99], a[208:211], a[136:139], v[96:99]
  ds_read_b64_tr_b16 a[200:201], v210 offset:16384
  ds_read_b64_tr_b16 a[202:203], v210 offset:20480
  v_mfma_f32_16x16x32_bf16 v[104:107], a[208:211], a[140:143], v[104:107]
  buffer_load_dwordx4 a[128:131], v3, s[12:15], s18 offen offset:0 sc1
  v_mfma_f32_16x16x32_bf16 v[100:103], a[212:215], a[136:139], v[100:103]
  ds_read_b64_tr_b16 a[204:205], v211 offset:16384
  ds_read_b64_tr_b16 a[206:207], v211 offset:20480
  v_mfma_f32_16x16x32_bf16 v[108:111], a[212:215], a[140:143], v[108:111]
  s_waitcnt lgkmcnt(8)
  v_mfma_f32_16x16x32_bf16 v[112:115], a[216:219], a[136:139], v[112:115]
  ds_read_b64_tr_b16 a[208:209], v212 offset:16384
  ds_read_b64_tr_b16 a[210:211], v212 offset:20480
  v_mfma_f32_16x16x32_bf16 v[120:123], a[216:219], a[140:143], v[120:123]
  buffer_load_dwordx4 a[132:135], v3, s[12:15], s18 offen offset:1024 sc1
  v_mfma_f32_16x16x32_bf16 v[116:119], a[220:223], a[136:139], v[116:119]
  ds_read_b64_tr_b16 a[212:213], v213 offset:16384
  ds_read_b64_tr_b16 a[214:215], v213 offset:20480
  v_mfma_f32_16x16x32_bf16 v[124:127], a[220:223], a[140:143], v[124:127]
  s_waitcnt vmcnt(24) lgkmcnt(8)
  v_mfma_f32_16x16x32_bf16 v[64:67], a[192:195], a[144:147], v[64:67]
  ds_read_b64_tr_b16 a[216:217], v214 offset:16384
  ds_read_b64_tr_b16 a[218:219], v214 offset:20480
  v_mfma_f32_16x16x32_bf16 v[72:75], a[192:195], a[148:151], v[72:75]
  buffer_load_dwordx4 a[136:139], v3, s[12:15], s18 offen offset:2048 sc1
  v_mfma_f32_16x16x32_bf16 v[68:71], a[196:199], a[144:147], v[68:71]
  ds_read_b64_tr_b16 a[220:221], v215 offset:16384
  ds_read_b64_tr_b16 a[222:223], v215 offset:20480
  v_mfma_f32_16x16x32_bf16 v[76:79], a[196:199], a[148:151], v[76:79]
  s_waitcnt lgkmcnt(8)
  v_mfma_f32_16x16x32_bf16 v[80:83], a[200:203], a[144:147], v[80:83]
  ds_read_b64_tr_b16 a[192:193], v208 offset:24576
  ds_read_b64_tr_b16 a[194:195], v208 offset:28672
  v_mfma_f32_16x16x32_bf16 v[88:91], a[200:203], a[148:151], v[88:91]
  buffer_load_dwordx4 a[140:143], v3, s[12:15], s18 offen offset:3072 sc1
  s_add_u32 s18, s18, 4096
  v_mfma_f32_16x16x32_bf16 v[84:87], a[204:207], a[144:147], v[84:87]
  ds_read_b64_tr_b16 a[196:197], v209 offset:24576
  ds_read_b64_tr_b16 a[198:199], v209 offset:28672
  v_mfma_f32_16x16x32_bf16 v[92:95], a[204:207], a[148:151], v[92:95]
  s_add_u32 m0, s19, 49152
  s_waitcnt lgkmcnt(8)
  v_mfma_f32_16x16x32_bf16 v[96:99], a[208:211], a[144:147], v[96:99]
  ds_read_b64_tr_b16 a[200:201], v210 offset:24576
  ds_read_b64_tr_b16 a[202:203], v210 offset:28672
  v_mfma_f32_16x16x32_bf16 v[104:107], a[208:211], a[148:151], v[104:107]
  buffer_load_dwordx4 v4, s[8:11], s17 offen offset:0 lds
  v_mfma_f32_16x16x32_bf16 v[100:103], a[212:215], a[144:147], v[100:103]
  ds_read_b64_tr_b16 a[204:205], v211 offset:24576
  ds_read_b64_tr_b16 a[206:207], v211 offset:28672
  v_mfma_f32_16x16x32_bf16 v[108:111], a[212:215], a[148:151], v[108:111]
  s_waitcnt lgkmcnt(8)
  v_mfma_f32_16x16x32_bf16 v[112:115], a[216:219], a[144:147], v[112:115]
  ds_read_b64_tr_b16 a[208:209], v212 offset:24576
  ds_read_b64_tr_b16 a[210:211], v212 offset:28672
  v_mfma_f32_16x16x32_bf16 v[120:123], a[216:219], a[148:151], v[120:123]
  buffer_load_dwordx4 v5, s[8:11], s17 offen offset:1024 lds
  v_mfma_f32_16x16x32_bf16 v[116:119], a[220:223], a[144:147], v[116:119]
  ds_read_b64_tr_b16 a[212:213], v213 offset:24576
  ds_read_b64_tr_b16 a[214:215], v213 offset:28672
  v_mfma_f32_16x16x32_bf16 v[124:127], a[220:223], a[148:151], v[124:127]
  s_waitcnt vmcnt(26) lgkmcnt(8)
  v_mfma_f32_16x16x32_bf16 v[64:67], a[192:195], a[152:155], v[64:67]
  ds_read_b64_tr_b16 a[216:217], v214 offset:24576
  ds_read_b64_tr_b16 a[218:219], v214 offset:28672
  v_mfma_f32_16x16x32_bf16 v[72:75], a[192:195], a[156:159], v[72:75]
  buffer_load_dwordx4 v6, s[8:11], s17 offen offset:2048 lds
  v_mfma_f32_16x16x32_bf16 v[68:71], a[196:199], a[152:155], v[68:71]
  ds_read_b64_tr_b16 a[220:221], v215 offset:24576
  ds_read_b64_tr_b16 a[222:223], v215 offset:28672
  v_mfma_f32_16x16x32_bf16 v[76:79], a[196:199], a[156:159], v[76:79]
  s_waitcnt lgkmcnt(8)
  v_mfma_f32_16x16x32_bf16 v[80:83], a[200:203], a[152:155], v[80:83]
  s_barrier
  ds_read_b64_tr_b16 a[192:193], v208 offset:32768
  ds_read_b64_tr_b16 a[194:195], v208 offset:36864
  v_mfma_f32_16x16x32_bf16 v[88:91], a[200:203], a[156:159], v[88:91]
  buffer_load_dwordx4 v7, s[8:11], s17 offen offset:3072 lds
  s_add_u32 s17, s17, 262144
  v_mfma_f32_16x16x32_bf16 v[84:87], a[204:207], a[152:155], v[84:87]
  ds_read_b64_tr_b16 a[196:197], v209 offset:32768
  ds_read_b64_tr_b16 a[198:199], v209 offset:36864
  v_mfma_f32_16x16x32_bf16 v[92:95], a[204:207], a[156:159], v[92:95]
  s_waitcnt lgkmcnt(8)
  v_mfma_f32_16x16x32_bf16 v[96:99], a[208:211], a[152:155], v[96:99]
  ds_read_b64_tr_b16 a[200:201], v210 offset:32768
  ds_read_b64_tr_b16 a[202:203], v210 offset:36864
  v_mfma_f32_16x16x32_bf16 v[104:107], a[208:211], a[156:159], v[104:107]
  buffer_load_dwordx4 a[144:147], v3, s[12:15], s18 offen offset:0 sc1
  v_mfma_f32_16x16x32_bf16 v[100:103], a[212:215], a[152:155], v[100:103]
  ds_read_b64_tr_b16 a[204:205], v211 offset:32768
  ds_read_b64_tr_b16 a[206:207], v211 offset:36864
  v_mfma_f32_16x16x32_bf16 v[108:111], a[212:215], a[156:159], v[108:111]
  s_waitcnt lgkmcnt(8)
  v_mfma_f32_16x16x32_bf16 v[112:115], a[216:219], a[152:155], v[112:115]
  ds_read_b64_tr_b16 a[208:209], v212 offset:32768
  ds_read_b64_tr_b16 a[210:211], v212 offset:36864
  v_mfma_f32_16x16x32_bf16 v[120:123], a[216:219], a[156:159], v[120:123]
  buffer_load_dwordx4 a[148:151], v3, s[12:15], s18 offen offset:1024 sc1
  v_mfma_f32_16x16x32_bf16 v[116:119], a[220:223], a[152:155], v[116:119]
  ds_read_b64_tr_b16 a[212:213], v213 offset:32768
  ds_read_b64_tr_b16 a[214:215], v213 offset:36864
  v_mfma_f32_16x16x32_bf16 v[124:127], a[220:223], a[156:159], v[124:127]
  s_waitcnt vmcnt(24) lgkmcnt(8)
  v_mfma_f32_16x16x32_bf16 v[64:67], a[192:195], a[160:163], v[64:67]
  ds_read_b64_tr_b16 a[216:217], v214 offset:32768
  ds_read_b64_tr_b16 a[218:219], v214 offset:36864
  v_mfma_f32_16x16x32_bf16 v[72:75], a[192:195], a[164:167], v[72:75]
  buffer_load_dwordx4 a[152:155], v3, s[12:15], s18 offen offset:2048 sc1
  v_mfma_f32_16x16x32_bf16 v[68:71], a[196:199], a[160:163], v[68:71]
  ds_read_b64_tr_b16 a[220:221], v215 offset:32768
  ds_read_b64_tr_b16 a[222:223], v215 offset:36864
  v_mfma_f32_16x16x32_bf16 v[76:79], a[196:199], a[164:167], v[76:79]
  s_waitcnt lgkmcnt(8)
  v_mfma_f32_16x16x32_bf16 v[80:83], a[200:203], a[160:163], v[80:83]
  ds_read_b64_tr_b16 a[192:193], v208 offset:40960
  ds_read_b64_tr_b16 a[194:195], v208 offset:45056
  v_mfma_f32_16x16x32_bf16 v[88:91], a[200:203], a[164:167], v[88:91]
  buffer_load_dwordx4 a[156:159], v3, s[12:15], s18 offen offset:3072 sc1
  s_add_u32 s18, s18, 4096
  v_mfma_f32_16x16x32_bf16 v[84:87], a[204:207], a[160:163], v[84:87]
  ds_read_b64_tr_b16 a[196:197], v209 offset:40960
  ds_read_b64_tr_b16 a[198:199], v209 offset:45056
  v_mfma_f32_16x16x32_bf16 v[92:95], a[204:207], a[164:167], v[92:95]
  s_add_u32 m0, s19, 65536
  s_waitcnt lgkmcnt(8)
  v_mfma_f32_16x16x32_bf16 v[96:99], a[208:211], a[160:163], v[96:99]
  ds_read_b64_tr_b16 a[200:201], v210 offset:40960
  ds_read_b64_tr_b16 a[202:203], v210 offset:45056
  v_mfma_f32_16x16x32_bf16 v[104:107], a[208:211], a[164:167], v[104:107]
  buffer_load_dwordx4 v4, s[8:11], s17 offen offset:0 lds
  v_mfma_f32_16x16x32_bf16 v[100:103], a[212:215], a[160:163], v[100:103]
  ds_read_b64_tr_b16 a[204:205], v211 offset:40960
  ds_read_b64_tr_b16 a[206:207], v211 offset:45056
  v_mfma_f32_16x16x32_bf16 v[108:111], a[212:215], a[164:167], v[108:111]
  s_waitcnt lgkmcnt(8)
  v_mfma_f32_16x16x32_bf16 v[112:115], a[216:219], a[160:163], v[112:115]
  ds_read_b64_tr_b16 a[208:209], v212 offset:40960
  ds_read_b64_tr_b16 a[210:211], v212 offset:45056
  v_mfma_f32_16x16x32_bf16 v[120:123], a[216:219], a[164:167], v[120:123]
  buffer_load_dwordx4 v5, s[8:11], s17 offen offset:1024 lds
  v_mfma_f32_16x16x32_bf16 v[116:119], a[220:223], a[160:163], v[116:119]
  ds_read_b64_tr_b16 a[212:213], v213 offset:40960
  ds_read_b64_tr_b16 a[214:215], v213 offset:45056
  v_mfma_f32_16x16x32_bf16 v[124:127], a[220:223], a[164:167], v[124:127]
  s_waitcnt vmcnt(26) lgkmcnt(8)
  v_mfma_f32_16x16x32_bf16 v[64:67], a[192:195], a[168:171], v[64:67]
  ds_read_b64_tr_b16 a[216:217], v214 offset:40960
  ds_read_b64_tr_b16 a[218:219], v214 offset:45056
  v_mfma_f32_16x16x32_bf16 v[72:75], a[192:195], a[172:175], v[72:75]
  buffer_load_dwordx4 v6, s[8:11], s17 offen offset:2048 lds
  v_mfma_f32_16x16x32_bf16 v[68:71], a[196:199], a[168:171], v[68:71]
  ds_read_b64_tr_b16 a[220:221], v215 offset:40960
  ds_read_b64_tr_b16 a[222:223], v215 offset:45056
  v_mfma_f32_16x16x32_bf16 v[76:79], a[196:199], a[172:175], v[76:79]
  s_waitcnt lgkmcnt(8)
  v_mfma_f32_16x16x32_bf16 v[80:83], a[200:203], a[168:171], v[80:83]
  s_barrier
  ds_read_b64_tr_b16 a[192:193], v208 offset:49152
  ds_read_b64_tr_b16 a[194:195], v208 offset:53248
  v_mfma_f32_16x16x32_bf16 v[88:91], a[200:203], a[172:175], v[88:91]
  buffer_load_dwordx4 v7, s[8:11], s17 offen offset:3072 lds
  s_add_u32 s17, s17, 262144
  v_mfma_f32_16x16x32_bf16 v[84:87], a[204:207], a[168:171], v[84:87]
  ds_read_b64_tr_b16 a[196:197], v209 offset:49152
  ds_read_b64_tr_b16 a[198:199], v209 offset:53248
  v_mfma_f32_16x16x32_bf16 v[92:95], a[204:207], a[172:175], v[92:95]
  s_waitcnt lgkmcnt(8)
  v_mfma_f32_16x16x32_bf16 v[96:99], a[208:211], a[168:171], v[96:99]
  ds_read_b64_tr_b16 a[200:201], v210 offset:49152
  ds_read_b64_tr_b16 a[202:203], v210 offset:53248
  v_mfma_f32_16x16x32_bf16 v[104:107], a[208:211], a[172:175], v[104:107]
  buffer_load_dwordx4 a[160:163], v3, s[12:15], s18 offen offset:0 sc1
  v_mfma_f32_16x16x32_bf16 v[100:103], a[212:215], a[168:171], v[100:103]
  ds_read_b64_tr_b16 a[204:205], v211 offset:49152
  ds_read_b64_tr_b16 a[206:207], v211 offset:53248
  v_mfma_f32_16x16x32_bf16 v[108:111], a[212:215], a[172:175], v[108:111]
  s_waitcnt lgkmcnt(8)
  v_mfma_f32_16x16x32_bf16 v[112:115], a[216:219], a[168:171], v[112:115]
  ds_read_b64_tr_b16 a[208:209], v212 offset:49152
  ds_read_b64_tr_b16 a[210:211], v212 offset:53248
  v_mfma_f32_16x16x32_bf16 v[120:123], a[216:219], a[172:175], v[120:123]
  buffer_load_dwordx4 a[164:167], v3, s[12:15], s18 offen offset:1024 sc1
  v_mfma_f32_16x16x32_bf16 v[116:119], a[220:223], a[168:171], v[116:119]
  ds_read_b64_tr_b16 a[212:213], v213 offset:49152
  ds_read_b64_tr_b16 a[214:215], v213 offset:53248
  v_mfma_f32_16x16x32_bf16 v[124:127], a[220:223], a[172:175], v[124:127]
  s_waitcnt vmcnt(24) lgkmcnt(8)
  v_mfma_f32_16x16x32_bf16 v[64:67], a[192:195], a[176:179], v[64:67]
  ds_read_b64_tr_b16 a[216:217], v214 offset:49152
  ds_read_b64_tr_b16 a[218:219], v214 offset:53248
  v_mfma_f32_16x16x32_bf16 v[72:75], a[192:195], a[180:183], v[72:75]
  buffer_load_dwordx4 a[168:171], v3, s[12:15], s18 offen offset:2048 sc1
  v_mfma_f32_16x16x32_bf16 v[68:71], a[196:199], a[176:179], v[68:71]
  ds_read_b64_tr_b16 a[220:221], v215 offset:49152
  ds_read_b64_tr_b16 a[222:223], v215 offset:53248
  v_mfma_f32_16x16x32_bf16 v[76:79], a[196:199], a[180:183], v[76:79]
  s_waitcnt lgkmcnt(8)
  v_mfma_f32_16x16x32_bf16 v[80:83], a[200:203], a[176:179], v[80:83]
  ds_read_b64_tr_b16 a[192:193], v208 offset:57344
  ds_read_b64_tr_b16 a[194:195], v208 offset:61440
  v_mfma_f32_16x16x32_bf16 v[88:91], a[200:203], a[180:183], v[88:91]
  buffer_load_dwordx4 a[172:175], v3, s[12:15], s18 offen offset:3072 sc1
  s_add_u32 s18, s18, 4096
  v_mfma_f32_16x16x32_bf16 v[84:87], a[204:207], a[176:179], v[84:87]
  ds_read_b64_tr_b16 a[196:197], v209 offset:57344
  ds_read_b64_tr_b16 a[198:199], v209 offset:61440
  v_mfma_f32_16x16x32_bf16 v[92:95], a[204:207], a[180:183], v[92:95]
  s_add_u32 m0, s19, 81920
  s_waitcnt lgkmcnt(8)
  v_mfma_f32_16x16x32_bf16 v[96:99], a[208:211], a[176:179], v[96:99]
  ds_read_b64_tr_b16 a[200:201], v210 offset:57344
  ds_read_b64_tr_b16 a[202:203], v210 offset:61440
  v_mfma_f32_16x16x32_bf16 v[104:107], a[208:211], a[180:183], v[104:107]
  buffer_load_dwordx4 v4, s[8:11], s17 offen offset:0 lds
  v_mfma_f32_16x16x32_bf16 v[100:103], a[212:215], a[176:179], v[100:103]
  ds_read_b64_tr_b16 a[204:205], v211 offset:57344
  ds_read_b64_tr_b16 a[206:207], v211 offset:61440
  v_mfma_f32_16x16x32_bf16 v[108:111], a[212:215], a[180:183], v[108:111]
  s_waitcnt lgkmcnt(8)
  v_mfma_f32_16x16x32_bf16 v[112:115], a[216:219], a[176:179], v[112:115]
  ds_read_b64_tr_b16 a[208:209], v212 offset:57344
  ds_read_b64_tr_b16 a[210:211], v212 offset:61440
  v_mfma_f32_16x16x32_bf16 v[120:123], a[216:219], a[180:183], v[120:123]
  buffer_load_dwordx4 v5, s[8:11], s17 offen offset:1024 lds
  v_mfma_f32_16x16x32_bf16 v[116:119], a[220:223], a[176:179], v[116:119]
  ds_read_b64_tr_b16 a[212:213], v213 offset:57344
  ds_read_b64_tr_b16 a[214:215], v213 offset:61440
  v_mfma_f32_16x16x32_bf16 v[124:127], a[220:223], a[180:183], v[124:127]
  s_waitcnt vmcnt(26) lgkmcnt(8)
  v_mfma_f32_16x16x32_bf16 v[64:67], a[192:195], a[184:187], v[64:67]
  ds_read_b64_tr_b16 a[216:217], v214 offset:57344
  ds_read_b64_tr_b16 a[218:219], v214 offset:61440
  v_mfma_f32_16x16x32_bf16 v[72:75], a[192:195], a[188:191], v[72:75]
  buffer_load_dwordx4 v6, s[8:11], s17 offen offset:2048 lds
  v_mfma_f32_16x16x32_bf16 v[68:71], a[196:199], a[184:187], v[68:71]
  ds_read_b64_tr_b16 a[220:221], v215 offset:57344
  ds_read_b64_tr_b16 a[222:223], v215 offset:61440
  v_mfma_f32_16x16x32_bf16 v[76:79], a[196:199], a[188:191], v[76:79]
  s_waitcnt lgkmcnt(8)
  v_mfma_f32_16x16x32_bf16 v[80:83], a[200:203], a[184:187], v[80:83]
  s_barrier
  ds_read_b64_tr_b16 a[192:193], v8 offset:0
  ds_read_b64_tr_b16 a[194:195], v8 offset:4096
  v_mfma_f32_16x16x32_bf16 v[88:91], a[200:203], a[188:191], v[88:91]
  buffer_load_dwordx4 v7, s[8:11], s17 offen offset:3072 lds
  s_add_u32 s17, s17, 262144
  v_mfma_f32_16x16x32_bf16 v[84:87], a[204:207], a[184:187], v[84:87]
  ds_read_b64_tr_b16 a[196:197], v9 offset:0
  ds_read_b64_tr_b16 a[198:199], v9 offset:4096
  v_mfma_f32_16x16x32_bf16 v[92:95], a[204:207], a[188:191], v[92:95]
  s_waitcnt lgkmcnt(8)
  v_mfma_f32_16x16x32_bf16 v[96:99], a[208:211], a[184:187], v[96:99]
  ds_read_b64_tr_b16 a[200:201], v10 offset:0
  ds_read_b64_tr_b16 a[202:203], v10 offset:4096
  v_mfma_f32_16x16x32_bf16 v[104:107], a[208:211], a[188:191], v[104:107]
  buffer_load_dwordx4 a[176:179], v3, s[12:15], s18 offen offset:0 sc1
  v_mfma_f32_16x16x32_bf16 v[100:103], a[212:215], a[184:187], v[100:103]
  ds_read_b64_tr_b16 a[204:205], v11 offset:0
  ds_read_b64_tr_b16 a[206:207], v11 offset:4096
  v_mfma_f32_16x16x32_bf16 v[108:111], a[212:215], a[188:191], v[108:111]
  s_waitcnt lgkmcnt(8)
  v_mfma_f32_16x16x32_bf16 v[112:115], a[216:219], a[184:187], v[112:115]
  ds_read_b64_tr_b16 a[208:209], v40 offset:0
  ds_read_b64_tr_b16 a[210:211], v40 offset:4096
  v_mfma_f32_16x16x32_bf16 v[120:123], a[216:219], a[188:191], v[120:123]
  buffer_load_dwordx4 a[180:183], v3, s[12:15], s18 offen offset:1024 sc1
  v_mfma_f32_16x16x32_bf16 v[116:119], a[220:223], a[184:187], v[116:119]
  ds_read_b64_tr_b16 a[212:213], v41 offset:0
  ds_read_b64_tr_b16 a[214:215], v41 offset:4096
  v_mfma_f32_16x16x32_bf16 v[124:127], a[220:223], a[188:191], v[124:127]
  s_waitcnt vmcnt(24) lgkmcnt(8)
  v_mfma_f32_16x16x32_bf16 v[128:131], a[128:131], a[192:195], 0
  ds_read_b64_tr_b16 a[216:217], v42 offset:0
  ds_read_b64_tr_b16 a[218:219], v42 offset:4096
  v_add_u32 v60, 512, v60
  s_mov_b32 s60, s90
  v_mfma_f32_16x16x32_bf16 v[132:135], a[132:135], a[192:195], 0
  buffer_load_dwordx4 a[184:187], v3, s[12:15], s18 offen offset:2048 sc1
  s_and_b32 s61, s91, 0xffff
  s_mov_b32 s62, 4096
  v_mfma_f32_16x16x32_bf16 v[136:139], a[128:131], a[196:199], 0
  ds_read_b64_tr_b16 a[220:221], v43 offset:0
  ds_read_b64_tr_b16 a[222:223], v43 offset:4096
  s_mov_b32 s63, 0x00020000
  v_and_b32 v1, 15, v2
  v_lshlrev_b32 v1, 1, v1
  v_mfma_f32_16x16x32_bf16 v[140:143], a[132:135], a[196:199], 0
  s_lshl_b32 s21, s41, 8
  buffer_load_ushort v224, v1, s[60:63], s21 offen offset:0
  s_waitcnt lgkmcnt(8)
  v_mfma_f32_16x16x32_bf16 v[144:147], a[128:131], a[200:203], 0
  ds_read_b64_tr_b16 a[192:193], v8 offset:8192
  ds_read_b64_tr_b16 a[194:195], v8 offset:12288
  buffer_load_ushort v225, v1, s[60:63], s21 offen offset:32
  buffer_load_ushort v226, v1, s[60:63], s21 offen offset:64
  buffer_load_ushort v227, v1, s[60:63], s21 offen offset:96
  v_mfma_f32_16x16x32_bf16 v[148:151], a[132:135], a[200:203], 0
  buffer_load_dwordx4 a[188:191], v3, s[12:15], s18 offen offset:3072 sc1
  s_add_u32 s18, s18, 4096
  buffer_load_ushort v228, v1, s[60:63], s21 offen offset:128
  buffer_load_ushort v229, v1, s[60:63], s21 offen offset:160
  v_mfma_f32_16x16x32_bf16 v[152:155], a[128:131], a[204:207], 0
  ds_read_b64_tr_b16 a[196:197], v9 offset:8192
  ds_read_b64_tr_b16 a[198:199], v9 offset:12288
  buffer_load_ushort v230, v1, s[60:63], s21 offen offset:192
  buffer_load_ushort v231, v1, s[60:63], s21 offen offset:224
  s_lshl_b32 s21, s38, 2
  v_mfma_f32_16x16x32_bf16 v[156:159], a[132:135], a[204:207], 0
  s_add_u32 m0, s19, 98304
  s_add_u32 s21, s21, s16
  s_mul_i32 s22, s21, 229376
  s_waitcnt lgkmcnt(8)
  v_mfma_f32_16x16x32_bf16 v[160:163], a[128:131], a[208:211], 0
  ds_read_b64_tr_b16 a[200:201], v10 offset:8192
  ds_read_b64_tr_b16 a[202:203], v10 offset:12288
  s_add_u32 s22, s22, 25165824
  s_add_u32 s32, s96, s22
  s_addc_u32 s33, s97, 0
  s_and_b32 s33, s33, 0xffff
  v_mfma_f32_16x16x32_bf16 v[164:167], a[132:135], a[208:211], 0
  buffer_load_dwordx4 v4, s[8:11], s17 offen offset:0 lds
  s_mov_b32 s34, 229376
  s_mov_b32 s35, 0x00020000
  v_mfma_f32_16x16x32_bf16 v[168:171], a[128:131], a[212:215], 0
  ds_read_b64_tr_b16 a[204:205], v11 offset:8192
  ds_read_b64_tr_b16 a[206:207], v11 offset:12288
  v_mov_b32 v35, 0xc0135761
  s_mov_b32 s23, 0xbdd2d3e8
  s_lshl_b32 s65, s71, 6
  v_mfma_f32_16x16x32_bf16 v[172:175], a[132:135], a[212:215], 0
  v_mul_f32 v192, v64, v64
  v_mul_f32 v193, v65, v65
  s_waitcnt lgkmcnt(8)
  v_mfma_f32_16x16x32_bf16 v[176:179], a[128:131], a[216:219], 0
  ds_read_b64_tr_b16 a[208:209], v40 offset:8192
  ds_read_b64_tr_b16 a[210:211], v40 offset:12288
  v_mul_f32 v194, v66, v66
  v_mul_f32 v195, v67, v67
  v_fma_f32 v192, v192, s23, v35
  v_mfma_f32_16x16x32_bf16 v[180:183], a[132:135], a[216:219], 0
  buffer_load_dwordx4 v5, s[8:11], s17 offen offset:1024 lds
  v_fma_f32 v193, v193, s23, v35
  v_fma_f32 v194, v194, s23, v35
  v_mfma_f32_16x16x32_bf16 v[184:187], a[128:131], a[220:223], 0
  ds_read_b64_tr_b16 a[212:213], v41 offset:8192
  ds_read_b64_tr_b16 a[214:215], v41 offset:12288
  v_fma_f32 v195, v195, s23, v35
  v_mul_f32 v192, v192, v64
  v_mfma_f32_16x16x32_bf16 v[188:191], a[132:135], a[220:223], 0
  v_mul_f32 v193, v193, v65
  v_mul_f32 v194, v194, v66
  v_mul_f32 v195, v195, v67
  s_waitcnt vmcnt(34) lgkmcnt(8)
  v_mfma_f32_16x16x32_bf16 v[128:131], a[136:139], a[192:195], v[128:131]
  ds_read_b64_tr_b16 a[216:217], v42 offset:8192
  ds_read_b64_tr_b16 a[218:219], v42 offset:12288
  v_exp_f32 v192, v192
  v_exp_f32 v193, v193
  v_mfma_f32_16x16x32_bf16 v[132:135], a[140:143], a[192:195], v[132:135]
  buffer_load_dwordx4 v6, s[8:11], s17 offen offset:2048 lds
  v_exp_f32 v194, v194
  v_exp_f32 v195, v195
  v_add_f32 v192, 1.0, v192
  v_mfma_f32_16x16x32_bf16 v[136:139], a[136:139], a[196:199], v[136:139]
  ds_read_b64_tr_b16 a[220:221], v43 offset:8192
  ds_read_b64_tr_b16 a[222:223], v43 offset:12288
  v_add_f32 v193, 1.0, v193
  v_add_f32 v194, 1.0, v194
  v_mfma_f32_16x16x32_bf16 v[140:143], a[140:143], a[196:199], v[140:143]
  v_add_f32 v195, 1.0, v195
  v_rcp_f32 v192, v192
  v_rcp_f32 v193, v193
  s_waitcnt lgkmcnt(8)
  v_mfma_f32_16x16x32_bf16 v[144:147], a[136:139], a[200:203], v[144:147]
  s_barrier
  ds_read_b64_tr_b16 a[192:193], v8 offset:16384
  ds_read_b64_tr_b16 a[194:195], v8 offset:20480
  v_rcp_f32 v194, v194
  v_rcp_f32 v195, v195
  v_mfma_f32_16x16x32_bf16 v[148:151], a[140:143], a[200:203], v[148:151]
  buffer_load_dwordx4 v7, s[8:11], s17 offen offset:3072 lds
  s_add_u32 s17, s17, 262144
  v_mul_f32 v64, v64, v192
  v_mul_f32 v65, v65, v193
  v_mul_f32 v66, v66, v194
  v_mfma_f32_16x16x32_bf16 v[152:155], a[136:139], a[204:207], v[152:155]
  ds_read_b64_tr_b16 a[196:197], v9 offset:16384
  ds_read_b64_tr_b16 a[198:199], v9 offset:20480
  v_mul_f32 v67, v67, v195
  v_cvt_pk_bf16_f32 v64, v64, v65
  v_mfma_f32_16x16x32_bf16 v[156:159], a[140:143], a[204:207], v[156:159]
  v_cvt_pk_bf16_f32 v65, v66, v67
  v_mul_f32 v192, v68, v68
  v_mul_f32 v193, v69, v69
  s_waitcnt lgkmcnt(8)
  v_mfma_f32_16x16x32_bf16 v[160:163], a[136:139], a[208:211], v[160:163]
  ds_read_b64_tr_b16 a[200:201], v10 offset:16384
  ds_read_b64_tr_b16 a[202:203], v10 offset:20480
  v_mul_f32 v194, v70, v70
  v_mul_f32 v195, v71, v71
  v_mfma_f32_16x16x32_bf16 v[164:167], a[140:143], a[208:211], v[164:167]
  buffer_load_dwordx4 a[128:131], v3, s[12:15], s18 offen offset:0 sc1
  v_fma_f32 v192, v192, s23, v35
  v_fma_f32 v193, v193, s23, v35
  v_fma_f32 v194, v194, s23, v35
  v_mfma_f32_16x16x32_bf16 v[168:171], a[136:139], a[212:215], v[168:171]
  ds_read_b64_tr_b16 a[204:205], v11 offset:16384
  ds_read_b64_tr_b16 a[206:207], v11 offset:20480
  v_fma_f32 v195, v195, s23, v35
  v_mul_f32 v192, v192, v68
  v_mfma_f32_16x16x32_bf16 v[172:175], a[140:143], a[212:215], v[172:175]
  v_mul_f32 v193, v193, v69
  v_mul_f32 v194, v194, v70
  s_waitcnt lgkmcnt(8)
  v_mfma_f32_16x16x32_bf16 v[176:179], a[136:139], a[216:219], v[176:179]
  ds_read_b64_tr_b16 a[208:209], v40 offset:16384
  ds_read_b64_tr_b16 a[210:211], v40 offset:20480
  v_mul_f32 v195, v195, v71
  v_exp_f32 v192, v192
  v_exp_f32 v193, v193
  v_mfma_f32_16x16x32_bf16 v[180:183], a[140:143], a[216:219], v[180:183]
  buffer_load_dwordx4 a[132:135], v3, s[12:15], s18 offen offset:1024 sc1
  v_exp_f32 v194, v194
  v_exp_f32 v195, v195
  v_mfma_f32_16x16x32_bf16 v[184:187], a[136:139], a[220:223], v[184:187]
  ds_read_b64_tr_b16 a[212:213], v41 offset:16384
  ds_read_b64_tr_b16 a[214:215], v41 offset:20480
  v_add_f32 v192, 1.0, v192
  v_add_f32 v193, 1.0, v193
  v_add_f32 v194, 1.0, v194
  v_mfma_f32_16x16x32_bf16 v[188:191], a[140:143], a[220:223], v[188:191]
  v_add_f32 v195, 1.0, v195
  v_rcp_f32 v192, v192
  s_waitcnt vmcnt(32) lgkmcnt(8)
  v_mfma_f32_16x16x32_bf16 v[128:131], a[144:147], a[192:195], v[128:131]
  ds_read_b64_tr_b16 a[216:217], v42 offset:16384
  ds_read_b64_tr_b16 a[218:219], v42 offset:20480
  v_rcp_f32 v193, v193
  v_rcp_f32 v194, v194
  v_rcp_f32 v195, v195
  v_mfma_f32_16x16x32_bf16 v[132:135], a[148:151], a[192:195], v[132:135]
  buffer_load_dwordx4 a[136:139], v3, s[12:15], s18 offen offset:2048 sc1
  v_mul_f32 v68, v68, v192
  v_mul_f32 v69, v69, v193
  v_mfma_f32_16x16x32_bf16 v[136:139], a[144:147], a[196:199], v[136:139]
  ds_read_b64_tr_b16 a[220:221], v43 offset:16384
  ds_read_b64_tr_b16 a[222:223], v43 offset:20480
  v_mul_f32 v70, v70, v194
  v_mul_f32 v71, v71, v195
  v_cvt_pk_bf16_f32 v66, v68, v69
  v_mfma_f32_16x16x32_bf16 v[140:143], a[148:151], a[196:199], v[140:143]
  v_cvt_pk_bf16_f32 v67, v70, v71
  buffer_store_dwordx4 v[64:67], v3, s[32:35], s65 offen offset:0 sc1
  s_waitcnt lgkmcnt(8)
  v_mfma_f32_16x16x32_bf16 v[144:147], a[144:147], a[200:203], v[144:147]
  ds_read_b64_tr_b16 a[192:193], v8 offset:24576
  ds_read_b64_tr_b16 a[194:195], v8 offset:28672
  v_mul_f32 v192, v72, v72
  v_mul_f32 v193, v73, v73
  v_mul_f32 v194, v74, v74
  v_mfma_f32_16x16x32_bf16 v[148:151], a[148:151], a[200:203], v[148:151]
  buffer_load_dwordx4 a[140:143], v3, s[12:15], s18 offen offset:3072 sc1
  s_add_u32 s18, s18, 4096
  v_mul_f32 v195, v75, v75
  v_fma_f32 v192, v192, s23, v35
  v_mfma_f32_16x16x32_bf16 v[152:155], a[144:147], a[204:207], v[152:155]
  ds_read_b64_tr_b16 a[196:197], v9 offset:24576
  ds_read_b64_tr_b16 a[198:199], v9 offset:28672
  v_fma_f32 v193, v193, s23, v35
  v_fma_f32 v194, v194, s23, v35
  v_fma_f32 v195, v195, s23, v35
  v_mfma_f32_16x16x32_bf16 v[156:159], a[148:151], a[204:207], v[156:159]
  s_add_u32 m0, s19, 114688
  v_mul_f32 v192, v192, v72
  v_mul_f32 v193, v193, v73
  s_waitcnt lgkmcnt(8)
  v_mfma_f32_16x16x32_bf16 v[160:163], a[144:147], a[208:211], v[160:163]
  ds_read_b64_tr_b16 a[200:201], v10 offset:24576
  ds_read_b64_tr_b16 a[202:203], v10 offset:28672
  v_mul_f32 v194, v194, v74
  v_mul_f32 v195, v195, v75
  v_exp_f32 v192, v192
  v_mfma_f32_16x16x32_bf16 v[164:167], a[148:151], a[208:211], v[164:167]
  buffer_load_dwordx4 v4, s[8:11], s17 offen offset:0 lds
  v_exp_f32 v193, v193
  v_exp_f32 v194, v194
  v_mfma_f32_16x16x32_bf16 v[168:171], a[144:147], a[212:215], v[168:171]
  ds_read_b64_tr_b16 a[204:205], v11 offset:24576
  ds_read_b64_tr_b16 a[206:207], v11 offset:28672
  v_exp_f32 v195, v195
  v_add_f32 v192, 1.0, v192
  v_mfma_f32_16x16x32_bf16 v[172:175], a[148:151], a[212:215], v[172:175]
  v_add_f32 v193, 1.0, v193
  v_add_f32 v194, 1.0, v194
  v_add_f32 v195, 1.0, v195
  s_waitcnt lgkmcnt(8)
  v_mfma_f32_16x16x32_bf16 v[176:179], a[144:147], a[216:219], v[176:179]
  ds_read_b64_tr_b16 a[208:209], v40 offset:24576
  ds_read_b64_tr_b16 a[210:211], v40 offset:28672
  v_rcp_f32 v192, v192
  v_rcp_f32 v193, v193
  v_mfma_f32_16x16x32_bf16 v[180:183], a[148:151], a[216:219], v[180:183]
  buffer_load_dwordx4 v5, s[8:11], s17 offen offset:1024 lds
  v_rcp_f32 v194, v194
  v_rcp_f32 v195, v195
  v_mul_f32 v72, v72, v192
  v_mfma_f32_16x16x32_bf16 v[184:187], a[144:147], a[220:223], v[184:187]
  ds_read_b64_tr_b16 a[212:213], v41 offset:24576
  ds_read_b64_tr_b16 a[214:215], v41 offset:28672
  v_mul_f32 v73, v73, v193
  v_mul_f32 v74, v74, v194
  v_mfma_f32_16x16x32_bf16 v[188:191], a[148:151], a[220:223], v[188:191]
  v_mul_f32 v75, v75, v195
  v_cvt_pk_bf16_f32 v72, v72, v73
  v_cvt_pk_bf16_f32 v73, v74, v75
  s_waitcnt vmcnt(35) lgkmcnt(8)
  v_mfma_f32_16x16x32_bf16 v[128:131], a[152:155], a[192:195], v[128:131]
  ds_read_b64_tr_b16 a[216:217], v42 offset:24576
  ds_read_b64_tr_b16 a[218:219], v42 offset:28672
  v_mul_f32 v192, v76, v76
  v_mul_f32 v193, v77, v77
  v_mfma_f32_16x16x32_bf16 v[132:135], a[156:159], a[192:195], v[132:135]
  buffer_load_dwordx4 v6, s[8:11], s17 offen offset:2048 lds
  v_mul_f32 v194, v78, v78
  v_mul_f32 v195, v79, v79
  v_fma_f32 v192, v192, s23, v35
  v_mfma_f32_16x16x32_bf16 v[136:139], a[152:155], a[196:199], v[136:139]
  ds_read_b64_tr_b16 a[220:221], v43 offset:24576
  ds_read_b64_tr_b16 a[222:223], v43 offset:28672
  v_fma_f32 v193, v193, s23, v35
  v_fma_f32 v194, v194, s23, v35
  v_mfma_f32_16x16x32_bf16 v[140:143], a[156:159], a[196:199], v[140:143]
  v_fma_f32 v195, v195, s23, v35
  v_mul_f32 v192, v192, v76
  v_mul_f32 v193, v193, v77
  s_waitcnt lgkmcnt(8)
  v_mfma_f32_16x16x32_bf16 v[144:147], a[152:155], a[200:203], v[144:147]
  s_barrier
  ds_read_b64_tr_b16 a[192:193], v8 offset:32768
  ds_read_b64_tr_b16 a[194:195], v8 offset:36864
  v_mul_f32 v194, v194, v78
  v_mul_f32 v195, v195, v79
  v_mfma_f32_16x16x32_bf16 v[148:151], a[156:159], a[200:203], v[148:151]
  buffer_load_dwordx4 v7, s[8:11], s17 offen offset:3072 lds
  s_add_u32 s17, s17, 262144
  v_exp_f32 v192, v192
  v_exp_f32 v193, v193
  v_exp_f32 v194, v194
  v_mfma_f32_16x16x32_bf16 v[152:155], a[152:155], a[204:207], v[152:155]
  ds_read_b64_tr_b16 a[196:197], v9 offset:32768
  ds_read_b64_tr_b16 a[198:199], v9 offset:36864
  v_exp_f32 v195, v195
  v_add_f32 v192, 1.0, v192
  v_mfma_f32_16x16x32_bf16 v[156:159], a[156:159], a[204:207], v[156:159]
  v_add_f32 v193, 1.0, v193
  v_add_f32 v194, 1.0, v194
  s_waitcnt lgkmcnt(8)
  v_mfma_f32_16x16x32_bf16 v[160:163], a[152:155], a[208:211], v[160:163]
  ds_read_b64_tr_b16 a[200:201], v10 offset:32768
  ds_read_b64_tr_b16 a[202:203], v10 offset:36864
  v_add_f32 v195, 1.0, v195
  v_rcp_f32 v192, v192
  v_rcp_f32 v193, v193
  v_mfma_f32_16x16x32_bf16 v[164:167], a[156:159], a[208:211], v[164:167]
  buffer_load_dwordx4 a[144:147], v3, s[12:15], s18 offen offset:0 sc1
  v_rcp_f32 v194, v194
  v_rcp_f32 v195, v195
  v_mfma_f32_16x16x32_bf16 v[168:171], a[152:155], a[212:215], v[168:171]
  ds_read_b64_tr_b16 a[204:205], v11 offset:32768
  ds_read_b64_tr_b16 a[206:207], v11 offset:36864
  v_mul_f32 v76, v76, v192
  v_mul_f32 v77, v77, v193
  v_mul_f32 v78, v78, v194
  v_mfma_f32_16x16x32_bf16 v[172:175], a[156:159], a[212:215], v[172:175]
  v_mul_f32 v79, v79, v195
  v_cvt_pk_bf16_f32 v74, v76, v77
  s_waitcnt lgkmcnt(8)
  v_mfma_f32_16x16x32_bf16 v[176:179], a[152:155], a[216:219], v[176:179]
  ds_read_b64_tr_b16 a[208:209], v40 offset:32768
  ds_read_b64_tr_b16 a[210:211], v40 offset:36864
  v_cvt_pk_bf16_f32 v75, v78, v79
  buffer_store_dwordx4 v[72:75], v3, s[32:35], s65 offen offset:1024 sc1
  v_mul_f32 v192, v80, v80
  v_mfma_f32_16x16x32_bf16 v[180:183], a[156:159], a[216:219], v[180:183]
  buffer_load_dwordx4 a[148:151], v3, s[12:15], s18 offen offset:1024 sc1
  v_mul_f32 v193, v81, v81
  v_mul_f32 v194, v82, v82
  v_mfma_f32_16x16x32_bf16 v[184:187], a[152:155], a[220:223], v[184:187]
  ds_read_b64_tr_b16 a[212:213], v41 offset:32768
  ds_read_b64_tr_b16 a[214:215], v41 offset:36864
  v_mul_f32 v195, v83, v83
  v_fma_f32 v192, v192, s23, v35
  v_fma_f32 v193, v193, s23, v35
  v_mfma_f32_16x16x32_bf16 v[188:191], a[156:159], a[220:223], v[188:191]
  v_fma_f32 v194, v194, s23, v35
  v_fma_f32 v195, v195, s23, v35
  s_waitcnt vmcnt(34) lgkmcnt(8)
  v_mfma_f32_16x16x32_bf16 v[128:131], a[160:163], a[192:195], v[128:131]
  ds_read_b64_tr_b16 a[216:217], v42 offset:32768
  ds_read_b64_tr_b16 a[218:219], v42 offset:36864
  v_mul_f32 v192, v192, v80
  v_mul_f32 v193, v193, v81
  v_mul_f32 v194, v194, v82
  v_mfma_f32_16x16x32_bf16 v[132:135], a[164:167], a[192:195], v[132:135]
  buffer_load_dwordx4 a[152:155], v3, s[12:15], s18 offen offset:2048 sc1
  v_mul_f32 v195, v195, v83
  v_exp_f32 v192, v192
  v_mfma_f32_16x16x32_bf16 v[136:139], a[160:163], a[196:199], v[136:139]
  ds_read_b64_tr_b16 a[220:221], v43 offset:32768
  ds_read_b64_tr_b16 a[222:223], v43 offset:36864
  v_exp_f32 v193, v193
  v_exp_f32 v194, v194
  v_exp_f32 v195, v195
  v_mfma_f32_16x16x32_bf16 v[140:143], a[164:167], a[196:199], v[140:143]
  v_add_f32 v192, 1.0, v192
  v_add_f32 v193, 1.0, v193
  s_waitcnt lgkmcnt(8)
  v_mfma_f32_16x16x32_bf16 v[144:147], a[160:163], a[200:203], v[144:147]
  ds_read_b64_tr_b16 a[192:193], v8 offset:40960
  ds_read_b64_tr_b16 a[194:195], v8 offset:45056
  v_add_f32 v194, 1.0, v194
  v_add_f32 v195, 1.0, v195
  v_rcp_f32 v192, v192
  v_mfma_f32_16x16x32_bf16 v[148:151], a[164:167], a[200:203], v[148:151]
  buffer_load_dwordx4 a[156:159], v3, s[12:15], s18 offen offset:3072 sc1
  s_add_u32 s18, s18, 4096
  v_rcp_f32 v193, v193
  v_rcp_f32 v194, v194
  v_mfma_f32_16x16x32_bf16 v[152:155], a[160:163], a[204:207], v[152:155]
  ds_read_b64_tr_b16 a[196:197], v9 offset:40960
  ds_read_b64_tr_b16 a[198:199], v9 offset:45056
  v_rcp_f32 v195, v195
  v_mul_f32 v80, v80, v192
  v_mfma_f32_16x16x32_bf16 v[156:159], a[164:167], a[204:207], v[156:159]
  s_add_u32 m0, s19, 0
  v_mul_f32 v81, v81, v193
  v_mul_f32 v82, v82, v194
  v_mul_f32 v83, v83, v195
  s_waitcnt lgkmcnt(8)
  v_mfma_f32_16x16x32_bf16 v[160:163], a[160:163], a[208:211], v[160:163]
  ds_read_b64_tr_b16 a[200:201], v10 offset:40960
  ds_read_b64_tr_b16 a[202:203], v10 offset:45056
  v_cvt_pk_bf16_f32 v80, v80, v81
  v_cvt_pk_bf16_f32 v81, v82, v83
  v_mfma_f32_16x16x32_bf16 v[164:167], a[164:167], a[208:211], v[164:167]
  buffer_load_dwordx4 v4, s[8:11], s17 offen offset:0 lds
  v_mul_f32 v192, v84, v84
  v_mul_f32 v193, v85, v85
  v_mul_f32 v194, v86, v86
  v_mfma_f32_16x16x32_bf16 v[168:171], a[160:163], a[212:215], v[168:171]
  ds_read_b64_tr_b16 a[204:205], v11 offset:40960
  ds_read_b64_tr_b16 a[206:207], v11 offset:45056
  v_mul_f32 v195, v87, v87
  v_fma_f32 v192, v192, s23, v35
  v_mfma_f32_16x16x32_bf16 v[172:175], a[164:167], a[212:215], v[172:175]
  v_fma_f32 v193, v193, s23, v35
  v_fma_f32 v194, v194, s23, v35
  v_fma_f32 v195, v195, s23, v35
  s_waitcnt lgkmcnt(8)
  v_mfma_f32_16x16x32_bf16 v[176:179], a[160:163], a[216:219], v[176:179]
  ds_read_b64_tr_b16 a[208:209], v40 offset:40960
  ds_read_b64_tr_b16 a[210:211], v40 offset:45056
  v_mul_f32 v192, v192, v84
  v_mul_f32 v193, v193, v85
  v_mfma_f32_16x16x32_bf16 v[180:183], a[164:167], a[216:219], v[180:183]
  buffer_load_dwordx4 v5, s[8:11], s17 offen offset:1024 lds
  v_mul_f32 v194, v194, v86
  v_mul_f32 v195, v195, v87
  v_exp_f32 v192, v192
  v_mfma_f32_16x16x32_bf16 v[184:187], a[160:163], a[220:223], v[184:187]
  ds_read_b64_tr_b16 a[212:213], v41 offset:40960
  ds_read_b64_tr_b16 a[214:215], v41 offset:45056
  v_exp_f32 v193, v193
  v_exp_f32 v194, v194
  v_mfma_f32_16x16x32_bf16 v[188:191], a[164:167], a[220:223], v[188:191]
  v_exp_f32 v195, v195
  v_add_f32 v192, 1.0, v192
  v_add_f32 v193, 1.0, v193
  s_waitcnt vmcnt(36) lgkmcnt(8)
  v_mfma_f32_16x16x32_bf16 v[128:131], a[168:171], a[192:195], v[128:131]
  ds_read_b64_tr_b16 a[216:217], v42 offset:40960
  ds_read_b64_tr_b16 a[218:219], v42 offset:45056
  v_add_f32 v194, 1.0, v194
  v_add_f32 v195, 1.0, v195
  v_mfma_f32_16x16x32_bf16 v[132:135], a[172:175], a[192:195], v[132:135]
  buffer_load_dwordx4 v6, s[8:11], s17 offen offset:2048 lds
  v_rcp_f32 v192, v192
  v_rcp_f32 v193, v193
  v_rcp_f32 v194, v194
  v_mfma_f32_16x16x32_bf16 v[136:139], a[168:171], a[196:199], v[136:139]
  ds_read_b64_tr_b16 a[220:221], v43 offset:40960
  ds_read_b64_tr_b16 a[222:223], v43 offset:45056
  v_rcp_f32 v195, v195
  v_mul_f32 v84, v84, v192
  v_mfma_f32_16x16x32_bf16 v[140:143], a[172:175], a[196:199], v[140:143]
  v_mul_f32 v85, v85, v193
  v_mul_f32 v86, v86, v194
  s_waitcnt lgkmcnt(8)
  v_mfma_f32_16x16x32_bf16 v[144:147], a[168:171], a[200:203], v[144:147]
  s_barrier
  ds_read_b64_tr_b16 a[192:193], v8 offset:49152
  ds_read_b64_tr_b16 a[194:195], v8 offset:53248
  v_mul_f32 v87, v87, v195
  v_cvt_pk_bf16_f32 v82, v84, v85
  v_cvt_pk_bf16_f32 v83, v86, v87
  v_mfma_f32_16x16x32_bf16 v[148:151], a[172:175], a[200:203], v[148:151]
  buffer_load_dwordx4 v7, s[8:11], s17 offen offset:3072 lds
  s_add_u32 s17, s17, 262144
  buffer_store_dwordx4 v[80:83], v3, s[32:35], s65 offen offset:2048 sc1
  v_mul_f32 v192, v88, v88
  v_mfma_f32_16x16x32_bf16 v[152:155], a[168:171], a[204:207], v[152:155]
  ds_read_b64_tr_b16 a[196:197], v9 offset:49152
  ds_read_b64_tr_b16 a[198:199], v9 offset:53248
  v_mul_f32 v193, v89, v89
  v_mul_f32 v194, v90, v90
  v_mul_f32 v195, v91, v91
  v_mfma_f32_16x16x32_bf16 v[156:159], a[172:175], a[204:207], v[156:159]
  v_fma_f32 v192, v192, s23, v35
  v_fma_f32 v193, v193, s23, v35
  s_waitcnt lgkmcnt(8)
  v_mfma_f32_16x16x32_bf16 v[160:163], a[168:171], a[208:211], v[160:163]
  ds_read_b64_tr_b16 a[200:201], v10 offset:49152
  ds_read_b64_tr_b16 a[202:203], v10 offset:53248
  v_fma_f32 v194, v194, s23, v35
  v_fma_f32 v195, v195, s23, v35
  v_mul_f32 v192, v192, v88
  v_mfma_f32_16x16x32_bf16 v[164:167], a[172:175], a[208:211], v[164:167]
  buffer_load_dwordx4 a[160:163], v3, s[12:15], s18 offen offset:0 sc1
  v_mul_f32 v193, v193, v89
  v_mul_f32 v194, v194, v90
  v_mfma_f32_16x16x32_bf16 v[168:171], a[168:171], a[212:215], v[168:171]
  ds_read_b64_tr_b16 a[204:205], v11 offset:49152
  ds_read_b64_tr_b16 a[206:207], v11 offset:53248
  v_mul_f32 v195, v195, v91
  v_exp_f32 v192, v192
  v_exp_f32 v193, v193
  v_mfma_f32_16x16x32_bf16 v[172:175], a[172:175], a[212:215], v[172:175]
  v_exp_f32 v194, v194
  v_exp_f32 v195, v195
  s_waitcnt lgkmcnt(8)
  v_mfma_f32_16x16x32_bf16 v[176:179], a[168:171], a[216:219], v[176:179]
  ds_read_b64_tr_b16 a[208:209], v40 offset:49152
  ds_read_b64_tr_b16 a[210:211], v40 offset:53248
  v_add_f32 v192, 1.0, v192
  v_add_f32 v193, 1.0, v193
  v_add_f32 v194, 1.0, v194
  v_mfma_f32_16x16x32_bf16 v[180:183], a[172:175], a[216:219], v[180:183]
  buffer_load_dwordx4 a[164:167], v3, s[12:15], s18 offen offset:1024 sc1
  v_add_f32 v195, 1.0, v195
  v_rcp_f32 v192, v192
  v_mfma_f32_16x16x32_bf16 v[184:187], a[168:171], a[220:223], v[184:187]
  ds_read_b64_tr_b16 a[212:213], v41 offset:49152
  ds_read_b64_tr_b16 a[214:215], v41 offset:53248
  v_rcp_f32 v193, v193
  v_rcp_f32 v194, v194
  v_rcp_f32 v195, v195
  v_mfma_f32_16x16x32_bf16 v[188:191], a[172:175], a[220:223], v[188:191]
  v_mul_f32 v88, v88, v192
  v_mul_f32 v89, v89, v193
  s_waitcnt vmcnt(35) lgkmcnt(8)
  v_mfma_f32_16x16x32_bf16 v[128:131], a[176:179], a[192:195], v[128:131]
  ds_read_b64_tr_b16 a[216:217], v42 offset:49152
  ds_read_b64_tr_b16 a[218:219], v42 offset:53248
  v_mul_f32 v90, v90, v194
  v_mul_f32 v91, v91, v195
  v_cvt_pk_bf16_f32 v88, v88, v89
  v_mfma_f32_16x16x32_bf16 v[132:135], a[180:183], a[192:195], v[132:135]
  buffer_load_dwordx4 a[168:171], v3, s[12:15], s18 offen offset:2048 sc1
  v_cvt_pk_bf16_f32 v89, v90, v91
  v_mul_f32 v192, v92, v92
  v_mfma_f32_16x16x32_bf16 v[136:139], a[176:179], a[196:199], v[136:139]
  ds_read_b64_tr_b16 a[220:221], v43 offset:49152
  ds_read_b64_tr_b16 a[222:223], v43 offset:53248
  v_mul_f32 v193, v93, v93
  v_mul_f32 v194, v94, v94
  v_mfma_f32_16x16x32_bf16 v[140:143], a[180:183], a[196:199], v[140:143]
  v_mul_f32 v195, v95, v95
  v_fma_f32 v192, v192, s23, v35
  v_fma_f32 v193, v193, s23, v35
  s_waitcnt lgkmcnt(8)
  v_mfma_f32_16x16x32_bf16 v[144:147], a[176:179], a[200:203], v[144:147]
  ds_read_b64_tr_b16 a[192:193], v8 offset:57344
  ds_read_b64_tr_b16 a[194:195], v8 offset:61440
  v_fma_f32 v194, v194, s23, v35
  v_fma_f32 v195, v195, s23, v35
  v_mfma_f32_16x16x32_bf16 v[148:151], a[180:183], a[200:203], v[148:151]
  buffer_load_dwordx4 a[172:175], v3, s[12:15], s18 offen offset:3072 sc1
  s_add_u32 s18, s18, 4096
  v_mul_f32 v192, v192, v92
  v_mul_f32 v193, v193, v93
  v_mul_f32 v194, v194, v94
  v_mfma_f32_16x16x32_bf16 v[152:155], a[176:179], a[204:207], v[152:155]
  ds_read_b64_tr_b16 a[196:197], v9 offset:57344
  ds_read_b64_tr_b16 a[198:199], v9 offset:61440
  v_mul_f32 v195, v195, v95
  v_exp_f32 v192, v192
  v_mfma_f32_16x16x32_bf16 v[156:159], a[180:183], a[204:207], v[156:159]
  s_add_u32 m0, s19, 16384
  v_exp_f32 v193, v193
  v_exp_f32 v194, v194
  v_exp_f32 v195, v195
  s_waitcnt lgkmcnt(8)
  v_mfma_f32_16x16x32_bf16 v[160:163], a[176:179], a[208:211], v[160:163]
  ds_read_b64_tr_b16 a[200:201], v10 offset:57344
  ds_read_b64_tr_b16 a[202:203], v10 offset:61440
  v_add_f32 v192, 1.0, v192
  v_add_f32 v193, 1.0, v193
  v_mfma_f32_16x16x32_bf16 v[164:167], a[180:183], a[208:211], v[164:167]
  buffer_load_dwordx4 v4, s[8:11], s17 offen offset:0 lds
  v_add_f32 v194, 1.0, v194
  v_add_f32 v195, 1.0, v195
  v_rcp_f32 v192, v192
  v_mfma_f32_16x16x32_bf16 v[168:171], a[176:179], a[212:215], v[168:171]
  ds_read_b64_tr_b16 a[204:205], v11 offset:57344
  ds_read_b64_tr_b16 a[206:207], v11 offset:61440
  v_rcp_f32 v193, v193
  v_rcp_f32 v194, v194
  v_mfma_f32_16x16x32_bf16 v[172:175], a[180:183], a[212:215], v[172:175]
  v_rcp_f32 v195, v195
  v_mul_f32 v92, v92, v192
  v_mul_f32 v93, v93, v193
  s_waitcnt lgkmcnt(8)
  v_mfma_f32_16x16x32_bf16 v[176:179], a[176:179], a[216:219], v[176:179]
  ds_read_b64_tr_b16 a[208:209], v40 offset:57344
  ds_read_b64_tr_b16 a[210:211], v40 offset:61440
  v_mul_f32 v94, v94, v194
  v_mul_f32 v95, v95, v195
  v_mfma_f32_16x16x32_bf16 v[180:183], a[180:183], a[216:219], v[180:183]
  buffer_load_dwordx4 v5, s[8:11], s17 offen offset:1024 lds
  v_cvt_pk_bf16_f32 v90, v92, v93
  v_cvt_pk_bf16_f32 v91, v94, v95
  buffer_store_dwordx4 v[88:91], v3, s[32:35], s65 offen offset:3072 sc1
  v_mfma_f32_16x16x32_bf16 v[184:187], a[176:179], a[220:223], v[184:187]
  ds_read_b64_tr_b16 a[212:213], v41 offset:57344
  ds_read_b64_tr_b16 a[214:215], v41 offset:61440
  v_mul_f32 v192, v96, v96
  v_mul_f32 v193, v97, v97
  v_mfma_f32_16x16x32_bf16 v[188:191], a[180:183], a[220:223], v[188:191]
  v_mul_f32 v194, v98, v98
  v_mul_f32 v195, v99, v99
  s_waitcnt vmcnt(34) lgkmcnt(8)
  v_mfma_f32_16x16x32_bf16 v[128:131], a[184:187], a[192:195], v[128:131]
  ds_read_b64_tr_b16 a[216:217], v42 offset:57344
  ds_read_b64_tr_b16 a[218:219], v42 offset:61440
  v_fma_f32 v192, v192, s23, v35
  v_fma_f32 v193, v193, s23, v35
  v_fma_f32 v194, v194, s23, v35
  v_mfma_f32_16x16x32_bf16 v[132:135], a[188:191], a[192:195], v[132:135]
  buffer_load_dwordx4 v6, s[8:11], s17 offen offset:2048 lds
  v_fma_f32 v195, v195, s23, v35
  v_mul_f32 v192, v192, v96
  v_mfma_f32_16x16x32_bf16 v[136:139], a[184:187], a[196:199], v[136:139]
  ds_read_b64_tr_b16 a[220:221], v43 offset:57344
  ds_read_b64_tr_b16 a[222:223], v43 offset:61440
  v_mul_f32 v193, v193, v97
  v_mul_f32 v194, v194, v98
  v_mul_f32 v195, v195, v99
  v_mfma_f32_16x16x32_bf16 v[140:143], a[188:191], a[196:199], v[140:143]
  v_exp_f32 v192, v192
  v_exp_f32 v193, v193
  s_waitcnt lgkmcnt(8)
  v_mfma_f32_16x16x32_bf16 v[144:147], a[184:187], a[200:203], v[144:147]
  s_barrier
  ds_read_b64_tr_b16 a[192:193], v208 offset:0
  ds_read_b64_tr_b16 a[194:195], v208 offset:4096
  v_exp_f32 v194, v194
  v_exp_f32 v195, v195
  v_add_f32 v192, 1.0, v192
  v_mfma_f32_16x16x32_bf16 v[148:151], a[188:191], a[200:203], v[148:151]
  buffer_load_dwordx4 v7, s[8:11], s17 offen offset:3072 lds
  s_add_u32 s17, s17, 262144
  v_add_f32 v193, 1.0, v193
  v_add_f32 v194, 1.0, v194
  v_mfma_f32_16x16x32_bf16 v[152:155], a[184:187], a[204:207], v[152:155]
  ds_read_b64_tr_b16 a[196:197], v209 offset:0
  ds_read_b64_tr_b16 a[198:199], v209 offset:4096
  v_add_f32 v195, 1.0, v195
  v_rcp_f32 v192, v192
  v_rcp_f32 v193, v193
  v_mfma_f32_16x16x32_bf16 v[156:159], a[188:191], a[204:207], v[156:159]
  v_rcp_f32 v194, v194
  v_rcp_f32 v195, v195
  s_waitcnt lgkmcnt(8)
  v_mfma_f32_16x16x32_bf16 v[160:163], a[184:187], a[208:211], v[160:163]
  ds_read_b64_tr_b16 a[200:201], v210 offset:0
  ds_read_b64_tr_b16 a[202:203], v210 offset:4096
  v_mul_f32 v96, v96, v192
  v_mul_f32 v97, v97, v193
  v_mul_f32 v98, v98, v194
  v_mfma_f32_16x16x32_bf16 v[164:167], a[188:191], a[208:211], v[164:167]
  buffer_load_dwordx4 a[176:179], v3, s[12:15], s18 offen offset:0 sc1
  v_mul_f32 v99, v99, v195
  v_cvt_pk_bf16_f32 v96, v96, v97
  v_mfma_f32_16x16x32_bf16 v[168:171], a[184:187], a[212:215], v[168:171]
  ds_read_b64_tr_b16 a[204:205], v211 offset:0
  ds_read_b64_tr_b16 a[206:207], v211 offset:4096
  v_cvt_pk_bf16_f32 v97, v98, v99
  v_mul_f32 v192, v100, v100
  v_mul_f32 v193, v101, v101
  v_mfma_f32_16x16x32_bf16 v[172:175], a[188:191], a[212:215], v[172:175]
  v_mul_f32 v194, v102, v102
  v_mul_f32 v195, v103, v103
  s_waitcnt lgkmcnt(8)
  v_mfma_f32_16x16x32_bf16 v[176:179], a[184:187], a[216:219], v[176:179]
  ds_read_b64_tr_b16 a[208:209], v212 offset:0
  ds_read_b64_tr_b16 a[210:211], v212 offset:4096
  v_fma_f32 v192, v192, s23, v35
  v_fma_f32 v193, v193, s23, v35
  v_fma_f32 v194, v194, s23, v35
  v_mfma_f32_16x16x32_bf16 v[180:183], a[188:191], a[216:219], v[180:183]
  buffer_load_dwordx4 a[180:183], v3, s[12:15], s18 offen offset:1024 sc1
  v_fma_f32 v195, v195, s23, v35
  v_mul_f32 v192, v192, v100
  v_mfma_f32_16x16x32_bf16 v[184:187], a[184:187], a[220:223], v[184:187]
  ds_read_b64_tr_b16 a[212:213], v213 offset:0
  ds_read_b64_tr_b16 a[214:215], v213 offset:4096
  v_mul_f32 v193, v193, v101
  v_mul_f32 v194, v194, v102
  v_mfma_f32_16x16x32_bf16 v[188:191], a[188:191], a[220:223], v[188:191]
  v_mul_f32 v195, v195, v103
  v_exp_f32 v192, v192
  v_exp_f32 v193, v193
  s_waitcnt vmcnt(28) lgkmcnt(8)
  v_mfma_f32_16x16x32_bf16 v[128:131], a[128:131], a[192:195], v[128:131]
  ds_read_b64_tr_b16 a[216:217], v214 offset:0
  ds_read_b64_tr_b16 a[218:219], v214 offset:4096
  v_exp_f32 v194, v194
  v_exp_f32 v195, v195
  v_mfma_f32_16x16x32_bf16 v[132:135], a[132:135], a[192:195], v[132:135]
  buffer_load_dwordx4 a[184:187], v3, s[12:15], s18 offen offset:2048 sc1
  v_add_f32 v192, 1.0, v192
  v_add_f32 v193, 1.0, v193
  v_add_f32 v194, 1.0, v194
  v_mfma_f32_16x16x32_bf16 v[136:139], a[128:131], a[196:199], v[136:139]
  ds_read_b64_tr_b16 a[220:221], v215 offset:0
  ds_read_b64_tr_b16 a[222:223], v215 offset:4096
  v_add_f32 v195, 1.0, v195
  v_rcp_f32 v192, v192
  v_mfma_f32_16x16x32_bf16 v[140:143], a[132:135], a[196:199], v[140:143]
  v_rcp_f32 v193, v193
  v_rcp_f32 v194, v194
  v_rcp_f32 v195, v195
  s_waitcnt lgkmcnt(8)
  v_mfma_f32_16x16x32_bf16 v[144:147], a[128:131], a[200:203], v[144:147]
  ds_read_b64_tr_b16 a[192:193], v208 offset:8192
  ds_read_b64_tr_b16 a[194:195], v208 offset:12288
  v_mul_f32 v100, v100, v192
  v_mul_f32 v101, v101, v193
  v_mfma_f32_16x16x32_bf16 v[148:151], a[132:135], a[200:203], v[148:151]
  buffer_load_dwordx4 a[188:191], v3, s[12:15], s18 offen offset:3072 sc1
  s_add_u32 s18, s18, 4096
  v_mul_f32 v102, v102, v194
  v_mul_f32 v103, v103, v195
  v_cvt_pk_bf16_f32 v98, v100, v101
  v_mfma_f32_16x16x32_bf16 v[152:155], a[128:131], a[204:207], v[152:155]
  ds_read_b64_tr_b16 a[196:197], v209 offset:8192
  ds_read_b64_tr_b16 a[198:199], v209 offset:12288
  v_cvt_pk_bf16_f32 v99, v102, v103
  buffer_store_dwordx4 v[96:99], v57, s[32:35], s65 offen offset:0 sc1
  v_mfma_f32_16x16x32_bf16 v[156:159], a[132:135], a[204:207], v[156:159]
  s_add_u32 m0, s19, 32768
  v_mul_f32 v192, v104, v104
  v_mul_f32 v193, v105, v105
  v_mul_f32 v194, v106, v106
  s_waitcnt lgkmcnt(8)
  v_mfma_f32_16x16x32_bf16 v[160:163], a[128:131], a[208:211], v[160:163]
  ds_read_b64_tr_b16 a[200:201], v210 offset:8192
  ds_read_b64_tr_b16 a[202:203], v210 offset:12288
  v_mul_f32 v195, v107, v107
  v_fma_f32 v192, v192, s23, v35
  v_mfma_f32_16x16x32_bf16 v[164:167], a[132:135], a[208:211], v[164:167]
  buffer_load_dwordx4 v4, s[8:11], s17 offen offset:0 lds
  v_fma_f32 v193, v193, s23, v35
  v_fma_f32 v194, v194, s23, v35
  v_fma_f32 v195, v195, s23, v35
  v_mfma_f32_16x16x32_bf16 v[168:171], a[128:131], a[212:215], v[168:171]
  ds_read_b64_tr_b16 a[204:205], v211 offset:8192
  ds_read_b64_tr_b16 a[206:207], v211 offset:12288
  v_mul_f32 v192, v192, v104
  v_mul_f32 v193, v193, v105
  v_mfma_f32_16x16x32_bf16 v[172:175], a[132:135], a[212:215], v[172:175]
  v_mul_f32 v194, v194, v106
  v_mul_f32 v195, v195, v107
  s_waitcnt lgkmcnt(8)
  v_mfma_f32_16x16x32_bf16 v[176:179], a[128:131], a[216:219], v[176:179]
  ds_read_b64_tr_b16 a[208:209], v212 offset:8192
  ds_read_b64_tr_b16 a[210:211], v212 offset:12288
  v_exp_f32 v192, v192
  v_exp_f32 v193, v193
  v_exp_f32 v194, v194
  v_mfma_f32_16x16x32_bf16 v[180:183], a[132:135], a[216:219], v[180:183]
  buffer_load_dwordx4 v5, s[8:11], s17 offen offset:1024 lds
  v_exp_f32 v195, v195
  v_add_f32 v192, 1.0, v192
  v_mfma_f32_16x16x32_bf16 v[184:187], a[128:131], a[220:223], v[184:187]
  ds_read_b64_tr_b16 a[212:213], v213 offset:8192
  ds_read_b64_tr_b16 a[214:215], v213 offset:12288
  v_add_f32 v193, 1.0, v193
  v_add_f32 v194, 1.0, v194
  v_add_f32 v195, 1.0, v195
  v_mfma_f32_16x16x32_bf16 v[188:191], a[132:135], a[220:223], v[188:191]
  v_rcp_f32 v192, v192
  v_rcp_f32 v193, v193
  s_waitcnt vmcnt(30) lgkmcnt(8)
  v_mfma_f32_16x16x32_bf16 v[128:131], a[136:139], a[192:195], v[128:131]
  ds_read_b64_tr_b16 a[216:217], v214 offset:8192
  ds_read_b64_tr_b16 a[218:219], v214 offset:12288
  v_rcp_f32 v194, v194
  v_rcp_f32 v195, v195
  v_mul_f32 v104, v104, v192
  v_mfma_f32_16x16x32_bf16 v[132:135], a[140:143], a[192:195], v[132:135]
  buffer_load_dwordx4 v6, s[8:11], s17 offen offset:2048 lds
  v_mul_f32 v105, v105, v193
  v_mul_f32 v106, v106, v194
  v_mfma_f32_16x16x32_bf16 v[136:139], a[136:139], a[196:199], v[136:139]
  ds_read_b64_tr_b16 a[220:221], v215 offset:8192
  ds_read_b64_tr_b16 a[222:223], v215 offset:12288
  v_mul_f32 v107, v107, v195
  v_cvt_pk_bf16_f32 v104, v104, v105
  v_cvt_pk_bf16_f32 v105, v106, v107
  v_mfma_f32_16x16x32_bf16 v[140:143], a[140:143], a[196:199], v[140:143]
  v_mul_f32 v192, v108, v108
  v_mul_f32 v193, v109, v109
  s_waitcnt lgkmcnt(8)
  v_mfma_f32_16x16x32_bf16 v[144:147], a[136:139], a[200:203], v[144:147]
  s_barrier
  ds_read_b64_tr_b16 a[192:193], v208 offset:16384
  ds_read_b64_tr_b16 a[194:195], v208 offset:20480
  v_mul_f32 v194, v110, v110
  v_mul_f32 v195, v111, v111
  v_fma_f32 v192, v192, s23, v35
  v_mfma_f32_16x16x32_bf16 v[148:151], a[140:143], a[200:203], v[148:151]
  buffer_load_dwordx4 v7, s[8:11], s17 offen offset:3072 lds
  s_add_u32 s17, s17, 262144
  v_fma_f32 v193, v193, s23, v35
  v_fma_f32 v194, v194, s23, v35
  v_mfma_f32_16x16x32_bf16 v[152:155], a[136:139], a[204:207], v[152:155]
  ds_read_b64_tr_b16 a[196:197], v209 offset:16384
  ds_read_b64_tr_b16 a[198:199], v209 offset:20480
  v_fma_f32 v195, v195, s23, v35
  v_mul_f32 v192, v192, v108
  v_mul_f32 v193, v193, v109
  v_mfma_f32_16x16x32_bf16 v[156:159], a[140:143], a[204:207], v[156:159]
  v_mul_f32 v194, v194, v110
  v_mul_f32 v195, v195, v111
  s_waitcnt lgkmcnt(8)
  v_mfma_f32_16x16x32_bf16 v[160:163], a[136:139], a[208:211], v[160:163]
  ds_read_b64_tr_b16 a[200:201], v210 offset:16384
  ds_read_b64_tr_b16 a[202:203], v210 offset:20480
  v_exp_f32 v192, v192
  v_exp_f32 v193, v193
  v_exp_f32 v194, v194
  v_mfma_f32_16x16x32_bf16 v[164:167], a[140:143], a[208:211], v[164:167]
  buffer_load_dwordx4 a[128:131], v3, s[12:15], s18 offen offset:0 sc1
  v_exp_f32 v195, v195
  v_add_f32 v192, 1.0, v192
  v_mfma_f32_16x16x32_bf16 v[168:171], a[136:139], a[212:215], v[168:171]
  ds_read_b64_tr_b16 a[204:205], v211 offset:16384
  ds_read_b64_tr_b16 a[206:207], v211 offset:20480
  v_add_f32 v193, 1.0, v193
  v_add_f32 v194, 1.0, v194
  v_mfma_f32_16x16x32_bf16 v[172:175], a[140:143], a[212:215], v[172:175]
  v_add_f32 v195, 1.0, v195
  v_rcp_f32 v192, v192
  v_rcp_f32 v193, v193
  s_waitcnt lgkmcnt(8)
  v_mfma_f32_16x16x32_bf16 v[176:179], a[136:139], a[216:219], v[176:179]
  ds_read_b64_tr_b16 a[208:209], v212 offset:16384
  ds_read_b64_tr_b16 a[210:211], v212 offset:20480
  v_rcp_f32 v194, v194
  v_rcp_f32 v195, v195
  v_mfma_f32_16x16x32_bf16 v[180:183], a[140:143], a[216:219], v[180:183]
  buffer_load_dwordx4 a[132:135], v3, s[12:15], s18 offen offset:1024 sc1
  v_mul_f32 v108, v108, v192
  v_mul_f32 v109, v109, v193
  v_mul_f32 v110, v110, v194
  v_mfma_f32_16x16x32_bf16 v[184:187], a[136:139], a[220:223], v[184:187]
  ds_read_b64_tr_b16 a[212:213], v213 offset:16384
  ds_read_b64_tr_b16 a[214:215], v213 offset:20480
  v_mul_f32 v111, v111, v195
  v_cvt_pk_bf16_f32 v106, v108, v109
  v_mfma_f32_16x16x32_bf16 v[188:191], a[140:143], a[220:223], v[188:191]
  v_cvt_pk_bf16_f32 v107, v110, v111
  buffer_store_dwordx4 v[104:107], v57, s[32:35], s65 offen offset:1024 sc1
  v_mul_f32 v192, v112, v112
  s_waitcnt vmcnt(28) lgkmcnt(8)
  v_mfma_f32_16x16x32_bf16 v[128:131], a[144:147], a[192:195], v[128:131]
  ds_read_b64_tr_b16 a[216:217], v214 offset:16384
  ds_read_b64_tr_b16 a[218:219], v214 offset:20480
  v_mul_f32 v193, v113, v113
  v_mul_f32 v194, v114, v114
  v_mfma_f32_16x16x32_bf16 v[132:135], a[148:151], a[192:195], v[132:135]
  buffer_load_dwordx4 a[136:139], v3, s[12:15], s18 offen offset:2048 sc1
  v_mul_f32 v195, v115, v115
  v_fma_f32 v192, v192, s23, v35
  v_fma_f32 v193, v193, s23, v35
  v_mfma_f32_16x16x32_bf16 v[136:139], a[144:147], a[196:199], v[136:139]
  ds_read_b64_tr_b16 a[220:221], v215 offset:16384
  ds_read_b64_tr_b16 a[222:223], v215 offset:20480
  v_fma_f32 v194, v194, s23, v35
  v_fma_f32 v195, v195, s23, v35
  v_mfma_f32_16x16x32_bf16 v[140:143], a[148:151], a[196:199], v[140:143]
  v_mul_f32 v192, v192, v112
  v_mul_f32 v193, v193, v113
  v_mul_f32 v194, v194, v114
  s_waitcnt lgkmcnt(8)
  v_mfma_f32_16x16x32_bf16 v[144:147], a[144:147], a[200:203], v[144:147]
  ds_read_b64_tr_b16 a[192:193], v208 offset:24576
  ds_read_b64_tr_b16 a[194:195], v208 offset:28672
  v_mul_f32 v195, v195, v115
  v_exp_f32 v192, v192
  v_mfma_f32_16x16x32_bf16 v[148:151], a[148:151], a[200:203], v[148:151]
  buffer_load_dwordx4 a[140:143], v3, s[12:15], s18 offen offset:3072 sc1
  s_add_u32 s18, s18, 4096
  v_exp_f32 v193, v193
  v_exp_f32 v194, v194
  v_exp_f32 v195, v195
  v_mfma_f32_16x16x32_bf16 v[152:155], a[144:147], a[204:207], v[152:155]
  ds_read_b64_tr_b16 a[196:197], v209 offset:24576
  ds_read_b64_tr_b16 a[198:199], v209 offset:28672
  v_add_f32 v192, 1.0, v192
  v_add_f32 v193, 1.0, v193
  v_mfma_f32_16x16x32_bf16 v[156:159], a[148:151], a[204:207], v[156:159]
  s_add_u32 m0, s19, 49152
  v_add_f32 v194, 1.0, v194
  v_add_f32 v195, 1.0, v195
  s_waitcnt lgkmcnt(8)
  v_mfma_f32_16x16x32_bf16 v[160:163], a[144:147], a[208:211], v[160:163]
  ds_read_b64_tr_b16 a[200:201], v210 offset:24576
  ds_read_b64_tr_b16 a[202:203], v210 offset:28672
  v_rcp_f32 v192, v192
  v_rcp_f32 v193, v193
  v_rcp_f32 v194, v194
  v_mfma_f32_16x16x32_bf16 v[164:167], a[148:151], a[208:211], v[164:167]
  buffer_load_dwordx4 v4, s[8:11], s17 offen offset:0 lds
  v_rcp_f32 v195, v195
  v_mul_f32 v112, v112, v192
  v_mfma_f32_16x16x32_bf16 v[168:171], a[144:147], a[212:215], v[168:171]
  ds_read_b64_tr_b16 a[204:205], v211 offset:24576
  ds_read_b64_tr_b16 a[206:207], v211 offset:28672
  v_mul_f32 v113, v113, v193
  v_mul_f32 v114, v114, v194
  v_mul_f32 v115, v115, v195
  v_mfma_f32_16x16x32_bf16 v[172:175], a[148:151], a[212:215], v[172:175]
  v_cvt_pk_bf16_f32 v112, v112, v113
  v_cvt_pk_bf16_f32 v113, v114, v115
  s_waitcnt lgkmcnt(8)
  v_mfma_f32_16x16x32_bf16 v[176:179], a[144:147], a[216:219], v[176:179]
  ds_read_b64_tr_b16 a[208:209], v212 offset:24576
  ds_read_b64_tr_b16 a[210:211], v212 offset:28672
  v_mul_f32 v192, v116, v116
  v_mul_f32 v193, v117, v117
  v_mul_f32 v194, v118, v118
  v_mfma_f32_16x16x32_bf16 v[180:183], a[148:151], a[216:219], v[180:183]
  buffer_load_dwordx4 v5, s[8:11], s17 offen offset:1024 lds
  v_mul_f32 v195, v119, v119
  v_fma_f32 v192, v192, s23, v35
  v_mfma_f32_16x16x32_bf16 v[184:187], a[144:147], a[220:223], v[184:187]
  ds_read_b64_tr_b16 a[212:213], v213 offset:24576
  ds_read_b64_tr_b16 a[214:215], v213 offset:28672
  v_fma_f32 v193, v193, s23, v35
  v_fma_f32 v194, v194, s23, v35
  v_fma_f32 v195, v195, s23, v35
  v_mfma_f32_16x16x32_bf16 v[188:191], a[148:151], a[220:223], v[188:191]
  v_mul_f32 v192, v192, v116
  v_mul_f32 v193, v193, v117
  s_waitcnt vmcnt(30) lgkmcnt(8)
  v_mfma_f32_16x16x32_bf16 v[128:131], a[152:155], a[192:195], v[128:131]
  ds_read_b64_tr_b16 a[216:217], v214 offset:24576
  ds_read_b64_tr_b16 a[218:219], v214 offset:28672
  v_mul_f32 v194, v194, v118
  v_mul_f32 v195, v195, v119
  v_exp_f32 v192, v192
  v_mfma_f32_16x16x32_bf16 v[132:135], a[156:159], a[192:195], v[132:135]
  buffer_load_dwordx4 v6, s[8:11], s17 offen offset:2048 lds
  v_exp_f32 v193, v193
  v_exp_f32 v194, v194
  v_mfma_f32_16x16x32_bf16 v[136:139], a[152:155], a[196:199], v[136:139]
  ds_read_b64_tr_b16 a[220:221], v215 offset:24576
  ds_read_b64_tr_b16 a[222:223], v215 offset:28672
  v_exp_f32 v195, v195
  v_add_f32 v192, 1.0, v192
  v_add_f32 v193, 1.0, v193
  v_mfma_f32_16x16x32_bf16 v[140:143], a[156:159], a[196:199], v[140:143]
  v_add_f32 v194, 1.0, v194
  v_add_f32 v195, 1.0, v195
  s_waitcnt lgkmcnt(8)
  v_mfma_f32_16x16x32_bf16 v[144:147], a[152:155], a[200:203], v[144:147]
  s_barrier
  ds_read_b64_tr_b16 a[192:193], v208 offset:32768
  ds_read_b64_tr_b16 a[194:195], v208 offset:36864
  v_rcp_f32 v192, v192
  v_rcp_f32 v193, v193
  v_rcp_f32 v194, v194
  v_mfma_f32_16x16x32_bf16 v[148:151], a[156:159], a[200:203], v[148:151]
  buffer_load_dwordx4 v7, s[8:11], s17 offen offset:3072 lds
  s_add_u32 s17, s17, 262144
  v_rcp_f32 v195, v195
  v_mul_f32 v116, v116, v192
  v_mfma_f32_16x16x32_bf16 v[152:155], a[152:155], a[204:207], v[152:155]
  ds_read_b64_tr_b16 a[196:197], v209 offset:32768
  ds_read_b64_tr_b16 a[198:199], v209 offset:36864
  v_mul_f32 v117, v117, v193
  v_mul_f32 v118, v118, v194
  v_mfma_f32_16x16x32_bf16 v[156:159], a[156:159], a[204:207], v[156:159]
  v_mul_f32 v119, v119, v195
  v_cvt_pk_bf16_f32 v114, v116, v117
  v_cvt_pk_bf16_f32 v115, v118, v119
  s_waitcnt lgkmcnt(8)
  v_mfma_f32_16x16x32_bf16 v[160:163], a[152:155], a[208:211], v[160:163]
  ds_read_b64_tr_b16 a[200:201], v210 offset:32768
  ds_read_b64_tr_b16 a[202:203], v210 offset:36864
  buffer_store_dwordx4 v[112:115], v57, s[32:35], s65 offen offset:2048 sc1
  v_mul_f32 v192, v120, v120
  v_mfma_f32_16x16x32_bf16 v[164:167], a[156:159], a[208:211], v[164:167]
  buffer_load_dwordx4 a[144:147], v3, s[12:15], s18 offen offset:0 sc1
  v_mul_f32 v193, v121, v121
  v_mul_f32 v194, v122, v122
  v_mul_f32 v195, v123, v123
  v_mfma_f32_16x16x32_bf16 v[168:171], a[152:155], a[212:215], v[168:171]
  ds_read_b64_tr_b16 a[204:205], v211 offset:32768
  ds_read_b64_tr_b16 a[206:207], v211 offset:36864
  v_fma_f32 v192, v192, s23, v35
  v_fma_f32 v193, v193, s23, v35
  v_mfma_f32_16x16x32_bf16 v[172:175], a[156:159], a[212:215], v[172:175]
  v_fma_f32 v194, v194, s23, v35
  v_fma_f32 v195, v195, s23, v35
  v_mul_f32 v192, v192, v120
  s_waitcnt lgkmcnt(8)
  v_mfma_f32_16x16x32_bf16 v[176:179], a[152:155], a[216:219], v[176:179]
  ds_read_b64_tr_b16 a[208:209], v212 offset:32768
  ds_read_b64_tr_b16 a[210:211], v212 offset:36864
  v_mul_f32 v193, v193, v121
  v_mul_f32 v194, v194, v122
  v_mfma_f32_16x16x32_bf16 v[180:183], a[156:159], a[216:219], v[180:183]
  buffer_load_dwordx4 a[148:151], v3, s[12:15], s18 offen offset:1024 sc1
  v_mul_f32 v195, v195, v123
  v_exp_f32 v192, v192
  v_exp_f32 v193, v193
  v_mfma_f32_16x16x32_bf16 v[184:187], a[152:155], a[220:223], v[184:187]
  ds_read_b64_tr_b16 a[212:213], v213 offset:32768
  ds_read_b64_tr_b16 a[214:215], v213 offset:36864
  v_exp_f32 v194, v194
  v_exp_f32 v195, v195
  v_mfma_f32_16x16x32_bf16 v[188:191], a[156:159], a[220:223], v[188:191]
  v_add_f32 v192, 1.0, v192
  v_add_f32 v193, 1.0, v193
  v_add_f32 v194, 1.0, v194
  s_waitcnt vmcnt(28) lgkmcnt(8)
  v_mfma_f32_16x16x32_bf16 v[128:131], a[160:163], a[192:195], v[128:131]
  ds_read_b64_tr_b16 a[216:217], v214 offset:32768
  ds_read_b64_tr_b16 a[218:219], v214 offset:36864
  v_add_f32 v195, 1.0, v195
  v_rcp_f32 v192, v192
  v_mfma_f32_16x16x32_bf16 v[132:135], a[164:167], a[192:195], v[132:135]
  buffer_load_dwordx4 a[152:155], v3, s[12:15], s18 offen offset:2048 sc1
  v_rcp_f32 v193, v193
  v_rcp_f32 v194, v194
  v_rcp_f32 v195, v195
  v_mfma_f32_16x16x32_bf16 v[136:139], a[160:163], a[196:199], v[136:139]
  ds_read_b64_tr_b16 a[220:221], v215 offset:32768
  ds_read_b64_tr_b16 a[222:223], v215 offset:36864
  v_mul_f32 v120, v120, v192
  v_mul_f32 v121, v121, v193
  v_mfma_f32_16x16x32_bf16 v[140:143], a[164:167], a[196:199], v[140:143]
  v_mul_f32 v122, v122, v194
  v_mul_f32 v123, v123, v195
  s_waitcnt lgkmcnt(8)
  v_mfma_f32_16x16x32_bf16 v[144:147], a[160:163], a[200:203], v[144:147]
  ds_read_b64_tr_b16 a[192:193], v208 offset:40960
  ds_read_b64_tr_b16 a[194:195], v208 offset:45056
  v_cvt_pk_bf16_f32 v120, v120, v121
  v_cvt_pk_bf16_f32 v121, v122, v123
  v_mul_f32 v192, v124, v124
  v_mfma_f32_16x16x32_bf16 v[148:151], a[164:167], a[200:203], v[148:151]
  buffer_load_dwordx4 a[156:159], v3, s[12:15], s18 offen offset:3072 sc1
  s_add_u32 s18, s18, 4096
  v_mul_f32 v193, v125, v125
  v_mul_f32 v194, v126, v126
  v_mfma_f32_16x16x32_bf16 v[152:155], a[160:163], a[204:207], v[152:155]
  ds_read_b64_tr_b16 a[196:197], v209 offset:40960
  ds_read_b64_tr_b16 a[198:199], v209 offset:45056
  v_mul_f32 v195, v127, v127
  v_fma_f32 v192, v192, s23, v35
  v_fma_f32 v193, v193, s23, v35
  v_mfma_f32_16x16x32_bf16 v[156:159], a[164:167], a[204:207], v[156:159]
  s_add_u32 m0, s19, 65536
  v_fma_f32 v194, v194, s23, v35
  v_fma_f32 v195, v195, s23, v35
  s_waitcnt lgkmcnt(8)
  v_mfma_f32_16x16x32_bf16 v[160:163], a[160:163], a[208:211], v[160:163]
  ds_read_b64_tr_b16 a[200:201], v210 offset:40960
  ds_read_b64_tr_b16 a[202:203], v210 offset:45056
  v_mul_f32 v192, v192, v124
  v_mul_f32 v193, v193, v125
  v_mul_f32 v194, v194, v126
  v_mfma_f32_16x16x32_bf16 v[164:167], a[164:167], a[208:211], v[164:167]
  buffer_load_dwordx4 v4, s[8:11], s17 offen offset:0 lds
  v_mul_f32 v195, v195, v127
  v_exp_f32 v192, v192
  v_mfma_f32_16x16x32_bf16 v[168:171], a[160:163], a[212:215], v[168:171]
  ds_read_b64_tr_b16 a[204:205], v211 offset:40960
  ds_read_b64_tr_b16 a[206:207], v211 offset:45056
  v_exp_f32 v193, v193
  v_exp_f32 v194, v194
  v_exp_f32 v195, v195
  v_mfma_f32_16x16x32_bf16 v[172:175], a[164:167], a[212:215], v[172:175]
  v_add_f32 v192, 1.0, v192
  v_add_f32 v193, 1.0, v193
  s_waitcnt lgkmcnt(8)
  v_mfma_f32_16x16x32_bf16 v[176:179], a[160:163], a[216:219], v[176:179]
  ds_read_b64_tr_b16 a[208:209], v212 offset:40960
  ds_read_b64_tr_b16 a[210:211], v212 offset:45056
  v_add_f32 v194, 1.0, v194
  v_add_f32 v195, 1.0, v195
  v_rcp_f32 v192, v192
  v_mfma_f32_16x16x32_bf16 v[180:183], a[164:167], a[216:219], v[180:183]
  buffer_load_dwordx4 v5, s[8:11], s17 offen offset:1024 lds
  v_rcp_f32 v193, v193
  v_rcp_f32 v194, v194
  v_mfma_f32_16x16x32_bf16 v[184:187], a[160:163], a[220:223], v[184:187]
  ds_read_b64_tr_b16 a[212:213], v213 offset:40960
  ds_read_b64_tr_b16 a[214:215], v213 offset:45056
  v_rcp_f32 v195, v195
  v_mul_f32 v124, v124, v192
  v_mul_f32 v125, v125, v193
  v_mfma_f32_16x16x32_bf16 v[188:191], a[164:167], a[220:223], v[188:191]
  v_mul_f32 v126, v126, v194
  v_mul_f32 v127, v127, v195
  s_waitcnt vmcnt(30) lgkmcnt(8)
  v_mfma_f32_16x16x32_bf16 v[128:131], a[168:171], a[192:195], v[128:131]
  ds_read_b64_tr_b16 a[216:217], v214 offset:40960
  ds_read_b64_tr_b16 a[218:219], v214 offset:45056
  v_cvt_pk_bf16_f32 v122, v124, v125
  v_cvt_pk_bf16_f32 v123, v126, v127
  buffer_store_dwordx4 v[120:123], v57, s[32:35], s65 offen offset:3072 sc1
  v_mfma_f32_16x16x32_bf16 v[132:135], a[172:175], a[192:195], v[132:135]
  buffer_load_dwordx4 v6, s[8:11], s17 offen offset:2048 lds
  v_mfma_f32_16x16x32_bf16 v[136:139], a[168:171], a[196:199], v[136:139]
  ds_read_b64_tr_b16 a[220:221], v215 offset:40960
  ds_read_b64_tr_b16 a[222:223], v215 offset:45056
  v_mfma_f32_16x16x32_bf16 v[140:143], a[172:175], a[196:199], v[140:143]
  s_waitcnt lgkmcnt(8)
  v_mfma_f32_16x16x32_bf16 v[144:147], a[168:171], a[200:203], v[144:147]
  s_barrier
  ds_read_b64_tr_b16 a[192:193], v208 offset:49152
  ds_read_b64_tr_b16 a[194:195], v208 offset:53248
  v_mfma_f32_16x16x32_bf16 v[148:151], a[172:175], a[200:203], v[148:151]
  buffer_load_dwordx4 v7, s[8:11], s17 offen offset:3072 lds
  s_add_u32 s17, s17, 262144
  v_mfma_f32_16x16x32_bf16 v[152:155], a[168:171], a[204:207], v[152:155]
  ds_read_b64_tr_b16 a[196:197], v209 offset:49152
  ds_read_b64_tr_b16 a[198:199], v209 offset:53248
  v_mfma_f32_16x16x32_bf16 v[156:159], a[172:175], a[204:207], v[156:159]
  s_waitcnt lgkmcnt(8)
  v_mfma_f32_16x16x32_bf16 v[160:163], a[168:171], a[208:211], v[160:163]
  ds_read_b64_tr_b16 a[200:201], v210 offset:49152
  ds_read_b64_tr_b16 a[202:203], v210 offset:53248
  v_mfma_f32_16x16x32_bf16 v[164:167], a[172:175], a[208:211], v[164:167]
  buffer_load_dwordx4 a[160:163], v3, s[12:15], s18 offen offset:0 sc1
  v_mfma_f32_16x16x32_bf16 v[168:171], a[168:171], a[212:215], v[168:171]
  ds_read_b64_tr_b16 a[204:205], v211 offset:49152
  ds_read_b64_tr_b16 a[206:207], v211 offset:53248
  v_mfma_f32_16x16x32_bf16 v[172:175], a[172:175], a[212:215], v[172:175]
  s_waitcnt lgkmcnt(8)
  v_mfma_f32_16x16x32_bf16 v[176:179], a[168:171], a[216:219], v[176:179]
  ds_read_b64_tr_b16 a[208:209], v212 offset:49152
  ds_read_b64_tr_b16 a[210:211], v212 offset:53248
  v_mfma_f32_16x16x32_bf16 v[180:183], a[172:175], a[216:219], v[180:183]
  buffer_load_dwordx4 a[164:167], v3, s[12:15], s18 offen offset:1024 sc1
  v_mfma_f32_16x16x32_bf16 v[184:187], a[168:171], a[220:223], v[184:187]
  ds_read_b64_tr_b16 a[212:213], v213 offset:49152
  ds_read_b64_tr_b16 a[214:215], v213 offset:53248
  v_mfma_f32_16x16x32_bf16 v[188:191], a[172:175], a[220:223], v[188:191]
  s_waitcnt vmcnt(28) lgkmcnt(8)
  v_mfma_f32_16x16x32_bf16 v[128:131], a[176:179], a[192:195], v[128:131]
  ds_read_b64_tr_b16 a[216:217], v214 offset:49152
  ds_read_b64_tr_b16 a[218:219], v214 offset:53248
  v_mfma_f32_16x16x32_bf16 v[132:135], a[180:183], a[192:195], v[132:135]
  buffer_load_dwordx4 a[168:171], v3, s[12:15], s18 offen offset:2048 sc1
  v_mfma_f32_16x16x32_bf16 v[136:139], a[176:179], a[196:199], v[136:139]
  ds_read_b64_tr_b16 a[220:221], v215 offset:49152
  ds_read_b64_tr_b16 a[222:223], v215 offset:53248
  v_mfma_f32_16x16x32_bf16 v[140:143], a[180:183], a[196:199], v[140:143]
  s_waitcnt lgkmcnt(8)
  v_mfma_f32_16x16x32_bf16 v[144:147], a[176:179], a[200:203], v[144:147]
  ds_read_b64_tr_b16 a[192:193], v208 offset:57344
  ds_read_b64_tr_b16 a[194:195], v208 offset:61440
  v_mfma_f32_16x16x32_bf16 v[148:151], a[180:183], a[200:203], v[148:151]
  buffer_load_dwordx4 a[172:175], v3, s[12:15], s18 offen offset:3072 sc1
  s_add_u32 s18, s18, 4096
  v_mfma_f32_16x16x32_bf16 v[152:155], a[176:179], a[204:207], v[152:155]
  ds_read_b64_tr_b16 a[196:197], v209 offset:57344
  ds_read_b64_tr_b16 a[198:199], v209 offset:61440
  v_mfma_f32_16x16x32_bf16 v[156:159], a[180:183], a[204:207], v[156:159]
  s_add_u32 m0, s19, 81920
  s_waitcnt lgkmcnt(8)
  v_mfma_f32_16x16x32_bf16 v[160:163], a[176:179], a[208:211], v[160:163]
  ds_read_b64_tr_b16 a[200:201], v210 offset:57344
  ds_read_b64_tr_b16 a[202:203], v210 offset:61440
  v_mfma_f32_16x16x32_bf16 v[164:167], a[180:183], a[208:211], v[164:167]
  buffer_load_dwordx4 v4, s[8:11], s17 offen offset:0 lds
  v_mfma_f32_16x16x32_bf16 v[168:171], a[176:179], a[212:215], v[168:171]
  ds_read_b64_tr_b16 a[204:205], v211 offset:57344
  ds_read_b64_tr_b16 a[206:207], v211 offset:61440
  v_mfma_f32_16x16x32_bf16 v[172:175], a[180:183], a[212:215], v[172:175]
  s_waitcnt lgkmcnt(8)
  v_mfma_f32_16x16x32_bf16 v[176:179], a[176:179], a[216:219], v[176:179]
  ds_read_b64_tr_b16 a[208:209], v212 offset:57344
  ds_read_b64_tr_b16 a[210:211], v212 offset:61440
  v_mfma_f32_16x16x32_bf16 v[180:183], a[180:183], a[216:219], v[180:183]
  buffer_load_dwordx4 v5, s[8:11], s17 offen offset:1024 lds
  v_mfma_f32_16x16x32_bf16 v[184:187], a[176:179], a[220:223], v[184:187]
  ds_read_b64_tr_b16 a[212:213], v213 offset:57344
  ds_read_b64_tr_b16 a[214:215], v213 offset:61440
  v_mfma_f32_16x16x32_bf16 v[188:191], a[180:183], a[220:223], v[188:191]
  s_waitcnt vmcnt(30) lgkmcnt(8)
  v_mfma_f32_16x16x32_bf16 v[128:131], a[184:187], a[192:195], v[128:131]
  ds_read_b64_tr_b16 a[216:217], v214 offset:57344
  ds_read_b64_tr_b16 a[218:219], v214 offset:61440
  v_mfma_f32_16x16x32_bf16 v[132:135], a[188:191], a[192:195], v[132:135]
  buffer_load_dwordx4 v6, s[8:11], s17 offen offset:2048 lds
  v_mfma_f32_16x16x32_bf16 v[136:139], a[184:187], a[196:199], v[136:139]
  ds_read_b64_tr_b16 a[220:221], v215 offset:57344
  ds_read_b64_tr_b16 a[222:223], v215 offset:61440
  v_mfma_f32_16x16x32_bf16 v[140:143], a[188:191], a[196:199], v[140:143]
  s_waitcnt lgkmcnt(8)
  v_mfma_f32_16x16x32_bf16 v[144:147], a[184:187], a[200:203], v[144:147]
  s_waitcnt vmcnt(9)
  s_barrier
  s_cmp_lg_u32 s16, 0
  s_cbranch_scc1 L_mk2_nopub_44
  v_mov_b32 v1, s70
  v_mov_b32 v56, s42
  s_mov_b64 exec, 1
  buffer_store_dword v56, v1, s[52:55], 0 offen sc1
  s_mov_b64 exec, -1
  s_nop 3
L_mk2_nopub_44:
  ds_read_b64_tr_b16 a[192:193], v8 offset:0
  ds_read_b64_tr_b16 a[194:195], v8 offset:4096
  v_mfma_f32_16x16x32_bf16 v[148:151], a[188:191], a[200:203], v[148:151]
  buffer_load_dwordx4 v7, s[8:11], s17 offen offset:3072 lds
  s_add_u32 s17, s17, 262144
  v_mfma_f32_16x16x32_bf16 v[152:155], a[184:187], a[204:207], v[152:155]
  ds_read_b64_tr_b16 a[196:197], v9 offset:0
  ds_read_b64_tr_b16 a[198:199], v9 offset:4096
  v_mfma_f32_16x16x32_bf16 v[156:159], a[188:191], a[204:207], v[156:159]
  s_waitcnt lgkmcnt(8)
  v_mfma_f32_16x16x32_bf16 v[160:163], a[184:187], a[208:211], v[160:163]
  ds_read_b64_tr_b16 a[200:201], v10 offset:0
  ds_read_b64_tr_b16 a[202:203], v10 offset:4096
  v_mfma_f32_16x16x32_bf16 v[164:167], a[188:191], a[208:211], v[164:167]
  buffer_load_dwordx4 a[176:179], v3, s[12:15], s18 offen offset:0 sc1
  v_mfma_f32_16x16x32_bf16 v[168:171], a[184:187], a[212:215], v[168:171]
  ds_read_b64_tr_b16 a[204:205], v11 offset:0
  ds_read_b64_tr_b16 a[206:207], v11 offset:4096
  v_mfma_f32_16x16x32_bf16 v[172:175], a[188:191], a[212:215], v[172:175]
  s_waitcnt lgkmcnt(8)
  v_mfma_f32_16x16x32_bf16 v[176:179], a[184:187], a[216:219], v[176:179]
  ds_read_b64_tr_b16 a[208:209], v40 offset:0
  ds_read_b64_tr_b16 a[210:211], v40 offset:4096
  v_mfma_f32_16x16x32_bf16 v[180:183], a[188:191], a[216:219], v[180:183]
  buffer_load_dwordx4 a[180:183], v3, s[12:15], s18 offen offset:1024 sc1
  v_mfma_f32_16x16x32_bf16 v[184:187], a[184:187], a[220:223], v[184:187]
  ds_read_b64_tr_b16 a[212:213], v41 offset:0
  ds_read_b64_tr_b16 a[214:215], v41 offset:4096
  v_mfma_f32_16x16x32_bf16 v[188:191], a[188:191], a[220:223], v[188:191]
  s_mov_b32 s20, 6
L_mk2_p_45:
  s_cmp_eq_u32 s20, 5
  s_cbranch_scc0 L_mk2_c2_46
  v_cmp_ne_u32 vcc, s42, v61
  s_cbranch_vccz L_mk2_c2_46
  s_call_b64 s[48:49], L_poll1
L_mk2_c2_46:
  s_waitcnt vmcnt(24) lgkmcnt(8)
  v_mfma_f32_16x16x32_bf16 v[128:131], a[128:131], a[192:195], v[128:131]
  ds_read_b64_tr_b16 a[216:217], v42 offset:0
  ds_read_b64_tr_b16 a[218:219], v42 offset:4096
  v_mfma_f32_16x16x32_bf16 v[132:135], a[132:135], a[192:195], v[132:135]
  buffer_load_dwordx4 a[184:187], v3, s[12:15], s18 offen offset:2048 sc1
  v_mfma_f32_16x16x32_bf16 v[136:139], a[128:131], a[196:199], v[136:139]
  ds_read_b64_tr_b16 a[220:221], v43 offset:0
  ds_read_b64_tr_b16 a[222:223], v43 offset:4096
  v_mfma_f32_16x16x32_bf16 v[140:143], a[132:135], a[196:199], v[140:143]
  s_waitcnt lgkmcnt(8)
  v_mfma_f32_16x16x32_bf16 v[144:147], a[128:131], a[200:203], v[144:147]
  ds_read_b64_tr_b16 a[192:193], v8 offset:8192
  ds_read_b64_tr_b16 a[194:195], v8 offset:12288
  v_mfma_f32_16x16x32_bf16 v[148:151], a[132:135], a[200:203], v[148:151]
  buffer_load_dwordx4 a[188:191], v3, s[12:15], s18 offen offset:3072 sc1
  s_add_u32 s18, s18, 4096
  v_mfma_f32_16x16x32_bf16 v[152:155], a[128:131], a[204:207], v[152:155]
  ds_read_b64_tr_b16 a[196:197], v9 offset:8192
  ds_read_b64_tr_b16 a[198:199], v9 offset:12288
  v_mfma_f32_16x16x32_bf16 v[156:159], a[132:135], a[204:207], v[156:159]
  s_add_u32 m0, s19, 98304
  s_waitcnt lgkmcnt(8)
  v_mfma_f32_16x16x32_bf16 v[160:163], a[128:131], a[208:211], v[160:163]
  ds_read_b64_tr_b16 a[200:201], v10 offset:8192
  ds_read_b64_tr_b16 a[202:203], v10 offset:12288
  v_mfma_f32_16x16x32_bf16 v[164:167], a[132:135], a[208:211], v[164:167]
  buffer_load_dwordx4 v4, s[8:11], s17 offen offset:0 lds
  v_mfma_f32_16x16x32_bf16 v[168:171], a[128:131], a[212:215], v[168:171]
  ds_read_b64_tr_b16 a[204:205], v11 offset:8192
  ds_read_b64_tr_b16 a[206:207], v11 offset:12288
  v_mfma_f32_16x16x32_bf16 v[172:175], a[132:135], a[212:215], v[172:175]
  s_waitcnt lgkmcnt(8)
  v_mfma_f32_16x16x32_bf16 v[176:179], a[128:131], a[216:219], v[176:179]
  ds_read_b64_tr_b16 a[208:209], v40 offset:8192
  ds_read_b64_tr_b16 a[210:211], v40 offset:12288
  v_mfma_f32_16x16x32_bf16 v[180:183], a[132:135], a[216:219], v[180:183]
  buffer_load_dwordx4 v5, s[8:11], s17 offen offset:1024 lds
  v_mfma_f32_16x16x32_bf16 v[184:187], a[128:131], a[220:223], v[184:187]
  ds_read_b64_tr_b16 a[212:213], v41 offset:8192
  ds_read_b64_tr_b16 a[214:215], v41 offset:12288
  v_mfma_f32_16x16x32_bf16 v[188:191], a[132:135], a[220:223], v[188:191]
  s_waitcnt vmcnt(26) lgkmcnt(8)
  v_mfma_f32_16x16x32_bf16 v[128:131], a[136:139], a[192:195], v[128:131]
  ds_read_b64_tr_b16 a[216:217], v42 offset:8192
  ds_read_b64_tr_b16 a[218:219], v42 offset:12288
  v_mfma_f32_16x16x32_bf16 v[132:135], a[140:143], a[192:195], v[132:135]
  buffer_load_dwordx4 v6, s[8:11], s17 offen offset:2048 lds
  v_mfma_f32_16x16x32_bf16 v[136:139], a[136:139], a[196:199], v[136:139]
  ds_read_b64_tr_b16 a[220:221], v43 offset:8192
  ds_read_b64_tr_b16 a[222:223], v43 offset:12288
  v_mfma_f32_16x16x32_bf16 v[140:143], a[140:143], a[196:199], v[140:143]
  s_waitcnt lgkmcnt(8)
  v_mfma_f32_16x16x32_bf16 v[144:147], a[136:139], a[200:203], v[144:147]
  s_barrier
  ds_read_b64_tr_b16 a[192:193], v8 offset:16384
  ds_read_b64_tr_b16 a[194:195], v8 offset:20480
  v_mfma_f32_16x16x32_bf16 v[148:151], a[140:143], a[200:203], v[148:151]
  buffer_load_dwordx4 v7, s[8:11], s17 offen offset:3072 lds
  s_add_u32 s17, s17, 262144
  v_mfma_f32_16x16x32_bf16 v[152:155], a[136:139], a[204:207], v[152:155]
  ds_read_b64_tr_b16 a[196:197], v9 offset:16384
  ds_read_b64_tr_b16 a[198:199], v9 offset:20480
  v_mfma_f32_16x16x32_bf16 v[156:159], a[140:143], a[204:207], v[156:159]
  s_waitcnt lgkmcnt(8)
  v_mfma_f32_16x16x32_bf16 v[160:163], a[136:139], a[208:211], v[160:163]
  ds_read_b64_tr_b16 a[200:201], v10 offset:16384
  ds_read_b64_tr_b16 a[202:203], v10 offset:20480
  v_mfma_f32_16x16x32_bf16 v[164:167], a[140:143], a[208:211], v[164:167]
  buffer_load_dwordx4 a[128:131], v3, s[12:15], s18 offen offset:0 sc1
  v_mfma_f32_16x16x32_bf16 v[168:171], a[136:139], a[212:215], v[168:171]
  ds_read_b64_tr_b16 a[204:205], v11 offset:16384
  ds_read_b64_tr_b16 a[206:207], v11 offset:20480
  v_mfma_f32_16x16x32_bf16 v[172:175], a[140:143], a[212:215], v[172:175]
  s_waitcnt lgkmcnt(8)
  v_mfma_f32_16x16x32_bf16 v[176:179], a[136:139], a[216:219], v[176:179]
  ds_read_b64_tr_b16 a[208:209], v40 offset:16384
  ds_read_b64_tr_b16 a[210:211], v40 offset:20480
  v_mfma_f32_16x16x32_bf16 v[180:183], a[140:143], a[216:219], v[180:183]
  buffer_load_dwordx4 a[132:135], v3, s[12:15], s18 offen offset:1024 sc1
  v_mfma_f32_16x16x32_bf16 v[184:187], a[136:139], a[220:223], v[184:187]
  ds_read_b64_tr_b16 a[212:213], v41 offset:16384
  ds_read_b64_tr_b16 a[214:215], v41 offset:20480
  v_mfma_f32_16x16x32_bf16 v[188:191], a[140:143], a[220:223], v[188:191]
  s_waitcnt vmcnt(24) lgkmcnt(8)
  v_mfma_f32_16x16x32_bf16 v[128:131], a[144:147], a[192:195], v[128:131]
  ds_read_b64_tr_b16 a[216:217], v42 offset:16384
  ds_read_b64_tr_b16 a[218:219], v42 offset:20480
  v_mfma_f32_16x16x32_bf16 v[132:135], a[148:151], a[192:195], v[132:135]
  buffer_load_dwordx4 a[136:139], v3, s[12:15], s18 offen offset:2048 sc1
  v_mfma_f32_16x16x32_bf16 v[136:139], a[144:147], a[196:199], v[136:139]
  ds_read_b64_tr_b16 a[220:221], v43 offset:16384
  ds_read_b64_tr_b16 a[222:223], v43 offset:20480
  v_mfma_f32_16x16x32_bf16 v[140:143], a[148:151], a[196:199], v[140:143]
  s_waitcnt lgkmcnt(8)
  v_mfma_f32_16x16x32_bf16 v[144:147], a[144:147], a[200:203], v[144:147]
  ds_read_b64_tr_b16 a[192:193], v8 offset:24576
  ds_read_b64_tr_b16 a[194:195], v8 offset:28672
  v_mfma_f32_16x16x32_bf16 v[148:151], a[148:151], a[200:203], v[148:151]
  buffer_load_dwordx4 a[140:143], v3, s[12:15], s18 offen offset:3072 sc1
  s_add_u32 s18, s18, 4096
  v_mfma_f32_16x16x32_bf16 v[152:155], a[144:147], a[204:207], v[152:155]
  ds_read_b64_tr_b16 a[196:197], v9 offset:24576
  ds_read_b64_tr_b16 a[198:199], v9 offset:28672
  v_mfma_f32_16x16x32_bf16 v[156:159], a[148:151], a[204:207], v[156:159]
  s_add_u32 m0, s19, 114688
  s_waitcnt lgkmcnt(8)
  v_mfma_f32_16x16x32_bf16 v[160:163], a[144:147], a[208:211], v[160:163]
  ds_read_b64_tr_b16 a[200:201], v10 offset:24576
  ds_read_b64_tr_b16 a[202:203], v10 offset:28672
  v_mfma_f32_16x16x32_bf16 v[164:167], a[148:151], a[208:211], v[164:167]
  buffer_load_dwordx4 v4, s[8:11], s17 offen offset:0 lds
  v_mfma_f32_16x16x32_bf16 v[168:171], a[144:147], a[212:215], v[168:171]
  ds_read_b64_tr_b16 a[204:205], v11 offset:24576
  ds_read_b64_tr_b16 a[206:207], v11 offset:28672
  v_mfma_f32_16x16x32_bf16 v[172:175], a[148:151], a[212:215], v[172:175]
  s_waitcnt lgkmcnt(8)
  v_mfma_f32_16x16x32_bf16 v[176:179], a[144:147], a[216:219], v[176:179]
  ds_read_b64_tr_b16 a[208:209], v40 offset:24576
  ds_read_b64_tr_b16 a[210:211], v40 offset:28672
  v_mfma_f32_16x16x32_bf16 v[180:183], a[148:151], a[216:219], v[180:183]
  buffer_load_dwordx4 v5, s[8:11], s17 offen offset:1024 lds
  v_mfma_f32_16x16x32_bf16 v[184:187], a[144:147], a[220:223], v[184:187]
  ds_read_b64_tr_b16 a[212:213], v41 offset:24576
  ds_read_b64_tr_b16 a[214:215], v41 offset:28672
  v_mfma_f32_16x16x32_bf16 v[188:191], a[148:151], a[220:223], v[188:191]
  s_waitcnt vmcnt(26) lgkmcnt(8)
  v_mfma_f32_16x16x32_bf16 v[128:131], a[152:155], a[192:195], v[128:131]
  ds_read_b64_tr_b16 a[216:217], v42 offset:24576
  ds_read_b64_tr_b16 a[218:219], v42 offset:28672
  v_mfma_f32_16x16x32_bf16 v[132:135], a[156:159], a[192:195], v[132:135]
  buffer_load_dwordx4 v6, s[8:11], s17 offen offset:2048 lds
  v_mfma_f32_16x16x32_bf16 v[136:139], a[152:155], a[196:199], v[136:139]
  ds_read_b64_tr_b16 a[220:221], v43 offset:24576
  ds_read_b64_tr_b16 a[222:223], v43 offset:28672
  v_mfma_f32_16x16x32_bf16 v[140:143], a[156:159], a[196:199], v[140:143]
  s_waitcnt lgkmcnt(8)
  v_mfma_f32_16x16x32_bf16 v[144:147], a[152:155], a[200:203], v[144:147]
  s_barrier
  ds_read_b64_tr_b16 a[192:193], v8 offset:32768
  ds_read_b64_tr_b16 a[194:195], v8 offset:36864
  v_mfma_f32_16x16x32_bf16 v[148:151], a[156:159], a[200:203], v[148:151]
  buffer_load_dwordx4 v7, s[8:11], s17 offen offset:3072 lds
  s_add_u32 s17, s17, 262144
  v_mfma_f32_16x16x32_bf16 v[152:155], a[152:155], a[204:207], v[152:155]
  ds_read_b64_tr_b16 a[196:197], v9 offset:32768
  ds_read_b64_tr_b16 a[198:199], v9 offset:36864
  v_mfma_f32_16x16x32_bf16 v[156:159], a[156:159], a[204:207], v[156:159]
  s_waitcnt lgkmcnt(8)
  v_mfma_f32_16x16x32_bf16 v[160:163], a[152:155], a[208:211], v[160:163]
  ds_read_b64_tr_b16 a[200:201], v10 offset:32768
  ds_read_b64_tr_b16 a[202:203], v10 offset:36864
  v_mfma_f32_16x16x32_bf16 v[164:167], a[156:159], a[208:211], v[164:167]
  buffer_load_dwordx4 a[144:147], v3, s[12:15], s18 offen offset:0 sc1
  v_mfma_f32_16x16x32_bf16 v[168:171], a[152:155], a[212:215], v[168:171]
  ds_read_b64_tr_b16 a[204:205], v11 offset:32768
  ds_read_b64_tr_b16 a[206:207], v11 offset:36864
  v_mfma_f32_16x16x32_bf16 v[172:175], a[156:159], a[212:215], v[172:175]
  s_waitcnt lgkmcnt(8)
  v_mfma_f32_16x16x32_bf16 v[176:179], a[152:155], a[216:219], v[176:179]
  ds_read_b64_tr_b16 a[208:209], v40 offset:32768
  ds_read_b64_tr_b16 a[210:211], v40 offset:36864
  v_mfma_f32_16x16x32_bf16 v[180:183], a[156:159], a[216:219], v[180:183]
  buffer_load_dwordx4 a[148:151], v3, s[12:15], s18 offen offset:1024 sc1
  v_mfma_f32_16x16x32_bf16 v[184:187], a[152:155], a[220:223], v[184:187]
  ds_read_b64_tr_b16 a[212:213], v41 offset:32768
  ds_read_b64_tr_b16 a[214:215], v41 offset:36864
  v_mfma_f32_16x16x32_bf16 v[188:191], a[156:159], a[220:223], v[188:191]
  s_waitcnt vmcnt(24) lgkmcnt(8)
  v_mfma_f32_16x16x32_bf16 v[128:131], a[160:163], a[192:195], v[128:131]
  ds_read_b64_tr_b16 a[216:217], v42 offset:32768
  ds_read_b64_tr_b16 a[218:219], v42 offset:36864
  v_mfma_f32_16x16x32_bf16 v[132:135], a[164:167], a[192:195], v[132:135]
  buffer_load_dwordx4 a[152:155], v3, s[12:15], s18 offen offset:2048 sc1
  v_mfma_f32_16x16x32_bf16 v[136:139], a[160:163], a[196:199], v[136:139]
  ds_read_b64_tr_b16 a[220:221], v43 offset:32768
  ds_read_b64_tr_b16 a[222:223], v43 offset:36864
  v_mfma_f32_16x16x32_bf16 v[140:143], a[164:167], a[196:199], v[140:143]
  s_waitcnt lgkmcnt(8)
  v_mfma_f32_16x16x32_bf16 v[144:147], a[160:163], a[200:203], v[144:147]
  ds_read_b64_tr_b16 a[192:193], v8 offset:40960
  ds_read_b64_tr_b16 a[194:195], v8 offset:45056
  v_mfma_f32_16x16x32_bf16 v[148:151], a[164:167], a[200:203], v[148:151]
  buffer_load_dwordx4 a[156:159], v3, s[12:15], s18 offen offset:3072 sc1
  s_add_u32 s18, s18, 4096
  v_mfma_f32_16x16x32_bf16 v[152:155], a[160:163], a[204:207], v[152:155]
  ds_read_b64_tr_b16 a[196:197], v9 offset:40960
  ds_read_b64_tr_b16 a[198:199], v9 offset:45056
  v_mfma_f32_16x16x32_bf16 v[156:159], a[164:167], a[204:207], v[156:159]
  s_add_u32 m0, s19, 0
  s_waitcnt lgkmcnt(8)
  v_mfma_f32_16x16x32_bf16 v[160:163], a[160:163], a[208:211], v[160:163]
  ds_read_b64_tr_b16 a[200:201], v10 offset:40960
  ds_read_b64_tr_b16 a[202:203], v10 offset:45056
  v_mfma_f32_16x16x32_bf16 v[164:167], a[164:167], a[208:211], v[164:167]
  buffer_load_dwordx4 v4, s[8:11], s17 offen offset:0 lds
  v_mfma_f32_16x16x32_bf16 v[168:171], a[160:163], a[212:215], v[168:171]
  ds_read_b64_tr_b16 a[204:205], v11 offset:40960
  ds_read_b64_tr_b16 a[206:207], v11 offset:45056
  v_mfma_f32_16x16x32_bf16 v[172:175], a[164:167], a[212:215], v[172:175]
  s_waitcnt lgkmcnt(8)
  v_mfma_f32_16x16x32_bf16 v[176:179], a[160:163], a[216:219], v[176:179]
  ds_read_b64_tr_b16 a[208:209], v40 offset:40960
  ds_read_b64_tr_b16 a[210:211], v40 offset:45056
  v_mfma_f32_16x16x32_bf16 v[180:183], a[164:167], a[216:219], v[180:183]
  buffer_load_dwordx4 v5, s[8:11], s17 offen offset:1024 lds
  v_mfma_f32_16x16x32_bf16 v[184:187], a[160:163], a[220:223], v[184:187]
  ds_read_b64_tr_b16 a[212:213], v41 offset:40960
  ds_read_b64_tr_b16 a[214:215], v41 offset:45056
  v_mfma_f32_16x16x32_bf16 v[188:191], a[164:167], a[220:223], v[188:191]
  s_waitcnt vmcnt(26) lgkmcnt(8)
  v_mfma_f32_16x16x32_bf16 v[128:131], a[168:171], a[192:195], v[128:131]
  ds_read_b64_tr_b16 a[216:217], v42 offset:40960
  ds_read_b64_tr_b16 a[218:219], v42 offset:45056
  v_mfma_f32_16x16x32_bf16 v[132:135], a[172:175], a[192:195], v[132:135]
  buffer_load_dwordx4 v6, s[8:11], s17 offen offset:2048 lds
  v_mfma_f32_16x16x32_bf16 v[136:139], a[168:171], a[196:199], v[136:139]
  ds_read_b64_tr_b16 a[220:221], v43 offset:40960
  ds_read_b64_tr_b16 a[222:223], v43 offset:45056
  v_mfma_f32_16x16x32_bf16 v[140:143], a[172:175], a[196:199], v[140:143]
  s_waitcnt lgkmcnt(8)
  v_mfma_f32_16x16x32_bf16 v[144:147], a[168:171], a[200:203], v[144:147]
  s_barrier
  ds_read_b64_tr_b16 a[192:193], v8 offset:49152
  ds_read_b64_tr_b16 a[194:195], v8 offset:53248
  v_mfma_f32_16x16x32_bf16 v[148:151], a[172:175], a[200:203], v[148:151]
  buffer_load_dwordx4 v7, s[8:11], s17 offen offset:3072 lds
  s_add_u32 s17, s17, 262144
  v_mfma_f32_16x16x32_bf16 v[152:155], a[168:171], a[204:207], v[152:155]
  ds_read_b64_tr_b16 a[196:197], v9 offset:49152
  ds_read_b64_tr_b16 a[198:199], v9 offset:53248
  v_mfma_f32_16x16x32_bf16 v[156:159], a[172:175], a[204:207], v[156:159]
  s_waitcnt lgkmcnt(8)
  v_mfma_f32_16x16x32_bf16 v[160:163], a[168:171], a[208:211], v[160:163]
  ds_read_b64_tr_b16 a[200:201], v10 offset:49152
  ds_read_b64_tr_b16 a[202:203], v10 offset:53248
  v_mfma_f32_16x16x32_bf16 v[164:167], a[172:175], a[208:211], v[164:167]
  buffer_load_dwordx4 a[160:163], v3, s[12:15], s18 offen offset:0 sc1
  v_mfma_f32_16x16x32_bf16 v[168:171], a[168:171], a[212:215], v[168:171]
  ds_read_b64_tr_b16 a[204:205], v11 offset:49152
  ds_read_b64_tr_b16 a[206:207], v11 offset:53248
  v_mfma_f32_16x16x32_bf16 v[172:175], a[172:175], a[212:215], v[172:175]
  s_waitcnt lgkmcnt(8)
  v_mfma_f32_16x16x32_bf16 v[176:179], a[168:171], a[216:219], v[176:179]
  ds_read_b64_tr_b16 a[208:209], v40 offset:49152
  ds_read_b64_tr_b16 a[210:211], v40 offset:53248
  v_mfma_f32_16x16x32_bf16 v[180:183], a[172:175], a[216:219], v[180:183]
  buffer_load_dwordx4 a[164:167], v3, s[12:15], s18 offen offset:1024 sc1
  v_mfma_f32_16x16x32_bf16 v[184:187], a[168:171], a[220:223], v[184:187]
  ds_read_b64_tr_b16 a[212:213], v41 offset:49152
  ds_read_b64_tr_b16 a[214:215], v41 offset:53248
  v_mfma_f32_16x16x32_bf16 v[188:191], a[172:175], a[220:223], v[188:191]
  s_waitcnt vmcnt(24) lgkmcnt(8)
  v_mfma_f32_16x16x32_bf16 v[128:131], a[176:179], a[192:195], v[128:131]
  s_cmp_eq_u32 s20, 6
  s_cbranch_scc0 L_mk2_c1_47
  buffer_load_dword v61, v60, s[52:55], 0 offen sc1
L_mk2_c1_47:
  ds_read_b64_tr_b16 a[216:217], v42 offset:49152
  ds_read_b64_tr_b16 a[218:219], v42 offset:53248
  v_mfma_f32_16x16x32_bf16 v[132:135], a[180:183], a[192:195], v[132:135]
  buffer_load_dwordx4 a[168:171], v3, s[12:15], s18 offen offset:2048 sc1
  v_mfma_f32_16x16x32_bf16 v[136:139], a[176:179], a[196:199], v[136:139]
  ds_read_b64_tr_b16 a[220:221], v43 offset:49152
  ds_read_b64_tr_b16 a[222:223], v43 offset:53248
  v_mfma_f32_16x16x32_bf16 v[140:143], a[180:183], a[196:199], v[140:143]
  s_waitcnt lgkmcnt(8)
  v_mfma_f32_16x16x32_bf16 v[144:147], a[176:179], a[200:203], v[144:147]
  ds_read_b64_tr_b16 a[192:193], v8 offset:57344
  ds_read_b64_tr_b16 a[194:195], v8 offset:61440
  v_mfma_f32_16x16x32_bf16 v[148:151], a[180:183], a[200:203], v[148:151]
  buffer_load_dwordx4 a[172:175], v3, s[12:15], s18 offen offset:3072 sc1
  s_add_u32 s18, s18, 4096
  v_mfma_f32_16x16x32_bf16 v[152:155], a[176:179], a[204:207], v[152:155]
  ds_read_b64_tr_b16 a[196:197], v9 offset:57344
  ds_read_b64_tr_b16 a[198:199], v9 offset:61440
  v_mfma_f32_16x16x32_bf16 v[156:159], a[180:183], a[204:207], v[156:159]
  s_add_u32 m0, s19, 16384
  s_waitcnt lgkmcnt(8)
  v_mfma_f32_16x16x32_bf16 v[160:163], a[176:179], a[208:211], v[160:163]
  ds_read_b64_tr_b16 a[200:201], v10 offset:57344
  ds_read_b64_tr_b16 a[202:203], v10 offset:61440
  v_mfma_f32_16x16x32_bf16 v[164:167], a[180:183], a[208:211], v[164:167]
  buffer_load_dwordx4 v4, s[8:11], s17 offen offset:0 lds
  v_mfma_f32_16x16x32_bf16 v[168:171], a[176:179], a[212:215], v[168:171]
  ds_read_b64_tr_b16 a[204:205], v11 offset:57344
  ds_read_b64_tr_b16 a[206:207], v11 offset:61440
  v_mfma_f32_16x16x32_bf16 v[172:175], a[180:183], a[212:215], v[172:175]
  s_waitcnt lgkmcnt(8)
  v_mfma_f32_16x16x32_bf16 v[176:179], a[176:179], a[216:219], v[176:179]
  ds_read_b64_tr_b16 a[208:209], v40 offset:57344
  ds_read_b64_tr_b16 a[210:211], v40 offset:61440
  v_mfma_f32_16x16x32_bf16 v[180:183], a[180:183], a[216:219], v[180:183]
  buffer_load_dwordx4 v5, s[8:11], s17 offen offset:1024 lds
  v_mfma_f32_16x16x32_bf16 v[184:187], a[176:179], a[220:223], v[184:187]
  ds_read_b64_tr_b16 a[212:213], v41 offset:57344
  ds_read_b64_tr_b16 a[214:215], v41 offset:61440
  v_mfma_f32_16x16x32_bf16 v[188:191], a[180:183], a[220:223], v[188:191]
  s_waitcnt vmcnt(26) lgkmcnt(8)
  v_mfma_f32_16x16x32_bf16 v[128:131], a[184:187], a[192:195], v[128:131]
  ds_read_b64_tr_b16 a[216:217], v42 offset:57344
  ds_read_b64_tr_b16 a[218:219], v42 offset:61440
  v_mfma_f32_16x16x32_bf16 v[132:135], a[188:191], a[192:195], v[132:135]
  buffer_load_dwordx4 v6, s[8:11], s17 offen offset:2048 lds
  v_mfma_f32_16x16x32_bf16 v[136:139], a[184:187], a[196:199], v[136:139]
  ds_read_b64_tr_b16 a[220:221], v43 offset:57344
  ds_read_b64_tr_b16 a[222:223], v43 offset:61440
  v_mfma_f32_16x16x32_bf16 v[140:143], a[188:191], a[196:199], v[140:143]
  s_waitcnt lgkmcnt(8)
  v_mfma_f32_16x16x32_bf16 v[144:147], a[184:187], a[200:203], v[144:147]
  s_barrier
  ds_read_b64_tr_b16 a[192:193], v208 offset:0
  ds_read_b64_tr_b16 a[194:195], v208 offset:4096
  v_mfma_f32_16x16x32_bf16 v[148:151], a[188:191], a[200:203], v[148:151]
  buffer_load_dwordx4 v7, s[8:11], s17 offen offset:3072 lds
  s_add_u32 s17, s17, 262144
  v_mfma_f32_16x16x32_bf16 v[152:155], a[184:187], a[204:207], v[152:155]
  ds_read_b64_tr_b16 a[196:197], v209 offset:0
  ds_read_b64_tr_b16 a[198:199], v209 offset:4096
  v_mfma_f32_16x16x32_bf16 v[156:159], a[188:191], a[204:207], v[156:159]
  s_waitcnt lgkmcnt(8)
  v_mfma_f32_16x16x32_bf16 v[160:163], a[184:187], a[208:211], v[160:163]
  ds_read_b64_tr_b16 a[200:201], v210 offset:0
  ds_read_b64_tr_b16 a[202:203], v210 offset:4096
  v_mfma_f32_16x16x32_bf16 v[164:167], a[188:191], a[208:211], v[164:167]
  buffer_load_dwordx4 a[176:179], v3, s[12:15], s18 offen offset:0 sc1
  v_mfma_f32_16x16x32_bf16 v[168:171], a[184:187], a[212:215], v[168:171]
  ds_read_b64_tr_b16 a[204:205], v211 offset:0
  ds_read_b64_tr_b16 a[206:207], v211 offset:4096
  v_mfma_f32_16x16x32_bf16 v[172:175], a[188:191], a[212:215], v[172:175]
  s_waitcnt lgkmcnt(8)
  v_mfma_f32_16x16x32_bf16 v[176:179], a[184:187], a[216:219], v[176:179]
  ds_read_b64_tr_b16 a[208:209], v212 offset:0
  ds_read_b64_tr_b16 a[210:211], v212 offset:4096
  v_mfma_f32_16x16x32_bf16 v[180:183], a[188:191], a[216:219], v[180:183]
  buffer_load_dwordx4 a[180:183], v3, s[12:15], s18 offen offset:1024 sc1
  v_mfma_f32_16x16x32_bf16 v[184:187], a[184:187], a[220:223], v[184:187]
  ds_read_b64_tr_b16 a[212:213], v213 offset:0
  ds_read_b64_tr_b16 a[214:215], v213 offset:4096
  v_mfma_f32_16x16x32_bf16 v[188:191], a[188:191], a[220:223], v[188:191]
  s_waitcnt vmcnt(24) lgkmcnt(8)
  v_mfma_f32_16x16x32_bf16 v[128:131], a[128:131], a[192:195], v[128:131]
  ds_read_b64_tr_b16 a[216:217], v214 offset:0
  ds_read_b64_tr_b16 a[218:219], v214 offset:4096
  v_mfma_f32_16x16x32_bf16 v[132:135], a[132:135], a[192:195], v[132:135]
  buffer_load_dwordx4 a[184:187], v3, s[12:15], s18 offen offset:2048 sc1
  v_mfma_f32_16x16x32_bf16 v[136:139], a[128:131], a[196:199], v[136:139]
  ds_read_b64_tr_b16 a[220:221], v215 offset:0
  ds_read_b64_tr_b16 a[222:223], v215 offset:4096
  v_mfma_f32_16x16x32_bf16 v[140:143], a[132:135], a[196:199], v[140:143]
  s_waitcnt lgkmcnt(8)
  v_mfma_f32_16x16x32_bf16 v[144:147], a[128:131], a[200:203], v[144:147]
  ds_read_b64_tr_b16 a[192:193], v208 offset:8192
  ds_read_b64_tr_b16 a[194:195], v208 offset:12288
  v_mfma_f32_16x16x32_bf16 v[148:151], a[132:135], a[200:203], v[148:151]
  buffer_load_dwordx4 a[188:191], v3, s[12:15], s18 offen offset:3072 sc1
  s_add_u32 s18, s18, 4096
  v_mfma_f32_16x16x32_bf16 v[152:155], a[128:131], a[204:207], v[152:155]
  ds_read_b64_tr_b16 a[196:197], v209 offset:8192
  ds_read_b64_tr_b16 a[198:199], v209 offset:12288
  v_mfma_f32_16x16x32_bf16 v[156:159], a[132:135], a[204:207], v[156:159]
  s_add_u32 m0, s19, 32768
  s_waitcnt lgkmcnt(8)
  v_mfma_f32_16x16x32_bf16 v[160:163], a[128:131], a[208:211], v[160:163]
  ds_read_b64_tr_b16 a[200:201], v210 offset:8192
  ds_read_b64_tr_b16 a[202:203], v210 offset:12288
  v_mfma_f32_16x16x32_bf16 v[164:167], a[132:135], a[208:211], v[164:167]
  buffer_load_dwordx4 v4, s[8:11], s17 offen offset:0 lds
  v_mfma_f32_16x16x32_bf16 v[168:171], a[128:131], a[212:215], v[168:171]
  ds_read_b64_tr_b16 a[204:205], v211 offset:8192
  ds_read_b64_tr_b16 a[206:207], v211 offset:12288
  v_mfma_f32_16x16x32_bf16 v[172:175], a[132:135], a[212:215], v[172:175]
  s_waitcnt lgkmcnt(8)
  v_mfma_f32_16x16x32_bf16 v[176:179], a[128:131], a[216:219], v[176:179]
  ds_read_b64_tr_b16 a[208:209], v212 offset:8192
  ds_read_b64_tr_b16 a[210:211], v212 offset:12288
  v_mfma_f32_16x16x32_bf16 v[180:183], a[132:135], a[216:219], v[180:183]
  buffer_load_dwordx4 v5, s[8:11], s17 offen offset:1024 lds
  v_mfma_f32_16x16x32_bf16 v[184:187], a[128:131], a[220:223], v[184:187]
  ds_read_b64_tr_b16 a[212:213], v213 offset:8192
  ds_read_b64_tr_b16 a[214:215], v213 offset:12288
  v_mfma_f32_16x16x32_bf16 v[188:191], a[132:135], a[220:223], v[188:191]
  s_waitcnt vmcnt(26) lgkmcnt(8)
  v_mfma_f32_16x16x32_bf16 v[128:131], a[136:139], a[192:195], v[128:131]
  ds_read_b64_tr_b16 a[216:217], v214 offset:8192
  ds_read_b64_tr_b16 a[218:219], v214 offset:12288
  v_mfma_f32_16x16x32_bf16 v[132:135], a[140:143], a[192:195], v[132:135]
  buffer_load_dwordx4 v6, s[8:11], s17 offen offset:2048 lds
  v_mfma_f32_16x16x32_bf16 v[136:139], a[136:139], a[196:199], v[136:139]
  ds_read_b64_tr_b16 a[220:221], v215 offset:8192
  ds_read_b64_tr_b16 a[222:223], v215 offset:12288
  v_mfma_f32_16x16x32_bf16 v[140:143], a[140:143], a[196:199], v[140:143]
  s_waitcnt lgkmcnt(8)
  v_mfma_f32_16x16x32_bf16 v[144:147], a[136:139], a[200:203], v[144:147]
  s_barrier
  ds_read_b64_tr_b16 a[192:193], v208 offset:16384
  ds_read_b64_tr_b16 a[194:195], v208 offset:20480
  v_mfma_f32_16x16x32_bf16 v[148:151], a[140:143], a[200:203], v[148:151]
  buffer_load_dwordx4 v7, s[8:11], s17 offen offset:3072 lds
  s_add_u32 s17, s17, 262144
  v_mfma_f32_16x16x32_bf16 v[152:155], a[136:139], a[204:207], v[152:155]
  ds_read_b64_tr_b16 a[196:197], v209 offset:16384
  ds_read_b64_tr_b16 a[198:199], v209 offset:20480
  v_mfma_f32_16x16x32_bf16 v[156:159], a[140:143], a[204:207], v[156:159]
  s_waitcnt lgkmcnt(8)
  v_mfma_f32_16x16x32_bf16 v[160:163], a[136:139], a[208:211], v[160:163]
  ds_read_b64_tr_b16 a[200:201], v210 offset:16384
  ds_read_b64_tr_b16 a[202:203], v210 offset:20480
  v_mfma_f32_16x16x32_bf16 v[164:167], a[140:143], a[208:211], v[164:167]
  buffer_load_dwordx4 a[128:131], v3, s[12:15], s18 offen offset:0 sc1
  v_mfma_f32_16x16x32_bf16 v[168:171], a[136:139], a[212:215], v[168:171]
  ds_read_b64_tr_b16 a[204:205], v211 offset:16384
  ds_read_b64_tr_b16 a[206:207], v211 offset:20480
  v_mfma_f32_16x16x32_bf16 v[172:175], a[140:143], a[212:215], v[172:175]
  s_waitcnt lgkmcnt(8)
  v_mfma_f32_16x16x32_bf16 v[176:179], a[136:139], a[216:219], v[176:179]
  ds_read_b64_tr_b16 a[208:209], v212 offset:16384
  ds_read_b64_tr_b16 a[210:211], v212 offset:20480
  v_mfma_f32_16x16x32_bf16 v[180:183], a[140:143], a[216:219], v[180:183]
  buffer_load_dwordx4 a[132:135], v3, s[12:15], s18 offen offset:1024 sc1
  v_mfma_f32_16x16x32_bf16 v[184:187], a[136:139], a[220:223], v[184:187]
  ds_read_b64_tr_b16 a[212:213], v213 offset:16384
  ds_read_b64_tr_b16 a[214:215], v213 offset:20480
  v_mfma_f32_16x16x32_bf16 v[188:191], a[140:143], a[220:223], v[188:191]
  s_waitcnt vmcnt(24) lgkmcnt(8)
  v_mfma_f32_16x16x32_bf16 v[128:131], a[144:147], a[192:195], v[128:131]
  ds_read_b64_tr_b16 a[216:217], v214 offset:16384
  ds_read_b64_tr_b16 a[218:219], v214 offset:20480
  v_mfma_f32_16x16x32_bf16 v[132:135], a[148:151], a[192:195], v[132:135]
  buffer_load_dwordx4 a[136:139], v3, s[12:15], s18 offen offset:2048 sc1
  v_mfma_f32_16x16x32_bf16 v[136:139], a[144:147], a[196:199], v[136:139]
  ds_read_b64_tr_b16 a[220:221], v215 offset:16384
  ds_read_b64_tr_b16 a[222:223], v215 offset:20480
  v_mfma_f32_16x16x32_bf16 v[140:143], a[148:151], a[196:199], v[140:143]
  s_waitcnt lgkmcnt(8)
  v_mfma_f32_16x16x32_bf16 v[144:147], a[144:147], a[200:203], v[144:147]
  ds_read_b64_tr_b16 a[192:193], v208 offset:24576
  ds_read_b64_tr_b16 a[194:195], v208 offset:28672
  v_mfma_f32_16x16x32_bf16 v[148:151], a[148:151], a[200:203], v[148:151]
  buffer_load_dwordx4 a[140:143], v3, s[12:15], s18 offen offset:3072 sc1
  s_add_u32 s18, s18, 4096
  v_mfma_f32_16x16x32_bf16 v[152:155], a[144:147], a[204:207], v[152:155]
  ds_read_b64_tr_b16 a[196:197], v209 offset:24576
  ds_read_b64_tr_b16 a[198:199], v209 offset:28672
  v_mfma_f32_16x16x32_bf16 v[156:159], a[148:151], a[204:207], v[156:159]
  s_add_u32 m0, s19, 49152
  s_waitcnt lgkmcnt(8)
  v_mfma_f32_16x16x32_bf16 v[160:163], a[144:147], a[208:211], v[160:163]
  ds_read_b64_tr_b16 a[200:201], v210 offset:24576
  ds_read_b64_tr_b16 a[202:203], v210 offset:28672
  v_mfma_f32_16x16x32_bf16 v[164:167], a[148:151], a[208:211], v[164:167]
  buffer_load_dwordx4 v4, s[8:11], s17 offen offset:0 lds
  v_mfma_f32_16x16x32_bf16 v[168:171], a[144:147], a[212:215], v[168:171]
  ds_read_b64_tr_b16 a[204:205], v211 offset:24576
  ds_read_b64_tr_b16 a[206:207], v211 offset:28672
  v_mfma_f32_16x16x32_bf16 v[172:175], a[148:151], a[212:215], v[172:175]
  s_waitcnt lgkmcnt(8)
  v_mfma_f32_16x16x32_bf16 v[176:179], a[144:147], a[216:219], v[176:179]
  ds_read_b64_tr_b16 a[208:209], v212 offset:24576
  ds_read_b64_tr_b16 a[210:211], v212 offset:28672
  v_mfma_f32_16x16x32_bf16 v[180:183], a[148:151], a[216:219], v[180:183]
  buffer_load_dwordx4 v5, s[8:11], s17 offen offset:1024 lds
  v_mfma_f32_16x16x32_bf16 v[184:187], a[144:147], a[220:223], v[184:187]
  ds_read_b64_tr_b16 a[212:213], v213 offset:24576
  ds_read_b64_tr_b16 a[214:215], v213 offset:28672
  v_mfma_f32_16x16x32_bf16 v[188:191], a[148:151], a[220:223], v[188:191]
  s_waitcnt vmcnt(26) lgkmcnt(8)
  v_mfma_f32_16x16x32_bf16 v[128:131], a[152:155], a[192:195], v[128:131]
  ds_read_b64_tr_b16 a[216:217], v214 offset:24576
  ds_read_b64_tr_b16 a[218:219], v214 offset:28672
  v_mfma_f32_16x16x32_bf16 v[132:135], a[156:159], a[192:195], v[132:135]
  buffer_load_dwordx4 v6, s[8:11], s17 offen offset:2048 lds
  v_mfma_f32_16x16x32_bf16 v[136:139], a[152:155], a[196:199], v[136:139]
  ds_read_b64_tr_b16 a[220:221], v215 offset:24576
  ds_read_b64_tr_b16 a[222:223], v215 offset:28672
  v_mfma_f32_16x16x32_bf16 v[140:143], a[156:159], a[196:199], v[140:143]
  s_waitcnt lgkmcnt(8)
  v_mfma_f32_16x16x32_bf16 v[144:147], a[152:155], a[200:203], v[144:147]
  s_barrier
  ds_read_b64_tr_b16 a[192:193], v208 offset:32768
  ds_read_b64_tr_b16 a[194:195], v208 offset:36864
  v_mfma_f32_16x16x32_bf16 v[148:151], a[156:159], a[200:203], v[148:151]
  buffer_load_dwordx4 v7, s[8:11], s17 offen offset:3072 lds
  s_add_u32 s17, s17, 262144
  v_mfma_f32_16x16x32_bf16 v[152:155], a[152:155], a[204:207], v[152:155]
  ds_read_b64_tr_b16 a[196:197], v209 offset:32768
  ds_read_b64_tr_b16 a[198:199], v209 offset:36864
  v_mfma_f32_16x16x32_bf16 v[156:159], a[156:159], a[204:207], v[156:159]
  s_waitcnt lgkmcnt(8)
  v_mfma_f32_16x16x32_bf16 v[160:163], a[152:155], a[208:211], v[160:163]
  ds_read_b64_tr_b16 a[200:201], v210 offset:32768
  ds_read_b64_tr_b16 a[202:203], v210 offset:36864
  v_mfma_f32_16x16x32_bf16 v[164:167], a[156:159], a[208:211], v[164:167]
  buffer_load_dwordx4 a[144:147], v3, s[12:15], s18 offen offset:0 sc1
  v_mfma_f32_16x16x32_bf16 v[168:171], a[152:155], a[212:215], v[168:171]
  ds_read_b64_tr_b16 a[204:205], v211 offset:32768
  ds_read_b64_tr_b16 a[206:207], v211 offset:36864
  v_mfma_f32_16x16x32_bf16 v[172:175], a[156:159], a[212:215], v[172:175]
  s_waitcnt lgkmcnt(8)
  v_mfma_f32_16x16x32_bf16 v[176:179], a[152:155], a[216:219], v[176:179]
  ds_read_b64_tr_b16 a[208:209], v212 offset:32768
  ds_read_b64_tr_b16 a[210:211], v212 offset:36864
  v_mfma_f32_16x16x32_bf16 v[180:183], a[156:159], a[216:219], v[180:183]
  buffer_load_dwordx4 a[148:151], v3, s[12:15], s18 offen offset:1024 sc1
  v_mfma_f32_16x16x32_bf16 v[184:187], a[152:155], a[220:223], v[184:187]
  ds_read_b64_tr_b16 a[212:213], v213 offset:32768
  ds_read_b64_tr_b16 a[214:215], v213 offset:36864
  v_mfma_f32_16x16x32_bf16 v[188:191], a[156:159], a[220:223], v[188:191]
  s_waitcnt vmcnt(24) lgkmcnt(8)
  v_mfma_f32_16x16x32_bf16 v[128:131], a[160:163], a[192:195], v[128:131]
  ds_read_b64_tr_b16 a[216:217], v214 offset:32768
  ds_read_b64_tr_b16 a[218:219], v214 offset:36864
  v_mfma_f32_16x16x32_bf16 v[132:135], a[164:167], a[192:195], v[132:135]
  buffer_load_dwordx4 a[152:155], v3, s[12:15], s18 offen offset:2048 sc1
  v_mfma_f32_16x16x32_bf16 v[136:139], a[160:163], a[196:199], v[136:139]
  ds_read_b64_tr_b16 a[220:221], v215 offset:32768
  ds_read_b64_tr_b16 a[222:223], v215 offset:36864
  v_mfma_f32_16x16x32_bf16 v[140:143], a[164:167], a[196:199], v[140:143]
  s_waitcnt lgkmcnt(8)
  v_mfma_f32_16x16x32_bf16 v[144:147], a[160:163], a[200:203], v[144:147]
  ds_read_b64_tr_b16 a[192:193], v208 offset:40960
  ds_read_b64_tr_b16 a[194:195], v208 offset:45056
  v_mfma_f32_16x16x32_bf16 v[148:151], a[164:167], a[200:203], v[148:151]
  buffer_load_dwordx4 a[156:159], v3, s[12:15], s18 offen offset:3072 sc1
  s_add_u32 s18, s18, 4096
  v_mfma_f32_16x16x32_bf16 v[152:155], a[160:163], a[204:207], v[152:155]
  ds_read_b64_tr_b16 a[196:197], v209 offset:40960
  ds_read_b64_tr_b16 a[198:199], v209 offset:45056
  v_mfma_f32_16x16x32_bf16 v[156:159], a[164:167], a[204:207], v[156:159]
  s_add_u32 m0, s19, 65536
  s_waitcnt lgkmcnt(8)
  v_mfma_f32_16x16x32_bf16 v[160:163], a[160:163], a[208:211], v[160:163]
  ds_read_b64_tr_b16 a[200:201], v210 offset:40960
  ds_read_b64_tr_b16 a[202:203], v210 offset:45056
  v_mfma_f32_16x16x32_bf16 v[164:167], a[164:167], a[208:211], v[164:167]
  buffer_load_dwordx4 v4, s[8:11], s17 offen offset:0 lds
  v_mfma_f32_16x16x32_bf16 v[168:171], a[160:163], a[212:215], v[168:171]
  ds_read_b64_tr_b16 a[204:205], v211 offset:40960
  ds_read_b64_tr_b16 a[206:207], v211 offset:45056
  v_mfma_f32_16x16x32_bf16 v[172:175], a[164:167], a[212:215], v[172:175]
  s_waitcnt lgkmcnt(8)
  v_mfma_f32_16x16x32_bf16 v[176:179], a[160:163], a[216:219], v[176:179]
  ds_read_b64_tr_b16 a[208:209], v212 offset:40960
  ds_read_b64_tr_b16 a[210:211], v212 offset:45056
  v_mfma_f32_16x16x32_bf16 v[180:183], a[164:167], a[216:219], v[180:183]
  buffer_load_dwordx4 v5, s[8:11], s17 offen offset:1024 lds
  v_mfma_f32_16x16x32_bf16 v[184:187], a[160:163], a[220:223], v[184:187]
  ds_read_b64_tr_b16 a[212:213], v213 offset:40960
  ds_read_b64_tr_b16 a[214:215], v213 offset:45056
  v_mfma_f32_16x16x32_bf16 v[188:191], a[164:167], a[220:223], v[188:191]
  s_waitcnt vmcnt(26) lgkmcnt(8)
  v_mfma_f32_16x16x32_bf16 v[128:131], a[168:171], a[192:195], v[128:131]
  ds_read_b64_tr_b16 a[216:217], v214 offset:40960
  ds_read_b64_tr_b16 a[218:219], v214 offset:45056
  v_mfma_f32_16x16x32_bf16 v[132:135], a[172:175], a[192:195], v[132:135]
  buffer_load_dwordx4 v6, s[8:11], s17 offen offset:2048 lds
  v_mfma_f32_16x16x32_bf16 v[136:139], a[168:171], a[196:199], v[136:139]
  ds_read_b64_tr_b16 a[220:221], v215 offset:40960
  ds_read_b64_tr_b16 a[222:223], v215 offset:45056
  v_mfma_f32_16x16x32_bf16 v[140:143], a[172:175], a[196:199], v[140:143]
  s_waitcnt lgkmcnt(8)
  v_mfma_f32_16x16x32_bf16 v[144:147], a[168:171], a[200:203], v[144:147]
  s_barrier
  ds_read_b64_tr_b16 a[192:193], v208 offset:49152
  ds_read_b64_tr_b16 a[194:195], v208 offset:53248
  v_mfma_f32_16x16x32_bf16 v[148:151], a[172:175], a[200:203], v[148:151]
  buffer_load_dwordx4 v7, s[8:11], s17 offen offset:3072 lds
  s_add_u32 s17, s17, 262144
  v_mfma_f32_16x16x32_bf16 v[152:155], a[168:171], a[204:207], v[152:155]
  ds_read_b64_tr_b16 a[196:197], v209 offset:49152
  ds_read_b64_tr_b16 a[198:199], v209 offset:53248
  v_mfma_f32_16x16x32_bf16 v[156:159], a[172:175], a[204:207], v[156:159]
  s_waitcnt lgkmcnt(8)
  v_mfma_f32_16x16x32_bf16 v[160:163], a[168:171], a[208:211], v[160:163]
  ds_read_b64_tr_b16 a[200:201], v210 offset:49152
  ds_read_b64_tr_b16 a[202:203], v210 offset:53248
  v_mfma_f32_16x16x32_bf16 v[164:167], a[172:175], a[208:211], v[164:167]
  buffer_load_dwordx4 a[160:163], v3, s[12:15], s18 offen offset:0 sc1
  v_mfma_f32_16x16x32_bf16 v[168:171], a[168:171], a[212:215], v[168:171]
  ds_read_b64_tr_b16 a[204:205], v211 offset:49152
  ds_read_b64_tr_b16 a[206:207], v211 offset:53248
  v_mfma_f32_16x16x32_bf16 v[172:175], a[172:175], a[212:215], v[172:175]
  s_waitcnt lgkmcnt(8)
  v_mfma_f32_16x16x32_bf16 v[176:179], a[168:171], a[216:219], v[176:179]
  ds_read_b64_tr_b16 a[208:209], v212 offset:49152
  ds_read_b64_tr_b16 a[210:211], v212 offset:53248
  v_mfma_f32_16x16x32_bf16 v[180:183], a[172:175], a[216:219], v[180:183]
  buffer_load_dwordx4 a[164:167], v3, s[12:15], s18 offen offset:1024 sc1
  v_mfma_f32_16x16x32_bf16 v[184:187], a[168:171], a[220:223], v[184:187]
  ds_read_b64_tr_b16 a[212:213], v213 offset:49152
  ds_read_b64_tr_b16 a[214:215], v213 offset:53248
  v_mfma_f32_16x16x32_bf16 v[188:191], a[172:175], a[220:223], v[188:191]
  s_waitcnt vmcnt(24) lgkmcnt(8)
  v_mfma_f32_16x16x32_bf16 v[128:131], a[176:179], a[192:195], v[128:131]
  ds_read_b64_tr_b16 a[216:217], v214 offset:49152
  ds_read_b64_tr_b16 a[218:219], v214 offset:53248
  v_mfma_f32_16x16x32_bf16 v[132:135], a[180:183], a[192:195], v[132:135]
  buffer_load_dwordx4 a[168:171], v3, s[12:15], s18 offen offset:2048 sc1
  v_mfma_f32_16x16x32_bf16 v[136:139], a[176:179], a[196:199], v[136:139]
  ds_read_b64_tr_b16 a[220:221], v215 offset:49152
  ds_read_b64_tr_b16 a[222:223], v215 offset:53248
  v_mfma_f32_16x16x32_bf16 v[140:143], a[180:183], a[196:199], v[140:143]
  s_waitcnt lgkmcnt(8)
  v_mfma_f32_16x16x32_bf16 v[144:147], a[176:179], a[200:203], v[144:147]
  ds_read_b64_tr_b16 a[192:193], v208 offset:57344
  ds_read_b64_tr_b16 a[194:195], v208 offset:61440
  v_mfma_f32_16x16x32_bf16 v[148:151], a[180:183], a[200:203], v[148:151]
  buffer_load_dwordx4 a[172:175], v3, s[12:15], s18 offen offset:3072 sc1
  s_add_u32 s18, s18, 4096
  v_mfma_f32_16x16x32_bf16 v[152:155], a[176:179], a[204:207], v[152:155]
  ds_read_b64_tr_b16 a[196:197], v209 offset:57344
  ds_read_b64_tr_b16 a[198:199], v209 offset:61440
  v_mfma_f32_16x16x32_bf16 v[156:159], a[180:183], a[204:207], v[156:159]
  s_add_u32 m0, s19, 81920
  s_waitcnt lgkmcnt(8)
  v_mfma_f32_16x16x32_bf16 v[160:163], a[176:179], a[208:211], v[160:163]
  ds_read_b64_tr_b16 a[200:201], v210 offset:57344
  ds_read_b64_tr_b16 a[202:203], v210 offset:61440
  v_mfma_f32_16x16x32_bf16 v[164:167], a[180:183], a[208:211], v[164:167]
  buffer_load_dwordx4 v4, s[8:11], s17 offen offset:0 lds
  v_mfma_f32_16x16x32_bf16 v[168:171], a[176:179], a[212:215], v[168:171]
  ds_read_b64_tr_b16 a[204:205], v211 offset:57344
  ds_read_b64_tr_b16 a[206:207], v211 offset:61440
  v_mfma_f32_16x16x32_bf16 v[172:175], a[180:183], a[212:215], v[172:175]
  s_waitcnt lgkmcnt(8)
  v_mfma_f32_16x16x32_bf16 v[176:179], a[176:179], a[216:219], v[176:179]
  ds_read_b64_tr_b16 a[208:209], v212 offset:57344
  ds_read_b64_tr_b16 a[210:211], v212 offset:61440
  v_mfma_f32_16x16x32_bf16 v[180:183], a[180:183], a[216:219], v[180:183]
  buffer_load_dwordx4 v5, s[8:11], s17 offen offset:1024 lds
  v_mfma_f32_16x16x32_bf16 v[184:187], a[176:179], a[220:223], v[184:187]
  ds_read_b64_tr_b16 a[212:213], v213 offset:57344
  ds_read_b64_tr_b16 a[214:215], v213 offset:61440
  v_mfma_f32_16x16x32_bf16 v[188:191], a[180:183], a[220:223], v[188:191]
  s_waitcnt vmcnt(26) lgkmcnt(8)
  v_mfma_f32_16x16x32_bf16 v[128:131], a[184:187], a[192:195], v[128:131]
  ds_read_b64_tr_b16 a[216:217], v214 offset:57344
  ds_read_b64_tr_b16 a[218:219], v214 offset:61440
  v_mfma_f32_16x16x32_bf16 v[132:135], a[188:191], a[192:195], v[132:135]
  buffer_load_dwordx4 v6, s[8:11], s17 offen offset:2048 lds
  v_mfma_f32_16x16x32_bf16 v[136:139], a[184:187], a[196:199], v[136:139]
  ds_read_b64_tr_b16 a[220:221], v215 offset:57344
  ds_read_b64_tr_b16 a[222:223], v215 offset:61440
  v_mfma_f32_16x16x32_bf16 v[140:143], a[188:191], a[196:199], v[140:143]
  s_waitcnt lgkmcnt(8)
  v_mfma_f32_16x16x32_bf16 v[144:147], a[184:187], a[200:203], v[144:147]
  s_barrier
  ds_read_b64_tr_b16 a[192:193], v8 offset:0
  ds_read_b64_tr_b16 a[194:195], v8 offset:4096
  v_mfma_f32_16x16x32_bf16 v[148:151], a[188:191], a[200:203], v[148:151]
  buffer_load_dwordx4 v7, s[8:11], s17 offen offset:3072 lds
  s_add_u32 s17, s17, 262144
  v_mfma_f32_16x16x32_bf16 v[152:155], a[184:187], a[204:207], v[152:155]
  ds_read_b64_tr_b16 a[196:197], v9 offset:0
  ds_read_b64_tr_b16 a[198:199], v9 offset:4096
  v_mfma_f32_16x16x32_bf16 v[156:159], a[188:191], a[204:207], v[156:159]
  s_waitcnt lgkmcnt(8)
  v_mfma_f32_16x16x32_bf16 v[160:163], a[184:187], a[208:211], v[160:163]
  ds_read_b64_tr_b16 a[200:201], v10 offset:0
  ds_read_b64_tr_b16 a[202:203], v10 offset:4096
  v_mfma_f32_16x16x32_bf16 v[164:167], a[188:191], a[208:211], v[164:167]
  buffer_load_dwordx4 a[176:179], v3, s[12:15], s18 offen offset:0 sc1
  v_mfma_f32_16x16x32_bf16 v[168:171], a[184:187], a[212:215], v[168:171]
  ds_read_b64_tr_b16 a[204:205], v11 offset:0
  ds_read_b64_tr_b16 a[206:207], v11 offset:4096
  v_mfma_f32_16x16x32_bf16 v[172:175], a[188:191], a[212:215], v[172:175]
  s_waitcnt lgkmcnt(8)
  v_mfma_f32_16x16x32_bf16 v[176:179], a[184:187], a[216:219], v[176:179]
  ds_read_b64_tr_b16 a[208:209], v40 offset:0
  ds_read_b64_tr_b16 a[210:211], v40 offset:4096
  v_mfma_f32_16x16x32_bf16 v[180:183], a[188:191], a[216:219], v[180:183]
  buffer_load_dwordx4 a[180:183], v3, s[12:15], s18 offen offset:1024 sc1
  v_mfma_f32_16x16x32_bf16 v[184:187], a[184:187], a[220:223], v[184:187]
  ds_read_b64_tr_b16 a[212:213], v41 offset:0
  ds_read_b64_tr_b16 a[214:215], v41 offset:4096
  v_mfma_f32_16x16x32_bf16 v[188:191], a[188:191], a[220:223], v[188:191]
  s_sub_u32 s20, s20, 1
  s_cmp_lg_u32 s20, 0
  s_cbranch_scc1 L_mk2_p_45
  s_lshl_b32 s22, s68, 15
  s_lshl_b32 s21, s16, 13
  s_add_u32 s22, s22, s21
  s_add_u32 s22, s22, 33554432
  s_add_u32 s32, s96, s22
  s_addc_u32 s33, s97, 0
  s_and_b32 s33, s33, 0xffff
  s_mov_b32 s34, 8192
  s_mov_b32 s35, 0x00020000
  s_mov_b32 s22, 0xbfb8aa3b
  v_lshlrev_b32 v224, 16, v224
  v_lshlrev_b32 v225, 16, v225
  v_lshlrev_b32 v226, 16, v226
  v_lshlrev_b32 v227, 16, v227
  v_lshlrev_b32 v228, 16, v228
  v_lshlrev_b32 v229, 16, v229
  v_lshlrev_b32 v230, 16, v230
  v_lshlrev_b32 v231, 16, v231
  v_add_f32 v128, v128, v224
  v_add_f32 v129, v129, v224
  v_add_f32 v130, v130, v224
  v_add_f32 v131, v131, v224
  v_add_f32 v132, v132, v224
  v_add_f32 v133, v133, v224
  v_add_f32 v134, v134, v224
  v_add_f32 v135, v135, v224
  v_mul_f32 v192, s22, v128
  v_mul_f32 v193, s22, v129
  v_mul_f32 v194, s22, v130
  v_mul_f32 v195, s22, v131
  v_mul_f32 v196, s22, v132
  v_mul_f32 v197, s22, v133
  v_mul_f32 v198, s22, v134
  v_mul_f32 v199, s22, v135
  v_exp_f32 v192, v192
  v_exp_f32 v193, v193
  v_exp_f32 v194, v194
  v_exp_f32 v195, v195
  v_exp_f32 v196, v196
  v_exp_f32 v197, v197
  v_exp_f32 v198, v198
  v_exp_f32 v199, v199
  v_add_f32 v192, 1.0, v192
  v_add_f32 v193, 1.0, v193
  v_add_f32 v194, 1.0, v194
  v_add_f32 v195, 1.0, v195
  v_add_f32 v196, 1.0, v196
  v_add_f32 v197, 1.0, v197
  v_add_f32 v198, 1.0, v198
  v_add_f32 v199, 1.0, v199
  v_rcp_f32 v192, v192
  v_rcp_f32 v193, v193
  v_rcp_f32 v194, v194
  v_rcp_f32 v195, v195
  v_rcp_f32 v196, v196
  v_rcp_f32 v197, v197
  v_rcp_f32 v198, v198
  v_rcp_f32 v199, v199
  v_mul_f32 v128, v128, v192
  v_mul_f32 v129, v129, v193
  v_mul_f32 v130, v130, v194
  v_mul_f32 v131, v131, v195
  v_mul_f32 v132, v132, v196
  v_mul_f32 v133, v133, v197
  v_mul_f32 v134, v134, v198
  v_mul_f32 v135, v135, v199
  v_cvt_pk_bf16_f32 v128, v128, v129
  v_cvt_pk_bf16_f32 v129, v130, v131
  v_cvt_pk_bf16_f32 v130, v132, v133
  v_cvt_pk_bf16_f32 v131, v134, v135
  buffer_store_dwordx4 v[128:131], v3, s[32:35], 0 offen offset:0 sc1
  v_add_f32 v136, v136, v225
  v_add_f32 v137, v137, v225
  v_add_f32 v138, v138, v225
  v_add_f32 v139, v139, v225
  v_add_f32 v140, v140, v225
  v_add_f32 v141, v141, v225
  v_add_f32 v142, v142, v225
  v_add_f32 v143, v143, v225
  v_mul_f32 v192, s22, v136
  v_mul_f32 v193, s22, v137
  v_mul_f32 v194, s22, v138
  v_mul_f32 v195, s22, v139
  v_mul_f32 v196, s22, v140
  v_mul_f32 v197, s22, v141
  v_mul_f32 v198, s22, v142
  v_mul_f32 v199, s22, v143
  v_exp_f32 v192, v192
  v_exp_f32 v193, v193
  v_exp_f32 v194, v194
  v_exp_f32 v195, v195
  v_exp_f32 v196, v196
  v_exp_f32 v197, v197
  v_exp_f32 v198, v198
  v_exp_f32 v199, v199
  v_add_f32 v192, 1.0, v192
  v_add_f32 v193, 1.0, v193
  v_add_f32 v194, 1.0, v194
  v_add_f32 v195, 1.0, v195
  v_add_f32 v196, 1.0, v196
  v_add_f32 v197, 1.0, v197
  v_add_f32 v198, 1.0, v198
  v_add_f32 v199, 1.0, v199
  v_rcp_f32 v192, v192
  v_rcp_f32 v193, v193
  v_rcp_f32 v194, v194
  v_rcp_f32 v195, v195
  v_rcp_f32 v196, v196
  v_rcp_f32 v197, v197
  v_rcp_f32 v198, v198
  v_rcp_f32 v199, v199
  v_mul_f32 v136, v136, v192
  v_mul_f32 v137, v137, v193
  v_mul_f32 v138, v138, v194
  v_mul_f32 v139, v139, v195
  v_mul_f32 v140, v140, v196
  v_mul_f32 v141, v141, v197
  v_mul_f32 v142, v142, v198
  v_mul_f32 v143, v143, v199
  v_cvt_pk_bf16_f32 v136, v136, v137
  v_cvt_pk_bf16_f32 v137, v138, v139
  v_cvt_pk_bf16_f32 v138, v140, v141
  v_cvt_pk_bf16_f32 v139, v142, v143
  buffer_store_dwordx4 v[136:139], v3, s[32:35], 0 offen offset:1024 sc1
  v_add_f32 v144, v144, v226
  v_add_f32 v145, v145, v226
  v_add_f32 v146, v146, v226
  v_add_f32 v147, v147, v226
  v_add_f32 v148, v148, v226
  v_add_f32 v149, v149, v226
  v_add_f32 v150, v150, v226
  v_add_f32 v151, v151, v226
  v_mul_f32 v192, s22, v144
  v_mul_f32 v193, s22, v145
  v_mul_f32 v194, s22, v146
  v_mul_f32 v195, s22, v147
  v_mul_f32 v196, s22, v148
  v_mul_f32 v197, s22, v149
  v_mul_f32 v198, s22, v150
  v_mul_f32 v199, s22, v151
  v_exp_f32 v192, v192
  v_exp_f32 v193, v193
  v_exp_f32 v194, v194
  v_exp_f32 v195, v195
  v_exp_f32 v196, v196
  v_exp_f32 v197, v197
  v_exp_f32 v198, v198
  v_exp_f32 v199, v199
  v_add_f32 v192, 1.0, v192
  v_add_f32 v193, 1.0, v193
  v_add_f32 v194, 1.0, v194
  v_add_f32 v195, 1.0, v195
  v_add_f32 v196, 1.0, v196
  v_add_f32 v197, 1.0, v197
  v_add_f32 v198, 1.0, v198
  v_add_f32 v199, 1.0, v199
  v_rcp_f32 v192, v192
  v_rcp_f32 v193, v193
  v_rcp_f32 v194, v194
  v_rcp_f32 v195, v195
  v_rcp_f32 v196, v196
  v_rcp_f32 v197, v197
  v_rcp_f32 v198, v198
  v_rcp_f32 v199, v199
  v_mul_f32 v144, v144, v192
  v_mul_f32 v145, v145, v193
  v_mul_f32 v146, v146, v194
  v_mul_f32 v147, v147, v195
  v_mul_f32 v148, v148, v196
  v_mul_f32 v149, v149, v197
  v_mul_f32 v150, v150, v198
  v_mul_f32 v151, v151, v199
  v_cvt_pk_bf16_f32 v144, v144, v145
  v_cvt_pk_bf16_f32 v145, v146, v147
  v_cvt_pk_bf16_f32 v146, v148, v149
  v_cvt_pk_bf16_f32 v147, v150, v151
  buffer_store_dwordx4 v[144:147], v3, s[32:35], 0 offen offset:2048 sc1
  v_add_f32 v152, v152, v227
  v_add_f32 v153, v153, v227
  v_add_f32 v154, v154, v227
  v_add_f32 v155, v155, v227
  v_add_f32 v156, v156, v227
  v_add_f32 v157, v157, v227
  v_add_f32 v158, v158, v227
  v_add_f32 v159, v159, v227
  v_mul_f32 v192, s22, v152
  v_mul_f32 v193, s22, v153
  v_mul_f32 v194, s22, v154
  v_mul_f32 v195, s22, v155
  v_mul_f32 v196, s22, v156
  v_mul_f32 v197, s22, v157
  v_mul_f32 v198, s22, v158
  v_mul_f32 v199, s22, v159
  v_exp_f32 v192, v192
  v_exp_f32 v193, v193
  v_exp_f32 v194, v194
  v_exp_f32 v195, v195
  v_exp_f32 v196, v196
  v_exp_f32 v197, v197
  v_exp_f32 v198, v198
  v_exp_f32 v199, v199
  v_add_f32 v192, 1.0, v192
  v_add_f32 v193, 1.0, v193
  v_add_f32 v194, 1.0, v194
  v_add_f32 v195, 1.0, v195
  v_add_f32 v196, 1.0, v196
  v_add_f32 v197, 1.0, v197
  v_add_f32 v198, 1.0, v198
  v_add_f32 v199, 1.0, v199
  v_rcp_f32 v192, v192
  v_rcp_f32 v193, v193
  v_rcp_f32 v194, v194
  v_rcp_f32 v195, v195
  v_rcp_f32 v196, v196
  v_rcp_f32 v197, v197
  v_rcp_f32 v198, v198
  v_rcp_f32 v199, v199
  v_mul_f32 v152, v152, v192
  v_mul_f32 v153, v153, v193
  v_mul_f32 v154, v154, v194
  v_mul_f32 v155, v155, v195
  v_mul_f32 v156, v156, v196
  v_mul_f32 v157, v157, v197
  v_mul_f32 v158, v158, v198
  v_mul_f32 v159, v159, v199
  v_cvt_pk_bf16_f32 v152, v152, v153
  v_cvt_pk_bf16_f32 v153, v154, v155
  v_cvt_pk_bf16_f32 v154, v156, v157
  v_cvt_pk_bf16_f32 v155, v158, v159
  buffer_store_dwordx4 v[152:155], v3, s[32:35], 0 offen offset:3072 sc1
  v_add_f32 v160, v160, v228
  v_add_f32 v161, v161, v228
  v_add_f32 v162, v162, v228
  v_add_f32 v163, v163, v228
  v_add_f32 v164, v164, v228
  v_add_f32 v165, v165, v228
  v_add_f32 v166, v166, v228
  v_add_f32 v167, v167, v228
  v_mul_f32 v192, s22, v160
  v_mul_f32 v193, s22, v161
  v_mul_f32 v194, s22, v162
  v_mul_f32 v195, s22, v163
  v_mul_f32 v196, s22, v164
  v_mul_f32 v197, s22, v165
  v_mul_f32 v198, s22, v166
  v_mul_f32 v199, s22, v167
  v_exp_f32 v192, v192
  v_exp_f32 v193, v193
  v_exp_f32 v194, v194
  v_exp_f32 v195, v195
  v_exp_f32 v196, v196
  v_exp_f32 v197, v197
  v_exp_f32 v198, v198
  v_exp_f32 v199, v199
  v_add_f32 v192, 1.0, v192
  v_add_f32 v193, 1.0, v193
  v_add_f32 v194, 1.0, v194
  v_add_f32 v195, 1.0, v195
  v_add_f32 v196, 1.0, v196
  v_add_f32 v197, 1.0, v197
  v_add_f32 v198, 1.0, v198
  v_add_f32 v199, 1.0, v199
  v_rcp_f32 v192, v192
  v_rcp_f32 v193, v193
  v_rcp_f32 v194, v194
  v_rcp_f32 v195, v195
  v_rcp_f32 v196, v196
  v_rcp_f32 v197, v197
  v_rcp_f32 v198, v198
  v_rcp_f32 v199, v199
  v_mul_f32 v160, v160, v192
  v_mul_f32 v161, v161, v193
  v_mul_f32 v162, v162, v194
  v_mul_f32 v163, v163, v195
  v_mul_f32 v164, v164, v196
  v_mul_f32 v165, v165, v197
  v_mul_f32 v166, v166, v198
  v_mul_f32 v167, v167, v199
  v_cvt_pk_bf16_f32 v160, v160, v161
  v_cvt_pk_bf16_f32 v161, v162, v163
  v_cvt_pk_bf16_f32 v162, v164, v165
  v_cvt_pk_bf16_f32 v163, v166, v167
  buffer_store_dwordx4 v[160:163], v57, s[32:35], 0 offen offset:0 sc1
  v_add_f32 v168, v168, v229
  v_add_f32 v169, v169, v229
  v_add_f32 v170, v170, v229
  v_add_f32 v171, v171, v229
  v_add_f32 v172, v172, v229
  v_add_f32 v173, v173, v229
  v_add_f32 v174, v174, v229
  v_add_f32 v175, v175, v229
  v_mul_f32 v192, s22, v168
  v_mul_f32 v193, s22, v169
  v_mul_f32 v194, s22, v170
  v_mul_f32 v195, s22, v171
  v_mul_f32 v196, s22, v172
  v_mul_f32 v197, s22, v173
  v_mul_f32 v198, s22, v174
  v_mul_f32 v199, s22, v175
  v_exp_f32 v192, v192
  v_exp_f32 v193, v193
  v_exp_f32 v194, v194
  v_exp_f32 v195, v195
  v_exp_f32 v196, v196
  v_exp_f32 v197, v197
  v_exp_f32 v198, v198
  v_exp_f32 v199, v199
  v_add_f32 v192, 1.0, v192
  v_add_f32 v193, 1.0, v193
  v_add_f32 v194, 1.0, v194
  v_add_f32 v195, 1.0, v195
  v_add_f32 v196, 1.0, v196
  v_add_f32 v197, 1.0, v197
  v_add_f32 v198, 1.0, v198
  v_add_f32 v199, 1.0, v199
  v_rcp_f32 v192, v192
  v_rcp_f32 v193, v193
  v_rcp_f32 v194, v194
  v_rcp_f32 v195, v195
  v_rcp_f32 v196, v196
  v_rcp_f32 v197, v197
  v_rcp_f32 v198, v198
  v_rcp_f32 v199, v199
  v_mul_f32 v168, v168, v192
  v_mul_f32 v169, v169, v193
  v_mul_f32 v170, v170, v194
  v_mul_f32 v171, v171, v195
  v_mul_f32 v172, v172, v196
  v_mul_f32 v173, v173, v197
  v_mul_f32 v174, v174, v198
  v_mul_f32 v175, v175, v199
  v_cvt_pk_bf16_f32 v168, v168, v169
  v_cvt_pk_bf16_f32 v169, v170, v171
  v_cvt_pk_bf16_f32 v170, v172, v173
  v_cvt_pk_bf16_f32 v171, v174, v175
  buffer_store_dwordx4 v[168:171], v57, s[32:35], 0 offen offset:1024 sc1
  v_add_f32 v176, v176, v230
  v_add_f32 v177, v177, v230
  v_add_f32 v178, v178, v230
  v_add_f32 v179, v179, v230
  v_add_f32 v180, v180, v230
  v_add_f32 v181, v181, v230
  v_add_f32 v182, v182, v230
  v_add_f32 v183, v183, v230
  v_mul_f32 v192, s22, v176
  v_mul_f32 v193, s22, v177
  v_mul_f32 v194, s22, v178
  v_mul_f32 v195, s22, v179
  v_mul_f32 v196, s22, v180
  v_mul_f32 v197, s22, v181
  v_mul_f32 v198, s22, v182
  v_mul_f32 v199, s22, v183
  v_exp_f32 v192, v192
  v_exp_f32 v193, v193
  v_exp_f32 v194, v194
  v_exp_f32 v195, v195
  v_exp_f32 v196, v196
  v_exp_f32 v197, v197
  v_exp_f32 v198, v198
  v_exp_f32 v199, v199
  v_add_f32 v192, 1.0, v192
  v_add_f32 v193, 1.0, v193
  v_add_f32 v194, 1.0, v194
  v_add_f32 v195, 1.0, v195
  v_add_f32 v196, 1.0, v196
  v_add_f32 v197, 1.0, v197
  v_add_f32 v198, 1.0, v198
  v_add_f32 v199, 1.0, v199
  v_rcp_f32 v192, v192
  v_rcp_f32 v193, v193
  v_rcp_f32 v194, v194
  v_rcp_f32 v195, v195
  v_rcp_f32 v196, v196
  v_rcp_f32 v197, v197
  v_rcp_f32 v198, v198
  v_rcp_f32 v199, v199
  v_mul_f32 v176, v176, v192
  v_mul_f32 v177, v177, v193
  v_mul_f32 v178, v178, v194
  v_mul_f32 v179, v179, v195
  v_mul_f32 v180, v180, v196
  v_mul_f32 v181, v181, v197
  v_mul_f32 v182, v182, v198
  v_mul_f32 v183, v183, v199
  v_cvt_pk_bf16_f32 v176, v176, v177
  v_cvt_pk_bf16_f32 v177, v178, v179
  v_cvt_pk_bf16_f32 v178, v180, v181
  v_cvt_pk_bf16_f32 v179, v182, v183
  buffer_store_dwordx4 v[176:179], v57, s[32:35], 0 offen offset:2048 sc1
  v_add_f32 v184, v184, v231
  v_add_f32 v185, v185, v231
  v_add_f32 v186, v186, v231
  v_add_f32 v187, v187, v231
  v_add_f32 v188, v188, v231
  v_add_f32 v189, v189, v231
  v_add_f32 v190, v190, v231
  v_add_f32 v191, v191, v231
  v_mul_f32 v192, s22, v184
  v_mul_f32 v193, s22, v185
  v_mul_f32 v194, s22, v186
  v_mul_f32 v195, s22, v187
  v_mul_f32 v196, s22, v188
  v_mul_f32 v197, s22, v189
  v_mul_f32 v198, s22, v190
  v_mul_f32 v199, s22, v191
  v_exp_f32 v192, v192
  v_exp_f32 v193, v193
  v_exp_f32 v194, v194
  v_exp_f32 v195, v195
  v_exp_f32 v196, v196
  v_exp_f32 v197, v197
  v_exp_f32 v198, v198
  v_exp_f32 v199, v199
  v_add_f32 v192, 1.0, v192
  v_add_f32 v193, 1.0, v193
  v_add_f32 v194, 1.0, v194
  v_add_f32 v195, 1.0, v195
  v_add_f32 v196, 1.0, v196
  v_add_f32 v197, 1.0, v197
  v_add_f32 v198, 1.0, v198
  v_add_f32 v199, 1.0, v199
  v_rcp_f32 v192, v192
  v_rcp_f32 v193, v193
  v_rcp_f32 v194, v194
  v_rcp_f32 v195, v195
  v_rcp_f32 v196, v196
  v_rcp_f32 v197, v197
  v_rcp_f32 v198, v198
  v_rcp_f32 v199, v199
  v_mul_f32 v184, v184, v192
  v_mul_f32 v185, v185, v193
  v_mul_f32 v186, v186, v194
  v_mul_f32 v187, v187, v195
  v_mul_f32 v188, v188, v196
  v_mul_f32 v189, v189, v197
  v_mul_f32 v190, v190, v198
  v_mul_f32 v191, v191, v199
  v_cvt_pk_bf16_f32 v184, v184, v185
  v_cvt_pk_bf16_f32 v185, v186, v187
  v_cvt_pk_bf16_f32 v186, v188, v189
  v_cvt_pk_bf16_f32 v187, v190, v191
  buffer_store_dwordx4 v[184:187], v57, s[32:35], 0 offen offset:3072 sc1
  s_lshl_b32 s21, s68, 5
  s_add_u32 s21, s21, 24576
  s_waitcnt vmcnt(0) lgkmcnt(0)
  s_barrier
  s_cmp_lg_u32 s16, 0
  s_cbranch_scc1 L_mk2_nopub_48
  v_mov_b32 v1, s21
  v_mov_b32 v56, s42
  s_mov_b64 exec, 1
  buffer_store_dword v56, v1, s[52:55], 0 offen sc1
  s_mov_b64 exec, -1
  s_nop 3
L_mk2_nopub_48:
  s_endpgm
L_poll1:
  s_mov_b32 s64, 0x200000
L_poll1_loop:
  buffer_load_dword v52, v60, s[52:55], 0 offen sc1
  s_waitcnt vmcnt(0)
  v_cmp_ne_u32 vcc, s42, v52
  s_cbranch_vccz L_poll1_done
  s_sleep 1
  s_sub_u32 s64, s64, 1
  s_cmp_lg_u32 s64, 0
  s_cbranch_scc1 L_poll1_loop
L_poll1_done:
  s_setpc_b64 s[48:49]
L_poll4:
  s_mov_b32 s64, 0x200000
L_poll4_loop:
  buffer_load_dword v52, v60, s[52:55], 0 offen sc1
  buffer_load_dword v53, v60, s[52:55], s98 offen sc1
  buffer_load_dword v54, v60, s[52:55], s99 offen sc1
  buffer_load_dword v55, v60, s[52:55], s100 offen sc1
  s_waitcnt vmcnt(0)
  v_xor_b32 v52, s42, v52
  v_xor_b32 v53, s42, v53
  v_xor_b32 v54, s42, v54
  v_xor_b32 v55, s42, v55
  v_or3_b32 v52, v52, v53, v54
  v_or_b32 v52, v52, v55
  v_cmp_ne_u32 vcc, 0, v52
  s_cbranch_vccz L_poll4_done
  s_sleep 1
  s_sub_u32 s64, s64, 1
  s_cmp_lg_u32 s64, 0
  s_cbranch_scc1 L_poll4_loop
L_poll4_done:
  s_setpc_b64 s[48:49]
L_q_rescale0:
  s_nop 15
  v_mov_b32 v36, v30
  v_mov_b32 v37, v31
  s_nop 1
  v_permlane32_swap_b32 v30, v36
  v_permlane32_swap_b32 v31, v37
  s_nop 0
  v_max3_f32 v30, v30, v36, 0
  v_max3_f32 v31, v31, v37, 0
  v_sub_f32 v36, 0, v30
  v_sub_f32 v37, 0, v31
  v_exp_f32 v36, v36
  v_exp_f32 v37, v37
  v_sub_f32 v128, v128, v30
  v_sub_f32 v129, v129, v30
  v_sub_f32 v130, v130, v30
  v_sub_f32 v131, v131, v30
  v_sub_f32 v132, v132, v30
  v_sub_f32 v133, v133, v30
  v_sub_f32 v134, v134, v30
  v_sub_f32 v135, v135, v30
  v_sub_f32 v136, v136, v30
  v_sub_f32 v137, v137, v30
  v_sub_f32 v138, v138, v30
  v_sub_f32 v139, v139, v30
  v_sub_f32 v140, v140, v30
  v_sub_f32 v141, v141, v30
  v_sub_f32 v142, v142, v30
  v_sub_f32 v143, v143, v30
  v_sub_f32 v144, v144, v31
  v_sub_f32 v145, v145, v31
  v_sub_f32 v146, v146, v31
  v_sub_f32 v147, v147, v31
  v_sub_f32 v148, v148, v31
  v_sub_f32 v149, v149, v31
  v_sub_f32 v150, v150, v31
  v_sub_f32 v151, v151, v31
  v_sub_f32 v152, v152, v31
  v_sub_f32 v153, v153, v31
  v_sub_f32 v154, v154, v31
  v_sub_f32 v155, v155, v31
  v_sub_f32 v156, v156, v31
  v_sub_f32 v157, v157, v31
  v_sub_f32 v158, v158, v31
  v_sub_f32 v159, v159, v31
  s_branch L_q_rescale_c
L_q_rescale1:
  s_nop 15
  v_mov_b32 v36, v30
  v_mov_b32 v37, v31
  s_nop 1
  v_permlane32_swap_b32 v30, v36
  v_permlane32_swap_b32 v31, v37
  s_nop 0
  v_max3_f32 v30, v30, v36, 0
  v_max3_f32 v31, v31, v37, 0
  v_sub_f32 v36, 0, v30
  v_sub_f32 v37, 0, v31
  v_exp_f32 v36, v36
  v_exp_f32 v37, v37
  v_sub_f32 v160, v160, v30
  v_sub_f32 v161, v161, v30
  v_sub_f32 v162, v162, v30
  v_sub_f32 v163, v163, v30
  v_sub_f32 v164, v164, v30
  v_sub_f32 v165, v165, v30
  v_sub_f32 v166, v166, v30
  v_sub_f32 v167, v167, v30
  v_sub_f32 v168, v168, v30
  v_sub_f32 v169, v169, v30
  v_sub_f32 v170, v170, v30
  v_sub_f32 v171, v171, v30
  v_sub_f32 v172, v172, v30
  v_sub_f32 v173, v173, v30
  v_sub_f32 v174, v174, v30
  v_sub_f32 v175, v175, v30
  v_sub_f32 v176, v176, v31
  v_sub_f32 v177, v177, v31
  v_sub_f32 v178, v178, v31
  v_sub_f32 v179, v179, v31
  v_sub_f32 v180, v180, v31
  v_sub_f32 v181, v181, v31
  v_sub_f32 v182, v182, v31
  v_sub_f32 v183, v183, v31
  v_sub_f32 v184, v184, v31
  v_sub_f32 v185, v185, v31
  v_sub_f32 v186, v186, v31
  v_sub_f32 v187, v187, v31
  v_sub_f32 v188, v188, v31
  v_sub_f32 v189, v189, v31
  v_sub_f32 v190, v190, v31
  v_sub_f32 v191, v191, v31
  s_branch L_q_rescale_c
L_q_rescale_c:
  v_sub_f32 v192, v192, v30
  v_sub_f32 v193, v193, v30
  v_sub_f32 v194, v194, v30
  v_sub_f32 v195, v195, v30
  v_sub_f32 v196, v196, v30
  v_sub_f32 v197, v197, v30
  v_sub_f32 v198, v198, v30
  v_sub_f32 v199, v199, v30
  v_sub_f32 v200, v200, v30
  v_sub_f32 v201, v201, v30
  v_sub_f32 v202, v202, v30
  v_sub_f32 v203, v203, v30
  v_sub_f32 v204, v204, v30
  v_sub_f32 v205, v205, v30
  v_sub_f32 v206, v206, v30
  v_sub_f32 v207, v207, v30
  v_mul_f32 v28, v28, v36
  v_sub_f32 v208, v208, v31
  v_sub_f32 v209, v209, v31
  v_sub_f32 v210, v210, v31
  v_sub_f32 v211, v211, v31
  v_sub_f32 v212, v212, v31
  v_sub_f32 v213, v213, v31
  v_sub_f32 v214, v214, v31
  v_sub_f32 v215, v215, v31
  v_sub_f32 v216, v216, v31
  v_sub_f32 v217, v217, v31
  v_sub_f32 v218, v218, v31
  v_sub_f32 v219, v219, v31
  v_sub_f32 v220, v220, v31
  v_sub_f32 v221, v221, v31
  v_sub_f32 v222, v222, v31
  v_sub_f32 v223, v223, v31
  v_mul_f32 v29, v29, v37
  v_accvgpr_read_b32 v240, a0
  v_accvgpr_read_b32 v241, a1
  v_accvgpr_read_b32 v242, a2
  v_accvgpr_read_b32 v243, a3
  v_accvgpr_read_b32 v244, a4
  v_accvgpr_read_b32 v245, a5
  v_accvgpr_read_b32 v246, a6
  v_accvgpr_read_b32 v247, a7
  v_accvgpr_read_b32 v248, a8
  v_accvgpr_read_b32 v249, a9
  v_accvgpr_read_b32 v250, a10
  v_accvgpr_read_b32 v251, a11
  v_accvgpr_read_b32 v252, a12
  v_accvgpr_read_b32 v253, a13
  v_accvgpr_read_b32 v254, a14
  v_accvgpr_read_b32 v255, a15
  v_mul_f32 v240, v240, v36
  v_mul_f32 v241, v241, v36
  v_mul_f32 v242, v242, v36
  v_mul_f32 v243, v243, v36
  v_mul_f32 v244, v244, v36
  v_mul_f32 v245, v245, v36
  v_mul_f32 v246, v246, v36
  v_mul_f32 v247, v247, v36
  v_mul_f32 v248, v248, v36
  v_mul_f32 v249, v249, v36
  v_mul_f32 v250, v250, v36
  v_mul_f32 v251, v251, v36
  v_mul_f32 v252, v252, v36
  v_mul_f32 v253, v253, v36
  v_mul_f32 v254, v254, v36
  v_mul_f32 v255, v255, v36
  v_accvgpr_write_b32 a0, v240
  v_accvgpr_write_b32 a1, v241
  v_accvgpr_write_b32 a2, v242
  v_accvgpr_write_b32 a3, v243
  v_accvgpr_write_b32 a4, v244
  v_accvgpr_write_b32 a5, v245
  v_accvgpr_write_b32 a6, v246
  v_accvgpr_write_b32 a7, v247
  v_accvgpr_write_b32 a8, v248
  v_accvgpr_write_b32 a9, v249
  v_accvgpr_write_b32 a10, v250
  v_accvgpr_write_b32 a11, v251
  v_accvgpr_write_b32 a12, v252
  v_accvgpr_write_b32 a13, v253
  v_accvgpr_write_b32 a14, v254
  v_accvgpr_write_b32 a15, v255
  v_accvgpr_read_b32 v240, a16
  v_accvgpr_read_b32 v241, a17
  v_accvgpr_read_b32 v242, a18
  v_accvgpr_read_b32 v243, a19
  v_accvgpr_read_b32 v244, a20
  v_accvgpr_read_b32 v245, a21
  v_accvgpr_read_b32 v246, a22
  v_accvgpr_read_b32 v247, a23
  v_accvgpr_read_b32 v248, a24
  v_accvgpr_read_b32 v249, a25
  v_accvgpr_read_b32 v250, a26
  v_accvgpr_read_b32 v251, a27
  v_accvgpr_read_b32 v252, a28
  v_accvgpr_read_b32 v253, a29
  v_accvgpr_read_b32 v254, a30
  v_accvgpr_read_b32 v255, a31
  v_mul_f32 v240, v240, v37
  v_mul_f32 v241, v241, v37
  v_mul_f32 v242, v242, v37
  v_mul_f32 v243, v243, v37
  v_mul_f32 v244, v244, v37
  v_mul_f32 v245, v245, v37
  v_mul_f32 v246, v246, v37
  v_mul_f32 v247, v247, v37
  v_mul_f32 v248, v248, v37
  v_mul_f32 v249, v249, v37
  v_mul_f32 v250, v250, v37
  v_mul_f32 v251, v251, v37
  v_mul_f32 v252, v252, v37
  v_mul_f32 v253, v253, v37
  v_mul_f32 v254, v254, v37
  v_mul_f32 v255, v255, v37
  v_accvgpr_write_b32 a16, v240
  v_accvgpr_write_b32 a17, v241
  v_accvgpr_write_b32 a18, v242
  v_accvgpr_write_b32 a19, v243
  v_accvgpr_write_b32 a20, v244
  v_accvgpr_write_b32 a21, v245
  v_accvgpr_write_b32 a22, v246
  v_accvgpr_write_b32 a23, v247
  v_accvgpr_write_b32 a24, v248
  v_accvgpr_write_b32 a25, v249
  v_accvgpr_write_b32 a26, v250
  v_accvgpr_write_b32 a27, v251
  v_accvgpr_write_b32 a28, v252
  v_accvgpr_write_b32 a29, v253
  v_accvgpr_write_b32 a30, v254
  v_accvgpr_write_b32 a31, v255
  v_accvgpr_read_b32 v240, a32
  v_accvgpr_read_b32 v241, a33
  v_accvgpr_read_b32 v242, a34
  v_accvgpr_read_b32 v243, a35
  v_accvgpr_read_b32 v244, a36
  v_accvgpr_read_b32 v245, a37
  v_accvgpr_read_b32 v246, a38
  v_accvgpr_read_b32 v247, a39
  v_accvgpr_read_b32 v248, a40
  v_accvgpr_read_b32 v249, a41
  v_accvgpr_read_b32 v250, a42
  v_accvgpr_read_b32 v251, a43
  v_accvgpr_read_b32 v252, a44
  v_accvgpr_read_b32 v253, a45
  v_accvgpr_read_b32 v254, a46
  v_accvgpr_read_b32 v255, a47
  v_mul_f32 v240, v240, v36
  v_mul_f32 v241, v241, v36
  v_mul_f32 v242, v242, v36
  v_mul_f32 v243, v243, v36
  v_mul_f32 v244, v244, v36
  v_mul_f32 v245, v245, v36
  v_mul_f32 v246, v246, v36
  v_mul_f32 v247, v247, v36
  v_mul_f32 v248, v248, v36
  v_mul_f32 v249, v249, v36
  v_mul_f32 v250, v250, v36
  v_mul_f32 v251, v251, v36
  v_mul_f32 v252, v252, v36
  v_mul_f32 v253, v253, v36
  v_mul_f32 v254, v254, v36
  v_mul_f32 v255, v255, v36
  v_accvgpr_write_b32 a32, v240
  v_accvgpr_write_b32 a33, v241
  v_accvgpr_write_b32 a34, v242
  v_accvgpr_write_b32 a35, v243
  v_accvgpr_write_b32 a36, v244
  v_accvgpr_write_b32 a37, v245
  v_accvgpr_write_b32 a38, v246
  v_accvgpr_write_b32 a39, v247
  v_accvgpr_write_b32 a40, v248
  v_accvgpr_write_b32 a41, v249
  v_accvgpr_write_b32 a42, v250
  v_accvgpr_write_b32 a43, v251
  v_accvgpr_write_b32 a44, v252
  v_accvgpr_write_b32 a45, v253
  v_accvgpr_write_b32 a46, v254
  v_accvgpr_write_b32 a47, v255
  v_accvgpr_read_b32 v240, a48
  v_accvgpr_read_b32 v241, a49
  v_accvgpr_read_b32 v242, a50
  v_accvgpr_read_b32 v243, a51
  v_accvgpr_read_b32 v244, a52
  v_accvgpr_read_b32 v245, a53
  v_accvgpr_read_b32 v246, a54
  v_accvgpr_read_b32 v247, a55
  v_accvgpr_read_b32 v248, a56
  v_accvgpr_read_b32 v249, a57
  v_accvgpr_read_b32 v250, a58
  v_accvgpr_read_b32 v251, a59
  v_accvgpr_read_b32 v252, a60
  v_accvgpr_read_b32 v253, a61
  v_accvgpr_read_b32 v254, a62
  v_accvgpr_read_b32 v255, a63
  v_mul_f32 v240, v240, v37
  v_mul_f32 v241, v241, v37
  v_mul_f32 v242, v242, v37
  v_mul_f32 v243, v243, v37
  v_mul_f32 v244, v244, v37
  v_mul_f32 v245, v245, v37
  v_mul_f32 v246, v246, v37
  v_mul_f32 v247, v247, v37
  v_mul_f32 v248, v248, v37
  v_mul_f32 v249, v249, v37
  v_mul_f32 v250, v250, v37
  v_mul_f32 v251, v251, v37
  v_mul_f32 v252, v252, v37
  v_mul_f32 v253, v253, v37
  v_mul_f32 v254, v254, v37
  v_mul_f32 v255, v255, v37
  v_accvgpr_write_b32 a48, v240
  v_accvgpr_write_b32 a49, v241
  v_accvgpr_write_b32 a50, v242
  v_accvgpr_write_b32 a51, v243
  v_accvgpr_write_b32 a52, v244
  v_accvgpr_write_b32 a53, v245
  v_accvgpr_write_b32 a54, v246
  v_accvgpr_write_b32 a55, v247
  v_accvgpr_write_b32 a56, v248
  v_accvgpr_write_b32 a57, v249
  v_accvgpr_write_b32 a58, v250
  v_accvgpr_write_b32 a59, v251
  v_accvgpr_write_b32 a60, v252
  v_accvgpr_write_b32 a61, v253
  v_accvgpr_write_b32 a62, v254
  v_accvgpr_write_b32 a63, v255
  v_accvgpr_read_b32 v240, a64
  v_accvgpr_read_b32 v241, a65
  v_accvgpr_read_b32 v242, a66
  v_accvgpr_read_b32 v243, a67
  v_accvgpr_read_b32 v244, a68
  v_accvgpr_read_b32 v245, a69
  v_accvgpr_read_b32 v246, a70
  v_accvgpr_read_b32 v247, a71
  v_accvgpr_read_b32 v248, a72
  v_accvgpr_read_b32 v249, a73
  v_accvgpr_read_b32 v250, a74
  v_accvgpr_read_b32 v251, a75
  v_accvgpr_read_b32 v252, a76
  v_accvgpr_read_b32 v253, a77
  v_accvgpr_read_b32 v254, a78
  v_accvgpr_read_b32 v255, a79
  v_mul_f32 v240, v240, v36
  v_mul_f32 v241, v241, v36
  v_mul_f32 v242, v242, v36
  v_mul_f32 v243, v243, v36
  v_mul_f32 v244, v244, v36
  v_mul_f32 v245, v245, v36
  v_mul_f32 v246, v246, v36
  v_mul_f32 v247, v247, v36
  v_mul_f32 v248, v248, v36
  v_mul_f32 v249, v249, v36
  v_mul_f32 v250, v250, v36
  v_mul_f32 v251, v251, v36
  v_mul_f32 v252, v252, v36
  v_mul_f32 v253, v253, v36
  v_mul_f32 v254, v254, v36
  v_mul_f32 v255, v255, v36
  v_accvgpr_write_b32 a64, v240
  v_accvgpr_write_b32 a65, v241
  v_accvgpr_write_b32 a66, v242
  v_accvgpr_write_b32 a67, v243
  v_accvgpr_write_b32 a68, v244
  v_accvgpr_write_b32 a69, v245
  v_accvgpr_write_b32 a70, v246
  v_accvgpr_write_b32 a71, v247
  v_accvgpr_write_b32 a72, v248
  v_accvgpr_write_b32 a73, v249
  v_accvgpr_write_b32 a74, v250
  v_accvgpr_write_b32 a75, v251
  v_accvgpr_write_b32 a76, v252
  v_accvgpr_write_b32 a77, v253
  v_accvgpr_write_b32 a78, v254
  v_accvgpr_write_b32 a79, v255
  v_accvgpr_read_b32 v240, a80
  v_accvgpr_read_b32 v241, a81
  v_accvgpr_read_b32 v242, a82
  v_accvgpr_read_b32 v243, a83
  v_accvgpr_read_b32 v244, a84
  v_accvgpr_read_b32 v245, a85
  v_accvgpr_read_b32 v246, a86
  v_accvgpr_read_b32 v247, a87
  v_accvgpr_read_b32 v248, a88
  v_accvgpr_read_b32 v249, a89
  v_accvgpr_read_b32 v250, a90
  v_accvgpr_read_b32 v251, a91
  v_accvgpr_read_b32 v252, a92
  v_accvgpr_read_b32 v253, a93
  v_accvgpr_read_b32 v254, a94
  v_accvgpr_read_b32 v255, a95
  v_mul_f32 v240, v240, v37
  v_mul_f32 v241, v241, v37
  v_mul_f32 v242, v242, v37
  v_mul_f32 v243, v243, v37
  v_mul_f32 v244, v244, v37
  v_mul_f32 v245, v245, v37
  v_mul_f32 v246, v246, v37
  v_mul_f32 v247, v247, v37
  v_mul_f32 v248, v248, v37
  v_mul_f32 v249, v249, v37
  v_mul_f32 v250, v250, v37
  v_mul_f32 v251, v251, v37
  v_mul_f32 v252, v252, v37
  v_mul_f32 v253, v253, v37
  v_mul_f32 v254, v254, v37
  v_mul_f32 v255, v255, v37
  v_accvgpr_write_b32 a80, v240
  v_accvgpr_write_b32 a81, v241
  v_accvgpr_write_b32 a82, v242
  v_accvgpr_write_b32 a83, v243
  v_accvgpr_write_b32 a84, v244
  v_accvgpr_write_b32 a85, v245
  v_accvgpr_write_b32 a86, v246
  v_accvgpr_write_b32 a87, v247
  v_accvgpr_write_b32 a88, v248
  v_accvgpr_write_b32 a89, v249
  v_accvgpr_write_b32 a90, v250
  v_accvgpr_write_b32 a91, v251
  v_accvgpr_write_b32 a92, v252
  v_accvgpr_write_b32 a93, v253
  v_accvgpr_write_b32 a94, v254
  v_accvgpr_write_b32 a95, v255
  v_accvgpr_read_b32 v240, a96
  v_accvgpr_read_b32 v241, a97
  v_accvgpr_read_b32 v242, a98
  v_accvgpr_read_b32 v243, a99
  v_accvgpr_read_b32 v244, a100
  v_accvgpr_read_b32 v245, a101
  v_accvgpr_read_b32 v246, a102
  v_accvgpr_read_b32 v247, a103
  v_accvgpr_read_b32 v248, a104
  v_accvgpr_read_b32 v249, a105
  v_accvgpr_read_b32 v250, a106
  v_accvgpr_read_b32 v251, a107
  v_accvgpr_read_b32 v252, a108
  v_accvgpr_read_b32 v253, a109
  v_accvgpr_read_b32 v254, a110
  v_accvgpr_read_b32 v255, a111
  v_mul_f32 v240, v240, v36
  v_mul_f32 v241, v241, v36
  v_mul_f32 v242, v242, v36
  v_mul_f32 v243, v243, v36
  v_mul_f32 v244, v244, v36
  v_mul_f32 v245, v245, v36
  v_mul_f32 v246, v246, v36
  v_mul_f32 v247, v247, v36
  v_mul_f32 v248, v248, v36
  v_mul_f32 v249, v249, v36
  v_mul_f32 v250, v250, v36
  v_mul_f32 v251, v251, v36
  v_mul_f32 v252, v252, v36
  v_mul_f32 v253, v253, v36
  v_mul_f32 v254, v254, v36
  v_mul_f32 v255, v255, v36
  v_accvgpr_write_b32 a96, v240
  v_accvgpr_write_b32 a97, v241
  v_accvgpr_write_b32 a98, v242
  v_accvgpr_write_b32 a99, v243
  v_accvgpr_write_b32 a100, v244
  v_accvgpr_write_b32 a101, v245
  v_accvgpr_write_b32 a102, v246
  v_accvgpr_write_b32 a103, v247
  v_accvgpr_write_b32 a104, v248
  v_accvgpr_write_b32 a105, v249
  v_accvgpr_write_b32 a106, v250
  v_accvgpr_write_b32 a107, v251
  v_accvgpr_write_b32 a108, v252
  v_accvgpr_write_b32 a109, v253
  v_accvgpr_write_b32 a110, v254
  v_accvgpr_write_b32 a111, v255
  v_accvgpr_read_b32 v240, a112
  v_accvgpr_read_b32 v241, a113
  v_accvgpr_read_b32 v242, a114
  v_accvgpr_read_b32 v243, a115
  v_accvgpr_read_b32 v244, a116
  v_accvgpr_read_b32 v245, a117
  v_accvgpr_read_b32 v246, a118
  v_accvgpr_read_b32 v247, a119
  v_accvgpr_read_b32 v248, a120
  v_accvgpr_read_b32 v249, a121
  v_accvgpr_read_b32 v250, a122
  v_accvgpr_read_b32 v251, a123
  v_accvgpr_read_b32 v252, a124
  v_accvgpr_read_b32 v253, a125
  v_accvgpr_read_b32 v254, a126
  v_accvgpr_read_b32 v255, a127
  v_mul_f32 v240, v240, v37
  v_mul_f32 v241, v241, v37
  v_mul_f32 v242, v242, v37
  v_mul_f32 v243, v243, v37
  v_mul_f32 v244, v244, v37
  v_mul_f32 v245, v245, v37
  v_mul_f32 v246, v246, v37
  v_mul_f32 v247, v247, v37
  v_mul_f32 v248, v248, v37
  v_mul_f32 v249, v249, v37
  v_mul_f32 v250, v250, v37
  v_mul_f32 v251, v251, v37
  v_mul_f32 v252, v252, v37
  v_mul_f32 v253, v253, v37
  v_mul_f32 v254, v254, v37
  v_mul_f32 v255, v255, v37
  v_accvgpr_write_b32 a112, v240
  v_accvgpr_write_b32 a113, v241
  v_accvgpr_write_b32 a114, v242
  v_accvgpr_write_b32 a115, v243
  v_accvgpr_write_b32 a116, v244
  v_accvgpr_write_b32 a117, v245
  v_accvgpr_write_b32 a118, v246
  v_accvgpr_write_b32 a119, v247
  v_accvgpr_write_b32 a120, v248
  v_accvgpr_write_b32 a121, v249
  v_accvgpr_write_b32 a122, v250
  v_accvgpr_write_b32 a123, v251
  v_accvgpr_write_b32 a124, v252
  v_accvgpr_write_b32 a125, v253
  v_accvgpr_write_b32 a126, v254
  v_accvgpr_write_b32 a127, v255
  s_nop 3
  s_setpc_b64 s[48:49]
L_c1:
  s_mov_b32 s60, s86
  s_and_b32 s61, s87, 0xffff
  s_mov_b32 s62, 7168
  s_mov_b32 s63, 0x00020000
  v_lshlrev_b32 v1, 3, v34
  s_lshl_b32 s23, s71, 1
  buffer_load_dwordx2 v[112:113], v1, s[60:63], s23 offen offset:0
  buffer_load_dwordx2 v[114:115], v1, s[60:63], s23 offen offset:32
  buffer_load_dwordx2 v[116:117], v1, s[60:63], s23 offen offset:64
  buffer_load_dwordx2 v[118:119], v1, s[60:63], s23 offen offset:96
  buffer_load_dwordx2 v[120:121], v1, s[60:63], s23 offen offset:128
  buffer_load_dwordx2 v[122:123], v1, s[60:63], s23 offen offset:160
  s_add_u32 m0, s19, 32768
  s_nop 0
  buffer_load_dwordx4 v4, s[8:11], s17 offen offset:0 lds
  buffer_load_dwordx4 v5, s[8:11], s17 offen offset:1024 lds
  buffer_load_dwordx4 v6, s[8:11], s17 offen offset:2048 lds
  buffer_load_dwordx4 v7, s[8:11], s17 offen offset:3072 lds
  s_add_u32 s17, s17, 458752
  s_cmp_eq_u32 s17, 14680064
  s_cselect_b32 s17, 0, s17
  s_add_u32 m0, s19, 49152
  s_nop 0
  buffer_load_dwordx4 v4, s[8:11], s17 offen offset:0 lds
  buffer_load_dwordx4 v5, s[8:11], s17 offen offset:1024 lds
  buffer_load_dwordx4 v6, s[8:11], s17 offen offset:2048 lds
  buffer_load_dwordx4 v7, s[8:11], s17 offen offset:3072 lds
  s_add_u32 s17, s17, 458752
  s_cmp_eq_u32 s17, 14680064
  s_cselect_b32 s17, 0, s17
  s_add_u32 m0, s19, 65536
  s_nop 0
  buffer_load_dwordx4 v4, s[8:11], s17 offen offset:0 lds
  buffer_load_dwordx4 v5, s[8:11], s17 offen offset:1024 lds
  buffer_load_dwordx4 v6, s[8:11], s17 offen offset:2048 lds
  buffer_load_dwordx4 v7, s[8:11], s17 offen offset:3072 lds
  s_add_u32 s17, s17, 458752
  s_cmp_eq_u32 s17, 14680064
  s_cselect_b32 s17, 0, s17
  s_add_u32 m0, s19, 81920
  s_nop 0
  buffer_load_dwordx4 v4, s[8:11], s17 offen offset:0 lds
  buffer_load_dwordx4 v5, s[8:11], s17 offen offset:1024 lds
  buffer_load_dwordx4 v6, s[8:11], s17 offen offset:2048 lds
  buffer_load_dwordx4 v7, s[8:11], s17 offen offset:3072 lds
  s_add_u32 s17, s17, 458752
  s_cmp_eq_u32 s17, 14680064
  s_cselect_b32 s17, 0, s17
  v_lshlrev_b32 v60, 5, v2
  v_add_u32 v208, 0x10000, v8
  v_add_u32 v209, 0x10000, v9
  v_add_u32 v210, 0x10000, v10
  v_add_u32 v211, 0x10000, v11
  v_add_u32 v212, 0x10000, v40
  v_add_u32 v213, 0x10000, v41
  v_add_u32 v214, 0x10000, v42
  v_add_u32 v215, 0x10000, v43
  s_waitcnt vmcnt(21)
  v_lshlrev_b32 v64, 16, v112
  v_and_b32 v65, 0xffff0000, v112
  v_lshlrev_b32 v66, 16, v113
  v_and_b32 v67, 0xffff0000, v113
  v_lshlrev_b32 v72, 16, v112
  v_and_b32 v73, 0xffff0000, v112
  v_lshlrev_b32 v74, 16, v113
  v_and_b32 v75, 0xffff0000, v113
  s_waitcnt vmcnt(20)
  v_lshlrev_b32 v68, 16, v114
  v_and_b32 v69, 0xffff0000, v114
  v_lshlrev_b32 v70, 16, v115
  v_and_b32 v71, 0xffff0000, v115
  v_lshlrev_b32 v76, 16, v114
  v_and_b32 v77, 0xffff0000, v114
  v_lshlrev_b32 v78, 16, v115
  v_and_b32 v79, 0xffff0000, v115
  s_waitcnt vmcnt(19)
  v_lshlrev_b32 v80, 16, v116
  v_and_b32 v81, 0xffff0000, v116
  v_lshlrev_b32 v82, 16, v117
  v_and_b32 v83, 0xffff0000, v117
  v_lshlrev_b32 v88, 16, v116
  v_and_b32 v89, 0xffff0000, v116
  v_lshlrev_b32 v90, 16, v117
  v_and_b32 v91, 0xffff0000, v117
  s_waitcnt vmcnt(18)
  v_lshlrev_b32 v84, 16, v118
  v_and_b32 v85, 0xffff0000, v118
  v_lshlrev_b32 v86, 16, v119
  v_and_b32 v87, 0xffff0000, v119
  v_lshlrev_b32 v92, 16, v118
  v_and_b32 v93, 0xffff0000, v118
  v_lshlrev_b32 v94, 16, v119
  v_and_b32 v95, 0xffff0000, v119
  s_waitcnt vmcnt(17)
  v_lshlrev_b32 v96, 16, v120
  v_and_b32 v97, 0xffff0000, v120
  v_lshlrev_b32 v98, 16, v121
  v_and_b32 v99, 0xffff0000, v121
  v_lshlrev_b32 v104, 16, v120
  v_and_b32 v105, 0xffff0000, v120
  v_lshlrev_b32 v106, 16, v121
  v_and_b32 v107, 0xffff0000, v121
  s_waitcnt vmcnt(16)
  v_lshlrev_b32 v100, 16, v122
  v_and_b32 v101, 0xffff0000, v122
  v_lshlrev_b32 v102, 16, v123
  v_and_b32 v103, 0xffff0000, v123
  v_lshlrev_b32 v108, 16, v122
  v_and_b32 v109, 0xffff0000, v122
  v_lshlrev_b32 v110, 16, v123
  v_and_b32 v111, 0xffff0000, v123
  v_readfirstlane_b32 s42, v61
  s_cmp_lg_u32 s16, 0
  s_cbranch_scc1 L_mk5_wp_1
  s_call_b64 s[48:49], L_poll4
L_mk5_wp_1:
  s_barrier
  buffer_load_dwordx4 a[128:131], v3, s[12:15], s18 offen offset:0 sc1
  buffer_load_dwordx4 a[132:135], v3, s[12:15], s18 offen offset:1024 sc1
  buffer_load_dwordx4 a[136:139], v3, s[12:15], s18 offen offset:2048 sc1
  buffer_load_dwordx4 a[140:143], v3, s[12:15], s18 offen offset:3072 sc1
  s_add_u32 s18, s18, 4096
  s_cmp_eq_u32 s18, 131072
  s_cselect_b32 s18, 0, s18
  buffer_load_dwordx4 a[144:147], v3, s[12:15], s18 offen offset:0 sc1
  buffer_load_dwordx4 a[148:151], v3, s[12:15], s18 offen offset:1024 sc1
  buffer_load_dwordx4 a[152:155], v3, s[12:15], s18 offen offset:2048 sc1
  buffer_load_dwordx4 a[156:159], v3, s[12:15], s18 offen offset:3072 sc1
  s_add_u32 s18, s18, 4096
  s_cmp_eq_u32 s18, 131072
  s_cselect_b32 s18, 0, s18
  buffer_load_dwordx4 a[160:163], v3, s[12:15], s18 offen offset:0 sc1
  buffer_load_dwordx4 a[164:167], v3, s[12:15], s18 offen offset:1024 sc1
  buffer_load_dwordx4 a[168:171], v3, s[12:15], s18 offen offset:2048 sc1
  buffer_load_dwordx4 a[172:175], v3, s[12:15], s18 offen offset:3072 sc1
  s_add_u32 s18, s18, 4096
  s_cmp_eq_u32 s18, 131072
  s_cselect_b32 s18, 0, s18
  buffer_load_dwordx4 a[176:179], v3, s[12:15], s18 offen offset:0 sc1
  buffer_load_dwordx4 a[180:183], v3, s[12:15], s18 offen offset:1024 sc1
  ds_read_b64_tr_b16 a[192:193], v8 offset:0
  ds_read_b64_tr_b16 a[194:195], v8 offset:4096
  ds_read_b64_tr_b16 a[196:197], v9 offset:0
  ds_read_b64_tr_b16 a[198:199], v9 offset:4096
  ds_read_b64_tr_b16 a[200:201], v10 offset:0
  ds_read_b64_tr_b16 a[202:203], v10 offset:4096
  ds_read_b64_tr_b16 a[204:205], v11 offset:0
  ds_read_b64_tr_b16 a[206:207], v11 offset:4096
  ds_read_b64_tr_b16 a[208:209], v40 offset:0
  ds_read_b64_tr_b16 a[210:211], v40 offset:4096
  ds_read_b64_tr_b16 a[212:213], v41 offset:0
  ds_read_b64_tr_b16 a[214:215], v41 offset:4096
  s_mov_b32 s20, 3
L_mk5_m_2:
  s_waitcnt vmcnt(12) lgkmcnt(8)
  v_mfma_f32_16x16x32_bf16 v[64:67], a[192:195], a[128:131], v[64:67]
  ds_read_b64_tr_b16 a[216:217], v8 offset:8192
  ds_read_b64_tr_b16 a[218:219], v8 offset:12288
  v_mfma_f32_16x16x32_bf16 v[72:75], a[192:195], a[132:135], v[72:75]
  buffer_load_dwordx4 a[184:187], v3, s[12:15], s18 offen offset:2048 sc1
  v_mfma_f32_16x16x32_bf16 v[68:71], a[196:199], a[128:131], v[68:71]
  ds_read_b64_tr_b16 a[220:221], v9 offset:8192
  ds_read_b64_tr_b16 a[222:223], v9 offset:12288
  v_mfma_f32_16x16x32_bf16 v[76:79], a[196:199], a[132:135], v[76:79]
  buffer_load_dwordx4 a[188:191], v3, s[12:15], s18 offen offset:3072 sc1
  s_add_u32 s18, s18, 4096
  s_cmp_eq_u32 s18, 131072
  s_cselect_b32 s18, 0, s18
  s_waitcnt lgkmcnt(8)
  v_mfma_f32_16x16x32_bf16 v[80:83], a[200:203], a[128:131], v[80:83]
  ds_read_b64_tr_b16 a[192:193], v10 offset:8192
  ds_read_b64_tr_b16 a[194:195], v10 offset:12288
  v_mfma_f32_16x16x32_bf16 v[88:91], a[200:203], a[132:135], v[88:91]
  s_add_u32 m0, s19, 98304
  v_mfma_f32_16x16x32_bf16 v[84:87], a[204:207], a[128:131], v[84:87]
  ds_read_b64_tr_b16 a[196:197], v11 offset:8192
  ds_read_b64_tr_b16 a[198:199], v11 offset:12288
  v_mfma_f32_16x16x32_bf16 v[92:95], a[204:207], a[132:135], v[92:95]
  buffer_load_dwordx4 v4, s[8:11], s17 offen offset:0 lds
  s_waitcnt lgkmcnt(8)
  v_mfma_f32_16x16x32_bf16 v[96:99], a[208:211], a[128:131], v[96:99]
  ds_read_b64_tr_b16 a[200:201], v40 offset:8192
  ds_read_b64_tr_b16 a[202:203], v40 offset:12288
  v_mfma_f32_16x16x32_bf16 v[104:107], a[208:211], a[132:135], v[104:107]
  buffer_load_dwordx4 v5, s[8:11], s17 offen offset:1024 lds
  v_mfma_f32_16x16x32_bf16 v[100:103], a[212:215], a[128:131], v[100:103]
  ds_read_b64_tr_b16 a[204:205], v41 offset:8192
  ds_read_b64_tr_b16 a[206:207], v41 offset:12288
  v_mfma_f32_16x16x32_bf16 v[108:111], a[212:215], a[132:135], v[108:111]
  buffer_load_dwordx4 v6, s[8:11], s17 offen offset:2048 lds
  s_waitcnt vmcnt(15) lgkmcnt(8)
  v_mfma_f32_16x16x32_bf16 v[64:67], a[216:219], a[136:139], v[64:67]
  s_barrier
  ds_read_b64_tr_b16 a[208:209], v8 offset:16384
  ds_read_b64_tr_b16 a[210:211], v8 offset:20480
  v_mfma_f32_16x16x32_bf16 v[72:75], a[216:219], a[140:143], v[72:75]
  v_mfma_f32_16x16x32_bf16 v[68:71], a[220:223], a[136:139], v[68:71]
  ds_read_b64_tr_b16 a[212:213], v9 offset:16384
  ds_read_b64_tr_b16 a[214:215], v9 offset:20480
  v_mfma_f32_16x16x32_bf16 v[76:79], a[220:223], a[140:143], v[76:79]
  buffer_load_dwordx4 v7, s[8:11], s17 offen offset:3072 lds
  s_add_u32 s17, s17, 458752
  s_cmp_eq_u32 s17, 14680064
  s_cselect_b32 s17, 0, s17
  s_waitcnt lgkmcnt(8)
  v_mfma_f32_16x16x32_bf16 v[80:83], a[192:195], a[136:139], v[80:83]
  ds_read_b64_tr_b16 a[216:217], v10 offset:16384
  ds_read_b64_tr_b16 a[218:219], v10 offset:20480
  v_mfma_f32_16x16x32_bf16 v[88:91], a[192:195], a[140:143], v[88:91]
  buffer_load_dwordx4 a[128:131], v3, s[12:15], s18 offen offset:0 sc1
  v_mfma_f32_16x16x32_bf16 v[84:87], a[196:199], a[136:139], v[84:87]
  ds_read_b64_tr_b16 a[220:221], v11 offset:16384
  ds_read_b64_tr_b16 a[222:223], v11 offset:20480
  v_mfma_f32_16x16x32_bf16 v[92:95], a[196:199], a[140:143], v[92:95]
  buffer_load_dwordx4 a[132:135], v3, s[12:15], s18 offen offset:1024 sc1
  s_waitcnt lgkmcnt(8)
  v_mfma_f32_16x16x32_bf16 v[96:99], a[200:203], a[136:139], v[96:99]
  ds_read_b64_tr_b16 a[192:193], v40 offset:16384
  ds_read_b64_tr_b16 a[194:195], v40 offset:20480
  v_mfma_f32_16x16x32_bf16 v[104:107], a[200:203], a[140:143], v[104:107]
  v_mfma_f32_16x16x32_bf16 v[100:103], a[204:207], a[136:139], v[100:103]
  ds_read_b64_tr_b16 a[196:197], v41 offset:16384
  ds_read_b64_tr_b16 a[198:199], v41 offset:20480
  v_mfma_f32_16x16x32_bf16 v[108:111], a[204:207], a[140:143], v[108:111]
  s_waitcnt vmcnt(16) lgkmcnt(8)
  v_mfma_f32_16x16x32_bf16 v[64:67], a[208:211], a[144:147], v[64:67]
  ds_read_b64_tr_b16 a[200:201], v8 offset:24576
  ds_read_b64_tr_b16 a[202:203], v8 offset:28672
  v_mfma_f32_16x16x32_bf16 v[72:75], a[208:211], a[148:151], v[72:75]
  buffer_load_dwordx4 a[136:139], v3, s[12:15], s18 offen offset:2048 sc1
  v_mfma_f32_16x16x32_bf16 v[68:71], a[212:215], a[144:147], v[68:71]
  ds_read_b64_tr_b16 a[204:205], v9 offset:24576
  ds_read_b64_tr_b16 a[206:207], v9 offset:28672
  v_mfma_f32_16x16x32_bf16 v[76:79], a[212:215], a[148:151], v[76:79]
  buffer_load_dwordx4 a[140:143], v3, s[12:15], s18 offen offset:3072 sc1
  s_add_u32 s18, s18, 4096
  s_cmp_eq_u32 s18, 131072
  s_cselect_b32 s18, 0, s18
  s_waitcnt lgkmcnt(8)
  v_mfma_f32_16x16x32_bf16 v[80:83], a[216:219], a[144:147], v[80:83]
  ds_read_b64_tr_b16 a[208:209], v10 offset:24576
  ds_read_b64_tr_b16 a[210:211], v10 offset:28672
  v_mfma_f32_16x16x32_bf16 v[88:91], a[216:219], a[148:151], v[88:91]
  s_add_u32 m0, s19, 114688
  v_mfma_f32_16x16x32_bf16 v[84:87], a[220:223], a[144:147], v[84:87]
  ds_read_b64_tr_b16 a[212:213], v11 offset:24576
  ds_read_b64_tr_b16 a[214:215], v11 offset:28672
  v_mfma_f32_16x16x32_bf16 v[92:95], a[220:223], a[148:151], v[92:95]
  buffer_load_dwordx4 v4, s[8:11], s17 offen offset:0 lds
  s_waitcnt lgkmcnt(8)
  v_mfma_f32_16x16x32_bf16 v[96:99], a[192:195], a[144:147], v[96:99]
  ds_read_b64_tr_b16 a[216:217], v40 offset:24576
  ds_read_b64_tr_b16 a[218:219], v40 offset:28672
  v_mfma_f32_16x16x32_bf16 v[104:107], a[192:195], a[148:151], v[104:107]
  buffer_load_dwordx4 v5, s[8:11], s17 offen offset:1024 lds
  v_mfma_f32_16x16x32_bf16 v[100:103], a[196:199], a[144:147], v[100:103]
  ds_read_b64_tr_b16 a[220:221], v41 offset:24576
  ds_read_b64_tr_b16 a[222:223], v41 offset:28672
  v_mfma_f32_16x16x32_bf16 v[108:111], a[196:199], a[148:151], v[108:111]
  buffer_load_dwordx4 v6, s[8:11], s17 offen offset:2048 lds
  s_waitcnt vmcnt(19) lgkmcnt(8)
  v_mfma_f32_16x16x32_bf16 v[64:67], a[200:203], a[152:155], v[64:67]
  s_barrier
  ds_read_b64_tr_b16 a[192:193], v8 offset:32768
  ds_read_b64_tr_b16 a[194:195], v8 offset:36864
  v_mfma_f32_16x16x32_bf16 v[72:75], a[200:203], a[156:159], v[72:75]
  v_mfma_f32_16x16x32_bf16 v[68:71], a[204:207], a[152:155], v[68:71]
  ds_read_b64_tr_b16 a[196:197], v9 offset:32768
  ds_read_b64_tr_b16 a[198:199], v9 offset:36864
  v_mfma_f32_16x16x32_bf16 v[76:79], a[204:207], a[156:159], v[76:79]
  buffer_load_dwordx4 v7, s[8:11], s17 offen offset:3072 lds
  s_add_u32 s17, s17, 458752
  s_cmp_eq_u32 s17, 14680064
  s_cselect_b32 s17, 0, s17
  s_waitcnt lgkmcnt(8)
  v_mfma_f32_16x16x32_bf16 v[80:83], a[208:211], a[152:155], v[80:83]
  ds_read_b64_tr_b16 a[200:201], v10 offset:32768
  ds_read_b64_tr_b16 a[202:203], v10 offset:36864
  v_mfma_f32_16x16x32_bf16 v[88:91], a[208:211], a[156:159], v[88:91]
  buffer_load_dwordx4 a[144:147], v3, s[12:15], s18 offen offset:0 sc1
  v_mfma_f32_16x16x32_bf16 v[84:87], a[212:215], a[152:155], v[84:87]
  ds_read_b64_tr_b16 a[204:205], v11 offset:32768
  ds_read_b64_tr_b16 a[206:207], v11 offset:36864
  v_mfma_f32_16x16x32_bf16 v[92:95], a[212:215], a[156:159], v[92:95]
  buffer_load_dwordx4 a[148:151], v3, s[12:15], s18 offen offset:1024 sc1
  s_waitcnt lgkmcnt(8)
  v_mfma_f32_16x16x32_bf16 v[96:99], a[216:219], a[152:155], v[96:99]
  ds_read_b64_tr_b16 a[208:209], v40 offset:32768
  ds_read_b64_tr_b16 a[210:211], v40 offset:36864
  v_mfma_f32_16x16x32_bf16 v[104:107], a[216:219], a[156:159], v[104:107]
  v_mfma_f32_16x16x32_bf16 v[100:103], a[220:223], a[152:155], v[100:103]
  ds_read_b64_tr_b16 a[212:213], v41 offset:32768
  ds_read_b64_tr_b16 a[214:215], v41 offset:36864
  v_mfma_f32_16x16x32_bf16 v[108:111], a[220:223], a[156:159], v[108:111]
  s_waitcnt vmcnt(20) lgkmcnt(8)
  v_mfma_f32_16x16x32_bf16 v[64:67], a[192:195], a[160:163], v[64:67]
  ds_read_b64_tr_b16 a[216:217], v8 offset:40960
  ds_read_b64_tr_b16 a[218:219], v8 offset:45056
  v_mfma_f32_16x16x32_bf16 v[72:75], a[192:195], a[164:167], v[72:75]
  buffer_load_dwordx4 a[152:155], v3, s[12:15], s18 offen offset:2048 sc1
  v_mfma_f32_16x16x32_bf16 v[68:71], a[196:199], a[160:163], v[68:71]
  ds_read_b64_tr_b16 a[220:221], v9 offset:40960
  ds_read_b64_tr_b16 a[222:223], v9 offset:45056
  v_mfma_f32_16x16x32_bf16 v[76:79], a[196:199], a[164:167], v[76:79]
  buffer_load_dwordx4 a[156:159], v3, s[12:15], s18 offen offset:3072 sc1
  s_add_u32 s18, s18, 4096
  s_cmp_eq_u32 s18, 131072
  s_cselect_b32 s18, 0, s18
  s_waitcnt lgkmcnt(8)
  v_mfma_f32_16x16x32_bf16 v[80:83], a[200:203], a[160:163], v[80:83]
  ds_read_b64_tr_b16 a[192:193], v10 offset:40960
  ds_read_b64_tr_b16 a[194:195], v10 offset:45056
  v_mfma_f32_16x16x32_bf16 v[88:91], a[200:203], a[164:167], v[88:91]
  s_add_u32 m0, s19, 0
  v_mfma_f32_16x16x32_bf16 v[84:87], a[204:207], a[160:163], v[84:87]
  ds_read_b64_tr_b16 a[196:197], v11 offset:40960
  ds_read_b64_tr_b16 a[198:199], v11 offset:45056
  v_mfma_f32_16x16x32_bf16 v[92:95], a[204:207], a[164:167], v[92:95]
  buffer_load_dwordx4 v4, s[8:11], s17 offen offset:0 lds
  s_waitcnt lgkmcnt(8)
  v_mfma_f32_16x16x32_bf16 v[96:99], a[208:211], a[160:163], v[96:99]
  ds_read_b64_tr_b16 a[200:201], v40 offset:40960
  ds_read_b64_tr_b16 a[202:203], v40 offset:45056
  v_mfma_f32_16x16x32_bf16 v[104:107], a[208:211], a[164:167], v[104:107]
  buffer_load_dwordx4 v5, s[8:11], s17 offen offset:1024 lds
  v_mfma_f32_16x16x32_bf16 v[100:103], a[212:215], a[160:163], v[100:103]
  ds_read_b64_tr_b16 a[204:205], v41 offset:40960
  ds_read_b64_tr_b16 a[206:207], v41 offset:45056
  v_mfma_f32_16x16x32_bf16 v[108:111], a[212:215], a[164:167], v[108:111]
  buffer_load_dwordx4 v6, s[8:11], s17 offen offset:2048 lds
  s_waitcnt vmcnt(23) lgkmcnt(8)
  v_mfma_f32_16x16x32_bf16 v[64:67], a[216:219], a[168:171], v[64:67]
  s_barrier
  ds_read_b64_tr_b16 a[208:209], v8 offset:49152
  ds_read_b64_tr_b16 a[210:211], v8 offset:53248
  v_mfma_f32_16x16x32_bf16 v[72:75], a[216:219], a[172:175], v[72:75]
  v_mfma_f32_16x16x32_bf16 v[68:71], a[220:223], a[168:171], v[68:71]
  ds_read_b64_tr_b16 a[212:213], v9 offset:49152
  ds_read_b64_tr_b16 a[214:215], v9 offset:53248
  v_mfma_f32_16x16x32_bf16 v[76:79], a[220:223], a[172:175], v[76:79]
  buffer_load_dwordx4 v7, s[8:11], s17 offen offset:3072 lds
  s_add_u32 s17, s17, 458752
  s_cmp_eq_u32 s17, 14680064
  s_cselect_b32 s17, 0, s17
  s_waitcnt lgkmcnt(8)
  v_mfma_f32_16x16x32_bf16 v[80:83], a[192:195], a[168:171], v[80:83]
  ds_read_b64_tr_b16 a[216:217], v10 offset:49152
  ds_read_b64_tr_b16 a[218:219], v10 offset:53248
  v_mfma_f32_16x16x32_bf16 v[88:91], a[192:195], a[172:175], v[88:91]
  buffer_load_dwordx4 a[160:163], v3, s[12:15], s18 offen offset:0 sc1
  v_mfma_f32_16x16x32_bf16 v[84:87], a[196:199], a[168:171], v[84:87]
  ds_read_b64_tr_b16 a[220:221], v11 offset:49152
  ds_read_b64_tr_b16 a[222:223], v11 offset:53248
  v_mfma_f32_16x16x32_bf16 v[92:95], a[196:199], a[172:175], v[92:95]
  buffer_load_dwordx4 a[164:167], v3, s[12:15], s18 offen offset:1024 sc1
  s_waitcnt lgkmcnt(8)
  v_mfma_f32_16x16x32_bf16 v[96:99], a[200:203], a[168:171], v[96:99]
  ds_read_b64_tr_b16 a[192:193], v40 offset:49152
  ds_read_b64_tr_b16 a[194:195], v40 offset:53248
  v_mfma_f32_16x16x32_bf16 v[104:107], a[200:203], a[172:175], v[104:107]
  v_mfma_f32_16x16x32_bf16 v[100:103], a[204:207], a[168:171], v[100:103]
  ds_read_b64_tr_b16 a[196:197], v41 offset:49152
  ds_read_b64_tr_b16 a[198:199], v41 offset:53248
  v_mfma_f32_16x16x32_bf16 v[108:111], a[204:207], a[172:175], v[108:111]
  s_waitcnt vmcnt(24) lgkmcnt(8)
  v_mfma_f32_16x16x32_bf16 v[64:67], a[208:211], a[176:179], v[64:67]
  ds_read_b64_tr_b16 a[200:201], v8 offset:57344
  ds_read_b64_tr_b16 a[202:203], v8 offset:61440
  v_mfma_f32_16x16x32_bf16 v[72:75], a[208:211], a[180:183], v[72:75]
  buffer_load_dwordx4 a[168:171], v3, s[12:15], s18 offen offset:2048 sc1
  v_mfma_f32_16x16x32_bf16 v[68:71], a[212:215], a[176:179], v[68:71]
  ds_read_b64_tr_b16 a[204:205], v9 offset:57344
  ds_read_b64_tr_b16 a[206:207], v9 offset:61440
  v_mfma_f32_16x16x32_bf16 v[76:79], a[212:215], a[180:183], v[76:79]
  buffer_load_dwordx4 a[172:175], v3, s[12:15], s18 offen offset:3072 sc1
  s_add_u32 s18, s18, 4096
  s_cmp_eq_u32 s18, 131072
  s_cselect_b32 s18, 0, s18
  s_waitcnt lgkmcnt(8)
  v_mfma_f32_16x16x32_bf16 v[80:83], a[216:219], a[176:179], v[80:83]
  ds_read_b64_tr_b16 a[208:209], v10 offset:57344
  ds_read_b64_tr_b16 a[210:211], v10 offset:61440
  v_mfma_f32_16x16x32_bf16 v[88:91], a[216:219], a[180:183], v[88:91]
  s_add_u32 m0, s19, 16384
  v_mfma_f32_16x16x32_bf16 v[84:87], a[220:223], a[176:179], v[84:87]
  ds_read_b64_tr_b16 a[212:213], v11 offset:57344
  ds_read_b64_tr_b16 a[214:215], v11 offset:61440
  v_mfma_f32_16x16x32_bf16 v[92:95], a[220:223], a[180:183], v[92:95]
  buffer_load_dwordx4 v4, s[8:11], s17 offen offset:0 lds
  s_waitcnt lgkmcnt(8)
  v_mfma_f32_16x16x32_bf16 v[96:99], a[192:195], a[176:179], v[96:99]
  ds_read_b64_tr_b16 a[216:217], v40 offset:57344
  ds_read_b64_tr_b16 a[218:219], v40 offset:61440
  v_mfma_f32_16x16x32_bf16 v[104:107], a[192:195], a[180:183], v[104:107]
  buffer_load_dwordx4 v5, s[8:11], s17 offen offset:1024 lds
  v_mfma_f32_16x16x32_bf16 v[100:103], a[196:199], a[176:179], v[100:103]
  ds_read_b64_tr_b16 a[220:221], v41 offset:57344
  ds_read_b64_tr_b16 a[222:223], v41 offset:61440
  v_mfma_f32_16x16x32_bf16 v[108:111], a[196:199], a[180:183], v[108:111]
  buffer_load_dwordx4 v6, s[8:11], s17 offen offset:2048 lds
  s_waitcnt vmcnt(27) lgkmcnt(8)
  v_mfma_f32_16x16x32_bf16 v[64:67], a[200:203], a[184:187], v[64:67]
  s_barrier
  ds_read_b64_tr_b16 a[192:193], v208 offset:0
  ds_read_b64_tr_b16 a[194:195], v208 offset:4096
  v_mfma_f32_16x16x32_bf16 v[72:75], a[200:203], a[188:191], v[72:75]
  v_mfma_f32_16x16x32_bf16 v[68:71], a[204:207], a[184:187], v[68:71]
  ds_read_b64_tr_b16 a[196:197], v209 offset:0
  ds_read_b64_tr_b16 a[198:199], v209 offset:4096
  v_mfma_f32_16x16x32_bf16 v[76:79], a[204:207], a[188:191], v[76:79]
  buffer_load_dwordx4 v7, s[8:11], s17 offen offset:3072 lds
  s_add_u32 s17, s17, 458752
  s_cmp_eq_u32 s17, 14680064
  s_cselect_b32 s17, 0, s17
  s_waitcnt lgkmcnt(8)
  v_mfma_f32_16x16x32_bf16 v[80:83], a[208:211], a[184:187], v[80:83]
  ds_read_b64_tr_b16 a[200:201], v210 offset:0
  ds_read_b64_tr_b16 a[202:203], v210 offset:4096
  v_mfma_f32_16x16x32_bf16 v[88:91], a[208:211], a[188:191], v[88:91]
  buffer_load_dwordx4 a[176:179], v3, s[12:15], s18 offen offset:0 sc1
  v_mfma_f32_16x16x32_bf16 v[84:87], a[212:215], a[184:187], v[84:87]
  ds_read_b64_tr_b16 a[204:205], v211 offset:0
  ds_read_b64_tr_b16 a[206:207], v211 offset:4096
  v_mfma_f32_16x16x32_bf16 v[92:95], a[212:215], a[188:191], v[92:95]
  buffer_load_dwordx4 a[180:183], v3, s[12:15], s18 offen offset:1024 sc1
  s_waitcnt lgkmcnt(8)
  v_mfma_f32_16x16x32_bf16 v[96:99], a[216:219], a[184:187], v[96:99]
  ds_read_b64_tr_b16 a[208:209], v212 offset:0
  ds_read_b64_tr_b16 a[210:211], v212 offset:4096
  v_mfma_f32_16x16x32_bf16 v[104:107], a[216:219], a[188:191], v[104:107]
  v_mfma_f32_16x16x32_bf16 v[100:103], a[220:223], a[184:187], v[100:103]
  ds_read_b64_tr_b16 a[212:213], v213 offset:0
  ds_read_b64_tr_b16 a[214:215], v213 offset:4096
  v_mfma_f32_16x16x32_bf16 v[108:111], a[220:223], a[188:191], v[108:111]
  s_waitcnt vmcnt(24) lgkmcnt(8)
  v_mfma_f32_16x16x32_bf16 v[64:67], a[192:195], a[128:131], v[64:67]
  ds_read_b64_tr_b16 a[216:217], v208 offset:8192
  ds_read_b64_tr_b16 a[218:219], v208 offset:12288
  v_mfma_f32_16x16x32_bf16 v[72:75], a[192:195], a[132:135], v[72:75]
  buffer_load_dwordx4 a[184:187], v3, s[12:15], s18 offen offset:2048 sc1
  v_mfma_f32_16x16x32_bf16 v[68:71], a[196:199], a[128:131], v[68:71]
  ds_read_b64_tr_b16 a[220:221], v209 offset:8192
  ds_read_b64_tr_b16 a[222:223], v209 offset:12288
  v_mfma_f32_16x16x32_bf16 v[76:79], a[196:199], a[132:135], v[76:79]
  buffer_load_dwordx4 a[188:191], v3, s[12:15], s18 offen offset:3072 sc1
  s_add_u32 s18, s18, 4096
  s_cmp_eq_u32 s18, 131072
  s_cselect_b32 s18, 0, s18
  s_waitcnt lgkmcnt(8)
  v_mfma_f32_16x16x32_bf16 v[80:83], a[200:203], a[128:131], v[80:83]
  ds_read_b64_tr_b16 a[192:193], v210 offset:8192
  ds_read_b64_tr_b16 a[194:195], v210 offset:12288
  v_mfma_f32_16x16x32_bf16 v[88:91], a[200:203], a[132:135], v[88:91]
  s_add_u32 m0, s19, 32768
  v_mfma_f32_16x16x32_bf16 v[84:87], a[204:207], a[128:131], v[84:87]
  ds_read_b64_tr_b16 a[196:197], v211 offset:8192
  ds_read_b64_tr_b16 a[198:199], v211 offset:12288
  v_mfma_f32_16x16x32_bf16 v[92:95], a[204:207], a[132:135], v[92:95]
  buffer_load_dwordx4 v4, s[8:11], s17 offen offset:0 lds
  s_waitcnt lgkmcnt(8)
  v_mfma_f32_16x16x32_bf16 v[96:99], a[208:211], a[128:131], v[96:99]
  ds_read_b64_tr_b16 a[200:201], v212 offset:8192
  ds_read_b64_tr_b16 a[202:203], v212 offset:12288
  v_mfma_f32_16x16x32_bf16 v[104:107], a[208:211], a[132:135], v[104:107]
  buffer_load_dwordx4 v5, s[8:11], s17 offen offset:1024 lds
  v_mfma_f32_16x16x32_bf16 v[100:103], a[212:215], a[128:131], v[100:103]
  ds_read_b64_tr_b16 a[204:205], v213 offset:8192
  ds_read_b64_tr_b16 a[206:207], v213 offset:12288
  v_mfma_f32_16x16x32_bf16 v[108:111], a[212:215], a[132:135], v[108:111]
  buffer_load_dwordx4 v6, s[8:11], s17 offen offset:2048 lds
  s_waitcnt vmcnt(27) lgkmcnt(8)
  v_mfma_f32_16x16x32_bf16 v[64:67], a[216:219], a[136:139], v[64:67]
  s_barrier
  ds_read_b64_tr_b16 a[208:209], v208 offset:16384
  ds_read_b64_tr_b16 a[210:211], v208 offset:20480
  v_mfma_f32_16x16x32_bf16 v[72:75], a[216:219], a[140:143], v[72:75]
  v_mfma_f32_16x16x32_bf16 v[68:71], a[220:223], a[136:139], v[68:71]
  ds_read_b64_tr_b16 a[212:213], v209 offset:16384
  ds_read_b64_tr_b16 a[214:215], v209 offset:20480
  v_mfma_f32_16x16x32_bf16 v[76:79], a[220:223], a[140:143], v[76:79]
  buffer_load_dwordx4 v7, s[8:11], s17 offen offset:3072 lds
  s_add_u32 s17, s17, 458752
  s_cmp_eq_u32 s17, 14680064
  s_cselect_b32 s17, 0, s17
  s_waitcnt lgkmcnt(8)
  v_mfma_f32_16x16x32_bf16 v[80:83], a[192:195], a[136:139], v[80:83]
  ds_read_b64_tr_b16 a[216:217], v210 offset:16384
  ds_read_b64_tr_b16 a[218:219], v210 offset:20480
  v_mfma_f32_16x16x32_bf16 v[88:91], a[192:195], a[140:143], v[88:91]
  buffer_load_dwordx4 a[128:131], v3, s[12:15], s18 offen offset:0 sc1
  v_mfma_f32_16x16x32_bf16 v[84:87], a[196:199], a[136:139], v[84:87]
  ds_read_b64_tr_b16 a[220:221], v211 offset:16384
  ds_read_b64_tr_b16 a[222:223], v211 offset:20480
  v_mfma_f32_16x16x32_bf16 v[92:95], a[196:199], a[140:143], v[92:95]
  buffer_load_dwordx4 a[132:135], v3, s[12:15], s18 offen offset:1024 sc1
  s_waitcnt lgkmcnt(8)
  v_mfma_f32_16x16x32_bf16 v[96:99], a[200:203], a[136:139], v[96:99]
  ds_read_b64_tr_b16 a[192:193], v212 offset:16384
  ds_read_b64_tr_b16 a[194:195], v212 offset:20480
  v_mfma_f32_16x16x32_bf16 v[104:107], a[200:203], a[140:143], v[104:107]
  v_mfma_f32_16x16x32_bf16 v[100:103], a[204:207], a[136:139], v[100:103]
  ds_read_b64_tr_b16 a[196:197], v213 offset:16384
  ds_read_b64_tr_b16 a[198:199], v213 offset:20480
  v_mfma_f32_16x16x32_bf16 v[108:111], a[204:207], a[140:143], v[108:111]
  s_waitcnt vmcnt(24) lgkmcnt(8)
  v_mfma_f32_16x16x32_bf16 v[64:67], a[208:211], a[144:147], v[64:67]
  ds_read_b64_tr_b16 a[200:201], v208 offset:24576
  ds_read_b64_tr_b16 a[202:203], v208 offset:28672
  v_mfma_f32_16x16x32_bf16 v[72:75], a[208:211], a[148:151], v[72:75]
  buffer_load_dwordx4 a[136:139], v3, s[12:15], s18 offen offset:2048 sc1
  v_mfma_f32_16x16x32_bf16 v[68:71], a[212:215], a[144:147], v[68:71]
  ds_read_b64_tr_b16 a[204:205], v209 offset:24576
  ds_read_b64_tr_b16 a[206:207], v209 offset:28672
  v_mfma_f32_16x16x32_bf16 v[76:79], a[212:215], a[148:151], v[76:79]
  buffer_load_dwordx4 a[140:143], v3, s[12:15], s18 offen offset:3072 sc1
  s_add_u32 s18, s18, 4096
  s_cmp_eq_u32 s18, 131072
  s_cselect_b32 s18, 0, s18
  s_waitcnt lgkmcnt(8)
  v_mfma_f32_16x16x32_bf16 v[80:83], a[216:219], a[144:147], v[80:83]
  ds_read_b64_tr_b16 a[208:209], v210 offset:24576
  ds_read_b64_tr_b16 a[210:211], v210 offset:28672
  v_mfma_f32_16x16x32_bf16 v[88:91], a[216:219], a[148:151], v[88:91]
  s_add_u32 m0, s19, 49152
  v_mfma_f32_16x16x32_bf16 v[84:87], a[220:223], a[144:147], v[84:87]
  ds_read_b64_tr_b16 a[212:213], v211 offset:24576
  ds_read_b64_tr_b16 a[214:215], v211 offset:28672
  v_mfma_f32_16x16x32_bf16 v[92:95], a[220:223], a[148:151], v[92:95]
  buffer_load_dwordx4 v4, s[8:11], s17 offen offset:0 lds
  s_waitcnt lgkmcnt(8)
  v_mfma_f32_16x16x32_bf16 v[96:99], a[192:195], a[144:147], v[96:99]
  ds_read_b64_tr_b16 a[216:217], v212 offset:24576
  ds_read_b64_tr_b16 a[218:219], v212 offset:28672
  v_mfma_f32_16x16x32_bf16 v[104:107], a[192:195], a[148:151], v[104:107]
  buffer_load_dwordx4 v5, s[8:11], s17 offen offset:1024 lds
  v_mfma_f32_16x16x32_bf16 v[100:103], a[196:199], a[144:147], v[100:103]
  ds_read_b64_tr_b16 a[220:221], v213 offset:24576
  ds_read_b64_tr_b16 a[222:223], v213 offset:28672
  v_mfma_f32_16x16x32_bf16 v[108:111], a[196:199], a[148:151], v[108:111]
  buffer_load_dwordx4 v6, s[8:11], s17 offen offset:2048 lds
  s_waitcnt vmcnt(27) lgkmcnt(8)
  v_mfma_f32_16x16x32_bf16 v[64:67], a[200:203], a[152:155], v[64:67]
  s_barrier
  ds_read_b64_tr_b16 a[192:193], v208 offset:32768
  ds_read_b64_tr_b16 a[194:195], v208 offset:36864
  v_mfma_f32_16x16x32_bf16 v[72:75], a[200:203], a[156:159], v[72:75]
  v_mfma_f32_16x16x32_bf16 v[68:71], a[204:207], a[152:155], v[68:71]
  ds_read_b64_tr_b16 a[196:197], v209 offset:32768
  ds_read_b64_tr_b16 a[198:199], v209 offset:36864
  v_mfma_f32_16x16x32_bf16 v[76:79], a[204:207], a[156:159], v[76:79]
  buffer_load_dwordx4 v7, s[8:11], s17 offen offset:3072 lds
  s_add_u32 s17, s17, 458752
  s_cmp_eq_u32 s17, 14680064
  s_cselect_b32 s17, 0, s17
  s_waitcnt lgkmcnt(8)
  v_mfma_f32_16x16x32_bf16 v[80:83], a[208:211], a[152:155], v[80:83]
  ds_read_b64_tr_b16 a[200:201], v210 offset:32768
  ds_read_b64_tr_b16 a[202:203], v210 offset:36864
  v_mfma_f32_16x16x32_bf16 v[88:91], a[208:211], a[156:159], v[88:91]
  buffer_load_dwordx4 a[144:147], v3, s[12:15], s18 offen offset:0 sc1
  v_mfma_f32_16x16x32_bf16 v[84:87], a[212:215], a[152:155], v[84:87]
  ds_read_b64_tr_b16 a[204:205], v211 offset:32768
  ds_read_b64_tr_b16 a[206:207], v211 offset:36864
  v_mfma_f32_16x16x32_bf16 v[92:95], a[212:215], a[156:159], v[92:95]
  buffer_load_dwordx4 a[148:151], v3, s[12:15], s18 offen offset:1024 sc1
  s_waitcnt lgkmcnt(8)
  v_mfma_f32_16x16x32_bf16 v[96:99], a[216:219], a[152:155], v[96:99]
  ds_read_b64_tr_b16 a[208:209], v212 offset:32768
  ds_read_b64_tr_b16 a[210:211], v212 offset:36864
  v_mfma_f32_16x16x32_bf16 v[104:107], a[216:219], a[156:159], v[104:107]
  v_mfma_f32_16x16x32_bf16 v[100:103], a[220:223], a[152:155], v[100:103]
  ds_read_b64_tr_b16 a[212:213], v213 offset:32768
  ds_read_b64_tr_b16 a[214:215], v213 offset:36864
  v_mfma_f32_16x16x32_bf16 v[108:111], a[220:223], a[156:159], v[108:111]
  s_waitcnt vmcnt(24) lgkmcnt(8)
  v_mfma_f32_16x16x32_bf16 v[64:67], a[192:195], a[160:163], v[64:67]
  ds_read_b64_tr_b16 a[216:217], v208 offset:40960
  ds_read_b64_tr_b16 a[218:219], v208 offset:45056
  v_mfma_f32_16x16x32_bf16 v[72:75], a[192:195], a[164:167], v[72:75]
  buffer_load_dwordx4 a[152:155], v3, s[12:15], s18 offen offset:2048 sc1
  v_mfma_f32_16x16x32_bf16 v[68:71], a[196:199], a[160:163], v[68:71]
  ds_read_b64_tr_b16 a[220:221], v209 offset:40960
  ds_read_b64_tr_b16 a[222:223], v209 offset:45056
  v_mfma_f32_16x16x32_bf16 v[76:79], a[196:199], a[164:167], v[76:79]
  buffer_load_dwordx4 a[156:159], v3, s[12:15], s18 offen offset:3072 sc1
  s_add_u32 s18, s18, 4096
  s_cmp_eq_u32 s18, 131072
  s_cselect_b32 s18, 0, s18
  s_waitcnt lgkmcnt(8)
  v_mfma_f32_16x16x32_bf16 v[80:83], a[200:203], a[160:163], v[80:83]
  ds_read_b64_tr_b16 a[192:193], v210 offset:40960
  ds_read_b64_tr_b16 a[194:195], v210 offset:45056
  v_mfma_f32_16x16x32_bf16 v[88:91], a[200:203], a[164:167], v[88:91]
  s_add_u32 m0, s19, 65536
  v_mfma_f32_16x16x32_bf16 v[84:87], a[204:207], a[160:163], v[84:87]
  ds_read_b64_tr_b16 a[196:197], v211 offset:40960
  ds_read_b64_tr_b16 a[198:199], v211 offset:45056
  v_mfma_f32_16x16x32_bf16 v[92:95], a[204:207], a[164:167], v[92:95]
  buffer_load_dwordx4 v4, s[8:11], s17 offen offset:0 lds
  s_waitcnt lgkmcnt(8)
  v_mfma_f32_16x16x32_bf16 v[96:99], a[208:211], a[160:163], v[96:99]
  ds_read_b64_tr_b16 a[200:201], v212 offset:40960
  ds_read_b64_tr_b16 a[202:203], v212 offset:45056
  v_mfma_f32_16x16x32_bf16 v[104:107], a[208:211], a[164:167], v[104:107]
  buffer_load_dwordx4 v5, s[8:11], s17 offen offset:1024 lds
  v_mfma_f32_16x16x32_bf16 v[100:103], a[212:215], a[160:163], v[100:103]
  ds_read_b64_tr_b16 a[204:205], v213 offset:40960
  ds_read_b64_tr_b16 a[206:207], v213 offset:45056
  v_mfma_f32_16x16x32_bf16 v[108:111], a[212:215], a[164:167], v[108:111]
  buffer_load_dwordx4 v6, s[8:11], s17 offen offset:2048 lds
  s_waitcnt vmcnt(27) lgkmcnt(8)
  v_mfma_f32_16x16x32_bf16 v[64:67], a[216:219], a[168:171], v[64:67]
  s_barrier
  ds_read_b64_tr_b16 a[208:209], v208 offset:49152
  ds_read_b64_tr_b16 a[210:211], v208 offset:53248
  v_mfma_f32_16x16x32_bf16 v[72:75], a[216:219], a[172:175], v[72:75]
  v_mfma_f32_16x16x32_bf16 v[68:71], a[220:223], a[168:171], v[68:71]
  ds_read_b64_tr_b16 a[212:213], v209 offset:49152
  ds_read_b64_tr_b16 a[214:215], v209 offset:53248
  v_mfma_f32_16x16x32_bf16 v[76:79], a[220:223], a[172:175], v[76:79]
  buffer_load_dwordx4 v7, s[8:11], s17 offen offset:3072 lds
  s_add_u32 s17, s17, 458752
  s_cmp_eq_u32 s17, 14680064
  s_cselect_b32 s17, 0, s17
  s_waitcnt lgkmcnt(8)
  v_mfma_f32_16x16x32_bf16 v[80:83], a[192:195], a[168:171], v[80:83]
  ds_read_b64_tr_b16 a[216:217], v210 offset:49152
  ds_read_b64_tr_b16 a[218:219], v210 offset:53248
  v_mfma_f32_16x16x32_bf16 v[88:91], a[192:195], a[172:175], v[88:91]
  buffer_load_dwordx4 a[160:163], v3, s[12:15], s18 offen offset:0 sc1
  v_mfma_f32_16x16x32_bf16 v[84:87], a[196:199], a[168:171], v[84:87]
  ds_read_b64_tr_b16 a[220:221], v211 offset:49152
  ds_read_b64_tr_b16 a[222:223], v211 offset:53248
  v_mfma_f32_16x16x32_bf16 v[92:95], a[196:199], a[172:175], v[92:95]
  buffer_load_dwordx4 a[164:167], v3, s[12:15], s18 offen offset:1024 sc1
  s_waitcnt lgkmcnt(8)
  v_mfma_f32_16x16x32_bf16 v[96:99], a[200:203], a[168:171], v[96:99]
  ds_read_b64_tr_b16 a[192:193], v212 offset:49152
  ds_read_b64_tr_b16 a[194:195], v212 offset:53248
  v_mfma_f32_16x16x32_bf16 v[104:107], a[200:203], a[172:175], v[104:107]
  v_mfma_f32_16x16x32_bf16 v[100:103], a[204:207], a[168:171], v[100:103]
  ds_read_b64_tr_b16 a[196:197], v213 offset:49152
  ds_read_b64_tr_b16 a[198:199], v213 offset:53248
  v_mfma_f32_16x16x32_bf16 v[108:111], a[204:207], a[172:175], v[108:111]
  s_waitcnt vmcnt(24) lgkmcnt(8)
  v_mfma_f32_16x16x32_bf16 v[64:67], a[208:211], a[176:179], v[64:67]
  ds_read_b64_tr_b16 a[200:201], v208 offset:57344
  ds_read_b64_tr_b16 a[202:203], v208 offset:61440
  v_mfma_f32_16x16x32_bf16 v[72:75], a[208:211], a[180:183], v[72:75]
  buffer_load_dwordx4 a[168:171], v3, s[12:15], s18 offen offset:2048 sc1
  v_mfma_f32_16x16x32_bf16 v[68:71], a[212:215], a[176:179], v[68:71]
  ds_read_b64_tr_b16 a[204:205], v209 offset:57344
  ds_read_b64_tr_b16 a[206:207], v209 offset:61440
  v_mfma_f32_16x16x32_bf16 v[76:79], a[212:215], a[180:183], v[76:79]
  buffer_load_dwordx4 a[172:175], v3, s[12:15], s18 offen offset:3072 sc1
  s_add_u32 s18, s18, 4096
  s_cmp_eq_u32 s18, 131072
  s_cselect_b32 s18, 0, s18
  s_waitcnt lgkmcnt(8)
  v_mfma_f32_16x16x32_bf16 v[80:83], a[216:219], a[176:179], v[80:83]
  ds_read_b64_tr_b16 a[208:209], v210 offset:57344
  ds_read_b64_tr_b16 a[210:211], v210 offset:61440
  v_mfma_f32_16x16x32_bf16 v[88:91], a[216:219], a[180:183], v[88:91]
  s_add_u32 m0, s19, 81920
  v_mfma_f32_16x16x32_bf16 v[84:87], a[220:223], a[176:179], v[84:87]
  ds_read_b64_tr_b16 a[212:213], v211 offset:57344
  ds_read_b64_tr_b16 a[214:215], v211 offset:61440
  v_mfma_f32_16x16x32_bf16 v[92:95], a[220:223], a[180:183], v[92:95]
  buffer_load_dwordx4 v4, s[8:11], s17 offen offset:0 lds
  s_waitcnt lgkmcnt(8)
  v_mfma_f32_16x16x32_bf16 v[96:99], a[192:195], a[176:179], v[96:99]
  ds_read_b64_tr_b16 a[216:217], v212 offset:57344
  ds_read_b64_tr_b16 a[218:219], v212 offset:61440
  v_mfma_f32_16x16x32_bf16 v[104:107], a[192:195], a[180:183], v[104:107]
  buffer_load_dwordx4 v5, s[8:11], s17 offen offset:1024 lds
  v_mfma_f32_16x16x32_bf16 v[100:103], a[196:199], a[176:179], v[100:103]
  ds_read_b64_tr_b16 a[220:221], v213 offset:57344
  ds_read_b64_tr_b16 a[222:223], v213 offset:61440
  v_mfma_f32_16x16x32_bf16 v[108:111], a[196:199], a[180:183], v[108:111]
  buffer_load_dwordx4 v6, s[8:11], s17 offen offset:2048 lds
  s_waitcnt vmcnt(27) lgkmcnt(8)
  v_mfma_f32_16x16x32_bf16 v[64:67], a[200:203], a[184:187], v[64:67]
  s_barrier
  ds_read_b64_tr_b16 a[192:193], v8 offset:0
  ds_read_b64_tr_b16 a[194:195], v8 offset:4096
  v_mfma_f32_16x16x32_bf16 v[72:75], a[200:203], a[188:191], v[72:75]
  v_mfma_f32_16x16x32_bf16 v[68:71], a[204:207], a[184:187], v[68:71]
  ds_read_b64_tr_b16 a[196:197], v9 offset:0
  ds_read_b64_tr_b16 a[198:199], v9 offset:4096
  v_mfma_f32_16x16x32_bf16 v[76:79], a[204:207], a[188:191], v[76:79]
  buffer_load_dwordx4 v7, s[8:11], s17 offen offset:3072 lds
  s_add_u32 s17, s17, 458752
  s_cmp_eq_u32 s17, 14680064
  s_cselect_b32 s17, 0, s17
  s_waitcnt lgkmcnt(8)
  v_mfma_f32_16x16x32_bf16 v[80:83], a[208:211], a[184:187], v[80:83]
  ds_read_b64_tr_b16 a[200:201], v10 offset:0
  ds_read_b64_tr_b16 a[202:203], v10 offset:4096
  v_mfma_f32_16x16x32_bf16 v[88:91], a[208:211], a[188:191], v[88:91]
  buffer_load_dwordx4 a[176:179], v3, s[12:15], s18 offen offset:0 sc1
  v_mfma_f32_16x16x32_bf16 v[84:87], a[212:215], a[184:187], v[84:87]
  ds_read_b64_tr_b16 a[204:205], v11 offset:0
  ds_read_b64_tr_b16 a[206:207], v11 offset:4096
  v_mfma_f32_16x16x32_bf16 v[92:95], a[212:215], a[188:191], v[92:95]
  buffer_load_dwordx4 a[180:183], v3, s[12:15], s18 offen offset:1024 sc1
  s_waitcnt lgkmcnt(8)
  v_mfma_f32_16x16x32_bf16 v[96:99], a[216:219], a[184:187], v[96:99]
  ds_read_b64_tr_b16 a[208:209], v40 offset:0
  ds_read_b64_tr_b16 a[210:211], v40 offset:4096
  v_mfma_f32_16x16x32_bf16 v[104:107], a[216:219], a[188:191], v[104:107]
  v_mfma_f32_16x16x32_bf16 v[100:103], a[220:223], a[184:187], v[100:103]
  ds_read_b64_tr_b16 a[212:213], v41 offset:0
  ds_read_b64_tr_b16 a[214:215], v41 offset:4096
  v_mfma_f32_16x16x32_bf16 v[108:111], a[220:223], a[188:191], v[108:111]
  s_sub_u32 s20, s20, 1
  s_cmp_lg_u32 s20, 0
  s_cbranch_scc1 L_mk5_m_2
  s_waitcnt vmcnt(24) lgkmcnt(8)
  v_mfma_f32_16x16x32_bf16 v[64:67], a[192:195], a[128:131], v[64:67]
  ds_read_b64_tr_b16 a[216:217], v8 offset:8192
  ds_read_b64_tr_b16 a[218:219], v8 offset:12288
  v_mfma_f32_16x16x32_bf16 v[72:75], a[192:195], a[132:135], v[72:75]
  buffer_load_dwordx4 a[184:187], v3, s[12:15], s18 offen offset:2048 sc1
  v_mfma_f32_16x16x32_bf16 v[68:71], a[196:199], a[128:131], v[68:71]
  ds_read_b64_tr_b16 a[220:221], v9 offset:8192
  ds_read_b64_tr_b16 a[222:223], v9 offset:12288
  v_mfma_f32_16x16x32_bf16 v[76:79], a[196:199], a[132:135], v[76:79]
  buffer_load_dwordx4 a[188:191], v3, s[12:15], s18 offen offset:3072 sc1
  s_add_u32 s18, s18, 4096
  s_cmp_eq_u32 s18, 131072
  s_cselect_b32 s18, 0, s18
  s_waitcnt lgkmcnt(8)
  v_mfma_f32_16x16x32_bf16 v[80:83], a[200:203], a[128:131], v[80:83]
  ds_read_b64_tr_b16 a[192:193], v10 offset:8192
  ds_read_b64_tr_b16 a[194:195], v10 offset:12288
  v_mfma_f32_16x16x32_bf16 v[88:91], a[200:203], a[132:135], v[88:91]
  s_add_u32 m0, s19, 98304
  v_mfma_f32_16x16x32_bf16 v[84:87], a[204:207], a[128:131], v[84:87]
  ds_read_b64_tr_b16 a[196:197], v11 offset:8192
  ds_read_b64_tr_b16 a[198:199], v11 offset:12288
  v_mfma_f32_16x16x32_bf16 v[92:95], a[204:207], a[132:135], v[92:95]
  buffer_load_dwordx4 v4, s[8:11], s17 offen offset:0 lds
  s_waitcnt lgkmcnt(8)
  v_mfma_f32_16x16x32_bf16 v[96:99], a[208:211], a[128:131], v[96:99]
  ds_read_b64_tr_b16 a[200:201], v40 offset:8192
  ds_read_b64_tr_b16 a[202:203], v40 offset:12288
  v_mfma_f32_16x16x32_bf16 v[104:107], a[208:211], a[132:135], v[104:107]
  buffer_load_dwordx4 v5, s[8:11], s17 offen offset:1024 lds
  v_mfma_f32_16x16x32_bf16 v[100:103], a[212:215], a[128:131], v[100:103]
  ds_read_b64_tr_b16 a[204:205], v41 offset:8192
  ds_read_b64_tr_b16 a[206:207], v41 offset:12288
  v_mfma_f32_16x16x32_bf16 v[108:111], a[212:215], a[132:135], v[108:111]
  buffer_load_dwordx4 v6, s[8:11], s17 offen offset:2048 lds
  s_waitcnt vmcnt(27) lgkmcnt(8)
  v_mfma_f32_16x16x32_bf16 v[64:67], a[216:219], a[136:139], v[64:67]
  s_barrier
  ds_read_b64_tr_b16 a[208:209], v8 offset:16384
  ds_read_b64_tr_b16 a[210:211], v8 offset:20480
  v_mfma_f32_16x16x32_bf16 v[72:75], a[216:219], a[140:143], v[72:75]
  v_mfma_f32_16x16x32_bf16 v[68:71], a[220:223], a[136:139], v[68:71]
  ds_read_b64_tr_b16 a[212:213], v9 offset:16384
  ds_read_b64_tr_b16 a[214:215], v9 offset:20480
  v_mfma_f32_16x16x32_bf16 v[76:79], a[220:223], a[140:143], v[76:79]
  buffer_load_dwordx4 v7, s[8:11], s17 offen offset:3072 lds
  s_add_u32 s17, s17, 458752
  s_cmp_eq_u32 s17, 14680064
  s_cselect_b32 s17, 0, s17
  s_waitcnt lgkmcnt(8)
  v_mfma_f32_16x16x32_bf16 v[80:83], a[192:195], a[136:139], v[80:83]
  ds_read_b64_tr_b16 a[216:217], v10 offset:16384
  ds_read_b64_tr_b16 a[218:219], v10 offset:20480
  v_mfma_f32_16x16x32_bf16 v[88:91], a[192:195], a[140:143], v[88:91]
  buffer_load_dwordx4 a[128:131], v3, s[12:15], s18 offen offset:0 sc1
  v_mfma_f32_16x16x32_bf16 v[84:87], a[196:199], a[136:139], v[84:87]
  ds_read_b64_tr_b16 a[220:221], v11 offset:16384
  ds_read_b64_tr_b16 a[222:223], v11 offset:20480
  v_mfma_f32_16x16x32_bf16 v[92:95], a[196:199], a[140:143], v[92:95]
  buffer_load_dwordx4 a[132:135], v3, s[12:15], s18 offen offset:1024 sc1
  s_waitcnt lgkmcnt(8)
  v_mfma_f32_16x16x32_bf16 v[96:99], a[200:203], a[136:139], v[96:99]
  ds_read_b64_tr_b16 a[192:193], v40 offset:16384
  ds_read_b64_tr_b16 a[194:195], v40 offset:20480
  v_mfma_f32_16x16x32_bf16 v[104:107], a[200:203], a[140:143], v[104:107]
  v_mfma_f32_16x16x32_bf16 v[100:103], a[204:207], a[136:139], v[100:103]
  ds_read_b64_tr_b16 a[196:197], v41 offset:16384
  ds_read_b64_tr_b16 a[198:199], v41 offset:20480
  v_mfma_f32_16x16x32_bf16 v[108:111], a[204:207], a[140:143], v[108:111]
  s_waitcnt vmcnt(24) lgkmcnt(8)
  v_mfma_f32_16x16x32_bf16 v[64:67], a[208:211], a[144:147], v[64:67]
  ds_read_b64_tr_b16 a[200:201], v8 offset:24576
  ds_read_b64_tr_b16 a[202:203], v8 offset:28672
  v_mfma_f32_16x16x32_bf16 v[72:75], a[208:211], a[148:151], v[72:75]
  buffer_load_dwordx4 a[136:139], v3, s[12:15], s18 offen offset:2048 sc1
  v_mfma_f32_16x16x32_bf16 v[68:71], a[212:215], a[144:147], v[68:71]
  ds_read_b64_tr_b16 a[204:205], v9 offset:24576
  ds_read_b64_tr_b16 a[206:207], v9 offset:28672
  v_mfma_f32_16x16x32_bf16 v[76:79], a[212:215], a[148:151], v[76:79]
  buffer_load_dwordx4 a[140:143], v3, s[12:15], s18 offen offset:3072 sc1
  s_add_u32 s18, s18, 4096
  s_cmp_eq_u32 s18, 131072
  s_cselect_b32 s18, 0, s18
  s_waitcnt lgkmcnt(8)
  v_mfma_f32_16x16x32_bf16 v[80:83], a[216:219], a[144:147], v[80:83]
  ds_read_b64_tr_b16 a[208:209], v10 offset:24576
  ds_read_b64_tr_b16 a[210:211], v10 offset:28672
  v_mfma_f32_16x16x32_bf16 v[88:91], a[216:219], a[148:151], v[88:91]
  s_add_u32 m0, s19, 114688
  v_mfma_f32_16x16x32_bf16 v[84:87], a[220:223], a[144:147], v[84:87]
  ds_read_b64_tr_b16 a[212:213], v11 offset:24576
  ds_read_b64_tr_b16 a[214:215], v11 offset:28672
  v_mfma_f32_16x16x32_bf16 v[92:95], a[220:223], a[148:151], v[92:95]
  buffer_load_dwordx4 v4, s[8:11], s17 offen offset:0 lds
  s_waitcnt lgkmcnt(8)
  v_mfma_f32_16x16x32_bf16 v[96:99], a[192:195], a[144:147], v[96:99]
  ds_read_b64_tr_b16 a[216:217], v40 offset:24576
  ds_read_b64_tr_b16 a[218:219], v40 offset:28672
  v_mfma_f32_16x16x32_bf16 v[104:107], a[192:195], a[148:151], v[104:107]
  buffer_load_dwordx4 v5, s[8:11], s17 offen offset:1024 lds
  v_mfma_f32_16x16x32_bf16 v[100:103], a[196:199], a[144:147], v[100:103]
  ds_read_b64_tr_b16 a[220:221], v41 offset:24576
  ds_read_b64_tr_b16 a[222:223], v41 offset:28672
  v_mfma_f32_16x16x32_bf16 v[108:111], a[196:199], a[148:151], v[108:111]
  buffer_load_dwordx4 v6, s[8:11], s17 offen offset:2048 lds
  s_waitcnt vmcnt(27) lgkmcnt(8)
  v_mfma_f32_16x16x32_bf16 v[64:67], a[200:203], a[152:155], v[64:67]
  s_barrier
  ds_read_b64_tr_b16 a[192:193], v8 offset:32768
  ds_read_b64_tr_b16 a[194:195], v8 offset:36864
  v_mfma_f32_16x16x32_bf16 v[72:75], a[200:203], a[156:159], v[72:75]
  v_mfma_f32_16x16x32_bf16 v[68:71], a[204:207], a[152:155], v[68:71]
  ds_read_b64_tr_b16 a[196:197], v9 offset:32768
  ds_read_b64_tr_b16 a[198:199], v9 offset:36864
  v_mfma_f32_16x16x32_bf16 v[76:79], a[204:207], a[156:159], v[76:79]
  buffer_load_dwordx4 v7, s[8:11], s17 offen offset:3072 lds
  s_add_u32 s17, s17, 458752
  s_cmp_eq_u32 s17, 14680064
  s_cselect_b32 s17, 0, s17
  s_waitcnt lgkmcnt(8)
  v_mfma_f32_16x16x32_bf16 v[80:83], a[208:211], a[152:155], v[80:83]
  ds_read_b64_tr_b16 a[200:201], v10 offset:32768
  ds_read_b64_tr_b16 a[202:203], v10 offset:36864
  v_mfma_f32_16x16x32_bf16 v[88:91], a[208:211], a[156:159], v[88:91]
  buffer_load_dwordx4 a[144:147], v3, s[12:15], s18 offen offset:0 sc1
  v_mfma_f32_16x16x32_bf16 v[84:87], a[212:215], a[152:155], v[84:87]
  ds_read_b64_tr_b16 a[204:205], v11 offset:32768
  ds_read_b64_tr_b16 a[206:207], v11 offset:36864
  v_mfma_f32_16x16x32_bf16 v[92:95], a[212:215], a[156:159], v[92:95]
  buffer_load_dwordx4 a[148:151], v3, s[12:15], s18 offen offset:1024 sc1
  s_waitcnt lgkmcnt(8)
  v_mfma_f32_16x16x32_bf16 v[96:99], a[216:219], a[152:155], v[96:99]
  ds_read_b64_tr_b16 a[208:209], v40 offset:32768
  ds_read_b64_tr_b16 a[210:211], v40 offset:36864
  v_mfma_f32_16x16x32_bf16 v[104:107], a[216:219], a[156:159], v[104:107]
  v_mfma_f32_16x16x32_bf16 v[100:103], a[220:223], a[152:155], v[100:103]
  ds_read_b64_tr_b16 a[212:213], v41 offset:32768
  ds_read_b64_tr_b16 a[214:215], v41 offset:36864
  v_mfma_f32_16x16x32_bf16 v[108:111], a[220:223], a[156:159], v[108:111]
  s_waitcnt vmcnt(24) lgkmcnt(8)
  v_mfma_f32_16x16x32_bf16 v[64:67], a[192:195], a[160:163], v[64:67]
  ds_read_b64_tr_b16 a[216:217], v8 offset:40960
  ds_read_b64_tr_b16 a[218:219], v8 offset:45056
  v_mfma_f32_16x16x32_bf16 v[72:75], a[192:195], a[164:167], v[72:75]
  buffer_load_dwordx4 a[152:155], v3, s[12:15], s18 offen offset:2048 sc1
  v_mfma_f32_16x16x32_bf16 v[68:71], a[196:199], a[160:163], v[68:71]
  ds_read_b64_tr_b16 a[220:221], v9 offset:40960
  ds_read_b64_tr_b16 a[222:223], v9 offset:45056
  v_mfma_f32_16x16x32_bf16 v[76:79], a[196:199], a[164:167], v[76:79]
  buffer_load_dwordx4 a[156:159], v3, s[12:15], s18 offen offset:3072 sc1
  s_add_u32 s18, s18, 4096
  s_cmp_eq_u32 s18, 131072
  s_cselect_b32 s18, 0, s18
  s_waitcnt lgkmcnt(8)
  v_mfma_f32_16x16x32_bf16 v[80:83], a[200:203], a[160:163], v[80:83]
  ds_read_b64_tr_b16 a[192:193], v10 offset:40960
  ds_read_b64_tr_b16 a[194:195], v10 offset:45056
  v_mfma_f32_16x16x32_bf16 v[88:91], a[200:203], a[164:167], v[88:91]
  s_add_u32 m0, s19, 0
  v_mfma_f32_16x16x32_bf16 v[84:87], a[204:207], a[160:163], v[84:87]
  ds_read_b64_tr_b16 a[196:197], v11 offset:40960
  ds_read_b64_tr_b16 a[198:199], v11 offset:45056
  v_mfma_f32_16x16x32_bf16 v[92:95], a[204:207], a[164:167], v[92:95]
  buffer_load_dwordx4 v48, s[4:7], s66 offen offset:0 lds
  s_waitcnt lgkmcnt(8)
  v_mfma_f32_16x16x32_bf16 v[96:99], a[208:211], a[160:163], v[96:99]
  ds_read_b64_tr_b16 a[200:201], v40 offset:40960
  ds_read_b64_tr_b16 a[202:203], v40 offset:45056
  v_mfma_f32_16x16x32_bf16 v[104:107], a[208:211], a[164:167], v[104:107]
  buffer_load_dwordx4 v49, s[4:7], s66 offen offset:1024 lds
  v_mfma_f32_16x16x32_bf16 v[100:103], a[212:215], a[160:163], v[100:103]
  ds_read_b64_tr_b16 a[204:205], v41 offset:40960
  ds_read_b64_tr_b16 a[206:207], v41 offset:45056
  v_mfma_f32_16x16x32_bf16 v[108:111], a[212:215], a[164:167], v[108:111]
  buffer_load_dwordx4 v50, s[4:7], s66 offen offset:2048 lds
  s_waitcnt vmcnt(27) lgkmcnt(8)
  v_mfma_f32_16x16x32_bf16 v[64:67], a[216:219], a[168:171], v[64:67]
  s_barrier
  ds_read_b64_tr_b16 a[208:209], v8 offset:49152
  ds_read_b64_tr_b16 a[210:211], v8 offset:53248
  v_mfma_f32_16x16x32_bf16 v[72:75], a[216:219], a[172:175], v[72:75]
  v_mfma_f32_16x16x32_bf16 v[68:71], a[220:223], a[168:171], v[68:71]
  ds_read_b64_tr_b16 a[212:213], v9 offset:49152
  ds_read_b64_tr_b16 a[214:215], v9 offset:53248
  v_mfma_f32_16x16x32_bf16 v[76:79], a[220:223], a[172:175], v[76:79]
  buffer_load_dwordx4 v51, s[4:7], s66 offen offset:3072 lds
  s_add_u32 s66, s66, 524288
  s_cmp_eq_u32 s66, 8388608
  s_cselect_b32 s66, 0, s66
  s_waitcnt lgkmcnt(8)
  v_mfma_f32_16x16x32_bf16 v[80:83], a[192:195], a[168:171], v[80:83]
  ds_read_b64_tr_b16 a[216:217], v10 offset:49152
  ds_read_b64_tr_b16 a[218:219], v10 offset:53248
  v_mfma_f32_16x16x32_bf16 v[88:91], a[192:195], a[172:175], v[88:91]
  buffer_load_dwordx4 a[160:163], v3, s[12:15], s18 offen offset:0 sc1
  v_mfma_f32_16x16x32_bf16 v[84:87], a[196:199], a[168:171], v[84:87]
  ds_read_b64_tr_b16 a[220:221], v11 offset:49152
  ds_read_b64_tr_b16 a[222:223], v11 offset:53248
  v_mfma_f32_16x16x32_bf16 v[92:95], a[196:199], a[172:175], v[92:95]
  buffer_load_dwordx4 a[164:167], v3, s[12:15], s18 offen offset:1024 sc1
  s_waitcnt lgkmcnt(8)
  v_mfma_f32_16x16x32_bf16 v[96:99], a[200:203], a[168:171], v[96:99]
  ds_read_b64_tr_b16 a[192:193], v40 offset:49152
  ds_read_b64_tr_b16 a[194:195], v40 offset:53248
  v_mfma_f32_16x16x32_bf16 v[104:107], a[200:203], a[172:175], v[104:107]
  v_mfma_f32_16x16x32_bf16 v[100:103], a[204:207], a[168:171], v[100:103]
  ds_read_b64_tr_b16 a[196:197], v41 offset:49152
  ds_read_b64_tr_b16 a[198:199], v41 offset:53248
  v_mfma_f32_16x16x32_bf16 v[108:111], a[204:207], a[172:175], v[108:111]
  s_waitcnt vmcnt(24) lgkmcnt(8)
  v_mfma_f32_16x16x32_bf16 v[64:67], a[208:211], a[176:179], v[64:67]
  ds_read_b64_tr_b16 a[200:201], v8 offset:57344
  ds_read_b64_tr_b16 a[202:203], v8 offset:61440
  v_mfma_f32_16x16x32_bf16 v[72:75], a[208:211], a[180:183], v[72:75]
  buffer_load_dwordx4 a[168:171], v3, s[12:15], s18 offen offset:2048 sc1
  v_mfma_f32_16x16x32_bf16 v[68:71], a[212:215], a[176:179], v[68:71]
  ds_read_b64_tr_b16 a[204:205], v9 offset:57344
  ds_read_b64_tr_b16 a[206:207], v9 offset:61440
  v_mfma_f32_16x16x32_bf16 v[76:79], a[212:215], a[180:183], v[76:79]
  buffer_load_dwordx4 a[172:175], v3, s[12:15], s18 offen offset:3072 sc1
  s_add_u32 s18, s18, 4096
  s_cmp_eq_u32 s18, 131072
  s_cselect_b32 s18, 0, s18
  s_waitcnt lgkmcnt(8)
  v_mfma_f32_16x16x32_bf16 v[80:83], a[216:219], a[176:179], v[80:83]
  ds_read_b64_tr_b16 a[208:209], v10 offset:57344
  ds_read_b64_tr_b16 a[210:211], v10 offset:61440
  v_mfma_f32_16x16x32_bf16 v[88:91], a[216:219], a[180:183], v[88:91]
  s_add_u32 m0, s19, 16384
  v_mfma_f32_16x16x32_bf16 v[84:87], a[220:223], a[176:179], v[84:87]
  ds_read_b64_tr_b16 a[212:213], v11 offset:57344
  ds_read_b64_tr_b16 a[214:215], v11 offset:61440
  v_mfma_f32_16x16x32_bf16 v[92:95], a[220:223], a[180:183], v[92:95]
  buffer_load_dwordx4 v48, s[4:7], s66 offen offset:0 lds
  s_waitcnt lgkmcnt(8)
  v_mfma_f32_16x16x32_bf16 v[96:99], a[192:195], a[176:179], v[96:99]
  ds_read_b64_tr_b16 a[216:217], v40 offset:57344
  ds_read_b64_tr_b16 a[218:219], v40 offset:61440
  v_mfma_f32_16x16x32_bf16 v[104:107], a[192:195], a[180:183], v[104:107]
  buffer_load_dwordx4 v49, s[4:7], s66 offen offset:1024 lds
  v_mfma_f32_16x16x32_bf16 v[100:103], a[196:199], a[176:179], v[100:103]
  ds_read_b64_tr_b16 a[220:221], v41 offset:57344
  ds_read_b64_tr_b16 a[222:223], v41 offset:61440
  v_mfma_f32_16x16x32_bf16 v[108:111], a[196:199], a[180:183], v[108:111]
  buffer_load_dwordx4 v50, s[4:7], s66 offen offset:2048 lds
  s_waitcnt vmcnt(27) lgkmcnt(8)
  v_mfma_f32_16x16x32_bf16 v[64:67], a[200:203], a[184:187], v[64:67]
  s_barrier
  ds_read_b64_tr_b16 a[192:193], v208 offset:0
  ds_read_b64_tr_b16 a[194:195], v208 offset:4096
  v_mfma_f32_16x16x32_bf16 v[72:75], a[200:203], a[188:191], v[72:75]
  v_mfma_f32_16x16x32_bf16 v[68:71], a[204:207], a[184:187], v[68:71]
  ds_read_b64_tr_b16 a[196:197], v209 offset:0
  ds_read_b64_tr_b16 a[198:199], v209 offset:4096
  v_mfma_f32_16x16x32_bf16 v[76:79], a[204:207], a[188:191], v[76:79]
  buffer_load_dwordx4 v51, s[4:7], s66 offen offset:3072 lds
  s_add_u32 s66, s66, 524288
  s_cmp_eq_u32 s66, 8388608
  s_cselect_b32 s66, 0, s66
  s_waitcnt lgkmcnt(8)
  v_mfma_f32_16x16x32_bf16 v[80:83], a[208:211], a[184:187], v[80:83]
  ds_read_b64_tr_b16 a[200:201], v210 offset:0
  ds_read_b64_tr_b16 a[202:203], v210 offset:4096
  v_mfma_f32_16x16x32_bf16 v[88:91], a[208:211], a[188:191], v[88:91]
  buffer_load_dwordx4 a[176:179], v3, s[12:15], s18 offen offset:0 sc1
  v_mfma_f32_16x16x32_bf16 v[84:87], a[212:215], a[184:187], v[84:87]
  ds_read_b64_tr_b16 a[204:205], v211 offset:0
  ds_read_b64_tr_b16 a[206:207], v211 offset:4096
  v_mfma_f32_16x16x32_bf16 v[92:95], a[212:215], a[188:191], v[92:95]
  buffer_load_dwordx4 a[180:183], v3, s[12:15], s18 offen offset:1024 sc1
  s_waitcnt lgkmcnt(8)
  v_mfma_f32_16x16x32_bf16 v[96:99], a[216:219], a[184:187], v[96:99]
  ds_read_b64_tr_b16 a[208:209], v212 offset:0
  ds_read_b64_tr_b16 a[210:211], v212 offset:4096
  v_mfma_f32_16x16x32_bf16 v[104:107], a[216:219], a[188:191], v[104:107]
  v_mfma_f32_16x16x32_bf16 v[100:103], a[220:223], a[184:187], v[100:103]
  ds_read_b64_tr_b16 a[212:213], v213 offset:0
  ds_read_b64_tr_b16 a[214:215], v213 offset:4096
  v_mfma_f32_16x16x32_bf16 v[108:111], a[220:223], a[188:191], v[108:111]
  s_waitcnt vmcnt(24) lgkmcnt(8)
  v_mfma_f32_16x16x32_bf16 v[64:67], a[192:195], a[128:131], v[64:67]
  ds_read_b64_tr_b16 a[216:217], v208 offset:8192
  ds_read_b64_tr_b16 a[218:219], v208 offset:12288
  v_mfma_f32_16x16x32_bf16 v[72:75], a[192:195], a[132:135], v[72:75]
  buffer_load_dwordx4 a[184:187], v3, s[12:15], s18 offen offset:2048 sc1
  v_mfma_f32_16x16x32_bf16 v[68:71], a[196:199], a[128:131], v[68:71]
  ds_read_b64_tr_b16 a[220:221], v209 offset:8192
  ds_read_b64_tr_b16 a[222:223], v209 offset:12288
  v_mfma_f32_16x16x32_bf16 v[76:79], a[196:199], a[132:135], v[76:79]
  buffer_load_dwordx4 a[188:191], v3, s[12:15], s18 offen offset:3072 sc1
  s_add_u32 s18, s18, 4096
  s_cmp_eq_u32 s18, 131072
  s_cselect_b32 s18, 0, s18
  s_waitcnt lgkmcnt(8)
  v_mfma_f32_16x16x32_bf16 v[80:83], a[200:203], a[128:131], v[80:83]
  ds_read_b64_tr_b16 a[192:193], v210 offset:8192
  ds_read_b64_tr_b16 a[194:195], v210 offset:12288
  v_mfma_f32_16x16x32_bf16 v[88:91], a[200:203], a[132:135], v[88:91]
  v_mfma_f32_16x16x32_bf16 v[84:87], a[204:207], a[128:131], v[84:87]
  ds_read_b64_tr_b16 a[196:197], v211 offset:8192
  ds_read_b64_tr_b16 a[198:199], v211 offset:12288
  v_mfma_f32_16x16x32_bf16 v[92:95], a[204:207], a[132:135], v[92:95]
  s_waitcnt lgkmcnt(8)
  v_mfma_f32_16x16x32_bf16 v[96:99], a[208:211], a[128:131], v[96:99]
  ds_read_b64_tr_b16 a[200:201], v212 offset:8192
  ds_read_b64_tr_b16 a[202:203], v212 offset:12288
  v_mfma_f32_16x16x32_bf16 v[104:107], a[208:211], a[132:135], v[104:107]
  v_mfma_f32_16x16x32_bf16 v[100:103], a[212:215], a[128:131], v[100:103]
  ds_read_b64_tr_b16 a[204:205], v213 offset:8192
  ds_read_b64_tr_b16 a[206:207], v213 offset:12288
  v_mfma_f32_16x16x32_bf16 v[108:111], a[212:215], a[132:135], v[108:111]
  s_waitcnt vmcnt(24) lgkmcnt(8)
  v_mfma_f32_16x16x32_bf16 v[64:67], a[216:219], a[136:139], v[64:67]
  s_barrier
  ds_read_b64_tr_b16 a[208:209], v208 offset:16384
  ds_read_b64_tr_b16 a[210:211], v208 offset:20480
  v_mfma_f32_16x16x32_bf16 v[72:75], a[216:219], a[140:143], v[72:75]
  buffer_load_dwordx4 a[0:3], v3, s[44:47], s67 offen offset:0 sc1
  v_mfma_f32_16x16x32_bf16 v[68:71], a[220:223], a[136:139], v[68:71]
  ds_read_b64_tr_b16 a[212:213], v209 offset:16384
  ds_read_b64_tr_b16 a[214:215], v209 offset:20480
  v_mfma_f32_16x16x32_bf16 v[76:79], a[220:223], a[140:143], v[76:79]
  buffer_load_dwordx4 a[4:7], v3, s[44:47], s67 offen offset:1024 sc1
  s_waitcnt lgkmcnt(8)
  v_mfma_f32_16x16x32_bf16 v[80:83], a[192:195], a[136:139], v[80:83]
  ds_read_b64_tr_b16 a[216:217], v210 offset:16384
  ds_read_b64_tr_b16 a[218:219], v210 offset:20480
  v_mfma_f32_16x16x32_bf16 v[88:91], a[192:195], a[140:143], v[88:91]
  v_mfma_f32_16x16x32_bf16 v[84:87], a[196:199], a[136:139], v[84:87]
  ds_read_b64_tr_b16 a[220:221], v211 offset:16384
  ds_read_b64_tr_b16 a[222:223], v211 offset:20480
  v_mfma_f32_16x16x32_bf16 v[92:95], a[196:199], a[140:143], v[92:95]
  s_waitcnt lgkmcnt(8)
  v_mfma_f32_16x16x32_bf16 v[96:99], a[200:203], a[136:139], v[96:99]
  ds_read_b64_tr_b16 a[192:193], v212 offset:16384
  ds_read_b64_tr_b16 a[194:195], v212 offset:20480
  v_mfma_f32_16x16x32_bf16 v[104:107], a[200:203], a[140:143], v[104:107]
  v_mfma_f32_16x16x32_bf16 v[100:103], a[204:207], a[136:139], v[100:103]
  ds_read_b64_tr_b16 a[196:197], v213 offset:16384
  ds_read_b64_tr_b16 a[198:199], v213 offset:20480
  v_mfma_f32_16x16x32_bf16 v[108:111], a[204:207], a[140:143], v[108:111]
  s_waitcnt vmcnt(20) lgkmcnt(8)
  v_mfma_f32_16x16x32_bf16 v[64:67], a[208:211], a[144:147], v[64:67]
  ds_read_b64_tr_b16 a[200:201], v208 offset:24576
  ds_read_b64_tr_b16 a[202:203], v208 offset:28672
  v_mfma_f32_16x16x32_bf16 v[72:75], a[208:211], a[148:151], v[72:75]
  buffer_load_dwordx4 a[8:11], v3, s[24:27], s67 offen offset:0 sc1
  v_mfma_f32_16x16x32_bf16 v[68:71], a[212:215], a[144:147], v[68:71]
  ds_read_b64_tr_b16 a[204:205], v209 offset:24576
  ds_read_b64_tr_b16 a[206:207], v209 offset:28672
  v_mfma_f32_16x16x32_bf16 v[76:79], a[212:215], a[148:151], v[76:79]
  buffer_load_dwordx4 a[12:15], v3, s[24:27], s67 offen offset:1024 sc1
  s_waitcnt lgkmcnt(8)
  v_mfma_f32_16x16x32_bf16 v[80:83], a[216:219], a[144:147], v[80:83]
  ds_read_b64_tr_b16 a[208:209], v210 offset:24576
  ds_read_b64_tr_b16 a[210:211], v210 offset:28672
  v_mfma_f32_16x16x32_bf16 v[88:91], a[216:219], a[148:151], v[88:91]
  v_mfma_f32_16x16x32_bf16 v[84:87], a[220:223], a[144:147], v[84:87]
  ds_read_b64_tr_b16 a[212:213], v211 offset:24576
  ds_read_b64_tr_b16 a[214:215], v211 offset:28672
  v_mfma_f32_16x16x32_bf16 v[92:95], a[220:223], a[148:151], v[92:95]
  s_waitcnt lgkmcnt(8)
  v_mfma_f32_16x16x32_bf16 v[96:99], a[192:195], a[144:147], v[96:99]
  ds_read_b64_tr_b16 a[216:217], v212 offset:24576
  ds_read_b64_tr_b16 a[218:219], v212 offset:28672
  v_mfma_f32_16x16x32_bf16 v[104:107], a[192:195], a[148:151], v[104:107]
  v_mfma_f32_16x16x32_bf16 v[100:103], a[196:199], a[144:147], v[100:103]
  ds_read_b64_tr_b16 a[220:221], v213 offset:24576
  ds_read_b64_tr_b16 a[222:223], v213 offset:28672
  v_mfma_f32_16x16x32_bf16 v[108:111], a[196:199], a[148:151], v[108:111]
  s_waitcnt vmcnt(20) lgkmcnt(8)
  v_mfma_f32_16x16x32_bf16 v[64:67], a[200:203], a[152:155], v[64:67]
  s_barrier
  ds_read_b64_tr_b16 a[192:193], v208 offset:32768
  ds_read_b64_tr_b16 a[194:195], v208 offset:36864
  v_mfma_f32_16x16x32_bf16 v[72:75], a[200:203], a[156:159], v[72:75]
  buffer_load_dwordx4 a[16:19], v3, s[44:47], s67 offen offset:2048 sc1
  v_mfma_f32_16x16x32_bf16 v[68:71], a[204:207], a[152:155], v[68:71]
  ds_read_b64_tr_b16 a[196:197], v209 offset:32768
  ds_read_b64_tr_b16 a[198:199], v209 offset:36864
  v_mfma_f32_16x16x32_bf16 v[76:79], a[204:207], a[156:159], v[76:79]
  buffer_load_dwordx4 a[20:23], v3, s[44:47], s67 offen offset:3072 sc1
  s_waitcnt lgkmcnt(8)
  v_mfma_f32_16x16x32_bf16 v[80:83], a[208:211], a[152:155], v[80:83]
  ds_read_b64_tr_b16 a[200:201], v210 offset:32768
  ds_read_b64_tr_b16 a[202:203], v210 offset:36864
  v_mfma_f32_16x16x32_bf16 v[88:91], a[208:211], a[156:159], v[88:91]
  v_mfma_f32_16x16x32_bf16 v[84:87], a[212:215], a[152:155], v[84:87]
  ds_read_b64_tr_b16 a[204:205], v211 offset:32768
  ds_read_b64_tr_b16 a[206:207], v211 offset:36864
  v_mfma_f32_16x16x32_bf16 v[92:95], a[212:215], a[156:159], v[92:95]
  s_waitcnt lgkmcnt(8)
  v_mfma_f32_16x16x32_bf16 v[96:99], a[216:219], a[152:155], v[96:99]
  ds_read_b64_tr_b16 a[208:209], v212 offset:32768
  ds_read_b64_tr_b16 a[210:211], v212 offset:36864
  v_mfma_f32_16x16x32_bf16 v[104:107], a[216:219], a[156:159], v[104:107]
  v_mfma_f32_16x16x32_bf16 v[100:103], a[220:223], a[152:155], v[100:103]
  ds_read_b64_tr_b16 a[212:213], v213 offset:32768
  ds_read_b64_tr_b16 a[214:215], v213 offset:36864
  v_mfma_f32_16x16x32_bf16 v[108:111], a[220:223], a[156:159], v[108:111]
  s_waitcnt vmcnt(16) lgkmcnt(8)
  v_mfma_f32_16x16x32_bf16 v[64:67], a[192:195], a[160:163], v[64:67]
  ds_read_b64_tr_b16 a[216:217], v208 offset:40960
  ds_read_b64_tr_b16 a[218:219], v208 offset:45056
  v_mfma_f32_16x16x32_bf16 v[72:75], a[192:195], a[164:167], v[72:75]
  buffer_load_dwordx4 a[24:27], v3, s[24:27], s67 offen offset:2048 sc1
  v_mfma_f32_16x16x32_bf16 v[68:71], a[196:199], a[160:163], v[68:71]
  ds_read_b64_tr_b16 a[220:221], v209 offset:40960
  ds_read_b64_tr_b16 a[222:223], v209 offset:45056
  v_mfma_f32_16x16x32_bf16 v[76:79], a[196:199], a[164:167], v[76:79]
  buffer_load_dwordx4 a[28:31], v3, s[24:27], s67 offen offset:3072 sc1
  s_add_u32 s67, s67, 4096
  s_cmp_eq_u32 s67, 65536
  s_cselect_b32 s67, 0, s67
  s_waitcnt lgkmcnt(8)
  v_mfma_f32_16x16x32_bf16 v[80:83], a[200:203], a[160:163], v[80:83]
  ds_read_b64_tr_b16 a[192:193], v210 offset:40960
  ds_read_b64_tr_b16 a[194:195], v210 offset:45056
  v_mfma_f32_16x16x32_bf16 v[88:91], a[200:203], a[164:167], v[88:91]
  s_add_u32 m0, s19, 65536
  v_mfma_f32_16x16x32_bf16 v[84:87], a[204:207], a[160:163], v[84:87]
  ds_read_b64_tr_b16 a[196:197], v211 offset:40960
  ds_read_b64_tr_b16 a[198:199], v211 offset:45056
  v_mfma_f32_16x16x32_bf16 v[92:95], a[204:207], a[164:167], v[92:95]
  buffer_load_dwordx4 v12, s[28:31], s43 offen offset:0 lds
  s_waitcnt lgkmcnt(8)
  v_mfma_f32_16x16x32_bf16 v[96:99], a[208:211], a[160:163], v[96:99]
  ds_read_b64_tr_b16 a[200:201], v212 offset:40960
  ds_read_b64_tr_b16 a[202:203], v212 offset:45056
  v_mfma_f32_16x16x32_bf16 v[104:107], a[208:211], a[164:167], v[104:107]
  buffer_load_dwordx4 v13, s[28:31], s43 offen offset:1024 lds
  v_mfma_f32_16x16x32_bf16 v[100:103], a[212:215], a[160:163], v[100:103]
  ds_read_b64_tr_b16 a[204:205], v213 offset:40960
  ds_read_b64_tr_b16 a[206:207], v213 offset:45056
  v_mfma_f32_16x16x32_bf16 v[108:111], a[212:215], a[164:167], v[108:111]
  buffer_load_dwordx4 v14, s[28:31], s43 offen offset:2048 lds
  s_waitcnt vmcnt(19) lgkmcnt(8)
  v_mfma_f32_16x16x32_bf16 v[64:67], a[216:219], a[168:171], v[64:67]
  s_barrier
  ds_read_b64_tr_b16 a[208:209], v208 offset:49152
  ds_read_b64_tr_b16 a[210:211], v208 offset:53248
  v_mfma_f32_16x16x32_bf16 v[72:75], a[216:219], a[172:175], v[72:75]
  v_mfma_f32_16x16x32_bf16 v[68:71], a[220:223], a[168:171], v[68:71]
  ds_read_b64_tr_b16 a[212:213], v209 offset:49152
  ds_read_b64_tr_b16 a[214:215], v209 offset:53248
  v_mfma_f32_16x16x32_bf16 v[76:79], a[220:223], a[172:175], v[76:79]
  buffer_load_dwordx4 v15, s[28:31], s43 offen offset:3072 lds
  s_add_u32 s43, s43, 8192
  s_waitcnt lgkmcnt(8)
  v_mfma_f32_16x16x32_bf16 v[80:83], a[192:195], a[168:171], v[80:83]
  ds_read_b64_tr_b16 a[216:217], v210 offset:49152
  ds_read_b64_tr_b16 a[218:219], v210 offset:53248
  v_mfma_f32_16x16x32_bf16 v[88:91], a[192:195], a[172:175], v[88:91]
  buffer_load_dwordx4 a[32:35], v3, s[44:47], s67 offen offset:0 sc1
  v_mfma_f32_16x16x32_bf16 v[84:87], a[196:199], a[168:171], v[84:87]
  ds_read_b64_tr_b16 a[220:221], v211 offset:49152
  ds_read_b64_tr_b16 a[222:223], v211 offset:53248
  v_mfma_f32_16x16x32_bf16 v[92:95], a[196:199], a[172:175], v[92:95]
  buffer_load_dwordx4 a[36:39], v3, s[44:47], s67 offen offset:1024 sc1
  s_waitcnt lgkmcnt(8)
  v_mfma_f32_16x16x32_bf16 v[96:99], a[200:203], a[168:171], v[96:99]
  ds_read_b64_tr_b16 a[192:193], v212 offset:49152
  ds_read_b64_tr_b16 a[194:195], v212 offset:53248
  v_mfma_f32_16x16x32_bf16 v[104:107], a[200:203], a[172:175], v[104:107]
  v_mfma_f32_16x16x32_bf16 v[100:103], a[204:207], a[168:171], v[100:103]
  ds_read_b64_tr_b16 a[196:197], v213 offset:49152
  ds_read_b64_tr_b16 a[198:199], v213 offset:53248
  v_mfma_f32_16x16x32_bf16 v[108:111], a[204:207], a[172:175], v[108:111]
  s_waitcnt vmcnt(16) lgkmcnt(8)
  v_mfma_f32_16x16x32_bf16 v[64:67], a[208:211], a[176:179], v[64:67]
  ds_read_b64_tr_b16 a[200:201], v208 offset:57344
  ds_read_b64_tr_b16 a[202:203], v208 offset:61440
  v_mfma_f32_16x16x32_bf16 v[72:75], a[208:211], a[180:183], v[72:75]
  buffer_load_dwordx4 a[40:43], v3, s[24:27], s67 offen offset:0 sc1
  v_mfma_f32_16x16x32_bf16 v[68:71], a[212:215], a[176:179], v[68:71]
  ds_read_b64_tr_b16 a[204:205], v209 offset:57344
  ds_read_b64_tr_b16 a[206:207], v209 offset:61440
  v_mfma_f32_16x16x32_bf16 v[76:79], a[212:215], a[180:183], v[76:79]
  buffer_load_dwordx4 a[44:47], v3, s[24:27], s67 offen offset:1024 sc1
  s_add_u32 m0, s19, 81920
  s_waitcnt lgkmcnt(8)
  v_mfma_f32_16x16x32_bf16 v[80:83], a[216:219], a[176:179], v[80:83]
  ds_read_b64_tr_b16 a[208:209], v210 offset:57344
  ds_read_b64_tr_b16 a[210:211], v210 offset:61440
  v_mfma_f32_16x16x32_bf16 v[88:91], a[216:219], a[180:183], v[88:91]
  buffer_load_dwordx4 v12, s[28:31], s43 offen offset:0 lds
  v_mfma_f32_16x16x32_bf16 v[84:87], a[220:223], a[176:179], v[84:87]
  ds_read_b64_tr_b16 a[212:213], v211 offset:57344
  ds_read_b64_tr_b16 a[214:215], v211 offset:61440
  v_mfma_f32_16x16x32_bf16 v[92:95], a[220:223], a[180:183], v[92:95]
  s_waitcnt lgkmcnt(8)
  v_mfma_f32_16x16x32_bf16 v[96:99], a[192:195], a[176:179], v[96:99]
  ds_read_b64_tr_b16 a[216:217], v212 offset:57344
  ds_read_b64_tr_b16 a[218:219], v212 offset:61440
  v_mfma_f32_16x16x32_bf16 v[104:107], a[192:195], a[180:183], v[104:107]
  buffer_load_dwordx4 v13, s[28:31], s43 offen offset:1024 lds
  v_mfma_f32_16x16x32_bf16 v[100:103], a[196:199], a[176:179], v[100:103]
  ds_read_b64_tr_b16 a[220:221], v213 offset:57344
  ds_read_b64_tr_b16 a[222:223], v213 offset:61440
  v_mfma_f32_16x16x32_bf16 v[108:111], a[196:199], a[180:183], v[108:111]
  buffer_load_dwordx4 v14, s[28:31], s43 offen offset:2048 lds
  s_waitcnt vmcnt(19) lgkmcnt(8)
  v_mfma_f32_16x16x32_bf16 v[64:67], a[200:203], a[184:187], v[64:67]
  s_barrier
  ds_read_b64_tr_b16 a[192:193], v8 offset:0
  ds_read_b64_tr_b16 a[194:195], v8 offset:4096
  v_mfma_f32_16x16x32_bf16 v[72:75], a[200:203], a[188:191], v[72:75]
  buffer_load_dwordx4 v15, s[28:31], s43 offen offset:3072 lds
  s_add_u32 s43, s43, 8192
  v_mfma_f32_16x16x32_bf16 v[68:71], a[204:207], a[184:187], v[68:71]
  ds_read_b64_tr_b16 a[196:197], v9 offset:0
  ds_read_b64_tr_b16 a[198:199], v9 offset:4096
  v_mfma_f32_16x16x32_bf16 v[76:79], a[204:207], a[188:191], v[76:79]
  s_waitcnt lgkmcnt(8)
  v_mfma_f32_16x16x32_bf16 v[80:83], a[208:211], a[184:187], v[80:83]
  ds_read_b64_tr_b16 a[200:201], v10 offset:0
  ds_read_b64_tr_b16 a[202:203], v10 offset:4096
  v_mfma_f32_16x16x32_bf16 v[88:91], a[208:211], a[188:191], v[88:91]
  v_mfma_f32_16x16x32_bf16 v[84:87], a[212:215], a[184:187], v[84:87]
  v_mfma_f32_16x16x32_bf16 v[92:95], a[212:215], a[188:191], v[92:95]
  s_waitcnt lgkmcnt(6)
  v_mfma_f32_16x16x32_bf16 v[96:99], a[216:219], a[184:187], v[96:99]
  v_mfma_f32_16x16x32_bf16 v[104:107], a[216:219], a[188:191], v[104:107]
  v_mfma_f32_16x16x32_bf16 v[100:103], a[220:223], a[184:187], v[100:103]
  v_mfma_f32_16x16x32_bf16 v[108:111], a[220:223], a[188:191], v[108:111]
  s_waitcnt vmcnt(16) lgkmcnt(2)
  v_mfma_f32_16x16x32_bf16 v[128:131], a[192:195], a[0:3], 0
  ds_read_b64_tr_b16 a[204:205], v11 offset:0
  s_lshl_b32 s21, s38, 2
  v_mfma_f32_16x16x32_bf16 v[132:135], a[192:195], a[4:7], 0
  ds_read_b64_tr_b16 a[206:207], v11 offset:4096
  s_add_u32 s21, s21, s16
  s_mul_i32 s22, s21, 229376
  v_mfma_f32_16x16x32_bf16 v[136:139], a[192:195], a[8:11], 0
  buffer_load_dwordx4 a[48:51], v3, s[44:47], s67 offen offset:2048 sc1
  s_add_u32 s22, s22, 25165824
  s_add_u32 s32, s96, s22
  s_addc_u32 s33, s97, 0
  v_mfma_f32_16x16x32_bf16 v[140:143], a[192:195], a[12:15], 0
  s_and_b32 s33, s33, 0xffff
  s_mov_b32 s34, 229376
  v_mfma_f32_16x16x32_bf16 v[144:147], a[196:199], a[0:3], 0
  ds_read_b64_tr_b16 a[208:209], v40 offset:0
  s_mov_b32 s35, 0x00020000
  v_mov_b32 v35, 0xc0135761
  v_mfma_f32_16x16x32_bf16 v[148:151], a[196:199], a[4:7], 0
  ds_read_b64_tr_b16 a[210:211], v40 offset:4096
  s_mov_b32 s23, 0xbdd2d3e8
  s_lshl_b32 s65, s71, 6
  v_mfma_f32_16x16x32_bf16 v[152:155], a[196:199], a[8:11], 0
  buffer_load_dwordx4 a[52:55], v3, s[44:47], s67 offen offset:3072 sc1
  v_mul_f32 v36, v64, v64
  v_mfma_f32_16x16x32_bf16 v[156:159], a[196:199], a[12:15], 0
  v_mul_f32 v37, v65, v65
  v_mul_f32 v38, v66, v66
  s_waitcnt lgkmcnt(2)
  v_mfma_f32_16x16x32_bf16 v[160:163], a[200:203], a[0:3], 0
  ds_read_b64_tr_b16 a[212:213], v41 offset:0
  v_mul_f32 v39, v67, v67
  v_fma_f32 v36, v36, s23, v35
  v_mfma_f32_16x16x32_bf16 v[164:167], a[200:203], a[4:7], 0
  ds_read_b64_tr_b16 a[214:215], v41 offset:4096
  v_fma_f32 v37, v37, s23, v35
  v_fma_f32 v38, v38, s23, v35
  v_mfma_f32_16x16x32_bf16 v[168:171], a[200:203], a[8:11], 0
  buffer_load_dwordx4 a[56:59], v3, s[24:27], s67 offen offset:2048 sc1
  v_fma_f32 v39, v39, s23, v35
  v_mul_f32 v36, v36, v64
  v_mfma_f32_16x16x32_bf16 v[172:175], a[200:203], a[12:15], 0
  v_mul_f32 v37, v37, v65
  v_mul_f32 v38, v38, v66
  v_mfma_f32_16x16x32_bf16 v[176:179], a[204:207], a[0:3], 0
  ds_read_b64_tr_b16 a[216:217], v42 offset:0
  v_mul_f32 v39, v39, v67
  v_exp_f32 v36, v36
  v_mfma_f32_16x16x32_bf16 v[180:183], a[204:207], a[4:7], 0
  ds_read_b64_tr_b16 a[218:219], v42 offset:4096
  v_exp_f32 v37, v37
  v_mfma_f32_16x16x32_bf16 v[184:187], a[204:207], a[8:11], 0
  buffer_load_dwordx4 a[60:63], v3, s[24:27], s67 offen offset:3072 sc1
  s_add_u32 s67, s67, 4096
  s_cmp_eq_u32 s67, 65536
  s_cselect_b32 s67, 0, s67
  v_exp_f32 v38, v38
  v_exp_f32 v39, v39
  v_mfma_f32_16x16x32_bf16 v[188:191], a[204:207], a[12:15], 0
  s_add_u32 m0, s19, 32768
  v_add_f32 v36, 1.0, v36
  v_add_f32 v37, 1.0, v37
  s_waitcnt lgkmcnt(2)
  v_mfma_f32_16x16x32_bf16 v[192:195], a[208:211], a[0:3], 0
  ds_read_b64_tr_b16 a[220:221], v43 offset:0
  v_add_f32 v38, 1.0, v38
  v_add_f32 v39, 1.0, v39
  v_mfma_f32_16x16x32_bf16 v[196:199], a[208:211], a[4:7], 0
  ds_read_b64_tr_b16 a[222:223], v43 offset:4096
  v_rcp_f32 v36, v36
  v_rcp_f32 v37, v37
  v_mfma_f32_16x16x32_bf16 v[200:203], a[208:211], a[8:11], 0
  v_rcp_f32 v38, v38
  v_rcp_f32 v39, v39
  v_mfma_f32_16x16x32_bf16 v[204:207], a[208:211], a[12:15], 0
  buffer_load_dwordx4 v48, s[4:7], s66 offen offset:0 lds
  v_mul_f32 v64, v64, v36
  v_mfma_f32_16x16x32_bf16 v[208:211], a[212:215], a[0:3], 0
  ds_read_b64_tr_b16 a[192:193], v8 offset:8192
  v_mul_f32 v65, v65, v37
  v_mul_f32 v66, v66, v38
  v_mfma_f32_16x16x32_bf16 v[212:215], a[212:215], a[4:7], 0
  ds_read_b64_tr_b16 a[194:195], v8 offset:12288
  v_mul_f32 v67, v67, v39
  v_cvt_pk_bf16_f32 v64, v64, v65
  v_mfma_f32_16x16x32_bf16 v[216:219], a[212:215], a[8:11], 0
  v_cvt_pk_bf16_f32 v65, v66, v67
  v_mul_f32 v36, v68, v68
  v_mfma_f32_16x16x32_bf16 v[220:223], a[212:215], a[12:15], 0
  buffer_load_dwordx4 v49, s[4:7], s66 offen offset:1024 lds
  v_mul_f32 v37, v69, v69
  v_mul_f32 v38, v70, v70
  s_waitcnt lgkmcnt(2)
  v_mfma_f32_16x16x32_bf16 v[224:227], a[216:219], a[0:3], 0
  ds_read_b64_tr_b16 a[196:197], v9 offset:8192
  v_mul_f32 v39, v71, v71
  v_fma_f32 v36, v36, s23, v35
  v_mfma_f32_16x16x32_bf16 v[228:231], a[216:219], a[4:7], 0
  ds_read_b64_tr_b16 a[198:199], v9 offset:12288
  v_fma_f32 v37, v37, s23, v35
  v_fma_f32 v38, v38, s23, v35
  v_mfma_f32_16x16x32_bf16 v[232:235], a[216:219], a[8:11], 0
  v_fma_f32 v39, v39, s23, v35
  v_mfma_f32_16x16x32_bf16 v[236:239], a[216:219], a[12:15], 0
  buffer_load_dwordx4 v50, s[4:7], s66 offen offset:2048 lds
  v_mul_f32 v36, v36, v68
  v_mul_f32 v37, v37, v69
  v_mfma_f32_16x16x32_bf16 v[240:243], a[220:223], a[0:3], 0
  ds_read_b64_tr_b16 a[200:201], v10 offset:8192
  v_mul_f32 v38, v38, v70
  v_mul_f32 v39, v39, v71
  v_mfma_f32_16x16x32_bf16 v[244:247], a[220:223], a[4:7], 0
  ds_read_b64_tr_b16 a[202:203], v10 offset:12288
  v_exp_f32 v36, v36
  v_exp_f32 v37, v37
  v_mfma_f32_16x16x32_bf16 v[248:251], a[220:223], a[8:11], 0
  v_exp_f32 v38, v38
  v_exp_f32 v39, v39
  v_mfma_f32_16x16x32_bf16 v[252:255], a[220:223], a[12:15], 0
  buffer_load_dwordx4 v51, s[4:7], s66 offen offset:3072 lds
  s_add_u32 s66, s66, 524288
  s_cmp_eq_u32 s66, 8388608
  s_cselect_b32 s66, 0, s66
  v_add_f32 v36, 1.0, v36
  v_add_f32 v37, 1.0, v37
  s_waitcnt vmcnt(20) lgkmcnt(2)
  v_mfma_f32_16x16x32_bf16 v[128:131], a[192:195], a[16:19], v[128:131]
  ds_read_b64_tr_b16 a[204:205], v11 offset:8192
  v_add_f32 v38, 1.0, v38
  v_mfma_f32_16x16x32_bf16 v[132:135], a[192:195], a[20:23], v[132:135]
  ds_read_b64_tr_b16 a[206:207], v11 offset:12288
  v_add_f32 v39, 1.0, v39
  v_rcp_f32 v36, v36
  v_mfma_f32_16x16x32_bf16 v[136:139], a[192:195], a[24:27], v[136:139]
  v_rcp_f32 v37, v37
  v_rcp_f32 v38, v38
  v_mfma_f32_16x16x32_bf16 v[140:143], a[192:195], a[28:31], v[140:143]
  v_rcp_f32 v39, v39
  v_mul_f32 v68, v68, v36
  v_mfma_f32_16x16x32_bf16 v[144:147], a[196:199], a[16:19], v[144:147]
  ds_read_b64_tr_b16 a[208:209], v40 offset:8192
  v_mul_f32 v69, v69, v37
  v_mul_f32 v70, v70, v38
  v_mfma_f32_16x16x32_bf16 v[148:151], a[196:199], a[20:23], v[148:151]
  ds_read_b64_tr_b16 a[210:211], v40 offset:12288
  v_mul_f32 v71, v71, v39
  v_cvt_pk_bf16_f32 v66, v68, v69
  v_mfma_f32_16x16x32_bf16 v[152:155], a[196:199], a[24:27], v[152:155]
  buffer_load_dwordx4 a[0:3], v3, s[44:47], s67 offen offset:0 sc1
  v_cvt_pk_bf16_f32 v67, v70, v71
  buffer_store_dwordx4 v[64:67], v3, s[32:35], s65 offen offset:0 sc1
  v_mfma_f32_16x16x32_bf16 v[156:159], a[196:199], a[28:31], v[156:159]
  v_mul_f32 v36, v72, v72
  s_waitcnt lgkmcnt(2)
  v_mfma_f32_16x16x32_bf16 v[160:163], a[200:203], a[16:19], v[160:163]
  ds_read_b64_tr_b16 a[212:213], v41 offset:8192
  v_mul_f32 v37, v73, v73
  v_mul_f32 v38, v74, v74
  v_mfma_f32_16x16x32_bf16 v[164:167], a[200:203], a[20:23], v[164:167]
  ds_read_b64_tr_b16 a[214:215], v41 offset:12288
  v_mul_f32 v39, v75, v75
  v_fma_f32 v36, v36, s23, v35
  v_mfma_f32_16x16x32_bf16 v[168:171], a[200:203], a[24:27], v[168:171]
  buffer_load_dwordx4 a[4:7], v3, s[44:47], s67 offen offset:1024 sc1
  v_fma_f32 v37, v37, s23, v35
  v_fma_f32 v38, v38, s23, v35
  v_mfma_f32_16x16x32_bf16 v[172:175], a[200:203], a[28:31], v[172:175]
  v_fma_f32 v39, v39, s23, v35
  v_mul_f32 v36, v36, v72
  v_mfma_f32_16x16x32_bf16 v[176:179], a[204:207], a[16:19], v[176:179]
  ds_read_b64_tr_b16 a[216:217], v42 offset:8192
  v_mul_f32 v37, v37, v73
  v_mul_f32 v38, v38, v74
  v_mfma_f32_16x16x32_bf16 v[180:183], a[204:207], a[20:23], v[180:183]
  ds_read_b64_tr_b16 a[218:219], v42 offset:12288
  v_mul_f32 v39, v39, v75
  v_exp_f32 v36, v36
  v_mfma_f32_16x16x32_bf16 v[184:187], a[204:207], a[24:27], v[184:187]
  buffer_load_dwordx4 a[8:11], v3, s[24:27], s67 offen offset:0 sc1
  v_exp_f32 v37, v37
  v_mfma_f32_16x16x32_bf16 v[188:191], a[204:207], a[28:31], v[188:191]
  v_exp_f32 v38, v38
  v_exp_f32 v39, v39
  s_waitcnt lgkmcnt(2)
  v_mfma_f32_16x16x32_bf16 v[192:195], a[208:211], a[16:19], v[192:195]
  ds_read_b64_tr_b16 a[220:221], v43 offset:8192
  v_add_f32 v36, 1.0, v36
  v_add_f32 v37, 1.0, v37
  v_mfma_f32_16x16x32_bf16 v[196:199], a[208:211], a[20:23], v[196:199]
  ds_read_b64_tr_b16 a[222:223], v43 offset:12288
  v_add_f32 v38, 1.0, v38
  v_add_f32 v39, 1.0, v39
  v_mfma_f32_16x16x32_bf16 v[200:203], a[208:211], a[24:27], v[200:203]
  buffer_load_dwordx4 a[12:15], v3, s[24:27], s67 offen offset:1024 sc1
  v_rcp_f32 v36, v36
  v_rcp_f32 v37, v37
  v_mfma_f32_16x16x32_bf16 v[204:207], a[208:211], a[28:31], v[204:207]
  v_rcp_f32 v38, v38
  v_rcp_f32 v39, v39
  v_mfma_f32_16x16x32_bf16 v[208:211], a[212:215], a[16:19], v[208:211]
  s_barrier
  ds_read_b64_tr_b16 a[192:193], v8 offset:16384
  v_mul_f32 v72, v72, v36
  v_mfma_f32_16x16x32_bf16 v[212:215], a[212:215], a[20:23], v[212:215]
  ds_read_b64_tr_b16 a[194:195], v8 offset:20480
  v_mul_f32 v73, v73, v37
  v_mul_f32 v74, v74, v38
  v_mfma_f32_16x16x32_bf16 v[216:219], a[212:215], a[24:27], v[216:219]
  v_mul_f32 v75, v75, v39
  v_cvt_pk_bf16_f32 v72, v72, v73
  v_mfma_f32_16x16x32_bf16 v[220:223], a[212:215], a[28:31], v[220:223]
  v_cvt_pk_bf16_f32 v73, v74, v75
  v_mul_f32 v36, v76, v76
  s_waitcnt lgkmcnt(2)
  v_mfma_f32_16x16x32_bf16 v[224:227], a[216:219], a[16:19], v[224:227]
  ds_read_b64_tr_b16 a[196:197], v9 offset:16384
  v_mul_f32 v37, v77, v77
  v_mul_f32 v38, v78, v78
  v_mfma_f32_16x16x32_bf16 v[228:231], a[216:219], a[20:23], v[228:231]
  ds_read_b64_tr_b16 a[198:199], v9 offset:20480
  v_mul_f32 v39, v79, v79
  v_fma_f32 v36, v36, s23, v35
  v_mfma_f32_16x16x32_bf16 v[232:235], a[216:219], a[24:27], v[232:235]
  v_fma_f32 v37, v37, s23, v35
  v_fma_f32 v38, v38, s23, v35
  v_mfma_f32_16x16x32_bf16 v[236:239], a[216:219], a[28:31], v[236:239]
  v_fma_f32 v39, v39, s23, v35
  v_mfma_f32_16x16x32_bf16 v[240:243], a[220:223], a[16:19], v[240:243]
  ds_read_b64_tr_b16 a[200:201], v10 offset:16384
  v_mul_f32 v36, v36, v76
  v_mul_f32 v37, v37, v77
  v_mfma_f32_16x16x32_bf16 v[244:247], a[220:223], a[20:23], v[244:247]
  ds_read_b64_tr_b16 a[202:203], v10 offset:20480
  v_mul_f32 v38, v38, v78
  v_mul_f32 v39, v39, v79
  v_mfma_f32_16x16x32_bf16 v[248:251], a[220:223], a[24:27], v[248:251]
  v_exp_f32 v36, v36
  v_exp_f32 v37, v37
  v_mfma_f32_16x16x32_bf16 v[252:255], a[220:223], a[28:31], v[252:255]
  v_exp_f32 v38, v38
  v_exp_f32 v39, v39
  s_waitcnt vmcnt(17) lgkmcnt(2)
  v_mfma_f32_16x16x32_bf16 v[128:131], a[192:195], a[32:35], v[128:131]
  ds_read_b64_tr_b16 a[204:205], v11 offset:16384
  v_add_f32 v36, 1.0, v36
  v_add_f32 v37, 1.0, v37
  v_mfma_f32_16x16x32_bf16 v[132:135], a[192:195], a[36:39], v[132:135]
  ds_read_b64_tr_b16 a[206:207], v11 offset:20480
  v_add_f32 v38, 1.0, v38
  v_mfma_f32_16x16x32_bf16 v[136:139], a[192:195], a[40:43], v[136:139]
  buffer_load_dwordx4 a[16:19], v3, s[44:47], s67 offen offset:2048 sc1
  v_add_f32 v39, 1.0, v39
  v_rcp_f32 v36, v36
  v_mfma_f32_16x16x32_bf16 v[140:143], a[192:195], a[44:47], v[140:143]
  v_rcp_f32 v37, v37
  v_rcp_f32 v38, v38
  v_mfma_f32_16x16x32_bf16 v[144:147], a[196:199], a[32:35], v[144:147]
  ds_read_b64_tr_b16 a[208:209], v40 offset:16384
  v_rcp_f32 v39, v39
  v_mul_f32 v76, v76, v36
  v_mfma_f32_16x16x32_bf16 v[148:151], a[196:199], a[36:39], v[148:151]
  ds_read_b64_tr_b16 a[210:211], v40 offset:20480
  v_mul_f32 v77, v77, v37
  v_mul_f32 v78, v78, v38
  v_mfma_f32_16x16x32_bf16 v[152:155], a[196:199], a[40:43], v[152:155]
  buffer_load_dwordx4 a[20:23], v3, s[44:47], s67 offen offset:3072 sc1
  v_mul_f32 v79, v79, v39
  v_cvt_pk_bf16_f32 v74, v76, v77
  v_mfma_f32_16x16x32_bf16 v[156:159], a[196:199], a[44:47], v[156:159]
  v_cvt_pk_bf16_f32 v75, v78, v79
  buffer_store_dwordx4 v[72:75], v3, s[32:35], s65 offen offset:1024 sc1
  s_waitcnt lgkmcnt(2)
  v_mfma_f32_16x16x32_bf16 v[160:163], a[200:203], a[32:35], v[160:163]
  ds_read_b64_tr_b16 a[212:213], v41 offset:16384
  v_mul_f32 v36, v80, v80
  v_mfma_f32_16x16x32_bf16 v[164:167], a[200:203], a[36:39], v[164:167]
  ds_read_b64_tr_b16 a[214:215], v41 offset:20480
  v_mul_f32 v37, v81, v81
  v_mul_f32 v38, v82, v82
  v_mfma_f32_16x16x32_bf16 v[168:171], a[200:203], a[40:43], v[168:171]
  buffer_load_dwordx4 a[24:27], v3, s[24:27], s67 offen offset:2048 sc1
  v_mul_f32 v39, v83, v83
  v_fma_f32 v36, v36, s23, v35
  v_mfma_f32_16x16x32_bf16 v[172:175], a[200:203], a[44:47], v[172:175]
  v_fma_f32 v37, v37, s23, v35
  v_fma_f32 v38, v38, s23, v35
  v_mfma_f32_16x16x32_bf16 v[176:179], a[204:207], a[32:35], v[176:179]
  ds_read_b64_tr_b16 a[216:217], v42 offset:16384
  v_fma_f32 v39, v39, s23, v35
  v_mul_f32 v36, v36, v80
  v_mfma_f32_16x16x32_bf16 v[180:183], a[204:207], a[36:39], v[180:183]
  ds_read_b64_tr_b16 a[218:219], v42 offset:20480
  v_mul_f32 v37, v37, v81
  v_mul_f32 v38, v38, v82
  v_mfma_f32_16x16x32_bf16 v[184:187], a[204:207], a[40:43], v[184:187]
  buffer_load_dwordx4 a[28:31], v3, s[24:27], s67 offen offset:3072 sc1
  s_add_u32 s67, s67, 4096
  s_cmp_eq_u32 s67, 65536
  s_cselect_b32 s67, 0, s67
  v_mul_f32 v39, v39, v83
  v_mfma_f32_16x16x32_bf16 v[188:191], a[204:207], a[44:47], v[188:191]
  s_add_u32 m0, s19, 49152
  v_exp_f32 v36, v36
  v_exp_f32 v37, v37
  s_waitcnt lgkmcnt(2)
  v_mfma_f32_16x16x32_bf16 v[192:195], a[208:211], a[32:35], v[192:195]
  ds_read_b64_tr_b16 a[220:221], v43 offset:16384
  v_exp_f32 v38, v38
  v_exp_f32 v39, v39
  v_mfma_f32_16x16x32_bf16 v[196:199], a[208:211], a[36:39], v[196:199]
  ds_read_b64_tr_b16 a[222:223], v43 offset:20480
  v_add_f32 v36, 1.0, v36
  v_add_f32 v37, 1.0, v37
  v_mfma_f32_16x16x32_bf16 v[200:203], a[208:211], a[40:43], v[200:203]
  v_add_f32 v38, 1.0, v38
  v_add_f32 v39, 1.0, v39
  v_mfma_f32_16x16x32_bf16 v[204:207], a[208:211], a[44:47], v[204:207]
  buffer_load_dwordx4 v48, s[4:7], s66 offen offset:0 lds
  v_rcp_f32 v36, v36
  v_rcp_f32 v37, v37
  v_mfma_f32_16x16x32_bf16 v[208:211], a[212:215], a[32:35], v[208:211]
  ds_read_b64_tr_b16 a[192:193], v8 offset:24576
  v_rcp_f32 v38, v38
  v_rcp_f32 v39, v39
  v_mfma_f32_16x16x32_bf16 v[212:215], a[212:215], a[36:39], v[212:215]
  ds_read_b64_tr_b16 a[194:195], v8 offset:28672
  v_mul_f32 v80, v80, v36
  v_mfma_f32_16x16x32_bf16 v[216:219], a[212:215], a[40:43], v[216:219]
  v_mul_f32 v81, v81, v37
  v_mul_f32 v82, v82, v38
  v_mfma_f32_16x16x32_bf16 v[220:223], a[212:215], a[44:47], v[220:223]
  buffer_load_dwordx4 v49, s[4:7], s66 offen offset:1024 lds
  v_mul_f32 v83, v83, v39
  v_cvt_pk_bf16_f32 v80, v80, v81
  s_waitcnt lgkmcnt(2)
  v_mfma_f32_16x16x32_bf16 v[224:227], a[216:219], a[32:35], v[224:227]
  ds_read_b64_tr_b16 a[196:197], v9 offset:24576
  v_cvt_pk_bf16_f32 v81, v82, v83
  v_mul_f32 v36, v84, v84
  v_mfma_f32_16x16x32_bf16 v[228:231], a[216:219], a[36:39], v[228:231]
  ds_read_b64_tr_b16 a[198:199], v9 offset:28672
  v_mul_f32 v37, v85, v85
  v_mul_f32 v38, v86, v86
  v_mfma_f32_16x16x32_bf16 v[232:235], a[216:219], a[40:43], v[232:235]
  v_mul_f32 v39, v87, v87
  v_fma_f32 v36, v36, s23, v35
  v_mfma_f32_16x16x32_bf16 v[236:239], a[216:219], a[44:47], v[236:239]
  buffer_load_dwordx4 v50, s[4:7], s66 offen offset:2048 lds
  v_fma_f32 v37, v37, s23, v35
  v_fma_f32 v38, v38, s23, v35
  v_mfma_f32_16x16x32_bf16 v[240:243], a[220:223], a[32:35], v[240:243]
  ds_read_b64_tr_b16 a[200:201], v10 offset:24576
  v_fma_f32 v39, v39, s23, v35
  v_mfma_f32_16x16x32_bf16 v[244:247], a[220:223], a[36:39], v[244:247]
  ds_read_b64_tr_b16 a[202:203], v10 offset:28672
  v_mul_f32 v36, v36, v84
  v_mul_f32 v37, v37, v85
  v_mfma_f32_16x16x32_bf16 v[248:251], a[220:223], a[40:43], v[248:251]
  v_mul_f32 v38, v38, v86
  v_mul_f32 v39, v39, v87
  v_mfma_f32_16x16x32_bf16 v[252:255], a[220:223], a[44:47], v[252:255]
  buffer_load_dwordx4 v51, s[4:7], s66 offen offset:3072 lds
  s_add_u32 s66, s66, 524288
  s_cmp_eq_u32 s66, 8388608
  s_cselect_b32 s66, 0, s66
  v_exp_f32 v36, v36
  v_exp_f32 v37, v37
  s_waitcnt vmcnt(18) lgkmcnt(2)
  v_mfma_f32_16x16x32_bf16 v[128:131], a[192:195], a[48:51], v[128:131]
  ds_read_b64_tr_b16 a[204:205], v11 offset:24576
  v_exp_f32 v38, v38
  v_exp_f32 v39, v39
  v_mfma_f32_16x16x32_bf16 v[132:135], a[192:195], a[52:55], v[132:135]
  ds_read_b64_tr_b16 a[206:207], v11 offset:28672
  v_add_f32 v36, 1.0, v36
  v_add_f32 v37, 1.0, v37
  v_mfma_f32_16x16x32_bf16 v[136:139], a[192:195], a[56:59], v[136:139]
  v_add_f32 v38, 1.0, v38
  v_mfma_f32_16x16x32_bf16 v[140:143], a[192:195], a[60:63], v[140:143]
  v_add_f32 v39, 1.0, v39
  v_rcp_f32 v36, v36
  v_mfma_f32_16x16x32_bf16 v[144:147], a[196:199], a[48:51], v[144:147]
  ds_read_b64_tr_b16 a[208:209], v40 offset:24576
  v_rcp_f32 v37, v37
  v_rcp_f32 v38, v38
  v_mfma_f32_16x16x32_bf16 v[148:151], a[196:199], a[52:55], v[148:151]
  ds_read_b64_tr_b16 a[210:211], v40 offset:28672
  v_rcp_f32 v39, v39
  v_mul_f32 v84, v84, v36
  v_mfma_f32_16x16x32_bf16 v[152:155], a[196:199], a[56:59], v[152:155]
  buffer_load_dwordx4 a[32:35], v3, s[44:47], s67 offen offset:0 sc1
  v_mul_f32 v85, v85, v37
  v_mul_f32 v86, v86, v38
  v_mfma_f32_16x16x32_bf16 v[156:159], a[196:199], a[60:63], v[156:159]
  v_mul_f32 v87, v87, v39
  v_cvt_pk_bf16_f32 v82, v84, v85
  s_waitcnt lgkmcnt(2)
  v_mfma_f32_16x16x32_bf16 v[160:163], a[200:203], a[48:51], v[160:163]
  ds_read_b64_tr_b16 a[212:213], v41 offset:24576
  v_cvt_pk_bf16_f32 v83, v86, v87
  buffer_store_dwordx4 v[80:83], v3, s[32:35], s65 offen offset:2048 sc1
  v_mfma_f32_16x16x32_bf16 v[164:167], a[200:203], a[52:55], v[164:167]
  ds_read_b64_tr_b16 a[214:215], v41 offset:28672
  v_mul_f32 v36, v88, v88
  v_mfma_f32_16x16x32_bf16 v[168:171], a[200:203], a[56:59], v[168:171]
  buffer_load_dwordx4 a[36:39], v3, s[44:47], s67 offen offset:1024 sc1
  v_mul_f32 v37, v89, v89
  v_mul_f32 v38, v90, v90
  v_mfma_f32_16x16x32_bf16 v[172:175], a[200:203], a[60:63], v[172:175]
  v_mul_f32 v39, v91, v91
  v_fma_f32 v36, v36, s23, v35
  v_mfma_f32_16x16x32_bf16 v[176:179], a[204:207], a[48:51], v[176:179]
  ds_read_b64_tr_b16 a[216:217], v42 offset:24576
  v_fma_f32 v37, v37, s23, v35
  v_fma_f32 v38, v38, s23, v35
  v_mfma_f32_16x16x32_bf16 v[180:183], a[204:207], a[52:55], v[180:183]
  ds_read_b64_tr_b16 a[218:219], v42 offset:28672
  v_fma_f32 v39, v39, s23, v35
  v_mul_f32 v36, v36, v88
  v_mfma_f32_16x16x32_bf16 v[184:187], a[204:207], a[56:59], v[184:187]
  buffer_load_dwordx4 a[40:43], v3, s[24:27], s67 offen offset:0 sc1
  v_mul_f32 v37, v37, v89
  v_mul_f32 v38, v38, v90
  v_mfma_f32_16x16x32_bf16 v[188:191], a[204:207], a[60:63], v[188:191]
  v_mul_f32 v39, v39, v91
  s_waitcnt lgkmcnt(2)
  v_mfma_f32_16x16x32_bf16 v[192:195], a[208:211], a[48:51], v[192:195]
  ds_read_b64_tr_b16 a[220:221], v43 offset:24576
  v_exp_f32 v36, v36
  v_exp_f32 v37, v37
  v_mfma_f32_16x16x32_bf16 v[196:199], a[208:211], a[52:55], v[196:199]
  ds_read_b64_tr_b16 a[222:223], v43 offset:28672
  v_exp_f32 v38, v38
  v_exp_f32 v39, v39
  v_mfma_f32_16x16x32_bf16 v[200:203], a[208:211], a[56:59], v[200:203]
  buffer_load_dwordx4 a[44:47], v3, s[24:27], s67 offen offset:1024 sc1
  v_add_f32 v36, 1.0, v36
  v_add_f32 v37, 1.0, v37
  v_mfma_f32_16x16x32_bf16 v[204:207], a[208:211], a[60:63], v[204:207]
  v_add_f32 v38, 1.0, v38
  v_add_f32 v39, 1.0, v39
  v_mfma_f32_16x16x32_bf16 v[208:211], a[212:215], a[48:51], v[208:211]
  s_waitcnt vmcnt(19)
  s_barrier
  ds_read_b64_tr_b16 a[192:193], v8 offset:32768
  v_rcp_f32 v36, v36
  v_rcp_f32 v37, v37
  v_mfma_f32_16x16x32_bf16 v[212:215], a[212:215], a[52:55], v[212:215]
  ds_read_b64_tr_b16 a[194:195], v8 offset:36864
  v_rcp_f32 v38, v38
  v_rcp_f32 v39, v39
  v_mfma_f32_16x16x32_bf16 v[216:219], a[212:215], a[56:59], v[216:219]
  v_mul_f32 v88, v88, v36
  v_mfma_f32_16x16x32_bf16 v[220:223], a[212:215], a[60:63], v[220:223]
  v_mul_f32 v89, v89, v37
  v_mul_f32 v90, v90, v38
  s_waitcnt lgkmcnt(2)
  v_mfma_f32_16x16x32_bf16 v[224:227], a[216:219], a[48:51], v[224:227]
  ds_read_b64_tr_b16 a[196:197], v9 offset:32768
  v_mul_f32 v91, v91, v39
  v_cvt_pk_bf16_f32 v88, v88, v89
  v_mfma_f32_16x16x32_bf16 v[228:231], a[216:219], a[52:55], v[228:231]
  ds_read_b64_tr_b16 a[198:199], v9 offset:36864
  v_cvt_pk_bf16_f32 v89, v90, v91
  v_mul_f32 v36, v92, v92
  v_mfma_f32_16x16x32_bf16 v[232:235], a[216:219], a[56:59], v[232:235]
  v_mul_f32 v37, v93, v93
  v_mul_f32 v38, v94, v94
  v_mfma_f32_16x16x32_bf16 v[236:239], a[216:219], a[60:63], v[236:239]
  v_mul_f32 v39, v95, v95
  v_fma_f32 v36, v36, s23, v35
  v_mfma_f32_16x16x32_bf16 v[240:243], a[220:223], a[48:51], v[240:243]
  ds_read_b64_tr_b16 a[200:201], v10 offset:32768
  v_fma_f32 v37, v37, s23, v35
  v_fma_f32 v38, v38, s23, v35
  v_mfma_f32_16x16x32_bf16 v[244:247], a[220:223], a[52:55], v[244:247]
  ds_read_b64_tr_b16 a[202:203], v10 offset:36864
  v_fma_f32 v39, v39, s23, v35
  v_mfma_f32_16x16x32_bf16 v[248:251], a[220:223], a[56:59], v[248:251]
  v_mul_f32 v36, v36, v92
  v_mul_f32 v37, v37, v93
  v_mfma_f32_16x16x32_bf16 v[252:255], a[220:223], a[60:63], v[252:255]
  v_mul_f32 v38, v38, v94
  v_mul_f32 v39, v39, v95
  s_waitcnt vmcnt(14) lgkmcnt(2)
  v_mfma_f32_16x16x32_bf16 v[128:131], a[192:195], a[0:3], v[128:131]
  ds_read_b64_tr_b16 a[204:205], v11 offset:32768
  v_exp_f32 v36, v36
  v_exp_f32 v37, v37
  v_mfma_f32_16x16x32_bf16 v[132:135], a[192:195], a[4:7], v[132:135]
  ds_read_b64_tr_b16 a[206:207], v11 offset:36864
  v_exp_f32 v38, v38
  v_exp_f32 v39, v39
  v_mfma_f32_16x16x32_bf16 v[136:139], a[192:195], a[8:11], v[136:139]
  buffer_load_dwordx4 a[48:51], v3, s[44:47], s67 offen offset:2048 sc1
  v_add_f32 v36, 1.0, v36
  v_add_f32 v37, 1.0, v37
  v_mfma_f32_16x16x32_bf16 v[140:143], a[192:195], a[12:15], v[140:143]
  v_add_f32 v38, 1.0, v38
  v_mfma_f32_16x16x32_bf16 v[144:147], a[196:199], a[0:3], v[144:147]
  ds_read_b64_tr_b16 a[208:209], v40 offset:32768
  v_add_f32 v39, 1.0, v39
  v_rcp_f32 v36, v36
  v_mfma_f32_16x16x32_bf16 v[148:151], a[196:199], a[4:7], v[148:151]
  ds_read_b64_tr_b16 a[210:211], v40 offset:36864
  v_rcp_f32 v37, v37
  v_rcp_f32 v38, v38
  v_mfma_f32_16x16x32_bf16 v[152:155], a[196:199], a[8:11], v[152:155]
  buffer_load_dwordx4 a[52:55], v3, s[44:47], s67 offen offset:3072 sc1
  v_rcp_f32 v39, v39
  v_mul_f32 v92, v92, v36
  v_mfma_f32_16x16x32_bf16 v[156:159], a[196:199], a[12:15], v[156:159]
  v_mul_f32 v93, v93, v37
  v_mul_f32 v94, v94, v38
  s_waitcnt lgkmcnt(2)
  v_mfma_f32_16x16x32_bf16 v[160:163], a[200:203], a[0:3], v[160:163]
  ds_read_b64_tr_b16 a[212:213], v41 offset:32768
  v_mul_f32 v95, v95, v39
  v_cvt_pk_bf16_f32 v90, v92, v93
  v_mfma_f32_16x16x32_bf16 v[164:167], a[200:203], a[4:7], v[164:167]
  ds_read_b64_tr_b16 a[214:215], v41 offset:36864
  v_cvt_pk_bf16_f32 v91, v94, v95
  buffer_store_dwordx4 v[88:91], v3, s[32:35], s65 offen offset:3072 sc1
  v_mfma_f32_16x16x32_bf16 v[168:171], a[200:203], a[8:11], v[168:171]
  buffer_load_dwordx4 a[56:59], v3, s[24:27], s67 offen offset:2048 sc1
  v_mul_f32 v36, v96, v96
  v_mfma_f32_16x16x32_bf16 v[172:175], a[200:203], a[12:15], v[172:175]
  v_mul_f32 v37, v97, v97
  v_mul_f32 v38, v98, v98
  v_mfma_f32_16x16x32_bf16 v[176:179], a[204:207], a[0:3], v[176:179]
  ds_read_b64_tr_b16 a[216:217], v42 offset:32768
  v_mul_f32 v39, v99, v99
  v_fma_f32 v36, v36, s23, v35
  v_mfma_f32_16x16x32_bf16 v[180:183], a[204:207], a[4:7], v[180:183]
  ds_read_b64_tr_b16 a[218:219], v42 offset:36864
  v_fma_f32 v37, v37, s23, v35
  v_fma_f32 v38, v38, s23, v35
  v_mfma_f32_16x16x32_bf16 v[184:187], a[204:207], a[8:11], v[184:187]
  buffer_load_dwordx4 a[60:63], v3, s[24:27], s67 offen offset:3072 sc1
  s_add_u32 s67, s67, 4096
  s_cmp_eq_u32 s67, 65536
  s_cselect_b32 s67, 0, s67
  v_fma_f32 v39, v39, s23, v35
  v_mul_f32 v36, v36, v96
  v_mfma_f32_16x16x32_bf16 v[188:191], a[204:207], a[12:15], v[188:191]
  s_add_u32 m0, s19, 0
  v_mul_f32 v37, v37, v97
  v_mul_f32 v38, v38, v98
  s_waitcnt lgkmcnt(2)
  v_mfma_f32_16x16x32_bf16 v[192:195], a[208:211], a[0:3], v[192:195]
  ds_read_b64_tr_b16 a[220:221], v43 offset:32768
  v_mul_f32 v39, v39, v99
  v_mfma_f32_16x16x32_bf16 v[196:199], a[208:211], a[4:7], v[196:199]
  ds_read_b64_tr_b16 a[222:223], v43 offset:36864
  v_exp_f32 v36, v36
  v_exp_f32 v37, v37
  v_mfma_f32_16x16x32_bf16 v[200:203], a[208:211], a[8:11], v[200:203]
  v_exp_f32 v38, v38
  v_exp_f32 v39, v39
  v_mfma_f32_16x16x32_bf16 v[204:207], a[208:211], a[12:15], v[204:207]
  buffer_load_dwordx4 v48, s[4:7], s66 offen offset:0 lds
  v_add_f32 v36, 1.0, v36
  v_add_f32 v37, 1.0, v37
  v_mfma_f32_16x16x32_bf16 v[208:211], a[212:215], a[0:3], v[208:211]
  ds_read_b64_tr_b16 a[192:193], v8 offset:40960
  v_add_f32 v38, 1.0, v38
  v_add_f32 v39, 1.0, v39
  v_mfma_f32_16x16x32_bf16 v[212:215], a[212:215], a[4:7], v[212:215]
  ds_read_b64_tr_b16 a[194:195], v8 offset:45056
  v_rcp_f32 v36, v36
  v_rcp_f32 v37, v37
  v_mfma_f32_16x16x32_bf16 v[216:219], a[212:215], a[8:11], v[216:219]
  v_rcp_f32 v38, v38
  v_rcp_f32 v39, v39
  v_mfma_f32_16x16x32_bf16 v[220:223], a[212:215], a[12:15], v[220:223]
  buffer_load_dwordx4 v49, s[4:7], s66 offen offset:1024 lds
  v_mul_f32 v96, v96, v36
  s_waitcnt lgkmcnt(2)
  v_mfma_f32_16x16x32_bf16 v[224:227], a[216:219], a[0:3], v[224:227]
  ds_read_b64_tr_b16 a[196:197], v9 offset:40960
  v_mul_f32 v97, v97, v37
  v_mul_f32 v98, v98, v38
  v_mfma_f32_16x16x32_bf16 v[228:231], a[216:219], a[4:7], v[228:231]
  ds_read_b64_tr_b16 a[198:199], v9 offset:45056
  v_mul_f32 v99, v99, v39
  v_cvt_pk_bf16_f32 v96, v96, v97
  v_mfma_f32_16x16x32_bf16 v[232:235], a[216:219], a[8:11], v[232:235]
  v_cvt_pk_bf16_f32 v97, v98, v99
  v_mul_f32 v36, v100, v100
  v_mfma_f32_16x16x32_bf16 v[236:239], a[216:219], a[12:15], v[236:239]
  buffer_load_dwordx4 v50, s[4:7], s66 offen offset:2048 lds
  v_mul_f32 v37, v101, v101
  v_mul_f32 v38, v102, v102
  v_mfma_f32_16x16x32_bf16 v[240:243], a[220:223], a[0:3], v[240:243]
  ds_read_b64_tr_b16 a[200:201], v10 offset:40960
  v_mul_f32 v39, v103, v103
  v_fma_f32 v36, v36, s23, v35
  v_mfma_f32_16x16x32_bf16 v[244:247], a[220:223], a[4:7], v[244:247]
  ds_read_b64_tr_b16 a[202:203], v10 offset:45056
  v_fma_f32 v37, v37, s23, v35
  v_mfma_f32_16x16x32_bf16 v[248:251], a[220:223], a[8:11], v[248:251]
  v_fma_f32 v38, v38, s23, v35
  v_fma_f32 v39, v39, s23, v35
  v_mfma_f32_16x16x32_bf16 v[252:255], a[220:223], a[12:15], v[252:255]
  buffer_load_dwordx4 v51, s[4:7], s66 offen offset:3072 lds
  s_add_u32 s66, s66, 524288
  s_cmp_eq_u32 s66, 8388608
  s_cselect_b32 s66, 0, s66
  v_mul_f32 v36, v36, v100
  v_mul_f32 v37, v37, v101
  s_waitcnt vmcnt(18) lgkmcnt(2)
  v_mfma_f32_16x16x32_bf16 v[128:131], a[192:195], a[16:19], v[128:131]
  ds_read_b64_tr_b16 a[204:205], v11 offset:40960
  v_mul_f32 v38, v38, v102
  v_mul_f32 v39, v39, v103
  v_mfma_f32_16x16x32_bf16 v[132:135], a[192:195], a[20:23], v[132:135]
  ds_read_b64_tr_b16 a[206:207], v11 offset:45056
  v_exp_f32 v36, v36
  v_exp_f32 v37, v37
  v_mfma_f32_16x16x32_bf16 v[136:139], a[192:195], a[24:27], v[136:139]
  v_exp_f32 v38, v38
  v_exp_f32 v39, v39
  v_mfma_f32_16x16x32_bf16 v[140:143], a[192:195], a[28:31], v[140:143]
  v_add_f32 v36, 1.0, v36
  v_add_f32 v37, 1.0, v37
  v_mfma_f32_16x16x32_bf16 v[144:147], a[196:199], a[16:19], v[144:147]
  ds_read_b64_tr_b16 a[208:209], v40 offset:40960
  v_add_f32 v38, 1.0, v38
  v_mfma_f32_16x16x32_bf16 v[148:151], a[196:199], a[20:23], v[148:151]
  ds_read_b64_tr_b16 a[210:211], v40 offset:45056
  v_add_f32 v39, 1.0, v39
  v_rcp_f32 v36, v36
  v_mfma_f32_16x16x32_bf16 v[152:155], a[196:199], a[24:27], v[152:155]
  buffer_load_dwordx4 a[0:3], v3, s[44:47], s67 offen offset:0 sc1
  v_rcp_f32 v37, v37
  v_rcp_f32 v38, v38
  v_mfma_f32_16x16x32_bf16 v[156:159], a[196:199], a[28:31], v[156:159]
  v_rcp_f32 v39, v39
  v_mul_f32 v100, v100, v36
  s_waitcnt lgkmcnt(2)
  v_mfma_f32_16x16x32_bf16 v[160:163], a[200:203], a[16:19], v[160:163]
  ds_read_b64_tr_b16 a[212:213], v41 offset:40960
  v_mul_f32 v101, v101, v37
  v_mul_f32 v102, v102, v38
  v_mfma_f32_16x16x32_bf16 v[164:167], a[200:203], a[20:23], v[164:167]
  ds_read_b64_tr_b16 a[214:215], v41 offset:45056
  v_mul_f32 v103, v103, v39
  v_cvt_pk_bf16_f32 v98, v100, v101
  v_mfma_f32_16x16x32_bf16 v[168:171], a[200:203], a[24:27], v[168:171]
  buffer_load_dwordx4 a[4:7], v3, s[44:47], s67 offen offset:1024 sc1
  v_cvt_pk_bf16_f32 v99, v102, v103
  buffer_store_dwordx4 v[96:99], v57, s[32:35], s65 offen offset:0 sc1
  v_mfma_f32_16x16x32_bf16 v[172:175], a[200:203], a[28:31], v[172:175]
  v_mul_f32 v36, v104, v104
  v_mfma_f32_16x16x32_bf16 v[176:179], a[204:207], a[16:19], v[176:179]
  ds_read_b64_tr_b16 a[216:217], v42 offset:40960
  v_mul_f32 v37, v105, v105
  v_mul_f32 v38, v106, v106
  v_mfma_f32_16x16x32_bf16 v[180:183], a[204:207], a[20:23], v[180:183]
  ds_read_b64_tr_b16 a[218:219], v42 offset:45056
  v_mul_f32 v39, v107, v107
  v_fma_f32 v36, v36, s23, v35
  v_mfma_f32_16x16x32_bf16 v[184:187], a[204:207], a[24:27], v[184:187]
  buffer_load_dwordx4 a[8:11], v3, s[24:27], s67 offen offset:0 sc1
  v_fma_f32 v37, v37, s23, v35
  v_fma_f32 v38, v38, s23, v35
  v_mfma_f32_16x16x32_bf16 v[188:191], a[204:207], a[28:31], v[188:191]
  v_fma_f32 v39, v39, s23, v35
  v_mul_f32 v36, v36, v104
  s_waitcnt lgkmcnt(2)
  v_mfma_f32_16x16x32_bf16 v[192:195], a[208:211], a[16:19], v[192:195]
  ds_read_b64_tr_b16 a[220:221], v43 offset:40960
  v_mul_f32 v37, v37, v105
  v_mul_f32 v38, v38, v106
  v_mfma_f32_16x16x32_bf16 v[196:199], a[208:211], a[20:23], v[196:199]
  ds_read_b64_tr_b16 a[222:223], v43 offset:45056
  v_mul_f32 v39, v39, v107
  v_mfma_f32_16x16x32_bf16 v[200:203], a[208:211], a[24:27], v[200:203]
  buffer_load_dwordx4 a[12:15], v3, s[24:27], s67 offen offset:1024 sc1
  v_exp_f32 v36, v36
  v_exp_f32 v37, v37
  v_mfma_f32_16x16x32_bf16 v[204:207], a[208:211], a[28:31], v[204:207]
  v_exp_f32 v38, v38
  v_exp_f32 v39, v39
  v_mfma_f32_16x16x32_bf16 v[208:211], a[212:215], a[16:19], v[208:211]
  s_waitcnt vmcnt(19)
  s_barrier
  ds_read_b64_tr_b16 a[192:193], v8 offset:49152
  v_add_f32 v36, 1.0, v36
  v_add_f32 v37, 1.0, v37
  v_mfma_f32_16x16x32_bf16 v[212:215], a[212:215], a[20:23], v[212:215]
  ds_read_b64_tr_b16 a[194:195], v8 offset:53248
  v_add_f32 v38, 1.0, v38
  v_add_f32 v39, 1.0, v39
  v_mfma_f32_16x16x32_bf16 v[216:219], a[212:215], a[24:27], v[216:219]
  v_rcp_f32 v36, v36
  v_rcp_f32 v37, v37
  v_mfma_f32_16x16x32_bf16 v[220:223], a[212:215], a[28:31], v[220:223]
  v_rcp_f32 v38, v38
  v_rcp_f32 v39, v39
  s_waitcnt lgkmcnt(2)
  v_mfma_f32_16x16x32_bf16 v[224:227], a[216:219], a[16:19], v[224:227]
  ds_read_b64_tr_b16 a[196:197], v9 offset:49152
  v_mul_f32 v104, v104, v36
  v_mfma_f32_16x16x32_bf16 v[228:231], a[216:219], a[20:23], v[228:231]
  ds_read_b64_tr_b16 a[198:199], v9 offset:53248
  v_mul_f32 v105, v105, v37
  v_mul_f32 v106, v106, v38
  v_mfma_f32_16x16x32_bf16 v[232:235], a[216:219], a[24:27], v[232:235]
  v_mul_f32 v107, v107, v39
  v_cvt_pk_bf16_f32 v104, v104, v105
  v_mfma_f32_16x16x32_bf16 v[236:239], a[216:219], a[28:31], v[236:239]
  v_cvt_pk_bf16_f32 v105, v106, v107
  v_mul_f32 v36, v108, v108
  v_mfma_f32_16x16x32_bf16 v[240:243], a[220:223], a[16:19], v[240:243]
  ds_read_b64_tr_b16 a[200:201], v10 offset:49152
  v_mul_f32 v37, v109, v109
  v_mul_f32 v38, v110, v110
  v_mfma_f32_16x16x32_bf16 v[244:247], a[220:223], a[20:23], v[244:247]
  ds_read_b64_tr_b16 a[202:203], v10 offset:53248
  v_mul_f32 v39, v111, v111
  v_fma_f32 v36, v36, s23, v35
  v_mfma_f32_16x16x32_bf16 v[248:251], a[220:223], a[24:27], v[248:251]
  v_fma_f32 v37, v37, s23, v35
  v_mfma_f32_16x16x32_bf16 v[252:255], a[220:223], a[28:31], v[252:255]
  v_fma_f32 v38, v38, s23, v35
  v_fma_f32 v39, v39, s23, v35
  s_waitcnt vmcnt(14) lgkmcnt(2)
  v_mfma_f32_16x16x32_bf16 v[128:131], a[192:195], a[32:35], v[128:131]
  ds_read_b64_tr_b16 a[204:205], v11 offset:49152
  v_mul_f32 v36, v36, v108
  v_mul_f32 v37, v37, v109
  v_mfma_f32_16x16x32_bf16 v[132:135], a[192:195], a[36:39], v[132:135]
  ds_read_b64_tr_b16 a[206:207], v11 offset:53248
  v_mul_f32 v38, v38, v110
  v_mul_f32 v39, v39, v111
  v_mfma_f32_16x16x32_bf16 v[136:139], a[192:195], a[40:43], v[136:139]
  buffer_load_dwordx4 a[16:19], v3, s[44:47], s67 offen offset:2048 sc1
  v_exp_f32 v36, v36
  v_exp_f32 v37, v37
  v_mfma_f32_16x16x32_bf16 v[140:143], a[192:195], a[44:47], v[140:143]
  v_exp_f32 v38, v38
  v_exp_f32 v39, v39
  v_mfma_f32_16x16x32_bf16 v[144:147], a[196:199], a[32:35], v[144:147]
  ds_read_b64_tr_b16 a[208:209], v40 offset:49152
  v_add_f32 v36, 1.0, v36
  v_add_f32 v37, 1.0, v37
  v_mfma_f32_16x16x32_bf16 v[148:151], a[196:199], a[36:39], v[148:151]
  ds_read_b64_tr_b16 a[210:211], v40 offset:53248
  v_add_f32 v38, 1.0, v38
  v_mfma_f32_16x16x32_bf16 v[152:155], a[196:199], a[40:43], v[152:155]
  buffer_load_dwordx4 a[20:23], v3, s[44:47], s67 offen offset:3072 sc1
  v_add_f32 v39, 1.0, v39
  v_rcp_f32 v36, v36
  v_mfma_f32_16x16x32_bf16 v[156:159], a[196:199], a[44:47], v[156:159]
  v_rcp_f32 v37, v37
  v_rcp_f32 v38, v38
  s_waitcnt lgkmcnt(2)
  v_mfma_f32_16x16x32_bf16 v[160:163], a[200:203], a[32:35], v[160:163]
  ds_read_b64_tr_b16 a[212:213], v41 offset:49152
  v_rcp_f32 v39, v39
  v_mul_f32 v108, v108, v36
  v_mfma_f32_16x16x32_bf16 v[164:167], a[200:203], a[36:39], v[164:167]
  ds_read_b64_tr_b16 a[214:215], v41 offset:53248
  v_mul_f32 v109, v109, v37
  v_mul_f32 v110, v110, v38
  v_mfma_f32_16x16x32_bf16 v[168:171], a[200:203], a[40:43], v[168:171]
  buffer_load_dwordx4 a[24:27], v3, s[24:27], s67 offen offset:2048 sc1
  v_mul_f32 v111, v111, v39
  v_cvt_pk_bf16_f32 v106, v108, v109
  v_mfma_f32_16x16x32_bf16 v[172:175], a[200:203], a[44:47], v[172:175]
  v_cvt_pk_bf16_f32 v107, v110, v111
  buffer_store_dwordx4 v[104:107], v57, s[32:35], s65 offen offset:1024 sc1
  v_mfma_f32_16x16x32_bf16 v[176:179], a[204:207], a[32:35], v[176:179]
  ds_read_b64_tr_b16 a[216:217], v42 offset:49152
  v_mfma_f32_16x16x32_bf16 v[180:183], a[204:207], a[36:39], v[180:183]
  ds_read_b64_tr_b16 a[218:219], v42 offset:53248
  v_mfma_f32_16x16x32_bf16 v[184:187], a[204:207], a[40:43], v[184:187]
  buffer_load_dwordx4 a[28:31], v3, s[24:27], s67 offen offset:3072 sc1
  s_add_u32 s67, s67, 4096
  s_cmp_eq_u32 s67, 65536
  s_cselect_b32 s67, 0, s67
  v_mfma_f32_16x16x32_bf16 v[188:191], a[204:207], a[44:47], v[188:191]
  s_add_u32 m0, s19, 16384
  s_waitcnt lgkmcnt(2)
  v_mfma_f32_16x16x32_bf16 v[192:195], a[208:211], a[32:35], v[192:195]
  ds_read_b64_tr_b16 a[220:221], v43 offset:49152
  v_mfma_f32_16x16x32_bf16 v[196:199], a[208:211], a[36:39], v[196:199]
  ds_read_b64_tr_b16 a[222:223], v43 offset:53248
  v_mfma_f32_16x16x32_bf16 v[200:203], a[208:211], a[40:43], v[200:203]
  v_mfma_f32_16x16x32_bf16 v[204:207], a[208:211], a[44:47], v[204:207]
  buffer_load_dwordx4 v48, s[4:7], s66 offen offset:0 lds
  v_mfma_f32_16x16x32_bf16 v[208:211], a[212:215], a[32:35], v[208:211]
  ds_read_b64_tr_b16 a[192:193], v8 offset:57344
  v_mfma_f32_16x16x32_bf16 v[212:215], a[212:215], a[36:39], v[212:215]
  ds_read_b64_tr_b16 a[194:195], v8 offset:61440
  v_mfma_f32_16x16x32_bf16 v[216:219], a[212:215], a[40:43], v[216:219]
  v_mfma_f32_16x16x32_bf16 v[220:223], a[212:215], a[44:47], v[220:223]
  buffer_load_dwordx4 v49, s[4:7], s66 offen offset:1024 lds
  s_waitcnt lgkmcnt(2)
  v_mfma_f32_16x16x32_bf16 v[224:227], a[216:219], a[32:35], v[224:227]
  ds_read_b64_tr_b16 a[196:197], v9 offset:57344
  v_mfma_f32_16x16x32_bf16 v[228:231], a[216:219], a[36:39], v[228:231]
  ds_read_b64_tr_b16 a[198:199], v9 offset:61440
  v_mfma_f32_16x16x32_bf16 v[232:235], a[216:219], a[40:43], v[232:235]
  v_mfma_f32_16x16x32_bf16 v[236:239], a[216:219], a[44:47], v[236:239]
  buffer_load_dwordx4 v50, s[4:7], s66 offen offset:2048 lds
  v_mfma_f32_16x16x32_bf16 v[240:243], a[220:223], a[32:35], v[240:243]
  ds_read_b64_tr_b16 a[200:201], v10 offset:57344
  v_mfma_f32_16x16x32_bf16 v[244:247], a[220:223], a[36:39], v[244:247]
  ds_read_b64_tr_b16 a[202:203], v10 offset:61440
  v_mfma_f32_16x16x32_bf16 v[248:251], a[220:223], a[40:43], v[248:251]
  v_mfma_f32_16x16x32_bf16 v[252:255], a[220:223], a[44:47], v[252:255]
  buffer_load_dwordx4 v51, s[4:7], s66 offen offset:3072 lds
  s_add_u32 s66, s66, 524288
  s_cmp_eq_u32 s66, 8388608
  s_cselect_b32 s66, 0, s66
  s_waitcnt vmcnt(18) lgkmcnt(2)
  v_mfma_f32_16x16x32_bf16 v[128:131], a[192:195], a[48:51], v[128:131]
  ds_read_b64_tr_b16 a[204:205], v11 offset:57344
  v_mfma_f32_16x16x32_bf16 v[132:135], a[192:195], a[52:55], v[132:135]
  ds_read_b64_tr_b16 a[206:207], v11 offset:61440
  v_mfma_f32_16x16x32_bf16 v[136:139], a[192:195], a[56:59], v[136:139]
  v_mfma_f32_16x16x32_bf16 v[140:143], a[192:195], a[60:63], v[140:143]
  v_mfma_f32_16x16x32_bf16 v[144:147], a[196:199], a[48:51], v[144:147]
  ds_read_b64_tr_b16 a[208:209], v40 offset:57344
  v_mfma_f32_16x16x32_bf16 v[148:151], a[196:199], a[52:55], v[148:151]
  ds_read_b64_tr_b16 a[210:211], v40 offset:61440
  v_mfma_f32_16x16x32_bf16 v[152:155], a[196:199], a[56:59], v[152:155]
  buffer_load_dwordx4 a[32:35], v3, s[44:47], s67 offen offset:0 sc1
  v_mfma_f32_16x16x32_bf16 v[156:159], a[196:199], a[60:63], v[156:159]
  s_waitcnt lgkmcnt(2)
  v_mfma_f32_16x16x32_bf16 v[160:163], a[200:203], a[48:51], v[160:163]
  ds_read_b64_tr_b16 a[212:213], v41 offset:57344
  v_mfma_f32_16x16x32_bf16 v[164:167], a[200:203], a[52:55], v[164:167]
  ds_read_b64_tr_b16 a[214:215], v41 offset:61440
  v_mfma_f32_16x16x32_bf16 v[168:171], a[200:203], a[56:59], v[168:171]
  buffer_load_dwordx4 a[36:39], v3, s[44:47], s67 offen offset:1024 sc1
  v_mfma_f32_16x16x32_bf16 v[172:175], a[200:203], a[60:63], v[172:175]
  v_mfma_f32_16x16x32_bf16 v[176:179], a[204:207], a[48:51], v[176:179]
  ds_read_b64_tr_b16 a[216:217], v42 offset:57344
  v_mfma_f32_16x16x32_bf16 v[180:183], a[204:207], a[52:55], v[180:183]
  ds_read_b64_tr_b16 a[218:219], v42 offset:61440
  v_mfma_f32_16x16x32_bf16 v[184:187], a[204:207], a[56:59], v[184:187]
  buffer_load_dwordx4 a[40:43], v3, s[24:27], s67 offen offset:0 sc1
  v_mfma_f32_16x16x32_bf16 v[188:191], a[204:207], a[60:63], v[188:191]
  s_waitcnt lgkmcnt(2)
  v_mfma_f32_16x16x32_bf16 v[192:195], a[208:211], a[48:51], v[192:195]
  ds_read_b64_tr_b16 a[220:221], v43 offset:57344
  v_mfma_f32_16x16x32_bf16 v[196:199], a[208:211], a[52:55], v[196:199]
  ds_read_b64_tr_b16 a[222:223], v43 offset:61440
  v_mfma_f32_16x16x32_bf16 v[200:203], a[208:211], a[56:59], v[200:203]
  buffer_load_dwordx4 a[44:47], v3, s[24:27], s67 offen offset:1024 sc1
  v_mfma_f32_16x16x32_bf16 v[204:207], a[208:211], a[60:63], v[204:207]
  v_mfma_f32_16x16x32_bf16 v[208:211], a[212:215], a[48:51], v[208:211]
  s_waitcnt vmcnt(18)
  s_waitcnt vmcnt(9)
  s_barrier
  s_cmp_lg_u32 s16, 0
  s_cbranch_scc1 L_mk5_nopub_3
  v_mov_b32 v1, s70
  v_mov_b32 v56, s42
  s_mov_b64 exec, 1
  buffer_store_dword v56, v1, s[52:55], 0 offen sc1
  s_mov_b64 exec, -1
  s_nop 3
L_mk5_nopub_3:
  ds_read_b64_tr_b16 a[192:193], v8 offset:0
  v_mfma_f32_16x16x32_bf16 v[212:215], a[212:215], a[52:55], v[212:215]
  ds_read_b64_tr_b16 a[194:195], v8 offset:4096
  v_mfma_f32_16x16x32_bf16 v[216:219], a[212:215], a[56:59], v[216:219]
  v_mfma_f32_16x16x32_bf16 v[220:223], a[212:215], a[60:63], v[220:223]
  s_waitcnt lgkmcnt(2)
  v_mfma_f32_16x16x32_bf16 v[224:227], a[216:219], a[48:51], v[224:227]
  ds_read_b64_tr_b16 a[196:197], v9 offset:0
  v_mfma_f32_16x16x32_bf16 v[228:231], a[216:219], a[52:55], v[228:231]
  ds_read_b64_tr_b16 a[198:199], v9 offset:4096
  v_mfma_f32_16x16x32_bf16 v[232:235], a[216:219], a[56:59], v[232:235]
  v_mfma_f32_16x16x32_bf16 v[236:239], a[216:219], a[60:63], v[236:239]
  v_mfma_f32_16x16x32_bf16 v[240:243], a[220:223], a[48:51], v[240:243]
  ds_read_b64_tr_b16 a[200:201], v10 offset:0
  v_mfma_f32_16x16x32_bf16 v[244:247], a[220:223], a[52:55], v[244:247]
  ds_read_b64_tr_b16 a[202:203], v10 offset:4096
  v_mfma_f32_16x16x32_bf16 v[248:251], a[220:223], a[56:59], v[248:251]
  v_mfma_f32_16x16x32_bf16 v[252:255], a[220:223], a[60:63], v[252:255]
  s_mov_b32 s20, 3
L_mk5_q_4:
  s_waitcnt vmcnt(12) lgkmcnt(2)
  v_mfma_f32_16x16x32_bf16 v[128:131], a[192:195], a[0:3], v[128:131]
  ds_read_b64_tr_b16 a[204:205], v11 offset:0
  v_mfma_f32_16x16x32_bf16 v[132:135], a[192:195], a[4:7], v[132:135]
  ds_read_b64_tr_b16 a[206:207], v11 offset:4096
  v_mfma_f32_16x16x32_bf16 v[136:139], a[192:195], a[8:11], v[136:139]
  buffer_load_dwordx4 a[48:51], v3, s[44:47], s67 offen offset:2048 sc1
  v_mfma_f32_16x16x32_bf16 v[140:143], a[192:195], a[12:15], v[140:143]
  v_mfma_f32_16x16x32_bf16 v[144:147], a[196:199], a[0:3], v[144:147]
  ds_read_b64_tr_b16 a[208:209], v40 offset:0
  v_mfma_f32_16x16x32_bf16 v[148:151], a[196:199], a[4:7], v[148:151]
  ds_read_b64_tr_b16 a[210:211], v40 offset:4096
  v_mfma_f32_16x16x32_bf16 v[152:155], a[196:199], a[8:11], v[152:155]
  buffer_load_dwordx4 a[52:55], v3, s[44:47], s67 offen offset:3072 sc1
  v_mfma_f32_16x16x32_bf16 v[156:159], a[196:199], a[12:15], v[156:159]
  s_waitcnt lgkmcnt(2)
  v_mfma_f32_16x16x32_bf16 v[160:163], a[200:203], a[0:3], v[160:163]
  ds_read_b64_tr_b16 a[212:213], v41 offset:0
  v_mfma_f32_16x16x32_bf16 v[164:167], a[200:203], a[4:7], v[164:167]
  ds_read_b64_tr_b16 a[214:215], v41 offset:4096
  v_mfma_f32_16x16x32_bf16 v[168:171], a[200:203], a[8:11], v[168:171]
  buffer_load_dwordx4 a[56:59], v3, s[24:27], s67 offen offset:2048 sc1
  v_mfma_f32_16x16x32_bf16 v[172:175], a[200:203], a[12:15], v[172:175]
  v_mfma_f32_16x16x32_bf16 v[176:179], a[204:207], a[0:3], v[176:179]
  ds_read_b64_tr_b16 a[216:217], v42 offset:0
  v_mfma_f32_16x16x32_bf16 v[180:183], a[204:207], a[4:7], v[180:183]
  ds_read_b64_tr_b16 a[218:219], v42 offset:4096
  v_mfma_f32_16x16x32_bf16 v[184:187], a[204:207], a[8:11], v[184:187]
  buffer_load_dwordx4 a[60:63], v3, s[24:27], s67 offen offset:3072 sc1
  s_add_u32 s67, s67, 4096
  s_cmp_eq_u32 s67, 65536
  s_cselect_b32 s67, 0, s67
  v_mfma_f32_16x16x32_bf16 v[188:191], a[204:207], a[12:15], v[188:191]
  s_add_u32 m0, s19, 32768
  s_waitcnt lgkmcnt(2)
  v_mfma_f32_16x16x32_bf16 v[192:195], a[208:211], a[0:3], v[192:195]
  ds_read_b64_tr_b16 a[220:221], v43 offset:0
  v_mfma_f32_16x16x32_bf16 v[196:199], a[208:211], a[4:7], v[196:199]
  ds_read_b64_tr_b16 a[222:223], v43 offset:4096
  v_mfma_f32_16x16x32_bf16 v[200:203], a[208:211], a[8:11], v[200:203]
  v_mfma_f32_16x16x32_bf16 v[204:207], a[208:211], a[12:15], v[204:207]
  buffer_load_dwordx4 v48, s[4:7], s66 offen offset:0 lds
  v_mfma_f32_16x16x32_bf16 v[208:211], a[212:215], a[0:3], v[208:211]
  ds_read_b64_tr_b16 a[192:193], v8 offset:8192
  v_mfma_f32_16x16x32_bf16 v[212:215], a[212:215], a[4:7], v[212:215]
  ds_read_b64_tr_b16 a[194:195], v8 offset:12288
  v_mfma_f32_16x16x32_bf16 v[216:219], a[212:215], a[8:11], v[216:219]
  v_mfma_f32_16x16x32_bf16 v[220:223], a[212:215], a[12:15], v[220:223]
  buffer_load_dwordx4 v49, s[4:7], s66 offen offset:1024 lds
  s_waitcnt lgkmcnt(2)
  v_mfma_f32_16x16x32_bf16 v[224:227], a[216:219], a[0:3], v[224:227]
  ds_read_b64_tr_b16 a[196:197], v9 offset:8192
  v_mfma_f32_16x16x32_bf16 v[228:231], a[216:219], a[4:7], v[228:231]
  ds_read_b64_tr_b16 a[198:199], v9 offset:12288
  v_mfma_f32_16x16x32_bf16 v[232:235], a[216:219], a[8:11], v[232:235]
  v_mfma_f32_16x16x32_bf16 v[236:239], a[216:219], a[12:15], v[236:239]
  buffer_load_dwordx4 v50, s[4:7], s66 offen offset:2048 lds
  v_mfma_f32_16x16x32_bf16 v[240:243], a[220:223], a[0:3], v[240:243]
  ds_read_b64_tr_b16 a[200:201], v10 offset:8192
  v_mfma_f32_16x16x32_bf16 v[244:247], a[220:223], a[4:7], v[244:247]
  ds_read_b64_tr_b16 a[202:203], v10 offset:12288
  v_mfma_f32_16x16x32_bf16 v[248:251], a[220:223], a[8:11], v[248:251]
  v_mfma_f32_16x16x32_bf16 v[252:255], a[220:223], a[12:15], v[252:255]
  buffer_load_dwordx4 v51, s[4:7], s66 offen offset:3072 lds
  s_add_u32 s66, s66, 524288
  s_cmp_eq_u32 s66, 8388608
  s_cselect_b32 s66, 0, s66
  s_waitcnt vmcnt(16) lgkmcnt(2)
  v_mfma_f32_16x16x32_bf16 v[128:131], a[192:195], a[16:19], v[128:131]
  ds_read_b64_tr_b16 a[204:205], v11 offset:8192
  v_mfma_f32_16x16x32_bf16 v[132:135], a[192:195], a[20:23], v[132:135]
  ds_read_b64_tr_b16 a[206:207], v11 offset:12288
  v_mfma_f32_16x16x32_bf16 v[136:139], a[192:195], a[24:27], v[136:139]
  v_mfma_f32_16x16x32_bf16 v[140:143], a[192:195], a[28:31], v[140:143]
  v_mfma_f32_16x16x32_bf16 v[144:147], a[196:199], a[16:19], v[144:147]
  ds_read_b64_tr_b16 a[208:209], v40 offset:8192
  v_mfma_f32_16x16x32_bf16 v[148:151], a[196:199], a[20:23], v[148:151]
  ds_read_b64_tr_b16 a[210:211], v40 offset:12288
  v_mfma_f32_16x16x32_bf16 v[152:155], a[196:199], a[24:27], v[152:155]
  buffer_load_dwordx4 a[0:3], v3, s[44:47], s67 offen offset:0 sc1
  v_mfma_f32_16x16x32_bf16 v[156:159], a[196:199], a[28:31], v[156:159]
  s_waitcnt lgkmcnt(2)
  v_mfma_f32_16x16x32_bf16 v[160:163], a[200:203], a[16:19], v[160:163]
  ds_read_b64_tr_b16 a[212:213], v41 offset:8192
  v_mfma_f32_16x16x32_bf16 v[164:167], a[200:203], a[20:23], v[164:167]
  ds_read_b64_tr_b16 a[214:215], v41 offset:12288
  v_mfma_f32_16x16x32_bf16 v[168:171], a[200:203], a[24:27], v[168:171]
  buffer_load_dwordx4 a[4:7], v3, s[44:47], s67 offen offset:1024 sc1
  v_mfma_f32_16x16x32_bf16 v[172:175], a[200:203], a[28:31], v[172:175]
  v_mfma_f32_16x16x32_bf16 v[176:179], a[204:207], a[16:19], v[176:179]
  ds_read_b64_tr_b16 a[216:217], v42 offset:8192
  v_mfma_f32_16x16x32_bf16 v[180:183], a[204:207], a[20:23], v[180:183]
  ds_read_b64_tr_b16 a[218:219], v42 offset:12288
  v_mfma_f32_16x16x32_bf16 v[184:187], a[204:207], a[24:27], v[184:187]
  buffer_load_dwordx4 a[8:11], v3, s[24:27], s67 offen offset:0 sc1
  v_mfma_f32_16x16x32_bf16 v[188:191], a[204:207], a[28:31], v[188:191]
  s_waitcnt lgkmcnt(2)
  v_mfma_f32_16x16x32_bf16 v[192:195], a[208:211], a[16:19], v[192:195]
  ds_read_b64_tr_b16 a[220:221], v43 offset:8192
  v_mfma_f32_16x16x32_bf16 v[196:199], a[208:211], a[20:23], v[196:199]
  ds_read_b64_tr_b16 a[222:223], v43 offset:12288
  v_mfma_f32_16x16x32_bf16 v[200:203], a[208:211], a[24:27], v[200:203]
  buffer_load_dwordx4 a[12:15], v3, s[24:27], s67 offen offset:1024 sc1
  v_mfma_f32_16x16x32_bf16 v[204:207], a[208:211], a[28:31], v[204:207]
  v_mfma_f32_16x16x32_bf16 v[208:211], a[212:215], a[16:19], v[208:211]
  s_waitcnt vmcnt(16)
  s_barrier
  ds_read_b64_tr_b16 a[192:193], v8 offset:16384
  v_mfma_f32_16x16x32_bf16 v[212:215], a[212:215], a[20:23], v[212:215]
  ds_read_b64_tr_b16 a[194:195], v8 offset:20480
  v_mfma_f32_16x16x32_bf16 v[216:219], a[212:215], a[24:27], v[216:219]
  v_mfma_f32_16x16x32_bf16 v[220:223], a[212:215], a[28:31], v[220:223]
  s_waitcnt lgkmcnt(2)
  v_mfma_f32_16x16x32_bf16 v[224:227], a[216:219], a[16:19], v[224:227]
  ds_read_b64_tr_b16 a[196:197], v9 offset:16384
  v_mfma_f32_16x16x32_bf16 v[228:231], a[216:219], a[20:23], v[228:231]
  ds_read_b64_tr_b16 a[198:199], v9 offset:20480
  v_mfma_f32_16x16x32_bf16 v[232:235], a[216:219], a[24:27], v[232:235]
  v_mfma_f32_16x16x32_bf16 v[236:239], a[216:219], a[28:31], v[236:239]
  v_mfma_f32_16x16x32_bf16 v[240:243], a[220:223], a[16:19], v[240:243]
  ds_read_b64_tr_b16 a[200:201], v10 offset:16384
  v_mfma_f32_16x16x32_bf16 v[244:247], a[220:223], a[20:23], v[244:247]
  ds_read_b64_tr_b16 a[202:203], v10 offset:20480
  v_mfma_f32_16x16x32_bf16 v[248:251], a[220:223], a[24:27], v[248:251]
  v_mfma_f32_16x16x32_bf16 v[252:255], a[220:223], a[28:31], v[252:255]
  s_waitcnt vmcnt(12) lgkmcnt(2)
  v_mfma_f32_16x16x32_bf16 v[128:131], a[192:195], a[32:35], v[128:131]
  ds_read_b64_tr_b16 a[204:205], v11 offset:16384
  v_mfma_f32_16x16x32_bf16 v[132:135], a[192:195], a[36:39], v[132:135]
  ds_read_b64_tr_b16 a[206:207], v11 offset:20480
  v_mfma_f32_16x16x32_bf16 v[136:139], a[192:195], a[40:43], v[136:139]
  buffer_load_dwordx4 a[16:19], v3, s[44:47], s67 offen offset:2048 sc1
  v_mfma_f32_16x16x32_bf16 v[140:143], a[192:195], a[44:47], v[140:143]
  v_mfma_f32_16x16x32_bf16 v[144:147], a[196:199], a[32:35], v[144:147]
  ds_read_b64_tr_b16 a[208:209], v40 offset:16384
  v_mfma_f32_16x16x32_bf16 v[148:151], a[196:199], a[36:39], v[148:151]
  ds_read_b64_tr_b16 a[210:211], v40 offset:20480
  v_mfma_f32_16x16x32_bf16 v[152:155], a[196:199], a[40:43], v[152:155]
  buffer_load_dwordx4 a[20:23], v3, s[44:47], s67 offen offset:3072 sc1
  v_mfma_f32_16x16x32_bf16 v[156:159], a[196:199], a[44:47], v[156:159]
  s_waitcnt lgkmcnt(2)
  v_mfma_f32_16x16x32_bf16 v[160:163], a[200:203], a[32:35], v[160:163]
  ds_read_b64_tr_b16 a[212:213], v41 offset:16384
  v_mfma_f32_16x16x32_bf16 v[164:167], a[200:203], a[36:39], v[164:167]
  ds_read_b64_tr_b16 a[214:215], v41 offset:20480
  v_mfma_f32_16x16x32_bf16 v[168:171], a[200:203], a[40:43], v[168:171]
  buffer_load_dwordx4 a[24:27], v3, s[24:27], s67 offen offset:2048 sc1
  v_mfma_f32_16x16x32_bf16 v[172:175], a[200:203], a[44:47], v[172:175]
  v_mfma_f32_16x16x32_bf16 v[176:179], a[204:207], a[32:35], v[176:179]
  ds_read_b64_tr_b16 a[216:217], v42 offset:16384
  v_mfma_f32_16x16x32_bf16 v[180:183], a[204:207], a[36:39], v[180:183]
  ds_read_b64_tr_b16 a[218:219], v42 offset:20480
  v_mfma_f32_16x16x32_bf16 v[184:187], a[204:207], a[40:43], v[184:187]
  buffer_load_dwordx4 a[28:31], v3, s[24:27], s67 offen offset:3072 sc1
  s_add_u32 s67, s67, 4096
  s_cmp_eq_u32 s67, 65536
  s_cselect_b32 s67, 0, s67
  v_mfma_f32_16x16x32_bf16 v[188:191], a[204:207], a[44:47], v[188:191]
  s_add_u32 m0, s19, 49152
  s_waitcnt lgkmcnt(2)
  v_mfma_f32_16x16x32_bf16 v[192:195], a[208:211], a[32:35], v[192:195]
  ds_read_b64_tr_b16 a[220:221], v43 offset:16384
  v_mfma_f32_16x16x32_bf16 v[196:199], a[208:211], a[36:39], v[196:199]
  ds_read_b64_tr_b16 a[222:223], v43 offset:20480
  v_mfma_f32_16x16x32_bf16 v[200:203], a[208:211], a[40:43], v[200:203]
  v_mfma_f32_16x16x32_bf16 v[204:207], a[208:211], a[44:47], v[204:207]
  buffer_load_dwordx4 v48, s[4:7], s66 offen offset:0 lds
  v_mfma_f32_16x16x32_bf16 v[208:211], a[212:215], a[32:35], v[208:211]
  ds_read_b64_tr_b16 a[192:193], v8 offset:24576
  v_mfma_f32_16x16x32_bf16 v[212:215], a[212:215], a[36:39], v[212:215]
  ds_read_b64_tr_b16 a[194:195], v8 offset:28672
  v_mfma_f32_16x16x32_bf16 v[216:219], a[212:215], a[40:43], v[216:219]
  v_mfma_f32_16x16x32_bf16 v[220:223], a[212:215], a[44:47], v[220:223]
  buffer_load_dwordx4 v49, s[4:7], s66 offen offset:1024 lds
  s_waitcnt lgkmcnt(2)
  v_mfma_f32_16x16x32_bf16 v[224:227], a[216:219], a[32:35], v[224:227]
  ds_read_b64_tr_b16 a[196:197], v9 offset:24576
  v_mfma_f32_16x16x32_bf16 v[228:231], a[216:219], a[36:39], v[228:231]
  ds_read_b64_tr_b16 a[198:199], v9 offset:28672
  v_mfma_f32_16x16x32_bf16 v[232:235], a[216:219], a[40:43], v[232:235]
  v_mfma_f32_16x16x32_bf16 v[236:239], a[216:219], a[44:47], v[236:239]
  buffer_load_dwordx4 v50, s[4:7], s66 offen offset:2048 lds
  v_mfma_f32_16x16x32_bf16 v[240:243], a[220:223], a[32:35], v[240:243]
  ds_read_b64_tr_b16 a[200:201], v10 offset:24576
  v_mfma_f32_16x16x32_bf16 v[244:247], a[220:223], a[36:39], v[244:247]
  ds_read_b64_tr_b16 a[202:203], v10 offset:28672
  v_mfma_f32_16x16x32_bf16 v[248:251], a[220:223], a[40:43], v[248:251]
  v_mfma_f32_16x16x32_bf16 v[252:255], a[220:223], a[44:47], v[252:255]
  buffer_load_dwordx4 v51, s[4:7], s66 offen offset:3072 lds
  s_add_u32 s66, s66, 524288
  s_cmp_eq_u32 s66, 8388608
  s_cselect_b32 s66, 0, s66
  s_waitcnt vmcnt(16) lgkmcnt(2)
  v_mfma_f32_16x16x32_bf16 v[128:131], a[192:195], a[48:51], v[128:131]
  ds_read_b64_tr_b16 a[204:205], v11 offset:24576
  v_mfma_f32_16x16x32_bf16 v[132:135], a[192:195], a[52:55], v[132:135]
  ds_read_b64_tr_b16 a[206:207], v11 offset:28672
  v_mfma_f32_16x16x32_bf16 v[136:139], a[192:195], a[56:59], v[136:139]
  v_mfma_f32_16x16x32_bf16 v[140:143], a[192:195], a[60:63], v[140:143]
  v_mfma_f32_16x16x32_bf16 v[144:147], a[196:199], a[48:51], v[144:147]
  ds_read_b64_tr_b16 a[208:209], v40 offset:24576
  v_mfma_f32_16x16x32_bf16 v[148:151], a[196:199], a[52:55], v[148:151]
  ds_read_b64_tr_b16 a[210:211], v40 offset:28672
  v_mfma_f32_16x16x32_bf16 v[152:155], a[196:199], a[56:59], v[152:155]
  buffer_load_dwordx4 a[32:35], v3, s[44:47], s67 offen offset:0 sc1
  v_mfma_f32_16x16x32_bf16 v[156:159], a[196:199], a[60:63], v[156:159]
  s_waitcnt lgkmcnt(2)
  v_mfma_f32_16x16x32_bf16 v[160:163], a[200:203], a[48:51], v[160:163]
  ds_read_b64_tr_b16 a[212:213], v41 offset:24576
  v_mfma_f32_16x16x32_bf16 v[164:167], a[200:203], a[52:55], v[164:167]
  ds_read_b64_tr_b16 a[214:215], v41 offset:28672
  v_mfma_f32_16x16x32_bf16 v[168:171], a[200:203], a[56:59], v[168:171]
  buffer_load_dwordx4 a[36:39], v3, s[44:47], s67 offen offset:1024 sc1
  v_mfma_f32_16x16x32_bf16 v[172:175], a[200:203], a[60:63], v[172:175]
  v_mfma_f32_16x16x32_bf16 v[176:179], a[204:207], a[48:51], v[176:179]
  ds_read_b64_tr_b16 a[216:217], v42 offset:24576
  v_mfma_f32_16x16x32_bf16 v[180:183], a[204:207], a[52:55], v[180:183]
  ds_read_b64_tr_b16 a[218:219], v42 offset:28672
  v_mfma_f32_16x16x32_bf16 v[184:187], a[204:207], a[56:59], v[184:187]
  buffer_load_dwordx4 a[40:43], v3, s[24:27], s67 offen offset:0 sc1
  v_mfma_f32_16x16x32_bf16 v[188:191], a[204:207], a[60:63], v[188:191]
  s_waitcnt lgkmcnt(2)
  v_mfma_f32_16x16x32_bf16 v[192:195], a[208:211], a[48:51], v[192:195]
  ds_read_b64_tr_b16 a[220:221], v43 offset:24576
  v_mfma_f32_16x16x32_bf16 v[196:199], a[208:211], a[52:55], v[196:199]
  ds_read_b64_tr_b16 a[222:223], v43 offset:28672
  v_mfma_f32_16x16x32_bf16 v[200:203], a[208:211], a[56:59], v[200:203]
  buffer_load_dwordx4 a[44:47], v3, s[24:27], s67 offen offset:1024 sc1
  v_mfma_f32_16x16x32_bf16 v[204:207], a[208:211], a[60:63], v[204:207]
  v_mfma_f32_16x16x32_bf16 v[208:211], a[212:215], a[48:51], v[208:211]
  s_waitcnt vmcnt(16)
  s_barrier
  ds_read_b64_tr_b16 a[192:193], v8 offset:32768
  v_mfma_f32_16x16x32_bf16 v[212:215], a[212:215], a[52:55], v[212:215]
  ds_read_b64_tr_b16 a[194:195], v8 offset:36864
  v_mfma_f32_16x16x32_bf16 v[216:219], a[212:215], a[56:59], v[216:219]
  v_mfma_f32_16x16x32_bf16 v[220:223], a[212:215], a[60:63], v[220:223]
  s_waitcnt lgkmcnt(2)
  v_mfma_f32_16x16x32_bf16 v[224:227], a[216:219], a[48:51], v[224:227]
  ds_read_b64_tr_b16 a[196:197], v9 offset:32768
  v_mfma_f32_16x16x32_bf16 v[228:231], a[216:219], a[52:55], v[228:231]
  ds_read_b64_tr_b16 a[198:199], v9 offset:36864
  v_mfma_f32_16x16x32_bf16 v[232:235], a[216:219], a[56:59], v[232:235]
  v_mfma_f32_16x16x32_bf16 v[236:239], a[216:219], a[60:63], v[236:239]
  v_mfma_f32_16x16x32_bf16 v[240:243], a[220:223], a[48:51], v[240:243]
  ds_read_b64_tr_b16 a[200:201], v10 offset:32768
  v_mfma_f32_16x16x32_bf16 v[244:247], a[220:223], a[52:55], v[244:247]
  ds_read_b64_tr_b16 a[202:203], v10 offset:36864
  v_mfma_f32_16x16x32_bf16 v[248:251], a[220:223], a[56:59], v[248:251]
  v_mfma_f32_16x16x32_bf16 v[252:255], a[220:223], a[60:63], v[252:255]
  s_waitcnt vmcnt(12) lgkmcnt(2)
  v_mfma_f32_16x16x32_bf16 v[128:131], a[192:195], a[0:3], v[128:131]
  ds_read_b64_tr_b16 a[204:205], v11 offset:32768
  v_mfma_f32_16x16x32_bf16 v[132:135], a[192:195], a[4:7], v[132:135]
  ds_read_b64_tr_b16 a[206:207], v11 offset:36864
  v_mfma_f32_16x16x32_bf16 v[136:139], a[192:195], a[8:11], v[136:139]
  buffer_load_dwordx4 a[48:51], v3, s[44:47], s67 offen offset:2048 sc1
  v_mfma_f32_16x16x32_bf16 v[140:143], a[192:195], a[12:15], v[140:143]
  v_mfma_f32_16x16x32_bf16 v[144:147], a[196:199], a[0:3], v[144:147]
  ds_read_b64_tr_b16 a[208:209], v40 offset:32768
  v_mfma_f32_16x16x32_bf16 v[148:151], a[196:199], a[4:7], v[148:151]
  ds_read_b64_tr_b16 a[210:211], v40 offset:36864
  v_mfma_f32_16x16x32_bf16 v[152:155], a[196:199], a[8:11], v[152:155]
  buffer_load_dwordx4 a[52:55], v3, s[44:47], s67 offen offset:3072 sc1
  v_mfma_f32_16x16x32_bf16 v[156:159], a[196:199], a[12:15], v[156:159]
  s_waitcnt lgkmcnt(2)
  v_mfma_f32_16x16x32_bf16 v[160:163], a[200:203], a[0:3], v[160:163]
  ds_read_b64_tr_b16 a[212:213], v41 offset:32768
  v_mfma_f32_16x16x32_bf16 v[164:167], a[200:203], a[4:7], v[164:167]
  ds_read_b64_tr_b16 a[214:215], v41 offset:36864
  v_mfma_f32_16x16x32_bf16 v[168:171], a[200:203], a[8:11], v[168:171]
  buffer_load_dwordx4 a[56:59], v3, s[24:27], s67 offen offset:2048 sc1
  v_mfma_f32_16x16x32_bf16 v[172:175], a[200:203], a[12:15], v[172:175]
  v_mfma_f32_16x16x32_bf16 v[176:179], a[204:207], a[0:3], v[176:179]
  ds_read_b64_tr_b16 a[216:217], v42 offset:32768
  v_mfma_f32_16x16x32_bf16 v[180:183], a[204:207], a[4:7], v[180:183]
  ds_read_b64_tr_b16 a[218:219], v42 offset:36864
  v_mfma_f32_16x16x32_bf16 v[184:187], a[204:207], a[8:11], v[184:187]
  buffer_load_dwordx4 a[60:63], v3, s[24:27], s67 offen offset:3072 sc1
  s_add_u32 s67, s67, 4096
  s_cmp_eq_u32 s67, 65536
  s_cselect_b32 s67, 0, s67
  v_mfma_f32_16x16x32_bf16 v[188:191], a[204:207], a[12:15], v[188:191]
  s_add_u32 m0, s19, 0
  s_waitcnt lgkmcnt(2)
  v_mfma_f32_16x16x32_bf16 v[192:195], a[208:211], a[0:3], v[192:195]
  ds_read_b64_tr_b16 a[220:221], v43 offset:32768
  v_mfma_f32_16x16x32_bf16 v[196:199], a[208:211], a[4:7], v[196:199]
  ds_read_b64_tr_b16 a[222:223], v43 offset:36864
  v_mfma_f32_16x16x32_bf16 v[200:203], a[208:211], a[8:11], v[200:203]
  v_mfma_f32_16x16x32_bf16 v[204:207], a[208:211], a[12:15], v[204:207]
  buffer_load_dwordx4 v48, s[4:7], s66 offen offset:0 lds
  v_mfma_f32_16x16x32_bf16 v[208:211], a[212:215], a[0:3], v[208:211]
  ds_read_b64_tr_b16 a[192:193], v8 offset:40960
  v_mfma_f32_16x16x32_bf16 v[212:215], a[212:215], a[4:7], v[212:215]
  ds_read_b64_tr_b16 a[194:195], v8 offset:45056
  v_mfma_f32_16x16x32_bf16 v[216:219], a[212:215], a[8:11], v[216:219]
  v_mfma_f32_16x16x32_bf16 v[220:223], a[212:215], a[12:15], v[220:223]
  buffer_load_dwordx4 v49, s[4:7], s66 offen offset:1024 lds
  s_waitcnt lgkmcnt(2)
  v_mfma_f32_16x16x32_bf16 v[224:227], a[216:219], a[0:3], v[224:227]
  ds_read_b64_tr_b16 a[196:197], v9 offset:40960
  v_mfma_f32_16x16x32_bf16 v[228:231], a[216:219], a[4:7], v[228:231]
  ds_read_b64_tr_b16 a[198:199], v9 offset:45056
  v_mfma_f32_16x16x32_bf16 v[232:235], a[216:219], a[8:11], v[232:235]
  v_mfma_f32_16x16x32_bf16 v[236:239], a[216:219], a[12:15], v[236:239]
  buffer_load_dwordx4 v50, s[4:7], s66 offen offset:2048 lds
  v_mfma_f32_16x16x32_bf16 v[240:243], a[220:223], a[0:3], v[240:243]
  ds_read_b64_tr_b16 a[200:201], v10 offset:40960
  v_mfma_f32_16x16x32_bf16 v[244:247], a[220:223], a[4:7], v[244:247]
  ds_read_b64_tr_b16 a[202:203], v10 offset:45056
  v_mfma_f32_16x16x32_bf16 v[248:251], a[220:223], a[8:11], v[248:251]
  v_mfma_f32_16x16x32_bf16 v[252:255], a[220:223], a[12:15], v[252:255]
  buffer_load_dwordx4 v51, s[4:7], s66 offen offset:3072 lds
  s_add_u32 s66, s66, 524288
  s_cmp_eq_u32 s66, 8388608
  s_cselect_b32 s66, 0, s66
  s_waitcnt vmcnt(16) lgkmcnt(2)
  v_mfma_f32_16x16x32_bf16 v[128:131], a[192:195], a[16:19], v[128:131]
  ds_read_b64_tr_b16 a[204:205], v11 offset:40960
  v_mfma_f32_16x16x32_bf16 v[132:135], a[192:195], a[20:23], v[132:135]
  ds_read_b64_tr_b16 a[206:207], v11 offset:45056
  v_mfma_f32_16x16x32_bf16 v[136:139], a[192:195], a[24:27], v[136:139]
  v_mfma_f32_16x16x32_bf16 v[140:143], a[192:195], a[28:31], v[140:143]
  v_mfma_f32_16x16x32_bf16 v[144:147], a[196:199], a[16:19], v[144:147]
  ds_read_b64_tr_b16 a[208:209], v40 offset:40960
  v_mfma_f32_16x16x32_bf16 v[148:151], a[196:199], a[20:23], v[148:151]
  ds_read_b64_tr_b16 a[210:211], v40 offset:45056
  v_mfma_f32_16x16x32_bf16 v[152:155], a[196:199], a[24:27], v[152:155]
  buffer_load_dwordx4 a[0:3], v3, s[44:47], s67 offen offset:0 sc1
  v_mfma_f32_16x16x32_bf16 v[156:159], a[196:199], a[28:31], v[156:159]
  s_waitcnt lgkmcnt(2)
  v_mfma_f32_16x16x32_bf16 v[160:163], a[200:203], a[16:19], v[160:163]
  ds_read_b64_tr_b16 a[212:213], v41 offset:40960
  v_mfma_f32_16x16x32_bf16 v[164:167], a[200:203], a[20:23], v[164:167]
  ds_read_b64_tr_b16 a[214:215], v41 offset:45056
  v_mfma_f32_16x16x32_bf16 v[168:171], a[200:203], a[24:27], v[168:171]
  buffer_load_dwordx4 a[4:7], v3, s[44:47], s67 offen offset:1024 sc1
  v_mfma_f32_16x16x32_bf16 v[172:175], a[200:203], a[28:31], v[172:175]
  v_mfma_f32_16x16x32_bf16 v[176:179], a[204:207], a[16:19], v[176:179]
  ds_read_b64_tr_b16 a[216:217], v42 offset:40960
  v_mfma_f32_16x16x32_bf16 v[180:183], a[204:207], a[20:23], v[180:183]
  ds_read_b64_tr_b16 a[218:219], v42 offset:45056
  v_mfma_f32_16x16x32_bf16 v[184:187], a[204:207], a[24:27], v[184:187]
  buffer_load_dwordx4 a[8:11], v3, s[24:27], s67 offen offset:0 sc1
  v_mfma_f32_16x16x32_bf16 v[188:191], a[204:207], a[28:31], v[188:191]
  s_waitcnt lgkmcnt(2)
  v_mfma_f32_16x16x32_bf16 v[192:195], a[208:211], a[16:19], v[192:195]
  ds_read_b64_tr_b16 a[220:221], v43 offset:40960
  v_mfma_f32_16x16x32_bf16 v[196:199], a[208:211], a[20:23], v[196:199]
  ds_read_b64_tr_b16 a[222:223], v43 offset:45056
  v_mfma_f32_16x16x32_bf16 v[200:203], a[208:211], a[24:27], v[200:203]
  buffer_load_dwordx4 a[12:15], v3, s[24:27], s67 offen offset:1024 sc1
  v_mfma_f32_16x16x32_bf16 v[204:207], a[208:211], a[28:31], v[204:207]
  v_mfma_f32_16x16x32_bf16 v[208:211], a[212:215], a[16:19], v[208:211]
  s_waitcnt vmcnt(16)
  s_barrier
  ds_read_b64_tr_b16 a[192:193], v8 offset:49152
  v_mfma_f32_16x16x32_bf16 v[212:215], a[212:215], a[20:23], v[212:215]
  ds_read_b64_tr_b16 a[194:195], v8 offset:53248
  v_mfma_f32_16x16x32_bf16 v[216:219], a[212:215], a[24:27], v[216:219]
  v_mfma_f32_16x16x32_bf16 v[220:223], a[212:215], a[28:31], v[220:223]
  s_waitcnt lgkmcnt(2)
  v_mfma_f32_16x16x32_bf16 v[224:227], a[216:219], a[16:19], v[224:227]
  ds_read_b64_tr_b16 a[196:197], v9 offset:49152
  v_mfma_f32_16x16x32_bf16 v[228:231], a[216:219], a[20:23], v[228:231]
  ds_read_b64_tr_b16 a[198:199], v9 offset:53248
  v_mfma_f32_16x16x32_bf16 v[232:235], a[216:219], a[24:27], v[232:235]
  v_mfma_f32_16x16x32_bf16 v[236:239], a[216:219], a[28:31], v[236:239]
  v_mfma_f32_16x16x32_bf16 v[240:243], a[220:223], a[16:19], v[240:243]
  ds_read_b64_tr_b16 a[200:201], v10 offset:49152
  v_mfma_f32_16x16x32_bf16 v[244:247], a[220:223], a[20:23], v[244:247]
  ds_read_b64_tr_b16 a[202:203], v10 offset:53248
  v_mfma_f32_16x16x32_bf16 v[248:251], a[220:223], a[24:27], v[248:251]
  v_mfma_f32_16x16x32_bf16 v[252:255], a[220:223], a[28:31], v[252:255]
  s_waitcnt vmcnt(12) lgkmcnt(2)
  v_mfma_f32_16x16x32_bf16 v[128:131], a[192:195], a[32:35], v[128:131]
  ds_read_b64_tr_b16 a[204:205], v11 offset:49152
  v_mfma_f32_16x16x32_bf16 v[132:135], a[192:195], a[36:39], v[132:135]
  ds_read_b64_tr_b16 a[206:207], v11 offset:53248
  v_mfma_f32_16x16x32_bf16 v[136:139], a[192:195], a[40:43], v[136:139]
  buffer_load_dwordx4 a[16:19], v3, s[44:47], s67 offen offset:2048 sc1
  v_mfma_f32_16x16x32_bf16 v[140:143], a[192:195], a[44:47], v[140:143]
  v_mfma_f32_16x16x32_bf16 v[144:147], a[196:199], a[32:35], v[144:147]
  ds_read_b64_tr_b16 a[208:209], v40 offset:49152
  v_mfma_f32_16x16x32_bf16 v[148:151], a[196:199], a[36:39], v[148:151]
  ds_read_b64_tr_b16 a[210:211], v40 offset:53248
  v_mfma_f32_16x16x32_bf16 v[152:155], a[196:199], a[40:43], v[152:155]
  buffer_load_dwordx4 a[20:23], v3, s[44:47], s67 offen offset:3072 sc1
  v_mfma_f32_16x16x32_bf16 v[156:159], a[196:199], a[44:47], v[156:159]
  s_waitcnt lgkmcnt(2)
  v_mfma_f32_16x16x32_bf16 v[160:163], a[200:203], a[32:35], v[160:163]
  ds_read_b64_tr_b16 a[212:213], v41 offset:49152
  v_mfma_f32_16x16x32_bf16 v[164:167], a[200:203], a[36:39], v[164:167]
  ds_read_b64_tr_b16 a[214:215], v41 offset:53248
  v_mfma_f32_16x16x32_bf16 v[168:171], a[200:203], a[40:43], v[168:171]
  buffer_load_dwordx4 a[24:27], v3, s[24:27], s67 offen offset:2048 sc1
  v_mfma_f32_16x16x32_bf16 v[172:175], a[200:203], a[44:47], v[172:175]
  v_mfma_f32_16x16x32_bf16 v[176:179], a[204:207], a[32:35], v[176:179]
  ds_read_b64_tr_b16 a[216:217], v42 offset:49152
  v_mfma_f32_16x16x32_bf16 v[180:183], a[204:207], a[36:39], v[180:183]
  ds_read_b64_tr_b16 a[218:219], v42 offset:53248
  v_mfma_f32_16x16x32_bf16 v[184:187], a[204:207], a[40:43], v[184:187]
  buffer_load_dwordx4 a[28:31], v3, s[24:27], s67 offen offset:3072 sc1
  s_add_u32 s67, s67, 4096
  s_cmp_eq_u32 s67, 65536
  s_cselect_b32 s67, 0, s67
  v_mfma_f32_16x16x32_bf16 v[188:191], a[204:207], a[44:47], v[188:191]
  s_add_u32 m0, s19, 16384
  s_waitcnt lgkmcnt(2)
  v_mfma_f32_16x16x32_bf16 v[192:195], a[208:211], a[32:35], v[192:195]
  ds_read_b64_tr_b16 a[220:221], v43 offset:49152
  v_mfma_f32_16x16x32_bf16 v[196:199], a[208:211], a[36:39], v[196:199]
  ds_read_b64_tr_b16 a[222:223], v43 offset:53248
  v_mfma_f32_16x16x32_bf16 v[200:203], a[208:211], a[40:43], v[200:203]
  v_mfma_f32_16x16x32_bf16 v[204:207], a[208:211], a[44:47], v[204:207]
  buffer_load_dwordx4 v48, s[4:7], s66 offen offset:0 lds
  v_mfma_f32_16x16x32_bf16 v[208:211], a[212:215], a[32:35], v[208:211]
  ds_read_b64_tr_b16 a[192:193], v8 offset:57344
  v_mfma_f32_16x16x32_bf16 v[212:215], a[212:215], a[36:39], v[212:215]
  ds_read_b64_tr_b16 a[194:195], v8 offset:61440
  v_mfma_f32_16x16x32_bf16 v[216:219], a[212:215], a[40:43], v[216:219]
  v_mfma_f32_16x16x32_bf16 v[220:223], a[212:215], a[44:47], v[220:223]
  buffer_load_dwordx4 v49, s[4:7], s66 offen offset:1024 lds
  s_waitcnt lgkmcnt(2)
  v_mfma_f32_16x16x32_bf16 v[224:227], a[216:219], a[32:35], v[224:227]
  ds_read_b64_tr_b16 a[196:197], v9 offset:57344
  v_mfma_f32_16x16x32_bf16 v[228:231], a[216:219], a[36:39], v[228:231]
  ds_read_b64_tr_b16 a[198:199], v9 offset:61440
  v_mfma_f32_16x16x32_bf16 v[232:235], a[216:219], a[40:43], v[232:235]
  v_mfma_f32_16x16x32_bf16 v[236:239], a[216:219], a[44:47], v[236:239]
  buffer_load_dwordx4 v50, s[4:7], s66 offen offset:2048 lds
  v_mfma_f32_16x16x32_bf16 v[240:243], a[220:223], a[32:35], v[240:243]
  ds_read_b64_tr_b16 a[200:201], v10 offset:57344
  v_mfma_f32_16x16x32_bf16 v[244:247], a[220:223], a[36:39], v[244:247]
  ds_read_b64_tr_b16 a[202:203], v10 offset:61440
  v_mfma_f32_16x16x32_bf16 v[248:251], a[220:223], a[40:43], v[248:251]
  v_mfma_f32_16x16x32_bf16 v[252:255], a[220:223], a[44:47], v[252:255]
  buffer_load_dwordx4 v51, s[4:7], s66 offen offset:3072 lds
  s_add_u32 s66, s66, 524288
  s_cmp_eq_u32 s66, 8388608
  s_cselect_b32 s66, 0, s66
  s_waitcnt vmcnt(16) lgkmcnt(2)
  v_mfma_f32_16x16x32_bf16 v[128:131], a[192:195], a[48:51], v[128:131]
  ds_read_b64_tr_b16 a[204:205], v11 offset:57344
  v_mfma_f32_16x16x32_bf16 v[132:135], a[192:195], a[52:55], v[132:135]
  ds_read_b64_tr_b16 a[206:207], v11 offset:61440
  v_mfma_f32_16x16x32_bf16 v[136:139], a[192:195], a[56:59], v[136:139]
  v_mfma_f32_16x16x32_bf16 v[140:143], a[192:195], a[60:63], v[140:143]
  v_mfma_f32_16x16x32_bf16 v[144:147], a[196:199], a[48:51], v[144:147]
  ds_read_b64_tr_b16 a[208:209], v40 offset:57344
  v_mfma_f32_16x16x32_bf16 v[148:151], a[196:199], a[52:55], v[148:151]
  ds_read_b64_tr_b16 a[210:211], v40 offset:61440
  v_mfma_f32_16x16x32_bf16 v[152:155], a[196:199], a[56:59], v[152:155]
  buffer_load_dwordx4 a[32:35], v3, s[44:47], s67 offen offset:0 sc1
  v_mfma_f32_16x16x32_bf16 v[156:159], a[196:199], a[60:63], v[156:159]
  s_waitcnt lgkmcnt(2)
  v_mfma_f32_16x16x32_bf16 v[160:163], a[200:203], a[48:51], v[160:163]
  ds_read_b64_tr_b16 a[212:213], v41 offset:57344
  v_mfma_f32_16x16x32_bf16 v[164:167], a[200:203], a[52:55], v[164:167]
  ds_read_b64_tr_b16 a[214:215], v41 offset:61440
  v_mfma_f32_16x16x32_bf16 v[168:171], a[200:203], a[56:59], v[168:171]
  buffer_load_dwordx4 a[36:39], v3, s[44:47], s67 offen offset:1024 sc1
  v_mfma_f32_16x16x32_bf16 v[172:175], a[200:203], a[60:63], v[172:175]
  v_mfma_f32_16x16x32_bf16 v[176:179], a[204:207], a[48:51], v[176:179]
  ds_read_b64_tr_b16 a[216:217], v42 offset:57344
  v_mfma_f32_16x16x32_bf16 v[180:183], a[204:207], a[52:55], v[180:183]
  ds_read_b64_tr_b16 a[218:219], v42 offset:61440
  v_mfma_f32_16x16x32_bf16 v[184:187], a[204:207], a[56:59], v[184:187]
  buffer_load_dwordx4 a[40:43], v3, s[24:27], s67 offen offset:0 sc1
  v_mfma_f32_16x16x32_bf16 v[188:191], a[204:207], a[60:63], v[188:191]
  s_waitcnt lgkmcnt(2)
  v_mfma_f32_16x16x32_bf16 v[192:195], a[208:211], a[48:51], v[192:195]
  ds_read_b64_tr_b16 a[220:221], v43 offset:57344
  v_mfma_f32_16x16x32_bf16 v[196:199], a[208:211], a[52:55], v[196:199]
  ds_read_b64_tr_b16 a[222:223], v43 offset:61440
  v_mfma_f32_16x16x32_bf16 v[200:203], a[208:211], a[56:59], v[200:203]
  buffer_load_dwordx4 a[44:47], v3, s[24:27], s67 offen offset:1024 sc1
  v_mfma_f32_16x16x32_bf16 v[204:207], a[208:211], a[60:63], v[204:207]
  v_mfma_f32_16x16x32_bf16 v[208:211], a[212:215], a[48:51], v[208:211]
  s_waitcnt vmcnt(16)
  s_barrier
  ds_read_b64_tr_b16 a[192:193], v8 offset:0
  v_mfma_f32_16x16x32_bf16 v[212:215], a[212:215], a[52:55], v[212:215]
  ds_read_b64_tr_b16 a[194:195], v8 offset:4096
  v_mfma_f32_16x16x32_bf16 v[216:219], a[212:215], a[56:59], v[216:219]
  v_mfma_f32_16x16x32_bf16 v[220:223], a[212:215], a[60:63], v[220:223]
  s_waitcnt lgkmcnt(2)
  v_mfma_f32_16x16x32_bf16 v[224:227], a[216:219], a[48:51], v[224:227]
  ds_read_b64_tr_b16 a[196:197], v9 offset:0
  v_mfma_f32_16x16x32_bf16 v[228:231], a[216:219], a[52:55], v[228:231]
  ds_read_b64_tr_b16 a[198:199], v9 offset:4096
  v_mfma_f32_16x16x32_bf16 v[232:235], a[216:219], a[56:59], v[232:235]
  v_mfma_f32_16x16x32_bf16 v[236:239], a[216:219], a[60:63], v[236:239]
  v_mfma_f32_16x16x32_bf16 v[240:243], a[220:223], a[48:51], v[240:243]
  ds_read_b64_tr_b16 a[200:201], v10 offset:0
  v_mfma_f32_16x16x32_bf16 v[244:247], a[220:223], a[52:55], v[244:247]
  ds_read_b64_tr_b16 a[202:203], v10 offset:4096
  v_mfma_f32_16x16x32_bf16 v[248:251], a[220:223], a[56:59], v[248:251]
  v_mfma_f32_16x16x32_bf16 v[252:255], a[220:223], a[60:63], v[252:255]
  s_sub_u32 s20, s20, 1
  s_cmp_lg_u32 s20, 0
  s_cbranch_scc1 L_mk5_q_4
  s_waitcnt lgkmcnt(4)
  ds_read_b128 a[192:195], v16 offset:0
  s_waitcnt lgkmcnt(3)
  ds_read_b128 a[196:199], v17 offset:0
  s_waitcnt lgkmcnt(2)
  ds_read_b128 a[200:203], v18 offset:0
  ds_read_b128 a[204:207], v19 offset:0
  ds_read_b128 a[208:211], v20 offset:0
  ds_read_b128 a[212:215], v21 offset:0
  ds_read_b128 a[216:219], v22 offset:0
  ds_read_b128 a[220:223], v23 offset:0
  s_add_u32 m0, s19, 98304
  s_nop 0
  buffer_load_dwordx4 v12, s[28:31], s43 offen offset:0 lds
  buffer_load_dwordx4 v13, s[28:31], s43 offen offset:1024 lds
  buffer_load_dwordx4 v14, s[28:31], s43 offen offset:2048 lds
  buffer_load_dwordx4 v15, s[28:31], s43 offen offset:3072 lds
  s_add_u32 s43, s43, 8192
  s_add_u32 m0, s19, 114688
  s_nop 0
  buffer_load_dwordx4 v12, s[28:31], s43 offen offset:0 lds
  buffer_load_dwordx4 v13, s[28:31], s43 offen offset:1024 lds
  buffer_load_dwordx4 v14, s[28:31], s43 offen offset:2048 lds
  buffer_load_dwordx4 v15, s[28:31], s43 offen offset:3072 lds
  s_add_u32 s43, s43, 8192
  v_cvt_pk_bf16_f32 v36, v128, v129
  v_cvt_pk_bf16_f32 v37, v130, v131
  v_cvt_pk_bf16_f32 v38, v132, v133
  v_cvt_pk_bf16_f32 v39, v134, v135
  v_cvt_pk_bf16_f32 v52, v136, v137
  v_cvt_pk_bf16_f32 v53, v138, v139
  v_cvt_pk_bf16_f32 v54, v140, v141
  v_cvt_pk_bf16_f32 v55, v142, v143
  v_permlane16_swap_b32 v36, v38
  v_permlane16_swap_b32 v37, v39
  v_accvgpr_write_b32 a128, v36
  v_permlane16_swap_b32 v52, v54
  v_permlane16_swap_b32 v53, v55
  v_accvgpr_write_b32 a129, v37
  v_accvgpr_write_b32 a130, v38
  v_accvgpr_write_b32 a131, v39
  v_accvgpr_write_b32 a160, v52
  v_accvgpr_write_b32 a161, v53
  v_accvgpr_write_b32 a162, v54
  v_accvgpr_write_b32 a163, v55
  v_cvt_pk_bf16_f32 v36, v144, v145
  v_cvt_pk_bf16_f32 v37, v146, v147
  v_cvt_pk_bf16_f32 v38, v148, v149
  v_cvt_pk_bf16_f32 v39, v150, v151
  v_cvt_pk_bf16_f32 v52, v152, v153
  v_cvt_pk_bf16_f32 v53, v154, v155
  v_cvt_pk_bf16_f32 v54, v156, v157
  v_cvt_pk_bf16_f32 v55, v158, v159
  v_permlane16_swap_b32 v36, v38
  v_permlane16_swap_b32 v37, v39
  v_accvgpr_write_b32 a132, v36
  v_permlane16_swap_b32 v52, v54
  v_permlane16_swap_b32 v53, v55
  v_accvgpr_write_b32 a133, v37
  v_accvgpr_write_b32 a134, v38
  v_accvgpr_write_b32 a135, v39
  v_accvgpr_write_b32 a164, v52
  v_accvgpr_write_b32 a165, v53
  v_accvgpr_write_b32 a166, v54
  v_accvgpr_write_b32 a167, v55
  v_cvt_pk_bf16_f32 v36, v160, v161
  v_cvt_pk_bf16_f32 v37, v162, v163
  v_cvt_pk_bf16_f32 v38, v164, v165
  v_cvt_pk_bf16_f32 v39, v166, v167
  v_cvt_pk_bf16_f32 v52, v168, v169
  v_cvt_pk_bf16_f32 v53, v170, v171
  v_cvt_pk_bf16_f32 v54, v172, v173
  v_cvt_pk_bf16_f32 v55, v174, v175
  v_permlane16_swap_b32 v36, v38
  v_permlane16_swap_b32 v37, v39
  v_accvgpr_write_b32 a136, v36
  v_permlane16_swap_b32 v52, v54
  v_permlane16_swap_b32 v53, v55
  v_accvgpr_write_b32 a137, v37
  v_accvgpr_write_b32 a138, v38
  v_accvgpr_write_b32 a139, v39
  v_accvgpr_write_b32 a168, v52
  v_accvgpr_write_b32 a169, v53
  v_accvgpr_write_b32 a170, v54
  v_accvgpr_write_b32 a171, v55
  v_cvt_pk_bf16_f32 v36, v176, v177
  v_cvt_pk_bf16_f32 v37, v178, v179
  v_cvt_pk_bf16_f32 v38, v180, v181
  v_cvt_pk_bf16_f32 v39, v182, v183
  v_cvt_pk_bf16_f32 v52, v184, v185
  v_cvt_pk_bf16_f32 v53, v186, v187
  v_cvt_pk_bf16_f32 v54, v188, v189
  v_cvt_pk_bf16_f32 v55, v190, v191
  v_permlane16_swap_b32 v36, v38
  v_permlane16_swap_b32 v37, v39
  v_accvgpr_write_b32 a140, v36
  v_permlane16_swap_b32 v52, v54
  v_permlane16_swap_b32 v53, v55
  v_accvgpr_write_b32 a141, v37
  v_accvgpr_write_b32 a142, v38
  v_accvgpr_write_b32 a143, v39
  v_accvgpr_write_b32 a172, v52
  v_accvgpr_write_b32 a173, v53
  v_accvgpr_write_b32 a174, v54
  v_accvgpr_write_b32 a175, v55
  s_nop 0
  s_waitcnt lgkmcnt(7)
  v_mfma_f32_32x32x16_bf16 v[128:143], a[192:195], a[128:131], 0
  v_cvt_pk_bf16_f32 v36, v192, v193
  v_cvt_pk_bf16_f32 v37, v194, v195
  v_cvt_pk_bf16_f32 v38, v196, v197
  v_cvt_pk_bf16_f32 v39, v198, v199
  v_cvt_pk_bf16_f32 v52, v200, v201
  v_cvt_pk_bf16_f32 v53, v202, v203
  v_cvt_pk_bf16_f32 v54, v204, v205
  v_cvt_pk_bf16_f32 v55, v206, v207
  v_permlane16_swap_b32 v36, v38
  v_permlane16_swap_b32 v37, v39
  v_mfma_f32_32x32x16_bf16 v[144:159], a[192:195], a[160:163], 0
  v_accvgpr_write_b32 a144, v36
  v_permlane16_swap_b32 v52, v54
  v_permlane16_swap_b32 v53, v55
  v_accvgpr_write_b32 a145, v37
  v_accvgpr_write_b32 a146, v38
  v_accvgpr_write_b32 a147, v39
  v_accvgpr_write_b32 a176, v52
  v_accvgpr_write_b32 a177, v53
  v_accvgpr_write_b32 a178, v54
  v_accvgpr_write_b32 a179, v55
  s_waitcnt lgkmcnt(6)
  v_mfma_f32_32x32x16_bf16 v[128:143], a[196:199], a[132:135], v[128:143]
  v_cvt_pk_bf16_f32 v36, v208, v209
  v_cvt_pk_bf16_f32 v37, v210, v211
  v_cvt_pk_bf16_f32 v38, v212, v213
  v_cvt_pk_bf16_f32 v39, v214, v215
  v_cvt_pk_bf16_f32 v52, v216, v217
  v_cvt_pk_bf16_f32 v53, v218, v219
  v_cvt_pk_bf16_f32 v54, v220, v221
  v_cvt_pk_bf16_f32 v55, v222, v223
  v_permlane16_swap_b32 v36, v38
  v_permlane16_swap_b32 v37, v39
  v_mfma_f32_32x32x16_bf16 v[144:159], a[196:199], a[164:167], v[144:159]
  v_accvgpr_write_b32 a148, v36
  v_permlane16_swap_b32 v52, v54
  v_permlane16_swap_b32 v53, v55
  v_accvgpr_write_b32 a149, v37
  v_accvgpr_write_b32 a150, v38
  v_accvgpr_write_b32 a151, v39
  v_accvgpr_write_b32 a180, v52
  v_accvgpr_write_b32 a181, v53
  v_accvgpr_write_b32 a182, v54
  v_accvgpr_write_b32 a183, v55
  s_waitcnt lgkmcnt(5)
  v_mfma_f32_32x32x16_bf16 v[128:143], a[200:203], a[136:139], v[128:143]
  v_cvt_pk_bf16_f32 v36, v224, v225
  v_cvt_pk_bf16_f32 v37, v226, v227
  v_cvt_pk_bf16_f32 v38, v228, v229
  v_cvt_pk_bf16_f32 v39, v230, v231
  v_cvt_pk_bf16_f32 v52, v232, v233
  v_cvt_pk_bf16_f32 v53, v234, v235
  v_cvt_pk_bf16_f32 v54, v236, v237
  v_cvt_pk_bf16_f32 v55, v238, v239
  v_permlane16_swap_b32 v36, v38
  v_permlane16_swap_b32 v37, v39
  v_mfma_f32_32x32x16_bf16 v[144:159], a[200:203], a[168:171], v[144:159]
  v_accvgpr_write_b32 a152, v36
  v_permlane16_swap_b32 v52, v54
  v_permlane16_swap_b32 v53, v55
  v_accvgpr_write_b32 a153, v37
  v_accvgpr_write_b32 a154, v38
  v_accvgpr_write_b32 a155, v39
  v_accvgpr_write_b32 a184, v52
  v_accvgpr_write_b32 a185, v53
  v_accvgpr_write_b32 a186, v54
  v_accvgpr_write_b32 a187, v55
  s_waitcnt lgkmcnt(4)
  v_mfma_f32_32x32x16_bf16 v[128:143], a[204:207], a[140:143], v[128:143]
  v_cvt_pk_bf16_f32 v36, v240, v241
  v_cvt_pk_bf16_f32 v37, v242, v243
  v_cvt_pk_bf16_f32 v38, v244, v245
  v_cvt_pk_bf16_f32 v39, v246, v247
  v_cvt_pk_bf16_f32 v52, v248, v249
  v_cvt_pk_bf16_f32 v53, v250, v251
  v_cvt_pk_bf16_f32 v54, v252, v253
  v_cvt_pk_bf16_f32 v55, v254, v255
  v_permlane16_swap_b32 v36, v38
  v_permlane16_swap_b32 v37, v39
  v_mfma_f32_32x32x16_bf16 v[144:159], a[204:207], a[172:175], v[144:159]
  v_accvgpr_write_b32 a156, v36
  v_permlane16_swap_b32 v52, v54
  v_permlane16_swap_b32 v53, v55
  v_accvgpr_write_b32 a157, v37
  v_accvgpr_write_b32 a158, v38
  v_accvgpr_write_b32 a159, v39
  v_accvgpr_write_b32 a188, v52
  v_accvgpr_write_b32 a189, v53
  v_accvgpr_write_b32 a190, v54
  v_accvgpr_write_b32 a191, v55
  s_waitcnt lgkmcnt(3)
  v_mfma_f32_32x32x16_bf16 v[128:143], a[208:211], a[144:147], v[128:143]
  v_mfma_f32_32x32x16_bf16 v[144:159], a[208:211], a[176:179], v[144:159]
  ds_read_b128 a[192:195], v16 offset:16384
  s_waitcnt lgkmcnt(3)
  v_mfma_f32_32x32x16_bf16 v[128:143], a[212:215], a[148:151], v[128:143]
  v_mfma_f32_32x32x16_bf16 v[144:159], a[212:215], a[180:183], v[144:159]
  ds_read_b128 a[196:199], v17 offset:16384
  s_waitcnt lgkmcnt(3)
  v_mfma_f32_32x32x16_bf16 v[128:143], a[216:219], a[152:155], v[128:143]
  v_mfma_f32_32x32x16_bf16 v[144:159], a[216:219], a[184:187], v[144:159]
  ds_read_b128 a[200:203], v18 offset:16384
  s_waitcnt lgkmcnt(3)
  v_mfma_f32_32x32x16_bf16 v[128:143], a[220:223], a[156:159], v[128:143]
  v_mfma_f32_32x32x16_bf16 v[144:159], a[220:223], a[188:191], v[144:159]
  ds_read_b128 a[204:207], v19 offset:16384
  v_mov_b32 v28, 0
  v_mov_b32 v29, 0
  s_nop 7
  s_nop 1
  v_max3_f32 v30, v128, v129, v130
  v_max3_f32 v31, v144, v145, v146
  v_max3_f32 v30, v30, v131, v132
  v_max3_f32 v31, v31, v147, v148
  v_max3_f32 v30, v30, v133, v134
  v_max3_f32 v31, v31, v149, v150
  v_max3_f32 v30, v30, v135, v136
  v_max3_f32 v31, v31, v151, v152
  v_max3_f32 v30, v30, v137, v138
  v_max3_f32 v31, v31, v153, v154
  v_max3_f32 v30, v30, v139, v140
  v_max3_f32 v31, v31, v155, v156
  v_max3_f32 v30, v30, v141, v142
  v_max3_f32 v31, v31, v157, v158
  v_max_f32 v30, v30, v143
  v_max_f32 v31, v31, v159
  v_mov_b32 v36, v30
  v_mov_b32 v37, v31
  s_nop 1
  v_permlane32_swap_b32 v30, v36
  v_permlane32_swap_b32 v31, v37
  s_nop 0
  v_max_f32 v30, v30, v36
  v_max_f32 v31, v31, v37
  v_sub_f32 v192, 0, v30
  v_sub_f32 v193, 0, v30
  v_sub_f32 v194, 0, v30
  v_sub_f32 v195, 0, v30
  v_sub_f32 v196, 0, v30
  v_sub_f32 v197, 0, v30
  v_sub_f32 v198, 0, v30
  v_sub_f32 v199, 0, v30
  v_sub_f32 v200, 0, v30
  v_sub_f32 v201, 0, v30
  v_sub_f32 v202, 0, v30
  v_sub_f32 v203, 0, v30
  v_sub_f32 v204, 0, v30
  v_sub_f32 v205, 0, v30
  v_sub_f32 v206, 0, v30
  v_sub_f32 v207, 0, v30
  v_sub_f32 v208, 0, v31
  v_sub_f32 v209, 0, v31
  v_sub_f32 v210, 0, v31
  v_sub_f32 v211, 0, v31
  v_sub_f32 v212, 0, v31
  v_sub_f32 v213, 0, v31
  v_sub_f32 v214, 0, v31
  v_sub_f32 v215, 0, v31
  v_sub_f32 v216, 0, v31
  v_sub_f32 v217, 0, v31
  v_sub_f32 v218, 0, v31
  v_sub_f32 v219, 0, v31
  v_sub_f32 v220, 0, v31
  v_sub_f32 v221, 0, v31
  v_sub_f32 v222, 0, v31
  v_sub_f32 v223, 0, v31
  v_sub_f32 v128, v128, v30
  v_sub_f32 v129, v129, v30
  v_sub_f32 v130, v130, v30
  v_sub_f32 v131, v131, v30
  v_sub_f32 v132, v132, v30
  v_sub_f32 v133, v133, v30
  v_sub_f32 v134, v134, v30
  v_sub_f32 v135, v135, v30
  v_sub_f32 v136, v136, v30
  v_sub_f32 v137, v137, v30
  v_sub_f32 v138, v138, v30
  v_sub_f32 v139, v139, v30
  v_sub_f32 v140, v140, v30
  v_sub_f32 v141, v141, v30
  v_sub_f32 v142, v142, v30
  v_sub_f32 v143, v143, v30
  v_sub_f32 v144, v144, v31
  v_sub_f32 v145, v145, v31
  v_sub_f32 v146, v146, v31
  v_sub_f32 v147, v147, v31
  v_sub_f32 v148, v148, v31
  v_sub_f32 v149, v149, v31
  v_sub_f32 v150, v150, v31
  v_sub_f32 v151, v151, v31
  v_sub_f32 v152, v152, v31
  v_sub_f32 v153, v153, v31
  v_sub_f32 v154, v154, v31
  v_sub_f32 v155, v155, v31
  v_sub_f32 v156, v156, v31
  v_sub_f32 v157, v157, v31
  v_sub_f32 v158, v158, v31
  v_sub_f32 v159, v159, v31
  s_waitcnt lgkmcnt(2)
  v_mfma_f32_32x32x16_bf16 v[160:175], a[192:195], a[128:131], v[192:207]
  ds_read_b128 a[208:211], v20 offset:16384
  v_exp_f32 v128, v128
  v_exp_f32 v129, v129
  v_mfma_f32_32x32x16_bf16 v[176:191], a[192:195], a[160:163], v[208:223]
  v_exp_f32 v130, v130
  v_cvt_pk_bf16_f32 v224, v128, v129
  v_exp_f32 v131, v131
  v_mfma_f32_32x32x16_bf16 v[160:175], a[196:199], a[132:135], v[160:175]
  ds_read_b128 a[212:215], v21 offset:16384
  v_exp_f32 v132, v132
  v_cvt_pk_bf16_f32 v225, v130, v131
  v_exp_f32 v133, v133
  v_mfma_f32_32x32x16_bf16 v[176:191], a[196:199], a[164:167], v[176:191]
  v_exp_f32 v134, v134
  v_cvt_pk_bf16_f32 v226, v132, v133
  v_exp_f32 v135, v135
  v_add_f32 v28, v28, v128
  s_waitcnt lgkmcnt(2)
  v_mfma_f32_32x32x16_bf16 v[160:175], a[200:203], a[136:139], v[160:175]
  ds_read_b128 a[216:219], v22 offset:16384
  v_exp_f32 v144, v144
  v_cvt_pk_bf16_f32 v227, v134, v135
  v_add_f32 v28, v28, v129
  v_mfma_f32_32x32x16_bf16 v[176:191], a[200:203], a[168:171], v[176:191]
  v_exp_f32 v145, v145
  v_exp_f32 v146, v146
  v_cvt_pk_bf16_f32 v232, v144, v145
  v_add_f32 v28, v28, v130
  v_mfma_f32_32x32x16_bf16 v[160:175], a[204:207], a[140:143], v[160:175]
  ds_read_b128 a[220:223], v23 offset:16384
  v_exp_f32 v147, v147
  v_exp_f32 v148, v148
  v_cvt_pk_bf16_f32 v233, v146, v147
  v_mfma_f32_32x32x16_bf16 v[176:191], a[204:207], a[172:175], v[176:191]
  v_exp_f32 v149, v149
  v_exp_f32 v150, v150
  v_cvt_pk_bf16_f32 v234, v148, v149
  v_add_f32 v28, v28, v131
  s_waitcnt lgkmcnt(2)
  v_mfma_f32_32x32x16_bf16 v[160:175], a[208:211], a[144:147], v[160:175]
  ds_read_b64_tr_b16 a[224:225], v24 offset:16384
  v_exp_f32 v151, v151
  v_exp_f32 v136, v136
  v_mfma_f32_32x32x16_bf16 v[176:191], a[208:211], a[176:179], v[176:191]
  ds_read_b64_tr_b16 a[226:227], v24 offset:18432
  v_cvt_pk_bf16_f32 v235, v150, v151
  v_exp_f32 v137, v137
  v_exp_f32 v138, v138
  v_mfma_f32_32x32x16_bf16 v[160:175], a[212:215], a[148:151], v[160:175]
  ds_read_b64_tr_b16 a[228:229], v25 offset:16384
  v_cvt_pk_bf16_f32 v228, v136, v137
  v_exp_f32 v139, v139
  v_exp_f32 v140, v140
  v_mfma_f32_32x32x16_bf16 v[176:191], a[212:215], a[180:183], v[176:191]
  ds_read_b64_tr_b16 a[230:231], v25 offset:18432
  v_cvt_pk_bf16_f32 v229, v138, v139
  v_exp_f32 v141, v141
  v_exp_f32 v142, v142
  s_waitcnt lgkmcnt(4)
  v_mfma_f32_32x32x16_bf16 v[160:175], a[216:219], a[152:155], v[160:175]
  ds_read_b64_tr_b16 a[232:233], v26 offset:16384
  v_cvt_pk_bf16_f32 v230, v140, v141
  v_exp_f32 v143, v143
  v_add_f32 v28, v28, v132
  v_mfma_f32_32x32x16_bf16 v[176:191], a[216:219], a[184:187], v[176:191]
  ds_read_b64_tr_b16 a[234:235], v26 offset:18432
  v_exp_f32 v152, v152
  v_cvt_pk_bf16_f32 v231, v142, v143
  v_exp_f32 v153, v153
  v_mfma_f32_32x32x16_bf16 v[160:175], a[220:223], a[156:159], v[160:175]
  ds_read_b64_tr_b16 a[236:237], v27 offset:16384
  v_exp_f32 v154, v154
  v_cvt_pk_bf16_f32 v236, v152, v153
  v_exp_f32 v155, v155
  v_mfma_f32_32x32x16_bf16 v[176:191], a[220:223], a[188:191], v[176:191]
  ds_read_b64_tr_b16 a[238:239], v27 offset:18432
  v_exp_f32 v156, v156
  v_cvt_pk_bf16_f32 v237, v154, v155
  v_exp_f32 v157, v157
  s_nop 0
  s_waitcnt vmcnt(20) lgkmcnt(4)
  v_mfma_f32_32x32x16_bf16 a[0:15], a[224:227], v[224:227], 0
  ds_read_b64_tr_b16 a[240:241], v24 offset:20480
  v_exp_f32 v158, v158
  v_cvt_pk_bf16_f32 v238, v156, v157
  v_add_f32 v28, v28, v133
  s_waitcnt vmcnt(16)
  v_mfma_f32_32x32x16_bf16 a[16:31], a[224:227], v[232:235], 0
  ds_read_b64_tr_b16 a[242:243], v24 offset:22528
  v_exp_f32 v159, v159
  v_add_f32 v28, v28, v134
  v_add_f32 v28, v28, v135
  v_add_f32 v29, v29, v144
  s_waitcnt vmcnt(8)
  v_mfma_f32_32x32x16_bf16 a[32:47], a[228:231], v[224:227], 0
  ds_read_b64_tr_b16 a[244:245], v25 offset:20480
  v_cvt_pk_bf16_f32 v239, v158, v159
  v_add_f32 v29, v29, v145
  v_add_f32 v29, v29, v146
  v_add_f32 v29, v29, v147
  v_max3_f32 v30, v160, v161, v162
  v_mfma_f32_32x32x16_bf16 a[48:63], a[228:231], v[232:235], 0
  ds_read_b64_tr_b16 a[246:247], v25 offset:22528
  v_add_f32 v29, v29, v148
  v_add_f32 v29, v29, v149
  v_add_f32 v29, v29, v150
  v_max3_f32 v31, v176, v177, v178
  v_add_f32 v29, v29, v151
  s_waitcnt lgkmcnt(4)
  v_mfma_f32_32x32x16_bf16 a[64:79], a[232:235], v[224:227], 0
  ds_read_b64_tr_b16 a[248:249], v26 offset:20480
  v_max3_f32 v30, v30, v163, v164
  v_add_f32 v28, v28, v136
  v_max3_f32 v31, v31, v179, v180
  v_add_f32 v28, v28, v137
  v_mfma_f32_32x32x16_bf16 a[80:95], a[232:235], v[232:235], 0
  ds_read_b64_tr_b16 a[250:251], v26 offset:22528
  v_max3_f32 v30, v30, v165, v166
  v_add_f32 v28, v28, v138
  v_max3_f32 v31, v31, v181, v182
  v_add_f32 v28, v28, v139
  v_max3_f32 v30, v30, v167, v168
  v_mfma_f32_32x32x16_bf16 a[96:111], a[236:239], v[224:227], 0
  ds_read_b64_tr_b16 a[252:253], v27 offset:20480
  v_add_f32 v28, v28, v140
  v_max3_f32 v31, v31, v183, v184
  v_add_f32 v28, v28, v141
  v_max3_f32 v30, v30, v169, v170
  v_add_f32 v28, v28, v142
  v_mfma_f32_32x32x16_bf16 a[112:127], a[236:239], v[232:235], 0
  ds_read_b64_tr_b16 a[254:255], v27 offset:22528
  v_max3_f32 v31, v31, v185, v186
  v_add_f32 v28, v28, v143
  v_max3_f32 v30, v30, v171, v172
  v_add_f32 v29, v29, v152
  v_max3_f32 v31, v31, v187, v188
  s_waitcnt lgkmcnt(4)
  v_mfma_f32_32x32x16_bf16 a[0:15], a[240:243], v[228:231], a[0:15]
  s_waitcnt vmcnt(4)
  s_barrier
  ds_read_b128 a[192:195], v16 offset:32768
  v_add_f32 v29, v29, v153
  v_max3_f32 v30, v30, v173, v174
  s_add_u32 m0, s19, 65536
  v_mfma_f32_32x32x16_bf16 a[16:31], a[240:243], v[236:239], a[16:31]
  v_add_f32 v29, v29, v154
  v_max3_f32 v31, v31, v189, v190
  v_add_f32 v29, v29, v155
  buffer_load_dwordx4 v12, s[28:31], s43 offen offset:0 lds
  v_mfma_f32_32x32x16_bf16 a[32:47], a[244:247], v[228:231], a[32:47]
  ds_read_b128 a[196:199], v17 offset:32768
  v_max_f32 v30, v30, v175
  v_add_f32 v29, v29, v156
  buffer_load_dwordx4 v13, s[28:31], s43 offen offset:1024 lds
  v_mfma_f32_32x32x16_bf16 a[48:63], a[244:247], v[236:239], a[48:63]
  v_max_f32 v31, v31, v191
  v_add_f32 v29, v29, v157
  v_add_f32 v29, v29, v158
  buffer_load_dwordx4 v14, s[28:31], s43 offen offset:2048 lds
  s_waitcnt lgkmcnt(2)
  v_mfma_f32_32x32x16_bf16 a[64:79], a[248:251], v[228:231], a[64:79]
  ds_read_b128 a[200:203], v18 offset:32768
  v_add_f32 v29, v29, v159
  buffer_load_dwordx4 v15, s[28:31], s43 offen offset:3072 lds
  s_add_u32 s43, s43, 8192
  v_mfma_f32_32x32x16_bf16 a[80:95], a[248:251], v[236:239], a[80:95]
  v_mfma_f32_32x32x16_bf16 a[96:111], a[252:255], v[228:231], a[96:111]
  ds_read_b128 a[204:207], v19 offset:32768
  v_mfma_f32_32x32x16_bf16 a[112:127], a[252:255], v[236:239], a[112:127]
  v_max_f32 v32, v30, v31
  v_cmp_lt_f32 vcc, s50, v32
  s_cbranch_vccz L_mk5_norescale_5
  s_call_b64 s[48:49], L_q_rescale1
L_mk5_norescale_5:
  s_waitcnt lgkmcnt(2)
  v_mfma_f32_32x32x16_bf16 v[128:143], a[192:195], a[128:131], v[192:207]
  ds_read_b128 a[208:211], v20 offset:32768
  v_exp_f32 v160, v160
  v_exp_f32 v161, v161
  v_mfma_f32_32x32x16_bf16 v[144:159], a[192:195], a[160:163], v[208:223]
  v_exp_f32 v162, v162
  v_cvt_pk_bf16_f32 v224, v160, v161
  v_exp_f32 v163, v163
  v_mfma_f32_32x32x16_bf16 v[128:143], a[196:199], a[132:135], v[128:143]
  ds_read_b128 a[212:215], v21 offset:32768
  v_exp_f32 v164, v164
  v_cvt_pk_bf16_f32 v225, v162, v163
  v_exp_f32 v165, v165
  v_mfma_f32_32x32x16_bf16 v[144:159], a[196:199], a[164:167], v[144:159]
  v_exp_f32 v166, v166
  v_cvt_pk_bf16_f32 v226, v164, v165
  v_exp_f32 v167, v167
  v_add_f32 v28, v28, v160
  s_waitcnt lgkmcnt(2)
  v_mfma_f32_32x32x16_bf16 v[128:143], a[200:203], a[136:139], v[128:143]
  ds_read_b128 a[216:219], v22 offset:32768
  v_exp_f32 v176, v176
  v_cvt_pk_bf16_f32 v227, v166, v167
  v_add_f32 v28, v28, v161
  v_mfma_f32_32x32x16_bf16 v[144:159], a[200:203], a[168:171], v[144:159]
  v_exp_f32 v177, v177
  v_exp_f32 v178, v178
  v_cvt_pk_bf16_f32 v232, v176, v177
  v_add_f32 v28, v28, v162
  v_mfma_f32_32x32x16_bf16 v[128:143], a[204:207], a[140:143], v[128:143]
  ds_read_b128 a[220:223], v23 offset:32768
  v_exp_f32 v179, v179
  v_exp_f32 v180, v180
  v_cvt_pk_bf16_f32 v233, v178, v179
  v_mfma_f32_32x32x16_bf16 v[144:159], a[204:207], a[172:175], v[144:159]
  v_exp_f32 v181, v181
  v_exp_f32 v182, v182
  v_cvt_pk_bf16_f32 v234, v180, v181
  v_add_f32 v28, v28, v163
  s_waitcnt lgkmcnt(2)
  v_mfma_f32_32x32x16_bf16 v[128:143], a[208:211], a[144:147], v[128:143]
  ds_read_b64_tr_b16 a[224:225], v24 offset:32768
  v_exp_f32 v183, v183
  v_exp_f32 v168, v168
  v_mfma_f32_32x32x16_bf16 v[144:159], a[208:211], a[176:179], v[144:159]
  ds_read_b64_tr_b16 a[226:227], v24 offset:34816
  v_cvt_pk_bf16_f32 v235, v182, v183
  v_exp_f32 v169, v169
  v_exp_f32 v170, v170
  v_mfma_f32_32x32x16_bf16 v[128:143], a[212:215], a[148:151], v[128:143]
  ds_read_b64_tr_b16 a[228:229], v25 offset:32768
  v_cvt_pk_bf16_f32 v228, v168, v169
  v_exp_f32 v171, v171
  v_exp_f32 v172, v172
  v_mfma_f32_32x32x16_bf16 v[144:159], a[212:215], a[180:183], v[144:159]
  ds_read_b64_tr_b16 a[230:231], v25 offset:34816
  v_cvt_pk_bf16_f32 v229, v170, v171
  v_exp_f32 v173, v173
  v_exp_f32 v174, v174
  s_waitcnt lgkmcnt(4)
  v_mfma_f32_32x32x16_bf16 v[128:143], a[216:219], a[152:155], v[128:143]
  ds_read_b64_tr_b16 a[232:233], v26 offset:32768
  v_cvt_pk_bf16_f32 v230, v172, v173
  v_exp_f32 v175, v175
  v_add_f32 v28, v28, v164
  v_mfma_f32_32x32x16_bf16 v[144:159], a[216:219], a[184:187], v[144:159]
  ds_read_b64_tr_b16 a[234:235], v26 offset:34816
  v_exp_f32 v184, v184
  v_cvt_pk_bf16_f32 v231, v174, v175
  v_exp_f32 v185, v185
  v_mfma_f32_32x32x16_bf16 v[128:143], a[220:223], a[156:159], v[128:143]
  ds_read_b64_tr_b16 a[236:237], v27 offset:32768
  v_exp_f32 v186, v186
  v_cvt_pk_bf16_f32 v236, v184, v185
  v_exp_f32 v187, v187
  v_mfma_f32_32x32x16_bf16 v[144:159], a[220:223], a[188:191], v[144:159]
  ds_read_b64_tr_b16 a[238:239], v27 offset:34816
  v_exp_f32 v188, v188
  v_cvt_pk_bf16_f32 v237, v186, v187
  v_exp_f32 v189, v189
  s_nop 0
  s_waitcnt lgkmcnt(4)
  v_mfma_f32_32x32x16_bf16 a[0:15], a[224:227], v[224:227], a[0:15]
  ds_read_b64_tr_b16 a[240:241], v24 offset:36864
  v_exp_f32 v190, v190
  v_cvt_pk_bf16_f32 v238, v188, v189
  v_add_f32 v28, v28, v165
  v_mfma_f32_32x32x16_bf16 a[16:31], a[224:227], v[232:235], a[16:31]
  ds_read_b64_tr_b16 a[242:243], v24 offset:38912
  v_exp_f32 v191, v191
  v_add_f32 v28, v28, v166
  v_add_f32 v28, v28, v167
  v_add_f32 v29, v29, v176
  v_mfma_f32_32x32x16_bf16 a[32:47], a[228:231], v[224:227], a[32:47]
  ds_read_b64_tr_b16 a[244:245], v25 offset:36864
  v_cvt_pk_bf16_f32 v239, v190, v191
  v_add_f32 v29, v29, v177
  v_add_f32 v29, v29, v178
  v_add_f32 v29, v29, v179
  v_max3_f32 v30, v128, v129, v130
  v_mfma_f32_32x32x16_bf16 a[48:63], a[228:231], v[232:235], a[48:63]
  ds_read_b64_tr_b16 a[246:247], v25 offset:38912
  v_add_f32 v29, v29, v180
  v_add_f32 v29, v29, v181
  v_add_f32 v29, v29, v182
  v_max3_f32 v31, v144, v145, v146
  v_add_f32 v29, v29, v183
  s_waitcnt lgkmcnt(4)
  v_mfma_f32_32x32x16_bf16 a[64:79], a[232:235], v[224:227], a[64:79]
  ds_read_b64_tr_b16 a[248:249], v26 offset:36864
  v_max3_f32 v30, v30, v131, v132
  v_add_f32 v28, v28, v168
  v_max3_f32 v31, v31, v147, v148
  v_add_f32 v28, v28, v169
  v_mfma_f32_32x32x16_bf16 a[80:95], a[232:235], v[232:235], a[80:95]
  ds_read_b64_tr_b16 a[250:251], v26 offset:38912
  v_max3_f32 v30, v30, v133, v134
  v_add_f32 v28, v28, v170
  v_max3_f32 v31, v31, v149, v150
  v_add_f32 v28, v28, v171
  v_max3_f32 v30, v30, v135, v136
  v_mfma_f32_32x32x16_bf16 a[96:111], a[236:239], v[224:227], a[96:111]
  ds_read_b64_tr_b16 a[252:253], v27 offset:36864
  v_add_f32 v28, v28, v172
  v_max3_f32 v31, v31, v151, v152
  v_add_f32 v28, v28, v173
  v_max3_f32 v30, v30, v137, v138
  v_add_f32 v28, v28, v174
  v_mfma_f32_32x32x16_bf16 a[112:127], a[236:239], v[232:235], a[112:127]
  ds_read_b64_tr_b16 a[254:255], v27 offset:38912
  v_max3_f32 v31, v31, v153, v154
  v_add_f32 v28, v28, v175
  v_max3_f32 v30, v30, v139, v140
  v_add_f32 v29, v29, v184
  v_max3_f32 v31, v31, v155, v156
  s_waitcnt lgkmcnt(4)
  v_mfma_f32_32x32x16_bf16 a[0:15], a[240:243], v[228:231], a[0:15]
  s_waitcnt vmcnt(4)
  s_barrier
  ds_read_b128 a[192:195], v16 offset:49152
  v_add_f32 v29, v29, v185
  v_max3_f32 v30, v30, v141, v142
  s_add_u32 m0, s19, 81920
  v_mfma_f32_32x32x16_bf16 a[16:31], a[240:243], v[236:239], a[16:31]
  v_add_f32 v29, v29, v186
  v_max3_f32 v31, v31, v157, v158
  v_add_f32 v29, v29, v187
  buffer_load_dwordx4 v12, s[28:31], s43 offen offset:0 lds
  v_mfma_f32_32x32x16_bf16 a[32:47], a[244:247], v[228:231], a[32:47]
  ds_read_b128 a[196:199], v17 offset:49152
  v_max_f32 v30, v30, v143
  v_add_f32 v29, v29, v188
  buffer_load_dwordx4 v13, s[28:31], s43 offen offset:1024 lds
  v_mfma_f32_32x32x16_bf16 a[48:63], a[244:247], v[236:239], a[48:63]
  v_max_f32 v31, v31, v159
  v_add_f32 v29, v29, v189
  v_add_f32 v29, v29, v190
  buffer_load_dwordx4 v14, s[28:31], s43 offen offset:2048 lds
  s_waitcnt lgkmcnt(2)
  v_mfma_f32_32x32x16_bf16 a[64:79], a[248:251], v[228:231], a[64:79]
  ds_read_b128 a[200:203], v18 offset:49152
  v_add_f32 v29, v29, v191
  buffer_load_dwordx4 v15, s[28:31], s43 offen offset:3072 lds
  s_add_u32 s43, s43, 8192
  v_mfma_f32_32x32x16_bf16 a[80:95], a[248:251], v[236:239], a[80:95]
  v_mfma_f32_32x32x16_bf16 a[96:111], a[252:255], v[228:231], a[96:111]
  ds_read_b128 a[204:207], v19 offset:49152
  v_mfma_f32_32x32x16_bf16 a[112:127], a[252:255], v[236:239], a[112:127]
  v_max_f32 v32, v30, v31
  v_cmp_lt_f32 vcc, s50, v32
  s_cbranch_vccz L_mk5_norescale_6
  s_call_b64 s[48:49], L_q_rescale0
L_mk5_norescale_6:
  s_waitcnt lgkmcnt(2)
  v_mfma_f32_32x32x16_bf16 v[160:175], a[192:195], a[128:131], v[192:207]
  ds_read_b128 a[208:211], v20 offset:49152
  v_exp_f32 v128, v128
  v_exp_f32 v129, v129
  v_mfma_f32_32x32x16_bf16 v[176:191], a[192:195], a[160:163], v[208:223]
  v_exp_f32 v130, v130
  v_cvt_pk_bf16_f32 v224, v128, v129
  v_exp_f32 v131, v131
  v_mfma_f32_32x32x16_bf16 v[160:175], a[196:199], a[132:135], v[160:175]
  ds_read_b128 a[212:215], v21 offset:49152
  v_exp_f32 v132, v132
  v_cvt_pk_bf16_f32 v225, v130, v131
  v_exp_f32 v133, v133
  v_mfma_f32_32x32x16_bf16 v[176:191], a[196:199], a[164:167], v[176:191]
  v_exp_f32 v134, v134
  v_cvt_pk_bf16_f32 v226, v132, v133
  v_exp_f32 v135, v135
  v_add_f32 v28, v28, v128
  s_waitcnt lgkmcnt(2)
  v_mfma_f32_32x32x16_bf16 v[160:175], a[200:203], a[136:139], v[160:175]
  ds_read_b128 a[216:219], v22 offset:49152
  v_exp_f32 v144, v144
  v_cvt_pk_bf16_f32 v227, v134, v135
  v_add_f32 v28, v28, v129
  v_mfma_f32_32x32x16_bf16 v[176:191], a[200:203], a[168:171], v[176:191]
  v_exp_f32 v145, v145
  v_exp_f32 v146, v146
  v_cvt_pk_bf16_f32 v232, v144, v145
  v_add_f32 v28, v28, v130
  v_mfma_f32_32x32x16_bf16 v[160:175], a[204:207], a[140:143], v[160:175]
  ds_read_b128 a[220:223], v23 offset:49152
  v_exp_f32 v147, v147
  v_exp_f32 v148, v148
  v_cvt_pk_bf16_f32 v233, v146, v147
  v_mfma_f32_32x32x16_bf16 v[176:191], a[204:207], a[172:175], v[176:191]
  v_exp_f32 v149, v149
  v_exp_f32 v150, v150
  v_cvt_pk_bf16_f32 v234, v148, v149
  v_add_f32 v28, v28, v131
  s_waitcnt lgkmcnt(2)
  v_mfma_f32_32x32x16_bf16 v[160:175], a[208:211], a[144:147], v[160:175]
  ds_read_b64_tr_b16 a[224:225], v24 offset:49152
  v_exp_f32 v151, v151
  v_exp_f32 v136, v136
  v_mfma_f32_32x32x16_bf16 v[176:191], a[208:211], a[176:179], v[176:191]
  ds_read_b64_tr_b16 a[226:227], v24 offset:51200
  v_cvt_pk_bf16_f32 v235, v150, v151
  v_exp_f32 v137, v137
  v_exp_f32 v138, v138
  v_mfma_f32_32x32x16_bf16 v[160:175], a[212:215], a[148:151], v[160:175]
  ds_read_b64_tr_b16 a[228:229], v25 offset:49152
  v_cvt_pk_bf16_f32 v228, v136, v137
  v_exp_f32 v139, v139
  v_exp_f32 v140, v140
  v_mfma_f32_32x32x16_bf16 v[176:191], a[212:215], a[180:183], v[176:191]
  ds_read_b64_tr_b16 a[230:231], v25 offset:51200
  v_cvt_pk_bf16_f32 v229, v138, v139
  v_exp_f32 v141, v141
  v_exp_f32 v142, v142
  s_waitcnt lgkmcnt(4)
  v_mfma_f32_32x32x16_bf16 v[160:175], a[216:219], a[152:155], v[160:175]
  ds_read_b64_tr_b16 a[232:233], v26 offset:49152
  v_cvt_pk_bf16_f32 v230, v140, v141
  v_exp_f32 v143, v143
  v_add_f32 v28, v28, v132
  v_mfma_f32_32x32x16_bf16 v[176:191], a[216:219], a[184:187], v[176:191]
  ds_read_b64_tr_b16 a[234:235], v26 offset:51200
  v_exp_f32 v152, v152
  v_cvt_pk_bf16_f32 v231, v142, v143
  v_exp_f32 v153, v153
  v_mfma_f32_32x32x16_bf16 v[160:175], a[220:223], a[156:159], v[160:175]
  ds_read_b64_tr_b16 a[236:237], v27 offset:49152
  v_exp_f32 v154, v154
  v_cvt_pk_bf16_f32 v236, v152, v153
  v_exp_f32 v155, v155
  v_mfma_f32_32x32x16_bf16 v[176:191], a[220:223], a[188:191], v[176:191]
  ds_read_b64_tr_b16 a[238:239], v27 offset:51200
  v_exp_f32 v156, v156
  v_cvt_pk_bf16_f32 v237, v154, v155
  v_exp_f32 v157, v157
  s_nop 0
  s_waitcnt lgkmcnt(4)
  v_mfma_f32_32x32x16_bf16 a[0:15], a[224:227], v[224:227], a[0:15]
  ds_read_b64_tr_b16 a[240:241], v24 offset:53248
  v_exp_f32 v158, v158
  v_cvt_pk_bf16_f32 v238, v156, v157
  v_add_f32 v28, v28, v133
  v_mfma_f32_32x32x16_bf16 a[16:31], a[224:227], v[232:235], a[16:31]
  ds_read_b64_tr_b16 a[242:243], v24 offset:55296
  v_exp_f32 v159, v159
  v_add_f32 v28, v28, v134
  v_add_f32 v28, v28, v135
  v_add_f32 v29, v29, v144
  v_mfma_f32_32x32x16_bf16 a[32:47], a[228:231], v[224:227], a[32:47]
  ds_read_b64_tr_b16 a[244:245], v25 offset:53248
  v_cvt_pk_bf16_f32 v239, v158, v159
  v_add_f32 v29, v29, v145
  v_add_f32 v29, v29, v146
  v_add_f32 v29, v29, v147
  v_max3_f32 v30, v160, v161, v162
  v_mfma_f32_32x32x16_bf16 a[48:63], a[228:231], v[232:235], a[48:63]
  ds_read_b64_tr_b16 a[246:247], v25 offset:55296
  v_add_f32 v29, v29, v148
  v_add_f32 v29, v29, v149
  v_add_f32 v29, v29, v150
  v_max3_f32 v31, v176, v177, v178
  v_add_f32 v29, v29, v151
  s_waitcnt lgkmcnt(4)
  v_mfma_f32_32x32x16_bf16 a[64:79], a[232:235], v[224:227], a[64:79]
  ds_read_b64_tr_b16 a[248:249], v26 offset:53248
  v_max3_f32 v30, v30, v163, v164
  v_add_f32 v28, v28, v136
  v_max3_f32 v31, v31, v179, v180
  v_add_f32 v28, v28, v137
  v_mfma_f32_32x32x16_bf16 a[80:95], a[232:235], v[232:235], a[80:95]
  ds_read_b64_tr_b16 a[250:251], v26 offset:55296
  v_max3_f32 v30, v30, v165, v166
  v_add_f32 v28, v28, v138
  v_max3_f32 v31, v31, v181, v182
  v_add_f32 v28, v28, v139
  v_max3_f32 v30, v30, v167, v168
  v_mfma_f32_32x32x16_bf16 a[96:111], a[236:239], v[224:227], a[96:111]
  ds_read_b64_tr_b16 a[252:253], v27 offset:53248
  v_add_f32 v28, v28, v140
  v_max3_f32 v31, v31, v183, v184
  v_add_f32 v28, v28, v141
  v_max3_f32 v30, v30, v169, v170
  v_add_f32 v28, v28, v142
  v_mfma_f32_32x32x16_bf16 a[112:127], a[236:239], v[232:235], a[112:127]
  ds_read_b64_tr_b16 a[254:255], v27 offset:55296
  v_max3_f32 v31, v31, v185, v186
  v_add_f32 v28, v28, v143
  v_max3_f32 v30, v30, v171, v172
  v_add_f32 v29, v29, v152
  v_max3_f32 v31, v31, v187, v188
  s_waitcnt lgkmcnt(4)
  v_mfma_f32_32x32x16_bf16 a[0:15], a[240:243], v[228:231], a[0:15]
  s_waitcnt vmcnt(4)
  s_barrier
  ds_read_b128 a[192:195], v16 offset:0
  v_add_f32 v29, v29, v153
  v_max3_f32 v30, v30, v173, v174
  s_add_u32 m0, s19, 98304
  v_mfma_f32_32x32x16_bf16 a[16:31], a[240:243], v[236:239], a[16:31]
  v_add_f32 v29, v29, v154
  v_max3_f32 v31, v31, v189, v190
  v_add_f32 v29, v29, v155
  buffer_load_dwordx4 v12, s[28:31], s43 offen offset:0 lds
  v_mfma_f32_32x32x16_bf16 a[32:47], a[244:247], v[228:231], a[32:47]
  ds_read_b128 a[196:199], v17 offset:0
  v_max_f32 v30, v30, v175
  v_add_f32 v29, v29, v156
  buffer_load_dwordx4 v13, s[28:31], s43 offen offset:1024 lds
  v_mfma_f32_32x32x16_bf16 a[48:63], a[244:247], v[236:239], a[48:63]
  v_max_f32 v31, v31, v191
  v_add_f32 v29, v29, v157
  v_add_f32 v29, v29, v158
  buffer_load_dwordx4 v14, s[28:31], s43 offen offset:2048 lds
  s_waitcnt lgkmcnt(2)
  v_mfma_f32_32x32x16_bf16 a[64:79], a[248:251], v[228:231], a[64:79]
  ds_read_b128 a[200:203], v18 offset:0
  v_add_f32 v29, v29, v159
  buffer_load_dwordx4 v15, s[28:31], s43 offen offset:3072 lds
  s_add_u32 s43, s43, 8192
  v_mfma_f32_32x32x16_bf16 a[80:95], a[248:251], v[236:239], a[80:95]
  v_mfma_f32_32x32x16_bf16 a[96:111], a[252:255], v[228:231], a[96:111]
  ds_read_b128 a[204:207], v19 offset:0
  v_mfma_f32_32x32x16_bf16 a[112:127], a[252:255], v[236:239], a[112:127]
  v_max_f32 v32, v30, v31
  v_cmp_lt_f32 vcc, s50, v32
  s_cbranch_vccz L_mk5_norescale_7
  s_call_b64 s[48:49], L_q_rescale1
L_mk5_norescale_7:
  s_waitcnt lgkmcnt(2)
  v_mfma_f32_32x32x16_bf16 v[128:143], a[192:195], a[128:131], v[192:207]
  ds_read_b128 a[208:211], v20 offset:0
  v_exp_f32 v160, v160
  v_exp_f32 v161, v161
  v_mfma_f32_32x32x16_bf16 v[144:159], a[192:195], a[160:163], v[208:223]
  v_exp_f32 v162, v162
  v_cvt_pk_bf16_f32 v224, v160, v161
  v_exp_f32 v163, v163
  v_mfma_f32_32x32x16_bf16 v[128:143], a[196:199], a[132:135], v[128:143]
  ds_read_b128 a[212:215], v21 offset:0
  v_exp_f32 v164, v164
  v_cvt_pk_bf16_f32 v225, v162, v163
  v_exp_f32 v165, v165
  v_mfma_f32_32x32x16_bf16 v[144:159], a[196:199], a[164:167], v[144:159]
  v_exp_f32 v166, v166
  v_cvt_pk_bf16_f32 v226, v164, v165
  v_exp_f32 v167, v167
  v_add_f32 v28, v28, v160
  s_waitcnt lgkmcnt(2)
  v_mfma_f32_32x32x16_bf16 v[128:143], a[200:203], a[136:139], v[128:143]
  ds_read_b128 a[216:219], v22 offset:0
  v_exp_f32 v176, v176
  v_cvt_pk_bf16_f32 v227, v166, v167
  v_add_f32 v28, v28, v161
  v_mfma_f32_32x32x16_bf16 v[144:159], a[200:203], a[168:171], v[144:159]
  v_exp_f32 v177, v177
  v_exp_f32 v178, v178
  v_cvt_pk_bf16_f32 v232, v176, v177
  v_add_f32 v28, v28, v162
  v_mfma_f32_32x32x16_bf16 v[128:143], a[204:207], a[140:143], v[128:143]
  ds_read_b128 a[220:223], v23 offset:0
  v_exp_f32 v179, v179
  v_exp_f32 v180, v180
  v_cvt_pk_bf16_f32 v233, v178, v179
  v_mfma_f32_32x32x16_bf16 v[144:159], a[204:207], a[172:175], v[144:159]
  v_exp_f32 v181, v181
  v_exp_f32 v182, v182
  v_cvt_pk_bf16_f32 v234, v180, v181
  v_add_f32 v28, v28, v163
  s_waitcnt lgkmcnt(2)
  v_mfma_f32_32x32x16_bf16 v[128:143], a[208:211], a[144:147], v[128:143]
  ds_read_b64_tr_b16 a[224:225], v24 offset:0
  v_exp_f32 v183, v183
  v_exp_f32 v168, v168
  v_mfma_f32_32x32x16_bf16 v[144:159], a[208:211], a[176:179], v[144:159]
  ds_read_b64_tr_b16 a[226:227], v24 offset:2048
  v_cvt_pk_bf16_f32 v235, v182, v183
  v_exp_f32 v169, v169
  v_exp_f32 v170, v170
  v_mfma_f32_32x32x16_bf16 v[128:143], a[212:215], a[148:151], v[128:143]
  ds_read_b64_tr_b16 a[228:229], v25 offset:0
  v_cvt_pk_bf16_f32 v228, v168, v169
  v_exp_f32 v171, v171
  v_exp_f32 v172, v172
  v_mfma_f32_32x32x16_bf16 v[144:159], a[212:215], a[180:183], v[144:159]
  ds_read_b64_tr_b16 a[230:231], v25 offset:2048
  v_cvt_pk_bf16_f32 v229, v170, v171
  v_exp_f32 v173, v173
  v_exp_f32 v174, v174
  s_waitcnt lgkmcnt(4)
  v_mfma_f32_32x32x16_bf16 v[128:143], a[216:219], a[152:155], v[128:143]
  ds_read_b64_tr_b16 a[232:233], v26 offset:0
  v_cvt_pk_bf16_f32 v230, v172, v173
  v_exp_f32 v175, v175
  v_add_f32 v28, v28, v164
  v_mfma_f32_32x32x16_bf16 v[144:159], a[216:219], a[184:187], v[144:159]
  ds_read_b64_tr_b16 a[234:235], v26 offset:2048
  v_exp_f32 v184, v184
  v_cvt_pk_bf16_f32 v231, v174, v175
  v_exp_f32 v185, v185
  v_mfma_f32_32x32x16_bf16 v[128:143], a[220:223], a[156:159], v[128:143]
  ds_read_b64_tr_b16 a[236:237], v27 offset:0
  v_exp_f32 v186, v186
  v_cvt_pk_bf16_f32 v236, v184, v185
  v_exp_f32 v187, v187
  v_mfma_f32_32x32x16_bf16 v[144:159], a[220:223], a[188:191], v[144:159]
  ds_read_b64_tr_b16 a[238:239], v27 offset:2048
  v_exp_f32 v188, v188
  v_cvt_pk_bf16_f32 v237, v186, v187
  v_exp_f32 v189, v189
  s_nop 0
  s_waitcnt lgkmcnt(4)
  v_mfma_f32_32x32x16_bf16 a[0:15], a[224:227], v[224:227], a[0:15]
  ds_read_b64_tr_b16 a[240:241], v24 offset:4096
  v_exp_f32 v190, v190
  v_cvt_pk_bf16_f32 v238, v188, v189
  v_add_f32 v28, v28, v165
  v_mfma_f32_32x32x16_bf16 a[16:31], a[224:227], v[232:235], a[16:31]
  ds_read_b64_tr_b16 a[242:243], v24 offset:6144
  v_exp_f32 v191, v191
  v_add_f32 v28, v28, v166
  v_add_f32 v28, v28, v167
  v_add_f32 v29, v29, v176
  v_mfma_f32_32x32x16_bf16 a[32:47], a[228:231], v[224:227], a[32:47]
  ds_read_b64_tr_b16 a[244:245], v25 offset:4096
  v_cvt_pk_bf16_f32 v239, v190, v191
  v_add_f32 v29, v29, v177
  v_add_f32 v29, v29, v178
  v_add_f32 v29, v29, v179
  v_max3_f32 v30, v128, v129, v130
  v_mfma_f32_32x32x16_bf16 a[48:63], a[228:231], v[232:235], a[48:63]
  ds_read_b64_tr_b16 a[246:247], v25 offset:6144
  v_add_f32 v29, v29, v180
  v_add_f32 v29, v29, v181
  v_add_f32 v29, v29, v182
  v_max3_f32 v31, v144, v145, v146
  v_add_f32 v29, v29, v183
  s_waitcnt lgkmcnt(4)
  v_mfma_f32_32x32x16_bf16 a[64:79], a[232:235], v[224:227], a[64:79]
  ds_read_b64_tr_b16 a[248:249], v26 offset:4096
  v_max3_f32 v30, v30, v131, v132
  v_add_f32 v28, v28, v168
  v_max3_f32 v31, v31, v147, v148
  v_add_f32 v28, v28, v169
  v_mfma_f32_32x32x16_bf16 a[80:95], a[232:235], v[232:235], a[80:95]
  ds_read_b64_tr_b16 a[250:251], v26 offset:6144
  v_max3_f32 v30, v30, v133, v134
  v_add_f32 v28, v28, v170
  v_max3_f32 v31, v31, v149, v150
  v_add_f32 v28, v28, v171
  v_max3_f32 v30, v30, v135, v136
  v_mfma_f32_32x32x16_bf16 a[96:111], a[236:239], v[224:227], a[96:111]
  ds_read_b64_tr_b16 a[252:253], v27 offset:4096
  v_add_f32 v28, v28, v172
  v_max3_f32 v31, v31, v151, v152
  v_add_f32 v28, v28, v173
  v_max3_f32 v30, v30, v137, v138
  v_add_f32 v28, v28, v174
  v_mfma_f32_32x32x16_bf16 a[112:127], a[236:239], v[232:235], a[112:127]
  ds_read_b64_tr_b16 a[254:255], v27 offset:6144
  v_max3_f32 v31, v31, v153, v154
  v_add_f32 v28, v28, v175
  v_max3_f32 v30, v30, v139, v140
  v_add_f32 v29, v29, v184
  v_max3_f32 v31, v31, v155, v156
  s_waitcnt lgkmcnt(4)
  v_mfma_f32_32x32x16_bf16 a[0:15], a[240:243], v[228:231], a[0:15]
  s_waitcnt vmcnt(4)
  s_barrier
  ds_read_b128 a[192:195], v16 offset:16384
  v_add_f32 v29, v29, v185
  v_max3_f32 v30, v30, v141, v142
  s_add_u32 m0, s19, 114688
  v_mfma_f32_32x32x16_bf16 a[16:31], a[240:243], v[236:239], a[16:31]
  v_add_f32 v29, v29, v186
  v_max3_f32 v31, v31, v157, v158
  v_add_f32 v29, v29, v187
  buffer_load_dwordx4 v12, s[28:31], s43 offen offset:0 lds
  v_mfma_f32_32x32x16_bf16 a[32:47], a[244:247], v[228:231], a[32:47]
  ds_read_b128 a[196:199], v17 offset:16384
  v_max_f32 v30, v30, v143
  v_add_f32 v29, v29, v188
  buffer_load_dwordx4 v13, s[28:31], s43 offen offset:1024 lds
  v_mfma_f32_32x32x16_bf16 a[48:63], a[244:247], v[236:239], a[48:63]
  v_max_f32 v31, v31, v159
  v_add_f32 v29, v29, v189
  v_add_f32 v29, v29, v190
  buffer_load_dwordx4 v14, s[28:31], s43 offen offset:2048 lds
  s_waitcnt lgkmcnt(2)
  v_mfma_f32_32x32x16_bf16 a[64:79], a[248:251], v[228:231], a[64:79]
  ds_read_b128 a[200:203], v18 offset:16384
  v_add_f32 v29, v29, v191
  buffer_load_dwordx4 v15, s[28:31], s43 offen offset:3072 lds
  s_add_u32 s43, s43, 8192
  v_mfma_f32_32x32x16_bf16 a[80:95], a[248:251], v[236:239], a[80:95]
  v_mfma_f32_32x32x16_bf16 a[96:111], a[252:255], v[228:231], a[96:111]
  ds_read_b128 a[204:207], v19 offset:16384
  v_mfma_f32_32x32x16_bf16 a[112:127], a[252:255], v[236:239], a[112:127]
  v_max_f32 v32, v30, v31
  v_cmp_lt_f32 vcc, s50, v32
  s_cbranch_vccz L_mk5_norescale_8
  s_call_b64 s[48:49], L_q_rescale0
L_mk5_norescale_8:
  s_waitcnt lgkmcnt(2)
  v_mfma_f32_32x32x16_bf16 v[160:175], a[192:195], a[128:131], v[192:207]
  ds_read_b128 a[208:211], v20 offset:16384
  v_exp_f32 v128, v128
  v_exp_f32 v129, v129
  v_mfma_f32_32x32x16_bf16 v[176:191], a[192:195], a[160:163], v[208:223]
  v_exp_f32 v130, v130
  v_cvt_pk_bf16_f32 v224, v128, v129
  v_exp_f32 v131, v131
  v_mfma_f32_32x32x16_bf16 v[160:175], a[196:199], a[132:135], v[160:175]
  ds_read_b128 a[212:215], v21 offset:16384
  v_exp_f32 v132, v132
  v_cvt_pk_bf16_f32 v225, v130, v131
  v_exp_f32 v133, v133
  v_mfma_f32_32x32x16_bf16 v[176:191], a[196:199], a[164:167], v[176:191]
  v_exp_f32 v134, v134
  v_cvt_pk_bf16_f32 v226, v132, v133
  v_exp_f32 v135, v135
  v_add_f32 v28, v28, v128
  s_waitcnt lgkmcnt(2)
  v_mfma_f32_32x32x16_bf16 v[160:175], a[200:203], a[136:139], v[160:175]
  ds_read_b128 a[216:219], v22 offset:16384
  v_exp_f32 v144, v144
  v_cvt_pk_bf16_f32 v227, v134, v135
  v_add_f32 v28, v28, v129
  v_mfma_f32_32x32x16_bf16 v[176:191], a[200:203], a[168:171], v[176:191]
  v_exp_f32 v145, v145
  v_exp_f32 v146, v146
  v_cvt_pk_bf16_f32 v232, v144, v145
  v_add_f32 v28, v28, v130
  v_mfma_f32_32x32x16_bf16 v[160:175], a[204:207], a[140:143], v[160:175]
  ds_read_b128 a[220:223], v23 offset:16384
  v_exp_f32 v147, v147
  v_exp_f32 v148, v148
  v_cvt_pk_bf16_f32 v233, v146, v147
  v_mfma_f32_32x32x16_bf16 v[176:191], a[204:207], a[172:175], v[176:191]
  v_exp_f32 v149, v149
  v_exp_f32 v150, v150
  v_cvt_pk_bf16_f32 v234, v148, v149
  v_add_f32 v28, v28, v131
  s_waitcnt lgkmcnt(2)
  v_mfma_f32_32x32x16_bf16 v[160:175], a[208:211], a[144:147], v[160:175]
  ds_read_b64_tr_b16 a[224:225], v24 offset:16384
  v_exp_f32 v151, v151
  v_exp_f32 v136, v136
  v_mfma_f32_32x32x16_bf16 v[176:191], a[208:211], a[176:179], v[176:191]
  ds_read_b64_tr_b16 a[226:227], v24 offset:18432
  v_cvt_pk_bf16_f32 v235, v150, v151
  v_exp_f32 v137, v137
  v_exp_f32 v138, v138
  v_mfma_f32_32x32x16_bf16 v[160:175], a[212:215], a[148:151], v[160:175]
  ds_read_b64_tr_b16 a[228:229], v25 offset:16384
  v_cvt_pk_bf16_f32 v228, v136, v137
  v_exp_f32 v139, v139
  v_exp_f32 v140, v140
  v_mfma_f32_32x32x16_bf16 v[176:191], a[212:215], a[180:183], v[176:191]
  ds_read_b64_tr_b16 a[230:231], v25 offset:18432
  v_cvt_pk_bf16_f32 v229, v138, v139
  v_exp_f32 v141, v141
  v_exp_f32 v142, v142
  s_waitcnt lgkmcnt(4)
  v_mfma_f32_32x32x16_bf16 v[160:175], a[216:219], a[152:155], v[160:175]
  ds_read_b64_tr_b16 a[232:233], v26 offset:16384
  v_cvt_pk_bf16_f32 v230, v140, v141
  v_exp_f32 v143, v143
  v_add_f32 v28, v28, v132
  v_mfma_f32_32x32x16_bf16 v[176:191], a[216:219], a[184:187], v[176:191]
  ds_read_b64_tr_b16 a[234:235], v26 offset:18432
  v_exp_f32 v152, v152
  v_cvt_pk_bf16_f32 v231, v142, v143
  v_exp_f32 v153, v153
  v_mfma_f32_32x32x16_bf16 v[160:175], a[220:223], a[156:159], v[160:175]
  ds_read_b64_tr_b16 a[236:237], v27 offset:16384
  v_exp_f32 v154, v154
  v_cvt_pk_bf16_f32 v236, v152, v153
  v_exp_f32 v155, v155
  v_mfma_f32_32x32x16_bf16 v[176:191], a[220:223], a[188:191], v[176:191]
  ds_read_b64_tr_b16 a[238:239], v27 offset:18432
  v_exp_f32 v156, v156
  v_cvt_pk_bf16_f32 v237, v154, v155
  v_exp_f32 v157, v157
  s_nop 0
  s_waitcnt lgkmcnt(4)
  v_mfma_f32_32x32x16_bf16 a[0:15], a[224:227], v[224:227], a[0:15]
  ds_read_b64_tr_b16 a[240:241], v24 offset:20480
  v_exp_f32 v158, v158
  v_cvt_pk_bf16_f32 v238, v156, v157
  v_add_f32 v28, v28, v133
  v_mfma_f32_32x32x16_bf16 a[16:31], a[224:227], v[232:235], a[16:31]
  ds_read_b64_tr_b16 a[242:243], v24 offset:22528
  v_exp_f32 v159, v159
  v_add_f32 v28, v28, v134
  v_add_f32 v28, v28, v135
  v_add_f32 v29, v29, v144
  v_mfma_f32_32x32x16_bf16 a[32:47], a[228:231], v[224:227], a[32:47]
  ds_read_b64_tr_b16 a[244:245], v25 offset:20480
  v_cvt_pk_bf16_f32 v239, v158, v159
  v_add_f32 v29, v29, v145
  v_add_f32 v29, v29, v146
  v_add_f32 v29, v29, v147
  v_max3_f32 v30, v160, v161, v162
  v_mfma_f32_32x32x16_bf16 a[48:63], a[228:231], v[232:235], a[48:63]
  ds_read_b64_tr_b16 a[246:247], v25 offset:22528
  v_add_f32 v29, v29, v148
  v_add_f32 v29, v29, v149
  v_add_f32 v29, v29, v150
  v_max3_f32 v31, v176, v177, v178
  v_add_f32 v29, v29, v151
  s_waitcnt lgkmcnt(4)
  v_mfma_f32_32x32x16_bf16 a[64:79], a[232:235], v[224:227], a[64:79]
  ds_read_b64_tr_b16 a[248:249], v26 offset:20480
  v_max3_f32 v30, v30, v163, v164
  v_add_f32 v28, v28, v136
  v_max3_f32 v31, v31, v179, v180
  v_add_f32 v28, v28, v137
  v_mfma_f32_32x32x16_bf16 a[80:95], a[232:235], v[232:235], a[80:95]
  ds_read_b64_tr_b16 a[250:251], v26 offset:22528
  v_max3_f32 v30, v30, v165, v166
  v_add_f32 v28, v28, v138
  v_max3_f32 v31, v31, v181, v182
  v_add_f32 v28, v28, v139
  v_max3_f32 v30, v30, v167, v168
  v_mfma_f32_32x32x16_bf16 a[96:111], a[236:239], v[224:227], a[96:111]
  ds_read_b64_tr_b16 a[252:253], v27 offset:20480
  v_add_f32 v28, v28, v140
  v_max3_f32 v31, v31, v183, v184
  v_add_f32 v28, v28, v141
  v_max3_f32 v30, v30, v169, v170
  v_add_f32 v28, v28, v142
  v_mfma_f32_32x32x16_bf16 a[112:127], a[236:239], v[232:235], a[112:127]
  ds_read_b64_tr_b16 a[254:255], v27 offset:22528
  v_max3_f32 v31, v31, v185, v186
  v_add_f32 v28, v28, v143
  v_max3_f32 v30, v30, v171, v172
  v_add_f32 v29, v29, v152
  v_max3_f32 v31, v31, v187, v188
  s_waitcnt lgkmcnt(4)
  v_mfma_f32_32x32x16_bf16 a[0:15], a[240:243], v[228:231], a[0:15]
  s_waitcnt vmcnt(4)
  s_barrier
  ds_read_b128 a[192:195], v16 offset:32768
  v_add_f32 v29, v29, v153
  v_max3_f32 v30, v30, v173, v174
  s_add_u32 m0, s19, 65536
  v_mfma_f32_32x32x16_bf16 a[16:31], a[240:243], v[236:239], a[16:31]
  v_add_f32 v29, v29, v154
  v_max3_f32 v31, v31, v189, v190
  v_add_f32 v29, v29, v155
  buffer_load_dwordx4 v12, s[28:31], s43 offen offset:0 lds
  v_mfma_f32_32x32x16_bf16 a[32:47], a[244:247], v[228:231], a[32:47]
  ds_read_b128 a[196:199], v17 offset:32768
  v_max_f32 v30, v30, v175
  v_add_f32 v29, v29, v156
  buffer_load_dwordx4 v13, s[28:31], s43 offen offset:1024 lds
  v_mfma_f32_32x32x16_bf16 a[48:63], a[244:247], v[236:239], a[48:63]
  v_max_f32 v31, v31, v191
  v_add_f32 v29, v29, v157
  v_add_f32 v29, v29, v158
  buffer_load_dwordx4 v14, s[28:31], s43 offen offset:2048 lds
  s_waitcnt lgkmcnt(2)
  v_mfma_f32_32x32x16_bf16 a[64:79], a[248:251], v[228:231], a[64:79]
  ds_read_b128 a[200:203], v18 offset:32768
  v_add_f32 v29, v29, v159
  buffer_load_dwordx4 v15, s[28:31], s43 offen offset:3072 lds
  s_add_u32 s43, s43, 8192
  v_mfma_f32_32x32x16_bf16 a[80:95], a[248:251], v[236:239], a[80:95]
  v_mfma_f32_32x32x16_bf16 a[96:111], a[252:255], v[228:231], a[96:111]
  ds_read_b128 a[204:207], v19 offset:32768
  v_mfma_f32_32x32x16_bf16 a[112:127], a[252:255], v[236:239], a[112:127]
  v_max_f32 v32, v30, v31
  v_cmp_lt_f32 vcc, s50, v32
  s_cbranch_vccz L_mk5_norescale_9
  s_call_b64 s[48:49], L_q_rescale1
L_mk5_norescale_9:
  s_waitcnt lgkmcnt(2)
  v_mfma_f32_32x32x16_bf16 v[128:143], a[192:195], a[128:131], v[192:207]
  ds_read_b128 a[208:211], v20 offset:32768
  v_exp_f32 v160, v160
  v_exp_f32 v161, v161
  v_mfma_f32_32x32x16_bf16 v[144:159], a[192:195], a[160:163], v[208:223]
  v_exp_f32 v162, v162
  v_cvt_pk_bf16_f32 v224, v160, v161
  v_exp_f32 v163, v163
  v_mfma_f32_32x32x16_bf16 v[128:143], a[196:199], a[132:135], v[128:143]
  ds_read_b128 a[212:215], v21 offset:32768
  v_exp_f32 v164, v164
  v_cvt_pk_bf16_f32 v225, v162, v163
  v_exp_f32 v165, v165
  v_mfma_f32_32x32x16_bf16 v[144:159], a[196:199], a[164:167], v[144:159]
  v_exp_f32 v166, v166
  v_cvt_pk_bf16_f32 v226, v164, v165
  v_exp_f32 v167, v167
  v_add_f32 v28, v28, v160
  s_waitcnt lgkmcnt(2)
  v_mfma_f32_32x32x16_bf16 v[128:143], a[200:203], a[136:139], v[128:143]
  ds_read_b128 a[216:219], v22 offset:32768
  v_exp_f32 v176, v176
  v_cvt_pk_bf16_f32 v227, v166, v167
  v_add_f32 v28, v28, v161
  v_mfma_f32_32x32x16_bf16 v[144:159], a[200:203], a[168:171], v[144:159]
  v_exp_f32 v177, v177
  v_exp_f32 v178, v178
  v_cvt_pk_bf16_f32 v232, v176, v177
  v_add_f32 v28, v28, v162
  v_mfma_f32_32x32x16_bf16 v[128:143], a[204:207], a[140:143], v[128:143]
  ds_read_b128 a[220:223], v23 offset:32768
  v_exp_f32 v179, v179
  v_exp_f32 v180, v180
  v_cvt_pk_bf16_f32 v233, v178, v179
  v_mfma_f32_32x32x16_bf16 v[144:159], a[204:207], a[172:175], v[144:159]
  v_exp_f32 v181, v181
  v_exp_f32 v182, v182
  v_cvt_pk_bf16_f32 v234, v180, v181
  v_add_f32 v28, v28, v163
  s_waitcnt lgkmcnt(2)
  v_mfma_f32_32x32x16_bf16 v[128:143], a[208:211], a[144:147], v[128:143]
  ds_read_b64_tr_b16 a[224:225], v24 offset:32768
  v_exp_f32 v183, v183
  v_exp_f32 v168, v168
  v_mfma_f32_32x32x16_bf16 v[144:159], a[208:211], a[176:179], v[144:159]
  ds_read_b64_tr_b16 a[226:227], v24 offset:34816
  v_cvt_pk_bf16_f32 v235, v182, v183
  v_exp_f32 v169, v169
  v_exp_f32 v170, v170
  v_mfma_f32_32x32x16_bf16 v[128:143], a[212:215], a[148:151], v[128:143]
  ds_read_b64_tr_b16 a[228:229], v25 offset:32768
  v_cvt_pk_bf16_f32 v228, v168, v169
  v_exp_f32 v171, v171
  v_exp_f32 v172, v172
  v_mfma_f32_32x32x16_bf16 v[144:159], a[212:215], a[180:183], v[144:159]
  ds_read_b64_tr_b16 a[230:231], v25 offset:34816
  v_cvt_pk_bf16_f32 v229, v170, v171
  v_exp_f32 v173, v173
  v_exp_f32 v174, v174
  s_waitcnt lgkmcnt(4)
  v_mfma_f32_32x32x16_bf16 v[128:143], a[216:219], a[152:155], v[128:143]
  ds_read_b64_tr_b16 a[232:233], v26 offset:32768
  v_cvt_pk_bf16_f32 v230, v172, v173
  v_exp_f32 v175, v175
  v_add_f32 v28, v28, v164
  v_mfma_f32_32x32x16_bf16 v[144:159], a[216:219], a[184:187], v[144:159]
  ds_read_b64_tr_b16 a[234:235], v26 offset:34816
  v_exp_f32 v184, v184
  v_cvt_pk_bf16_f32 v231, v174, v175
  v_exp_f32 v185, v185
  v_mfma_f32_32x32x16_bf16 v[128:143], a[220:223], a[156:159], v[128:143]
  ds_read_b64_tr_b16 a[236:237], v27 offset:32768
  v_exp_f32 v186, v186
  v_cvt_pk_bf16_f32 v236, v184, v185
  v_exp_f32 v187, v187
  v_mfma_f32_32x32x16_bf16 v[144:159], a[220:223], a[188:191], v[144:159]
  ds_read_b64_tr_b16 a[238:239], v27 offset:34816
  v_exp_f32 v188, v188
  v_cvt_pk_bf16_f32 v237, v186, v187
  v_exp_f32 v189, v189
  s_nop 0
  s_waitcnt lgkmcnt(4)
  v_mfma_f32_32x32x16_bf16 a[0:15], a[224:227], v[224:227], a[0:15]
  ds_read_b64_tr_b16 a[240:241], v24 offset:36864
  v_exp_f32 v190, v190
  v_cvt_pk_bf16_f32 v238, v188, v189
  v_add_f32 v28, v28, v165
  v_mfma_f32_32x32x16_bf16 a[16:31], a[224:227], v[232:235], a[16:31]
  ds_read_b64_tr_b16 a[242:243], v24 offset:38912
  v_exp_f32 v191, v191
  v_add_f32 v28, v28, v166
  v_add_f32 v28, v28, v167
  v_add_f32 v29, v29, v176
  v_mfma_f32_32x32x16_bf16 a[32:47], a[228:231], v[224:227], a[32:47]
  ds_read_b64_tr_b16 a[244:245], v25 offset:36864
  v_cvt_pk_bf16_f32 v239, v190, v191
  v_add_f32 v29, v29, v177
  v_add_f32 v29, v29, v178
  v_add_f32 v29, v29, v179
  v_max3_f32 v30, v128, v129, v130
  v_mfma_f32_32x32x16_bf16 a[48:63], a[228:231], v[232:235], a[48:63]
  ds_read_b64_tr_b16 a[246:247], v25 offset:38912
  v_add_f32 v29, v29, v180
  v_add_f32 v29, v29, v181
  v_add_f32 v29, v29, v182
  v_max3_f32 v31, v144, v145, v146
  v_add_f32 v29, v29, v183
  s_waitcnt lgkmcnt(4)
  v_mfma_f32_32x32x16_bf16 a[64:79], a[232:235], v[224:227], a[64:79]
  ds_read_b64_tr_b16 a[248:249], v26 offset:36864
  v_max3_f32 v30, v30, v131, v132
  v_add_f32 v28, v28, v168
  v_max3_f32 v31, v31, v147, v148
  v_add_f32 v28, v28, v169
  v_mfma_f32_32x32x16_bf16 a[80:95], a[232:235], v[232:235], a[80:95]
  ds_read_b64_tr_b16 a[250:251], v26 offset:38912
  v_max3_f32 v30, v30, v133, v134
  v_add_f32 v28, v28, v170
  v_max3_f32 v31, v31, v149, v150
  v_add_f32 v28, v28, v171
  v_max3_f32 v30, v30, v135, v136
  v_mfma_f32_32x32x16_bf16 a[96:111], a[236:239], v[224:227], a[96:111]
  ds_read_b64_tr_b16 a[252:253], v27 offset:36864
  v_add_f32 v28, v28, v172
  v_max3_f32 v31, v31, v151, v152
  v_add_f32 v28, v28, v173
  v_max3_f32 v30, v30, v137, v138
  v_add_f32 v28, v28, v174
  v_mfma_f32_32x32x16_bf16 a[112:127], a[236:239], v[232:235], a[112:127]
  ds_read_b64_tr_b16 a[254:255], v27 offset:38912
  v_max3_f32 v31, v31, v153, v154
  v_add_f32 v28, v28, v175
  v_max3_f32 v30, v30, v139, v140
  v_add_f32 v29, v29, v184
  v_max3_f32 v31, v31, v155, v156
  s_waitcnt lgkmcnt(4)
  v_mfma_f32_32x32x16_bf16 a[0:15], a[240:243], v[228:231], a[0:15]
  s_waitcnt vmcnt(4)
  s_barrier
  ds_read_b128 a[192:195], v16 offset:49152
  v_add_f32 v29, v29, v185
  v_max3_f32 v30, v30, v141, v142
  s_add_u32 m0, s19, 81920
  v_mfma_f32_32x32x16_bf16 a[16:31], a[240:243], v[236:239], a[16:31]
  v_add_f32 v29, v29, v186
  v_max3_f32 v31, v31, v157, v158
  v_add_f32 v29, v29, v187
  buffer_load_dwordx4 v12, s[28:31], s43 offen offset:0 lds
  v_mfma_f32_32x32x16_bf16 a[32:47], a[244:247], v[228:231], a[32:47]
  ds_read_b128 a[196:199], v17 offset:49152
  v_max_f32 v30, v30, v143
  v_add_f32 v29, v29, v188
  buffer_load_dwordx4 v13, s[28:31], s43 offen offset:1024 lds
  v_mfma_f32_32x32x16_bf16 a[48:63], a[244:247], v[236:239], a[48:63]
  v_max_f32 v31, v31, v159
  v_add_f32 v29, v29, v189
  v_add_f32 v29, v29, v190
  buffer_load_dwordx4 v14, s[28:31], s43 offen offset:2048 lds
  s_waitcnt lgkmcnt(2)
  v_mfma_f32_32x32x16_bf16 a[64:79], a[248:251], v[228:231], a[64:79]
  ds_read_b128 a[200:203], v18 offset:49152
  v_add_f32 v29, v29, v191
  buffer_load_dwordx4 v15, s[28:31], s43 offen offset:3072 lds
  s_add_u32 s43, s43, 8192
  v_mfma_f32_32x32x16_bf16 a[80:95], a[248:251], v[236:239], a[80:95]
  v_mfma_f32_32x32x16_bf16 a[96:111], a[252:255], v[228:231], a[96:111]
  ds_read_b128 a[204:207], v19 offset:49152
  v_mfma_f32_32x32x16_bf16 a[112:127], a[252:255], v[236:239], a[112:127]
  v_max_f32 v32, v30, v31
  v_cmp_lt_f32 vcc, s50, v32
  s_cbranch_vccz L_mk5_norescale_10
  s_call_b64 s[48:49], L_q_rescale0
L_mk5_norescale_10:
  s_waitcnt lgkmcnt(2)
  v_mfma_f32_32x32x16_bf16 v[160:175], a[192:195], a[128:131], v[192:207]
  ds_read_b128 a[208:211], v20 offset:49152
  v_exp_f32 v128, v128
  v_exp_f32 v129, v129
  v_mfma_f32_32x32x16_bf16 v[176:191], a[192:195], a[160:163], v[208:223]
  v_exp_f32 v130, v130
  v_cvt_pk_bf16_f32 v224, v128, v129
  v_exp_f32 v131, v131
  v_mfma_f32_32x32x16_bf16 v[160:175], a[196:199], a[132:135], v[160:175]
  ds_read_b128 a[212:215], v21 offset:49152
  v_exp_f32 v132, v132
  v_cvt_pk_bf16_f32 v225, v130, v131
  v_exp_f32 v133, v133
  v_mfma_f32_32x32x16_bf16 v[176:191], a[196:199], a[164:167], v[176:191]
  v_exp_f32 v134, v134
  v_cvt_pk_bf16_f32 v226, v132, v133
  v_exp_f32 v135, v135
  v_add_f32 v28, v28, v128
  s_waitcnt lgkmcnt(2)
  v_mfma_f32_32x32x16_bf16 v[160:175], a[200:203], a[136:139], v[160:175]
  ds_read_b128 a[216:219], v22 offset:49152
  v_exp_f32 v144, v144
  v_cvt_pk_bf16_f32 v227, v134, v135
  v_add_f32 v28, v28, v129
  v_mfma_f32_32x32x16_bf16 v[176:191], a[200:203], a[168:171], v[176:191]
  v_exp_f32 v145, v145
  v_exp_f32 v146, v146
  v_cvt_pk_bf16_f32 v232, v144, v145
  v_add_f32 v28, v28, v130
  v_mfma_f32_32x32x16_bf16 v[160:175], a[204:207], a[140:143], v[160:175]
  ds_read_b128 a[220:223], v23 offset:49152
  v_exp_f32 v147, v147
  v_exp_f32 v148, v148
  v_cvt_pk_bf16_f32 v233, v146, v147
  v_mfma_f32_32x32x16_bf16 v[176:191], a[204:207], a[172:175], v[176:191]
  v_exp_f32 v149, v149
  v_exp_f32 v150, v150
  v_cvt_pk_bf16_f32 v234, v148, v149
  v_add_f32 v28, v28, v131
  s_waitcnt lgkmcnt(2)
  v_mfma_f32_32x32x16_bf16 v[160:175], a[208:211], a[144:147], v[160:175]
  ds_read_b64_tr_b16 a[224:225], v24 offset:49152
  v_exp_f32 v151, v151
  v_exp_f32 v136, v136
  v_mfma_f32_32x32x16_bf16 v[176:191], a[208:211], a[176:179], v[176:191]
  ds_read_b64_tr_b16 a[226:227], v24 offset:51200
  v_cvt_pk_bf16_f32 v235, v150, v151
  v_exp_f32 v137, v137
  v_exp_f32 v138, v138
  v_mfma_f32_32x32x16_bf16 v[160:175], a[212:215], a[148:151], v[160:175]
  ds_read_b64_tr_b16 a[228:229], v25 offset:49152
  v_cvt_pk_bf16_f32 v228, v136, v137
  v_exp_f32 v139, v139
  v_exp_f32 v140, v140
  v_mfma_f32_32x32x16_bf16 v[176:191], a[212:215], a[180:183], v[176:191]
  ds_read_b64_tr_b16 a[230:231], v25 offset:51200
  v_cvt_pk_bf16_f32 v229, v138, v139
  v_exp_f32 v141, v141
  v_exp_f32 v142, v142
  s_waitcnt lgkmcnt(4)
  v_mfma_f32_32x32x16_bf16 v[160:175], a[216:219], a[152:155], v[160:175]
  ds_read_b64_tr_b16 a[232:233], v26 offset:49152
  v_cvt_pk_bf16_f32 v230, v140, v141
  v_exp_f32 v143, v143
  v_add_f32 v28, v28, v132
  v_mfma_f32_32x32x16_bf16 v[176:191], a[216:219], a[184:187], v[176:191]
  ds_read_b64_tr_b16 a[234:235], v26 offset:51200
  v_exp_f32 v152, v152
  v_cvt_pk_bf16_f32 v231, v142, v143
  v_exp_f32 v153, v153
  v_mfma_f32_32x32x16_bf16 v[160:175], a[220:223], a[156:159], v[160:175]
  ds_read_b64_tr_b16 a[236:237], v27 offset:49152
  v_exp_f32 v154, v154
  v_cvt_pk_bf16_f32 v236, v152, v153
  v_exp_f32 v155, v155
  v_mfma_f32_32x32x16_bf16 v[176:191], a[220:223], a[188:191], v[176:191]
  ds_read_b64_tr_b16 a[238:239], v27 offset:51200
  v_exp_f32 v156, v156
  v_cvt_pk_bf16_f32 v237, v154, v155
  v_exp_f32 v157, v157
  s_nop 0
  s_waitcnt lgkmcnt(4)
  v_mfma_f32_32x32x16_bf16 a[0:15], a[224:227], v[224:227], a[0:15]
  ds_read_b64_tr_b16 a[240:241], v24 offset:53248
  v_exp_f32 v158, v158
  v_cvt_pk_bf16_f32 v238, v156, v157
  v_add_f32 v28, v28, v133
  v_mfma_f32_32x32x16_bf16 a[16:31], a[224:227], v[232:235], a[16:31]
  ds_read_b64_tr_b16 a[242:243], v24 offset:55296
  v_exp_f32 v159, v159
  v_add_f32 v28, v28, v134
  v_add_f32 v28, v28, v135
  v_add_f32 v29, v29, v144
  v_mfma_f32_32x32x16_bf16 a[32:47], a[228:231], v[224:227], a[32:47]
  ds_read_b64_tr_b16 a[244:245], v25 offset:53248
  v_cvt_pk_bf16_f32 v239, v158, v159
  v_add_f32 v29, v29, v145
  v_add_f32 v29, v29, v146
  v_add_f32 v29, v29, v147
  v_max3_f32 v30, v160, v161, v162
  v_mfma_f32_32x32x16_bf16 a[48:63], a[228:231], v[232:235], a[48:63]
  ds_read_b64_tr_b16 a[246:247], v25 offset:55296
  v_add_f32 v29, v29, v148
  v_add_f32 v29, v29, v149
  v_add_f32 v29, v29, v150
  v_max3_f32 v31, v176, v177, v178
  v_add_f32 v29, v29, v151
  s_waitcnt lgkmcnt(4)
  v_mfma_f32_32x32x16_bf16 a[64:79], a[232:235], v[224:227], a[64:79]
  ds_read_b64_tr_b16 a[248:249], v26 offset:53248
  v_max3_f32 v30, v30, v163, v164
  v_add_f32 v28, v28, v136
  v_max3_f32 v31, v31, v179, v180
  v_add_f32 v28, v28, v137
  v_mfma_f32_32x32x16_bf16 a[80:95], a[232:235], v[232:235], a[80:95]
  ds_read_b64_tr_b16 a[250:251], v26 offset:55296
  v_max3_f32 v30, v30, v165, v166
  v_add_f32 v28, v28, v138
  v_max3_f32 v31, v31, v181, v182
  v_add_f32 v28, v28, v139
  v_max3_f32 v30, v30, v167, v168
  v_mfma_f32_32x32x16_bf16 a[96:111], a[236:239], v[224:227], a[96:111]
  ds_read_b64_tr_b16 a[252:253], v27 offset:53248
  v_add_f32 v28, v28, v140
  v_max3_f32 v31, v31, v183, v184
  v_add_f32 v28, v28, v141
  v_max3_f32 v30, v30, v169, v170
  v_add_f32 v28, v28, v142
  v_mfma_f32_32x32x16_bf16 a[112:127], a[236:239], v[232:235], a[112:127]
  ds_read_b64_tr_b16 a[254:255], v27 offset:55296
  v_max3_f32 v31, v31, v185, v186
  v_add_f32 v28, v28, v143
  v_max3_f32 v30, v30, v171, v172
  v_add_f32 v29, v29, v152
  v_max3_f32 v31, v31, v187, v188
  s_waitcnt lgkmcnt(4)
  v_mfma_f32_32x32x16_bf16 a[0:15], a[240:243], v[228:231], a[0:15]
  s_waitcnt vmcnt(4)
  s_barrier
  ds_read_b128 a[192:195], v16 offset:0
  v_add_f32 v29, v29, v153
  v_max3_f32 v30, v30, v173, v174
  s_add_u32 m0, s19, 98304
  v_mfma_f32_32x32x16_bf16 a[16:31], a[240:243], v[236:239], a[16:31]
  v_add_f32 v29, v29, v154
  v_max3_f32 v31, v31, v189, v190
  v_add_f32 v29, v29, v155
  buffer_load_dwordx4 v12, s[28:31], s43 offen offset:0 lds
  v_mfma_f32_32x32x16_bf16 a[32:47], a[244:247], v[228:231], a[32:47]
  ds_read_b128 a[196:199], v17 offset:0
  v_max_f32 v30, v30, v175
  v_add_f32 v29, v29, v156
  buffer_load_dwordx4 v13, s[28:31], s43 offen offset:1024 lds
  v_mfma_f32_32x32x16_bf16 a[48:63], a[244:247], v[236:239], a[48:63]
  v_max_f32 v31, v31, v191
  v_add_f32 v29, v29, v157
  v_add_f32 v29, v29, v158
  buffer_load_dwordx4 v14, s[28:31], s43 offen offset:2048 lds
  s_waitcnt lgkmcnt(2)
  v_mfma_f32_32x32x16_bf16 a[64:79], a[248:251], v[228:231], a[64:79]
  ds_read_b128 a[200:203], v18 offset:0
  v_add_f32 v29, v29, v159
  buffer_load_dwordx4 v15, s[28:31], s43 offen offset:3072 lds
  s_add_u32 s43, s43, 8192
  v_mfma_f32_32x32x16_bf16 a[80:95], a[248:251], v[236:239], a[80:95]
  v_mfma_f32_32x32x16_bf16 a[96:111], a[252:255], v[228:231], a[96:111]
  ds_read_b128 a[204:207], v19 offset:0
  v_mfma_f32_32x32x16_bf16 a[112:127], a[252:255], v[236:239], a[112:127]
  v_max_f32 v32, v30, v31
  v_cmp_lt_f32 vcc, s50, v32
  s_cbranch_vccz L_mk5_norescale_11
  s_call_b64 s[48:49], L_q_rescale1
L_mk5_norescale_11:
  s_waitcnt lgkmcnt(2)
  v_mfma_f32_32x32x16_bf16 v[128:143], a[192:195], a[128:131], v[192:207]
  ds_read_b128 a[208:211], v20 offset:0
  v_exp_f32 v160, v160
  v_exp_f32 v161, v161
  v_mfma_f32_32x32x16_bf16 v[144:159], a[192:195], a[160:163], v[208:223]
  v_exp_f32 v162, v162
  v_cvt_pk_bf16_f32 v224, v160, v161
  v_exp_f32 v163, v163
  v_mfma_f32_32x32x16_bf16 v[128:143], a[196:199], a[132:135], v[128:143]
  ds_read_b128 a[212:215], v21 offset:0
  v_exp_f32 v164, v164
  v_cvt_pk_bf16_f32 v225, v162, v163
  v_exp_f32 v165, v165
  v_mfma_f32_32x32x16_bf16 v[144:159], a[196:199], a[164:167], v[144:159]
  v_exp_f32 v166, v166
  v_cvt_pk_bf16_f32 v226, v164, v165
  v_exp_f32 v167, v167
  v_add_f32 v28, v28, v160
  s_waitcnt lgkmcnt(2)
  v_mfma_f32_32x32x16_bf16 v[128:143], a[200:203], a[136:139], v[128:143]
  ds_read_b128 a[216:219], v22 offset:0
  v_exp_f32 v176, v176
  v_cvt_pk_bf16_f32 v227, v166, v167
  v_add_f32 v28, v28, v161
  v_mfma_f32_32x32x16_bf16 v[144:159], a[200:203], a[168:171], v[144:159]
  v_exp_f32 v177, v177
  v_exp_f32 v178, v178
  v_cvt_pk_bf16_f32 v232, v176, v177
  v_add_f32 v28, v28, v162
  v_mfma_f32_32x32x16_bf16 v[128:143], a[204:207], a[140:143], v[128:143]
  ds_read_b128 a[220:223], v23 offset:0
  v_exp_f32 v179, v179
  v_exp_f32 v180, v180
  v_cvt_pk_bf16_f32 v233, v178, v179
  v_mfma_f32_32x32x16_bf16 v[144:159], a[204:207], a[172:175], v[144:159]
  v_exp_f32 v181, v181
  v_exp_f32 v182, v182
  v_cvt_pk_bf16_f32 v234, v180, v181
  v_add_f32 v28, v28, v163
  s_waitcnt lgkmcnt(2)
  v_mfma_f32_32x32x16_bf16 v[128:143], a[208:211], a[144:147], v[128:143]
  ds_read_b64_tr_b16 a[224:225], v24 offset:0
  v_exp_f32 v183, v183
  v_exp_f32 v168, v168
  v_mfma_f32_32x32x16_bf16 v[144:159], a[208:211], a[176:179], v[144:159]
  ds_read_b64_tr_b16 a[226:227], v24 offset:2048
  v_cvt_pk_bf16_f32 v235, v182, v183
  v_exp_f32 v169, v169
  v_exp_f32 v170, v170
  v_mfma_f32_32x32x16_bf16 v[128:143], a[212:215], a[148:151], v[128:143]
  ds_read_b64_tr_b16 a[228:229], v25 offset:0
  v_cvt_pk_bf16_f32 v228, v168, v169
  v_exp_f32 v171, v171
  v_exp_f32 v172, v172
  v_mfma_f32_32x32x16_bf16 v[144:159], a[212:215], a[180:183], v[144:159]
  ds_read_b64_tr_b16 a[230:231], v25 offset:2048
  v_cvt_pk_bf16_f32 v229, v170, v171
  v_exp_f32 v173, v173
  v_exp_f32 v174, v174
  s_waitcnt lgkmcnt(4)
  v_mfma_f32_32x32x16_bf16 v[128:143], a[216:219], a[152:155], v[128:143]
  ds_read_b64_tr_b16 a[232:233], v26 offset:0
  v_cvt_pk_bf16_f32 v230, v172, v173
  v_exp_f32 v175, v175
  v_add_f32 v28, v28, v164
  v_mfma_f32_32x32x16_bf16 v[144:159], a[216:219], a[184:187], v[144:159]
  ds_read_b64_tr_b16 a[234:235], v26 offset:2048
  v_exp_f32 v184, v184
  v_cvt_pk_bf16_f32 v231, v174, v175
  v_exp_f32 v185, v185
  v_mfma_f32_32x32x16_bf16 v[128:143], a[220:223], a[156:159], v[128:143]
  ds_read_b64_tr_b16 a[236:237], v27 offset:0
  v_exp_f32 v186, v186
  v_cvt_pk_bf16_f32 v236, v184, v185
  v_exp_f32 v187, v187
  v_mfma_f32_32x32x16_bf16 v[144:159], a[220:223], a[188:191], v[144:159]
  ds_read_b64_tr_b16 a[238:239], v27 offset:2048
  v_exp_f32 v188, v188
  v_cvt_pk_bf16_f32 v237, v186, v187
  v_exp_f32 v189, v189
  s_nop 0
  s_waitcnt lgkmcnt(4)
  v_mfma_f32_32x32x16_bf16 a[0:15], a[224:227], v[224:227], a[0:15]
  ds_read_b64_tr_b16 a[240:241], v24 offset:4096
  v_exp_f32 v190, v190
  v_cvt_pk_bf16_f32 v238, v188, v189
  v_add_f32 v28, v28, v165
  v_mfma_f32_32x32x16_bf16 a[16:31], a[224:227], v[232:235], a[16:31]
  ds_read_b64_tr_b16 a[242:243], v24 offset:6144
  v_exp_f32 v191, v191
  v_add_f32 v28, v28, v166
  v_add_f32 v28, v28, v167
  v_add_f32 v29, v29, v176
  v_mfma_f32_32x32x16_bf16 a[32:47], a[228:231], v[224:227], a[32:47]
  ds_read_b64_tr_b16 a[244:245], v25 offset:4096
  v_cvt_pk_bf16_f32 v239, v190, v191
  v_add_f32 v29, v29, v177
  v_add_f32 v29, v29, v178
  v_add_f32 v29, v29, v179
  v_max3_f32 v30, v128, v129, v130
  v_mfma_f32_32x32x16_bf16 a[48:63], a[228:231], v[232:235], a[48:63]
  ds_read_b64_tr_b16 a[246:247], v25 offset:6144
  v_add_f32 v29, v29, v180
  v_add_f32 v29, v29, v181
  v_add_f32 v29, v29, v182
  v_max3_f32 v31, v144, v145, v146
  v_add_f32 v29, v29, v183
  s_waitcnt lgkmcnt(4)
  v_mfma_f32_32x32x16_bf16 a[64:79], a[232:235], v[224:227], a[64:79]
  ds_read_b64_tr_b16 a[248:249], v26 offset:4096
  v_max3_f32 v30, v30, v131, v132
  v_add_f32 v28, v28, v168
  v_max3_f32 v31, v31, v147, v148
  v_add_f32 v28, v28, v169
  v_mfma_f32_32x32x16_bf16 a[80:95], a[232:235], v[232:235], a[80:95]
  ds_read_b64_tr_b16 a[250:251], v26 offset:6144
  v_max3_f32 v30, v30, v133, v134
  v_add_f32 v28, v28, v170
  v_max3_f32 v31, v31, v149, v150
  v_add_f32 v28, v28, v171
  v_max3_f32 v30, v30, v135, v136
  v_mfma_f32_32x32x16_bf16 a[96:111], a[236:239], v[224:227], a[96:111]
  ds_read_b64_tr_b16 a[252:253], v27 offset:4096
  v_add_f32 v28, v28, v172
  v_max3_f32 v31, v31, v151, v152
  v_add_f32 v28, v28, v173
  v_max3_f32 v30, v30, v137, v138
  v_add_f32 v28, v28, v174
  v_mfma_f32_32x32x16_bf16 a[112:127], a[236:239], v[232:235], a[112:127]
  ds_read_b64_tr_b16 a[254:255], v27 offset:6144
  v_max3_f32 v31, v31, v153, v154
  v_add_f32 v28, v28, v175
  v_max3_f32 v30, v30, v139, v140
  v_add_f32 v29, v29, v184
  v_max3_f32 v31, v31, v155, v156
  s_waitcnt lgkmcnt(4)
  v_mfma_f32_32x32x16_bf16 a[0:15], a[240:243], v[228:231], a[0:15]
  s_waitcnt vmcnt(4)
  s_barrier
  ds_read_b128 a[192:195], v16 offset:16384
  v_add_f32 v29, v29, v185
  v_max3_f32 v30, v30, v141, v142
  s_add_u32 m0, s19, 114688
  v_mfma_f32_32x32x16_bf16 a[16:31], a[240:243], v[236:239], a[16:31]
  v_add_f32 v29, v29, v186
  v_max3_f32 v31, v31, v157, v158
  v_add_f32 v29, v29, v187
  buffer_load_dwordx4 v12, s[28:31], s43 offen offset:0 lds
  v_mfma_f32_32x32x16_bf16 a[32:47], a[244:247], v[228:231], a[32:47]
  ds_read_b128 a[196:199], v17 offset:16384
  v_max_f32 v30, v30, v143
  v_add_f32 v29, v29, v188
  buffer_load_dwordx4 v13, s[28:31], s43 offen offset:1024 lds
  v_mfma_f32_32x32x16_bf16 a[48:63], a[244:247], v[236:239], a[48:63]
  v_max_f32 v31, v31, v159
  v_add_f32 v29, v29, v189
  v_add_f32 v29, v29, v190
  buffer_load_dwordx4 v14, s[28:31], s43 offen offset:2048 lds
  s_waitcnt lgkmcnt(2)
  v_mfma_f32_32x32x16_bf16 a[64:79], a[248:251], v[228:231], a[64:79]
  ds_read_b128 a[200:203], v18 offset:16384
  v_add_f32 v29, v29, v191
  buffer_load_dwordx4 v15, s[28:31], s43 offen offset:3072 lds
  s_add_u32 s43, s43, 8192
  v_mfma_f32_32x32x16_bf16 a[80:95], a[248:251], v[236:239], a[80:95]
  v_mfma_f32_32x32x16_bf16 a[96:111], a[252:255], v[228:231], a[96:111]
  ds_read_b128 a[204:207], v19 offset:16384
  v_mfma_f32_32x32x16_bf16 a[112:127], a[252:255], v[236:239], a[112:127]
  v_max_f32 v32, v30, v31
  v_cmp_lt_f32 vcc, s50, v32
  s_cbranch_vccz L_mk5_norescale_12
  s_call_b64 s[48:49], L_q_rescale0
L_mk5_norescale_12:
  s_waitcnt lgkmcnt(2)
  v_mfma_f32_32x32x16_bf16 v[160:175], a[192:195], a[128:131], v[192:207]
  ds_read_b128 a[208:211], v20 offset:16384
  v_exp_f32 v128, v128
  v_exp_f32 v129, v129
  v_mfma_f32_32x32x16_bf16 v[176:191], a[192:195], a[160:163], v[208:223]
  v_exp_f32 v130, v130
  v_cvt_pk_bf16_f32 v224, v128, v129
  v_exp_f32 v131, v131
  v_mfma_f32_32x32x16_bf16 v[160:175], a[196:199], a[132:135], v[160:175]
  ds_read_b128 a[212:215], v21 offset:16384
  v_exp_f32 v132, v132
  v_cvt_pk_bf16_f32 v225, v130, v131
  v_exp_f32 v133, v133
  v_mfma_f32_32x32x16_bf16 v[176:191], a[196:199], a[164:167], v[176:191]
  v_exp_f32 v134, v134
  v_cvt_pk_bf16_f32 v226, v132, v133
  v_exp_f32 v135, v135
  v_add_f32 v28, v28, v128
  s_waitcnt lgkmcnt(2)
  v_mfma_f32_32x32x16_bf16 v[160:175], a[200:203], a[136:139], v[160:175]
  ds_read_b128 a[216:219], v22 offset:16384
  v_exp_f32 v144, v144
  v_cvt_pk_bf16_f32 v227, v134, v135
  v_add_f32 v28, v28, v129
  v_mfma_f32_32x32x16_bf16 v[176:191], a[200:203], a[168:171], v[176:191]
  v_exp_f32 v145, v145
  v_exp_f32 v146, v146
  v_cvt_pk_bf16_f32 v232, v144, v145
  v_add_f32 v28, v28, v130
  v_mfma_f32_32x32x16_bf16 v[160:175], a[204:207], a[140:143], v[160:175]
  ds_read_b128 a[220:223], v23 offset:16384
  v_exp_f32 v147, v147
  v_exp_f32 v148, v148
  v_cvt_pk_bf16_f32 v233, v146, v147
  v_mfma_f32_32x32x16_bf16 v[176:191], a[204:207], a[172:175], v[176:191]
  v_exp_f32 v149, v149
  v_exp_f32 v150, v150
  v_cvt_pk_bf16_f32 v234, v148, v149
  v_add_f32 v28, v28, v131
  s_waitcnt lgkmcnt(2)
  v_mfma_f32_32x32x16_bf16 v[160:175], a[208:211], a[144:147], v[160:175]
  ds_read_b64_tr_b16 a[224:225], v24 offset:16384
  v_exp_f32 v151, v151
  v_exp_f32 v136, v136
  v_mfma_f32_32x32x16_bf16 v[176:191], a[208:211], a[176:179], v[176:191]
  ds_read_b64_tr_b16 a[226:227], v24 offset:18432
  v_cvt_pk_bf16_f32 v235, v150, v151
  v_exp_f32 v137, v137
  v_exp_f32 v138, v138
  v_mfma_f32_32x32x16_bf16 v[160:175], a[212:215], a[148:151], v[160:175]
  ds_read_b64_tr_b16 a[228:229], v25 offset:16384
  v_cvt_pk_bf16_f32 v228, v136, v137
  v_exp_f32 v139, v139
  v_exp_f32 v140, v140
  v_mfma_f32_32x32x16_bf16 v[176:191], a[212:215], a[180:183], v[176:191]
  ds_read_b64_tr_b16 a[230:231], v25 offset:18432
  v_cvt_pk_bf16_f32 v229, v138, v139
  v_exp_f32 v141, v141
  v_exp_f32 v142, v142
  s_waitcnt lgkmcnt(4)
  v_mfma_f32_32x32x16_bf16 v[160:175], a[216:219], a[152:155], v[160:175]
  ds_read_b64_tr_b16 a[232:233], v26 offset:16384
  v_cvt_pk_bf16_f32 v230, v140, v141
  v_exp_f32 v143, v143
  v_add_f32 v28, v28, v132
  v_mfma_f32_32x32x16_bf16 v[176:191], a[216:219], a[184:187], v[176:191]
  ds_read_b64_tr_b16 a[234:235], v26 offset:18432
  v_exp_f32 v152, v152
  v_cvt_pk_bf16_f32 v231, v142, v143
  v_exp_f32 v153, v153
  v_mfma_f32_32x32x16_bf16 v[160:175], a[220:223], a[156:159], v[160:175]
  ds_read_b64_tr_b16 a[236:237], v27 offset:16384
  v_exp_f32 v154, v154
  v_cvt_pk_bf16_f32 v236, v152, v153
  v_exp_f32 v155, v155
  v_mfma_f32_32x32x16_bf16 v[176:191], a[220:223], a[188:191], v[176:191]
  ds_read_b64_tr_b16 a[238:239], v27 offset:18432
  v_exp_f32 v156, v156
  v_cvt_pk_bf16_f32 v237, v154, v155
  v_exp_f32 v157, v157
  s_nop 0
  s_waitcnt lgkmcnt(4)
  v_mfma_f32_32x32x16_bf16 a[0:15], a[224:227], v[224:227], a[0:15]
  ds_read_b64_tr_b16 a[240:241], v24 offset:20480
  v_exp_f32 v158, v158
  v_cvt_pk_bf16_f32 v238, v156, v157
  v_add_f32 v28, v28, v133
  v_mfma_f32_32x32x16_bf16 a[16:31], a[224:227], v[232:235], a[16:31]
  ds_read_b64_tr_b16 a[242:243], v24 offset:22528
  v_exp_f32 v159, v159
  v_add_f32 v28, v28, v134
  v_add_f32 v28, v28, v135
  v_add_f32 v29, v29, v144
  v_mfma_f32_32x32x16_bf16 a[32:47], a[228:231], v[224:227], a[32:47]
  ds_read_b64_tr_b16 a[244:245], v25 offset:20480
  v_cvt_pk_bf16_f32 v239, v158, v159
  v_add_f32 v29, v29, v145
  v_add_f32 v29, v29, v146
  v_add_f32 v29, v29, v147
  v_max3_f32 v30, v160, v161, v162
  v_mfma_f32_32x32x16_bf16 a[48:63], a[228:231], v[232:235], a[48:63]
  ds_read_b64_tr_b16 a[246:247], v25 offset:22528
  v_add_f32 v29, v29, v148
  v_add_f32 v29, v29, v149
  v_add_f32 v29, v29, v150
  v_max3_f32 v31, v176, v177, v178
  v_add_f32 v29, v29, v151
  s_waitcnt lgkmcnt(4)
  v_mfma_f32_32x32x16_bf16 a[64:79], a[232:235], v[224:227], a[64:79]
  ds_read_b64_tr_b16 a[248:249], v26 offset:20480
  v_max3_f32 v30, v30, v163, v164
  v_add_f32 v28, v28, v136
  v_max3_f32 v31, v31, v179, v180
  v_add_f32 v28, v28, v137
  v_mfma_f32_32x32x16_bf16 a[80:95], a[232:235], v[232:235], a[80:95]
  ds_read_b64_tr_b16 a[250:251], v26 offset:22528
  v_max3_f32 v30, v30, v165, v166
  v_add_f32 v28, v28, v138
  v_max3_f32 v31, v31, v181, v182
  v_add_f32 v28, v28, v139
  v_max3_f32 v30, v30, v167, v168
  v_mfma_f32_32x32x16_bf16 a[96:111], a[236:239], v[224:227], a[96:111]
  ds_read_b64_tr_b16 a[252:253], v27 offset:20480
  v_add_f32 v28, v28, v140
  v_max3_f32 v31, v31, v183, v184
  v_add_f32 v28, v28, v141
  v_max3_f32 v30, v30, v169, v170
  v_add_f32 v28, v28, v142
  v_mfma_f32_32x32x16_bf16 a[112:127], a[236:239], v[232:235], a[112:127]
  ds_read_b64_tr_b16 a[254:255], v27 offset:22528
  v_max3_f32 v31, v31, v185, v186
  v_add_f32 v28, v28, v143
  v_max3_f32 v30, v30, v171, v172
  v_add_f32 v29, v29, v152
  v_max3_f32 v31, v31, v187, v188
  s_waitcnt lgkmcnt(4)
  v_mfma_f32_32x32x16_bf16 a[0:15], a[240:243], v[228:231], a[0:15]
  s_waitcnt vmcnt(4)
  s_barrier
  ds_read_b128 a[192:195], v16 offset:32768
  v_add_f32 v29, v29, v153
  v_max3_f32 v30, v30, v173, v174
  s_add_u32 m0, s19, 65536
  v_mfma_f32_32x32x16_bf16 a[16:31], a[240:243], v[236:239], a[16:31]
  v_add_f32 v29, v29, v154
  v_max3_f32 v31, v31, v189, v190
  v_add_f32 v29, v29, v155
  buffer_load_dwordx4 v12, s[28:31], s43 offen offset:0 lds
  v_mfma_f32_32x32x16_bf16 a[32:47], a[244:247], v[228:231], a[32:47]
  ds_read_b128 a[196:199], v17 offset:32768
  v_max_f32 v30, v30, v175
  v_add_f32 v29, v29, v156
  buffer_load_dwordx4 v13, s[28:31], s43 offen offset:1024 lds
  v_mfma_f32_32x32x16_bf16 a[48:63], a[244:247], v[236:239], a[48:63]
  v_max_f32 v31, v31, v191
  v_add_f32 v29, v29, v157
  v_add_f32 v29, v29, v158
  buffer_load_dwordx4 v14, s[28:31], s43 offen offset:2048 lds
  s_waitcnt lgkmcnt(2)
  v_mfma_f32_32x32x16_bf16 a[64:79], a[248:251], v[228:231], a[64:79]
  ds_read_b128 a[200:203], v18 offset:32768
  v_add_f32 v29, v29, v159
  buffer_load_dwordx4 v15, s[28:31], s43 offen offset:3072 lds
  s_add_u32 s43, s43, 8192
  v_mfma_f32_32x32x16_bf16 a[80:95], a[248:251], v[236:239], a[80:95]
  v_mfma_f32_32x32x16_bf16 a[96:111], a[252:255], v[228:231], a[96:111]
  ds_read_b128 a[204:207], v19 offset:32768
  v_mfma_f32_32x32x16_bf16 a[112:127], a[252:255], v[236:239], a[112:127]
  v_max_f32 v32, v30, v31
  v_cmp_lt_f32 vcc, s50, v32
  s_cbranch_vccz L_mk5_norescale_13
  s_call_b64 s[48:49], L_q_rescale1
L_mk5_norescale_13:
  s_waitcnt lgkmcnt(2)
  v_mfma_f32_32x32x16_bf16 v[128:143], a[192:195], a[128:131], v[192:207]
  ds_read_b128 a[208:211], v20 offset:32768
  v_exp_f32 v160, v160
  v_exp_f32 v161, v161
  v_mfma_f32_32x32x16_bf16 v[144:159], a[192:195], a[160:163], v[208:223]
  v_exp_f32 v162, v162
  v_cvt_pk_bf16_f32 v224, v160, v161
  v_exp_f32 v163, v163
  v_mfma_f32_32x32x16_bf16 v[128:143], a[196:199], a[132:135], v[128:143]
  ds_read_b128 a[212:215], v21 offset:32768
  s_mul_i32 s21, s16, 32768
  v_mul_u32_u24 v7, 2048, v34
  v_exp_f32 v164, v164
  v_cvt_pk_bf16_f32 v225, v162, v163
  v_mfma_f32_32x32x16_bf16 v[144:159], a[196:199], a[164:167], v[144:159]
  v_add3_u32 v4, v7, v44, s21
  v_add3_u32 v5, v7, v45, s21
  v_exp_f32 v165, v165
  v_exp_f32 v166, v166
  s_waitcnt lgkmcnt(2)
  v_mfma_f32_32x32x16_bf16 v[128:143], a[200:203], a[136:139], v[128:143]
  ds_read_b128 a[216:219], v22 offset:32768
  v_add_u32 v5, 7168, v5
  v_add_u32 v6, 14336, v4
  v_cvt_pk_bf16_f32 v226, v164, v165
  v_add_f32 v28, v28, v160
  v_mfma_f32_32x32x16_bf16 v[144:159], a[200:203], a[168:171], v[144:159]
  v_exp_f32 v167, v167
  v_exp_f32 v176, v176
  v_cvt_pk_bf16_f32 v227, v166, v167
  v_add_f32 v28, v28, v161
  v_mfma_f32_32x32x16_bf16 v[128:143], a[204:207], a[140:143], v[128:143]
  ds_read_b128 a[220:223], v23 offset:32768
  v_add_u32 v7, 14336, v5
  s_mov_b32 s17, 0
  v_exp_f32 v177, v177
  v_add_f32 v28, v28, v162
  v_mfma_f32_32x32x16_bf16 v[144:159], a[204:207], a[172:175], v[144:159]
  s_mov_b32 s18, 0
  s_lshl_b32 s21, s40, 8
  v_exp_f32 v178, v178
  v_cvt_pk_bf16_f32 v232, v176, v177
  v_add_f32 v28, v28, v163
  s_waitcnt lgkmcnt(2)
  v_mfma_f32_32x32x16_bf16 v[128:143], a[208:211], a[144:147], v[128:143]
  ds_read_b64_tr_b16 a[224:225], v24 offset:32768
  s_sub_u32 s22, 8388608, s21
  s_add_u32 s8, s80, s21
  s_addc_u32 s9, s81, 0
  v_exp_f32 v179, v179
  v_mfma_f32_32x32x16_bf16 v[144:159], a[208:211], a[176:179], v[144:159]
  ds_read_b64_tr_b16 a[226:227], v24 offset:34816
  v_exp_f32 v180, v180
  v_cvt_pk_bf16_f32 v233, v178, v179
  v_exp_f32 v181, v181
  v_mfma_f32_32x32x16_bf16 v[128:143], a[212:215], a[148:151], v[128:143]
  ds_read_b64_tr_b16 a[228:229], v25 offset:32768
  s_and_b32 s9, s9, 0xffff
  s_mov_b32 s10, s22
  v_exp_f32 v182, v182
  v_cvt_pk_bf16_f32 v234, v180, v181
  v_mfma_f32_32x32x16_bf16 v[144:159], a[212:215], a[180:183], v[144:159]
  ds_read_b64_tr_b16 a[230:231], v25 offset:34816
  s_mov_b32 s11, 0x00020000
  s_lshl_b32 s21, s41, 2
  v_exp_f32 v183, v183
  v_add_f32 v28, v28, v164
  s_waitcnt lgkmcnt(4)
  v_mfma_f32_32x32x16_bf16 v[128:143], a[216:219], a[152:155], v[128:143]
  ds_read_b64_tr_b16 a[232:233], v26 offset:32768
  s_add_u32 s21, s21, s16
  s_lshl_b32 s22, s21, 18
  v_exp_f32 v168, v168
  v_mfma_f32_32x32x16_bf16 v[144:159], a[216:219], a[184:187], v[144:159]
  ds_read_b64_tr_b16 a[234:235], v26 offset:34816
  v_cvt_pk_bf16_f32 v235, v182, v183
  v_exp_f32 v169, v169
  v_exp_f32 v170, v170
  v_mfma_f32_32x32x16_bf16 v[128:143], a[220:223], a[156:159], v[128:143]
  ds_read_b64_tr_b16 a[236:237], v27 offset:32768
  s_add_u32 s22, s22, 8388608
  s_add_u32 s12, s96, s22
  s_addc_u32 s13, s97, 0
  v_cvt_pk_bf16_f32 v228, v168, v169
  v_exp_f32 v171, v171
  v_mfma_f32_32x32x16_bf16 v[144:159], a[220:223], a[188:191], v[144:159]
  ds_read_b64_tr_b16 a[238:239], v27 offset:34816
  s_and_b32 s13, s13, 0xffff
  s_mov_b32 s14, 262144
  v_exp_f32 v172, v172
  v_cvt_pk_bf16_f32 v229, v170, v171
  s_nop 0
  s_nop 0
  s_waitcnt lgkmcnt(4)
  v_mfma_f32_32x32x16_bf16 a[0:15], a[224:227], v[224:227], a[0:15]
  ds_read_b64_tr_b16 a[240:241], v24 offset:36864
  s_mov_b32 s15, 0x00020000
  v_and_b32 v60, 15, v2
  v_exp_f32 v173, v173
  v_mfma_f32_32x32x16_bf16 a[16:31], a[224:227], v[232:235], a[16:31]
  ds_read_b64_tr_b16 a[242:243], v24 offset:38912
  v_exp_f32 v174, v174
  v_cvt_pk_bf16_f32 v230, v172, v173
  v_exp_f32 v175, v175
  v_mfma_f32_32x32x16_bf16 a[32:47], a[228:231], v[224:227], a[32:47]
  ds_read_b64_tr_b16 a[244:245], v25 offset:36864
  v_lshlrev_b32 v60, 5, v60
  s_lshr_b32 s21, s41, 1
  v_exp_f32 v184, v184
  v_cvt_pk_bf16_f32 v231, v174, v175
  v_mfma_f32_32x32x16_bf16 a[48:63], a[228:231], v[232:235], a[48:63]
  ds_read_b64_tr_b16 a[246:247], v25 offset:38912
  s_lshl_b32 s21, s21, 10
  s_add_u32 s21, s21, 8192
  v_exp_f32 v185, v185
  v_add_f32 v28, v28, v165
  s_waitcnt lgkmcnt(4)
  v_mfma_f32_32x32x16_bf16 a[64:79], a[232:235], v[224:227], a[64:79]
  ds_read_b64_tr_b16 a[248:249], v26 offset:36864
  v_add_u32 v60, s21, v60
  v_exp_f32 v186, v186
  v_cvt_pk_bf16_f32 v236, v184, v185
  v_mfma_f32_32x32x16_bf16 a[80:95], a[232:235], v[232:235], a[80:95]
  ds_read_b64_tr_b16 a[250:251], v26 offset:38912
  v_exp_f32 v187, v187
  v_exp_f32 v188, v188
  v_cvt_pk_bf16_f32 v237, v186, v187
  v_mfma_f32_32x32x16_bf16 a[96:111], a[236:239], v[224:227], a[96:111]
  ds_read_b64_tr_b16 a[252:253], v27 offset:36864
  v_exp_f32 v189, v189
  v_exp_f32 v190, v190
  v_cvt_pk_bf16_f32 v238, v188, v189
  v_mfma_f32_32x32x16_bf16 a[112:127], a[236:239], v[232:235], a[112:127]
  ds_read_b64_tr_b16 a[254:255], v27 offset:38912
  v_exp_f32 v191, v191
  v_add_f32 v28, v28, v166
  v_cvt_pk_bf16_f32 v239, v190, v191
  v_add_f32 v28, v28, v167
  v_add_f32 v29, v29, v176
  s_waitcnt lgkmcnt(4)
  v_mfma_f32_32x32x16_bf16 a[0:15], a[240:243], v[228:231], a[0:15]
  s_waitcnt vmcnt(4)
  s_barrier
  ds_read_b128 a[192:195], v16 offset:49152
  v_add_f32 v29, v29, v177
  v_add_f32 v29, v29, v178
  s_add_u32 m0, s19, 81920
  v_mfma_f32_32x32x16_bf16 a[16:31], a[240:243], v[236:239], a[16:31]
  v_add_f32 v29, v29, v179
  v_add_f32 v29, v29, v180
  v_add_f32 v29, v29, v181
  buffer_load_dwordx4 v12, s[28:31], s43 offen offset:0 lds
  v_mfma_f32_32x32x16_bf16 a[32:47], a[244:247], v[228:231], a[32:47]
  ds_read_b128 a[196:199], v17 offset:49152
  v_max3_f32 v30, v128, v129, v130
  v_add_f32 v29, v29, v182
  buffer_load_dwordx4 v13, s[28:31], s43 offen offset:1024 lds
  v_mfma_f32_32x32x16_bf16 a[48:63], a[244:247], v[236:239], a[48:63]
  v_max3_f32 v31, v144, v145, v146
  v_add_f32 v29, v29, v183
  v_max3_f32 v30, v30, v131, v132
  buffer_load_dwordx4 v14, s[28:31], s43 offen offset:2048 lds
  s_waitcnt lgkmcnt(2)
  v_mfma_f32_32x32x16_bf16 a[64:79], a[248:251], v[228:231], a[64:79]
  ds_read_b128 a[200:203], v18 offset:49152
  v_add_f32 v28, v28, v168
  buffer_load_dwordx4 v15, s[28:31], s43 offen offset:3072 lds
  s_add_u32 s43, s43, 8192
  v_mfma_f32_32x32x16_bf16 a[80:95], a[248:251], v[236:239], a[80:95]
  v_max3_f32 v31, v31, v147, v148
  v_add_f32 v28, v28, v169
  v_max3_f32 v30, v30, v133, v134
  v_add_f32 v28, v28, v170
  v_max3_f32 v31, v31, v149, v150
  v_add_f32 v28, v28, v171
  v_mfma_f32_32x32x16_bf16 a[96:111], a[252:255], v[228:231], a[96:111]
  ds_read_b128 a[204:207], v19 offset:49152
  v_max3_f32 v30, v30, v135, v136
  v_add_f32 v28, v28, v172
  v_max3_f32 v31, v31, v151, v152
  v_add_f32 v28, v28, v173
  v_max3_f32 v30, v30, v137, v138
  v_mfma_f32_32x32x16_bf16 a[112:127], a[252:255], v[236:239], a[112:127]
  v_add_f32 v28, v28, v174
  v_max3_f32 v31, v31, v153, v154
  v_add_f32 v28, v28, v175
  v_max3_f32 v30, v30, v139, v140
  v_add_f32 v29, v29, v184
  v_max3_f32 v31, v31, v155, v156
  v_add_f32 v29, v29, v185
  v_max3_f32 v30, v30, v141, v142
  v_add_f32 v29, v29, v186
  v_max3_f32 v31, v31, v157, v158
  v_add_f32 v29, v29, v187
  v_max_f32 v30, v30, v143
  v_add_f32 v29, v29, v188
  v_max_f32 v31, v31, v159
  v_add_f32 v29, v29, v189
  v_max_f32 v32, v30, v31
  v_add_f32 v29, v29, v190
  v_cmp_lt_f32 vcc, s50, v32
  v_add_f32 v29, v29, v191
  s_cbranch_vccz L_mk5_norescale_14
  s_call_b64 s[48:49], L_q_rescale0
L_mk5_norescale_14:
  s_waitcnt lgkmcnt(2)
  v_mfma_f32_32x32x16_bf16 v[160:175], a[192:195], a[128:131], v[192:207]
  ds_read_b128 a[208:211], v20 offset:49152
  v_exp_f32 v128, v128
  v_exp_f32 v129, v129
  v_mfma_f32_32x32x16_bf16 v[176:191], a[192:195], a[160:163], v[208:223]
  v_exp_f32 v130, v130
  v_cvt_pk_bf16_f32 v224, v128, v129
  v_exp_f32 v131, v131
  v_mfma_f32_32x32x16_bf16 v[160:175], a[196:199], a[132:135], v[160:175]
  ds_read_b128 a[212:215], v21 offset:49152
  buffer_load_dword v52, v60, s[52:55], 0 offen sc1
  v_exp_f32 v132, v132
  v_cvt_pk_bf16_f32 v225, v130, v131
  v_add_f32 v28, v28, v128
  v_mfma_f32_32x32x16_bf16 v[176:191], a[196:199], a[164:167], v[176:191]
  v_exp_f32 v133, v133
  v_exp_f32 v134, v134
  v_cvt_pk_bf16_f32 v226, v132, v133
  v_add_f32 v28, v28, v129
  s_waitcnt lgkmcnt(2)
  v_mfma_f32_32x32x16_bf16 v[160:175], a[200:203], a[136:139], v[160:175]
  ds_read_b128 a[216:219], v22 offset:49152
  v_exp_f32 v135, v135
  v_exp_f32 v144, v144
  v_mfma_f32_32x32x16_bf16 v[176:191], a[200:203], a[168:171], v[176:191]
  v_cvt_pk_bf16_f32 v227, v134, v135
  v_exp_f32 v145, v145
  v_exp_f32 v146, v146
  v_cvt_pk_bf16_f32 v232, v144, v145
  v_mfma_f32_32x32x16_bf16 v[160:175], a[204:207], a[140:143], v[160:175]
  ds_read_b128 a[220:223], v23 offset:49152
  v_exp_f32 v147, v147
  v_exp_f32 v148, v148
  v_cvt_pk_bf16_f32 v233, v146, v147
  v_mfma_f32_32x32x16_bf16 v[176:191], a[204:207], a[172:175], v[176:191]
  v_exp_f32 v149, v149
  v_exp_f32 v150, v150
  v_cvt_pk_bf16_f32 v234, v148, v149
  v_add_f32 v28, v28, v130
  s_waitcnt lgkmcnt(2)
  v_mfma_f32_32x32x16_bf16 v[160:175], a[208:211], a[144:147], v[160:175]
  ds_read_b64_tr_b16 a[224:225], v24 offset:49152
  v_exp_f32 v151, v151
  v_exp_f32 v136, v136
  v_mfma_f32_32x32x16_bf16 v[176:191], a[208:211], a[176:179], v[176:191]
  ds_read_b64_tr_b16 a[226:227], v24 offset:51200
  v_cvt_pk_bf16_f32 v235, v150, v151
  v_exp_f32 v137, v137
  v_exp_f32 v138, v138
  v_mfma_f32_32x32x16_bf16 v[160:175], a[212:215], a[148:151], v[160:175]
  ds_read_b64_tr_b16 a[228:229], v25 offset:49152
  v_cvt_pk_bf16_f32 v228, v136, v137
  v_exp_f32 v139, v139
  v_exp_f32 v140, v140
  v_mfma_f32_32x32x16_bf16 v[176:191], a[212:215], a[180:183], v[176:191]
  ds_read_b64_tr_b16 a[230:231], v25 offset:51200
  v_cvt_pk_bf16_f32 v229, v138, v139
  v_exp_f32 v141, v141
  v_exp_f32 v142, v142
  s_waitcnt lgkmcnt(4)
  v_mfma_f32_32x32x16_bf16 v[160:175], a[216:219], a[152:155], v[160:175]
  ds_read_b64_tr_b16 a[232:233], v26 offset:49152
  v_cvt_pk_bf16_f32 v230, v140, v141
  v_exp_f32 v143, v143
  v_add_f32 v28, v28, v131
  v_mfma_f32_32x32x16_bf16 v[176:191], a[216:219], a[184:187], v[176:191]
  ds_read_b64_tr_b16 a[234:235], v26 offset:51200
  v_exp_f32 v152, v152
  v_cvt_pk_bf16_f32 v231, v142, v143
  v_exp_f32 v153, v153
  v_mfma_f32_32x32x16_bf16 v[160:175], a[220:223], a[156:159], v[160:175]
  ds_read_b64_tr_b16 a[236:237], v27 offset:49152
  v_exp_f32 v154, v154
  v_cvt_pk_bf16_f32 v236, v152, v153
  v_exp_f32 v155, v155
  v_mfma_f32_32x32x16_bf16 v[176:191], a[220:223], a[188:191], v[176:191]
  ds_read_b64_tr_b16 a[238:239], v27 offset:51200
  v_exp_f32 v156, v156
  v_cvt_pk_bf16_f32 v237, v154, v155
  v_exp_f32 v157, v157
  s_nop 0
  s_waitcnt lgkmcnt(4)
  v_mfma_f32_32x32x16_bf16 a[0:15], a[224:227], v[224:227], a[0:15]
  ds_read_b64_tr_b16 a[240:241], v24 offset:53248
  v_exp_f32 v158, v158
  v_cvt_pk_bf16_f32 v238, v156, v157
  v_add_f32 v28, v28, v132
  v_mfma_f32_32x32x16_bf16 a[16:31], a[224:227], v[232:235], a[16:31]
  ds_read_b64_tr_b16 a[242:243], v24 offset:55296
  v_exp_f32 v159, v159
  v_add_f32 v28, v28, v133
  v_add_f32 v28, v28, v134
  v_add_f32 v28, v28, v135
  v_mfma_f32_32x32x16_bf16 a[32:47], a[228:231], v[224:227], a[32:47]
  ds_read_b64_tr_b16 a[244:245], v25 offset:53248
  v_cvt_pk_bf16_f32 v239, v158, v159
  v_add_f32 v29, v29, v144
  v_add_f32 v29, v29, v145
  v_add_f32 v29, v29, v146
  v_add_f32 v29, v29, v147
  v_mfma_f32_32x32x16_bf16 a[48:63], a[228:231], v[232:235], a[48:63]
  ds_read_b64_tr_b16 a[246:247], v25 offset:55296
  v_add_f32 v29, v29, v148
  v_add_f32 v29, v29, v149
  v_max3_f32 v30, v160, v161, v162
  v_add_f32 v29, v29, v150
  v_max3_f32 v31, v176, v177, v178
  s_waitcnt lgkmcnt(4)
  v_mfma_f32_32x32x16_bf16 a[64:79], a[232:235], v[224:227], a[64:79]
  ds_read_b64_tr_b16 a[248:249], v26 offset:53248
  v_add_f32 v29, v29, v151
  v_max3_f32 v30, v30, v163, v164
  v_add_f32 v28, v28, v136
  v_max3_f32 v31, v31, v179, v180
  v_mfma_f32_32x32x16_bf16 a[80:95], a[232:235], v[232:235], a[80:95]
  ds_read_b64_tr_b16 a[250:251], v26 offset:55296
  v_add_f32 v28, v28, v137
  v_max3_f32 v30, v30, v165, v166
  v_add_f32 v28, v28, v138
  v_max3_f32 v31, v31, v181, v182
  v_add_f32 v28, v28, v139
  v_mfma_f32_32x32x16_bf16 a[96:111], a[236:239], v[224:227], a[96:111]
  ds_read_b64_tr_b16 a[252:253], v27 offset:53248
  v_max3_f32 v30, v30, v167, v168
  v_add_f32 v28, v28, v140
  v_max3_f32 v31, v31, v183, v184
  v_add_f32 v28, v28, v141
  v_max3_f32 v30, v30, v169, v170
  v_mfma_f32_32x32x16_bf16 a[112:127], a[236:239], v[232:235], a[112:127]
  ds_read_b64_tr_b16 a[254:255], v27 offset:55296
  v_add_f32 v28, v28, v142
  v_max3_f32 v31, v31, v185, v186
  v_add_f32 v28, v28, v143
  v_max3_f32 v30, v30, v171, v172
  v_add_f32 v29, v29, v152
  s_waitcnt lgkmcnt(4)
  v_mfma_f32_32x32x16_bf16 a[0:15], a[240:243], v[228:231], a[0:15]
  s_waitcnt vmcnt(5)
  s_barrier
  ds_read_b128 a[192:195], v16 offset:0
  v_max3_f32 v31, v31, v187, v188
  v_add_f32 v29, v29, v153
  s_add_u32 m0, s19, 98304
  v_mfma_f32_32x32x16_bf16 a[16:31], a[240:243], v[236:239], a[16:31]
  v_max3_f32 v30, v30, v173, v174
  v_add_f32 v29, v29, v154
  v_max3_f32 v31, v31, v189, v190
  buffer_load_dwordx4 v12, s[28:31], s43 offen offset:0 lds
  v_mfma_f32_32x32x16_bf16 a[32:47], a[244:247], v[228:231], a[32:47]
  ds_read_b128 a[196:199], v17 offset:0
  v_add_f32 v29, v29, v155
  v_max_f32 v30, v30, v175
  buffer_load_dwordx4 v13, s[28:31], s43 offen offset:1024 lds
  v_mfma_f32_32x32x16_bf16 a[48:63], a[244:247], v[236:239], a[48:63]
  v_add_f32 v29, v29, v156
  v_max_f32 v31, v31, v191
  v_add_f32 v29, v29, v157
  buffer_load_dwordx4 v14, s[28:31], s43 offen offset:2048 lds
  s_waitcnt lgkmcnt(2)
  v_mfma_f32_32x32x16_bf16 a[64:79], a[248:251], v[228:231], a[64:79]
  ds_read_b128 a[200:203], v18 offset:0
  v_add_f32 v29, v29, v158
  buffer_load_dwordx4 v15, s[28:31], s43 offen offset:3072 lds
  s_add_u32 s43, s43, 8192
  v_mfma_f32_32x32x16_bf16 a[80:95], a[248:251], v[236:239], a[80:95]
  v_add_f32 v29, v29, v159
  v_mfma_f32_32x32x16_bf16 a[96:111], a[252:255], v[228:231], a[96:111]
  ds_read_b128 a[204:207], v19 offset:0
  v_mfma_f32_32x32x16_bf16 a[112:127], a[252:255], v[236:239], a[112:127]
  v_max_f32 v32, v30, v31
  v_cmp_lt_f32 vcc, s50, v32
  s_cbranch_vccz L_mk5_norescale_15
  s_call_b64 s[48:49], L_q_rescale1
L_mk5_norescale_15:
  s_waitcnt lgkmcnt(2)
  v_mfma_f32_32x32x16_bf16 v[128:143], a[192:195], a[128:131], v[192:207]
  ds_read_b128 a[208:211], v20 offset:0
  v_exp_f32 v160, v160
  v_exp_f32 v161, v161
  v_mfma_f32_32x32x16_bf16 v[144:159], a[192:195], a[160:163], v[208:223]
  v_exp_f32 v162, v162
  v_cvt_pk_bf16_f32 v224, v160, v161
  v_exp_f32 v163, v163
  v_mfma_f32_32x32x16_bf16 v[128:143], a[196:199], a[132:135], v[128:143]
  ds_read_b128 a[212:215], v21 offset:0
  s_add_u32 m0, s19, 0
  v_exp_f32 v164, v164
  v_cvt_pk_bf16_f32 v225, v162, v163
  v_add_f32 v28, v28, v160
  v_mfma_f32_32x32x16_bf16 v[144:159], a[196:199], a[164:167], v[144:159]
  v_exp_f32 v165, v165
  v_exp_f32 v166, v166
  v_cvt_pk_bf16_f32 v226, v164, v165
  v_add_f32 v28, v28, v161
  s_waitcnt lgkmcnt(2)
  v_mfma_f32_32x32x16_bf16 v[128:143], a[200:203], a[136:139], v[128:143]
  ds_read_b128 a[216:219], v22 offset:0
  buffer_load_dwordx4 v4, s[8:11], s17 offen offset:0 lds
  v_add_f32 v28, v28, v162
  v_mfma_f32_32x32x16_bf16 v[144:159], a[200:203], a[168:171], v[144:159]
  v_exp_f32 v167, v167
  v_exp_f32 v176, v176
  v_cvt_pk_bf16_f32 v227, v166, v167
  v_add_f32 v28, v28, v163
  v_mfma_f32_32x32x16_bf16 v[128:143], a[204:207], a[140:143], v[128:143]
  ds_read_b128 a[220:223], v23 offset:0
  buffer_load_dwordx4 v5, s[8:11], s17 offen offset:1024 lds
  v_exp_f32 v177, v177
  v_mfma_f32_32x32x16_bf16 v[144:159], a[204:207], a[172:175], v[144:159]
  v_exp_f32 v178, v178
  v_cvt_pk_bf16_f32 v232, v176, v177
  v_exp_f32 v179, v179
  v_add_f32 v28, v28, v164
  s_waitcnt lgkmcnt(2)
  v_mfma_f32_32x32x16_bf16 v[128:143], a[208:211], a[144:147], v[128:143]
  ds_read_b64_tr_b16 a[224:225], v24 offset:0
  buffer_load_dwordx4 v6, s[8:11], s17 offen offset:2048 lds
  v_add_f32 v28, v28, v165
  v_mfma_f32_32x32x16_bf16 v[144:159], a[208:211], a[176:179], v[144:159]
  ds_read_b64_tr_b16 a[226:227], v24 offset:2048
  v_exp_f32 v180, v180
  v_cvt_pk_bf16_f32 v233, v178, v179
  v_exp_f32 v181, v181
  v_mfma_f32_32x32x16_bf16 v[128:143], a[212:215], a[148:151], v[128:143]
  ds_read_b64_tr_b16 a[228:229], v25 offset:0
  buffer_load_dwordx4 v7, s[8:11], s17 offen offset:3072 lds
  s_add_u32 s17, s17, 131072
  v_add_f32 v28, v28, v166
  v_mfma_f32_32x32x16_bf16 v[144:159], a[212:215], a[180:183], v[144:159]
  ds_read_b64_tr_b16 a[230:231], v25 offset:2048
  v_exp_f32 v182, v182
  v_cvt_pk_bf16_f32 v234, v180, v181
  v_exp_f32 v183, v183
  s_waitcnt lgkmcnt(4)
  v_mfma_f32_32x32x16_bf16 v[128:143], a[216:219], a[152:155], v[128:143]
  ds_read_b64_tr_b16 a[232:233], v26 offset:0
  s_add_u32 m0, s19, 16384
  v_exp_f32 v168, v168
  v_cvt_pk_bf16_f32 v235, v182, v183
  v_mfma_f32_32x32x16_bf16 v[144:159], a[216:219], a[184:187], v[144:159]
  ds_read_b64_tr_b16 a[234:235], v26 offset:2048
  v_exp_f32 v169, v169
  v_exp_f32 v170, v170
  v_cvt_pk_bf16_f32 v228, v168, v169
  v_mfma_f32_32x32x16_bf16 v[128:143], a[220:223], a[156:159], v[128:143]
  ds_read_b64_tr_b16 a[236:237], v27 offset:0
  buffer_load_dwordx4 v4, s[8:11], s17 offen offset:0 lds
  v_exp_f32 v171, v171
  v_mfma_f32_32x32x16_bf16 v[144:159], a[220:223], a[188:191], v[144:159]
  ds_read_b64_tr_b16 a[238:239], v27 offset:2048
  v_exp_f32 v172, v172
  v_cvt_pk_bf16_f32 v229, v170, v171
  v_exp_f32 v173, v173
  s_nop 0
  s_waitcnt lgkmcnt(4)
  v_mfma_f32_32x32x16_bf16 a[0:15], a[224:227], v[224:227], a[0:15]
  ds_read_b64_tr_b16 a[240:241], v24 offset:4096
  buffer_load_dwordx4 v5, s[8:11], s17 offen offset:1024 lds
  v_add_f32 v28, v28, v167
  v_mfma_f32_32x32x16_bf16 a[16:31], a[224:227], v[232:235], a[16:31]
  ds_read_b64_tr_b16 a[242:243], v24 offset:6144
  v_exp_f32 v174, v174
  v_cvt_pk_bf16_f32 v230, v172, v173
  v_exp_f32 v175, v175
  v_mfma_f32_32x32x16_bf16 a[32:47], a[228:231], v[224:227], a[32:47]
  ds_read_b64_tr_b16 a[244:245], v25 offset:4096
  buffer_load_dwordx4 v6, s[8:11], s17 offen offset:2048 lds
  v_exp_f32 v184, v184
  v_mfma_f32_32x32x16_bf16 a[48:63], a[228:231], v[232:235], a[48:63]
  ds_read_b64_tr_b16 a[246:247], v25 offset:6144
  v_cvt_pk_bf16_f32 v231, v174, v175
  v_exp_f32 v185, v185
  v_exp_f32 v186, v186
  s_waitcnt lgkmcnt(4)
  v_mfma_f32_32x32x16_bf16 a[64:79], a[232:235], v[224:227], a[64:79]
  ds_read_b64_tr_b16 a[248:249], v26 offset:4096
  buffer_load_dwordx4 v7, s[8:11], s17 offen offset:3072 lds
  s_add_u32 s17, s17, 131072
  v_mfma_f32_32x32x16_bf16 a[80:95], a[232:235], v[232:235], a[80:95]
  ds_read_b64_tr_b16 a[250:251], v26 offset:6144
  v_cvt_pk_bf16_f32 v236, v184, v185
  v_exp_f32 v187, v187
  v_exp_f32 v188, v188
  v_mfma_f32_32x32x16_bf16 a[96:111], a[236:239], v[224:227], a[96:111]
  ds_read_b64_tr_b16 a[252:253], v27 offset:4096
  v_cvt_pk_bf16_f32 v237, v186, v187
  v_exp_f32 v189, v189
  v_exp_f32 v190, v190
  v_mfma_f32_32x32x16_bf16 a[112:127], a[236:239], v[232:235], a[112:127]
  ds_read_b64_tr_b16 a[254:255], v27 offset:6144
  v_cvt_pk_bf16_f32 v238, v188, v189
  v_exp_f32 v191, v191
  v_add_f32 v29, v29, v176
  v_cvt_pk_bf16_f32 v239, v190, v191
  v_add_f32 v29, v29, v177
  s_nop 0
  s_waitcnt lgkmcnt(4)
  v_mfma_f32_32x32x16_bf16 a[0:15], a[240:243], v[228:231], a[0:15]
  s_waitcnt vmcnt(13)
  s_barrier
  ds_read_b128 a[192:195], v16 offset:16384
  v_add_f32 v29, v29, v178
  v_add_f32 v29, v29, v179
  s_add_u32 m0, s19, 114688
  v_mfma_f32_32x32x16_bf16 a[16:31], a[240:243], v[236:239], a[16:31]
  v_add_f32 v29, v29, v180
  v_add_f32 v29, v29, v181
  v_max3_f32 v30, v128, v129, v130
  buffer_load_dwordx4 v12, s[28:31], s43 offen offset:0 lds
  v_mfma_f32_32x32x16_bf16 a[32:47], a[244:247], v[228:231], a[32:47]
  ds_read_b128 a[196:199], v17 offset:16384
  v_add_f32 v29, v29, v182
  v_max3_f32 v31, v144, v145, v146
  buffer_load_dwordx4 v13, s[28:31], s43 offen offset:1024 lds
  v_mfma_f32_32x32x16_bf16 a[48:63], a[244:247], v[236:239], a[48:63]
  v_add_f32 v29, v29, v183
  v_max3_f32 v30, v30, v131, v132
  v_add_f32 v28, v28, v168
  buffer_load_dwordx4 v14, s[28:31], s43 offen offset:2048 lds
  s_waitcnt lgkmcnt(2)
  v_mfma_f32_32x32x16_bf16 a[64:79], a[248:251], v[228:231], a[64:79]
  ds_read_b128 a[200:203], v18 offset:16384
  v_max3_f32 v31, v31, v147, v148
  buffer_load_dwordx4 v15, s[28:31], s43 offen offset:3072 lds
  s_add_u32 s43, s43, 8192
  v_mfma_f32_32x32x16_bf16 a[80:95], a[248:251], v[236:239], a[80:95]
  v_add_f32 v28, v28, v169
  v_max3_f32 v30, v30, v133, v134
  v_add_f32 v28, v28, v170
  v_max3_f32 v31, v31, v149, v150
  v_add_f32 v28, v28, v171
  v_max3_f32 v30, v30, v135, v136
  v_mfma_f32_32x32x16_bf16 a[96:111], a[252:255], v[228:231], a[96:111]
  ds_read_b128 a[204:207], v19 offset:16384
  v_add_f32 v28, v28, v172
  v_max3_f32 v31, v31, v151, v152
  v_add_f32 v28, v28, v173
  v_max3_f32 v30, v30, v137, v138
  v_add_f32 v28, v28, v174
  v_mfma_f32_32x32x16_bf16 a[112:127], a[252:255], v[236:239], a[112:127]
  v_max3_f32 v31, v31, v153, v154
  v_add_f32 v28, v28, v175
  v_max3_f32 v30, v30, v139, v140
  v_add_f32 v29, v29, v184
  v_max3_f32 v31, v31, v155, v156
  v_add_f32 v29, v29, v185
  v_max3_f32 v30, v30, v141, v142
  v_add_f32 v29, v29, v186
  v_max3_f32 v31, v31, v157, v158
  v_add_f32 v29, v29, v187
  v_max_f32 v30, v30, v143
  v_add_f32 v29, v29, v188
  v_max_f32 v31, v31, v159
  v_add_f32 v29, v29, v189
  v_max_f32 v32, v30, v31
  v_add_f32 v29, v29, v190
  v_cmp_lt_f32 vcc, s50, v32
  v_add_f32 v29, v29, v191
  s_cbranch_vccz L_mk5_norescale_16
  s_call_b64 s[48:49], L_q_rescale0
L_mk5_norescale_16:
  s_waitcnt lgkmcnt(2)
  v_mfma_f32_32x32x16_bf16 v[160:175], a[192:195], a[128:131], v[192:207]
  ds_read_b128 a[208:211], v20 offset:16384
  v_exp_f32 v128, v128
  v_exp_f32 v129, v129
  v_mfma_f32_32x32x16_bf16 v[176:191], a[192:195], a[160:163], v[208:223]
  v_exp_f32 v130, v130
  v_cvt_pk_bf16_f32 v224, v128, v129
  v_exp_f32 v131, v131
  v_mfma_f32_32x32x16_bf16 v[160:175], a[196:199], a[132:135], v[160:175]
  ds_read_b128 a[212:215], v21 offset:16384
  s_add_u32 m0, s19, 32768
  v_exp_f32 v132, v132
  v_cvt_pk_bf16_f32 v225, v130, v131
  v_add_f32 v28, v28, v128
  v_mfma_f32_32x32x16_bf16 v[176:191], a[196:199], a[164:167], v[176:191]
  v_exp_f32 v133, v133
  v_exp_f32 v134, v134
  v_cvt_pk_bf16_f32 v226, v132, v133
  v_add_f32 v28, v28, v129
  s_waitcnt lgkmcnt(2)
  v_mfma_f32_32x32x16_bf16 v[160:175], a[200:203], a[136:139], v[160:175]
  ds_read_b128 a[216:219], v22 offset:16384
  buffer_load_dwordx4 v4, s[8:11], s17 offen offset:0 lds
  v_add_f32 v28, v28, v130
  v_mfma_f32_32x32x16_bf16 v[176:191], a[200:203], a[168:171], v[176:191]
  v_exp_f32 v135, v135
  v_exp_f32 v144, v144
  v_cvt_pk_bf16_f32 v227, v134, v135
  v_add_f32 v28, v28, v131
  v_mfma_f32_32x32x16_bf16 v[160:175], a[204:207], a[140:143], v[160:175]
  ds_read_b128 a[220:223], v23 offset:16384
  buffer_load_dwordx4 v5, s[8:11], s17 offen offset:1024 lds
  v_exp_f32 v145, v145
  v_mfma_f32_32x32x16_bf16 v[176:191], a[204:207], a[172:175], v[176:191]
  v_exp_f32 v146, v146
  v_cvt_pk_bf16_f32 v232, v144, v145
  v_exp_f32 v147, v147
  v_add_f32 v28, v28, v132
  s_waitcnt lgkmcnt(2)
  v_mfma_f32_32x32x16_bf16 v[160:175], a[208:211], a[144:147], v[160:175]
  ds_read_b64_tr_b16 a[224:225], v24 offset:16384
  buffer_load_dwordx4 v6, s[8:11], s17 offen offset:2048 lds
  v_add_f32 v28, v28, v133
  v_mfma_f32_32x32x16_bf16 v[176:191], a[208:211], a[176:179], v[176:191]
  ds_read_b64_tr_b16 a[226:227], v24 offset:18432
  v_exp_f32 v148, v148
  v_cvt_pk_bf16_f32 v233, v146, v147
  v_exp_f32 v149, v149
  v_mfma_f32_32x32x16_bf16 v[160:175], a[212:215], a[148:151], v[160:175]
  ds_read_b64_tr_b16 a[228:229], v25 offset:16384
  buffer_load_dwordx4 v7, s[8:11], s17 offen offset:3072 lds
  s_add_u32 s17, s17, 131072
  v_add_f32 v28, v28, v134
  v_mfma_f32_32x32x16_bf16 v[176:191], a[212:215], a[180:183], v[176:191]
  ds_read_b64_tr_b16 a[230:231], v25 offset:18432
  v_exp_f32 v150, v150
  v_cvt_pk_bf16_f32 v234, v148, v149
  v_exp_f32 v151, v151
  s_waitcnt lgkmcnt(4)
  v_mfma_f32_32x32x16_bf16 v[160:175], a[216:219], a[152:155], v[160:175]
  ds_read_b64_tr_b16 a[232:233], v26 offset:16384
  s_add_u32 m0, s19, 49152
  v_exp_f32 v136, v136
  v_cvt_pk_bf16_f32 v235, v150, v151
  v_mfma_f32_32x32x16_bf16 v[176:191], a[216:219], a[184:187], v[176:191]
  ds_read_b64_tr_b16 a[234:235], v26 offset:18432
  v_exp_f32 v137, v137
  v_exp_f32 v138, v138
  v_cvt_pk_bf16_f32 v228, v136, v137
  v_mfma_f32_32x32x16_bf16 v[160:175], a[220:223], a[156:159], v[160:175]
  ds_read_b64_tr_b16 a[236:237], v27 offset:16384
  buffer_load_dwordx4 v4, s[8:11], s17 offen offset:0 lds
  v_exp_f32 v139, v139
  v_mfma_f32_32x32x16_bf16 v[176:191], a[220:223], a[188:191], v[176:191]
  ds_read_b64_tr_b16 a[238:239], v27 offset:18432
  v_exp_f32 v140, v140
  v_cvt_pk_bf16_f32 v229, v138, v139
  v_exp_f32 v141, v141
  s_nop 0
  s_waitcnt lgkmcnt(4)
  v_mfma_f32_32x32x16_bf16 a[0:15], a[224:227], v[224:227], a[0:15]
  ds_read_b64_tr_b16 a[240:241], v24 offset:20480
  buffer_load_dwordx4 v5, s[8:11], s17 offen offset:1024 lds
  v_add_f32 v28, v28, v135
  v_mfma_f32_32x32x16_bf16 a[16:31], a[224:227], v[232:235], a[16:31]
  ds_read_b64_tr_b16 a[242:243], v24 offset:22528
  v_exp_f32 v142, v142
  v_cvt_pk_bf16_f32 v230, v140, v141
  v_exp_f32 v143, v143
  v_mfma_f32_32x32x16_bf16 a[32:47], a[228:231], v[224:227], a[32:47]
  ds_read_b64_tr_b16 a[244:245], v25 offset:20480
  buffer_load_dwordx4 v6, s[8:11], s17 offen offset:2048 lds
  v_exp_f32 v152, v152
  v_mfma_f32_32x32x16_bf16 a[48:63], a[228:231], v[232:235], a[48:63]
  ds_read_b64_tr_b16 a[246:247], v25 offset:22528
  v_cvt_pk_bf16_f32 v231, v142, v143
  v_exp_f32 v153, v153
  v_exp_f32 v154, v154
  s_waitcnt lgkmcnt(4)
  v_mfma_f32_32x32x16_bf16 a[64:79], a[232:235], v[224:227], a[64:79]
  ds_read_b64_tr_b16 a[248:249], v26 offset:20480
  buffer_load_dwordx4 v7, s[8:11], s17 offen offset:3072 lds
  s_add_u32 s17, s17, 131072
  v_mfma_f32_32x32x16_bf16 a[80:95], a[232:235], v[232:235], a[80:95]
  ds_read_b64_tr_b16 a[250:251], v26 offset:22528
  v_cvt_pk_bf16_f32 v236, v152, v153
  v_exp_f32 v155, v155
  v_exp_f32 v156, v156
  v_mfma_f32_32x32x16_bf16 a[96:111], a[236:239], v[224:227], a[96:111]
  ds_read_b64_tr_b16 a[252:253], v27 offset:20480
  v_cvt_pk_bf16_f32 v237, v154, v155
  v_exp_f32 v157, v157
  v_exp_f32 v158, v158
  v_mfma_f32_32x32x16_bf16 a[112:127], a[236:239], v[232:235], a[112:127]
  ds_read_b64_tr_b16 a[254:255], v27 offset:22528
  v_cvt_pk_bf16_f32 v238, v156, v157
  v_exp_f32 v159, v159
  v_add_f32 v29, v29, v144
  v_cvt_pk_bf16_f32 v239, v158, v159
  v_add_f32 v29, v29, v145
  s_nop 0
  s_waitcnt lgkmcnt(4)
  v_mfma_f32_32x32x16_bf16 a[0:15], a[240:243], v[228:231], a[0:15]
  s_waitcnt vmcnt(20)
  s_barrier
  ds_read_b128 a[192:195], v16 offset:32768
  v_add_f32 v29, v29, v146
  v_add_f32 v29, v29, v147
  s_add_u32 m0, s19, 65536
  v_mfma_f32_32x32x16_bf16 a[16:31], a[240:243], v[236:239], a[16:31]
  v_add_f32 v29, v29, v148
  v_add_f32 v29, v29, v149
  v_max3_f32 v30, v160, v161, v162
  buffer_load_dwordx4 v12, s[28:31], s43 offen offset:0 lds
  v_mfma_f32_32x32x16_bf16 a[32:47], a[244:247], v[228:231], a[32:47]
  ds_read_b128 a[196:199], v17 offset:32768
  v_add_f32 v29, v29, v150
  v_max3_f32 v31, v176, v177, v178
  buffer_load_dwordx4 v13, s[28:31], s43 offen offset:1024 lds
  v_mfma_f32_32x32x16_bf16 a[48:63], a[244:247], v[236:239], a[48:63]
  v_add_f32 v29, v29, v151
  v_max3_f32 v30, v30, v163, v164
  v_add_f32 v28, v28, v136
  buffer_load_dwordx4 v14, s[28:31], s43 offen offset:2048 lds
  s_waitcnt lgkmcnt(2)
  v_mfma_f32_32x32x16_bf16 a[64:79], a[248:251], v[228:231], a[64:79]
  ds_read_b128 a[200:203], v18 offset:32768
  v_max3_f32 v31, v31, v179, v180
  buffer_load_dwordx4 v15, s[28:31], s43 offen offset:3072 lds
  s_add_u32 s43, s43, 8192
  v_mfma_f32_32x32x16_bf16 a[80:95], a[248:251], v[236:239], a[80:95]
  v_add_f32 v28, v28, v137
  v_max3_f32 v30, v30, v165, v166
  v_add_f32 v28, v28, v138
  v_max3_f32 v31, v31, v181, v182
  v_add_f32 v28, v28, v139
  v_max3_f32 v30, v30, v167, v168
  v_mfma_f32_32x32x16_bf16 a[96:111], a[252:255], v[228:231], a[96:111]
  ds_read_b128 a[204:207], v19 offset:32768
  v_add_f32 v28, v28, v140
  v_max3_f32 v31, v31, v183, v184
  v_add_f32 v28, v28, v141
  v_max3_f32 v30, v30, v169, v170
  v_add_f32 v28, v28, v142
  v_mfma_f32_32x32x16_bf16 a[112:127], a[252:255], v[236:239], a[112:127]
  v_max3_f32 v31, v31, v185, v186
  v_add_f32 v28, v28, v143
  v_max3_f32 v30, v30, v171, v172
  v_add_f32 v29, v29, v152
  v_max3_f32 v31, v31, v187, v188
  v_add_f32 v29, v29, v153
  v_max3_f32 v30, v30, v173, v174
  v_add_f32 v29, v29, v154
  v_max3_f32 v31, v31, v189, v190
  v_add_f32 v29, v29, v155
  v_max_f32 v30, v30, v175
  v_add_f32 v29, v29, v156
  v_max_f32 v31, v31, v191
  v_add_f32 v29, v29, v157
  v_max_f32 v32, v30, v31
  v_add_f32 v29, v29, v158
  v_cmp_lt_f32 vcc, s50, v32
  v_add_f32 v29, v29, v159
  s_cbranch_vccz L_mk5_norescale_17
  s_call_b64 s[48:49], L_q_rescale1
L_mk5_norescale_17:
  s_waitcnt lgkmcnt(2)
  v_mfma_f32_32x32x16_bf16 v[128:143], a[192:195], a[128:131], v[192:207]
  ds_read_b128 a[208:211], v20 offset:32768
  v_exp_f32 v160, v160
  v_exp_f32 v161, v161
  v_mfma_f32_32x32x16_bf16 v[144:159], a[192:195], a[160:163], v[208:223]
  v_exp_f32 v162, v162
  v_cvt_pk_bf16_f32 v224, v160, v161
  v_exp_f32 v163, v163
  v_mfma_f32_32x32x16_bf16 v[128:143], a[196:199], a[132:135], v[128:143]
  ds_read_b128 a[212:215], v21 offset:32768
  v_exp_f32 v164, v164
  v_cvt_pk_bf16_f32 v225, v162, v163
  v_exp_f32 v165, v165
  v_mfma_f32_32x32x16_bf16 v[144:159], a[196:199], a[164:167], v[144:159]
  v_exp_f32 v166, v166
  v_cvt_pk_bf16_f32 v226, v164, v165
  v_exp_f32 v167, v167
  v_add_f32 v28, v28, v160
  s_waitcnt lgkmcnt(2)
  v_mfma_f32_32x32x16_bf16 v[128:143], a[200:203], a[136:139], v[128:143]
  ds_read_b128 a[216:219], v22 offset:32768
  v_cmp_ne_u32 vcc, s42, v52
  s_cbranch_vccz L_mk5_fok_18
  s_call_b64 s[48:49], L_poll1
L_mk5_fok_18:
  v_exp_f32 v176, v176
  v_cvt_pk_bf16_f32 v227, v166, v167
  v_mfma_f32_32x32x16_bf16 v[144:159], a[200:203], a[168:171], v[144:159]
  v_exp_f32 v177, v177
  v_exp_f32 v178, v178
  v_cvt_pk_bf16_f32 v232, v176, v177
  v_add_f32 v28, v28, v161
  v_mfma_f32_32x32x16_bf16 v[128:143], a[204:207], a[140:143], v[128:143]
  ds_read_b128 a[220:223], v23 offset:32768
  v_exp_f32 v179, v179
  v_exp_f32 v180, v180
  v_cvt_pk_bf16_f32 v233, v178, v179
  v_mfma_f32_32x32x16_bf16 v[144:159], a[204:207], a[172:175], v[144:159]
  v_exp_f32 v181, v181
  v_exp_f32 v182, v182
  v_cvt_pk_bf16_f32 v234, v180, v181
  v_add_f32 v28, v28, v162
  s_waitcnt lgkmcnt(2)
  v_mfma_f32_32x32x16_bf16 v[128:143], a[208:211], a[144:147], v[128:143]
  ds_read_b64_tr_b16 a[224:225], v24 offset:32768
  v_exp_f32 v183, v183
  v_exp_f32 v168, v168
  v_mfma_f32_32x32x16_bf16 v[144:159], a[208:211], a[176:179], v[144:159]
  ds_read_b64_tr_b16 a[226:227], v24 offset:34816
  v_cvt_pk_bf16_f32 v235, v182, v183
  v_exp_f32 v169, v169
  v_exp_f32 v170, v170
  v_mfma_f32_32x32x16_bf16 v[128:143], a[212:215], a[148:151], v[128:143]
  ds_read_b64_tr_b16 a[228:229], v25 offset:32768
  v_cvt_pk_bf16_f32 v228, v168, v169
  v_exp_f32 v171, v171
  v_exp_f32 v172, v172
  v_mfma_f32_32x32x16_bf16 v[144:159], a[212:215], a[180:183], v[144:159]
  ds_read_b64_tr_b16 a[230:231], v25 offset:34816
  v_cvt_pk_bf16_f32 v229, v170, v171
  v_exp_f32 v173, v173
  v_exp_f32 v174, v174
  s_waitcnt lgkmcnt(4)
  v_mfma_f32_32x32x16_bf16 v[128:143], a[216:219], a[152:155], v[128:143]
  ds_read_b64_tr_b16 a[232:233], v26 offset:32768
  v_cvt_pk_bf16_f32 v230, v172, v173
  v_exp_f32 v175, v175
  v_add_f32 v28, v28, v163
  v_mfma_f32_32x32x16_bf16 v[144:159], a[216:219], a[184:187], v[144:159]
  ds_read_b64_tr_b16 a[234:235], v26 offset:34816
  v_exp_f32 v184, v184
  v_cvt_pk_bf16_f32 v231, v174, v175
  v_exp_f32 v185, v185
  v_mfma_f32_32x32x16_bf16 v[128:143], a[220:223], a[156:159], v[128:143]
  ds_read_b64_tr_b16 a[236:237], v27 offset:32768
  v_exp_f32 v186, v186
  v_cvt_pk_bf16_f32 v236, v184, v185
  v_exp_f32 v187, v187
  v_mfma_f32_32x32x16_bf16 v[144:159], a[220:223], a[188:191], v[144:159]
  ds_read_b64_tr_b16 a[238:239], v27 offset:34816
  v_exp_f32 v188, v188
  v_cvt_pk_bf16_f32 v237, v186, v187
  v_exp_f32 v189, v189
  s_nop 0
  s_waitcnt lgkmcnt(4)
  v_mfma_f32_32x32x16_bf16 a[0:15], a[224:227], v[224:227], a[0:15]
  ds_read_b64_tr_b16 a[240:241], v24 offset:36864
  v_exp_f32 v190, v190
  v_cvt_pk_bf16_f32 v238, v188, v189
  v_add_f32 v28, v28, v164
  v_mfma_f32_32x32x16_bf16 a[16:31], a[224:227], v[232:235], a[16:31]
  ds_read_b64_tr_b16 a[242:243], v24 offset:38912
  v_exp_f32 v191, v191
  v_add_f32 v28, v28, v165
  v_add_f32 v28, v28, v166
  v_add_f32 v28, v28, v167
  v_mfma_f32_32x32x16_bf16 a[32:47], a[228:231], v[224:227], a[32:47]
  ds_read_b64_tr_b16 a[244:245], v25 offset:36864
  v_cvt_pk_bf16_f32 v239, v190, v191
  v_add_f32 v29, v29, v176
  v_add_f32 v29, v29, v177
  v_add_f32 v29, v29, v178
  v_add_f32 v29, v29, v179
  v_mfma_f32_32x32x16_bf16 a[48:63], a[228:231], v[232:235], a[48:63]
  ds_read_b64_tr_b16 a[246:247], v25 offset:38912
  v_add_f32 v29, v29, v180
  v_add_f32 v29, v29, v181
  v_max3_f32 v30, v128, v129, v130
  v_add_f32 v29, v29, v182
  v_max3_f32 v31, v144, v145, v146
  s_waitcnt lgkmcnt(4)
  v_mfma_f32_32x32x16_bf16 a[64:79], a[232:235], v[224:227], a[64:79]
  ds_read_b64_tr_b16 a[248:249], v26 offset:36864
  v_add_f32 v29, v29, v183
  v_max3_f32 v30, v30, v131, v132
  v_add_f32 v28, v28, v168
  v_max3_f32 v31, v31, v147, v148
  v_mfma_f32_32x32x16_bf16 a[80:95], a[232:235], v[232:235], a[80:95]
  ds_read_b64_tr_b16 a[250:251], v26 offset:38912
  v_add_f32 v28, v28, v169
  v_max3_f32 v30, v30, v133, v134
  v_add_f32 v28, v28, v170
  v_max3_f32 v31, v31, v149, v150
  v_add_f32 v28, v28, v171
  v_mfma_f32_32x32x16_bf16 a[96:111], a[236:239], v[224:227], a[96:111]
  ds_read_b64_tr_b16 a[252:253], v27 offset:36864
  v_max3_f32 v30, v30, v135, v136
  v_add_f32 v28, v28, v172
  v_max3_f32 v31, v31, v151, v152
  v_add_f32 v28, v28, v173
  v_max3_f32 v30, v30, v137, v138
  v_mfma_f32_32x32x16_bf16 a[112:127], a[236:239], v[232:235], a[112:127]
  ds_read_b64_tr_b16 a[254:255], v27 offset:38912
  v_add_f32 v28, v28, v174
  v_max3_f32 v31, v31, v153, v154
  v_add_f32 v28, v28, v175
  v_max3_f32 v30, v30, v139, v140
  v_add_f32 v29, v29, v184
  s_waitcnt lgkmcnt(4)
  v_mfma_f32_32x32x16_bf16 a[0:15], a[240:243], v[228:231], a[0:15]
  s_waitcnt vmcnt(12)
  s_barrier
  ds_read_b128 a[192:195], v16 offset:49152
  v_max3_f32 v31, v31, v155, v156
  v_add_f32 v29, v29, v185
  v_max3_f32 v30, v30, v141, v142
  v_add_f32 v29, v29, v186
  v_mfma_f32_32x32x16_bf16 a[16:31], a[240:243], v[236:239], a[16:31]
  v_max3_f32 v31, v31, v157, v158
  v_add_f32 v29, v29, v187
  v_max_f32 v30, v30, v143
  v_add_f32 v29, v29, v188
  v_max_f32 v31, v31, v159
  v_add_f32 v29, v29, v189
  v_mfma_f32_32x32x16_bf16 a[32:47], a[244:247], v[228:231], a[32:47]
  ds_read_b128 a[196:199], v17 offset:49152
  v_add_f32 v29, v29, v190
  v_add_f32 v29, v29, v191
  v_mfma_f32_32x32x16_bf16 a[48:63], a[244:247], v[236:239], a[48:63]
  s_waitcnt lgkmcnt(2)
  v_mfma_f32_32x32x16_bf16 a[64:79], a[248:251], v[228:231], a[64:79]
  ds_read_b128 a[200:203], v18 offset:49152
  v_mfma_f32_32x32x16_bf16 a[80:95], a[248:251], v[236:239], a[80:95]
  v_mfma_f32_32x32x16_bf16 a[96:111], a[252:255], v[228:231], a[96:111]
  ds_read_b128 a[204:207], v19 offset:49152
  v_mfma_f32_32x32x16_bf16 a[112:127], a[252:255], v[236:239], a[112:127]
  v_max_f32 v32, v30, v31
  v_cmp_lt_f32 vcc, s50, v32
  s_cbranch_vccz L_mk5_norescale_19
  s_call_b64 s[48:49], L_q_rescale0
L_mk5_norescale_19:
  s_waitcnt lgkmcnt(2)
  v_mfma_f32_32x32x16_bf16 v[160:175], a[192:195], a[128:131], v[192:207]
  ds_read_b128 a[208:211], v20 offset:49152
  v_exp_f32 v128, v128
  v_exp_f32 v129, v129
  v_mfma_f32_32x32x16_bf16 v[176:191], a[192:195], a[160:163], v[208:223]
  v_exp_f32 v130, v130
  v_cvt_pk_bf16_f32 v224, v128, v129
  v_exp_f32 v131, v131
  v_mfma_f32_32x32x16_bf16 v[160:175], a[196:199], a[132:135], v[160:175]
  ds_read_b128 a[212:215], v21 offset:49152
  v_exp_f32 v132, v132
  v_cvt_pk_bf16_f32 v225, v130, v131
  v_exp_f32 v133, v133
  v_mfma_f32_32x32x16_bf16 v[176:191], a[196:199], a[164:167], v[176:191]
  v_exp_f32 v134, v134
  v_cvt_pk_bf16_f32 v226, v132, v133
  v_exp_f32 v135, v135
  v_add_f32 v28, v28, v128
  s_waitcnt lgkmcnt(2)
  v_mfma_f32_32x32x16_bf16 v[160:175], a[200:203], a[136:139], v[160:175]
  ds_read_b128 a[216:219], v22 offset:49152
  v_exp_f32 v144, v144
  v_cvt_pk_bf16_f32 v227, v134, v135
  v_add_f32 v28, v28, v129
  v_mfma_f32_32x32x16_bf16 v[176:191], a[200:203], a[168:171], v[176:191]
  v_exp_f32 v145, v145
  v_exp_f32 v146, v146
  v_cvt_pk_bf16_f32 v232, v144, v145
  v_add_f32 v28, v28, v130
  v_mfma_f32_32x32x16_bf16 v[160:175], a[204:207], a[140:143], v[160:175]
  ds_read_b128 a[220:223], v23 offset:49152
  v_exp_f32 v147, v147
  v_exp_f32 v148, v148
  v_cvt_pk_bf16_f32 v233, v146, v147
  v_mfma_f32_32x32x16_bf16 v[176:191], a[204:207], a[172:175], v[176:191]
  v_exp_f32 v149, v149
  v_exp_f32 v150, v150
  v_cvt_pk_bf16_f32 v234, v148, v149
  v_add_f32 v28, v28, v131
  s_waitcnt lgkmcnt(2)
  v_mfma_f32_32x32x16_bf16 v[160:175], a[208:211], a[144:147], v[160:175]
  ds_read_b64_tr_b16 a[224:225], v24 offset:49152
  v_exp_f32 v151, v151
  v_exp_f32 v136, v136
  v_mfma_f32_32x32x16_bf16 v[176:191], a[208:211], a[176:179], v[176:191]
  ds_read_b64_tr_b16 a[226:227], v24 offset:51200
  v_cvt_pk_bf16_f32 v235, v150, v151
  v_exp_f32 v137, v137
  v_exp_f32 v138, v138
  v_mfma_f32_32x32x16_bf16 v[160:175], a[212:215], a[148:151], v[160:175]
  ds_read_b64_tr_b16 a[228:229], v25 offset:49152
  v_cvt_pk_bf16_f32 v228, v136, v137
  v_exp_f32 v139, v139
  v_exp_f32 v140, v140
  v_mfma_f32_32x32x16_bf16 v[176:191], a[212:215], a[180:183], v[176:191]
  ds_read_b64_tr_b16 a[230:231], v25 offset:51200
  v_cvt_pk_bf16_f32 v229, v138, v139
  v_exp_f32 v141, v141
  v_exp_f32 v142, v142
  s_waitcnt lgkmcnt(4)
  v_mfma_f32_32x32x16_bf16 v[160:175], a[216:219], a[152:155], v[160:175]
  ds_read_b64_tr_b16 a[232:233], v26 offset:49152
  v_cvt_pk_bf16_f32 v230, v140, v141
  v_exp_f32 v143, v143
  v_add_f32 v28, v28, v132
  v_mfma_f32_32x32x16_bf16 v[176:191], a[216:219], a[184:187], v[176:191]
  ds_read_b64_tr_b16 a[234:235], v26 offset:51200
  v_exp_f32 v152, v152
  v_cvt_pk_bf16_f32 v231, v142, v143
  v_exp_f32 v153, v153
  v_mfma_f32_32x32x16_bf16 v[160:175], a[220:223], a[156:159], v[160:175]
  ds_read_b64_tr_b16 a[236:237], v27 offset:49152
  v_exp_f32 v154, v154
  v_cvt_pk_bf16_f32 v236, v152, v153
  v_exp_f32 v155, v155
  v_mfma_f32_32x32x16_bf16 v[176:191], a[220:223], a[188:191], v[176:191]
  ds_read_b64_tr_b16 a[238:239], v27 offset:51200
  v_exp_f32 v156, v156
  v_cvt_pk_bf16_f32 v237, v154, v155
  v_exp_f32 v157, v157
  s_nop 0
  s_waitcnt lgkmcnt(4)
  v_mfma_f32_32x32x16_bf16 a[0:15], a[224:227], v[224:227], a[0:15]
  ds_read_b64_tr_b16 a[240:241], v24 offset:53248
  buffer_load_dwordx4 a[128:131], v3, s[12:15], s18 offen offset:0 sc1
  v_add_f32 v28, v28, v133
  v_mfma_f32_32x32x16_bf16 a[16:31], a[224:227], v[232:235], a[16:31]
  ds_read_b64_tr_b16 a[242:243], v24 offset:55296
  v_exp_f32 v158, v158
  v_cvt_pk_bf16_f32 v238, v156, v157
  v_exp_f32 v159, v159
  v_mfma_f32_32x32x16_bf16 a[32:47], a[228:231], v[224:227], a[32:47]
  ds_read_b64_tr_b16 a[244:245], v25 offset:53248
  buffer_load_dwordx4 a[132:135], v3, s[12:15], s18 offen offset:1024 sc1
  v_cvt_pk_bf16_f32 v239, v158, v159
  v_mfma_f32_32x32x16_bf16 a[48:63], a[228:231], v[232:235], a[48:63]
  ds_read_b64_tr_b16 a[246:247], v25 offset:55296
  v_add_f32 v28, v28, v134
  v_add_f32 v28, v28, v135
  v_add_f32 v29, v29, v144
  v_add_f32 v29, v29, v145
  v_add_f32 v29, v29, v146
  s_waitcnt lgkmcnt(4)
  v_mfma_f32_32x32x16_bf16 a[64:79], a[232:235], v[224:227], a[64:79]
  ds_read_b64_tr_b16 a[248:249], v26 offset:53248
  v_add_f32 v29, v29, v147
  v_add_f32 v29, v29, v148
  v_add_f32 v29, v29, v149
  v_max3_f32 v30, v160, v161, v162
  v_mfma_f32_32x32x16_bf16 a[80:95], a[232:235], v[232:235], a[80:95]
  ds_read_b64_tr_b16 a[250:251], v26 offset:55296
  buffer_load_dwordx4 a[136:139], v3, s[12:15], s18 offen offset:2048 sc1
  v_add_f32 v29, v29, v150
  v_max3_f32 v31, v176, v177, v178
  v_mfma_f32_32x32x16_bf16 a[96:111], a[236:239], v[224:227], a[96:111]
  ds_read_b64_tr_b16 a[252:253], v27 offset:53248
  v_add_f32 v29, v29, v151
  v_max3_f32 v30, v30, v163, v164
  v_add_f32 v28, v28, v136
  v_max3_f32 v31, v31, v179, v180
  v_add_f32 v28, v28, v137
  v_mfma_f32_32x32x16_bf16 a[112:127], a[236:239], v[232:235], a[112:127]
  ds_read_b64_tr_b16 a[254:255], v27 offset:55296
  v_max3_f32 v30, v30, v165, v166
  v_add_f32 v28, v28, v138
  v_max3_f32 v31, v31, v181, v182
  v_add_f32 v28, v28, v139
  v_max3_f32 v30, v30, v167, v168
  s_waitcnt lgkmcnt(4)
  v_mfma_f32_32x32x16_bf16 a[0:15], a[240:243], v[228:231], a[0:15]
  s_waitcnt vmcnt(3)
  s_barrier
  buffer_load_dwordx4 a[140:143], v3, s[12:15], s18 offen offset:3072 sc1
  s_add_u32 s18, s18, 4096
  v_add_f32 v28, v28, v140
  v_mfma_f32_32x32x16_bf16 a[16:31], a[240:243], v[236:239], a[16:31]
  v_max3_f32 v31, v31, v183, v184
  v_add_f32 v28, v28, v141
  v_max3_f32 v30, v30, v169, v170
  v_add_f32 v28, v28, v142
  v_max3_f32 v31, v31, v185, v186
  v_add_f32 v28, v28, v143
  v_mfma_f32_32x32x16_bf16 a[32:47], a[244:247], v[228:231], a[32:47]
  buffer_load_dwordx4 a[144:147], v3, s[12:15], s18 offen offset:0 sc1
  v_max3_f32 v30, v30, v171, v172
  v_add_f32 v29, v29, v152
  v_max3_f32 v31, v31, v187, v188
  v_mfma_f32_32x32x16_bf16 a[48:63], a[244:247], v[236:239], a[48:63]
  v_add_f32 v29, v29, v153
  v_max3_f32 v30, v30, v173, v174
  v_add_f32 v29, v29, v154
  v_max3_f32 v31, v31, v189, v190
  v_add_f32 v29, v29, v155
  v_max_f32 v30, v30, v175
  s_waitcnt lgkmcnt(0)
  v_mfma_f32_32x32x16_bf16 a[64:79], a[248:251], v[228:231], a[64:79]
  v_add_f32 v29, v29, v156
  v_max_f32 v31, v31, v191
  v_add_f32 v29, v29, v157
  v_add_f32 v29, v29, v158
  v_add_f32 v29, v29, v159
  v_mfma_f32_32x32x16_bf16 a[80:95], a[248:251], v[236:239], a[80:95]
  buffer_load_dwordx4 a[148:151], v3, s[12:15], s18 offen offset:1024 sc1
  v_mfma_f32_32x32x16_bf16 a[96:111], a[252:255], v[228:231], a[96:111]
  v_mfma_f32_32x32x16_bf16 a[112:127], a[252:255], v[236:239], a[112:127]
  v_max_f32 v32, v30, v31
  v_cmp_lt_f32 vcc, s50, v32
  s_cbranch_vccz L_mk5_norescale_20
  s_call_b64 s[48:49], L_q_rescale1
L_mk5_norescale_20:
  buffer_load_dwordx4 a[152:155], v3, s[12:15], s18 offen offset:2048 sc1
  buffer_load_dwordx4 a[156:159], v3, s[12:15], s18 offen offset:3072 sc1
  s_add_u32 s18, s18, 4096
  buffer_load_dwordx4 a[160:163], v3, s[12:15], s18 offen offset:0 sc1
  buffer_load_dwordx4 a[164:167], v3, s[12:15], s18 offen offset:1024 sc1
  ds_read_b64_tr_b16 a[224:225], v24 offset:0
  ds_read_b64_tr_b16 a[226:227], v24 offset:2048
  ds_read_b64_tr_b16 a[228:229], v25 offset:0
  buffer_load_dwordx4 a[168:171], v3, s[12:15], s18 offen offset:2048 sc1
  ds_read_b64_tr_b16 a[230:231], v25 offset:2048
  ds_read_b64_tr_b16 a[232:233], v26 offset:0
  buffer_load_dwordx4 a[172:175], v3, s[12:15], s18 offen offset:3072 sc1
  s_add_u32 s18, s18, 4096
  ds_read_b64_tr_b16 a[234:235], v26 offset:2048
  ds_read_b64_tr_b16 a[236:237], v27 offset:0
  ds_read_b64_tr_b16 a[238:239], v27 offset:2048
  buffer_load_dwordx4 a[176:179], v3, s[12:15], s18 offen offset:0 sc1
  v_exp_f32 v160, v160
  v_exp_f32 v161, v161
  v_exp_f32 v162, v162
  v_cvt_pk_bf16_f32 v224, v160, v161
  v_exp_f32 v163, v163
  v_exp_f32 v164, v164
  v_cvt_pk_bf16_f32 v225, v162, v163
  v_exp_f32 v165, v165
  v_exp_f32 v166, v166
  v_cvt_pk_bf16_f32 v226, v164, v165
  v_exp_f32 v167, v167
  v_exp_f32 v176, v176
  v_cvt_pk_bf16_f32 v227, v166, v167
  v_exp_f32 v177, v177
  v_exp_f32 v178, v178
  v_cvt_pk_bf16_f32 v232, v176, v177
  v_exp_f32 v179, v179
  v_exp_f32 v180, v180
  v_cvt_pk_bf16_f32 v233, v178, v179
  v_exp_f32 v181, v181
  v_exp_f32 v182, v182
  v_cvt_pk_bf16_f32 v234, v180, v181
  v_exp_f32 v183, v183
  v_exp_f32 v168, v168
  v_cvt_pk_bf16_f32 v235, v182, v183
  s_nop 0
  s_nop 0
  s_waitcnt lgkmcnt(4)
  v_mfma_f32_32x32x16_bf16 a[0:15], a[224:227], v[224:227], a[0:15]
  ds_read_b64_tr_b16 a[240:241], v24 offset:4096
  v_exp_f32 v169, v169
  v_exp_f32 v170, v170
  v_mfma_f32_32x32x16_bf16 a[16:31], a[224:227], v[232:235], a[16:31]
  ds_read_b64_tr_b16 a[242:243], v24 offset:6144
  buffer_load_dwordx4 a[180:183], v3, s[12:15], s18 offen offset:1024 sc1
  v_cvt_pk_bf16_f32 v228, v168, v169
  v_mfma_f32_32x32x16_bf16 a[32:47], a[228:231], v[224:227], a[32:47]
  ds_read_b64_tr_b16 a[244:245], v25 offset:4096
  v_exp_f32 v171, v171
  v_exp_f32 v172, v172
  v_cvt_pk_bf16_f32 v229, v170, v171
  v_mfma_f32_32x32x16_bf16 a[48:63], a[228:231], v[232:235], a[48:63]
  ds_read_b64_tr_b16 a[246:247], v25 offset:6144
  v_exp_f32 v173, v173
  v_exp_f32 v174, v174
  v_cvt_pk_bf16_f32 v230, v172, v173
  s_waitcnt lgkmcnt(4)
  v_mfma_f32_32x32x16_bf16 a[64:79], a[232:235], v[224:227], a[64:79]
  ds_read_b64_tr_b16 a[248:249], v26 offset:4096
  v_exp_f32 v175, v175
  v_exp_f32 v184, v184
  v_mfma_f32_32x32x16_bf16 a[80:95], a[232:235], v[232:235], a[80:95]
  ds_read_b64_tr_b16 a[250:251], v26 offset:6144
  v_cvt_pk_bf16_f32 v231, v174, v175
  v_exp_f32 v185, v185
  v_exp_f32 v186, v186
  v_mfma_f32_32x32x16_bf16 a[96:111], a[236:239], v[224:227], a[96:111]
  ds_read_b64_tr_b16 a[252:253], v27 offset:4096
  v_cvt_pk_bf16_f32 v236, v184, v185
  v_exp_f32 v187, v187
  v_exp_f32 v188, v188
  v_mfma_f32_32x32x16_bf16 a[112:127], a[236:239], v[232:235], a[112:127]
  ds_read_b64_tr_b16 a[254:255], v27 offset:6144
  v_cvt_pk_bf16_f32 v237, v186, v187
  v_exp_f32 v189, v189
  v_exp_f32 v190, v190
  v_cvt_pk_bf16_f32 v238, v188, v189
  v_exp_f32 v191, v191
  v_add_f32 v28, v28, v160
  v_cvt_pk_bf16_f32 v239, v190, v191
  s_nop 0
  s_nop 0
  s_waitcnt lgkmcnt(4)
  v_mfma_f32_32x32x16_bf16 a[0:15], a[240:243], v[228:231], a[0:15]
  v_add_f32 v28, v28, v161
  v_add_f32 v28, v28, v162
  v_add_f32 v28, v28, v163
  v_add_f32 v28, v28, v164
  v_add_f32 v28, v28, v165
  v_mfma_f32_32x32x16_bf16 a[16:31], a[240:243], v[236:239], a[16:31]
  v_add_f32 v28, v28, v166
  v_add_f32 v28, v28, v167
  v_add_f32 v29, v29, v176
  v_add_f32 v29, v29, v177
  v_add_f32 v29, v29, v178
  v_add_f32 v29, v29, v179
  v_mfma_f32_32x32x16_bf16 a[32:47], a[244:247], v[228:231], a[32:47]
  v_add_f32 v29, v29, v180
  v_add_f32 v29, v29, v181
  v_add_f32 v29, v29, v182
  v_add_f32 v29, v29, v183
  v_add_f32 v28, v28, v168
  v_add_f32 v28, v28, v169
  v_mfma_f32_32x32x16_bf16 a[48:63], a[244:247], v[236:239], a[48:63]
  v_add_f32 v28, v28, v170
  v_add_f32 v28, v28, v171
  v_add_f32 v28, v28, v172
  v_add_f32 v28, v28, v173
  v_add_f32 v28, v28, v174
  v_add_f32 v28, v28, v175
  s_waitcnt lgkmcnt(0)
  v_mfma_f32_32x32x16_bf16 a[64:79], a[248:251], v[228:231], a[64:79]
  v_add_f32 v29, v29, v184
  v_add_f32 v29, v29, v185
  v_add_f32 v29, v29, v186
  v_add_f32 v29, v29, v187
  v_add_f32 v29, v29, v188
  v_mfma_f32_32x32x16_bf16 a[80:95], a[248:251], v[236:239], a[80:95]
  v_add_f32 v29, v29, v189
  v_add_f32 v29, v29, v190
  v_add_f32 v29, v29, v191
  v_mfma_f32_32x32x16_bf16 a[96:111], a[252:255], v[228:231], a[96:111]
  v_mfma_f32_32x32x16_bf16 a[112:127], a[252:255], v[236:239], a[112:127]
  s_barrier
  ds_read_b64_tr_b16 a[192:193], v8 offset:0
  ds_read_b64_tr_b16 a[194:195], v8 offset:4096
  ds_read_b64_tr_b16 a[196:197], v9 offset:0
  ds_read_b64_tr_b16 a[198:199], v9 offset:4096
  ds_read_b64_tr_b16 a[200:201], v10 offset:0
  ds_read_b64_tr_b16 a[202:203], v10 offset:4096
  ds_read_b64_tr_b16 a[204:205], v11 offset:0
  ds_read_b64_tr_b16 a[206:207], v11 offset:4096
  ds_read_b64_tr_b16 a[208:209], v40 offset:0
  ds_read_b64_tr_b16 a[210:211], v40 offset:4096
  ds_read_b64_tr_b16 a[212:213], v41 offset:0
  ds_read_b64_tr_b16 a[214:215], v41 offset:4096
  v_add_u32 v208, 0x10000, v8
  v_add_u32 v209, 0x10000, v9
  v_add_u32 v210, 0x10000, v10
  v_add_u32 v211, 0x10000, v11
  v_add_u32 v212, 0x10000, v40
  v_add_u32 v213, 0x10000, v41
  v_add_u32 v214, 0x10000, v42
  v_add_u32 v215, 0x10000, v43
  v_mov_b32 v36, v28
  v_mov_b32 v37, v29
  s_lshl_b32 s21, s37, 3
  s_lshl_b32 s22, s16, 1
  v_permlane32_swap_b32 v28, v36
  v_permlane32_swap_b32 v29, v37
  s_add_u32 s21, s21, s22
  v_add_f32 v28, v28, v36
  v_add_f32 v29, v29, v37
  v_rcp_f32 v28, v28
  v_rcp_f32 v29, v29
  s_lshl_b32 s22, s21, 18
  s_add_u32 s22, s22, 8388608
  s_add_u32 s32, s96, s22
  s_addc_u32 s33, s97, 0
  s_and_b32 s33, s33, 0xffff
  s_mov_b32 s34, 524288
  s_mov_b32 s35, 0x00020000
  s_lshl_b32 s65, s36, 13
  s_add_u32 s23, s65, 262144
  s_lshl_b32 s3, s37, 5
  s_add_u32 s3, s3, s36
  s_lshl_b32 s3, s3, 5
  s_add_u32 s101, s3, 8192
  v_add_u32 v38, 4096, v46
  v_accvgpr_read_b32 v128, a0
  v_accvgpr_read_b32 v129, a1
  v_accvgpr_read_b32 v130, a2
  v_accvgpr_read_b32 v131, a3
  v_accvgpr_read_b32 v132, a8
  v_accvgpr_read_b32 v133, a9
  v_accvgpr_read_b32 v134, a10
  v_accvgpr_read_b32 v135, a11
  v_mul_f32 v128, v128, v28
  v_mul_f32 v129, v129, v28
  v_mul_f32 v130, v130, v28
  v_mul_f32 v131, v131, v28
  v_mul_f32 v132, v132, v28
  v_mul_f32 v133, v133, v28
  v_mul_f32 v134, v134, v28
  v_mul_f32 v135, v135, v28
  s_waitcnt vmcnt(12) lgkmcnt(8)
  v_mfma_f32_16x16x32_bf16 v[64:67], a[192:195], a[128:131], 0
  ds_read_b64_tr_b16 a[216:217], v42 offset:0
  ds_read_b64_tr_b16 a[218:219], v42 offset:4096
  v_cvt_pk_bf16_f32 v192, v128, v129
  v_mfma_f32_16x16x32_bf16 v[72:75], a[192:195], a[132:135], 0
  s_add_u32 m0, s19, 65536
  v_cvt_pk_bf16_f32 v193, v130, v131
  v_cvt_pk_bf16_f32 v194, v132, v133
  v_mfma_f32_16x16x32_bf16 v[68:71], a[196:199], a[128:131], 0
  ds_read_b64_tr_b16 a[220:221], v43 offset:0
  ds_read_b64_tr_b16 a[222:223], v43 offset:4096
  v_cvt_pk_bf16_f32 v195, v134, v135
  v_mfma_f32_16x16x32_bf16 v[76:79], a[196:199], a[132:135], 0
  buffer_load_dwordx4 v4, s[8:11], s17 offen offset:0 lds
  buffer_store_dwordx4 v[192:195], v46, s[32:35], s65 offen offset:0 sc1
  v_accvgpr_read_b32 v136, a4
  s_waitcnt lgkmcnt(8)
  v_mfma_f32_16x16x32_bf16 v[80:83], a[200:203], a[128:131], 0
  ds_read_b64_tr_b16 a[192:193], v8 offset:8192
  ds_read_b64_tr_b16 a[194:195], v8 offset:12288
  v_accvgpr_read_b32 v137, a5
  v_accvgpr_read_b32 v138, a6
  v_mfma_f32_16x16x32_bf16 v[88:91], a[200:203], a[132:135], 0
  buffer_load_dwordx4 v5, s[8:11], s17 offen offset:1024 lds
  v_accvgpr_read_b32 v139, a7
  v_mfma_f32_16x16x32_bf16 v[84:87], a[204:207], a[128:131], 0
  ds_read_b64_tr_b16 a[196:197], v9 offset:8192
  ds_read_b64_tr_b16 a[198:199], v9 offset:12288
  v_accvgpr_read_b32 v140, a12
  v_accvgpr_read_b32 v141, a13
  v_mfma_f32_16x16x32_bf16 v[92:95], a[204:207], a[132:135], 0
  buffer_load_dwordx4 v6, s[8:11], s17 offen offset:2048 lds
  v_accvgpr_read_b32 v142, a14
  s_waitcnt lgkmcnt(8)
  v_mfma_f32_16x16x32_bf16 v[96:99], a[208:211], a[128:131], 0
  ds_read_b64_tr_b16 a[200:201], v10 offset:8192
  ds_read_b64_tr_b16 a[202:203], v10 offset:12288
  v_accvgpr_read_b32 v143, a15
  v_mul_f32 v136, v136, v28
  v_mfma_f32_16x16x32_bf16 v[104:107], a[208:211], a[132:135], 0
  buffer_load_dwordx4 v7, s[8:11], s17 offen offset:3072 lds
  s_add_u32 s17, s17, 131072
  v_mul_f32 v137, v137, v28
  v_mul_f32 v138, v138, v28
  v_mfma_f32_16x16x32_bf16 v[100:103], a[212:215], a[128:131], 0
  ds_read_b64_tr_b16 a[204:205], v11 offset:8192
  ds_read_b64_tr_b16 a[206:207], v11 offset:12288
  v_mul_f32 v139, v139, v28
  v_mfma_f32_16x16x32_bf16 v[108:111], a[212:215], a[132:135], 0
  s_add_u32 m0, s19, 81920
  v_mul_f32 v140, v140, v28
  v_mul_f32 v141, v141, v28
  s_waitcnt lgkmcnt(8)
  v_mfma_f32_16x16x32_bf16 v[112:115], a[216:219], a[128:131], 0
  ds_read_b64_tr_b16 a[208:209], v40 offset:8192
  ds_read_b64_tr_b16 a[210:211], v40 offset:12288
  v_mul_f32 v142, v142, v28
  v_mfma_f32_16x16x32_bf16 v[120:123], a[216:219], a[132:135], 0
  buffer_load_dwordx4 v4, s[8:11], s17 offen offset:0 lds
  v_mul_f32 v143, v143, v28
  v_cvt_pk_bf16_f32 v196, v136, v137
  v_mfma_f32_16x16x32_bf16 v[116:119], a[220:223], a[128:131], 0
  ds_read_b64_tr_b16 a[212:213], v41 offset:8192
  ds_read_b64_tr_b16 a[214:215], v41 offset:12288
  v_cvt_pk_bf16_f32 v197, v138, v139
  v_cvt_pk_bf16_f32 v198, v140, v141
  v_mfma_f32_16x16x32_bf16 v[124:127], a[220:223], a[132:135], 0
  buffer_load_dwordx4 v5, s[8:11], s17 offen offset:1024 lds
  v_cvt_pk_bf16_f32 v199, v142, v143
  s_waitcnt vmcnt(17) lgkmcnt(8)
  v_mfma_f32_16x16x32_bf16 v[64:67], a[192:195], a[136:139], v[64:67]
  ds_read_b64_tr_b16 a[216:217], v42 offset:8192
  ds_read_b64_tr_b16 a[218:219], v42 offset:12288
  buffer_store_dwordx4 v[196:199], v46, s[32:35], s65 offen offset:512 sc1
  v_accvgpr_read_b32 v144, a16
  v_mfma_f32_16x16x32_bf16 v[72:75], a[192:195], a[140:143], v[72:75]
  buffer_load_dwordx4 v6, s[8:11], s17 offen offset:2048 lds
  v_accvgpr_read_b32 v145, a17
  v_accvgpr_read_b32 v146, a18
  v_mfma_f32_16x16x32_bf16 v[68:71], a[196:199], a[136:139], v[68:71]
  ds_read_b64_tr_b16 a[220:221], v43 offset:8192
  ds_read_b64_tr_b16 a[222:223], v43 offset:12288
  v_accvgpr_read_b32 v147, a19
  v_mfma_f32_16x16x32_bf16 v[76:79], a[196:199], a[140:143], v[76:79]
  buffer_load_dwordx4 v7, s[8:11], s17 offen offset:3072 lds
  s_add_u32 s17, s17, 131072
  v_accvgpr_read_b32 v148, a24
  v_accvgpr_read_b32 v149, a25
  s_waitcnt lgkmcnt(8)
  v_mfma_f32_16x16x32_bf16 v[80:83], a[200:203], a[136:139], v[80:83]
  s_barrier
  ds_read_b64_tr_b16 a[192:193], v8 offset:16384
  ds_read_b64_tr_b16 a[194:195], v8 offset:20480
  v_accvgpr_read_b32 v150, a26
  v_mfma_f32_16x16x32_bf16 v[88:91], a[200:203], a[140:143], v[88:91]
  buffer_load_dwordx4 a[184:187], v3, s[12:15], s18 offen offset:2048 sc1
  v_accvgpr_read_b32 v151, a27
  v_mul_f32 v144, v144, v29
  v_mfma_f32_16x16x32_bf16 v[84:87], a[204:207], a[136:139], v[84:87]
  ds_read_b64_tr_b16 a[196:197], v9 offset:16384
  ds_read_b64_tr_b16 a[198:199], v9 offset:20480
  v_mul_f32 v145, v145, v29
  v_mul_f32 v146, v146, v29
  v_mfma_f32_16x16x32_bf16 v[92:95], a[204:207], a[140:143], v[92:95]
  buffer_load_dwordx4 a[188:191], v3, s[12:15], s18 offen offset:3072 sc1
  s_add_u32 s18, s18, 4096
  v_mul_f32 v147, v147, v29
  s_waitcnt lgkmcnt(8)
  v_mfma_f32_16x16x32_bf16 v[96:99], a[208:211], a[136:139], v[96:99]
  ds_read_b64_tr_b16 a[200:201], v10 offset:16384
  ds_read_b64_tr_b16 a[202:203], v10 offset:20480
  v_mul_f32 v148, v148, v29
  v_mul_f32 v149, v149, v29
  v_mfma_f32_16x16x32_bf16 v[104:107], a[208:211], a[140:143], v[104:107]
  s_add_u32 m0, s19, 98304
  v_mul_f32 v150, v150, v29
  v_mfma_f32_16x16x32_bf16 v[100:103], a[212:215], a[136:139], v[100:103]
  ds_read_b64_tr_b16 a[204:205], v11 offset:16384
  ds_read_b64_tr_b16 a[206:207], v11 offset:20480
  v_mul_f32 v151, v151, v29
  v_cvt_pk_bf16_f32 v200, v144, v145
  v_mfma_f32_16x16x32_bf16 v[108:111], a[212:215], a[140:143], v[108:111]
  buffer_load_dwordx4 v4, s[8:11], s17 offen offset:0 lds
  v_cvt_pk_bf16_f32 v201, v146, v147
  v_cvt_pk_bf16_f32 v202, v148, v149
  s_waitcnt lgkmcnt(8)
  v_mfma_f32_16x16x32_bf16 v[112:115], a[216:219], a[136:139], v[112:115]
  ds_read_b64_tr_b16 a[208:209], v40 offset:16384
  ds_read_b64_tr_b16 a[210:211], v40 offset:20480
  v_cvt_pk_bf16_f32 v203, v150, v151
  v_mfma_f32_16x16x32_bf16 v[120:123], a[216:219], a[140:143], v[120:123]
  buffer_store_dwordx4 v[200:203], v46, s[32:35], s23 offen offset:0 sc1
  v_accvgpr_read_b32 v152, a20
  v_mfma_f32_16x16x32_bf16 v[116:119], a[220:223], a[136:139], v[116:119]
  ds_read_b64_tr_b16 a[212:213], v41 offset:16384
  ds_read_b64_tr_b16 a[214:215], v41 offset:20480
  v_accvgpr_read_b32 v153, a21
  v_accvgpr_read_b32 v154, a22
  v_mfma_f32_16x16x32_bf16 v[124:127], a[220:223], a[140:143], v[124:127]
  buffer_load_dwordx4 v5, s[8:11], s17 offen offset:1024 lds
  v_accvgpr_read_b32 v155, a23
  s_waitcnt vmcnt(23) lgkmcnt(8)
  v_mfma_f32_16x16x32_bf16 v[64:67], a[192:195], a[144:147], v[64:67]
  ds_read_b64_tr_b16 a[216:217], v42 offset:16384
  ds_read_b64_tr_b16 a[218:219], v42 offset:20480
  v_accvgpr_read_b32 v156, a28
  v_accvgpr_read_b32 v157, a29
  v_mfma_f32_16x16x32_bf16 v[72:75], a[192:195], a[148:151], v[72:75]
  buffer_load_dwordx4 v6, s[8:11], s17 offen offset:2048 lds
  v_accvgpr_read_b32 v158, a30
  v_mfma_f32_16x16x32_bf16 v[68:71], a[196:199], a[144:147], v[68:71]
  ds_read_b64_tr_b16 a[220:221], v43 offset:16384
  ds_read_b64_tr_b16 a[222:223], v43 offset:20480
  v_accvgpr_read_b32 v159, a31
  v_mul_f32 v152, v152, v29
  v_mfma_f32_16x16x32_bf16 v[76:79], a[196:199], a[148:151], v[76:79]
  buffer_load_dwordx4 v7, s[8:11], s17 offen offset:3072 lds
  s_add_u32 s17, s17, 131072
  v_mul_f32 v153, v153, v29
  v_mul_f32 v154, v154, v29
  s_waitcnt lgkmcnt(8)
  v_mfma_f32_16x16x32_bf16 v[80:83], a[200:203], a[144:147], v[80:83]
  ds_read_b64_tr_b16 a[192:193], v8 offset:24576
  ds_read_b64_tr_b16 a[194:195], v8 offset:28672
  v_mul_f32 v155, v155, v29
  v_mfma_f32_16x16x32_bf16 v[88:91], a[200:203], a[148:151], v[88:91]
  buffer_load_dwordx4 a[128:131], v3, s[12:15], s18 offen offset:0 sc1
  v_mul_f32 v156, v156, v29
  v_mul_f32 v157, v157, v29
  v_mfma_f32_16x16x32_bf16 v[84:87], a[204:207], a[144:147], v[84:87]
  ds_read_b64_tr_b16 a[196:197], v9 offset:24576
  ds_read_b64_tr_b16 a[198:199], v9 offset:28672
  v_mul_f32 v158, v158, v29
  v_mfma_f32_16x16x32_bf16 v[92:95], a[204:207], a[148:151], v[92:95]
  buffer_load_dwordx4 a[132:135], v3, s[12:15], s18 offen offset:1024 sc1
  v_mul_f32 v159, v159, v29
  v_cvt_pk_bf16_f32 v204, v152, v153
  s_waitcnt lgkmcnt(8)
  v_mfma_f32_16x16x32_bf16 v[96:99], a[208:211], a[144:147], v[96:99]
  ds_read_b64_tr_b16 a[200:201], v10 offset:24576
  ds_read_b64_tr_b16 a[202:203], v10 offset:28672
  v_cvt_pk_bf16_f32 v205, v154, v155
  v_cvt_pk_bf16_f32 v206, v156, v157
  v_mfma_f32_16x16x32_bf16 v[104:107], a[208:211], a[148:151], v[104:107]
  v_cvt_pk_bf16_f32 v207, v158, v159
  v_mfma_f32_16x16x32_bf16 v[100:103], a[212:215], a[144:147], v[100:103]
  ds_read_b64_tr_b16 a[204:205], v11 offset:24576
  ds_read_b64_tr_b16 a[206:207], v11 offset:28672
  buffer_store_dwordx4 v[204:207], v46, s[32:35], s23 offen offset:512 sc1
  v_accvgpr_read_b32 v160, a32
  v_mfma_f32_16x16x32_bf16 v[108:111], a[212:215], a[148:151], v[108:111]
  buffer_load_dwordx4 a[136:139], v3, s[12:15], s18 offen offset:2048 sc1
  v_accvgpr_read_b32 v161, a33
  s_waitcnt lgkmcnt(8)
  v_mfma_f32_16x16x32_bf16 v[112:115], a[216:219], a[144:147], v[112:115]
  ds_read_b64_tr_b16 a[208:209], v40 offset:24576
  ds_read_b64_tr_b16 a[210:211], v40 offset:28672
  v_accvgpr_read_b32 v162, a34
  v_accvgpr_read_b32 v163, a35
  v_mfma_f32_16x16x32_bf16 v[120:123], a[216:219], a[148:151], v[120:123]
  v_accvgpr_read_b32 v164, a40
  v_accvgpr_read_b32 v165, a41
  v_mfma_f32_16x16x32_bf16 v[116:119], a[220:223], a[144:147], v[116:119]
  ds_read_b64_tr_b16 a[212:213], v41 offset:24576
  ds_read_b64_tr_b16 a[214:215], v41 offset:28672
  v_accvgpr_read_b32 v166, a42
  v_mfma_f32_16x16x32_bf16 v[124:127], a[220:223], a[148:151], v[124:127]
  buffer_load_dwordx4 a[140:143], v3, s[12:15], s18 offen offset:3072 sc1
  s_add_u32 s18, s18, 4096
  v_accvgpr_read_b32 v167, a43
  v_mul_f32 v160, v160, v28
  s_waitcnt vmcnt(28) lgkmcnt(8)
  v_mfma_f32_16x16x32_bf16 v[64:67], a[192:195], a[152:155], v[64:67]
  ds_read_b64_tr_b16 a[216:217], v42 offset:24576
  ds_read_b64_tr_b16 a[218:219], v42 offset:28672
  v_mul_f32 v161, v161, v28
  v_mul_f32 v162, v162, v28
  v_mfma_f32_16x16x32_bf16 v[72:75], a[192:195], a[156:159], v[72:75]
  s_add_u32 m0, s19, 114688
  v_mul_f32 v163, v163, v28
  v_mfma_f32_16x16x32_bf16 v[68:71], a[196:199], a[152:155], v[68:71]
  ds_read_b64_tr_b16 a[220:221], v43 offset:24576
  ds_read_b64_tr_b16 a[222:223], v43 offset:28672
  v_mul_f32 v164, v164, v28
  v_mul_f32 v165, v165, v28
  v_mfma_f32_16x16x32_bf16 v[76:79], a[196:199], a[156:159], v[76:79]
  buffer_load_dwordx4 v4, s[8:11], s17 offen offset:0 lds
  v_mul_f32 v166, v166, v28
  s_waitcnt lgkmcnt(8)
  v_mfma_f32_16x16x32_bf16 v[80:83], a[200:203], a[152:155], v[80:83]
  s_barrier
  ds_read_b64_tr_b16 a[192:193], v8 offset:32768
  ds_read_b64_tr_b16 a[194:195], v8 offset:36864
  v_mul_f32 v167, v167, v28
  v_cvt_pk_bf16_f32 v192, v160, v161
  v_mfma_f32_16x16x32_bf16 v[88:91], a[200:203], a[156:159], v[88:91]
  v_cvt_pk_bf16_f32 v193, v162, v163
  v_cvt_pk_bf16_f32 v194, v164, v165
  v_mfma_f32_16x16x32_bf16 v[84:87], a[204:207], a[152:155], v[84:87]
  ds_read_b64_tr_b16 a[196:197], v9 offset:32768
  ds_read_b64_tr_b16 a[198:199], v9 offset:36864
  v_cvt_pk_bf16_f32 v195, v166, v167
  v_mfma_f32_16x16x32_bf16 v[92:95], a[204:207], a[156:159], v[92:95]
  buffer_load_dwordx4 v5, s[8:11], s17 offen offset:1024 lds
  buffer_store_dwordx4 v[192:195], v46, s[32:35], s65 offen offset:2048 sc1
  v_accvgpr_read_b32 v168, a36
  s_waitcnt lgkmcnt(8)
  v_mfma_f32_16x16x32_bf16 v[96:99], a[208:211], a[152:155], v[96:99]
  ds_read_b64_tr_b16 a[200:201], v10 offset:32768
  ds_read_b64_tr_b16 a[202:203], v10 offset:36864
  v_accvgpr_read_b32 v169, a37
  v_mfma_f32_16x16x32_bf16 v[104:107], a[208:211], a[156:159], v[104:107]
  v_accvgpr_read_b32 v170, a38
  v_accvgpr_read_b32 v171, a39
  v_mfma_f32_16x16x32_bf16 v[100:103], a[212:215], a[152:155], v[100:103]
  ds_read_b64_tr_b16 a[204:205], v11 offset:32768
  ds_read_b64_tr_b16 a[206:207], v11 offset:36864
  v_accvgpr_read_b32 v172, a44
  v_accvgpr_read_b32 v173, a45
  v_mfma_f32_16x16x32_bf16 v[108:111], a[212:215], a[156:159], v[108:111]
  buffer_load_dwordx4 v6, s[8:11], s17 offen offset:2048 lds
  v_accvgpr_read_b32 v174, a46
  s_waitcnt lgkmcnt(8)
  v_mfma_f32_16x16x32_bf16 v[112:115], a[216:219], a[152:155], v[112:115]
  ds_read_b64_tr_b16 a[208:209], v40 offset:32768
  ds_read_b64_tr_b16 a[210:211], v40 offset:36864
  v_accvgpr_read_b32 v175, a47
  v_mul_f32 v168, v168, v28
  v_mfma_f32_16x16x32_bf16 v[120:123], a[216:219], a[156:159], v[120:123]
  v_mul_f32 v169, v169, v28
  v_mul_f32 v170, v170, v28
  v_mfma_f32_16x16x32_bf16 v[116:119], a[220:223], a[152:155], v[116:119]
  ds_read_b64_tr_b16 a[212:213], v41 offset:32768
  ds_read_b64_tr_b16 a[214:215], v41 offset:36864
  v_mul_f32 v171, v171, v28
  v_mfma_f32_16x16x32_bf16 v[124:127], a[220:223], a[156:159], v[124:127]
  buffer_load_dwordx4 v7, s[8:11], s17 offen offset:3072 lds
  s_add_u32 s17, s17, 131072
  v_mul_f32 v172, v172, v28
  v_mul_f32 v173, v173, v28
  s_waitcnt vmcnt(31) lgkmcnt(8)
  v_mfma_f32_16x16x32_bf16 v[64:67], a[192:195], a[160:163], v[64:67]
  ds_read_b64_tr_b16 a[216:217], v42 offset:32768
  ds_read_b64_tr_b16 a[218:219], v42 offset:36864
  v_mul_f32 v174, v174, v28
  v_mfma_f32_16x16x32_bf16 v[72:75], a[192:195], a[164:167], v[72:75]
  buffer_load_dwordx4 a[144:147], v3, s[12:15], s18 offen offset:0 sc1
  v_mul_f32 v175, v175, v28
  v_cvt_pk_bf16_f32 v196, v168, v169
  v_mfma_f32_16x16x32_bf16 v[68:71], a[196:199], a[160:163], v[68:71]
  ds_read_b64_tr_b16 a[220:221], v43 offset:32768
  ds_read_b64_tr_b16 a[222:223], v43 offset:36864
  v_cvt_pk_bf16_f32 v197, v170, v171
  v_cvt_pk_bf16_f32 v198, v172, v173
  v_mfma_f32_16x16x32_bf16 v[76:79], a[196:199], a[164:167], v[76:79]
  buffer_load_dwordx4 a[148:151], v3, s[12:15], s18 offen offset:1024 sc1
  v_cvt_pk_bf16_f32 v199, v174, v175
  s_waitcnt lgkmcnt(8)
  v_mfma_f32_16x16x32_bf16 v[80:83], a[200:203], a[160:163], v[80:83]
  ds_read_b64_tr_b16 a[192:193], v8 offset:40960
  ds_read_b64_tr_b16 a[194:195], v8 offset:45056
  buffer_store_dwordx4 v[196:199], v46, s[32:35], s65 offen offset:2560 sc1
  v_accvgpr_read_b32 v176, a48
  v_mfma_f32_16x16x32_bf16 v[88:91], a[200:203], a[164:167], v[88:91]
  v_accvgpr_read_b32 v177, a49
  v_mfma_f32_16x16x32_bf16 v[84:87], a[204:207], a[160:163], v[84:87]
  ds_read_b64_tr_b16 a[196:197], v9 offset:40960
  ds_read_b64_tr_b16 a[198:199], v9 offset:45056
  v_accvgpr_read_b32 v178, a50
  v_accvgpr_read_b32 v179, a51
  v_mfma_f32_16x16x32_bf16 v[92:95], a[204:207], a[164:167], v[92:95]
  buffer_load_dwordx4 a[152:155], v3, s[12:15], s18 offen offset:2048 sc1
  v_accvgpr_read_b32 v180, a56
  v_accvgpr_read_b32 v181, a57
  s_waitcnt lgkmcnt(8)
  v_mfma_f32_16x16x32_bf16 v[96:99], a[208:211], a[160:163], v[96:99]
  ds_read_b64_tr_b16 a[200:201], v10 offset:40960
  ds_read_b64_tr_b16 a[202:203], v10 offset:45056
  v_accvgpr_read_b32 v182, a58
  v_mfma_f32_16x16x32_bf16 v[104:107], a[208:211], a[164:167], v[104:107]
  v_accvgpr_read_b32 v183, a59
  v_mul_f32 v176, v176, v29
  v_mfma_f32_16x16x32_bf16 v[100:103], a[212:215], a[160:163], v[100:103]
  ds_read_b64_tr_b16 a[204:205], v11 offset:40960
  ds_read_b64_tr_b16 a[206:207], v11 offset:45056
  v_mul_f32 v177, v177, v29
  v_mfma_f32_16x16x32_bf16 v[108:111], a[212:215], a[164:167], v[108:111]
  buffer_load_dwordx4 a[156:159], v3, s[12:15], s18 offen offset:3072 sc1
  s_add_u32 s18, s18, 4096
  v_mul_f32 v178, v178, v29
  v_mul_f32 v179, v179, v29
  s_waitcnt lgkmcnt(8)
  v_mfma_f32_16x16x32_bf16 v[112:115], a[216:219], a[160:163], v[112:115]
  ds_read_b64_tr_b16 a[208:209], v40 offset:40960
  ds_read_b64_tr_b16 a[210:211], v40 offset:45056
  v_mul_f32 v180, v180, v29
  v_mul_f32 v181, v181, v29
  v_mfma_f32_16x16x32_bf16 v[120:123], a[216:219], a[164:167], v[120:123]
  s_add_u32 m0, s19, 0
  v_mul_f32 v182, v182, v29
  v_mfma_f32_16x16x32_bf16 v[116:119], a[220:223], a[160:163], v[116:119]
  ds_read_b64_tr_b16 a[212:213], v41 offset:40960
  ds_read_b64_tr_b16 a[214:215], v41 offset:45056
  v_mul_f32 v183, v183, v29
  v_cvt_pk_bf16_f32 v200, v176, v177
  v_mfma_f32_16x16x32_bf16 v[124:127], a[220:223], a[164:167], v[124:127]
  buffer_load_dwordx4 v4, s[8:11], s17 offen offset:0 lds
  v_cvt_pk_bf16_f32 v201, v178, v179
  v_cvt_pk_bf16_f32 v202, v180, v181
  s_waitcnt vmcnt(35) lgkmcnt(8)
  v_mfma_f32_16x16x32_bf16 v[64:67], a[192:195], a[168:171], v[64:67]
  ds_read_b64_tr_b16 a[216:217], v42 offset:40960
  ds_read_b64_tr_b16 a[218:219], v42 offset:45056
  v_cvt_pk_bf16_f32 v203, v182, v183
  v_mfma_f32_16x16x32_bf16 v[72:75], a[192:195], a[172:175], v[72:75]
  buffer_store_dwordx4 v[200:203], v46, s[32:35], s23 offen offset:2048 sc1
  v_accvgpr_read_b32 v184, a52
  v_mfma_f32_16x16x32_bf16 v[68:71], a[196:199], a[168:171], v[68:71]
  ds_read_b64_tr_b16 a[220:221], v43 offset:40960
  ds_read_b64_tr_b16 a[222:223], v43 offset:45056
  v_accvgpr_read_b32 v185, a53
  v_mfma_f32_16x16x32_bf16 v[76:79], a[196:199], a[172:175], v[76:79]
  buffer_load_dwordx4 v5, s[8:11], s17 offen offset:1024 lds
  v_accvgpr_read_b32 v186, a54
  v_accvgpr_read_b32 v187, a55
  s_waitcnt lgkmcnt(8)
  v_mfma_f32_16x16x32_bf16 v[80:83], a[200:203], a[168:171], v[80:83]
  s_barrier
  ds_read_b64_tr_b16 a[192:193], v8 offset:49152
  ds_read_b64_tr_b16 a[194:195], v8 offset:53248
  v_accvgpr_read_b32 v188, a60
  v_accvgpr_read_b32 v189, a61
  v_mfma_f32_16x16x32_bf16 v[88:91], a[200:203], a[172:175], v[88:91]
  v_accvgpr_read_b32 v190, a62
  v_mfma_f32_16x16x32_bf16 v[84:87], a[204:207], a[168:171], v[84:87]
  ds_read_b64_tr_b16 a[196:197], v9 offset:49152
  ds_read_b64_tr_b16 a[198:199], v9 offset:53248
  v_accvgpr_read_b32 v191, a63
  v_mul_f32 v184, v184, v29
  v_mfma_f32_16x16x32_bf16 v[92:95], a[204:207], a[172:175], v[92:95]
  buffer_load_dwordx4 v6, s[8:11], s17 offen offset:2048 lds
  v_mul_f32 v185, v185, v29
  s_waitcnt lgkmcnt(8)
  v_mfma_f32_16x16x32_bf16 v[96:99], a[208:211], a[168:171], v[96:99]
  ds_read_b64_tr_b16 a[200:201], v10 offset:49152
  ds_read_b64_tr_b16 a[202:203], v10 offset:53248
  v_mul_f32 v186, v186, v29
  v_mul_f32 v187, v187, v29
  v_mfma_f32_16x16x32_bf16 v[104:107], a[208:211], a[172:175], v[104:107]
  v_mul_f32 v188, v188, v29
  v_mul_f32 v189, v189, v29
  v_mfma_f32_16x16x32_bf16 v[100:103], a[212:215], a[168:171], v[100:103]
  ds_read_b64_tr_b16 a[204:205], v11 offset:49152
  ds_read_b64_tr_b16 a[206:207], v11 offset:53248
  v_mul_f32 v190, v190, v29
  v_mfma_f32_16x16x32_bf16 v[108:111], a[212:215], a[172:175], v[108:111]
  buffer_load_dwordx4 v7, s[8:11], s17 offen offset:3072 lds
  s_add_u32 s17, s17, 131072
  v_mul_f32 v191, v191, v29
  v_cvt_pk_bf16_f32 v204, v184, v185
  s_waitcnt lgkmcnt(8)
  v_mfma_f32_16x16x32_bf16 v[112:115], a[216:219], a[168:171], v[112:115]
  ds_read_b64_tr_b16 a[208:209], v40 offset:49152
  ds_read_b64_tr_b16 a[210:211], v40 offset:53248
  v_cvt_pk_bf16_f32 v205, v186, v187
  v_cvt_pk_bf16_f32 v206, v188, v189
  v_mfma_f32_16x16x32_bf16 v[120:123], a[216:219], a[172:175], v[120:123]
  v_cvt_pk_bf16_f32 v207, v190, v191
  v_mfma_f32_16x16x32_bf16 v[116:119], a[220:223], a[168:171], v[116:119]
  ds_read_b64_tr_b16 a[212:213], v41 offset:49152
  ds_read_b64_tr_b16 a[214:215], v41 offset:53248
  buffer_store_dwordx4 v[204:207], v46, s[32:35], s23 offen offset:2560 sc1
  v_accvgpr_read_b32 v128, a64
  v_mfma_f32_16x16x32_bf16 v[124:127], a[220:223], a[172:175], v[124:127]
  buffer_load_dwordx4 a[160:163], v3, s[12:15], s18 offen offset:0 sc1
  v_accvgpr_read_b32 v129, a65
  s_waitcnt vmcnt(39) lgkmcnt(8)
  v_mfma_f32_16x16x32_bf16 v[64:67], a[192:195], a[176:179], v[64:67]
  ds_read_b64_tr_b16 a[216:217], v42 offset:49152
  ds_read_b64_tr_b16 a[218:219], v42 offset:53248
  v_accvgpr_read_b32 v130, a66
  v_accvgpr_read_b32 v131, a67
  v_mfma_f32_16x16x32_bf16 v[72:75], a[192:195], a[180:183], v[72:75]
  buffer_load_dwordx4 a[164:167], v3, s[12:15], s18 offen offset:1024 sc1
  v_accvgpr_read_b32 v132, a72
  v_accvgpr_read_b32 v133, a73
  v_mfma_f32_16x16x32_bf16 v[68:71], a[196:199], a[176:179], v[68:71]
  ds_read_b64_tr_b16 a[220:221], v43 offset:49152
  ds_read_b64_tr_b16 a[222:223], v43 offset:53248
  v_accvgpr_read_b32 v134, a74
  v_mfma_f32_16x16x32_bf16 v[76:79], a[196:199], a[180:183], v[76:79]
  v_accvgpr_read_b32 v135, a75
  v_mul_f32 v128, v128, v28
  s_waitcnt lgkmcnt(8)
  v_mfma_f32_16x16x32_bf16 v[80:83], a[200:203], a[176:179], v[80:83]
  ds_read_b64_tr_b16 a[192:193], v8 offset:57344
  ds_read_b64_tr_b16 a[194:195], v8 offset:61440
  v_mul_f32 v129, v129, v28
  v_mfma_f32_16x16x32_bf16 v[88:91], a[200:203], a[180:183], v[88:91]
  buffer_load_dwordx4 a[168:171], v3, s[12:15], s18 offen offset:2048 sc1
  v_mul_f32 v130, v130, v28
  v_mul_f32 v131, v131, v28
  v_mfma_f32_16x16x32_bf16 v[84:87], a[204:207], a[176:179], v[84:87]
  ds_read_b64_tr_b16 a[196:197], v9 offset:57344
  ds_read_b64_tr_b16 a[198:199], v9 offset:61440
  v_mul_f32 v132, v132, v28
  v_mul_f32 v133, v133, v28
  v_mfma_f32_16x16x32_bf16 v[92:95], a[204:207], a[180:183], v[92:95]
  v_mul_f32 v134, v134, v28
  s_waitcnt lgkmcnt(8)
  v_mfma_f32_16x16x32_bf16 v[96:99], a[208:211], a[176:179], v[96:99]
  ds_read_b64_tr_b16 a[200:201], v10 offset:57344
  ds_read_b64_tr_b16 a[202:203], v10 offset:61440
  v_mul_f32 v135, v135, v28
  v_cvt_pk_bf16_f32 v192, v128, v129
  v_mfma_f32_16x16x32_bf16 v[104:107], a[208:211], a[180:183], v[104:107]
  buffer_load_dwordx4 a[172:175], v3, s[12:15], s18 offen offset:3072 sc1
  s_add_u32 s18, s18, 4096
  v_cvt_pk_bf16_f32 v193, v130, v131
  v_mfma_f32_16x16x32_bf16 v[100:103], a[212:215], a[176:179], v[100:103]
  ds_read_b64_tr_b16 a[204:205], v11 offset:57344
  ds_read_b64_tr_b16 a[206:207], v11 offset:61440
  v_cvt_pk_bf16_f32 v194, v132, v133
  v_cvt_pk_bf16_f32 v195, v134, v135
  v_mfma_f32_16x16x32_bf16 v[108:111], a[212:215], a[180:183], v[108:111]
  s_add_u32 m0, s19, 16384
  buffer_store_dwordx4 v[192:195], v38, s[32:35], s65 offen offset:0 sc1
  v_accvgpr_read_b32 v136, a68
  s_waitcnt lgkmcnt(8)
  v_mfma_f32_16x16x32_bf16 v[112:115], a[216:219], a[176:179], v[112:115]
  ds_read_b64_tr_b16 a[208:209], v40 offset:57344
  ds_read_b64_tr_b16 a[210:211], v40 offset:61440
  v_accvgpr_read_b32 v137, a69
  v_mfma_f32_16x16x32_bf16 v[120:123], a[216:219], a[180:183], v[120:123]
  buffer_load_dwordx4 v4, s[8:11], s17 offen offset:0 lds
  v_accvgpr_read_b32 v138, a70
  v_accvgpr_read_b32 v139, a71
  v_mfma_f32_16x16x32_bf16 v[116:119], a[220:223], a[176:179], v[116:119]
  ds_read_b64_tr_b16 a[212:213], v41 offset:57344
  ds_read_b64_tr_b16 a[214:215], v41 offset:61440
  v_accvgpr_read_b32 v140, a76
  v_accvgpr_read_b32 v141, a77
  v_mfma_f32_16x16x32_bf16 v[124:127], a[220:223], a[180:183], v[124:127]
  v_accvgpr_read_b32 v142, a78
  s_waitcnt vmcnt(32) lgkmcnt(8)
  v_mfma_f32_16x16x32_bf16 v[64:67], a[192:195], a[184:187], v[64:67]
  ds_read_b64_tr_b16 a[216:217], v42 offset:57344
  ds_read_b64_tr_b16 a[218:219], v42 offset:61440
  v_accvgpr_read_b32 v143, a79
  v_mul_f32 v136, v136, v28
  v_mfma_f32_16x16x32_bf16 v[72:75], a[192:195], a[188:191], v[72:75]
  buffer_load_dwordx4 v5, s[8:11], s17 offen offset:1024 lds
  v_mul_f32 v137, v137, v28
  v_mfma_f32_16x16x32_bf16 v[68:71], a[196:199], a[184:187], v[68:71]
  ds_read_b64_tr_b16 a[220:221], v43 offset:57344
  ds_read_b64_tr_b16 a[222:223], v43 offset:61440
  v_mul_f32 v138, v138, v28
  v_mul_f32 v139, v139, v28
  v_mfma_f32_16x16x32_bf16 v[76:79], a[196:199], a[188:191], v[76:79]
  v_mul_f32 v140, v140, v28
  v_mul_f32 v141, v141, v28
  s_waitcnt lgkmcnt(8)
  v_mfma_f32_16x16x32_bf16 v[80:83], a[200:203], a[184:187], v[80:83]
  s_barrier
  ds_read_b64_tr_b16 a[192:193], v208 offset:0
  ds_read_b64_tr_b16 a[194:195], v208 offset:4096
  v_mul_f32 v142, v142, v28
  v_mfma_f32_16x16x32_bf16 v[88:91], a[200:203], a[188:191], v[88:91]
  buffer_load_dwordx4 v6, s[8:11], s17 offen offset:2048 lds
  v_mul_f32 v143, v143, v28
  v_cvt_pk_bf16_f32 v196, v136, v137
  v_mfma_f32_16x16x32_bf16 v[84:87], a[204:207], a[184:187], v[84:87]
  ds_read_b64_tr_b16 a[196:197], v209 offset:0
  ds_read_b64_tr_b16 a[198:199], v209 offset:4096
  v_cvt_pk_bf16_f32 v197, v138, v139
  v_mfma_f32_16x16x32_bf16 v[92:95], a[204:207], a[188:191], v[92:95]
  v_cvt_pk_bf16_f32 v198, v140, v141
  v_cvt_pk_bf16_f32 v199, v142, v143
  s_waitcnt lgkmcnt(8)
  v_mfma_f32_16x16x32_bf16 v[96:99], a[208:211], a[184:187], v[96:99]
  ds_read_b64_tr_b16 a[200:201], v210 offset:0
  ds_read_b64_tr_b16 a[202:203], v210 offset:4096
  buffer_store_dwordx4 v[196:199], v38, s[32:35], s65 offen offset:512 sc1
  v_accvgpr_read_b32 v144, a80
  v_mfma_f32_16x16x32_bf16 v[104:107], a[208:211], a[188:191], v[104:107]
  buffer_load_dwordx4 v7, s[8:11], s17 offen offset:3072 lds
  s_add_u32 s17, s17, 131072
  v_accvgpr_read_b32 v145, a81
  v_mfma_f32_16x16x32_bf16 v[100:103], a[212:215], a[184:187], v[100:103]
  ds_read_b64_tr_b16 a[204:205], v211 offset:0
  ds_read_b64_tr_b16 a[206:207], v211 offset:4096
  v_accvgpr_read_b32 v146, a82
  v_accvgpr_read_b32 v147, a83
  v_mfma_f32_16x16x32_bf16 v[108:111], a[212:215], a[188:191], v[108:111]
  v_accvgpr_read_b32 v148, a88
  v_accvgpr_read_b32 v149, a89
  s_waitcnt lgkmcnt(8)
  v_mfma_f32_16x16x32_bf16 v[112:115], a[216:219], a[184:187], v[112:115]
  ds_read_b64_tr_b16 a[208:209], v212 offset:0
  ds_read_b64_tr_b16 a[210:211], v212 offset:4096
  v_accvgpr_read_b32 v150, a90
  v_mfma_f32_16x16x32_bf16 v[120:123], a[216:219], a[188:191], v[120:123]
  buffer_load_dwordx4 a[176:179], v3, s[12:15], s18 offen offset:0 sc1
  v_accvgpr_read_b32 v151, a91
  v_mul_f32 v144, v144, v29
  v_mfma_f32_16x16x32_bf16 v[116:119], a[220:223], a[184:187], v[116:119]
  ds_read_b64_tr_b16 a[212:213], v213 offset:0
  ds_read_b64_tr_b16 a[214:215], v213 offset:4096
  v_mul_f32 v145, v145, v29
  v_mfma_f32_16x16x32_bf16 v[124:127], a[220:223], a[188:191], v[124:127]
  v_mul_f32 v146, v146, v29
  v_mul_f32 v147, v147, v29
  s_waitcnt vmcnt(30) lgkmcnt(8)
  v_mfma_f32_16x16x32_bf16 v[64:67], a[192:195], a[128:131], v[64:67]
  ds_read_b64_tr_b16 a[216:217], v214 offset:0
  ds_read_b64_tr_b16 a[218:219], v214 offset:4096
  v_mul_f32 v148, v148, v29
  v_mul_f32 v149, v149, v29
  v_mfma_f32_16x16x32_bf16 v[72:75], a[192:195], a[132:135], v[72:75]
  buffer_load_dwordx4 a[180:183], v3, s[12:15], s18 offen offset:1024 sc1
  v_mul_f32 v150, v150, v29
  v_mfma_f32_16x16x32_bf16 v[68:71], a[196:199], a[128:131], v[68:71]
  ds_read_b64_tr_b16 a[220:221], v215 offset:0
  ds_read_b64_tr_b16 a[222:223], v215 offset:4096
  v_mul_f32 v151, v151, v29
  v_cvt_pk_bf16_f32 v200, v144, v145
  v_mfma_f32_16x16x32_bf16 v[76:79], a[196:199], a[132:135], v[76:79]
  v_cvt_pk_bf16_f32 v201, v146, v147
  s_waitcnt lgkmcnt(8)
  v_mfma_f32_16x16x32_bf16 v[80:83], a[200:203], a[128:131], v[80:83]
  ds_read_b64_tr_b16 a[192:193], v208 offset:8192
  ds_read_b64_tr_b16 a[194:195], v208 offset:12288
  v_cvt_pk_bf16_f32 v202, v148, v149
  v_cvt_pk_bf16_f32 v203, v150, v151
  v_mfma_f32_16x16x32_bf16 v[88:91], a[200:203], a[132:135], v[88:91]
  buffer_load_dwordx4 a[184:187], v3, s[12:15], s18 offen offset:2048 sc1
  buffer_store_dwordx4 v[200:203], v38, s[32:35], s23 offen offset:0 sc1
  v_accvgpr_read_b32 v152, a84
  v_mfma_f32_16x16x32_bf16 v[84:87], a[204:207], a[128:131], v[84:87]
  ds_read_b64_tr_b16 a[196:197], v209 offset:8192
  ds_read_b64_tr_b16 a[198:199], v209 offset:12288
  v_accvgpr_read_b32 v153, a85
  v_mfma_f32_16x16x32_bf16 v[92:95], a[204:207], a[132:135], v[92:95]
  v_accvgpr_read_b32 v154, a86
  v_accvgpr_read_b32 v155, a87
  s_waitcnt lgkmcnt(8)
  v_mfma_f32_16x16x32_bf16 v[96:99], a[208:211], a[128:131], v[96:99]
  ds_read_b64_tr_b16 a[200:201], v210 offset:8192
  ds_read_b64_tr_b16 a[202:203], v210 offset:12288
  v_accvgpr_read_b32 v156, a92
  v_mfma_f32_16x16x32_bf16 v[104:107], a[208:211], a[132:135], v[104:107]
  buffer_load_dwordx4 a[188:191], v3, s[12:15], s18 offen offset:3072 sc1
  s_add_u32 s18, s18, 4096
  v_accvgpr_read_b32 v157, a93
  v_accvgpr_read_b32 v158, a94
  v_mfma_f32_16x16x32_bf16 v[100:103], a[212:215], a[128:131], v[100:103]
  ds_read_b64_tr_b16 a[204:205], v211 offset:8192
  ds_read_b64_tr_b16 a[206:207], v211 offset:12288
  v_accvgpr_read_b32 v159, a95
  v_mul_f32 v152, v152, v29
  v_mfma_f32_16x16x32_bf16 v[108:111], a[212:215], a[132:135], v[108:111]
  s_add_u32 m0, s19, 32768
  v_mul_f32 v153, v153, v29
  s_waitcnt lgkmcnt(8)
  v_mfma_f32_16x16x32_bf16 v[112:115], a[216:219], a[128:131], v[112:115]
  ds_read_b64_tr_b16 a[208:209], v212 offset:8192
  ds_read_b64_tr_b16 a[210:211], v212 offset:12288
  v_mul_f32 v154, v154, v29
  v_mul_f32 v155, v155, v29
  v_mfma_f32_16x16x32_bf16 v[120:123], a[216:219], a[132:135], v[120:123]
  buffer_load_dwordx4 v4, s[8:11], s17 offen offset:0 lds
  v_mul_f32 v156, v156, v29
  v_mul_f32 v157, v157, v29
  v_mfma_f32_16x16x32_bf16 v[116:119], a[220:223], a[128:131], v[116:119]
  ds_read_b64_tr_b16 a[212:213], v213 offset:8192
  ds_read_b64_tr_b16 a[214:215], v213 offset:12288
  v_mul_f32 v158, v158, v29
  v_mfma_f32_16x16x32_bf16 v[124:127], a[220:223], a[132:135], v[124:127]
  v_mul_f32 v159, v159, v29
  v_cvt_pk_bf16_f32 v204, v152, v153
  s_waitcnt vmcnt(32) lgkmcnt(8)
  v_mfma_f32_16x16x32_bf16 v[64:67], a[192:195], a[136:139], v[64:67]
  ds_read_b64_tr_b16 a[216:217], v214 offset:8192
  ds_read_b64_tr_b16 a[218:219], v214 offset:12288
  v_cvt_pk_bf16_f32 v205, v154, v155
  v_mfma_f32_16x16x32_bf16 v[72:75], a[192:195], a[140:143], v[72:75]
  buffer_load_dwordx4 v5, s[8:11], s17 offen offset:1024 lds
  v_cvt_pk_bf16_f32 v206, v156, v157
  v_cvt_pk_bf16_f32 v207, v158, v159
  v_mfma_f32_16x16x32_bf16 v[68:71], a[196:199], a[136:139], v[68:71]
  ds_read_b64_tr_b16 a[220:221], v215 offset:8192
  ds_read_b64_tr_b16 a[222:223], v215 offset:12288
  buffer_store_dwordx4 v[204:207], v38, s[32:35], s23 offen offset:512 sc1
  v_accvgpr_read_b32 v160, a96
  v_mfma_f32_16x16x32_bf16 v[76:79], a[196:199], a[140:143], v[76:79]
  v_accvgpr_read_b32 v161, a97
  s_waitcnt lgkmcnt(8)
  v_mfma_f32_16x16x32_bf16 v[80:83], a[200:203], a[136:139], v[80:83]
  s_barrier
  ds_read_b64_tr_b16 a[192:193], v208 offset:16384
  ds_read_b64_tr_b16 a[194:195], v208 offset:20480
  v_accvgpr_read_b32 v162, a98
  v_accvgpr_read_b32 v163, a99
  v_mfma_f32_16x16x32_bf16 v[88:91], a[200:203], a[140:143], v[88:91]
  buffer_load_dwordx4 v6, s[8:11], s17 offen offset:2048 lds
  v_accvgpr_read_b32 v164, a104
  v_mfma_f32_16x16x32_bf16 v[84:87], a[204:207], a[136:139], v[84:87]
  ds_read_b64_tr_b16 a[196:197], v209 offset:16384
  ds_read_b64_tr_b16 a[198:199], v209 offset:20480
  v_accvgpr_read_b32 v165, a105
  v_accvgpr_read_b32 v166, a106
  v_mfma_f32_16x16x32_bf16 v[92:95], a[204:207], a[140:143], v[92:95]
  v_accvgpr_read_b32 v167, a107
  v_mul_f32 v160, v160, v28
  s_waitcnt lgkmcnt(8)
  v_mfma_f32_16x16x32_bf16 v[96:99], a[208:211], a[136:139], v[96:99]
  ds_read_b64_tr_b16 a[200:201], v210 offset:16384
  ds_read_b64_tr_b16 a[202:203], v210 offset:20480
  v_mul_f32 v161, v161, v28
  v_mfma_f32_16x16x32_bf16 v[104:107], a[208:211], a[140:143], v[104:107]
  buffer_load_dwordx4 v7, s[8:11], s17 offen offset:3072 lds
  s_add_u32 s17, s17, 131072
  v_mul_f32 v162, v162, v28
  v_mul_f32 v163, v163, v28
  v_mfma_f32_16x16x32_bf16 v[100:103], a[212:215], a[136:139], v[100:103]
  ds_read_b64_tr_b16 a[204:205], v211 offset:16384
  ds_read_b64_tr_b16 a[206:207], v211 offset:20480
  v_mul_f32 v164, v164, v28
  v_mul_f32 v165, v165, v28
  v_mfma_f32_16x16x32_bf16 v[108:111], a[212:215], a[140:143], v[108:111]
  v_mul_f32 v166, v166, v28
  s_waitcnt lgkmcnt(8)
  v_mfma_f32_16x16x32_bf16 v[112:115], a[216:219], a[136:139], v[112:115]
  ds_read_b64_tr_b16 a[208:209], v212 offset:16384
  ds_read_b64_tr_b16 a[210:211], v212 offset:20480
  v_mul_f32 v167, v167, v28
  v_cvt_pk_bf16_f32 v192, v160, v161
  v_mfma_f32_16x16x32_bf16 v[120:123], a[216:219], a[140:143], v[120:123]
  buffer_load_dwordx4 a[128:131], v3, s[12:15], s18 offen offset:0 sc1
  v_cvt_pk_bf16_f32 v193, v162, v163
  v_mfma_f32_16x16x32_bf16 v[116:119], a[220:223], a[136:139], v[116:119]
  ds_read_b64_tr_b16 a[212:213], v213 offset:16384
  ds_read_b64_tr_b16 a[214:215], v213 offset:20480
  v_cvt_pk_bf16_f32 v194, v164, v165
  v_cvt_pk_bf16_f32 v195, v166, v167
  v_mfma_f32_16x16x32_bf16 v[124:127], a[220:223], a[140:143], v[124:127]
  buffer_store_dwordx4 v[192:195], v38, s[32:35], s65 offen offset:2048 sc1
  v_accvgpr_read_b32 v168, a100
  s_waitcnt vmcnt(31) lgkmcnt(8)
  v_mfma_f32_16x16x32_bf16 v[64:67], a[192:195], a[144:147], v[64:67]
  ds_read_b64_tr_b16 a[216:217], v214 offset:16384
  ds_read_b64_tr_b16 a[218:219], v214 offset:20480
  v_accvgpr_read_b32 v169, a101
  v_mfma_f32_16x16x32_bf16 v[72:75], a[192:195], a[148:151], v[72:75]
  buffer_load_dwordx4 a[132:135], v3, s[12:15], s18 offen offset:1024 sc1
  v_accvgpr_read_b32 v170, a102
  v_accvgpr_read_b32 v171, a103
  v_mfma_f32_16x16x32_bf16 v[68:71], a[196:199], a[144:147], v[68:71]
  ds_read_b64_tr_b16 a[220:221], v215 offset:16384
  ds_read_b64_tr_b16 a[222:223], v215 offset:20480
  v_accvgpr_read_b32 v172, a108
  v_mfma_f32_16x16x32_bf16 v[76:79], a[196:199], a[148:151], v[76:79]
  v_accvgpr_read_b32 v173, a109
  v_accvgpr_read_b32 v174, a110
  s_waitcnt lgkmcnt(8)
  v_mfma_f32_16x16x32_bf16 v[80:83], a[200:203], a[144:147], v[80:83]
  ds_read_b64_tr_b16 a[192:193], v208 offset:24576
  ds_read_b64_tr_b16 a[194:195], v208 offset:28672
  v_accvgpr_read_b32 v175, a111
  v_mul_f32 v168, v168, v28
  v_mfma_f32_16x16x32_bf16 v[88:91], a[200:203], a[148:151], v[88:91]
  buffer_load_dwordx4 a[136:139], v3, s[12:15], s18 offen offset:2048 sc1
  v_mul_f32 v169, v169, v28
  v_mfma_f32_16x16x32_bf16 v[84:87], a[204:207], a[144:147], v[84:87]
  ds_read_b64_tr_b16 a[196:197], v209 offset:24576
  ds_read_b64_tr_b16 a[198:199], v209 offset:28672
  v_mul_f32 v170, v170, v28
  v_mul_f32 v171, v171, v28
  v_mfma_f32_16x16x32_bf16 v[92:95], a[204:207], a[148:151], v[92:95]
  v_mul_f32 v172, v172, v28
  s_waitcnt lgkmcnt(8)
  v_mfma_f32_16x16x32_bf16 v[96:99], a[208:211], a[144:147], v[96:99]
  ds_read_b64_tr_b16 a[200:201], v210 offset:24576
  ds_read_b64_tr_b16 a[202:203], v210 offset:28672
  v_mul_f32 v173, v173, v28
  v_mul_f32 v174, v174, v28
  v_mfma_f32_16x16x32_bf16 v[104:107], a[208:211], a[148:151], v[104:107]
  buffer_load_dwordx4 a[140:143], v3, s[12:15], s18 offen offset:3072 sc1
  s_add_u32 s18, s18, 4096
  v_mul_f32 v175, v175, v28
  v_cvt_pk_bf16_f32 v196, v168, v169
  v_mfma_f32_16x16x32_bf16 v[100:103], a[212:215], a[144:147], v[100:103]
  ds_read_b64_tr_b16 a[204:205], v211 offset:24576
  ds_read_b64_tr_b16 a[206:207], v211 offset:28672
  v_cvt_pk_bf16_f32 v197, v170, v171
  v_mfma_f32_16x16x32_bf16 v[108:111], a[212:215], a[148:151], v[108:111]
  s_add_u32 m0, s19, 49152
  v_cvt_pk_bf16_f32 v198, v172, v173
  v_cvt_pk_bf16_f32 v199, v174, v175
  s_waitcnt lgkmcnt(8)
  v_mfma_f32_16x16x32_bf16 v[112:115], a[216:219], a[144:147], v[112:115]
  ds_read_b64_tr_b16 a[208:209], v212 offset:24576
  ds_read_b64_tr_b16 a[210:211], v212 offset:28672
  buffer_store_dwordx4 v[196:199], v38, s[32:35], s65 offen offset:2560 sc1
  v_accvgpr_read_b32 v176, a112
  v_mfma_f32_16x16x32_bf16 v[120:123], a[216:219], a[148:151], v[120:123]
  buffer_load_dwordx4 v4, s[8:11], s17 offen offset:0 lds
  v_accvgpr_read_b32 v177, a113
  v_mfma_f32_16x16x32_bf16 v[116:119], a[220:223], a[144:147], v[116:119]
  ds_read_b64_tr_b16 a[212:213], v213 offset:24576
  ds_read_b64_tr_b16 a[214:215], v213 offset:28672
  v_accvgpr_read_b32 v178, a114
  v_accvgpr_read_b32 v179, a115
  v_mfma_f32_16x16x32_bf16 v[124:127], a[220:223], a[148:151], v[124:127]
  v_accvgpr_read_b32 v180, a120
  s_waitcnt vmcnt(33) lgkmcnt(8)
  v_mfma_f32_16x16x32_bf16 v[64:67], a[192:195], a[152:155], v[64:67]
  ds_read_b64_tr_b16 a[216:217], v214 offset:24576
  ds_read_b64_tr_b16 a[218:219], v214 offset:28672
  v_accvgpr_read_b32 v181, a121
  v_accvgpr_read_b32 v182, a122
  v_mfma_f32_16x16x32_bf16 v[72:75], a[192:195], a[156:159], v[72:75]
  buffer_load_dwordx4 v5, s[8:11], s17 offen offset:1024 lds
  v_accvgpr_read_b32 v183, a123
  v_mul_f32 v176, v176, v29
  v_mfma_f32_16x16x32_bf16 v[68:71], a[196:199], a[152:155], v[68:71]
  ds_read_b64_tr_b16 a[220:221], v215 offset:24576
  ds_read_b64_tr_b16 a[222:223], v215 offset:28672
  v_mul_f32 v177, v177, v29
  v_mfma_f32_16x16x32_bf16 v[76:79], a[196:199], a[156:159], v[76:79]
  v_mul_f32 v178, v178, v29
  v_mul_f32 v179, v179, v29
  s_waitcnt lgkmcnt(8)
  v_mfma_f32_16x16x32_bf16 v[80:83], a[200:203], a[152:155], v[80:83]
  s_barrier
  ds_read_b64_tr_b16 a[192:193], v208 offset:32768
  ds_read_b64_tr_b16 a[194:195], v208 offset:36864
  v_mul_f32 v180, v180, v29
  v_mfma_f32_16x16x32_bf16 v[88:91], a[200:203], a[156:159], v[88:91]
  buffer_load_dwordx4 v6, s[8:11], s17 offen offset:2048 lds
  v_mul_f32 v181, v181, v29
  v_mul_f32 v182, v182, v29
  v_mfma_f32_16x16x32_bf16 v[84:87], a[204:207], a[152:155], v[84:87]
  ds_read_b64_tr_b16 a[196:197], v209 offset:32768
  ds_read_b64_tr_b16 a[198:199], v209 offset:36864
  v_mul_f32 v183, v183, v29
  v_cvt_pk_bf16_f32 v200, v176, v177
  v_mfma_f32_16x16x32_bf16 v[92:95], a[204:207], a[156:159], v[92:95]
  v_cvt_pk_bf16_f32 v201, v178, v179
  s_waitcnt lgkmcnt(8)
  v_mfma_f32_16x16x32_bf16 v[96:99], a[208:211], a[152:155], v[96:99]
  ds_read_b64_tr_b16 a[200:201], v210 offset:32768
  ds_read_b64_tr_b16 a[202:203], v210 offset:36864
  v_cvt_pk_bf16_f32 v202, v180, v181
  v_cvt_pk_bf16_f32 v203, v182, v183
  v_mfma_f32_16x16x32_bf16 v[104:107], a[208:211], a[156:159], v[104:107]
  buffer_load_dwordx4 v7, s[8:11], s17 offen offset:3072 lds
  s_add_u32 s17, s17, 131072
  buffer_store_dwordx4 v[200:203], v38, s[32:35], s23 offen offset:2048 sc1
  v_accvgpr_read_b32 v184, a116
  v_mfma_f32_16x16x32_bf16 v[100:103], a[212:215], a[152:155], v[100:103]
  ds_read_b64_tr_b16 a[204:205], v211 offset:32768
  ds_read_b64_tr_b16 a[206:207], v211 offset:36864
  v_accvgpr_read_b32 v185, a117
  v_mfma_f32_16x16x32_bf16 v[108:111], a[212:215], a[156:159], v[108:111]
  v_accvgpr_read_b32 v186, a118
  v_accvgpr_read_b32 v187, a119
  s_waitcnt lgkmcnt(8)
  v_mfma_f32_16x16x32_bf16 v[112:115], a[216:219], a[152:155], v[112:115]
  ds_read_b64_tr_b16 a[208:209], v212 offset:32768
  ds_read_b64_tr_b16 a[210:211], v212 offset:36864
  v_accvgpr_read_b32 v188, a124
  v_mfma_f32_16x16x32_bf16 v[120:123], a[216:219], a[156:159], v[120:123]
  buffer_load_dwordx4 a[144:147], v3, s[12:15], s18 offen offset:0 sc1
  v_accvgpr_read_b32 v189, a125
  v_accvgpr_read_b32 v190, a126
  v_mfma_f32_16x16x32_bf16 v[116:119], a[220:223], a[152:155], v[116:119]
  ds_read_b64_tr_b16 a[212:213], v213 offset:32768
  ds_read_b64_tr_b16 a[214:215], v213 offset:36864
  v_accvgpr_read_b32 v191, a127
  v_mul_f32 v184, v184, v29
  v_mfma_f32_16x16x32_bf16 v[124:127], a[220:223], a[156:159], v[124:127]
  v_mul_f32 v185, v185, v29
  s_waitcnt vmcnt(30) lgkmcnt(8)
  v_mfma_f32_16x16x32_bf16 v[64:67], a[192:195], a[160:163], v[64:67]
  ds_read_b64_tr_b16 a[216:217], v214 offset:32768
  ds_read_b64_tr_b16 a[218:219], v214 offset:36864
  v_mul_f32 v186, v186, v29
  v_mul_f32 v187, v187, v29
  v_mfma_f32_16x16x32_bf16 v[72:75], a[192:195], a[164:167], v[72:75]
  buffer_load_dwordx4 a[148:151], v3, s[12:15], s18 offen offset:1024 sc1
  v_mul_f32 v188, v188, v29
  v_mfma_f32_16x16x32_bf16 v[68:71], a[196:199], a[160:163], v[68:71]
  ds_read_b64_tr_b16 a[220:221], v215 offset:32768
  ds_read_b64_tr_b16 a[222:223], v215 offset:36864
  v_mul_f32 v189, v189, v29
  v_mul_f32 v190, v190, v29
  v_mfma_f32_16x16x32_bf16 v[76:79], a[196:199], a[164:167], v[76:79]
  v_mul_f32 v191, v191, v29
  v_cvt_pk_bf16_f32 v204, v184, v185
  s_waitcnt lgkmcnt(8)
  v_mfma_f32_16x16x32_bf16 v[80:83], a[200:203], a[160:163], v[80:83]
  ds_read_b64_tr_b16 a[192:193], v208 offset:40960
  ds_read_b64_tr_b16 a[194:195], v208 offset:45056
  v_cvt_pk_bf16_f32 v205, v186, v187
  v_mfma_f32_16x16x32_bf16 v[88:91], a[200:203], a[164:167], v[88:91]
  buffer_load_dwordx4 a[152:155], v3, s[12:15], s18 offen offset:2048 sc1
  v_cvt_pk_bf16_f32 v206, v188, v189
  v_cvt_pk_bf16_f32 v207, v190, v191
  v_mfma_f32_16x16x32_bf16 v[84:87], a[204:207], a[160:163], v[84:87]
  ds_read_b64_tr_b16 a[196:197], v209 offset:40960
  ds_read_b64_tr_b16 a[198:199], v209 offset:45056
  buffer_store_dwordx4 v[204:207], v38, s[32:35], s23 offen offset:2560 sc1
  v_add_u32 v60, 512, v60
  v_mfma_f32_16x16x32_bf16 v[92:95], a[204:207], a[164:167], v[92:95]
  s_waitcnt lgkmcnt(8)
  v_mfma_f32_16x16x32_bf16 v[96:99], a[208:211], a[160:163], v[96:99]
  ds_read_b64_tr_b16 a[200:201], v210 offset:40960
  ds_read_b64_tr_b16 a[202:203], v210 offset:45056
  v_mfma_f32_16x16x32_bf16 v[104:107], a[208:211], a[164:167], v[104:107]
  buffer_load_dwordx4 a[156:159], v3, s[12:15], s18 offen offset:3072 sc1
  s_add_u32 s18, s18, 4096
  v_mfma_f32_16x16x32_bf16 v[100:103], a[212:215], a[160:163], v[100:103]
  ds_read_b64_tr_b16 a[204:205], v211 offset:40960
  ds_read_b64_tr_b16 a[206:207], v211 offset:45056
  v_mfma_f32_16x16x32_bf16 v[108:111], a[212:215], a[164:167], v[108:111]
  s_add_u32 m0, s19, 65536
  s_waitcnt lgkmcnt(8)
  v_mfma_f32_16x16x32_bf16 v[112:115], a[216:219], a[160:163], v[112:115]
  ds_read_b64_tr_b16 a[208:209], v212 offset:40960
  ds_read_b64_tr_b16 a[210:211], v212 offset:45056
  v_mfma_f32_16x16x32_bf16 v[120:123], a[216:219], a[164:167], v[120:123]
  buffer_load_dwordx4 v4, s[8:11], s17 offen offset:0 lds
  v_mfma_f32_16x16x32_bf16 v[116:119], a[220:223], a[160:163], v[116:119]
  ds_read_b64_tr_b16 a[212:213], v213 offset:40960
  ds_read_b64_tr_b16 a[214:215], v213 offset:45056
  v_mfma_f32_16x16x32_bf16 v[124:127], a[220:223], a[164:167], v[124:127]
  s_waitcnt vmcnt(33) lgkmcnt(8)
  v_mfma_f32_16x16x32_bf16 v[64:67], a[192:195], a[168:171], v[64:67]
  ds_read_b64_tr_b16 a[216:217], v214 offset:40960
  ds_read_b64_tr_b16 a[218:219], v214 offset:45056
  v_mfma_f32_16x16x32_bf16 v[72:75], a[192:195], a[172:175], v[72:75]
  buffer_load_dwordx4 v5, s[8:11], s17 offen offset:1024 lds
  v_mfma_f32_16x16x32_bf16 v[68:71], a[196:199], a[168:171], v[68:71]
  ds_read_b64_tr_b16 a[220:221], v215 offset:40960
  ds_read_b64_tr_b16 a[222:223], v215 offset:45056
  v_mfma_f32_16x16x32_bf16 v[76:79], a[196:199], a[172:175], v[76:79]
  s_waitcnt lgkmcnt(8)
  v_mfma_f32_16x16x32_bf16 v[80:83], a[200:203], a[168:171], v[80:83]
  s_barrier
  ds_read_b64_tr_b16 a[192:193], v208 offset:49152
  ds_read_b64_tr_b16 a[194:195], v208 offset:53248
  v_mfma_f32_16x16x32_bf16 v[88:91], a[200:203], a[172:175], v[88:91]
  buffer_load_dwordx4 v6, s[8:11], s17 offen offset:2048 lds
  v_mfma_f32_16x16x32_bf16 v[84:87], a[204:207], a[168:171], v[84:87]
  ds_read_b64_tr_b16 a[196:197], v209 offset:49152
  ds_read_b64_tr_b16 a[198:199], v209 offset:53248
  v_mfma_f32_16x16x32_bf16 v[92:95], a[204:207], a[172:175], v[92:95]
  s_waitcnt lgkmcnt(8)
  v_mfma_f32_16x16x32_bf16 v[96:99], a[208:211], a[168:171], v[96:99]
  ds_read_b64_tr_b16 a[200:201], v210 offset:49152
  ds_read_b64_tr_b16 a[202:203], v210 offset:53248
  v_mfma_f32_16x16x32_bf16 v[104:107], a[208:211], a[172:175], v[104:107]
  buffer_load_dwordx4 v7, s[8:11], s17 offen offset:3072 lds
  s_add_u32 s17, s17, 131072
  v_mfma_f32_16x16x32_bf16 v[100:103], a[212:215], a[168:171], v[100:103]
  ds_read_b64_tr_b16 a[204:205], v211 offset:49152
  ds_read_b64_tr_b16 a[206:207], v211 offset:53248
  v_mfma_f32_16x16x32_bf16 v[108:111], a[212:215], a[172:175], v[108:111]
  s_waitcnt lgkmcnt(8)
  v_mfma_f32_16x16x32_bf16 v[112:115], a[216:219], a[168:171], v[112:115]
  ds_read_b64_tr_b16 a[208:209], v212 offset:49152
  ds_read_b64_tr_b16 a[210:211], v212 offset:53248
  v_mfma_f32_16x16x32_bf16 v[120:123], a[216:219], a[172:175], v[120:123]
  buffer_load_dwordx4 a[160:163], v3, s[12:15], s18 offen offset:0 sc1
  v_mfma_f32_16x16x32_bf16 v[116:119], a[220:223], a[168:171], v[116:119]
  ds_read_b64_tr_b16 a[212:213], v213 offset:49152
  ds_read_b64_tr_b16 a[214:215], v213 offset:53248
  v_mfma_f32_16x16x32_bf16 v[124:127], a[220:223], a[172:175], v[124:127]
  s_waitcnt vmcnt(29) lgkmcnt(8)
  v_mfma_f32_16x16x32_bf16 v[64:67], a[192:195], a[176:179], v[64:67]
  ds_read_b64_tr_b16 a[216:217], v214 offset:49152
  ds_read_b64_tr_b16 a[218:219], v214 offset:53248
  v_mfma_f32_16x16x32_bf16 v[72:75], a[192:195], a[180:183], v[72:75]
  buffer_load_dwordx4 a[164:167], v3, s[12:15], s18 offen offset:1024 sc1
  v_mfma_f32_16x16x32_bf16 v[68:71], a[196:199], a[176:179], v[68:71]
  ds_read_b64_tr_b16 a[220:221], v215 offset:49152
  ds_read_b64_tr_b16 a[222:223], v215 offset:53248
  v_mfma_f32_16x16x32_bf16 v[76:79], a[196:199], a[180:183], v[76:79]
  s_waitcnt lgkmcnt(8)
  v_mfma_f32_16x16x32_bf16 v[80:83], a[200:203], a[176:179], v[80:83]
  ds_read_b64_tr_b16 a[192:193], v208 offset:57344
  ds_read_b64_tr_b16 a[194:195], v208 offset:61440
  v_mfma_f32_16x16x32_bf16 v[88:91], a[200:203], a[180:183], v[88:91]
  buffer_load_dwordx4 a[168:171], v3, s[12:15], s18 offen offset:2048 sc1
  v_mfma_f32_16x16x32_bf16 v[84:87], a[204:207], a[176:179], v[84:87]
  ds_read_b64_tr_b16 a[196:197], v209 offset:57344
  ds_read_b64_tr_b16 a[198:199], v209 offset:61440
  v_mfma_f32_16x16x32_bf16 v[92:95], a[204:207], a[180:183], v[92:95]
  s_waitcnt lgkmcnt(8)
  v_mfma_f32_16x16x32_bf16 v[96:99], a[208:211], a[176:179], v[96:99]
  ds_read_b64_tr_b16 a[200:201], v210 offset:57344
  ds_read_b64_tr_b16 a[202:203], v210 offset:61440
  v_mfma_f32_16x16x32_bf16 v[104:107], a[208:211], a[180:183], v[104:107]
  buffer_load_dwordx4 a[172:175], v3, s[12:15], s18 offen offset:3072 sc1
  s_add_u32 s18, s18, 4096
  v_mfma_f32_16x16x32_bf16 v[100:103], a[212:215], a[176:179], v[100:103]
  ds_read_b64_tr_b16 a[204:205], v211 offset:57344
  ds_read_b64_tr_b16 a[206:207], v211 offset:61440
  v_mfma_f32_16x16x32_bf16 v[108:111], a[212:215], a[180:183], v[108:111]
  s_add_u32 m0, s19, 81920
  s_waitcnt lgkmcnt(8)
  v_mfma_f32_16x16x32_bf16 v[112:115], a[216:219], a[176:179], v[112:115]
  ds_read_b64_tr_b16 a[208:209], v212 offset:57344
  ds_read_b64_tr_b16 a[210:211], v212 offset:61440
  v_mfma_f32_16x16x32_bf16 v[120:123], a[216:219], a[180:183], v[120:123]
  buffer_load_dwordx4 v4, s[8:11], s17 offen offset:0 lds
  v_mfma_f32_16x16x32_bf16 v[116:119], a[220:223], a[176:179], v[116:119]
  ds_read_b64_tr_b16 a[212:213], v213 offset:57344
  ds_read_b64_tr_b16 a[214:215], v213 offset:61440
  v_mfma_f32_16x16x32_bf16 v[124:127], a[220:223], a[180:183], v[124:127]
  s_waitcnt vmcnt(30) lgkmcnt(8)
  v_mfma_f32_16x16x32_bf16 v[64:67], a[192:195], a[184:187], v[64:67]
  ds_read_b64_tr_b16 a[216:217], v214 offset:57344
  ds_read_b64_tr_b16 a[218:219], v214 offset:61440
  v_mfma_f32_16x16x32_bf16 v[72:75], a[192:195], a[188:191], v[72:75]
  buffer_load_dwordx4 v5, s[8:11], s17 offen offset:1024 lds
  v_mfma_f32_16x16x32_bf16 v[68:71], a[196:199], a[184:187], v[68:71]
  ds_read_b64_tr_b16 a[220:221], v215 offset:57344
  ds_read_b64_tr_b16 a[222:223], v215 offset:61440
  v_mfma_f32_16x16x32_bf16 v[76:79], a[196:199], a[188:191], v[76:79]
  s_waitcnt lgkmcnt(8)
  v_mfma_f32_16x16x32_bf16 v[80:83], a[200:203], a[184:187], v[80:83]
  s_waitcnt vmcnt(11)
  s_barrier
  s_cmp_lg_u32 s16, 0
  s_cbranch_scc1 L_mk5_nopub_21
  v_mov_b32 v1, s101
  v_mov_b32 v56, s42
  s_mov_b64 exec, 1
  buffer_store_dword v56, v1, s[52:55], 0 offen sc1
  s_mov_b64 exec, -1
  s_nop 3
L_mk5_nopub_21:
  ds_read_b64_tr_b16 a[192:193], v8 offset:0
  ds_read_b64_tr_b16 a[194:195], v8 offset:4096
  v_mfma_f32_16x16x32_bf16 v[88:91], a[200:203], a[188:191], v[88:91]
  buffer_load_dwordx4 v6, s[8:11], s17 offen offset:2048 lds
  v_mfma_f32_16x16x32_bf16 v[84:87], a[204:207], a[184:187], v[84:87]
  ds_read_b64_tr_b16 a[196:197], v9 offset:0
  ds_read_b64_tr_b16 a[198:199], v9 offset:4096
  v_mfma_f32_16x16x32_bf16 v[92:95], a[204:207], a[188:191], v[92:95]
  s_waitcnt lgkmcnt(8)
  v_mfma_f32_16x16x32_bf16 v[96:99], a[208:211], a[184:187], v[96:99]
  ds_read_b64_tr_b16 a[200:201], v10 offset:0
  ds_read_b64_tr_b16 a[202:203], v10 offset:4096
  v_mfma_f32_16x16x32_bf16 v[104:107], a[208:211], a[188:191], v[104:107]
  buffer_load_dwordx4 v7, s[8:11], s17 offen offset:3072 lds
  s_add_u32 s17, s17, 131072
  v_mfma_f32_16x16x32_bf16 v[100:103], a[212:215], a[184:187], v[100:103]
  ds_read_b64_tr_b16 a[204:205], v11 offset:0
  ds_read_b64_tr_b16 a[206:207], v11 offset:4096
  v_mfma_f32_16x16x32_bf16 v[108:111], a[212:215], a[188:191], v[108:111]
  buffer_load_dwordx4 a[176:179], v3, s[12:15], s18 offen offset:0 sc1
  s_waitcnt lgkmcnt(8)
  v_mfma_f32_16x16x32_bf16 v[112:115], a[216:219], a[184:187], v[112:115]
  ds_read_b64_tr_b16 a[208:209], v40 offset:0
  ds_read_b64_tr_b16 a[210:211], v40 offset:4096
  v_mfma_f32_16x16x32_bf16 v[120:123], a[216:219], a[188:191], v[120:123]
  buffer_load_dwordx4 a[180:183], v3, s[12:15], s18 offen offset:1024 sc1
  v_mfma_f32_16x16x32_bf16 v[116:119], a[220:223], a[184:187], v[116:119]
  ds_read_b64_tr_b16 a[212:213], v41 offset:0
  ds_read_b64_tr_b16 a[214:215], v41 offset:4096
  v_mfma_f32_16x16x32_bf16 v[124:127], a[220:223], a[188:191], v[124:127]
  s_mov_b32 s20, 6
L_mk5_p_22:
  s_cmp_eq_u32 s20, 4
  s_cbranch_scc0 L_mk5_c2_23
  v_cmp_ne_u32 vcc, s42, v61
  s_cbranch_vccz L_mk5_c2_23
  s_call_b64 s[48:49], L_poll1
L_mk5_c2_23:
  s_waitcnt vmcnt(24) lgkmcnt(8)
  v_mfma_f32_16x16x32_bf16 v[64:67], a[192:195], a[128:131], v[64:67]
  ds_read_b64_tr_b16 a[216:217], v42 offset:0
  ds_read_b64_tr_b16 a[218:219], v42 offset:4096
  v_mfma_f32_16x16x32_bf16 v[72:75], a[192:195], a[132:135], v[72:75]
  buffer_load_dwordx4 a[184:187], v3, s[12:15], s18 offen offset:2048 sc1
  v_mfma_f32_16x16x32_bf16 v[68:71], a[196:199], a[128:131], v[68:71]
  ds_read_b64_tr_b16 a[220:221], v43 offset:0
  ds_read_b64_tr_b16 a[222:223], v43 offset:4096
  v_mfma_f32_16x16x32_bf16 v[76:79], a[196:199], a[132:135], v[76:79]
  s_waitcnt lgkmcnt(8)
  v_mfma_f32_16x16x32_bf16 v[80:83], a[200:203], a[128:131], v[80:83]
  ds_read_b64_tr_b16 a[192:193], v8 offset:8192
  ds_read_b64_tr_b16 a[194:195], v8 offset:12288
  v_mfma_f32_16x16x32_bf16 v[88:91], a[200:203], a[132:135], v[88:91]
  buffer_load_dwordx4 a[188:191], v3, s[12:15], s18 offen offset:3072 sc1
  s_add_u32 s18, s18, 4096
  v_mfma_f32_16x16x32_bf16 v[84:87], a[204:207], a[128:131], v[84:87]
  ds_read_b64_tr_b16 a[196:197], v9 offset:8192
  ds_read_b64_tr_b16 a[198:199], v9 offset:12288
  v_mfma_f32_16x16x32_bf16 v[92:95], a[204:207], a[132:135], v[92:95]
  s_add_u32 m0, s19, 98304
  s_waitcnt lgkmcnt(8)
  v_mfma_f32_16x16x32_bf16 v[96:99], a[208:211], a[128:131], v[96:99]
  ds_read_b64_tr_b16 a[200:201], v10 offset:8192
  ds_read_b64_tr_b16 a[202:203], v10 offset:12288
  v_mfma_f32_16x16x32_bf16 v[104:107], a[208:211], a[132:135], v[104:107]
  buffer_load_dwordx4 v4, s[8:11], s17 offen offset:0 lds
  v_mfma_f32_16x16x32_bf16 v[100:103], a[212:215], a[128:131], v[100:103]
  ds_read_b64_tr_b16 a[204:205], v11 offset:8192
  ds_read_b64_tr_b16 a[206:207], v11 offset:12288
  v_mfma_f32_16x16x32_bf16 v[108:111], a[212:215], a[132:135], v[108:111]
  s_waitcnt lgkmcnt(8)
  v_mfma_f32_16x16x32_bf16 v[112:115], a[216:219], a[128:131], v[112:115]
  ds_read_b64_tr_b16 a[208:209], v40 offset:8192
  ds_read_b64_tr_b16 a[210:211], v40 offset:12288
  v_mfma_f32_16x16x32_bf16 v[120:123], a[216:219], a[132:135], v[120:123]
  buffer_load_dwordx4 v5, s[8:11], s17 offen offset:1024 lds
  v_mfma_f32_16x16x32_bf16 v[116:119], a[220:223], a[128:131], v[116:119]
  ds_read_b64_tr_b16 a[212:213], v41 offset:8192
  ds_read_b64_tr_b16 a[214:215], v41 offset:12288
  v_mfma_f32_16x16x32_bf16 v[124:127], a[220:223], a[132:135], v[124:127]
  s_waitcnt vmcnt(26) lgkmcnt(8)
  v_mfma_f32_16x16x32_bf16 v[64:67], a[192:195], a[136:139], v[64:67]
  ds_read_b64_tr_b16 a[216:217], v42 offset:8192
  ds_read_b64_tr_b16 a[218:219], v42 offset:12288
  v_mfma_f32_16x16x32_bf16 v[72:75], a[192:195], a[140:143], v[72:75]
  buffer_load_dwordx4 v6, s[8:11], s17 offen offset:2048 lds
  v_mfma_f32_16x16x32_bf16 v[68:71], a[196:199], a[136:139], v[68:71]
  ds_read_b64_tr_b16 a[220:221], v43 offset:8192
  ds_read_b64_tr_b16 a[222:223], v43 offset:12288
  v_mfma_f32_16x16x32_bf16 v[76:79], a[196:199], a[140:143], v[76:79]
  s_waitcnt lgkmcnt(8)
  v_mfma_f32_16x16x32_bf16 v[80:83], a[200:203], a[136:139], v[80:83]
  s_barrier
  ds_read_b64_tr_b16 a[192:193], v8 offset:16384
  ds_read_b64_tr_b16 a[194:195], v8 offset:20480
  v_mfma_f32_16x16x32_bf16 v[88:91], a[200:203], a[140:143], v[88:91]
  buffer_load_dwordx4 v7, s[8:11], s17 offen offset:3072 lds
  s_add_u32 s17, s17, 131072
  v_mfma_f32_16x16x32_bf16 v[84:87], a[204:207], a[136:139], v[84:87]
  ds_read_b64_tr_b16 a[196:197], v9 offset:16384
  ds_read_b64_tr_b16 a[198:199], v9 offset:20480
  v_mfma_f32_16x16x32_bf16 v[92:95], a[204:207], a[140:143], v[92:95]
  s_waitcnt lgkmcnt(8)
  v_mfma_f32_16x16x32_bf16 v[96:99], a[208:211], a[136:139], v[96:99]
  ds_read_b64_tr_b16 a[200:201], v10 offset:16384
  ds_read_b64_tr_b16 a[202:203], v10 offset:20480
  v_mfma_f32_16x16x32_bf16 v[104:107], a[208:211], a[140:143], v[104:107]
  buffer_load_dwordx4 a[128:131], v3, s[12:15], s18 offen offset:0 sc1
  v_mfma_f32_16x16x32_bf16 v[100:103], a[212:215], a[136:139], v[100:103]
  ds_read_b64_tr_b16 a[204:205], v11 offset:16384
  ds_read_b64_tr_b16 a[206:207], v11 offset:20480
  v_mfma_f32_16x16x32_bf16 v[108:111], a[212:215], a[140:143], v[108:111]
  s_waitcnt lgkmcnt(8)
  v_mfma_f32_16x16x32_bf16 v[112:115], a[216:219], a[136:139], v[112:115]
  ds_read_b64_tr_b16 a[208:209], v40 offset:16384
  ds_read_b64_tr_b16 a[210:211], v40 offset:20480
  v_mfma_f32_16x16x32_bf16 v[120:123], a[216:219], a[140:143], v[120:123]
  buffer_load_dwordx4 a[132:135], v3, s[12:15], s18 offen offset:1024 sc1
  v_mfma_f32_16x16x32_bf16 v[116:119], a[220:223], a[136:139], v[116:119]
  ds_read_b64_tr_b16 a[212:213], v41 offset:16384
  ds_read_b64_tr_b16 a[214:215], v41 offset:20480
  v_mfma_f32_16x16x32_bf16 v[124:127], a[220:223], a[140:143], v[124:127]
  s_waitcnt vmcnt(24) lgkmcnt(8)
  v_mfma_f32_16x16x32_bf16 v[64:67], a[192:195], a[144:147], v[64:67]
  ds_read_b64_tr_b16 a[216:217], v42 offset:16384
  ds_read_b64_tr_b16 a[218:219], v42 offset:20480
  v_mfma_f32_16x16x32_bf16 v[72:75], a[192:195], a[148:151], v[72:75]
  buffer_load_dwordx4 a[136:139], v3, s[12:15], s18 offen offset:2048 sc1
  v_mfma_f32_16x16x32_bf16 v[68:71], a[196:199], a[144:147], v[68:71]
  ds_read_b64_tr_b16 a[220:221], v43 offset:16384
  ds_read_b64_tr_b16 a[222:223], v43 offset:20480
  v_mfma_f32_16x16x32_bf16 v[76:79], a[196:199], a[148:151], v[76:79]
  s_waitcnt lgkmcnt(8)
  v_mfma_f32_16x16x32_bf16 v[80:83], a[200:203], a[144:147], v[80:83]
  ds_read_b64_tr_b16 a[192:193], v8 offset:24576
  ds_read_b64_tr_b16 a[194:195], v8 offset:28672
  v_mfma_f32_16x16x32_bf16 v[88:91], a[200:203], a[148:151], v[88:91]
  buffer_load_dwordx4 a[140:143], v3, s[12:15], s18 offen offset:3072 sc1
  s_add_u32 s18, s18, 4096
  v_mfma_f32_16x16x32_bf16 v[84:87], a[204:207], a[144:147], v[84:87]
  ds_read_b64_tr_b16 a[196:197], v9 offset:24576
  ds_read_b64_tr_b16 a[198:199], v9 offset:28672
  v_mfma_f32_16x16x32_bf16 v[92:95], a[204:207], a[148:151], v[92:95]
  s_add_u32 m0, s19, 114688
  s_waitcnt lgkmcnt(8)
  v_mfma_f32_16x16x32_bf16 v[96:99], a[208:211], a[144:147], v[96:99]
  ds_read_b64_tr_b16 a[200:201], v10 offset:24576
  ds_read_b64_tr_b16 a[202:203], v10 offset:28672
  v_mfma_f32_16x16x32_bf16 v[104:107], a[208:211], a[148:151], v[104:107]
  buffer_load_dwordx4 v4, s[8:11], s17 offen offset:0 lds
  v_mfma_f32_16x16x32_bf16 v[100:103], a[212:215], a[144:147], v[100:103]
  ds_read_b64_tr_b16 a[204:205], v11 offset:24576
  ds_read_b64_tr_b16 a[206:207], v11 offset:28672
  v_mfma_f32_16x16x32_bf16 v[108:111], a[212:215], a[148:151], v[108:111]
  s_waitcnt lgkmcnt(8)
  v_mfma_f32_16x16x32_bf16 v[112:115], a[216:219], a[144:147], v[112:115]
  ds_read_b64_tr_b16 a[208:209], v40 offset:24576
  ds_read_b64_tr_b16 a[210:211], v40 offset:28672
  v_mfma_f32_16x16x32_bf16 v[120:123], a[216:219], a[148:151], v[120:123]
  buffer_load_dwordx4 v5, s[8:11], s17 offen offset:1024 lds
  v_mfma_f32_16x16x32_bf16 v[116:119], a[220:223], a[144:147], v[116:119]
  ds_read_b64_tr_b16 a[212:213], v41 offset:24576
  ds_read_b64_tr_b16 a[214:215], v41 offset:28672
  v_mfma_f32_16x16x32_bf16 v[124:127], a[220:223], a[148:151], v[124:127]
  s_waitcnt vmcnt(26) lgkmcnt(8)
  v_mfma_f32_16x16x32_bf16 v[64:67], a[192:195], a[152:155], v[64:67]
  ds_read_b64_tr_b16 a[216:217], v42 offset:24576
  ds_read_b64_tr_b16 a[218:219], v42 offset:28672
  v_mfma_f32_16x16x32_bf16 v[72:75], a[192:195], a[156:159], v[72:75]
  buffer_load_dwordx4 v6, s[8:11], s17 offen offset:2048 lds
  v_mfma_f32_16x16x32_bf16 v[68:71], a[196:199], a[152:155], v[68:71]
  ds_read_b64_tr_b16 a[220:221], v43 offset:24576
  ds_read_b64_tr_b16 a[222:223], v43 offset:28672
  v_mfma_f32_16x16x32_bf16 v[76:79], a[196:199], a[156:159], v[76:79]
  s_waitcnt lgkmcnt(8)
  v_mfma_f32_16x16x32_bf16 v[80:83], a[200:203], a[152:155], v[80:83]
  s_barrier
  ds_read_b64_tr_b16 a[192:193], v8 offset:32768
  ds_read_b64_tr_b16 a[194:195], v8 offset:36864
  v_mfma_f32_16x16x32_bf16 v[88:91], a[200:203], a[156:159], v[88:91]
  buffer_load_dwordx4 v7, s[8:11], s17 offen offset:3072 lds
  s_add_u32 s17, s17, 131072
  v_mfma_f32_16x16x32_bf16 v[84:87], a[204:207], a[152:155], v[84:87]
  ds_read_b64_tr_b16 a[196:197], v9 offset:32768
  ds_read_b64_tr_b16 a[198:199], v9 offset:36864
  v_mfma_f32_16x16x32_bf16 v[92:95], a[204:207], a[156:159], v[92:95]
  s_waitcnt lgkmcnt(8)
  v_mfma_f32_16x16x32_bf16 v[96:99], a[208:211], a[152:155], v[96:99]
  ds_read_b64_tr_b16 a[200:201], v10 offset:32768
  ds_read_b64_tr_b16 a[202:203], v10 offset:36864
  v_mfma_f32_16x16x32_bf16 v[104:107], a[208:211], a[156:159], v[104:107]
  buffer_load_dwordx4 a[144:147], v3, s[12:15], s18 offen offset:0 sc1
  v_mfma_f32_16x16x32_bf16 v[100:103], a[212:215], a[152:155], v[100:103]
  ds_read_b64_tr_b16 a[204:205], v11 offset:32768
  ds_read_b64_tr_b16 a[206:207], v11 offset:36864
  v_mfma_f32_16x16x32_bf16 v[108:111], a[212:215], a[156:159], v[108:111]
  s_waitcnt lgkmcnt(8)
  v_mfma_f32_16x16x32_bf16 v[112:115], a[216:219], a[152:155], v[112:115]
  ds_read_b64_tr_b16 a[208:209], v40 offset:32768
  ds_read_b64_tr_b16 a[210:211], v40 offset:36864
  v_mfma_f32_16x16x32_bf16 v[120:123], a[216:219], a[156:159], v[120:123]
  buffer_load_dwordx4 a[148:151], v3, s[12:15], s18 offen offset:1024 sc1
  v_mfma_f32_16x16x32_bf16 v[116:119], a[220:223], a[152:155], v[116:119]
  ds_read_b64_tr_b16 a[212:213], v41 offset:32768
  ds_read_b64_tr_b16 a[214:215], v41 offset:36864
  v_mfma_f32_16x16x32_bf16 v[124:127], a[220:223], a[156:159], v[124:127]
  s_waitcnt vmcnt(24) lgkmcnt(8)
  v_mfma_f32_16x16x32_bf16 v[64:67], a[192:195], a[160:163], v[64:67]
  ds_read_b64_tr_b16 a[216:217], v42 offset:32768
  ds_read_b64_tr_b16 a[218:219], v42 offset:36864
  v_mfma_f32_16x16x32_bf16 v[72:75], a[192:195], a[164:167], v[72:75]
  buffer_load_dwordx4 a[152:155], v3, s[12:15], s18 offen offset:2048 sc1
  v_mfma_f32_16x16x32_bf16 v[68:71], a[196:199], a[160:163], v[68:71]
  ds_read_b64_tr_b16 a[220:221], v43 offset:32768
  ds_read_b64_tr_b16 a[222:223], v43 offset:36864
  v_mfma_f32_16x16x32_bf16 v[76:79], a[196:199], a[164:167], v[76:79]
  s_waitcnt lgkmcnt(8)
  v_mfma_f32_16x16x32_bf16 v[80:83], a[200:203], a[160:163], v[80:83]
  ds_read_b64_tr_b16 a[192:193], v8 offset:40960
  ds_read_b64_tr_b16 a[194:195], v8 offset:45056
  v_mfma_f32_16x16x32_bf16 v[88:91], a[200:203], a[164:167], v[88:91]
  buffer_load_dwordx4 a[156:159], v3, s[12:15], s18 offen offset:3072 sc1
  s_add_u32 s18, s18, 4096
  v_mfma_f32_16x16x32_bf16 v[84:87], a[204:207], a[160:163], v[84:87]
  ds_read_b64_tr_b16 a[196:197], v9 offset:40960
  ds_read_b64_tr_b16 a[198:199], v9 offset:45056
  v_mfma_f32_16x16x32_bf16 v[92:95], a[204:207], a[164:167], v[92:95]
  s_add_u32 m0, s19, 0
  s_waitcnt lgkmcnt(8)
  v_mfma_f32_16x16x32_bf16 v[96:99], a[208:211], a[160:163], v[96:99]
  ds_read_b64_tr_b16 a[200:201], v10 offset:40960
  ds_read_b64_tr_b16 a[202:203], v10 offset:45056
  v_mfma_f32_16x16x32_bf16 v[104:107], a[208:211], a[164:167], v[104:107]
  buffer_load_dwordx4 v4, s[8:11], s17 offen offset:0 lds
  v_mfma_f32_16x16x32_bf16 v[100:103], a[212:215], a[160:163], v[100:103]
  ds_read_b64_tr_b16 a[204:205], v11 offset:40960
  ds_read_b64_tr_b16 a[206:207], v11 offset:45056
  v_mfma_f32_16x16x32_bf16 v[108:111], a[212:215], a[164:167], v[108:111]
  s_waitcnt lgkmcnt(8)
  v_mfma_f32_16x16x32_bf16 v[112:115], a[216:219], a[160:163], v[112:115]
  ds_read_b64_tr_b16 a[208:209], v40 offset:40960
  ds_read_b64_tr_b16 a[210:211], v40 offset:45056
  v_mfma_f32_16x16x32_bf16 v[120:123], a[216:219], a[164:167], v[120:123]
  buffer_load_dwordx4 v5, s[8:11], s17 offen offset:1024 lds
  v_mfma_f32_16x16x32_bf16 v[116:119], a[220:223], a[160:163], v[116:119]
  ds_read_b64_tr_b16 a[212:213], v41 offset:40960
  ds_read_b64_tr_b16 a[214:215], v41 offset:45056
  v_mfma_f32_16x16x32_bf16 v[124:127], a[220:223], a[164:167], v[124:127]
  s_waitcnt vmcnt(26) lgkmcnt(8)
  v_mfma_f32_16x16x32_bf16 v[64:67], a[192:195], a[168:171], v[64:67]
  ds_read_b64_tr_b16 a[216:217], v42 offset:40960
  ds_read_b64_tr_b16 a[218:219], v42 offset:45056
  v_mfma_f32_16x16x32_bf16 v[72:75], a[192:195], a[172:175], v[72:75]
  buffer_load_dwordx4 v6, s[8:11], s17 offen offset:2048 lds
  v_mfma_f32_16x16x32_bf16 v[68:71], a[196:199], a[168:171], v[68:71]
  ds_read_b64_tr_b16 a[220:221], v43 offset:40960
  ds_read_b64_tr_b16 a[222:223], v43 offset:45056
  v_mfma_f32_16x16x32_bf16 v[76:79], a[196:199], a[172:175], v[76:79]
  s_waitcnt lgkmcnt(8)
  v_mfma_f32_16x16x32_bf16 v[80:83], a[200:203], a[168:171], v[80:83]
  s_barrier
  ds_read_b64_tr_b16 a[192:193], v8 offset:49152
  ds_read_b64_tr_b16 a[194:195], v8 offset:53248
  v_mfma_f32_16x16x32_bf16 v[88:91], a[200:203], a[172:175], v[88:91]
  buffer_load_dwordx4 v7, s[8:11], s17 offen offset:3072 lds
  s_add_u32 s17, s17, 131072
  v_mfma_f32_16x16x32_bf16 v[84:87], a[204:207], a[168:171], v[84:87]
  ds_read_b64_tr_b16 a[196:197], v9 offset:49152
  ds_read_b64_tr_b16 a[198:199], v9 offset:53248
  v_mfma_f32_16x16x32_bf16 v[92:95], a[204:207], a[172:175], v[92:95]
  s_waitcnt lgkmcnt(8)
  v_mfma_f32_16x16x32_bf16 v[96:99], a[208:211], a[168:171], v[96:99]
  ds_read_b64_tr_b16 a[200:201], v10 offset:49152
  ds_read_b64_tr_b16 a[202:203], v10 offset:53248
  v_mfma_f32_16x16x32_bf16 v[104:107], a[208:211], a[172:175], v[104:107]
  buffer_load_dwordx4 a[160:163], v3, s[12:15], s18 offen offset:0 sc1
  v_mfma_f32_16x16x32_bf16 v[100:103], a[212:215], a[168:171], v[100:103]
  ds_read_b64_tr_b16 a[204:205], v11 offset:49152
  ds_read_b64_tr_b16 a[206:207], v11 offset:53248
  v_mfma_f32_16x16x32_bf16 v[108:111], a[212:215], a[172:175], v[108:111]
  s_waitcnt lgkmcnt(8)
  v_mfma_f32_16x16x32_bf16 v[112:115], a[216:219], a[168:171], v[112:115]
  ds_read_b64_tr_b16 a[208:209], v40 offset:49152
  ds_read_b64_tr_b16 a[210:211], v40 offset:53248
  v_mfma_f32_16x16x32_bf16 v[120:123], a[216:219], a[172:175], v[120:123]
  buffer_load_dwordx4 a[164:167], v3, s[12:15], s18 offen offset:1024 sc1
  v_mfma_f32_16x16x32_bf16 v[116:119], a[220:223], a[168:171], v[116:119]
  ds_read_b64_tr_b16 a[212:213], v41 offset:49152
  ds_read_b64_tr_b16 a[214:215], v41 offset:53248
  v_mfma_f32_16x16x32_bf16 v[124:127], a[220:223], a[172:175], v[124:127]
  s_waitcnt vmcnt(24) lgkmcnt(8)
  v_mfma_f32_16x16x32_bf16 v[64:67], a[192:195], a[176:179], v[64:67]
  s_cmp_eq_u32 s20, 5
  s_cbranch_scc0 L_mk5_c1_24
  buffer_load_dword v61, v60, s[52:55], 0 offen sc1
L_mk5_c1_24:
  ds_read_b64_tr_b16 a[216:217], v42 offset:49152
  ds_read_b64_tr_b16 a[218:219], v42 offset:53248
  v_mfma_f32_16x16x32_bf16 v[72:75], a[192:195], a[180:183], v[72:75]
  buffer_load_dwordx4 a[168:171], v3, s[12:15], s18 offen offset:2048 sc1
  v_mfma_f32_16x16x32_bf16 v[68:71], a[196:199], a[176:179], v[68:71]
  ds_read_b64_tr_b16 a[220:221], v43 offset:49152
  ds_read_b64_tr_b16 a[222:223], v43 offset:53248
  v_mfma_f32_16x16x32_bf16 v[76:79], a[196:199], a[180:183], v[76:79]
  s_waitcnt lgkmcnt(8)
  v_mfma_f32_16x16x32_bf16 v[80:83], a[200:203], a[176:179], v[80:83]
  ds_read_b64_tr_b16 a[192:193], v8 offset:57344
  ds_read_b64_tr_b16 a[194:195], v8 offset:61440
  v_mfma_f32_16x16x32_bf16 v[88:91], a[200:203], a[180:183], v[88:91]
  buffer_load_dwordx4 a[172:175], v3, s[12:15], s18 offen offset:3072 sc1
  s_add_u32 s18, s18, 4096
  v_mfma_f32_16x16x32_bf16 v[84:87], a[204:207], a[176:179], v[84:87]
  ds_read_b64_tr_b16 a[196:197], v9 offset:57344
  ds_read_b64_tr_b16 a[198:199], v9 offset:61440
  v_mfma_f32_16x16x32_bf16 v[92:95], a[204:207], a[180:183], v[92:95]
  s_add_u32 m0, s19, 16384
  s_waitcnt lgkmcnt(8)
  v_mfma_f32_16x16x32_bf16 v[96:99], a[208:211], a[176:179], v[96:99]
  ds_read_b64_tr_b16 a[200:201], v10 offset:57344
  ds_read_b64_tr_b16 a[202:203], v10 offset:61440
  v_mfma_f32_16x16x32_bf16 v[104:107], a[208:211], a[180:183], v[104:107]
  buffer_load_dwordx4 v4, s[8:11], s17 offen offset:0 lds
  v_mfma_f32_16x16x32_bf16 v[100:103], a[212:215], a[176:179], v[100:103]
  ds_read_b64_tr_b16 a[204:205], v11 offset:57344
  ds_read_b64_tr_b16 a[206:207], v11 offset:61440
  v_mfma_f32_16x16x32_bf16 v[108:111], a[212:215], a[180:183], v[108:111]
  s_waitcnt lgkmcnt(8)
  v_mfma_f32_16x16x32_bf16 v[112:115], a[216:219], a[176:179], v[112:115]
  ds_read_b64_tr_b16 a[208:209], v40 offset:57344
  ds_read_b64_tr_b16 a[210:211], v40 offset:61440
  v_mfma_f32_16x16x32_bf16 v[120:123], a[216:219], a[180:183], v[120:123]
  buffer_load_dwordx4 v5, s[8:11], s17 offen offset:1024 lds
  v_mfma_f32_16x16x32_bf16 v[116:119], a[220:223], a[176:179], v[116:119]
  ds_read_b64_tr_b16 a[212:213], v41 offset:57344
  ds_read_b64_tr_b16 a[214:215], v41 offset:61440
  v_mfma_f32_16x16x32_bf16 v[124:127], a[220:223], a[180:183], v[124:127]
  s_waitcnt vmcnt(26) lgkmcnt(8)
  v_mfma_f32_16x16x32_bf16 v[64:67], a[192:195], a[184:187], v[64:67]
  ds_read_b64_tr_b16 a[216:217], v42 offset:57344
  ds_read_b64_tr_b16 a[218:219], v42 offset:61440
  v_mfma_f32_16x16x32_bf16 v[72:75], a[192:195], a[188:191], v[72:75]
  buffer_load_dwordx4 v6, s[8:11], s17 offen offset:2048 lds
  v_mfma_f32_16x16x32_bf16 v[68:71], a[196:199], a[184:187], v[68:71]
  ds_read_b64_tr_b16 a[220:221], v43 offset:57344
  ds_read_b64_tr_b16 a[222:223], v43 offset:61440
  v_mfma_f32_16x16x32_bf16 v[76:79], a[196:199], a[188:191], v[76:79]
  s_waitcnt lgkmcnt(8)
  v_mfma_f32_16x16x32_bf16 v[80:83], a[200:203], a[184:187], v[80:83]
  s_barrier
  ds_read_b64_tr_b16 a[192:193], v208 offset:0
  ds_read_b64_tr_b16 a[194:195], v208 offset:4096
  v_mfma_f32_16x16x32_bf16 v[88:91], a[200:203], a[188:191], v[88:91]
  buffer_load_dwordx4 v7, s[8:11], s17 offen offset:3072 lds
  s_add_u32 s17, s17, 131072
  v_mfma_f32_16x16x32_bf16 v[84:87], a[204:207], a[184:187], v[84:87]
  ds_read_b64_tr_b16 a[196:197], v209 offset:0
  ds_read_b64_tr_b16 a[198:199], v209 offset:4096
  v_mfma_f32_16x16x32_bf16 v[92:95], a[204:207], a[188:191], v[92:95]
  s_waitcnt lgkmcnt(8)
  v_mfma_f32_16x16x32_bf16 v[96:99], a[208:211], a[184:187], v[96:99]
  ds_read_b64_tr_b16 a[200:201], v210 offset:0
  ds_read_b64_tr_b16 a[202:203], v210 offset:4096
  v_mfma_f32_16x16x32_bf16 v[104:107], a[208:211], a[188:191], v[104:107]
  buffer_load_dwordx4 a[176:179], v3, s[12:15], s18 offen offset:0 sc1
  v_mfma_f32_16x16x32_bf16 v[100:103], a[212:215], a[184:187], v[100:103]
  ds_read_b64_tr_b16 a[204:205], v211 offset:0
  ds_read_b64_tr_b16 a[206:207], v211 offset:4096
  v_mfma_f32_16x16x32_bf16 v[108:111], a[212:215], a[188:191], v[108:111]
  s_waitcnt lgkmcnt(8)
  v_mfma_f32_16x16x32_bf16 v[112:115], a[216:219], a[184:187], v[112:115]
  ds_read_b64_tr_b16 a[208:209], v212 offset:0
  ds_read_b64_tr_b16 a[210:211], v212 offset:4096
  v_mfma_f32_16x16x32_bf16 v[120:123], a[216:219], a[188:191], v[120:123]
  buffer_load_dwordx4 a[180:183], v3, s[12:15], s18 offen offset:1024 sc1
  v_mfma_f32_16x16x32_bf16 v[116:119], a[220:223], a[184:187], v[116:119]
  ds_read_b64_tr_b16 a[212:213], v213 offset:0
  ds_read_b64_tr_b16 a[214:215], v213 offset:4096
  v_mfma_f32_16x16x32_bf16 v[124:127], a[220:223], a[188:191], v[124:127]
  s_waitcnt vmcnt(24) lgkmcnt(8)
  v_mfma_f32_16x16x32_bf16 v[64:67], a[192:195], a[128:131], v[64:67]
  ds_read_b64_tr_b16 a[216:217], v214 offset:0
  ds_read_b64_tr_b16 a[218:219], v214 offset:4096
  v_mfma_f32_16x16x32_bf16 v[72:75], a[192:195], a[132:135], v[72:75]
  buffer_load_dwordx4 a[184:187], v3, s[12:15], s18 offen offset:2048 sc1
  v_mfma_f32_16x16x32_bf16 v[68:71], a[196:199], a[128:131], v[68:71]
  ds_read_b64_tr_b16 a[220:221], v215 offset:0
  ds_read_b64_tr_b16 a[222:223], v215 offset:4096
  v_mfma_f32_16x16x32_bf16 v[76:79], a[196:199], a[132:135], v[76:79]
  s_waitcnt lgkmcnt(8)
  v_mfma_f32_16x16x32_bf16 v[80:83], a[200:203], a[128:131], v[80:83]
  ds_read_b64_tr_b16 a[192:193], v208 offset:8192
  ds_read_b64_tr_b16 a[194:195], v208 offset:12288
  v_mfma_f32_16x16x32_bf16 v[88:91], a[200:203], a[132:135], v[88:91]
  buffer_load_dwordx4 a[188:191], v3, s[12:15], s18 offen offset:3072 sc1
  s_add_u32 s18, s18, 4096
  v_mfma_f32_16x16x32_bf16 v[84:87], a[204:207], a[128:131], v[84:87]
  ds_read_b64_tr_b16 a[196:197], v209 offset:8192
  ds_read_b64_tr_b16 a[198:199], v209 offset:12288
  v_mfma_f32_16x16x32_bf16 v[92:95], a[204:207], a[132:135], v[92:95]
  s_add_u32 m0, s19, 32768
  s_waitcnt lgkmcnt(8)
  v_mfma_f32_16x16x32_bf16 v[96:99], a[208:211], a[128:131], v[96:99]
  ds_read_b64_tr_b16 a[200:201], v210 offset:8192
  ds_read_b64_tr_b16 a[202:203], v210 offset:12288
  v_mfma_f32_16x16x32_bf16 v[104:107], a[208:211], a[132:135], v[104:107]
  buffer_load_dwordx4 v4, s[8:11], s17 offen offset:0 lds
  v_mfma_f32_16x16x32_bf16 v[100:103], a[212:215], a[128:131], v[100:103]
  ds_read_b64_tr_b16 a[204:205], v211 offset:8192
  ds_read_b64_tr_b16 a[206:207], v211 offset:12288
  v_mfma_f32_16x16x32_bf16 v[108:111], a[212:215], a[132:135], v[108:111]
  s_waitcnt lgkmcnt(8)
  v_mfma_f32_16x16x32_bf16 v[112:115], a[216:219], a[128:131], v[112:115]
  ds_read_b64_tr_b16 a[208:209], v212 offset:8192
  ds_read_b64_tr_b16 a[210:211], v212 offset:12288
  v_mfma_f32_16x16x32_bf16 v[120:123], a[216:219], a[132:135], v[120:123]
  buffer_load_dwordx4 v5, s[8:11], s17 offen offset:1024 lds
  v_mfma_f32_16x16x32_bf16 v[116:119], a[220:223], a[128:131], v[116:119]
  ds_read_b64_tr_b16 a[212:213], v213 offset:8192
  ds_read_b64_tr_b16 a[214:215], v213 offset:12288
  v_mfma_f32_16x16x32_bf16 v[124:127], a[220:223], a[132:135], v[124:127]
  s_waitcnt vmcnt(26) lgkmcnt(8)
  v_mfma_f32_16x16x32_bf16 v[64:67], a[192:195], a[136:139], v[64:67]
  ds_read_b64_tr_b16 a[216:217], v214 offset:8192
  ds_read_b64_tr_b16 a[218:219], v214 offset:12288
  v_mfma_f32_16x16x32_bf16 v[72:75], a[192:195], a[140:143], v[72:75]
  buffer_load_dwordx4 v6, s[8:11], s17 offen offset:2048 lds
  v_mfma_f32_16x16x32_bf16 v[68:71], a[196:199], a[136:139], v[68:71]
  ds_read_b64_tr_b16 a[220:221], v215 offset:8192
  ds_read_b64_tr_b16 a[222:223], v215 offset:12288
  v_mfma_f32_16x16x32_bf16 v[76:79], a[196:199], a[140:143], v[76:79]
  s_waitcnt lgkmcnt(8)
  v_mfma_f32_16x16x32_bf16 v[80:83], a[200:203], a[136:139], v[80:83]
  s_barrier
  ds_read_b64_tr_b16 a[192:193], v208 offset:16384
  ds_read_b64_tr_b16 a[194:195], v208 offset:20480
  v_mfma_f32_16x16x32_bf16 v[88:91], a[200:203], a[140:143], v[88:91]
  buffer_load_dwordx4 v7, s[8:11], s17 offen offset:3072 lds
  s_add_u32 s17, s17, 131072
  v_mfma_f32_16x16x32_bf16 v[84:87], a[204:207], a[136:139], v[84:87]
  ds_read_b64_tr_b16 a[196:197], v209 offset:16384
  ds_read_b64_tr_b16 a[198:199], v209 offset:20480
  v_mfma_f32_16x16x32_bf16 v[92:95], a[204:207], a[140:143], v[92:95]
  s_waitcnt lgkmcnt(8)
  v_mfma_f32_16x16x32_bf16 v[96:99], a[208:211], a[136:139], v[96:99]
  ds_read_b64_tr_b16 a[200:201], v210 offset:16384
  ds_read_b64_tr_b16 a[202:203], v210 offset:20480
  v_mfma_f32_16x16x32_bf16 v[104:107], a[208:211], a[140:143], v[104:107]
  buffer_load_dwordx4 a[128:131], v3, s[12:15], s18 offen offset:0 sc1
  v_mfma_f32_16x16x32_bf16 v[100:103], a[212:215], a[136:139], v[100:103]
  ds_read_b64_tr_b16 a[204:205], v211 offset:16384
  ds_read_b64_tr_b16 a[206:207], v211 offset:20480
  v_mfma_f32_16x16x32_bf16 v[108:111], a[212:215], a[140:143], v[108:111]
  s_waitcnt lgkmcnt(8)
  v_mfma_f32_16x16x32_bf16 v[112:115], a[216:219], a[136:139], v[112:115]
  ds_read_b64_tr_b16 a[208:209], v212 offset:16384
  ds_read_b64_tr_b16 a[210:211], v212 offset:20480
  v_mfma_f32_16x16x32_bf16 v[120:123], a[216:219], a[140:143], v[120:123]
  buffer_load_dwordx4 a[132:135], v3, s[12:15], s18 offen offset:1024 sc1
  v_mfma_f32_16x16x32_bf16 v[116:119], a[220:223], a[136:139], v[116:119]
  ds_read_b64_tr_b16 a[212:213], v213 offset:16384
  ds_read_b64_tr_b16 a[214:215], v213 offset:20480
  v_mfma_f32_16x16x32_bf16 v[124:127], a[220:223], a[140:143], v[124:127]
  s_waitcnt vmcnt(24) lgkmcnt(8)
  v_mfma_f32_16x16x32_bf16 v[64:67], a[192:195], a[144:147], v[64:67]
  ds_read_b64_tr_b16 a[216:217], v214 offset:16384
  ds_read_b64_tr_b16 a[218:219], v214 offset:20480
  v_mfma_f32_16x16x32_bf16 v[72:75], a[192:195], a[148:151], v[72:75]
  buffer_load_dwordx4 a[136:139], v3, s[12:15], s18 offen offset:2048 sc1
  v_mfma_f32_16x16x32_bf16 v[68:71], a[196:199], a[144:147], v[68:71]
  ds_read_b64_tr_b16 a[220:221], v215 offset:16384
  ds_read_b64_tr_b16 a[222:223], v215 offset:20480
  v_mfma_f32_16x16x32_bf16 v[76:79], a[196:199], a[148:151], v[76:79]
  s_waitcnt lgkmcnt(8)
  v_mfma_f32_16x16x32_bf16 v[80:83], a[200:203], a[144:147], v[80:83]
  ds_read_b64_tr_b16 a[192:193], v208 offset:24576
  ds_read_b64_tr_b16 a[194:195], v208 offset:28672
  v_mfma_f32_16x16x32_bf16 v[88:91], a[200:203], a[148:151], v[88:91]
  buffer_load_dwordx4 a[140:143], v3, s[12:15], s18 offen offset:3072 sc1
  s_add_u32 s18, s18, 4096
  v_mfma_f32_16x16x32_bf16 v[84:87], a[204:207], a[144:147], v[84:87]
  ds_read_b64_tr_b16 a[196:197], v209 offset:24576
  ds_read_b64_tr_b16 a[198:199], v209 offset:28672
  v_mfma_f32_16x16x32_bf16 v[92:95], a[204:207], a[148:151], v[92:95]
  s_add_u32 m0, s19, 49152
  s_waitcnt lgkmcnt(8)
  v_mfma_f32_16x16x32_bf16 v[96:99], a[208:211], a[144:147], v[96:99]
  ds_read_b64_tr_b16 a[200:201], v210 offset:24576
  ds_read_b64_tr_b16 a[202:203], v210 offset:28672
  v_mfma_f32_16x16x32_bf16 v[104:107], a[208:211], a[148:151], v[104:107]
  buffer_load_dwordx4 v4, s[8:11], s17 offen offset:0 lds
  v_mfma_f32_16x16x32_bf16 v[100:103], a[212:215], a[144:147], v[100:103]
  ds_read_b64_tr_b16 a[204:205], v211 offset:24576
  ds_read_b64_tr_b16 a[206:207], v211 offset:28672
  v_mfma_f32_16x16x32_bf16 v[108:111], a[212:215], a[148:151], v[108:111]
  s_waitcnt lgkmcnt(8)
  v_mfma_f32_16x16x32_bf16 v[112:115], a[216:219], a[144:147], v[112:115]
  ds_read_b64_tr_b16 a[208:209], v212 offset:24576
  ds_read_b64_tr_b16 a[210:211], v212 offset:28672
  v_mfma_f32_16x16x32_bf16 v[120:123], a[216:219], a[148:151], v[120:123]
  buffer_load_dwordx4 v5, s[8:11], s17 offen offset:1024 lds
  v_mfma_f32_16x16x32_bf16 v[116:119], a[220:223], a[144:147], v[116:119]
  ds_read_b64_tr_b16 a[212:213], v213 offset:24576
  ds_read_b64_tr_b16 a[214:215], v213 offset:28672
  v_mfma_f32_16x16x32_bf16 v[124:127], a[220:223], a[148:151], v[124:127]
  s_waitcnt vmcnt(26) lgkmcnt(8)
  v_mfma_f32_16x16x32_bf16 v[64:67], a[192:195], a[152:155], v[64:67]
  ds_read_b64_tr_b16 a[216:217], v214 offset:24576
  ds_read_b64_tr_b16 a[218:219], v214 offset:28672
  v_mfma_f32_16x16x32_bf16 v[72:75], a[192:195], a[156:159], v[72:75]
  buffer_load_dwordx4 v6, s[8:11], s17 offen offset:2048 lds
  v_mfma_f32_16x16x32_bf16 v[68:71], a[196:199], a[152:155], v[68:71]
  ds_read_b64_tr_b16 a[220:221], v215 offset:24576
  ds_read_b64_tr_b16 a[222:223], v215 offset:28672
  v_mfma_f32_16x16x32_bf16 v[76:79], a[196:199], a[156:159], v[76:79]
  s_waitcnt lgkmcnt(8)
  v_mfma_f32_16x16x32_bf16 v[80:83], a[200:203], a[152:155], v[80:83]
  s_barrier
  ds_read_b64_tr_b16 a[192:193], v208 offset:32768
  ds_read_b64_tr_b16 a[194:195], v208 offset:36864
  v_mfma_f32_16x16x32_bf16 v[88:91], a[200:203], a[156:159], v[88:91]
  buffer_load_dwordx4 v7, s[8:11], s17 offen offset:3072 lds
  s_add_u32 s17, s17, 131072
  v_mfma_f32_16x16x32_bf16 v[84:87], a[204:207], a[152:155], v[84:87]
  ds_read_b64_tr_b16 a[196:197], v209 offset:32768
  ds_read_b64_tr_b16 a[198:199], v209 offset:36864
  v_mfma_f32_16x16x32_bf16 v[92:95], a[204:207], a[156:159], v[92:95]
  s_waitcnt lgkmcnt(8)
  v_mfma_f32_16x16x32_bf16 v[96:99], a[208:211], a[152:155], v[96:99]
  ds_read_b64_tr_b16 a[200:201], v210 offset:32768
  ds_read_b64_tr_b16 a[202:203], v210 offset:36864
  v_mfma_f32_16x16x32_bf16 v[104:107], a[208:211], a[156:159], v[104:107]
  buffer_load_dwordx4 a[144:147], v3, s[12:15], s18 offen offset:0 sc1
  v_mfma_f32_16x16x32_bf16 v[100:103], a[212:215], a[152:155], v[100:103]
  ds_read_b64_tr_b16 a[204:205], v211 offset:32768
  ds_read_b64_tr_b16 a[206:207], v211 offset:36864
  v_mfma_f32_16x16x32_bf16 v[108:111], a[212:215], a[156:159], v[108:111]
  s_waitcnt lgkmcnt(8)
  v_mfma_f32_16x16x32_bf16 v[112:115], a[216:219], a[152:155], v[112:115]
  ds_read_b64_tr_b16 a[208:209], v212 offset:32768
  ds_read_b64_tr_b16 a[210:211], v212 offset:36864
  v_mfma_f32_16x16x32_bf16 v[120:123], a[216:219], a[156:159], v[120:123]
  buffer_load_dwordx4 a[148:151], v3, s[12:15], s18 offen offset:1024 sc1
  v_mfma_f32_16x16x32_bf16 v[116:119], a[220:223], a[152:155], v[116:119]
  ds_read_b64_tr_b16 a[212:213], v213 offset:32768
  ds_read_b64_tr_b16 a[214:215], v213 offset:36864
  v_mfma_f32_16x16x32_bf16 v[124:127], a[220:223], a[156:159], v[124:127]
  s_waitcnt vmcnt(24) lgkmcnt(8)
  v_mfma_f32_16x16x32_bf16 v[64:67], a[192:195], a[160:163], v[64:67]
  ds_read_b64_tr_b16 a[216:217], v214 offset:32768
  ds_read_b64_tr_b16 a[218:219], v214 offset:36864
  v_mfma_f32_16x16x32_bf16 v[72:75], a[192:195], a[164:167], v[72:75]
  buffer_load_dwordx4 a[152:155], v3, s[12:15], s18 offen offset:2048 sc1
  v_mfma_f32_16x16x32_bf16 v[68:71], a[196:199], a[160:163], v[68:71]
  ds_read_b64_tr_b16 a[220:221], v215 offset:32768
  ds_read_b64_tr_b16 a[222:223], v215 offset:36864
  v_mfma_f32_16x16x32_bf16 v[76:79], a[196:199], a[164:167], v[76:79]
  s_waitcnt lgkmcnt(8)
  v_mfma_f32_16x16x32_bf16 v[80:83], a[200:203], a[160:163], v[80:83]
  ds_read_b64_tr_b16 a[192:193], v208 offset:40960
  ds_read_b64_tr_b16 a[194:195], v208 offset:45056
  v_mfma_f32_16x16x32_bf16 v[88:91], a[200:203], a[164:167], v[88:91]
  buffer_load_dwordx4 a[156:159], v3, s[12:15], s18 offen offset:3072 sc1
  s_add_u32 s18, s18, 4096
  v_mfma_f32_16x16x32_bf16 v[84:87], a[204:207], a[160:163], v[84:87]
  ds_read_b64_tr_b16 a[196:197], v209 offset:40960
  ds_read_b64_tr_b16 a[198:199], v209 offset:45056
  v_mfma_f32_16x16x32_bf16 v[92:95], a[204:207], a[164:167], v[92:95]
  s_add_u32 m0, s19, 65536
  s_waitcnt lgkmcnt(8)
  v_mfma_f32_16x16x32_bf16 v[96:99], a[208:211], a[160:163], v[96:99]
  ds_read_b64_tr_b16 a[200:201], v210 offset:40960
  ds_read_b64_tr_b16 a[202:203], v210 offset:45056
  v_mfma_f32_16x16x32_bf16 v[104:107], a[208:211], a[164:167], v[104:107]
  buffer_load_dwordx4 v4, s[8:11], s17 offen offset:0 lds
  v_mfma_f32_16x16x32_bf16 v[100:103], a[212:215], a[160:163], v[100:103]
  ds_read_b64_tr_b16 a[204:205], v211 offset:40960
  ds_read_b64_tr_b16 a[206:207], v211 offset:45056
  v_mfma_f32_16x16x32_bf16 v[108:111], a[212:215], a[164:167], v[108:111]
  s_waitcnt lgkmcnt(8)
  v_mfma_f32_16x16x32_bf16 v[112:115], a[216:219], a[160:163], v[112:115]
  ds_read_b64_tr_b16 a[208:209], v212 offset:40960
  ds_read_b64_tr_b16 a[210:211], v212 offset:45056
  v_mfma_f32_16x16x32_bf16 v[120:123], a[216:219], a[164:167], v[120:123]
  buffer_load_dwordx4 v5, s[8:11], s17 offen offset:1024 lds
  v_mfma_f32_16x16x32_bf16 v[116:119], a[220:223], a[160:163], v[116:119]
  ds_read_b64_tr_b16 a[212:213], v213 offset:40960
  ds_read_b64_tr_b16 a[214:215], v213 offset:45056
  v_mfma_f32_16x16x32_bf16 v[124:127], a[220:223], a[164:167], v[124:127]
  s_waitcnt vmcnt(26) lgkmcnt(8)
  v_mfma_f32_16x16x32_bf16 v[64:67], a[192:195], a[168:171], v[64:67]
  ds_read_b64_tr_b16 a[216:217], v214 offset:40960
  ds_read_b64_tr_b16 a[218:219], v214 offset:45056
  v_mfma_f32_16x16x32_bf16 v[72:75], a[192:195], a[172:175], v[72:75]
  buffer_load_dwordx4 v6, s[8:11], s17 offen offset:2048 lds
  v_mfma_f32_16x16x32_bf16 v[68:71], a[196:199], a[168:171], v[68:71]
  ds_read_b64_tr_b16 a[220:221], v215 offset:40960
  ds_read_b64_tr_b16 a[222:223], v215 offset:45056
  v_mfma_f32_16x16x32_bf16 v[76:79], a[196:199], a[172:175], v[76:79]
  s_waitcnt lgkmcnt(8)
  v_mfma_f32_16x16x32_bf16 v[80:83], a[200:203], a[168:171], v[80:83]
  s_barrier
  ds_read_b64_tr_b16 a[192:193], v208 offset:49152
  ds_read_b64_tr_b16 a[194:195], v208 offset:53248
  v_mfma_f32_16x16x32_bf16 v[88:91], a[200:203], a[172:175], v[88:91]
  buffer_load_dwordx4 v7, s[8:11], s17 offen offset:3072 lds
  s_add_u32 s17, s17, 131072
  v_mfma_f32_16x16x32_bf16 v[84:87], a[204:207], a[168:171], v[84:87]
  ds_read_b64_tr_b16 a[196:197], v209 offset:49152
  ds_read_b64_tr_b16 a[198:199], v209 offset:53248
  v_mfma_f32_16x16x32_bf16 v[92:95], a[204:207], a[172:175], v[92:95]
  s_waitcnt lgkmcnt(8)
  v_mfma_f32_16x16x32_bf16 v[96:99], a[208:211], a[168:171], v[96:99]
  ds_read_b64_tr_b16 a[200:201], v210 offset:49152
  ds_read_b64_tr_b16 a[202:203], v210 offset:53248
  v_mfma_f32_16x16x32_bf16 v[104:107], a[208:211], a[172:175], v[104:107]
  buffer_load_dwordx4 a[160:163], v3, s[12:15], s18 offen offset:0 sc1
  v_mfma_f32_16x16x32_bf16 v[100:103], a[212:215], a[168:171], v[100:103]
  ds_read_b64_tr_b16 a[204:205], v211 offset:49152
  ds_read_b64_tr_b16 a[206:207], v211 offset:53248
  v_mfma_f32_16x16x32_bf16 v[108:111], a[212:215], a[172:175], v[108:111]
  s_waitcnt lgkmcnt(8)
  v_mfma_f32_16x16x32_bf16 v[112:115], a[216:219], a[168:171], v[112:115]
  ds_read_b64_tr_b16 a[208:209], v212 offset:49152
  ds_read_b64_tr_b16 a[210:211], v212 offset:53248
  v_mfma_f32_16x16x32_bf16 v[120:123], a[216:219], a[172:175], v[120:123]
  buffer_load_dwordx4 a[164:167], v3, s[12:15], s18 offen offset:1024 sc1
  v_mfma_f32_16x16x32_bf16 v[116:119], a[220:223], a[168:171], v[116:119]
  ds_read_b64_tr_b16 a[212:213], v213 offset:49152
  ds_read_b64_tr_b16 a[214:215], v213 offset:53248
  v_mfma_f32_16x16x32_bf16 v[124:127], a[220:223], a[172:175], v[124:127]
  s_waitcnt vmcnt(24) lgkmcnt(8)
  v_mfma_f32_16x16x32_bf16 v[64:67], a[192:195], a[176:179], v[64:67]
  ds_read_b64_tr_b16 a[216:217], v214 offset:49152
  ds_read_b64_tr_b16 a[218:219], v214 offset:53248
  v_mfma_f32_16x16x32_bf16 v[72:75], a[192:195], a[180:183], v[72:75]
  buffer_load_dwordx4 a[168:171], v3, s[12:15], s18 offen offset:2048 sc1
  v_mfma_f32_16x16x32_bf16 v[68:71], a[196:199], a[176:179], v[68:71]
  ds_read_b64_tr_b16 a[220:221], v215 offset:49152
  ds_read_b64_tr_b16 a[222:223], v215 offset:53248
  v_mfma_f32_16x16x32_bf16 v[76:79], a[196:199], a[180:183], v[76:79]
  s_waitcnt lgkmcnt(8)
  v_mfma_f32_16x16x32_bf16 v[80:83], a[200:203], a[176:179], v[80:83]
  ds_read_b64_tr_b16 a[192:193], v208 offset:57344
  ds_read_b64_tr_b16 a[194:195], v208 offset:61440
  v_mfma_f32_16x16x32_bf16 v[88:91], a[200:203], a[180:183], v[88:91]
  buffer_load_dwordx4 a[172:175], v3, s[12:15], s18 offen offset:3072 sc1
  s_add_u32 s18, s18, 4096
  v_mfma_f32_16x16x32_bf16 v[84:87], a[204:207], a[176:179], v[84:87]
  ds_read_b64_tr_b16 a[196:197], v209 offset:57344
  ds_read_b64_tr_b16 a[198:199], v209 offset:61440
  v_mfma_f32_16x16x32_bf16 v[92:95], a[204:207], a[180:183], v[92:95]
  s_add_u32 m0, s19, 81920
  s_waitcnt lgkmcnt(8)
  v_mfma_f32_16x16x32_bf16 v[96:99], a[208:211], a[176:179], v[96:99]
  ds_read_b64_tr_b16 a[200:201], v210 offset:57344
  ds_read_b64_tr_b16 a[202:203], v210 offset:61440
  v_mfma_f32_16x16x32_bf16 v[104:107], a[208:211], a[180:183], v[104:107]
  buffer_load_dwordx4 v4, s[8:11], s17 offen offset:0 lds
  v_mfma_f32_16x16x32_bf16 v[100:103], a[212:215], a[176:179], v[100:103]
  ds_read_b64_tr_b16 a[204:205], v211 offset:57344
  ds_read_b64_tr_b16 a[206:207], v211 offset:61440
  v_mfma_f32_16x16x32_bf16 v[108:111], a[212:215], a[180:183], v[108:111]
  s_waitcnt lgkmcnt(8)
  v_mfma_f32_16x16x32_bf16 v[112:115], a[216:219], a[176:179], v[112:115]
  ds_read_b64_tr_b16 a[208:209], v212 offset:57344
  ds_read_b64_tr_b16 a[210:211], v212 offset:61440
  v_mfma_f32_16x16x32_bf16 v[120:123], a[216:219], a[180:183], v[120:123]
  buffer_load_dwordx4 v5, s[8:11], s17 offen offset:1024 lds
  v_mfma_f32_16x16x32_bf16 v[116:119], a[220:223], a[176:179], v[116:119]
  ds_read_b64_tr_b16 a[212:213], v213 offset:57344
  ds_read_b64_tr_b16 a[214:215], v213 offset:61440
  v_mfma_f32_16x16x32_bf16 v[124:127], a[220:223], a[180:183], v[124:127]
  s_waitcnt vmcnt(26) lgkmcnt(8)
  v_mfma_f32_16x16x32_bf16 v[64:67], a[192:195], a[184:187], v[64:67]
  ds_read_b64_tr_b16 a[216:217], v214 offset:57344
  ds_read_b64_tr_b16 a[218:219], v214 offset:61440
  v_mfma_f32_16x16x32_bf16 v[72:75], a[192:195], a[188:191], v[72:75]
  buffer_load_dwordx4 v6, s[8:11], s17 offen offset:2048 lds
  v_mfma_f32_16x16x32_bf16 v[68:71], a[196:199], a[184:187], v[68:71]
  ds_read_b64_tr_b16 a[220:221], v215 offset:57344
  ds_read_b64_tr_b16 a[222:223], v215 offset:61440
  v_mfma_f32_16x16x32_bf16 v[76:79], a[196:199], a[188:191], v[76:79]
  s_waitcnt lgkmcnt(8)
  v_mfma_f32_16x16x32_bf16 v[80:83], a[200:203], a[184:187], v[80:83]
  s_barrier
  ds_read_b64_tr_b16 a[192:193], v8 offset:0
  ds_read_b64_tr_b16 a[194:195], v8 offset:4096
  v_mfma_f32_16x16x32_bf16 v[88:91], a[200:203], a[188:191], v[88:91]
  buffer_load_dwordx4 v7, s[8:11], s17 offen offset:3072 lds
  s_add_u32 s17, s17, 131072
  v_mfma_f32_16x16x32_bf16 v[84:87], a[204:207], a[184:187], v[84:87]
  ds_read_b64_tr_b16 a[196:197], v9 offset:0
  ds_read_b64_tr_b16 a[198:199], v9 offset:4096
  v_mfma_f32_16x16x32_bf16 v[92:95], a[204:207], a[188:191], v[92:95]
  s_waitcnt lgkmcnt(8)
  v_mfma_f32_16x16x32_bf16 v[96:99], a[208:211], a[184:187], v[96:99]
  ds_read_b64_tr_b16 a[200:201], v10 offset:0
  ds_read_b64_tr_b16 a[202:203], v10 offset:4096
  v_mfma_f32_16x16x32_bf16 v[104:107], a[208:211], a[188:191], v[104:107]
  buffer_load_dwordx4 a[176:179], v3, s[12:15], s18 offen offset:0 sc1
  v_mfma_f32_16x16x32_bf16 v[100:103], a[212:215], a[184:187], v[100:103]
  ds_read_b64_tr_b16 a[204:205], v11 offset:0
  ds_read_b64_tr_b16 a[206:207], v11 offset:4096
  v_mfma_f32_16x16x32_bf16 v[108:111], a[212:215], a[188:191], v[108:111]
  s_waitcnt lgkmcnt(8)
  v_mfma_f32_16x16x32_bf16 v[112:115], a[216:219], a[184:187], v[112:115]
  ds_read_b64_tr_b16 a[208:209], v40 offset:0
  ds_read_b64_tr_b16 a[210:211], v40 offset:4096
  v_mfma_f32_16x16x32_bf16 v[120:123], a[216:219], a[188:191], v[120:123]
  buffer_load_dwordx4 a[180:183], v3, s[12:15], s18 offen offset:1024 sc1
  v_mfma_f32_16x16x32_bf16 v[116:119], a[220:223], a[184:187], v[116:119]
  ds_read_b64_tr_b16 a[212:213], v41 offset:0
  ds_read_b64_tr_b16 a[214:215], v41 offset:4096
  v_mfma_f32_16x16x32_bf16 v[124:127], a[220:223], a[188:191], v[124:127]
  s_sub_u32 s20, s20, 1
  s_cmp_lg_u32 s20, 0
  s_cbranch_scc1 L_mk5_p_22
  s_waitcnt vmcnt(24) lgkmcnt(8)
  v_mfma_f32_16x16x32_bf16 v[64:67], a[192:195], a[128:131], v[64:67]
  ds_read_b64_tr_b16 a[216:217], v42 offset:0
  ds_read_b64_tr_b16 a[218:219], v42 offset:4096
  v_mfma_f32_16x16x32_bf16 v[72:75], a[192:195], a[132:135], v[72:75]
  buffer_load_dwordx4 a[184:187], v3, s[12:15], s18 offen offset:2048 sc1
  s_mov_b32 s60, s72
  v_mfma_f32_16x16x32_bf16 v[68:71], a[196:199], a[128:131], v[68:71]
  ds_read_b64_tr_b16 a[220:221], v43 offset:0
  ds_read_b64_tr_b16 a[222:223], v43 offset:4096
  s_and_b32 s61, s73, 0xffff
  v_mfma_f32_16x16x32_bf16 v[76:79], a[196:199], a[132:135], v[76:79]
  s_mov_b32 s62, 4194304
  s_waitcnt lgkmcnt(8)
  v_mfma_f32_16x16x32_bf16 v[80:83], a[200:203], a[128:131], v[80:83]
  ds_read_b64_tr_b16 a[192:193], v8 offset:8192
  ds_read_b64_tr_b16 a[194:195], v8 offset:12288
  s_mov_b32 s63, 0x00020000
  v_mfma_f32_16x16x32_bf16 v[88:91], a[200:203], a[132:135], v[88:91]
  buffer_load_dwordx4 a[188:191], v3, s[12:15], s18 offen offset:3072 sc1
  s_add_u32 s18, s18, 4096
  v_and_b32 v37, 15, v2
  v_mfma_f32_16x16x32_bf16 v[84:87], a[204:207], a[128:131], v[84:87]
  ds_read_b64_tr_b16 a[196:197], v9 offset:8192
  ds_read_b64_tr_b16 a[198:199], v9 offset:12288
  v_lshlrev_b32 v35, 11, v37
  v_mfma_f32_16x16x32_bf16 v[92:95], a[204:207], a[132:135], v[92:95]
  s_add_u32 m0, s19, 98304
  v_lshl_add_u32 v35, v34, 3, v35
  s_waitcnt lgkmcnt(8)
  v_mfma_f32_16x16x32_bf16 v[96:99], a[208:211], a[128:131], v[96:99]
  ds_read_b64_tr_b16 a[200:201], v10 offset:8192
  ds_read_b64_tr_b16 a[202:203], v10 offset:12288
  v_add_u32 v39, 0x8000, v35
  v_mfma_f32_16x16x32_bf16 v[104:107], a[208:211], a[132:135], v[104:107]
  buffer_load_dwordx4 v4, s[8:11], s17 offen offset:0 lds
  s_lshl_b32 s21, s41, 2
  v_mfma_f32_16x16x32_bf16 v[100:103], a[212:215], a[128:131], v[100:103]
  ds_read_b64_tr_b16 a[204:205], v11 offset:8192
  ds_read_b64_tr_b16 a[206:207], v11 offset:12288
  v_mfma_f32_16x16x32_bf16 v[108:111], a[212:215], a[132:135], v[108:111]
  s_add_u32 s21, s21, s16
  s_waitcnt lgkmcnt(8)
  v_mfma_f32_16x16x32_bf16 v[112:115], a[216:219], a[128:131], v[112:115]
  ds_read_b64_tr_b16 a[208:209], v40 offset:8192
  ds_read_b64_tr_b16 a[210:211], v40 offset:12288
  s_lshl_b32 s65, s21, 16
  v_mfma_f32_16x16x32_bf16 v[120:123], a[216:219], a[132:135], v[120:123]
  buffer_load_dwordx4 v5, s[8:11], s17 offen offset:1024 lds
  s_lshl_b32 s21, s40, 8
  v_mfma_f32_16x16x32_bf16 v[116:119], a[220:223], a[128:131], v[116:119]
  ds_read_b64_tr_b16 a[212:213], v41 offset:8192
  ds_read_b64_tr_b16 a[214:215], v41 offset:12288
  s_add_u32 s65, s65, s21
  v_mfma_f32_16x16x32_bf16 v[124:127], a[220:223], a[132:135], v[124:127]
  s_lshl_b32 s21, s68, 5
  s_waitcnt vmcnt(26) lgkmcnt(8)
  v_mfma_f32_16x16x32_bf16 v[64:67], a[192:195], a[136:139], v[64:67]
  ds_read_b64_tr_b16 a[216:217], v42 offset:8192
  ds_read_b64_tr_b16 a[218:219], v42 offset:12288
  s_add_u32 s21, s21, 24576
  v_mfma_f32_16x16x32_bf16 v[72:75], a[192:195], a[140:143], v[72:75]
  buffer_load_dwordx4 v6, s[8:11], s17 offen offset:2048 lds
  v_mov_b32 v60, s21
  v_mfma_f32_16x16x32_bf16 v[68:71], a[196:199], a[136:139], v[68:71]
  ds_read_b64_tr_b16 a[220:221], v43 offset:8192
  ds_read_b64_tr_b16 a[222:223], v43 offset:12288
  s_lshl_b32 s22, s68, 15
  v_mfma_f32_16x16x32_bf16 v[76:79], a[196:199], a[140:143], v[76:79]
  s_lshl_b32 s21, s16, 11
  s_waitcnt lgkmcnt(8)
  v_mfma_f32_16x16x32_bf16 v[80:83], a[200:203], a[136:139], v[80:83]
  s_barrier
  ds_read_b64_tr_b16 a[192:193], v8 offset:16384
  ds_read_b64_tr_b16 a[194:195], v8 offset:20480
  v_mfma_f32_16x16x32_bf16 v[88:91], a[200:203], a[140:143], v[88:91]
  buffer_load_dwordx4 v7, s[8:11], s17 offen offset:3072 lds
  s_add_u32 s17, s17, 131072
  s_add_u32 s22, s22, s21
  v_mfma_f32_16x16x32_bf16 v[84:87], a[204:207], a[136:139], v[84:87]
  ds_read_b64_tr_b16 a[196:197], v9 offset:16384
  ds_read_b64_tr_b16 a[198:199], v9 offset:20480
  s_add_u32 s22, s22, 33554432
  v_mfma_f32_16x16x32_bf16 v[92:95], a[204:207], a[140:143], v[92:95]
  s_add_u32 s28, s96, s22
  s_addc_u32 s29, s97, 0
  s_waitcnt lgkmcnt(8)
  v_mfma_f32_16x16x32_bf16 v[96:99], a[208:211], a[136:139], v[96:99]
  ds_read_b64_tr_b16 a[200:201], v10 offset:16384
  ds_read_b64_tr_b16 a[202:203], v10 offset:20480
  s_and_b32 s29, s29, 0xffff
  v_mfma_f32_16x16x32_bf16 v[104:107], a[208:211], a[140:143], v[104:107]
  buffer_load_dwordx4 a[128:131], v3, s[12:15], s18 offen offset:0 sc1
  s_mov_b32 s30, 32768
  v_mfma_f32_16x16x32_bf16 v[100:103], a[212:215], a[136:139], v[100:103]
  ds_read_b64_tr_b16 a[204:205], v11 offset:16384
  ds_read_b64_tr_b16 a[206:207], v11 offset:20480
  s_mov_b32 s31, 0x00020000
  v_mfma_f32_16x16x32_bf16 v[108:111], a[212:215], a[140:143], v[108:111]
  s_mov_b32 s32, s92
  s_waitcnt lgkmcnt(8)
  v_mfma_f32_16x16x32_bf16 v[112:115], a[216:219], a[136:139], v[112:115]
  ds_read_b64_tr_b16 a[208:209], v40 offset:16384
  ds_read_b64_tr_b16 a[210:211], v40 offset:20480
  s_and_b32 s33, s93, 0xffff
  v_mfma_f32_16x16x32_bf16 v[120:123], a[216:219], a[140:143], v[120:123]
  buffer_load_dwordx4 a[132:135], v3, s[12:15], s18 offen offset:1024 sc1
  s_mov_b32 s34, 4194304
  v_mfma_f32_16x16x32_bf16 v[116:119], a[220:223], a[136:139], v[116:119]
  ds_read_b64_tr_b16 a[212:213], v41 offset:16384
  ds_read_b64_tr_b16 a[214:215], v41 offset:20480
  v_mfma_f32_16x16x32_bf16 v[124:127], a[220:223], a[140:143], v[124:127]
  s_mov_b32 s35, 0x00020000
  s_waitcnt vmcnt(24) lgkmcnt(8)
  v_mfma_f32_16x16x32_bf16 v[64:67], a[192:195], a[144:147], v[64:67]
  ds_read_b64_tr_b16 a[216:217], v42 offset:16384
  ds_read_b64_tr_b16 a[218:219], v42 offset:20480
  s_lshl_b32 s21, s16, 13
  v_mfma_f32_16x16x32_bf16 v[72:75], a[192:195], a[148:151], v[72:75]
  buffer_load_dwordx4 a[136:139], v3, s[12:15], s18 offen offset:2048 sc1
  s_add_u32 s21, s21, 131072
  v_mfma_f32_16x16x32_bf16 v[68:71], a[196:199], a[144:147], v[68:71]
  ds_read_b64_tr_b16 a[220:221], v43 offset:16384
  ds_read_b64_tr_b16 a[222:223], v43 offset:20480
  v_lshrrev_b32 v1, 5, v2
  v_mfma_f32_16x16x32_bf16 v[76:79], a[196:199], a[148:151], v[76:79]
  v_xor_b32 v36, v37, v1
  s_waitcnt lgkmcnt(8)
  v_mfma_f32_16x16x32_bf16 v[80:83], a[200:203], a[144:147], v[80:83]
  ds_read_b64_tr_b16 a[192:193], v8 offset:24576
  ds_read_b64_tr_b16 a[194:195], v8 offset:28672
  v_lshlrev_b32 v36, 4, v36
  v_mfma_f32_16x16x32_bf16 v[88:91], a[200:203], a[148:151], v[88:91]
  buffer_load_dwordx4 a[140:143], v3, s[12:15], s18 offen offset:3072 sc1
  s_add_u32 s18, s18, 4096
  v_lshl_add_u32 v36, v37, 8, v36
  v_mfma_f32_16x16x32_bf16 v[84:87], a[204:207], a[144:147], v[84:87]
  ds_read_b64_tr_b16 a[196:197], v9 offset:24576
  ds_read_b64_tr_b16 a[198:199], v9 offset:28672
  v_and_b32 v1, 1, v34
  v_mfma_f32_16x16x32_bf16 v[92:95], a[204:207], a[148:151], v[92:95]
  s_add_u32 m0, s19, 114688
  v_lshl_add_u32 v36, v1, 3, v36
  s_waitcnt lgkmcnt(8)
  v_mfma_f32_16x16x32_bf16 v[96:99], a[208:211], a[144:147], v[96:99]
  ds_read_b64_tr_b16 a[200:201], v10 offset:24576
  ds_read_b64_tr_b16 a[202:203], v10 offset:28672
  v_mfma_f32_16x16x32_bf16 v[104:107], a[208:211], a[148:151], v[104:107]
  buffer_load_dwordx4 v4, s[8:11], s17 offen offset:0 lds
  v_add_u32 v36, s21, v36
  v_mfma_f32_16x16x32_bf16 v[100:103], a[212:215], a[144:147], v[100:103]
  ds_read_b64_tr_b16 a[204:205], v11 offset:24576
  ds_read_b64_tr_b16 a[206:207], v11 offset:28672
  v_lshlrev_b32 v38, 4, v37
  v_mfma_f32_16x16x32_bf16 v[108:111], a[212:215], a[148:151], v[108:111]
  v_lshl_add_u32 v38, v34, 11, v38
  s_waitcnt lgkmcnt(8)
  v_mfma_f32_16x16x32_bf16 v[112:115], a[216:219], a[144:147], v[112:115]
  ds_read_b64_tr_b16 a[208:209], v40 offset:24576
  ds_read_b64_tr_b16 a[210:211], v40 offset:28672
  v_xor_b32 v37, v37, v34
  v_mfma_f32_16x16x32_bf16 v[120:123], a[216:219], a[148:151], v[120:123]
  buffer_load_dwordx4 v5, s[8:11], s17 offen offset:1024 lds
  v_lshlrev_b32 v37, 4, v37
  v_mfma_f32_16x16x32_bf16 v[116:119], a[220:223], a[144:147], v[116:119]
  ds_read_b64_tr_b16 a[212:213], v41 offset:24576
  ds_read_b64_tr_b16 a[214:215], v41 offset:28672
  v_lshl_add_u32 v37, v34, 8, v37
  v_mfma_f32_16x16x32_bf16 v[124:127], a[220:223], a[148:151], v[124:127]
  v_add_u32 v37, s21, v37
  s_waitcnt vmcnt(26) lgkmcnt(8)
  v_mfma_f32_16x16x32_bf16 v[64:67], a[192:195], a[152:155], v[64:67]
  ds_read_b64_tr_b16 a[216:217], v42 offset:24576
  ds_read_b64_tr_b16 a[218:219], v42 offset:28672
  s_mov_b32 s21, 8192
  v_mfma_f32_16x16x32_bf16 v[72:75], a[192:195], a[156:159], v[72:75]
  buffer_load_dwordx4 v6, s[8:11], s17 offen offset:2048 lds
  s_mov_b32 s22, 16384
  v_mfma_f32_16x16x32_bf16 v[68:71], a[196:199], a[152:155], v[68:71]
  ds_read_b64_tr_b16 a[220:221], v43 offset:24576
  ds_read_b64_tr_b16 a[222:223], v43 offset:28672
  s_mov_b32 s23, 24576
  v_mfma_f32_16x16x32_bf16 v[76:79], a[196:199], a[156:159], v[76:79]
  s_waitcnt lgkmcnt(8)
  v_mfma_f32_16x16x32_bf16 v[80:83], a[200:203], a[152:155], v[80:83]
  s_barrier
  ds_read_b64_tr_b16 a[192:193], v8 offset:32768
  ds_read_b64_tr_b16 a[194:195], v8 offset:36864
  v_mfma_f32_16x16x32_bf16 v[88:91], a[200:203], a[156:159], v[88:91]
  buffer_load_dwordx4 v7, s[8:11], s17 offen offset:3072 lds
  s_add_u32 s17, s17, 131072
  v_mfma_f32_16x16x32_bf16 v[84:87], a[204:207], a[152:155], v[84:87]
  ds_read_b64_tr_b16 a[196:197], v9 offset:32768
  ds_read_b64_tr_b16 a[198:199], v9 offset:36864
  v_mfma_f32_16x16x32_bf16 v[92:95], a[204:207], a[156:159], v[92:95]
  s_waitcnt lgkmcnt(8)
  v_mfma_f32_16x16x32_bf16 v[96:99], a[208:211], a[152:155], v[96:99]
  ds_read_b64_tr_b16 a[200:201], v10 offset:32768
  ds_read_b64_tr_b16 a[202:203], v10 offset:36864
  v_mfma_f32_16x16x32_bf16 v[104:107], a[208:211], a[156:159], v[104:107]
  buffer_load_dwordx4 a[144:147], v3, s[12:15], s18 offen offset:0 sc1
  v_mfma_f32_16x16x32_bf16 v[100:103], a[212:215], a[152:155], v[100:103]
  ds_read_b64_tr_b16 a[204:205], v11 offset:32768
  ds_read_b64_tr_b16 a[206:207], v11 offset:36864
  v_mfma_f32_16x16x32_bf16 v[108:111], a[212:215], a[156:159], v[108:111]
  s_waitcnt lgkmcnt(8)
  v_mfma_f32_16x16x32_bf16 v[112:115], a[216:219], a[152:155], v[112:115]
  ds_read_b64_tr_b16 a[208:209], v40 offset:32768
  ds_read_b64_tr_b16 a[210:211], v40 offset:36864
  v_mfma_f32_16x16x32_bf16 v[120:123], a[216:219], a[156:159], v[120:123]
  buffer_load_dwordx4 a[148:151], v3, s[12:15], s18 offen offset:1024 sc1
  v_mfma_f32_16x16x32_bf16 v[116:119], a[220:223], a[152:155], v[116:119]
  ds_read_b64_tr_b16 a[212:213], v41 offset:32768
  ds_read_b64_tr_b16 a[214:215], v41 offset:36864
  v_mfma_f32_16x16x32_bf16 v[124:127], a[220:223], a[156:159], v[124:127]
  s_waitcnt vmcnt(24) lgkmcnt(8)
  v_mfma_f32_16x16x32_bf16 v[64:67], a[192:195], a[160:163], v[64:67]
  ds_read_b64_tr_b16 a[216:217], v42 offset:32768
  ds_read_b64_tr_b16 a[218:219], v42 offset:36864
  v_mfma_f32_16x16x32_bf16 v[72:75], a[192:195], a[164:167], v[72:75]
  buffer_load_dwordx4 a[152:155], v3, s[12:15], s18 offen offset:2048 sc1
  v_mfma_f32_16x16x32_bf16 v[68:71], a[196:199], a[160:163], v[68:71]
  ds_read_b64_tr_b16 a[220:221], v43 offset:32768
  ds_read_b64_tr_b16 a[222:223], v43 offset:36864
  v_mfma_f32_16x16x32_bf16 v[76:79], a[196:199], a[164:167], v[76:79]
  s_waitcnt lgkmcnt(8)
  v_mfma_f32_16x16x32_bf16 v[80:83], a[200:203], a[160:163], v[80:83]
  ds_read_b64_tr_b16 a[192:193], v8 offset:40960
  ds_read_b64_tr_b16 a[194:195], v8 offset:45056
  v_mfma_f32_16x16x32_bf16 v[88:91], a[200:203], a[164:167], v[88:91]
  buffer_load_dwordx4 a[156:159], v3, s[12:15], s18 offen offset:3072 sc1
  s_add_u32 s18, s18, 4096
  v_mfma_f32_16x16x32_bf16 v[84:87], a[204:207], a[160:163], v[84:87]
  ds_read_b64_tr_b16 a[196:197], v9 offset:40960
  ds_read_b64_tr_b16 a[198:199], v9 offset:45056
  v_mfma_f32_16x16x32_bf16 v[92:95], a[204:207], a[164:167], v[92:95]
  s_waitcnt lgkmcnt(8)
  v_mfma_f32_16x16x32_bf16 v[96:99], a[208:211], a[160:163], v[96:99]
  ds_read_b64_tr_b16 a[200:201], v10 offset:40960
  ds_read_b64_tr_b16 a[202:203], v10 offset:45056
  v_mfma_f32_16x16x32_bf16 v[104:107], a[208:211], a[164:167], v[104:107]
  buffer_load_dwordx2 v[224:225], v35, s[60:63], s65 offen offset:0
  v_mfma_f32_16x16x32_bf16 v[100:103], a[212:215], a[160:163], v[100:103]
  ds_read_b64_tr_b16 a[204:205], v11 offset:40960
  ds_read_b64_tr_b16 a[206:207], v11 offset:45056
  v_mfma_f32_16x16x32_bf16 v[108:111], a[212:215], a[164:167], v[108:111]
  s_waitcnt lgkmcnt(8)
  v_mfma_f32_16x16x32_bf16 v[112:115], a[216:219], a[160:163], v[112:115]
  ds_read_b64_tr_b16 a[208:209], v40 offset:40960
  ds_read_b64_tr_b16 a[210:211], v40 offset:45056
  v_mfma_f32_16x16x32_bf16 v[120:123], a[216:219], a[164:167], v[120:123]
  buffer_load_dwordx2 v[226:227], v35, s[60:63], s65 offen offset:32
  v_mfma_f32_16x16x32_bf16 v[116:119], a[220:223], a[160:163], v[116:119]
  ds_read_b64_tr_b16 a[212:213], v41 offset:40960
  ds_read_b64_tr_b16 a[214:215], v41 offset:45056
  v_mfma_f32_16x16x32_bf16 v[124:127], a[220:223], a[164:167], v[124:127]
  s_waitcnt vmcnt(26) lgkmcnt(8)
  v_mfma_f32_16x16x32_bf16 v[64:67], a[192:195], a[168:171], v[64:67]
  ds_read_b64_tr_b16 a[216:217], v42 offset:40960
  ds_read_b64_tr_b16 a[218:219], v42 offset:45056
  v_mfma_f32_16x16x32_bf16 v[72:75], a[192:195], a[172:175], v[72:75]
  buffer_load_dwordx2 v[228:229], v39, s[60:63], s65 offen offset:0
  v_mfma_f32_16x16x32_bf16 v[68:71], a[196:199], a[168:171], v[68:71]
  ds_read_b64_tr_b16 a[220:221], v43 offset:40960
  ds_read_b64_tr_b16 a[222:223], v43 offset:45056
  v_mfma_f32_16x16x32_bf16 v[76:79], a[196:199], a[172:175], v[76:79]
  s_waitcnt lgkmcnt(8)
  v_mfma_f32_16x16x32_bf16 v[80:83], a[200:203], a[168:171], v[80:83]
  s_barrier
  ds_read_b64_tr_b16 a[192:193], v8 offset:49152
  ds_read_b64_tr_b16 a[194:195], v8 offset:53248
  v_mfma_f32_16x16x32_bf16 v[88:91], a[200:203], a[172:175], v[88:91]
  buffer_load_dwordx2 v[230:231], v39, s[60:63], s65 offen offset:32
  v_mfma_f32_16x16x32_bf16 v[84:87], a[204:207], a[168:171], v[84:87]
  ds_read_b64_tr_b16 a[196:197], v9 offset:49152
  ds_read_b64_tr_b16 a[198:199], v9 offset:53248
  v_mfma_f32_16x16x32_bf16 v[92:95], a[204:207], a[172:175], v[92:95]
  s_waitcnt lgkmcnt(8)
  v_mfma_f32_16x16x32_bf16 v[96:99], a[208:211], a[168:171], v[96:99]
  ds_read_b64_tr_b16 a[200:201], v10 offset:49152
  ds_read_b64_tr_b16 a[202:203], v10 offset:53248
  v_mfma_f32_16x16x32_bf16 v[104:107], a[208:211], a[172:175], v[104:107]
  buffer_load_dwordx4 a[160:163], v3, s[12:15], s18 offen offset:0 sc1
  v_mfma_f32_16x16x32_bf16 v[100:103], a[212:215], a[168:171], v[100:103]
  ds_read_b64_tr_b16 a[204:205], v11 offset:49152
  ds_read_b64_tr_b16 a[206:207], v11 offset:53248
  v_mfma_f32_16x16x32_bf16 v[108:111], a[212:215], a[172:175], v[108:111]
  s_waitcnt lgkmcnt(8)
  v_mfma_f32_16x16x32_bf16 v[112:115], a[216:219], a[168:171], v[112:115]
  ds_read_b64_tr_b16 a[208:209], v40 offset:49152
  ds_read_b64_tr_b16 a[210:211], v40 offset:53248
  v_mfma_f32_16x16x32_bf16 v[120:123], a[216:219], a[172:175], v[120:123]
  buffer_load_dwordx4 a[164:167], v3, s[12:15], s18 offen offset:1024 sc1
  v_mfma_f32_16x16x32_bf16 v[116:119], a[220:223], a[168:171], v[116:119]
  ds_read_b64_tr_b16 a[212:213], v41 offset:49152
  ds_read_b64_tr_b16 a[214:215], v41 offset:53248
  v_mfma_f32_16x16x32_bf16 v[124:127], a[220:223], a[172:175], v[124:127]
  s_waitcnt vmcnt(24) lgkmcnt(8)
  v_mfma_f32_16x16x32_bf16 v[64:67], a[192:195], a[176:179], v[64:67]
  ds_read_b64_tr_b16 a[216:217], v42 offset:49152
  ds_read_b64_tr_b16 a[218:219], v42 offset:53248
  v_mfma_f32_16x16x32_bf16 v[72:75], a[192:195], a[180:183], v[72:75]
  buffer_load_dwordx4 a[168:171], v3, s[12:15], s18 offen offset:2048 sc1
  v_mfma_f32_16x16x32_bf16 v[68:71], a[196:199], a[176:179], v[68:71]
  ds_read_b64_tr_b16 a[220:221], v43 offset:49152
  ds_read_b64_tr_b16 a[222:223], v43 offset:53248
  v_mfma_f32_16x16x32_bf16 v[76:79], a[196:199], a[180:183], v[76:79]
  s_waitcnt lgkmcnt(8)
  v_mfma_f32_16x16x32_bf16 v[80:83], a[200:203], a[176:179], v[80:83]
  ds_read_b64_tr_b16 a[192:193], v8 offset:57344
  ds_read_b64_tr_b16 a[194:195], v8 offset:61440
  v_mfma_f32_16x16x32_bf16 v[88:91], a[200:203], a[180:183], v[88:91]
  buffer_load_dwordx4 a[172:175], v3, s[12:15], s18 offen offset:3072 sc1
  s_add_u32 s18, s18, 4096
  v_mfma_f32_16x16x32_bf16 v[84:87], a[204:207], a[176:179], v[84:87]
  ds_read_b64_tr_b16 a[196:197], v9 offset:57344
  ds_read_b64_tr_b16 a[198:199], v9 offset:61440
  v_mfma_f32_16x16x32_bf16 v[92:95], a[204:207], a[180:183], v[92:95]
  s_waitcnt lgkmcnt(8)
  v_mfma_f32_16x16x32_bf16 v[96:99], a[208:211], a[176:179], v[96:99]
  ds_read_b64_tr_b16 a[200:201], v10 offset:57344
  ds_read_b64_tr_b16 a[202:203], v10 offset:61440
  v_mfma_f32_16x16x32_bf16 v[104:107], a[208:211], a[180:183], v[104:107]
  buffer_load_dwordx2 v[232:233], v35, s[60:63], s65 offen offset:64
  v_mfma_f32_16x16x32_bf16 v[100:103], a[212:215], a[176:179], v[100:103]
  ds_read_b64_tr_b16 a[204:205], v11 offset:57344
  ds_read_b64_tr_b16 a[206:207], v11 offset:61440
  v_mfma_f32_16x16x32_bf16 v[108:111], a[212:215], a[180:183], v[108:111]
  s_waitcnt lgkmcnt(8)
  v_mfma_f32_16x16x32_bf16 v[112:115], a[216:219], a[176:179], v[112:115]
  ds_read_b64_tr_b16 a[208:209], v40 offset:57344
  ds_read_b64_tr_b16 a[210:211], v40 offset:61440
  v_mfma_f32_16x16x32_bf16 v[120:123], a[216:219], a[180:183], v[120:123]
  buffer_load_dwordx2 v[234:235], v35, s[60:63], s65 offen offset:96
  v_mfma_f32_16x16x32_bf16 v[116:119], a[220:223], a[176:179], v[116:119]
  ds_read_b64_tr_b16 a[212:213], v41 offset:57344
  ds_read_b64_tr_b16 a[214:215], v41 offset:61440
  v_mfma_f32_16x16x32_bf16 v[124:127], a[220:223], a[180:183], v[124:127]
  s_waitcnt vmcnt(26) lgkmcnt(8)
  v_mfma_f32_16x16x32_bf16 v[64:67], a[192:195], a[184:187], v[64:67]
  ds_read_b64_tr_b16 a[216:217], v42 offset:57344
  ds_read_b64_tr_b16 a[218:219], v42 offset:61440
  v_mfma_f32_16x16x32_bf16 v[72:75], a[192:195], a[188:191], v[72:75]
  buffer_load_dwordx2 v[236:237], v39, s[60:63], s65 offen offset:64
  v_mfma_f32_16x16x32_bf16 v[68:71], a[196:199], a[184:187], v[68:71]
  ds_read_b64_tr_b16 a[220:221], v43 offset:57344
  ds_read_b64_tr_b16 a[222:223], v43 offset:61440
  v_mfma_f32_16x16x32_bf16 v[76:79], a[196:199], a[188:191], v[76:79]
  s_waitcnt lgkmcnt(8)
  v_mfma_f32_16x16x32_bf16 v[80:83], a[200:203], a[184:187], v[80:83]
  s_barrier
  ds_read_b64_tr_b16 a[192:193], v208 offset:0
  ds_read_b64_tr_b16 a[194:195], v208 offset:4096
  v_mfma_f32_16x16x32_bf16 v[88:91], a[200:203], a[188:191], v[88:91]
  buffer_load_dwordx2 v[238:239], v39, s[60:63], s65 offen offset:96
  v_mfma_f32_16x16x32_bf16 v[84:87], a[204:207], a[184:187], v[84:87]
  ds_read_b64_tr_b16 a[196:197], v209 offset:0
  ds_read_b64_tr_b16 a[198:199], v209 offset:4096
  v_mfma_f32_16x16x32_bf16 v[92:95], a[204:207], a[188:191], v[92:95]
  s_waitcnt lgkmcnt(8)
  v_mfma_f32_16x16x32_bf16 v[96:99], a[208:211], a[184:187], v[96:99]
  ds_read_b64_tr_b16 a[200:201], v210 offset:0
  ds_read_b64_tr_b16 a[202:203], v210 offset:4096
  v_mfma_f32_16x16x32_bf16 v[104:107], a[208:211], a[188:191], v[104:107]
  buffer_load_dwordx4 a[176:179], v3, s[12:15], s18 offen offset:0 sc1
  v_mfma_f32_16x16x32_bf16 v[100:103], a[212:215], a[184:187], v[100:103]
  ds_read_b64_tr_b16 a[204:205], v211 offset:0
  ds_read_b64_tr_b16 a[206:207], v211 offset:4096
  v_mfma_f32_16x16x32_bf16 v[108:111], a[212:215], a[188:191], v[108:111]
  s_waitcnt lgkmcnt(8)
  v_mfma_f32_16x16x32_bf16 v[112:115], a[216:219], a[184:187], v[112:115]
  ds_read_b64_tr_b16 a[208:209], v212 offset:0
  ds_read_b64_tr_b16 a[210:211], v212 offset:4096
  v_mfma_f32_16x16x32_bf16 v[120:123], a[216:219], a[188:191], v[120:123]
  buffer_load_dwordx4 a[180:183], v3, s[12:15], s18 offen offset:1024 sc1
  v_mfma_f32_16x16x32_bf16 v[116:119], a[220:223], a[184:187], v[116:119]
  ds_read_b64_tr_b16 a[212:213], v213 offset:0
  ds_read_b64_tr_b16 a[214:215], v213 offset:4096
  v_mfma_f32_16x16x32_bf16 v[124:127], a[220:223], a[188:191], v[124:127]
  s_waitcnt vmcnt(24) lgkmcnt(8)
  v_mfma_f32_16x16x32_bf16 v[64:67], a[192:195], a[128:131], v[64:67]
  buffer_load_dword v52, v60, s[52:55], 0 offen sc1
  ds_read_b64_tr_b16 a[216:217], v214 offset:0
  ds_read_b64_tr_b16 a[218:219], v214 offset:4096
  v_mfma_f32_16x16x32_bf16 v[72:75], a[192:195], a[132:135], v[72:75]
  buffer_load_dwordx4 a[184:187], v3, s[12:15], s18 offen offset:2048 sc1
  v_mfma_f32_16x16x32_bf16 v[68:71], a[196:199], a[128:131], v[68:71]
  ds_read_b64_tr_b16 a[220:221], v215 offset:0
  ds_read_b64_tr_b16 a[222:223], v215 offset:4096
  v_mfma_f32_16x16x32_bf16 v[76:79], a[196:199], a[132:135], v[76:79]
  s_waitcnt lgkmcnt(8)
  v_mfma_f32_16x16x32_bf16 v[80:83], a[200:203], a[128:131], v[80:83]
  ds_read_b64_tr_b16 a[192:193], v208 offset:8192
  ds_read_b64_tr_b16 a[194:195], v208 offset:12288
  v_mfma_f32_16x16x32_bf16 v[88:91], a[200:203], a[132:135], v[88:91]
  buffer_load_dwordx4 a[188:191], v3, s[12:15], s18 offen offset:3072 sc1
  s_add_u32 s18, s18, 4096
  v_mfma_f32_16x16x32_bf16 v[84:87], a[204:207], a[128:131], v[84:87]
  ds_read_b64_tr_b16 a[196:197], v209 offset:8192
  ds_read_b64_tr_b16 a[198:199], v209 offset:12288
  v_mfma_f32_16x16x32_bf16 v[92:95], a[204:207], a[132:135], v[92:95]
  s_waitcnt lgkmcnt(8)
  v_mfma_f32_16x16x32_bf16 v[96:99], a[208:211], a[128:131], v[96:99]
  ds_read_b64_tr_b16 a[200:201], v210 offset:8192
  ds_read_b64_tr_b16 a[202:203], v210 offset:12288
  v_mfma_f32_16x16x32_bf16 v[104:107], a[208:211], a[132:135], v[104:107]
  buffer_load_dwordx2 v[240:241], v35, s[60:63], s65 offen offset:128
  v_mfma_f32_16x16x32_bf16 v[100:103], a[212:215], a[128:131], v[100:103]
  ds_read_b64_tr_b16 a[204:205], v211 offset:8192
  ds_read_b64_tr_b16 a[206:207], v211 offset:12288
  v_mfma_f32_16x16x32_bf16 v[108:111], a[212:215], a[132:135], v[108:111]
  s_waitcnt lgkmcnt(8)
  v_mfma_f32_16x16x32_bf16 v[112:115], a[216:219], a[128:131], v[112:115]
  ds_read_b64_tr_b16 a[208:209], v212 offset:8192
  ds_read_b64_tr_b16 a[210:211], v212 offset:12288
  v_mfma_f32_16x16x32_bf16 v[120:123], a[216:219], a[132:135], v[120:123]
  buffer_load_dwordx2 v[242:243], v35, s[60:63], s65 offen offset:160
  v_mfma_f32_16x16x32_bf16 v[116:119], a[220:223], a[128:131], v[116:119]
  ds_read_b64_tr_b16 a[212:213], v213 offset:8192
  ds_read_b64_tr_b16 a[214:215], v213 offset:12288
  v_mfma_f32_16x16x32_bf16 v[124:127], a[220:223], a[132:135], v[124:127]
  s_waitcnt vmcnt(27) lgkmcnt(8)
  v_mfma_f32_16x16x32_bf16 v[64:67], a[192:195], a[136:139], v[64:67]
  ds_read_b64_tr_b16 a[216:217], v214 offset:8192
  ds_read_b64_tr_b16 a[218:219], v214 offset:12288
  v_mfma_f32_16x16x32_bf16 v[72:75], a[192:195], a[140:143], v[72:75]
  buffer_load_dwordx2 v[244:245], v39, s[60:63], s65 offen offset:128
  v_mfma_f32_16x16x32_bf16 v[68:71], a[196:199], a[136:139], v[68:71]
  ds_read_b64_tr_b16 a[220:221], v215 offset:8192
  ds_read_b64_tr_b16 a[222:223], v215 offset:12288
  v_mfma_f32_16x16x32_bf16 v[76:79], a[196:199], a[140:143], v[76:79]
  s_waitcnt lgkmcnt(8)
  v_mfma_f32_16x16x32_bf16 v[80:83], a[200:203], a[136:139], v[80:83]
  s_barrier
  ds_read_b64_tr_b16 a[192:193], v208 offset:16384
  ds_read_b64_tr_b16 a[194:195], v208 offset:20480
  v_mfma_f32_16x16x32_bf16 v[88:91], a[200:203], a[140:143], v[88:91]
  buffer_load_dwordx2 v[246:247], v39, s[60:63], s65 offen offset:160
  v_mfma_f32_16x16x32_bf16 v[84:87], a[204:207], a[136:139], v[84:87]
  ds_read_b64_tr_b16 a[196:197], v209 offset:16384
  ds_read_b64_tr_b16 a[198:199], v209 offset:20480
  v_mfma_f32_16x16x32_bf16 v[92:95], a[204:207], a[140:143], v[92:95]
  s_waitcnt lgkmcnt(8)
  v_mfma_f32_16x16x32_bf16 v[96:99], a[208:211], a[136:139], v[96:99]
  ds_read_b64_tr_b16 a[200:201], v210 offset:16384
  ds_read_b64_tr_b16 a[202:203], v210 offset:20480
  v_mfma_f32_16x16x32_bf16 v[104:107], a[208:211], a[140:143], v[104:107]
  v_mfma_f32_16x16x32_bf16 v[100:103], a[212:215], a[136:139], v[100:103]
  ds_read_b64_tr_b16 a[204:205], v211 offset:16384
  ds_read_b64_tr_b16 a[206:207], v211 offset:20480
  v_mfma_f32_16x16x32_bf16 v[108:111], a[212:215], a[140:143], v[108:111]
  s_waitcnt lgkmcnt(8)
  v_mfma_f32_16x16x32_bf16 v[112:115], a[216:219], a[136:139], v[112:115]
  ds_read_b64_tr_b16 a[208:209], v212 offset:16384
  ds_read_b64_tr_b16 a[210:211], v212 offset:20480
  v_mfma_f32_16x16x32_bf16 v[120:123], a[216:219], a[140:143], v[120:123]
  v_mfma_f32_16x16x32_bf16 v[116:119], a[220:223], a[136:139], v[116:119]
  ds_read_b64_tr_b16 a[212:213], v213 offset:16384
  ds_read_b64_tr_b16 a[214:215], v213 offset:20480
  v_mfma_f32_16x16x32_bf16 v[124:127], a[220:223], a[140:143], v[124:127]
  s_waitcnt vmcnt(23) lgkmcnt(8)
  v_mfma_f32_16x16x32_bf16 v[64:67], a[192:195], a[144:147], v[64:67]
  ds_read_b64_tr_b16 a[216:217], v214 offset:16384
  ds_read_b64_tr_b16 a[218:219], v214 offset:20480
  v_mfma_f32_16x16x32_bf16 v[72:75], a[192:195], a[148:151], v[72:75]
  buffer_load_dwordx2 v[248:249], v35, s[60:63], s65 offen offset:192
  v_mfma_f32_16x16x32_bf16 v[68:71], a[196:199], a[144:147], v[68:71]
  ds_read_b64_tr_b16 a[220:221], v215 offset:16384
  ds_read_b64_tr_b16 a[222:223], v215 offset:20480
  v_mfma_f32_16x16x32_bf16 v[76:79], a[196:199], a[148:151], v[76:79]
  s_waitcnt lgkmcnt(8)
  v_mfma_f32_16x16x32_bf16 v[80:83], a[200:203], a[144:147], v[80:83]
  ds_read_b64_tr_b16 a[192:193], v208 offset:24576
  ds_read_b64_tr_b16 a[194:195], v208 offset:28672
  v_mfma_f32_16x16x32_bf16 v[88:91], a[200:203], a[148:151], v[88:91]
  buffer_load_dwordx2 v[250:251], v35, s[60:63], s65 offen offset:224
  v_mfma_f32_16x16x32_bf16 v[84:87], a[204:207], a[144:147], v[84:87]
  ds_read_b64_tr_b16 a[196:197], v209 offset:24576
  ds_read_b64_tr_b16 a[198:199], v209 offset:28672
  v_mfma_f32_16x16x32_bf16 v[92:95], a[204:207], a[148:151], v[92:95]
  s_waitcnt lgkmcnt(8)
  v_mfma_f32_16x16x32_bf16 v[96:99], a[208:211], a[144:147], v[96:99]
  ds_read_b64_tr_b16 a[200:201], v210 offset:24576
  ds_read_b64_tr_b16 a[202:203], v210 offset:28672
  v_mfma_f32_16x16x32_bf16 v[104:107], a[208:211], a[148:151], v[104:107]
  buffer_load_dwordx2 v[252:253], v39, s[60:63], s65 offen offset:192
  v_mfma_f32_16x16x32_bf16 v[100:103], a[212:215], a[144:147], v[100:103]
  ds_read_b64_tr_b16 a[204:205], v211 offset:24576
  ds_read_b64_tr_b16 a[206:207], v211 offset:28672
  v_mfma_f32_16x16x32_bf16 v[108:111], a[212:215], a[148:151], v[108:111]
  s_waitcnt lgkmcnt(8)
  v_mfma_f32_16x16x32_bf16 v[112:115], a[216:219], a[144:147], v[112:115]
  ds_read_b64_tr_b16 a[208:209], v212 offset:24576
  ds_read_b64_tr_b16 a[210:211], v212 offset:28672
  v_mfma_f32_16x16x32_bf16 v[120:123], a[216:219], a[148:151], v[120:123]
  buffer_load_dwordx2 v[254:255], v39, s[60:63], s65 offen offset:224
  v_mfma_f32_16x16x32_bf16 v[116:119], a[220:223], a[144:147], v[116:119]
  ds_read_b64_tr_b16 a[212:213], v213 offset:24576
  ds_read_b64_tr_b16 a[214:215], v213 offset:28672
  v_mfma_f32_16x16x32_bf16 v[124:127], a[220:223], a[148:151], v[124:127]
  s_waitcnt vmcnt(25) lgkmcnt(8)
  v_mfma_f32_16x16x32_bf16 v[64:67], a[192:195], a[152:155], v[64:67]
  ds_read_b64_tr_b16 a[216:217], v214 offset:24576
  ds_read_b64_tr_b16 a[218:219], v214 offset:28672
  v_mfma_f32_16x16x32_bf16 v[72:75], a[192:195], a[156:159], v[72:75]
  v_mfma_f32_16x16x32_bf16 v[68:71], a[196:199], a[152:155], v[68:71]
  ds_read_b64_tr_b16 a[220:221], v215 offset:24576
  ds_read_b64_tr_b16 a[222:223], v215 offset:28672
  v_mfma_f32_16x16x32_bf16 v[76:79], a[196:199], a[156:159], v[76:79]
  s_waitcnt lgkmcnt(8)
  v_mfma_f32_16x16x32_bf16 v[80:83], a[200:203], a[152:155], v[80:83]
  s_barrier
  ds_read_b64_tr_b16 a[192:193], v208 offset:32768
  ds_read_b64_tr_b16 a[194:195], v208 offset:36864
  v_mfma_f32_16x16x32_bf16 v[88:91], a[200:203], a[156:159], v[88:91]
  v_mfma_f32_16x16x32_bf16 v[84:87], a[204:207], a[152:155], v[84:87]
  ds_read_b64_tr_b16 a[196:197], v209 offset:32768
  ds_read_b64_tr_b16 a[198:199], v209 offset:36864
  v_mfma_f32_16x16x32_bf16 v[92:95], a[204:207], a[156:159], v[92:95]
  s_waitcnt lgkmcnt(8)
  v_mfma_f32_16x16x32_bf16 v[96:99], a[208:211], a[152:155], v[96:99]
  s_waitcnt vmcnt(10)
  v_cmp_ne_u32 vcc, s42, v52
  s_cbranch_vccz L_mk5_fok_25
  s_call_b64 s[48:49], L_poll1
L_mk5_fok_25:
  ds_read_b64_tr_b16 a[200:201], v210 offset:32768
  ds_read_b64_tr_b16 a[202:203], v210 offset:36864
  v_mfma_f32_16x16x32_bf16 v[104:107], a[208:211], a[156:159], v[104:107]
  v_mfma_f32_16x16x32_bf16 v[100:103], a[212:215], a[152:155], v[100:103]
  ds_read_b64_tr_b16 a[204:205], v211 offset:32768
  ds_read_b64_tr_b16 a[206:207], v211 offset:36864
  v_mfma_f32_16x16x32_bf16 v[108:111], a[212:215], a[156:159], v[108:111]
  s_waitcnt lgkmcnt(8)
  v_mfma_f32_16x16x32_bf16 v[112:115], a[216:219], a[152:155], v[112:115]
  ds_read_b64_tr_b16 a[208:209], v212 offset:32768
  ds_read_b64_tr_b16 a[210:211], v212 offset:36864
  v_mfma_f32_16x16x32_bf16 v[120:123], a[216:219], a[156:159], v[120:123]
  v_mfma_f32_16x16x32_bf16 v[116:119], a[220:223], a[152:155], v[116:119]
  ds_read_b64_tr_b16 a[212:213], v213 offset:32768
  ds_read_b64_tr_b16 a[214:215], v213 offset:36864
  v_mfma_f32_16x16x32_bf16 v[124:127], a[220:223], a[156:159], v[124:127]
  s_waitcnt lgkmcnt(8)
  v_mfma_f32_16x16x32_bf16 v[64:67], a[192:195], a[160:163], v[64:67]
  ds_read_b64_tr_b16 a[216:217], v214 offset:32768
  ds_read_b64_tr_b16 a[218:219], v214 offset:36864
  v_mfma_f32_16x16x32_bf16 v[72:75], a[192:195], a[164:167], v[72:75]
  buffer_load_dwordx4 v[160:163], v3, s[28:31], 0 offen offset:0 sc1
  v_mfma_f32_16x16x32_bf16 v[68:71], a[196:199], a[160:163], v[68:71]
  ds_read_b64_tr_b16 a[220:221], v215 offset:32768
  ds_read_b64_tr_b16 a[222:223], v215 offset:36864
  v_mfma_f32_16x16x32_bf16 v[76:79], a[196:199], a[164:167], v[76:79]
  s_waitcnt lgkmcnt(8)
  v_mfma_f32_16x16x32_bf16 v[80:83], a[200:203], a[160:163], v[80:83]
  ds_read_b64_tr_b16 a[192:193], v208 offset:40960
  ds_read_b64_tr_b16 a[194:195], v208 offset:45056
  v_mfma_f32_16x16x32_bf16 v[88:91], a[200:203], a[164:167], v[88:91]
  buffer_load_dwordx4 v[164:167], v3, s[28:31], 0 offen offset:1024 sc1
  v_mfma_f32_16x16x32_bf16 v[84:87], a[204:207], a[160:163], v[84:87]
  ds_read_b64_tr_b16 a[196:197], v209 offset:40960
  ds_read_b64_tr_b16 a[198:199], v209 offset:45056
  v_mfma_f32_16x16x32_bf16 v[92:95], a[204:207], a[164:167], v[92:95]
  s_waitcnt lgkmcnt(8)
  v_mfma_f32_16x16x32_bf16 v[96:99], a[208:211], a[160:163], v[96:99]
  ds_read_b64_tr_b16 a[200:201], v210 offset:40960
  ds_read_b64_tr_b16 a[202:203], v210 offset:45056
  v_mfma_f32_16x16x32_bf16 v[104:107], a[208:211], a[164:167], v[104:107]
  v_mfma_f32_16x16x32_bf16 v[100:103], a[212:215], a[160:163], v[100:103]
  ds_read_b64_tr_b16 a[204:205], v211 offset:40960
  ds_read_b64_tr_b16 a[206:207], v211 offset:45056
  v_mfma_f32_16x16x32_bf16 v[108:111], a[212:215], a[164:167], v[108:111]
  s_waitcnt lgkmcnt(8)
  v_mfma_f32_16x16x32_bf16 v[112:115], a[216:219], a[160:163], v[112:115]
  ds_read_b64_tr_b16 a[208:209], v212 offset:40960
  ds_read_b64_tr_b16 a[210:211], v212 offset:45056
  v_mfma_f32_16x16x32_bf16 v[120:123], a[216:219], a[164:167], v[120:123]
  v_mfma_f32_16x16x32_bf16 v[116:119], a[220:223], a[160:163], v[116:119]
  ds_read_b64_tr_b16 a[212:213], v213 offset:40960
  ds_read_b64_tr_b16 a[214:215], v213 offset:45056
  v_mfma_f32_16x16x32_bf16 v[124:127], a[220:223], a[164:167], v[124:127]
  s_waitcnt lgkmcnt(8)
  v_mfma_f32_16x16x32_bf16 v[64:67], a[192:195], a[168:171], v[64:67]
  ds_read_b64_tr_b16 a[216:217], v214 offset:40960
  ds_read_b64_tr_b16 a[218:219], v214 offset:45056
  v_mfma_f32_16x16x32_bf16 v[72:75], a[192:195], a[172:175], v[72:75]
  buffer_load_dwordx4 v[168:171], v3, s[28:31], s21 offen offset:0 sc1
  v_mfma_f32_16x16x32_bf16 v[68:71], a[196:199], a[168:171], v[68:71]
  ds_read_b64_tr_b16 a[220:221], v215 offset:40960
  ds_read_b64_tr_b16 a[222:223], v215 offset:45056
  v_mfma_f32_16x16x32_bf16 v[76:79], a[196:199], a[172:175], v[76:79]
  s_waitcnt lgkmcnt(8)
  v_mfma_f32_16x16x32_bf16 v[80:83], a[200:203], a[168:171], v[80:83]
  s_barrier
  ds_read_b64_tr_b16 a[192:193], v208 offset:49152
  ds_read_b64_tr_b16 a[194:195], v208 offset:53248
  v_mfma_f32_16x16x32_bf16 v[88:91], a[200:203], a[172:175], v[88:91]
  buffer_load_dwordx4 v[172:175], v3, s[28:31], s21 offen offset:1024 sc1
  v_mfma_f32_16x16x32_bf16 v[84:87], a[204:207], a[168:171], v[84:87]
  ds_read_b64_tr_b16 a[196:197], v209 offset:49152
  ds_read_b64_tr_b16 a[198:199], v209 offset:53248
  v_mfma_f32_16x16x32_bf16 v[92:95], a[204:207], a[172:175], v[92:95]
  s_waitcnt lgkmcnt(8)
  v_mfma_f32_16x16x32_bf16 v[96:99], a[208:211], a[168:171], v[96:99]
  ds_read_b64_tr_b16 a[200:201], v210 offset:49152
  ds_read_b64_tr_b16 a[202:203], v210 offset:53248
  v_mfma_f32_16x16x32_bf16 v[104:107], a[208:211], a[172:175], v[104:107]
  v_mfma_f32_16x16x32_bf16 v[100:103], a[212:215], a[168:171], v[100:103]
  ds_read_b64_tr_b16 a[204:205], v211 offset:49152
  ds_read_b64_tr_b16 a[206:207], v211 offset:53248
  v_mfma_f32_16x16x32_bf16 v[108:111], a[212:215], a[172:175], v[108:111]
  s_waitcnt lgkmcnt(8)
  v_mfma_f32_16x16x32_bf16 v[112:115], a[216:219], a[168:171], v[112:115]
  ds_read_b64_tr_b16 a[208:209], v212 offset:49152
  ds_read_b64_tr_b16 a[210:211], v212 offset:53248
  v_mfma_f32_16x16x32_bf16 v[120:123], a[216:219], a[172:175], v[120:123]
  v_mfma_f32_16x16x32_bf16 v[116:119], a[220:223], a[168:171], v[116:119]
  ds_read_b64_tr_b16 a[212:213], v213 offset:49152
  ds_read_b64_tr_b16 a[214:215], v213 offset:53248
  v_mfma_f32_16x16x32_bf16 v[124:127], a[220:223], a[172:175], v[124:127]
  s_waitcnt lgkmcnt(8)
  v_mfma_f32_16x16x32_bf16 v[64:67], a[192:195], a[176:179], v[64:67]
  ds_read_b64_tr_b16 a[216:217], v214 offset:49152
  ds_read_b64_tr_b16 a[218:219], v214 offset:53248
  v_mfma_f32_16x16x32_bf16 v[72:75], a[192:195], a[180:183], v[72:75]
  buffer_load_dwordx4 v[176:179], v3, s[28:31], s22 offen offset:0 sc1
  v_mfma_f32_16x16x32_bf16 v[68:71], a[196:199], a[176:179], v[68:71]
  ds_read_b64_tr_b16 a[220:221], v215 offset:49152
  ds_read_b64_tr_b16 a[222:223], v215 offset:53248
  v_mfma_f32_16x16x32_bf16 v[76:79], a[196:199], a[180:183], v[76:79]
  s_waitcnt lgkmcnt(8)
  v_mfma_f32_16x16x32_bf16 v[80:83], a[200:203], a[176:179], v[80:83]
  ds_read_b64_tr_b16 a[192:193], v208 offset:57344
  ds_read_b64_tr_b16 a[194:195], v208 offset:61440
  v_mfma_f32_16x16x32_bf16 v[88:91], a[200:203], a[180:183], v[88:91]
  buffer_load_dwordx4 v[180:183], v3, s[28:31], s22 offen offset:1024 sc1
  v_mfma_f32_16x16x32_bf16 v[84:87], a[204:207], a[176:179], v[84:87]
  ds_read_b64_tr_b16 a[196:197], v209 offset:57344
  ds_read_b64_tr_b16 a[198:199], v209 offset:61440
  v_mfma_f32_16x16x32_bf16 v[92:95], a[204:207], a[180:183], v[92:95]
  s_waitcnt lgkmcnt(8)
  v_mfma_f32_16x16x32_bf16 v[96:99], a[208:211], a[176:179], v[96:99]
  ds_read_b64_tr_b16 a[200:201], v210 offset:57344
  ds_read_b64_tr_b16 a[202:203], v210 offset:61440
  v_mfma_f32_16x16x32_bf16 v[104:107], a[208:211], a[180:183], v[104:107]
  v_mfma_f32_16x16x32_bf16 v[100:103], a[212:215], a[176:179], v[100:103]
  ds_read_b64_tr_b16 a[204:205], v211 offset:57344
  ds_read_b64_tr_b16 a[206:207], v211 offset:61440
  v_mfma_f32_16x16x32_bf16 v[108:111], a[212:215], a[180:183], v[108:111]
  s_waitcnt lgkmcnt(8)
  v_mfma_f32_16x16x32_bf16 v[112:115], a[216:219], a[176:179], v[112:115]
  ds_read_b64_tr_b16 a[208:209], v212 offset:57344
  ds_read_b64_tr_b16 a[210:211], v212 offset:61440
  v_mfma_f32_16x16x32_bf16 v[120:123], a[216:219], a[180:183], v[120:123]
  v_mfma_f32_16x16x32_bf16 v[116:119], a[220:223], a[176:179], v[116:119]
  ds_read_b64_tr_b16 a[212:213], v213 offset:57344
  ds_read_b64_tr_b16 a[214:215], v213 offset:61440
  v_mfma_f32_16x16x32_bf16 v[124:127], a[220:223], a[180:183], v[124:127]
  s_waitcnt vmcnt(14) lgkmcnt(8)
  v_mfma_f32_16x16x32_bf16 v[64:67], a[192:195], a[184:187], v[64:67]
  ds_read_b64_tr_b16 a[216:217], v214 offset:57344
  ds_read_b64_tr_b16 a[218:219], v214 offset:61440
  v_mfma_f32_16x16x32_bf16 v[72:75], a[192:195], a[188:191], v[72:75]
  buffer_load_dwordx4 v[184:187], v3, s[28:31], s23 offen offset:0 sc1
  v_mfma_f32_16x16x32_bf16 v[68:71], a[196:199], a[184:187], v[68:71]
  ds_read_b64_tr_b16 a[220:221], v215 offset:57344
  ds_read_b64_tr_b16 a[222:223], v215 offset:61440
  v_mfma_f32_16x16x32_bf16 v[76:79], a[196:199], a[188:191], v[76:79]
  s_waitcnt lgkmcnt(8)
  v_mfma_f32_16x16x32_bf16 v[80:83], a[200:203], a[184:187], v[80:83]
  s_barrier
  v_mfma_f32_16x16x32_bf16 v[88:91], a[200:203], a[188:191], v[88:91]
  buffer_load_dwordx4 v[188:191], v3, s[28:31], s23 offen offset:1024 sc1
  v_mfma_f32_16x16x32_bf16 v[84:87], a[204:207], a[184:187], v[84:87]
  v_mfma_f32_16x16x32_bf16 v[92:95], a[204:207], a[188:191], v[92:95]
  s_waitcnt lgkmcnt(4)
  v_mfma_f32_16x16x32_bf16 v[96:99], a[208:211], a[184:187], v[96:99]
  v_mfma_f32_16x16x32_bf16 v[104:107], a[208:211], a[188:191], v[104:107]
  v_mfma_f32_16x16x32_bf16 v[100:103], a[212:215], a[184:187], v[100:103]
  v_mfma_f32_16x16x32_bf16 v[108:111], a[212:215], a[188:191], v[108:111]
  s_waitcnt lgkmcnt(0)
  v_mfma_f32_16x16x32_bf16 v[112:115], a[216:219], a[184:187], v[112:115]
  v_mfma_f32_16x16x32_bf16 v[120:123], a[216:219], a[188:191], v[120:123]
  v_mfma_f32_16x16x32_bf16 v[116:119], a[220:223], a[184:187], v[116:119]
  v_mfma_f32_16x16x32_bf16 v[124:127], a[220:223], a[188:191], v[124:127]
  s_mov_b32 s3, 0xffff0000
  s_waitcnt vmcnt(7)
  v_lshlrev_b32 v192, 16, v160
  v_and_b32 v193, s3, v160
  v_lshlrev_b32 v200, 16, v224
  v_and_b32 v201, s3, v224
  v_lshlrev_b32 v194, 16, v161
  v_and_b32 v195, s3, v161
  v_lshlrev_b32 v202, 16, v225
  v_and_b32 v203, s3, v225
  v_lshlrev_b32 v196, 16, v162
  v_and_b32 v197, s3, v162
  v_lshlrev_b32 v204, 16, v226
  v_and_b32 v205, s3, v226
  v_lshlrev_b32 v198, 16, v163
  v_and_b32 v199, s3, v163
  v_lshlrev_b32 v206, 16, v227
  v_and_b32 v207, s3, v227
  v_fmac_f32 v200, v64, v192
  v_fmac_f32 v201, v65, v193
  v_fmac_f32 v202, v66, v194
  v_fmac_f32 v203, v67, v195
  v_fmac_f32 v204, v68, v196
  v_fmac_f32 v205, v69, v197
  v_fmac_f32 v206, v70, v198
  v_fmac_f32 v207, v71, v199
  v_cvt_pk_bf16_f32 v224, v200, v201
  v_cvt_pk_bf16_f32 v225, v202, v203
  v_cvt_pk_bf16_f32 v226, v204, v205
  v_cvt_pk_bf16_f32 v227, v206, v207
  v_xor_b32 v208, 0, v36
  ds_write_b64 v208, v[224:225] offset:0
  v_xor_b32 v209, 32, v36
  ds_write_b64 v209, v[226:227] offset:0
  s_waitcnt vmcnt(6)
  v_lshlrev_b32 v192, 16, v164
  v_and_b32 v193, s3, v164
  v_lshlrev_b32 v200, 16, v228
  v_and_b32 v201, s3, v228
  v_lshlrev_b32 v194, 16, v165
  v_and_b32 v195, s3, v165
  v_lshlrev_b32 v202, 16, v229
  v_and_b32 v203, s3, v229
  v_lshlrev_b32 v196, 16, v166
  v_and_b32 v197, s3, v166
  v_lshlrev_b32 v204, 16, v230
  v_and_b32 v205, s3, v230
  v_lshlrev_b32 v198, 16, v167
  v_and_b32 v199, s3, v167
  v_lshlrev_b32 v206, 16, v231
  v_and_b32 v207, s3, v231
  v_fmac_f32 v200, v72, v192
  v_fmac_f32 v201, v73, v193
  v_fmac_f32 v202, v74, v194
  v_fmac_f32 v203, v75, v195
  v_fmac_f32 v204, v76, v196
  v_fmac_f32 v205, v77, v197
  v_fmac_f32 v206, v78, v198
  v_fmac_f32 v207, v79, v199
  v_cvt_pk_bf16_f32 v228, v200, v201
  v_cvt_pk_bf16_f32 v229, v202, v203
  v_cvt_pk_bf16_f32 v230, v204, v205
  v_cvt_pk_bf16_f32 v231, v206, v207
  ds_write_b64 v208, v[228:229] offset:4096
  ds_write_b64 v209, v[230:231] offset:4096
  s_waitcnt vmcnt(5)
  v_lshlrev_b32 v192, 16, v168
  v_and_b32 v193, s3, v168
  v_lshlrev_b32 v200, 16, v232
  v_and_b32 v201, s3, v232
  v_lshlrev_b32 v194, 16, v169
  v_and_b32 v195, s3, v169
  v_lshlrev_b32 v202, 16, v233
  v_and_b32 v203, s3, v233
  v_lshlrev_b32 v196, 16, v170
  v_and_b32 v197, s3, v170
  v_lshlrev_b32 v204, 16, v234
  v_and_b32 v205, s3, v234
  v_lshlrev_b32 v198, 16, v171
  v_and_b32 v199, s3, v171
  v_lshlrev_b32 v206, 16, v235
  v_and_b32 v207, s3, v235
  v_fmac_f32 v200, v80, v192
  v_fmac_f32 v201, v81, v193
  v_fmac_f32 v202, v82, v194
  v_fmac_f32 v203, v83, v195
  v_fmac_f32 v204, v84, v196
  v_fmac_f32 v205, v85, v197
  v_fmac_f32 v206, v86, v198
  v_fmac_f32 v207, v87, v199
  v_cvt_pk_bf16_f32 v232, v200, v201
  v_cvt_pk_bf16_f32 v233, v202, v203
  v_cvt_pk_bf16_f32 v234, v204, v205
  v_cvt_pk_bf16_f32 v235, v206, v207
  v_xor_b32 v208, 64, v36
  ds_write_b64 v208, v[232:233] offset:0
  v_xor_b32 v209, 96, v36
  ds_write_b64 v209, v[234:235] offset:0
  s_waitcnt vmcnt(4)
  v_lshlrev_b32 v192, 16, v172
  v_and_b32 v193, s3, v172
  v_lshlrev_b32 v200, 16, v236
  v_and_b32 v201, s3, v236
  v_lshlrev_b32 v194, 16, v173
  v_and_b32 v195, s3, v173
  v_lshlrev_b32 v202, 16, v237
  v_and_b32 v203, s3, v237
  v_lshlrev_b32 v196, 16, v174
  v_and_b32 v197, s3, v174
  v_lshlrev_b32 v204, 16, v238
  v_and_b32 v205, s3, v238
  v_lshlrev_b32 v198, 16, v175
  v_and_b32 v199, s3, v175
  v_lshlrev_b32 v206, 16, v239
  v_and_b32 v207, s3, v239
  v_fmac_f32 v200, v88, v192
  v_fmac_f32 v201, v89, v193
  v_fmac_f32 v202, v90, v194
  v_fmac_f32 v203, v91, v195
  v_fmac_f32 v204, v92, v196
  v_fmac_f32 v205, v93, v197
  v_fmac_f32 v206, v94, v198
  v_fmac_f32 v207, v95, v199
  v_cvt_pk_bf16_f32 v236, v200, v201
  v_cvt_pk_bf16_f32 v237, v202, v203
  v_cvt_pk_bf16_f32 v238, v204, v205
  v_cvt_pk_bf16_f32 v239, v206, v207
  ds_write_b64 v208, v[236:237] offset:4096
  ds_write_b64 v209, v[238:239] offset:4096
  s_waitcnt vmcnt(3)
  v_lshlrev_b32 v192, 16, v176
  v_and_b32 v193, s3, v176
  v_lshlrev_b32 v200, 16, v240
  v_and_b32 v201, s3, v240
  v_lshlrev_b32 v194, 16, v177
  v_and_b32 v195, s3, v177
  v_lshlrev_b32 v202, 16, v241
  v_and_b32 v203, s3, v241
  v_lshlrev_b32 v196, 16, v178
  v_and_b32 v197, s3, v178
  v_lshlrev_b32 v204, 16, v242
  v_and_b32 v205, s3, v242
  v_lshlrev_b32 v198, 16, v179
  v_and_b32 v199, s3, v179
  v_lshlrev_b32 v206, 16, v243
  v_and_b32 v207, s3, v243
  v_fmac_f32 v200, v96, v192
  v_fmac_f32 v201, v97, v193
  v_fmac_f32 v202, v98, v194
  v_fmac_f32 v203, v99, v195
  v_fmac_f32 v204, v100, v196
  v_fmac_f32 v205, v101, v197
  v_fmac_f32 v206, v102, v198
  v_fmac_f32 v207, v103, v199
  v_cvt_pk_bf16_f32 v240, v200, v201
  v_cvt_pk_bf16_f32 v241, v202, v203
  v_cvt_pk_bf16_f32 v242, v204, v205
  v_cvt_pk_bf16_f32 v243, v206, v207
  v_xor_b32 v208, 128, v36
  ds_write_b64 v208, v[240:241] offset:0
  v_xor_b32 v209, 160, v36
  ds_write_b64 v209, v[242:243] offset:0
  s_waitcnt vmcnt(2)
  v_lshlrev_b32 v192, 16, v180
  v_and_b32 v193, s3, v180
  v_lshlrev_b32 v200, 16, v244
  v_and_b32 v201, s3, v244
  v_lshlrev_b32 v194, 16, v181
  v_and_b32 v195, s3, v181
  v_lshlrev_b32 v202, 16, v245
  v_and_b32 v203, s3, v245
  v_lshlrev_b32 v196, 16, v182
  v_and_b32 v197, s3, v182
  v_lshlrev_b32 v204, 16, v246
  v_and_b32 v205, s3, v246
  v_lshlrev_b32 v198, 16, v183
  v_and_b32 v199, s3, v183
  v_lshlrev_b32 v206, 16, v247
  v_and_b32 v207, s3, v247
  v_fmac_f32 v200, v104, v192
  v_fmac_f32 v201, v105, v193
  v_fmac_f32 v202, v106, v194
  v_fmac_f32 v203, v107, v195
  v_fmac_f32 v204, v108, v196
  v_fmac_f32 v205, v109, v197
  v_fmac_f32 v206, v110, v198
  v_fmac_f32 v207, v111, v199
  v_cvt_pk_bf16_f32 v244, v200, v201
  v_cvt_pk_bf16_f32 v245, v202, v203
  v_cvt_pk_bf16_f32 v246, v204, v205
  v_cvt_pk_bf16_f32 v247, v206, v207
  ds_write_b64 v208, v[244:245] offset:4096
  ds_write_b64 v209, v[246:247] offset:4096
  s_waitcnt vmcnt(1)
  v_lshlrev_b32 v192, 16, v184
  v_and_b32 v193, s3, v184
  v_lshlrev_b32 v200, 16, v248
  v_and_b32 v201, s3, v248
  v_lshlrev_b32 v194, 16, v185
  v_and_b32 v195, s3, v185
  v_lshlrev_b32 v202, 16, v249
  v_and_b32 v203, s3, v249
  v_lshlrev_b32 v196, 16, v186
  v_and_b32 v197, s3, v186
  v_lshlrev_b32 v204, 16, v250
  v_and_b32 v205, s3, v250
  v_lshlrev_b32 v198, 16, v187
  v_and_b32 v199, s3, v187
  v_lshlrev_b32 v206, 16, v251
  v_and_b32 v207, s3, v251
  v_fmac_f32 v200, v112, v192
  v_fmac_f32 v201, v113, v193
  v_fmac_f32 v202, v114, v194
  v_fmac_f32 v203, v115, v195
  v_fmac_f32 v204, v116, v196
  v_fmac_f32 v205, v117, v197
  v_fmac_f32 v206, v118, v198
  v_fmac_f32 v207, v119, v199
  v_cvt_pk_bf16_f32 v248, v200, v201
  v_cvt_pk_bf16_f32 v249, v202, v203
  v_cvt_pk_bf16_f32 v250, v204, v205
  v_cvt_pk_bf16_f32 v251, v206, v207
  v_xor_b32 v208, 192, v36
  ds_write_b64 v208, v[248:249] offset:0
  v_xor_b32 v209, 224, v36
  ds_write_b64 v209, v[250:251] offset:0
  s_waitcnt vmcnt(0)
  v_lshlrev_b32 v192, 16, v188
  v_and_b32 v193, s3, v188
  v_lshlrev_b32 v200, 16, v252
  v_and_b32 v201, s3, v252
  v_lshlrev_b32 v194, 16, v189
  v_and_b32 v195, s3, v189
  v_lshlrev_b32 v202, 16, v253
  v_and_b32 v203, s3, v253
  v_lshlrev_b32 v196, 16, v190
  v_and_b32 v197, s3, v190
  v_lshlrev_b32 v204, 16, v254
  v_and_b32 v205, s3, v254
  v_lshlrev_b32 v198, 16, v191
  v_and_b32 v199, s3, v191
  v_lshlrev_b32 v206, 16, v255
  v_and_b32 v207, s3, v255
  v_fmac_f32 v200, v120, v192
  v_fmac_f32 v201, v121, v193
  v_fmac_f32 v202, v122, v194
  v_fmac_f32 v203, v123, v195
  v_fmac_f32 v204, v124, v196
  v_fmac_f32 v205, v125, v197
  v_fmac_f32 v206, v126, v198
  v_fmac_f32 v207, v127, v199
  v_cvt_pk_bf16_f32 v252, v200, v201
  v_cvt_pk_bf16_f32 v253, v202, v203
  v_cvt_pk_bf16_f32 v254, v204, v205
  v_cvt_pk_bf16_f32 v255, v206, v207
  ds_write_b64 v208, v[252:253] offset:4096
  ds_write_b64 v209, v[254:255] offset:4096
  v_xor_b32 v208, 0, v37
  ds_read_b128 v[160:163], v208 offset:0
  v_xor_b32 v209, 64, v37
  ds_read_b128 v[164:167], v209 offset:1024
  v_xor_b32 v210, 128, v37
  ds_read_b128 v[168:171], v210 offset:2048
  v_xor_b32 v211, 192, v37
  ds_read_b128 v[172:175], v211 offset:3072
  ds_read_b128 v[176:179], v208 offset:4096
  ds_read_b128 v[180:183], v209 offset:5120
  ds_read_b128 v[184:187], v210 offset:6144
  ds_read_b128 v[188:191], v211 offset:7168
  s_waitcnt lgkmcnt(7)
  buffer_store_dwordx4 v[160:163], v38, s[32:35], s65 offen sc1
  s_add_u32 s65, s65, 8192
  s_waitcnt lgkmcnt(6)
  buffer_store_dwordx4 v[164:167], v38, s[32:35], s65 offen sc1
  s_add_u32 s65, s65, 8192
  s_waitcnt lgkmcnt(5)
  buffer_store_dwordx4 v[168:171], v38, s[32:35], s65 offen sc1
  s_add_u32 s65, s65, 8192
  s_waitcnt lgkmcnt(4)
  buffer_store_dwordx4 v[172:175], v38, s[32:35], s65 offen sc1
  s_add_u32 s65, s65, 8192
  s_waitcnt lgkmcnt(3)
  buffer_store_dwordx4 v[176:179], v38, s[32:35], s65 offen sc1
  s_add_u32 s65, s65, 8192
  s_waitcnt lgkmcnt(2)
  buffer_store_dwordx4 v[180:183], v38, s[32:35], s65 offen sc1
  s_add_u32 s65, s65, 8192
  s_waitcnt lgkmcnt(1)
  buffer_store_dwordx4 v[184:187], v38, s[32:35], s65 offen sc1
  s_add_u32 s65, s65, 8192
  s_waitcnt lgkmcnt(0)
  buffer_store_dwordx4 v[188:191], v38, s[32:35], s65 offen sc1
  s_add_u32 s65, s65, 8192
  s_endpgm
L_code_end:
.section .rodata,"a"

.p2align 6
.amdhsa_kernel recurrent_scan__sliding_block_cached__mixer_token_mlp__prompt_kernel
  .amdhsa_next_free_vgpr 512
  .amdhsa_next_free_sgpr 102
  .amdhsa_accum_offset 256
  .amdhsa_group_segment_fixed_size 0
  .amdhsa_kernarg_size 104
  .amdhsa_user_sgpr_count 2
  .amdhsa_user_sgpr_kernarg_segment_ptr 1
  .amdhsa_system_sgpr_workgroup_id_x 1
.end_amdhsa_kernel
```
